```python
import torch

def _softmax(x, axis=-1):
    return torch.softmax(x, dim=axis)
def _gelu(x):
    return torch.nn.functional.gelu(x, approximate="tanh")
def _silu(x):
    return torch.nn.functional.silu(x)
def _sigmoid(x):
    return torch.sigmoid(x)
def _layernorm(x, axis=-1, eps=1e-5):
    m = x.mean(dim=axis, keepdim=True)
    v = x.var(dim=axis, keepdim=True, unbiased=False)
    return (x - m) / torch.sqrt(v + eps)
def _scatter_add(tgt, idx, src, axis=0):
    return tgt.clone().index_add_(axis, idx, src)
def _segment_sum(src, seg, n):
    out = torch.zeros((n,) + src.shape[1:], dtype=src.dtype)
    return out.index_add_(0, seg, src)
def _pad(x, pw):
    flat = tuple(v for pair in reversed(pw) for v in pair)
    return torch.nn.functional.pad(x, flat)

kernel_name = 'interleave_layers__ssm_conv_s5__ssm_conv_h3__prompt'

def setup_inputs():

    _w = (lambda a: (lambda t: t.to(torch.bfloat16) if t.is_floating_point() else t)(torch.as_tensor(a)))
    def _A_setup():
        B, S, D = 1, 2048, 640
        P = D
        Lambda_re = -0.5 * (lambda _x: torch.exp(torch.as_tensor(_x)))((lambda *s: torch.randn(*s, dtype=torch.bfloat16) * 0.2)(P))
        Lambda_im = (lambda *s: torch.randn(*s, dtype=torch.bfloat16) * 0.8)(P) * 1.0
        B_re = (lambda *s: torch.randn(*s, dtype=torch.bfloat16) * 0.2)(P, D) * (D ** -0.5)
        B_im = (lambda *s: torch.randn(*s, dtype=torch.bfloat16) * 0.2)(P, D) * (D ** -0.5)
        C_re = (lambda *s: torch.randn(*s, dtype=torch.bfloat16) * 0.2)(D, P) * (P ** -0.5)
        C_im = (lambda *s: torch.randn(*s, dtype=torch.bfloat16) * 0.2)(D, P) * (P ** -0.5)
        log_dt = (lambda *s: torch.randn(*s, dtype=torch.bfloat16) * 0.2)(P) * 0.3 - 2.0
        Dskip = (lambda *s: torch.randn(*s, dtype=torch.bfloat16) * 0.05)(D)
        return {
            "x": _w((lambda *s: torch.randn(*s, dtype=torch.bfloat16) * 0.05)(B, S, D)),
            "Lambda_re": _w(Lambda_re),
            "Lambda_im": _w(Lambda_im),
            "B_re": _w(B_re),
            "B_im": _w(B_im),
            "C_re": _w(C_re),
            "C_im": _w(C_im),
            "log_dt": _w(log_dt),
            "Dskip": _w(Dskip),
        }
    _A_in = _A_setup()

    def _B_setup():
        B, S, D = 1, 2048, 640
        ks = 4
        return {
            "q": _w((lambda *s: torch.randn(*s, dtype=torch.bfloat16) * 0.05)(B, S, D)),
            "k": _w((lambda *s: torch.randn(*s, dtype=torch.bfloat16) * 0.4)(B, S, D)),
            "v": _w((lambda *s: torch.randn(*s, dtype=torch.bfloat16) * 0.4)(B, S, D)),
            "shift_k": _w((lambda *s: torch.randn(*s, dtype=torch.bfloat16) * 0.4)(D, ks) * 0.5),
            "ssm_k": _w((lambda *s: torch.randn(*s, dtype=torch.bfloat16) * 0.4)(D, S) * (1.0 / S ** 0.5)),
            "ssm_D": _w((lambda *s: torch.randn(*s, dtype=torch.bfloat16) * 0.4)(D)),
        }
    _B_in = _B_setup()

    return {
        "A_x": _A_in["x"],
        "A_Lambda_re": _A_in["Lambda_re"],
        "A_Lambda_im": _A_in["Lambda_im"],
        "A_B_re": _A_in["B_re"],
        "A_B_im": _A_in["B_im"],
        "A_C_re": _A_in["C_re"],
        "A_C_im": _A_in["C_im"],
        "A_log_dt": _A_in["log_dt"],
        "A_Dskip": _A_in["Dskip"],
        "B_q": _B_in["q"],
        "B_k": _B_in["k"],
        "B_v": _B_in["v"],
        "B_shift_k": _B_in["shift_k"],
        "B_ssm_k": _B_in["ssm_k"],
        "B_ssm_D": _B_in["ssm_D"],
    }

def reference(A_x, A_Lambda_re, A_Lambda_im, A_B_re, A_B_im, A_C_re, A_C_im, A_log_dt, A_Dskip, B_q, B_k, B_v, B_shift_k, B_ssm_k, B_ssm_D):
    def _A_ref(x, Lambda_re, Lambda_im, B_re, B_im, C_re, C_im, log_dt, Dskip):
        Bsz, L, H = x.shape
        Lam = Lambda_re + 1j * Lambda_im
        Bmat = B_re + 1j * B_im
        Cmat = C_re + 1j * C_im
        dt = torch.exp(log_dt)
        Lam_bar = torch.exp(dt * Lam)
        B_bar = ((Lam_bar - 1.0) / Lam)[:, None] * Bmat
        Bu = torch.einsum("bld,pd->blp", x + 0j, B_bar)
        h = torch.zeros_like(Bu[:, 0, :])
        hs = []
        for t in range(L):
            h = Lam_bar[None, :] * h + Bu[:, t, :]
            hs.append(h)
        hseq = torch.stack(hs, 1)
        y = 2.0 * torch.einsum("blp,dp->bld", hseq, Cmat).real + x * Dskip[None, None, :]
        return y

    def _B_ref(q, k, v, shift_k, ssm_k, ssm_D):
        B, S, D = q.shape
        ks = shift_k.shape[-1]
        k_pad = _pad(k, ((0, 0), (ks - 1, 0), (0, 0)))
        k_shift = torch.zeros_like(k)
        for t in range(ks):
            k_shift = k_shift + k_pad[:, t:t + S, :] * shift_k[:, ks - 1 - t][None, None, :]
        kv = k_shift * v
        L = 2 * S
        kv_pad = _pad(kv, ((0, 0), (0, S), (0, 0)))
        kf_pad = _pad(ssm_k, ((0, 0), (0, S)))
        kv_f = (lambda x, axes=(-2,-1): torch.fft.rfft2(x.float(), dim=axes))(kv_pad[:, None, :, :], axes=(1, 2))
        kf_f = (lambda x, axes=(-2,-1): torch.fft.rfft2(x.float(), dim=axes))(kf_pad[:, None, :], axes=(1, 2))
        kf_f = (lambda x, *d: x.permute(*d))(kf_f, 1, 2, 0)
        y_f = kv_f * kf_f[None, :, :, :]
        y = (lambda x, s, axes=(-2,-1): torch.fft.irfft2(x, s=s, dim=axes).to(torch.bfloat16))(y_f, (1, L), axes=(1, 2))[:, 0, :S, :]
        y = y + kv * ssm_D[None, None, :]
        return q * y

    x = A_x
    x = x + _A_ref(_layernorm(x, axis=-1), A_Lambda_re, A_Lambda_im, A_B_re, A_B_im, A_C_re, A_C_im, A_log_dt, A_Dskip)
    x = x + _B_ref(_layernorm(x, axis=-1), B_k, B_v, B_shift_k, B_ssm_k, B_ssm_D)
    x = x + _A_ref(_layernorm(x, axis=-1), A_Lambda_re, A_Lambda_im, A_B_re, A_B_im, A_C_re, A_C_im, A_log_dt, A_Dskip)
    x = x + _B_ref(_layernorm(x, axis=-1), B_k, B_v, B_shift_k, B_ssm_k, B_ssm_D)
    return x
```

```asm
; @launch grid=(256,1,1) block=(256,1,1) lds=163840
.amdgcn_target "amdgcn-amd-amdhsa--gfx950"
.text
.globl interleave_layers__ssm_conv_s5__ssm_conv_h3__prompt_kernel
.p2align 8
.type interleave_layers__ssm_conv_s5__ssm_conv_h3__prompt_kernel,@function
interleave_layers__ssm_conv_s5__ssm_conv_h3__prompt_kernel:
  s_cmp_ge_u32 s2, 256
  s_cbranch_scc1 L_end
  s_load_dwordx16 s[16:31], s[0:1], 0
  s_load_dwordx16 s[32:47], s[0:1], 64
  s_load_dwordx4 s[48:51], s[0:1], 128
  v_and_b32 v1, 63, v0
  v_lshrrev_b32 v11, 6, v0
  v_lshlrev_b32 v2, 4, v1
  v_readfirstlane_b32 s7, v11
  v_and_b32 v3, 15, v1
  v_lshrrev_b32 v4, 4, v1
  s_and_b32 s12, s2, 7
  s_lshr_b32 s13, s2, 3
  s_and_b32 s4, s13, 15
  s_lshr_b32 s14, s13, 4
  s_lshl_b32 s3, s12, 1
  s_add_u32 s3, s3, s14
  s_lshr_b32 s14, s4, 3
  s_lshl_b32 s5, s3, 1
  s_add_u32 s5, s5, s14
  s_and_b32 s6, s4, 7
  s_mov_b32 s0, s12
  s_mov_b32 s1, s13
  s_getreg_b32 s11, hwreg(HW_REG_XCC_ID, 0, 4)
  s_mov_b32 s10, 524288
  s_mul_i32 s95, s4, 31
  s_add_u32 s95, s95, s3
  s_mul_i32 s95, s95, 768
  s_getpc_b64 s[98:99]
L_pc:
  s_and_b32 vcc_lo, s1, 7
  s_lshl_b32 vcc_lo, vcc_lo, 2
  s_add_u32 vcc_lo, vcc_lo, s7
  s_lshl_b32 vcc_lo, vcc_lo, 11
  v_lshl_add_u32 v15, v3, 7, vcc_lo
  v_min_u32 v15, L_codeend-L_pc-4, v15
  s_mov_b64 exec, 0xffff
  global_load_dword a250, v15, s[98:99]
  s_mov_b64 exec, -1
  s_mov_b32 s2, 0x3f803f80
  s_waitcnt lgkmcnt(0)
  s_load_dword s8, s[50:51], 0
  s_lshr_b32 s12, s1, 1
  s_mul_i32 s12, s12, 5
  s_mul_i32 s13, s0, 80
  s_add_u32 s12, s12, s13
  s_and_b32 s13, s1, 1
  s_lshl_b32 s13, s13, 1
  s_add_u32 s14, s13, s7
  s_cmp_lt_u32 s7, 2
  s_cselect_b32 s14, s14, 4
  s_add_u32 s74, s12, s14
  s_lshr_b32 s14, s7, 1
  s_add_u32 s14, s14, s13
  s_add_u32 s14, s14, s12
  s_lshl_b32 s14, s14, 1
  s_and_b32 s14, s14, 0xfffffffc
  s_load_dword s72, s[44:45], s14
  s_add_u32 s14, s12, 4
  s_lshl_b32 s14, s14, 1
  s_and_b32 s14, s14, 0xfffffffc
  s_load_dword s9, s[44:45], s14
  s_mov_b32 s97, s12
  s_mov_b32 s45, s13
  s_mul_i32 s34, s7, 4608
  s_add_u32 s34, s34, 61440
  s_lshl_b32 s73, s3, 8
  s_lshl_b32 s13, s4, 4
  s_add_u32 s73, s73, s13
  s_lshl_b32 s13, s7, 2
  s_add_u32 s73, s73, s13
  s_mov_b32 s80, s16
  s_and_b32 s81, s17, 0xffff
  s_mov_b32 s82, 2621440
  s_mov_b32 s83, 0x20000
  s_mov_b32 s52, s50
  s_and_b32 s53, s51, 0xffff
  s_mov_b32 s54, 41943040
  s_mov_b32 s55, 0x20000
  s_mov_b32 s56, s22
  s_and_b32 s57, s23, 0xffff
  s_mov_b32 s58, 819200
  s_mov_b32 s59, 0x20000
  s_mov_b32 s60, s24
  s_and_b32 s61, s25, 0xffff
  s_mov_b32 s62, 819200
  s_mov_b32 s63, 0x20000
  v_mov_b32 v185, 0
  s_cmp_lt_u32 s7, 2
  s_cbranch_scc1 ln_1
  s_cmp_eq_u32 s7, 2
  s_cbranch_scc1 w2_2
  s_mov_b32 s64, s36
  s_and_b32 s65, s37, 0xffff
  s_mov_b32 s66, 2621440
  s_mov_b32 s67, 0x20000
  s_mov_b32 s68, s38
  s_and_b32 s69, s39, 0xffff
  s_mov_b32 s70, 2621440
  s_mov_b32 s71, 0x20000
  s_mul_i32 s13, s1, 81920
  s_mul_i32 s14, s0, 160
  s_add_u32 s13, s13, s14
  v_mul_u32_u24 v11, 205, v1
  v_lshrrev_b32 v11, 11, v11
  v_mul_u32_u24 v11, 1120, v11
  v_add3_u32 v11, v11, v2, s13
  v_subrev_u32 v12, 3840, v11
  v_add_u32 v13, 3840, v11
  s_mov_b32 exec_hi, 0x0fffffff
  s_mov_b32 m0, 77824
  s_mov_b32 s12, 0
  buffer_load_dwordx4 v12, s[64:67], s12 offen nt lds
  s_mov_b32 m0, 89344
  s_mov_b32 s12, 0
  buffer_load_dwordx4 v11, s[68:71], s12 offen nt lds
  s_mov_b32 m0, 78784
  s_mov_b32 s12, 0
  buffer_load_dwordx4 v13, s[64:67], s12 offen nt lds
  s_mov_b32 m0, 90304
  s_mov_b32 s12, 7680
  buffer_load_dwordx4 v11, s[68:71], s12 offen nt lds
  s_mov_b32 m0, 79744
  s_mov_b32 s12, 7680
  buffer_load_dwordx4 v13, s[64:67], s12 offen nt lds
  s_mov_b32 m0, 91264
  s_mov_b32 s12, 15360
  buffer_load_dwordx4 v11, s[68:71], s12 offen nt lds
  s_mov_b32 m0, 80704
  s_mov_b32 s12, 15360
  buffer_load_dwordx4 v13, s[64:67], s12 offen nt lds
  s_mov_b32 m0, 92224
  s_mov_b32 s12, 23040
  buffer_load_dwordx4 v11, s[68:71], s12 offen nt lds
  s_mov_b32 m0, 81664
  s_mov_b32 s12, 23040
  buffer_load_dwordx4 v13, s[64:67], s12 offen nt lds
  s_mov_b32 m0, 93184
  s_mov_b32 s12, 30720
  buffer_load_dwordx4 v11, s[68:71], s12 offen nt lds
  s_mov_b32 m0, 82624
  s_mov_b32 s12, 30720
  buffer_load_dwordx4 v13, s[64:67], s12 offen nt lds
  s_mov_b32 m0, 94144
  s_mov_b32 s12, 38400
  buffer_load_dwordx4 v11, s[68:71], s12 offen nt lds
  s_mov_b32 m0, 83584
  s_mov_b32 s12, 38400
  buffer_load_dwordx4 v13, s[64:67], s12 offen nt lds
  s_mov_b32 m0, 95104
  s_mov_b32 s12, 46080
  buffer_load_dwordx4 v11, s[68:71], s12 offen nt lds
  s_mov_b32 m0, 84544
  s_mov_b32 s12, 46080
  buffer_load_dwordx4 v13, s[64:67], s12 offen nt lds
  s_mov_b32 m0, 96064
  s_mov_b32 s12, 53760
  buffer_load_dwordx4 v11, s[68:71], s12 offen nt lds
  s_mov_b32 m0, 85504
  s_mov_b32 s12, 53760
  buffer_load_dwordx4 v13, s[64:67], s12 offen nt lds
  s_mov_b32 m0, 97024
  s_mov_b32 s12, 61440
  buffer_load_dwordx4 v11, s[68:71], s12 offen nt lds
  s_mov_b32 m0, 86464
  s_mov_b32 s12, 61440
  buffer_load_dwordx4 v13, s[64:67], s12 offen nt lds
  s_mov_b32 m0, 97984
  s_mov_b32 s12, 69120
  buffer_load_dwordx4 v11, s[68:71], s12 offen nt lds
  s_mov_b32 exec_hi, 0x0fffffff
  s_mov_b32 m0, 87424
  s_mov_b32 s12, 69120
  buffer_load_dwordx4 v13, s[64:67], s12 offen nt lds
  s_mov_b32 exec_hi, 0xff
  s_mov_b32 m0, 98944
  s_mov_b32 s12, 76800
  buffer_load_dwordx4 v11, s[68:71], s12 offen nt lds
  s_mov_b32 s68, s40
  s_and_b32 s69, s41, 0xffff
  s_mov_b32 s70, 5120
  s_mov_b32 s71, 0x20000
  s_mul_i32 s13, s0, 640
  s_mov_b32 m0, 99904
  s_nop 0
  buffer_load_dwordx4 v2, s[68:71], s13 offen nt lds
  s_mov_b64 exec, 0x3ff
  s_mov_b32 m0, 88384
  s_mov_b32 s12, 76800
  buffer_load_dwordx4 v13, s[64:67], s12 offen nt lds
  s_mov_b64 exec, -1
  s_branch join_3
w2_2:
  v_min_u32 v11, 39, v1
  s_mul_i32 s12, s4, 80
  v_lshl_add_u32 v14, v11, 1, s12
  global_load_ushort v42, v14, s[18:19] nt
  global_load_ushort v43, v14, s[20:21] nt
  global_load_ushort v44, v14, s[30:31] nt
  s_branch join_3
ln_1:
  v_lshrrev_b32 v12, 1, v1
  v_and_b32 v11, 1, v1
  v_lshlrev_b32 v11, 7, v11
  v_lshl_add_u32 v11, v12, 12, v11
  s_lshl_b32 s12, s3, 8
  s_add_u32 s12, s12, 4096
  v_add_u32 v11, s12, v11
  s_lshl_b32 s12, s0, 9
  s_add_u32 s12, s12, 27648
  v_lshl_add_u32 v12, v1, 7, s12
  v_cmp_lt_u32 vcc, 7, v1
  s_lshl_b32 s12, s0, 8
  s_add_u32 s12, s12, 294912
  v_cndmask_b32 v11, v11, v12, vcc
  v_mov_b32 v12, s12
  v_cmp_lt_u32 vcc, 11, v1
  s_nop 1
  v_cndmask_b32 v11, v11, v12, vcc
  buffer_load_dword a250, v11, s[52:55], 0 offen nt
join_3:
  s_lshl_b32 s12, s5, 6
  s_lshr_b32 s13, s7, 1
  s_lshl_b32 s13, s13, 5
  s_add_u32 s12, s12, s13
  s_and_b32 s13, s7, 1
  s_lshl_b32 s13, s13, 2
  s_add_u32 s12, s12, s13
  s_mul_i32 s12, s12, 1280
  s_mul_i32 s13, s6, 160
  s_add_u32 s12, s12, s13
  v_add_u32_e64 v11, 0, v1
  v_mul_u32_u24 v12, 205, v11
  v_lshrrev_b32 v12, 11, v12
  v_lshrrev_b32 v13, 2, v12
  v_mul_u32_u24 v12, 1120, v12
  v_mul_u32_u24 v13, 5120, v13
  v_lshlrev_b32_e64 v11, 4, v11
  v_add3_u32 v11, v11, v12, v13
  v_add_u32 v174, s12, v11
  v_add_u32 v11, 64, v1
  v_mul_u32_u24 v12, 205, v11
  v_lshrrev_b32 v12, 11, v12
  v_lshrrev_b32 v13, 2, v12
  v_mul_u32_u24 v12, 1120, v12
  v_mul_u32_u24 v13, 5120, v13
  v_lshlrev_b32_e64 v11, 4, v11
  v_add3_u32 v11, v11, v12, v13
  v_add_u32_e64 v175, s12, v11
  v_add_u32 v11, 128, v1
  v_mul_u32_u24 v12, 205, v11
  v_lshrrev_b32 v12, 11, v12
  v_lshrrev_b32 v13, 2, v12
  v_mul_u32_u24 v12, 1120, v12
  v_mul_u32_u24 v13, 5120, v13
  v_lshlrev_b32_e64 v11, 4, v11
  v_add3_u32 v11, v11, v12, v13
  v_add_u32 v176, s12, v11
  s_mov_b32 s44, s7
  s_lshl_b32 s17, s6, 9
  s_lshl_b32 s13, s7, 2
  s_add_u32 s17, s17, s13
  s_lshl_b32 s13, s5, 4
  s_add_u32 s17, s17, s13
  s_lshl_b32 s16, s0, 9
  s_lshl_b32 s13, s7, 2
  s_add_u32 s16, s16, s13
  s_lshl_b32 s13, s1, 4
  s_add_u32 s16, s16, s13
  s_lshl_b32 s12, s5, 2
  s_add_u32 s12, s12, s7
  s_min_u32 s12, s12, 99
  s_mul_i32 s13, s12, 205
  s_lshr_b32 s13, s13, 10
  s_mul_i32 s14, s13, 5
  s_sub_u32 s14, s12, s14
  s_mul_i32 s96, s6, 200
  s_mul_i32 s15, s13, 10
  s_add_u32 s96, s96, s15
  s_add_u32 s96, s96, s14
  s_lshl_b32 s96, s96, 10
  s_add_u32 s96, s96, 23068672
  s_mul_i32 s15, s6, 5
  s_add_u32 s15, s15, s14
  s_mul_i32 s15, s15, 20480
  s_lshl_b32 s13, s13, 6
  s_add_u32 s15, s15, s13
  v_mul_u32_u24 v14, 1280, v3
  v_lshl_add_u32 v14, v4, 4, v14
  v_add_u32 v247, s15, v14
  v_lshrrev_b32 v11, 3, v1
  v_and_b32 v12, 7, v1
  v_lshrrev_b32 v13, 1, v11
  v_lshlrev_b32 v13, 1, v13
  s_movk_i32 s15, 0x78
  v_bfe_u32 v13, s15, v13, 2
  v_xor_b32 v12, v12, v13
  v_mul_u32_u24 v11, 1280, v11
  v_lshl_add_u32 v45, v12, 4, v11
  v_xor_b32 v46, 64, v45
  s_bitcmp1_b32 s7, 0
  s_cselect_b32 s64, s60, s56
  s_cselect_b32 s65, s61, s57
  s_mov_b32 s66, 819200
  s_mov_b32 s67, 0x20000
  s_cselect_b32 s30, 1024, 0
  s_cselect_b32 vcc_lo, -1, 0
  s_cselect_b32 vcc_hi, -1, 0
  s_mul_i32 s31, s4, 51200
  v_cndmask_b32 v47, v45, v46, vcc
  s_mul_i32 s12, s0, 80
  s_lshl_b32 s13, s44, 5
  s_add_u32 s12, s12, s13
  s_lshl_b32 s12, s12, 12
  s_lshl_b32 s13, s1, 7
  s_sub_u32 s12, s12, s13
  s_add_u32 s12, s12, 4198272
  s_cmp_lt_u32 s44, 3
  s_cselect_b32 s36, s12, 1879048192
  s_cmp_lt_u32 s44, 2
  s_cselect_b32 s13, 0, 1879048192
  v_cmp_lt_u32 vcc, 31, v1
  v_mov_b32 v13, s13
  s_nop 0
  v_cndmask_b32 v13, 0, v13, vcc
  s_cmp_lt_u32 s5, 25
  s_cselect_b32 s38, s96, 1879048192
  s_add_u32 s95, s95, 327680
  s_cmp_lt_u32 s3, 15
  s_cselect_b32 s37, s95, 1879048192
  v_lshrrev_b32 v11, 3, v1
  v_and_b32 v12, 7, v1
  v_lshlrev_b32_e64 v12, 4, v12
  v_lshl_add_u32 v211, v11, 14, v12
  v_add_u32 v211, v211, v13
  v_mov_b32 v248, 0
  v_mov_b32 v249, 0
  v_min_u32 v222, 39, v1
  v_lshlrev_b32 v222, 4, v222
  v_and_b32 v223, 31, v1
  v_lshlrev_b32 v223, 4, v223
  s_lshr_b32 s12, s7, 1
  s_mul_i32 s13, s12, 10240
  s_add_u32 s40, s30, s13
  s_lshl_b32 s12, s12, 7
  s_add_u32 s41, s31, s12
  s_mul_i32 s12, s7, 6
  s_add_u32 s12, s12, 0
  s_lshr_b32 s13, s12, 3
  s_and_b32 s12, s12, 7
  s_add_u32 s14, s13, s45
  s_cmp_lt_u32 s13, 2
  s_cselect_b32 s14, s14, 4
  s_add_u32 s14, s14, s97
  s_lshl_b32 s14, s14, 12
  s_add_u32 s14, s14, 4194304
  s_cmp_lt_u32 s12, 6
  s_cselect_b32 s20, s14, 1879048192
  s_lshl_b32 s12, s12, 6
  v_add_u32_e64 v11, s12, v1
  v_mul_u32_u24 v12, 171, v11
  v_lshrrev_b32 v12, 10, v12
  v_lshlrev_b32 v12, 1, v12
  v_sub_u32 v11, v11, v12
  v_lshlrev_b32 v216, 4, v11
  s_mul_i32 s12, s7, 6
  s_add_u32 s12, s12, 1
  s_lshr_b32 s13, s12, 3
  s_and_b32 s12, s12, 7
  s_add_u32 s14, s13, s45
  s_cmp_lt_u32 s13, 2
  s_cselect_b32 s14, s14, 4
  s_add_u32 s14, s14, s97
  s_lshl_b32 s14, s14, 12
  s_add_u32 s14, s14, 4194304
  s_cmp_lt_u32 s12, 6
  s_cselect_b32 s21, s14, 1879048192
  s_lshl_b32 s12, s12, 6
  v_add_u32 v11, s12, v1
  v_mul_u32_u24 v12, 171, v11
  v_lshrrev_b32 v12, 10, v12
  v_lshlrev_b32 v12, 1, v12
  v_sub_u32 v11, v11, v12
  v_lshlrev_b32 v217, 4, v11
  s_mul_i32 s12, s7, 6
  s_add_u32 s12, s12, 2
  s_lshr_b32 s13, s12, 3
  s_and_b32 s12, s12, 7
  s_add_u32 s14, s13, s45
  s_cmp_lt_u32 s13, 2
  s_cselect_b32 s14, s14, 4
  s_add_u32 s14, s14, s97
  s_lshl_b32 s14, s14, 12
  s_add_u32 s14, s14, 4194304
  s_cmp_lt_u32 s12, 6
  s_cselect_b32 s22, s14, 1879048192
  s_lshl_b32 s12, s12, 6
  v_add_u32 v11, s12, v1
  v_mul_u32_u24 v12, 171, v11
  v_lshrrev_b32 v12, 10, v12
  v_lshlrev_b32 v12, 1, v12
  v_sub_u32 v11, v11, v12
  v_lshlrev_b32 v218, 4, v11
  s_mul_i32 s12, s7, 6
  s_add_u32 s12, s12, 3
  s_lshr_b32 s13, s12, 3
  s_and_b32 s12, s12, 7
  s_add_u32 s14, s13, s45
  s_cmp_lt_u32 s13, 2
  s_cselect_b32 s14, s14, 4
  s_add_u32 s14, s14, s97
  s_lshl_b32 s14, s14, 12
  s_add_u32 s14, s14, 4194304
  s_cmp_lt_u32 s12, 6
  s_cselect_b32 s23, s14, 1879048192
  s_lshl_b32 s12, s12, 6
  v_add_u32 v11, s12, v1
  v_mul_u32_u24 v12, 171, v11
  v_lshrrev_b32 v12, 10, v12
  v_lshlrev_b32 v12, 1, v12
  v_sub_u32 v11, v11, v12
  v_lshlrev_b32 v219, 4, v11
  s_mul_i32 s12, s7, 6
  s_add_u32 s12, s12, 4
  s_lshr_b32 s13, s12, 3
  s_and_b32 s12, s12, 7
  s_add_u32 s14, s13, s45
  s_cmp_lt_u32 s13, 2
  s_cselect_b32 s14, s14, 4
  s_add_u32 s14, s14, s97
  s_lshl_b32 s14, s14, 12
  s_add_u32 s14, s14, 4194304
  s_cmp_lt_u32 s12, 6
  s_cselect_b32 s24, s14, 1879048192
  s_lshl_b32 s12, s12, 6
  v_add_u32 v11, s12, v1
  v_mul_u32_u24 v12, 171, v11
  v_lshrrev_b32 v12, 10, v12
  v_lshlrev_b32 v12, 1, v12
  v_sub_u32 v11, v11, v12
  v_lshlrev_b32 v220, 4, v11
  s_mul_i32 s12, s7, 6
  s_add_u32 s12, s12, 5
  s_lshr_b32 s13, s12, 3
  s_and_b32 s12, s12, 7
  s_add_u32 s14, s13, s45
  s_cmp_lt_u32 s13, 2
  s_cselect_b32 s14, s14, 4
  s_add_u32 s14, s14, s97
  s_lshl_b32 s14, s14, 12
  s_add_u32 s14, s14, 4194304
  s_cmp_lt_u32 s12, 6
  s_cselect_b32 s25, s14, 1879048192
  s_lshl_b32 s12, s12, 6
  v_add_u32 v11, s12, v1
  v_mul_u32_u24 v12, 171, v11
  v_lshrrev_b32 v12, 10, v12
  v_lshlrev_b32 v12, 1, v12
  v_sub_u32 v11, v11, v12
  v_lshlrev_b32 v221, 4, v11
  s_lshl_b32 s12, s74, 12
  s_add_u32 s68, s42, s12
  s_addc_u32 s69, s43, 0
  s_and_b32 s69, s69, 0xffff
  s_mov_b32 s70, 4096
  s_mov_b32 s71, 0x20000
  v_and_b32 v11, 1, v3
  v_lshrrev_b32 v12, 1, v3
  v_lshrrev_b32 v13, 2, v3
  v_lshlrev_b32 v13, 1, v13
  s_movk_i32 s15, 0x78
  v_bfe_u32 v13, s15, v13, 2
  v_xor_b32_e64 v13, v13, v4
  v_lshl_add_u32 v13, v11, 2, v13
  v_lshlrev_b32_e64 v13, 4, v13
  v_lshl_add_u32 v13, v12, 7, v13
  v_lshl_add_u32 v5, v11, 10, v13
  v_xor_b32_e64 v6, 64, v5
  v_add_u32 v7, 51200, v5
  v_add_u32 v8, 51200, v6
  v_mul_u32_u24 v9, 144, v12
  v_lshl_add_u32 v9, v11, 2, v9
  v_lshl_add_u32 v9, v4, 3, v9
  s_lshl_b32 s12, s7, 5
  s_add_u32 s12, s12, 158080
  v_add_u32 v9, s12, v9
  v_lshrrev_b32_e64 v11, 2, v3
  v_mul_u32_u24 v11, 5120, v11
  v_and_b32_e64 v12, 3, v3
  v_lshl_add_u32 v11, v12, 4, v11
  v_lshl_add_u32 v0, v4, 6, v11
  s_lshl_b32 s12, s3, 2
  s_add_u32 s12, s12, s7
  s_mul_i32 s12, s12, 81920
  s_mul_i32 s13, s4, 5
  s_add_u32 s14, s13, 0
  s_lshr_b32 s15, s14, 2
  s_lshl_b32 s15, s15, 11
  s_and_b32 s14, s14, 3
  s_lshl_b32 s14, s14, 8
  s_add_u32 s14, s14, s15
  s_add_u32 s75, s14, s12
  s_add_u32 s14, s13, 1
  s_lshr_b32 s15, s14, 2
  s_lshl_b32 s15, s15, 11
  s_and_b32 s14, s14, 3
  s_lshl_b32 s14, s14, 8
  s_add_u32 s14, s14, s15
  s_add_u32 s76, s14, s12
  s_add_u32 s14, s13, 2
  s_lshr_b32 s15, s14, 2
  s_lshl_b32 s15, s15, 11
  s_and_b32 s14, s14, 3
  s_lshl_b32 s14, s14, 8
  s_add_u32 s14, s14, s15
  s_add_u32 s77, s14, s12
  s_add_u32 s14, s13, 3
  s_lshr_b32 s15, s14, 2
  s_lshl_b32 s15, s15, 11
  s_and_b32 s14, s14, 3
  s_lshl_b32 s14, s14, 8
  s_add_u32 s14, s14, s15
  s_add_u32 s78, s14, s12
  s_add_u32 s14, s13, 4
  s_lshr_b32 s15, s14, 2
  s_lshl_b32 s15, s15, 11
  s_and_b32 s14, s14, 3
  s_lshl_b32 s14, s14, 8
  s_add_u32 s14, s14, s15
  s_add_u32 s79, s14, s12
  s_lshl_b32 s12, s5, 5
  s_lshl_b32 s13, s6, 2
  s_add_u32 s12, s12, s13
  s_add_u32 s35, s12, s7
  v_lshrrev_b32 v11, 3, v1
  v_and_b32 v12, 6, v11
  v_xor_b32 v12, v12, v1
  v_and_b32 v12, 7, v12
  v_lshrrev_b32_e64 v13, 2, v11
  v_lshl_add_u32 v11, v13, 2, v11
  v_mul_u32_u24 v11, 1280, v11
  v_lshl_add_u32 v186, v12, 4, v11
  s_mul_i32 s19, s7, 14336
  s_add_u32 s19, s19, 102400
  v_and_b32 v11, 6, v3
  v_xor_b32 v11, v11, v4
  v_lshlrev_b32_e64 v11, 4, v11
  v_lshl_add_u32 v11, v3, 7, v11
  v_add_u32 v184, s19, v11
  v_xor_b32 v189, 64, v184
  s_lshl_b32 s18, s3, 2
  s_add_u32 s18, s18, s7
  s_mul_i32 s18, s18, 40960
  v_mul_u32_u24 v187, 160, v3
  v_lshl_add_u32 v187, v4, 3, v187
  v_add_u32 v187, s19, v187
  s_cmp_lt_u32 s7, 2
  s_cbranch_scc1 ln_4
  s_cmp_eq_u32 s7, 2
  s_cbranch_scc1 w2_5
  s_lshl_b32 s12, s3, 4
  s_add_u32 s12, s12, s4
  s_mul_i32 s12, s12, 10240
  v_lshrrev_b32 v11, 3, v1
  v_mul_u32_u24 v11, 1280, v11
  v_and_b32_e64 v12, 7, v1
  v_lshl_add_u32 v11, v12, 4, v11
  buffer_load_dwordx4 v[128:131], v11, s[80:83], s12 offen offset:0
  buffer_load_dwordx4 v[132:135], v11, s[80:83], s12 offen offset:128
  buffer_load_dwordx4 v[136:139], v11, s[80:83], s12 offen offset:256
  buffer_load_dwordx4 v[140:143], v11, s[80:83], s12 offen offset:384
  buffer_load_dwordx4 v[144:147], v11, s[80:83], s12 offen offset:512
  buffer_load_dwordx4 v[148:151], v11, s[80:83], s12 offen offset:640
  buffer_load_dwordx4 v[152:155], v11, s[80:83], s12 offen offset:768
  buffer_load_dwordx4 v[156:159], v11, s[80:83], s12 offen offset:896
  buffer_load_dwordx4 v[160:163], v11, s[80:83], s12 offen offset:1024
  buffer_load_dwordx4 v[164:167], v11, s[80:83], s12 offen offset:1152
  s_waitcnt lgkmcnt(0)
  s_lshr_b32 s8, s8, 4
  s_mul_i32 s8, s8, 0x19660d
  s_add_u32 s8, s8, 0x3c6ef35f
  s_lshl_b32 s8, s8, 4
  s_lshr_b32 s12, s7, 1
  s_add_u32 s12, s12, s97
  s_bitcmp1_b32 s12, 0
  s_cselect_b32 s12, 16, 0
  s_lshr_b32 s72, s72, s12
  s_and_b32 s72, s72, 0xffff
  s_bitcmp1_b32 s97, 0
  s_cselect_b32 s12, 16, 0
  s_lshr_b32 s9, s9, s12
  s_lshl_b32 s9, s9, 16
  s_or_b32 s72, s72, s9
  s_branch join_6
w2_5:
  s_waitcnt lgkmcnt(0)
  s_lshr_b32 s8, s8, 4
  s_mul_i32 s8, s8, 0x19660d
  s_add_u32 s8, s8, 0x3c6ef35f
  s_lshl_b32 s8, s8, 4
  s_lshr_b32 s12, s7, 1
  s_add_u32 s12, s12, s97
  s_bitcmp1_b32 s12, 0
  s_cselect_b32 s12, 16, 0
  s_lshr_b32 s72, s72, s12
  s_and_b32 s72, s72, 0xffff
  s_bitcmp1_b32 s97, 0
  s_cselect_b32 s12, 16, 0
  s_lshr_b32 s9, s9, s12
  s_lshl_b32 s9, s9, 16
  s_or_b32 s72, s72, s9
  s_lshl_b32 s12, s0, 8
  s_lshl_b32 s13, s1, 2
  s_add_u32 s12, s12, s13
  s_add_u32 s12, s12, 294912
  s_or_b32 s13, s8, s11
  v_mov_b32 v15, s13
  s_mov_b64 exec, 1
  buffer_store_dword v15, off, s[52:55], s12 offset:128 sc1
  s_mov_b64 exec, -1
  s_waitcnt vmcnt(1)
  v_lshlrev_b32 v42, 16, v42
  v_lshlrev_b32 v43, 16, v43
  v_lshlrev_b32 v44, 16, v44
  v_mul_f32 v44, 0x3fb8aa3b, v44
  v_exp_f32 v44, v44
  s_nop 0
  v_cvt_pk_bf16_f32 v44, v44, v44
  v_and_b32 v44, 0xffff0000, v44
  v_mul_f32 v88, v44, v42
  v_mul_f32 v89, v44, v43
  v_mul_f32 v88, 0x3fb8aa3b, v88
  v_mul_f32 v89, 0x3e22f983, v89
  v_mul_f32 v90, 1.0, v88
  v_mul_f32 v91, 1.0, v89
  v_exp_f32 v90, v90
  v_fract_f32 v91, v91
  v_sin_f32 v92, v91
  v_cos_f32 v93, v91
  v_mul_f32 v97, v90, v92
  v_mul_f32_e64 v96, v90, v93
  v_mul_f32 v90, 0x41000000, v88
  v_mul_f32 v91, 0x41000000, v89
  v_exp_f32 v90, v90
  v_fract_f32 v91, v91
  v_sin_f32 v92, v91
  v_cos_f32 v93, v91
  v_mul_f32 v37, v90, v92
  v_mul_f32 v36, v90, v93
  v_mul_f32 v90, 0x43000000, v88
  v_mul_f32 v91, 0x43000000, v89
  v_exp_f32 v90, v90
  v_fract_f32 v91, v91
  v_sin_f32 v92, v91
  v_cos_f32 v93, v91
  v_mul_f32 v39, v90, v92
  v_mul_f32 v38, v90, v93
  v_mul_f32 v90, v42, v42
  v_fmac_f32 v90, v43, v43
  v_rcp_f32 v90, v90
  v_add_f32 v91, -1.0, v96
  v_add_f32 v90, v90, v90
  v_mul_f32 v92, v91, v42
  v_fmac_f32 v92, v97, v43
  v_mul_f32 v93, v97, v42
  v_fma_f32 v93, -v91, v43, v93
  v_mul_f32 v98, v90, v92
  v_mul_f32 v99, v90, v93
  v_min_u32 v11, 39, v1
  v_lshlrev_b32 v11, 5, v11
  v_add_u32 v11, 160000, v11
  ds_write_b128 v11, v[96:99]
  ds_write_b128 v11, v[36:39] offset:16
  s_waitcnt lgkmcnt(0)
  s_branch join_6
ln_4:
  s_cmp_eq_u32 s7, 0
  s_cbranch_scc1 skip_7
  s_add_u32 s14, s31, 0
  s_mov_b32 m0, 0
  s_nop 0
  buffer_load_dwordx4 v45, s[56:59], s14 offen lds
  s_mov_b32 m0, 1024
  s_nop 0
  buffer_load_dwordx4 v46, s[60:63], s14 offen lds
  s_add_u32 s14, s31, 10240
  s_mov_b32 m0, 2048
  s_nop 0
  buffer_load_dwordx4 v45, s[56:59], s14 offen lds
  s_mov_b32 m0, 3072
  s_nop 0
  buffer_load_dwordx4 v46, s[60:63], s14 offen lds
  s_add_u32 s14, s31, 20480
  s_mov_b32 m0, 4096
  s_nop 0
  buffer_load_dwordx4 v45, s[56:59], s14 offen lds
  s_mov_b32 m0, 5120
  s_nop 0
  buffer_load_dwordx4 v46, s[60:63], s14 offen lds
  s_add_u32 s14, s31, 30720
  s_mov_b32 m0, 6144
  s_nop 0
  buffer_load_dwordx4 v45, s[56:59], s14 offen lds
  s_mov_b32 m0, 7168
  s_nop 0
  buffer_load_dwordx4 v46, s[60:63], s14 offen lds
  s_add_u32 s14, s31, 40960
  s_mov_b32 m0, 8192
  s_nop 0
  buffer_load_dwordx4 v45, s[56:59], s14 offen lds
  s_mov_b32 m0, 9216
  s_nop 0
  buffer_load_dwordx4 v46, s[60:63], s14 offen lds
  s_add_u32 s14, s31, 128
  s_mov_b32 m0, 10240
  s_nop 0
  buffer_load_dwordx4 v45, s[56:59], s14 offen lds
  s_mov_b32 m0, 11264
  s_nop 0
  buffer_load_dwordx4 v46, s[60:63], s14 offen lds
  s_add_u32 s14, s31, 10368
  s_mov_b32 m0, 12288
  s_nop 0
  buffer_load_dwordx4 v45, s[56:59], s14 offen lds
  s_mov_b32 m0, 13312
  s_nop 0
  buffer_load_dwordx4 v46, s[60:63], s14 offen lds
  s_add_u32 s14, s31, 20608
  s_mov_b32 m0, 14336
  s_nop 0
  buffer_load_dwordx4 v45, s[56:59], s14 offen lds
  s_mov_b32 m0, 15360
  s_nop 0
  buffer_load_dwordx4 v46, s[60:63], s14 offen lds
  s_add_u32 s14, s31, 30848
  s_mov_b32 m0, 16384
  s_nop 0
  buffer_load_dwordx4 v45, s[56:59], s14 offen lds
  s_mov_b32 m0, 17408
  s_nop 0
  buffer_load_dwordx4 v46, s[60:63], s14 offen lds
  s_add_u32 s14, s31, 41088
  s_mov_b32 m0, 18432
  s_nop 0
  buffer_load_dwordx4 v45, s[56:59], s14 offen lds
  s_mov_b32 m0, 19456
  s_nop 0
  buffer_load_dwordx4 v46, s[60:63], s14 offen lds
skip_7:
  s_waitcnt lgkmcnt(0)
  s_lshr_b32 s8, s8, 4
  s_mul_i32 s8, s8, 0x19660d
  s_add_u32 s8, s8, 0x3c6ef35f
  s_lshl_b32 s8, s8, 4
  s_lshr_b32 s12, s7, 1
  s_add_u32 s12, s12, s97
  s_bitcmp1_b32 s12, 0
  s_cselect_b32 s12, 16, 0
  s_lshr_b32 s72, s72, s12
  s_and_b32 s72, s72, 0xffff
  s_bitcmp1_b32 s97, 0
  s_cselect_b32 s12, 16, 0
  s_lshr_b32 s9, s9, s12
  s_lshl_b32 s9, s9, 16
  s_or_b32 s72, s72, s9
  s_lshl_b32 s12, s0, 8
  s_lshl_b32 s13, s1, 2
  s_add_u32 s12, s12, s13
  s_add_u32 s12, s12, 294912
  s_or_b32 s13, s8, s11
  v_mov_b32 v15, s13
  s_mov_b64 exec, 1
  buffer_store_dword v15, off, s[52:55], s12
  s_mov_b64 exec, -1
join_6:
  v_mov_b32 v250, s8
  v_mov_b32 v251, s8
  v_and_b32 v80, 31, v1
  v_lshlrev_b32 v80, 2, v80
  s_lshl_b32 s96, s0, 8
  s_add_u32 s96, s96, 294912
  v_and_b32 v11, 3, v3
  v_mul_u32_u24 v11, 4160, v11
  v_lshrrev_b32_e64 v12, 2, v3
  v_lshl_add_u32 v11, v12, 3, v11
  v_lshlrev_b32 v12, 4, v4
  v_sub_u32 v12, 48, v12
  v_add_u32 v11, v11, v12
  v_sub_u32 v13, 15, v3
  v_mul_u32_u24 v13, 96, v13
  v_add_u32 v13, v13, v12
  s_lshr_b32 s12, s7, 1
  s_mul_i32 s13, s12, 16640
  s_and_b32 s14, s7, 1
  s_lshl_b32 s14, s14, 5
  s_add_u32 s13, s13, s14
  s_add_u32 s13, s13, 102400
  v_add_u32 v252, s13, v11
  s_lshl_b32 s12, s12, 13
  v_add_u32 v254, s12, v13
  s_and_b32 s14, s1, 1
  s_lshl_b32 s14, s14, 5
  s_lshl_b32 s13, s7, 8
  s_add_u32 s13, s13, s14
  s_add_u32 s13, s13, 135680
  v_add_u32_e64 v253, s13, v11
  s_mul_i32 s13, s7, 384
  s_add_u32 s13, s13, 16384
  v_add_u32_e64 v255, s13, v13
  v_accvgpr_write_b32 a208, v252
  v_accvgpr_write_b32 a209, v253
  v_accvgpr_write_b32 a210, v254
  v_accvgpr_write_b32 a211, v255
  v_sub_u32_e64 v11, 15, v3
  v_mul_u32_u24 v11, 96, v11
  v_lshlrev_b32 v12, 3, v4
  v_sub_u32 v11, v11, v12
  s_lshr_b32 s12, s7, 1
  s_and_b32 s13, s7, 1
  s_lshl_b32 s13, s13, 5
  s_lshl_b32 s14, s12, 13
  s_sub_u32 s14, s14, s13
  s_add_u32 s14, s14, 56
  v_add_u32_e64 v13, s14, v11
  v_accvgpr_write_b32 a232, v13
  s_and_b32 s14, s1, 1
  s_lshl_b32 s14, s14, 5
  s_mul_i32 s15, s7, 1536
  s_add_u32 s14, s14, s15
  s_sub_u32 s14, 21048, s14
  v_add_u32 v13, s14, v11
  v_accvgpr_write_b32 a233, v13
  v_mul_u32_u24 v11, 80, v3
  v_add_u32_e64 v11, v11, v12
  s_mul_i32 s14, s12, 5120
  s_add_u32 s14, s14, s13
  s_add_u32 s14, s14, 118784
  v_add_u32 v12, s14, v11
  v_accvgpr_write_b32 a234, v12
  s_lshl_b32 s14, s7, 12
  s_add_u32 s14, s14, 102400
  v_add_u32 v13, s14, v2
  v_accvgpr_write_b32 a235, v13
  s_lshl_b32 s14, s7, 10
  s_add_u32 s14, s14, 102400
  v_add_u32 v13, s14, v2
  v_accvgpr_write_b32 a236, v13
  v_lshrrev_b32_e64 v14, 2, v1
  v_mul_u32_u24 v14, 80, v14
  v_and_b32_e64 v12, 3, v1
  v_lshl_add_u32 v14, v12, 4, v14
  s_mul_i32 s14, s7, 2560
  s_add_u32 s14, s14, 118784
  v_add_u32_e64 v14, s14, v14
  v_accvgpr_write_b32 a237, v14
  s_mul_i32 s14, s7, 1280
  s_add_u32 s14, s14, 129024
  v_add_u32_e64 v11, s14, v11
  v_accvgpr_write_b32 a238, v11
  v_lshrrev_b32 v14, 1, v1
  v_and_b32 v12, 1, v1
  v_lshlrev_b32_e64 v12, 4, v12
  v_lshl_add_u32 v13, v14, 6, v12
  v_mul_u32_u24 v14, 80, v14
  v_add3_u32 v14, v14, v12, s14
  v_accvgpr_write_b32 a251, v13
  v_accvgpr_write_b32 a239, v14
  s_lshr_b32 s92, s1, 1
  s_mul_i32 s92, s92, 5
  s_mul_i32 s93, s0, 80
  s_add_u32 s92, s92, s93
  s_lshl_b32 s92, s92, 12
  s_add_u32 s92, s92, 19922944
  s_and_b32 s14, s1, 1
  s_lshl_b32 s93, s14, 13
  s_lshl_b32 s15, s7, 11
  s_add_u32 s93, s93, s15
  s_add_u32 s93, s93, s92
  s_lshl_b32 s14, s14, 5
  s_lshl_b32 s15, s7, 10
  s_add_u32 s92, s92, s14
  s_add_u32 s92, s92, s15
  s_add_u32 s92, s92, 16384
  s_mul_i32 s12, s7, 1280
  s_add_u32 s12, s12, 152320
  v_mul_u32_u24 v11, 80, v3
  v_lshl_add_u32 v11, v4, 4, v11
  v_add_u32 v252, s12, v11
  v_bfe_u32 v12, v1, 2, 2
  v_mul_u32_u24 v12, 160, v12
  v_and_b32_e64 v13, 3, v1
  v_lshl_add_u32 v12, v13, 4, v12
  v_lshrrev_b32_e64 v13, 1, v4
  v_mul_u32_u24 v14, 80, v13
  v_lshlrev_b32_e64 v13, 10, v13
  v_add3_u32 v12, v12, v14, s12
  v_and_b32_e64 v14, 1, v4
  v_lshl_add_u32 v253, v14, 3, v12
  v_mul_u32_u24 v14, 40960, v14
  v_lshl_add_u32 v13, v3, 4, v13
  v_add_u32_e64 v254, v13, v14
  v_accvgpr_write_b32 a252, v252
  v_accvgpr_write_b32 a253, v253
  v_accvgpr_write_b32 a254, v254
  s_cmp_lg_u32 s7, 3
  s_cbranch_scc1 skip_8
  s_waitcnt vmcnt(10)
skip_8:
  s_cmp_eq_u32 s7, 3
  s_cbranch_scc1 skip_9
  s_add_u32 m0, s19, 0
  s_add_u32 s15, s18, 0
  buffer_load_dwordx4 v186, s[80:83], s15 offen lds
  s_add_u32 m0, s19, 1024
  s_add_u32 s15, s18, 20480
  buffer_load_dwordx4 v186, s[80:83], s15 offen lds
  s_add_u32 m0, s19, 2048
  s_add_u32 s15, s18, 5120
  buffer_load_dwordx4 v186, s[80:83], s15 offen lds
  s_add_u32 m0, s19, 3072
  s_add_u32 s15, s18, 25600
  buffer_load_dwordx4 v186, s[80:83], s15 offen lds
  s_add_u32 m0, s19, 4096
  s_add_u32 s15, s18, 128
  buffer_load_dwordx4 v186, s[80:83], s15 offen lds
  s_add_u32 m0, s19, 5120
  s_add_u32 s15, s18, 20608
  buffer_load_dwordx4 v186, s[80:83], s15 offen lds
  s_add_u32 m0, s19, 6144
  s_add_u32 s15, s18, 5248
  buffer_load_dwordx4 v186, s[80:83], s15 offen lds
  s_add_u32 m0, s19, 7168
  s_add_u32 s15, s18, 25728
  buffer_load_dwordx4 v186, s[80:83], s15 offen lds
  s_add_u32 m0, s19, 8192
  s_add_u32 s15, s18, 256
  buffer_load_dwordx4 v186, s[80:83], s15 offen lds
  s_add_u32 m0, s19, 9216
  s_add_u32 s15, s18, 20736
  buffer_load_dwordx4 v186, s[80:83], s15 offen lds
skip_9:
  s_barrier
  s_cmp_eq_u32 s7, 3
  s_cbranch_scc1 w3_10
  v_lshrrev_b32 v11, 3, v1
  v_and_b32 v12, 7, v1
  v_mul_u32_u24 v11, 1280, v11
  v_lshl_add_u32 v11, v12, 3, v11
  s_lshl_b32 s12, s44, 6
  s_add_u32 s12, s12, 77824
  v_add_u32 v11, s12, v11
  s_lshl_b32 s12, s44, 8
  s_add_u32 s12, s12, 99904
  v_lshl_add_u32 v12, v12, 5, s12
  ds_read_b128 v[166:169], v12
  ds_read_b128 v[170:173], v12 offset:16
  ds_read_b64 v[128:129], v11 offset:0
  ds_read_b64 v[130:131], v11 offset:160
  ds_read_b64 v[132:133], v11 offset:320
  ds_read_b64 v[134:135], v11 offset:480
  ds_read_b64 v[136:137], v11 offset:640
  ds_read_b64 v[138:139], v11 offset:800
  ds_read_b64 v[140:141], v11 offset:960
  ds_read_b64 v[142:143], v11 offset:1120
  ds_read_b64 v[144:145], v11 offset:1280
  ds_read_b64 v[146:147], v11 offset:1440
  ds_read_b64 v[148:149], v11 offset:1600
  s_waitcnt lgkmcnt(11)
  ds_read_b64 v[150:151], v11 offset:11520
  ds_read_b64 v[152:153], v11 offset:11680
  ds_read_b64 v[154:155], v11 offset:11840
  ds_read_b64 v[156:157], v11 offset:12000
  ds_read_b64 v[158:159], v11 offset:12160
  ds_read_b64 v[160:161], v11 offset:12320
  ds_read_b64 v[162:163], v11 offset:12480
  ds_read_b64 v[164:165], v11 offset:12640
  v_lshlrev_b32_e64 v192, 16, v166
  v_and_b32 v196, 0xffff0000, v166
  v_lshlrev_b32_e64 v200, 16, v167
  v_and_b32 v204, 0xffff0000, v167
  v_lshlrev_b32_e64 v193, 16, v168
  v_and_b32 v197, 0xffff0000, v168
  v_lshlrev_b32_e64 v201, 16, v169
  v_and_b32 v205, 0xffff0000, v169
  v_lshlrev_b32_e64 v194, 16, v170
  v_and_b32 v198, 0xffff0000, v170
  v_lshlrev_b32_e64 v202, 16, v171
  v_and_b32 v206, 0xffff0000, v171
  v_lshlrev_b32_e64 v195, 16, v172
  v_and_b32 v199, 0xffff0000, v172
  v_lshlrev_b32_e64 v203, 16, v173
  v_and_b32 v207, 0xffff0000, v173
  s_waitcnt lgkmcnt(8)
  v_lshlrev_b32 v84, 16, v128
  v_and_b32 v85, 0xffff0000, v128
  v_lshlrev_b32_e64 v86, 16, v129
  v_and_b32 v87, 0xffff0000, v129
  v_lshlrev_b32_e64 v88, 16, v130
  v_and_b32 v89, 0xffff0000, v130
  v_lshlrev_b32_e64 v90, 16, v131
  v_and_b32 v91, 0xffff0000, v131
  v_lshlrev_b32_e64 v92, 16, v132
  v_and_b32 v93, 0xffff0000, v132
  v_lshlrev_b32_e64 v94, 16, v133
  v_and_b32 v95, 0xffff0000, v133
  s_add_u32 m0, s19, 10240
  s_nop 0
  buffer_load_dwordx4 v174, s[80:83], 0 offen lds
  v_lshlrev_b32 v96, 16, v134
  v_and_b32 v97, 0xffff0000, v134
  v_lshlrev_b32_e64 v98, 16, v135
  v_and_b32 v99, 0xffff0000, v135
  v_lshlrev_b32_e64 v100, 16, v136
  v_and_b32 v101, 0xffff0000, v136
  v_lshlrev_b32_e64 v102, 16, v137
  v_and_b32 v103, 0xffff0000, v137
  v_lshlrev_b32_e64 v104, 16, v138
  v_and_b32 v105, 0xffff0000, v138
  v_lshlrev_b32_e64 v106, 16, v139
  v_and_b32 v107, 0xffff0000, v139
  s_add_u32 m0, s19, 11264
  s_nop 0
  buffer_load_dwordx4 v175, s[80:83], 0 offen lds
  v_lshlrev_b32 v108, 16, v140
  v_and_b32 v109, 0xffff0000, v140
  v_lshlrev_b32_e64 v110, 16, v141
  v_and_b32 v111, 0xffff0000, v141
  v_lshlrev_b32_e64 v112, 16, v142
  v_and_b32 v113, 0xffff0000, v142
  v_lshlrev_b32_e64 v114, 16, v143
  v_and_b32 v115, 0xffff0000, v143
  v_lshlrev_b32_e64 v116, 16, v144
  v_and_b32 v117, 0xffff0000, v144
  v_lshlrev_b32_e64 v118, 16, v145
  v_and_b32 v119, 0xffff0000, v145
  s_add_u32 m0, s19, 12288
  s_mov_b32 exec_hi, 0
  buffer_load_dwordx4 v176, s[80:83], 0 offen lds
  s_mov_b32 exec_hi, -1
  v_lshlrev_b32_e64 v120, 16, v146
  v_and_b32 v121, 0xffff0000, v146
  v_lshlrev_b32_e64 v122, 16, v147
  v_and_b32 v123, 0xffff0000, v147
  v_lshlrev_b32_e64 v124, 16, v148
  v_and_b32 v125, 0xffff0000, v148
  v_lshlrev_b32_e64 v126, 16, v149
  v_and_b32 v127, 0xffff0000, v149
  s_waitcnt lgkmcnt(0)
  v_lshlrev_b32 v48, 16, v150
  v_and_b32 v49, 0xffff0000, v150
  v_lshlrev_b32_e64 v50, 16, v151
  buffer_load_dword v81, v80, s[52:55], s96 offen sc1
  v_and_b32 v51, 0xffff0000, v151
  v_lshlrev_b32_e64 v52, 16, v152
  v_and_b32 v53, 0xffff0000, v152
  v_lshlrev_b32_e64 v54, 16, v153
  v_and_b32 v55, 0xffff0000, v153
  v_lshlrev_b32_e64 v56, 16, v154
  v_and_b32 v57, 0xffff0000, v154
  v_lshlrev_b32_e64 v58, 16, v155
  v_and_b32 v59, 0xffff0000, v155
  v_lshlrev_b32_e64 v60, 16, v156
  v_and_b32 v61, 0xffff0000, v156
  v_lshlrev_b32_e64 v62, 16, v157
  global_load_dwordx4 a[200:203], v247, s[26:27] nt
  v_and_b32 v63, 0xffff0000, v157
  v_lshlrev_b32_e64 v64, 16, v158
  v_and_b32 v65, 0xffff0000, v158
  v_lshlrev_b32_e64 v66, 16, v159
  v_and_b32 v67, 0xffff0000, v159
  v_lshlrev_b32_e64 v68, 16, v160
  v_and_b32 v69, 0xffff0000, v160
  v_lshlrev_b32_e64 v70, 16, v161
  v_and_b32 v71, 0xffff0000, v161
  v_lshlrev_b32_e64 v72, 16, v162
  v_and_b32 v73, 0xffff0000, v162
  v_lshlrev_b32_e64 v74, 16, v163
  global_load_dwordx4 a[204:207], v247, s[28:29] nt
  v_and_b32 v75, 0xffff0000, v163
  v_lshlrev_b32_e64 v76, 16, v164
  v_and_b32 v77, 0xffff0000, v164
  v_lshlrev_b32_e64 v78, 16, v165
  v_and_b32 v79, 0xffff0000, v165
  v_pk_mul_f32 v[128:129], v[84:85], v[204:205]
  v_pk_mul_f32 v[130:131], v[86:87], v[206:207]
  v_pk_mul_f32 v[132:133], v[88:89], v[204:205]
  v_pk_mul_f32 v[134:135], v[90:91], v[206:207]
  v_pk_mul_f32 v[136:137], v[92:93], v[204:205]
  v_pk_mul_f32 v[138:139], v[94:95], v[206:207]
  v_pk_mul_f32 v[140:141], v[96:97], v[204:205]
  v_pk_mul_f32 v[142:143], v[98:99], v[206:207]
  v_pk_mul_f32 v[144:145], v[100:101], v[204:205]
  v_pk_mul_f32 v[146:147], v[102:103], v[206:207]
  v_pk_mul_f32 v[148:149], v[104:105], v[204:205]
  v_pk_mul_f32 v[150:151], v[106:107], v[206:207]
  v_pk_mul_f32 v[152:153], v[108:109], v[204:205]
  v_pk_mul_f32 v[154:155], v[110:111], v[206:207]
  v_pk_mul_f32 v[156:157], v[112:113], v[204:205]
  v_pk_mul_f32 v[158:159], v[114:115], v[206:207]
  v_pk_fma_f32 v[128:129], v[88:89], v[200:201], v[128:129]
  v_pk_fma_f32 v[130:131], v[90:91], v[202:203], v[130:131]
  v_pk_fma_f32 v[132:133], v[92:93], v[200:201], v[132:133]
  v_pk_fma_f32 v[134:135], v[94:95], v[202:203], v[134:135]
  v_pk_fma_f32 v[136:137], v[96:97], v[200:201], v[136:137]
  v_pk_fma_f32 v[138:139], v[98:99], v[202:203], v[138:139]
  v_pk_fma_f32 v[140:141], v[100:101], v[200:201], v[140:141]
  v_pk_fma_f32 v[142:143], v[102:103], v[202:203], v[142:143]
  v_pk_fma_f32 v[144:145], v[104:105], v[200:201], v[144:145]
  v_pk_fma_f32 v[146:147], v[106:107], v[202:203], v[146:147]
  v_pk_fma_f32 v[148:149], v[108:109], v[200:201], v[148:149]
  v_pk_fma_f32 v[150:151], v[110:111], v[202:203], v[150:151]
  v_pk_fma_f32 v[152:153], v[112:113], v[200:201], v[152:153]
  v_pk_fma_f32 v[154:155], v[114:115], v[202:203], v[154:155]
  v_pk_fma_f32 v[156:157], v[116:117], v[200:201], v[156:157]
  v_pk_fma_f32 v[158:159], v[118:119], v[202:203], v[158:159]
  v_pk_fma_f32 v[128:129], v[92:93], v[196:197], v[128:129]
  v_pk_fma_f32 v[130:131], v[94:95], v[198:199], v[130:131]
  v_pk_fma_f32 v[132:133], v[96:97], v[196:197], v[132:133]
  v_pk_fma_f32 v[134:135], v[98:99], v[198:199], v[134:135]
  v_pk_fma_f32 v[136:137], v[100:101], v[196:197], v[136:137]
  v_pk_fma_f32 v[138:139], v[102:103], v[198:199], v[138:139]
  v_pk_fma_f32 v[140:141], v[104:105], v[196:197], v[140:141]
  v_pk_fma_f32 v[142:143], v[106:107], v[198:199], v[142:143]
  v_pk_fma_f32 v[144:145], v[108:109], v[196:197], v[144:145]
  v_pk_fma_f32 v[146:147], v[110:111], v[198:199], v[146:147]
  v_pk_fma_f32 v[148:149], v[112:113], v[196:197], v[148:149]
  v_pk_fma_f32 v[150:151], v[114:115], v[198:199], v[150:151]
  v_pk_fma_f32 v[152:153], v[116:117], v[196:197], v[152:153]
  v_pk_fma_f32 v[154:155], v[118:119], v[198:199], v[154:155]
  v_pk_fma_f32 v[156:157], v[120:121], v[196:197], v[156:157]
  v_pk_fma_f32 v[158:159], v[122:123], v[198:199], v[158:159]
  v_pk_fma_f32 v[128:129], v[96:97], v[192:193], v[128:129]
  v_pk_fma_f32 v[130:131], v[98:99], v[194:195], v[130:131]
  v_pk_fma_f32 v[132:133], v[100:101], v[192:193], v[132:133]
  v_pk_fma_f32 v[134:135], v[102:103], v[194:195], v[134:135]
  v_pk_fma_f32 v[136:137], v[104:105], v[192:193], v[136:137]
  v_pk_fma_f32 v[138:139], v[106:107], v[194:195], v[138:139]
  v_pk_fma_f32 v[140:141], v[108:109], v[192:193], v[140:141]
  v_pk_fma_f32 v[142:143], v[110:111], v[194:195], v[142:143]
  v_pk_fma_f32 v[144:145], v[112:113], v[192:193], v[144:145]
  v_pk_fma_f32 v[146:147], v[114:115], v[194:195], v[146:147]
  v_pk_fma_f32 v[148:149], v[116:117], v[192:193], v[148:149]
  v_pk_fma_f32 v[150:151], v[118:119], v[194:195], v[150:151]
  v_pk_fma_f32 v[152:153], v[120:121], v[192:193], v[152:153]
  v_pk_fma_f32 v[154:155], v[122:123], v[194:195], v[154:155]
  v_pk_fma_f32 v[156:157], v[124:125], v[192:193], v[156:157]
  v_pk_fma_f32 v[158:159], v[126:127], v[194:195], v[158:159]
  v_pk_mul_f32 v[128:129], v[128:129], v[48:49]
  v_pk_mul_f32 v[130:131], v[130:131], v[50:51]
  v_pk_mul_f32 v[132:133], v[132:133], v[52:53]
  v_pk_mul_f32 v[134:135], v[134:135], v[54:55]
  v_pk_mul_f32 v[136:137], v[136:137], v[56:57]
  v_pk_mul_f32 v[138:139], v[138:139], v[58:59]
  v_pk_mul_f32 v[140:141], v[140:141], v[60:61]
  v_pk_mul_f32 v[142:143], v[142:143], v[62:63]
  v_pk_mul_f32 v[144:145], v[144:145], v[64:65]
  v_pk_mul_f32 v[146:147], v[146:147], v[66:67]
  v_pk_mul_f32 v[148:149], v[148:149], v[68:69]
  v_pk_mul_f32 v[150:151], v[150:151], v[70:71]
  v_pk_mul_f32 v[152:153], v[152:153], v[72:73]
  v_pk_mul_f32 v[154:155], v[154:155], v[74:75]
  v_pk_mul_f32 v[156:157], v[156:157], v[76:77]
  v_pk_mul_f32 v[158:159], v[158:159], v[78:79]
  v_cvt_pk_bf16_f32 v48, v156, v152
  v_cvt_pk_bf16_f32 v49, v148, v144
  v_cvt_pk_bf16_f32 v50, v140, v136
  v_cvt_pk_bf16_f32 v51, v132, v128
  v_cvt_pk_bf16_f32 v52, v157, v153
  v_cvt_pk_bf16_f32 v53, v149, v145
  v_cvt_pk_bf16_f32 v54, v141, v137
  v_cvt_pk_bf16_f32 v55, v133, v129
  v_cvt_pk_bf16_f32 v56, v158, v154
  v_cvt_pk_bf16_f32 v57, v150, v146
  v_cvt_pk_bf16_f32 v58, v142, v138
  v_cvt_pk_bf16_f32 v59, v134, v130
  v_cvt_pk_bf16_f32 v60, v159, v155
  v_cvt_pk_bf16_f32 v61, v151, v147
  v_cvt_pk_bf16_f32 v62, v143, v139
  v_cvt_pk_bf16_f32 v63, v135, v131
  v_lshrrev_b32 v11, 3, v1
  v_and_b32 v12, 7, v1
  v_sub_u32 v13, 7, v11
  v_lshlrev_b32 v13, 4, v13
  v_mul_u32_u24 v14, 144, v12
  v_add3_u32 v13, v13, v14, s34
  v_lshlrev_b32_e64 v12, 4, v12
  v_mul_u32_u24 v14, 144, v11
  v_add3_u32 v14, v14, v12, s34
  ds_write_b128 v13, v[48:51] offset:0
  ds_read_b128 v[192:195], v14 offset:0
  ds_write_b128 v13, v[52:55] offset:1152
  ds_read_b128 v[196:199], v14 offset:1152
  ds_write_b128 v13, v[56:59] offset:2304
  ds_read_b128 v[200:203], v14 offset:2304
  ds_write_b128 v13, v[60:63] offset:3456
  ds_read_b128 v[204:207], v14 offset:3456
  s_waitcnt vmcnt(2)
  s_branch join_11
w3_10:
  s_add_u32 m0, s19, 0
  s_add_u32 s15, s18, 0
  buffer_load_dwordx4 v186, s[80:83], s15 offen lds
  s_add_u32 m0, s19, 1024
  s_add_u32 s15, s18, 20480
  buffer_load_dwordx4 v186, s[80:83], s15 offen lds
  s_add_u32 m0, s19, 2048
  s_add_u32 s15, s18, 5120
  buffer_load_dwordx4 v186, s[80:83], s15 offen lds
  s_add_u32 m0, s19, 3072
  s_add_u32 s15, s18, 25600
  buffer_load_dwordx4 v186, s[80:83], s15 offen lds
  s_add_u32 m0, s19, 4096
  s_add_u32 s15, s18, 128
  buffer_load_dwordx4 v186, s[80:83], s15 offen lds
  s_add_u32 m0, s19, 5120
  s_add_u32 s15, s18, 20608
  buffer_load_dwordx4 v186, s[80:83], s15 offen lds
  s_add_u32 m0, s19, 6144
  s_add_u32 s15, s18, 5248
  buffer_load_dwordx4 v186, s[80:83], s15 offen lds
  s_add_u32 m0, s19, 7168
  s_add_u32 s15, s18, 25728
  buffer_load_dwordx4 v186, s[80:83], s15 offen lds
  s_add_u32 m0, s19, 8192
  s_add_u32 s15, s18, 256
  buffer_load_dwordx4 v186, s[80:83], s15 offen lds
  s_add_u32 m0, s19, 9216
  s_add_u32 s15, s18, 20736
  buffer_load_dwordx4 v186, s[80:83], s15 offen lds
  s_add_u32 m0, s19, 10240
  s_nop 0
  buffer_load_dwordx4 v174, s[80:83], 0 offen lds
  s_add_u32 m0, s19, 11264
  s_nop 0
  buffer_load_dwordx4 v175, s[80:83], 0 offen lds
  s_add_u32 m0, s19, 12288
  s_mov_b32 exec_hi, 0
  buffer_load_dwordx4 v176, s[80:83], 0 offen lds
  s_mov_b32 exec_hi, -1
  buffer_load_dword v81, v80, s[52:55], s96 offen sc1
  v_lshrrev_b32 v11, 3, v1
  v_min_u32 v11, 4, v11
  s_mul_i32 s12, s3, 5
  v_add_u32 v11, s12, v11
  v_and_b32 v12, 1, v11
  v_cmp_eq_u32 vcc, 1, v12
  v_lshlrev_b32 v185, 3, v11
  v_lshrrev_b32 v11, 1, v11
  s_mul_i32 s12, s4, 40
  v_add_u32 v11, s12, v11
  v_mul_u32_u24 v11, 1280, v11
  v_and_b32_e64 v12, 7, v1
  v_lshl_add_u32 v11, v12, 4, v11
  v_mov_b32 v12, s56
  v_mov_b32 v13, s57
  v_mov_b32 v14, s60
  v_mov_b32 v15, s61
  v_cndmask_b32 v12, v12, v14, vcc
  v_cndmask_b32 v13, v13, v15, vcc
  v_add_co_u32 v12, vcc, v12, v11
  s_nop 1
  v_addc_co_u32 v13, vcc, 0, v13, vcc
  global_load_dwordx4 v[88:91], v[12:13], off offset:0
  global_load_dwordx4 v[92:95], v[12:13], off offset:128
  global_load_dwordx4 v[96:99], v[12:13], off offset:256
  global_load_dwordx4 v[100:103], v[12:13], off offset:384
  global_load_dwordx4 v[104:107], v[12:13], off offset:512
  global_load_dwordx4 v[108:111], v[12:13], off offset:640
  global_load_dwordx4 v[112:115], v[12:13], off offset:768
  global_load_dwordx4 v[116:119], v[12:13], off offset:896
  global_load_dwordx4 v[120:123], v[12:13], off offset:1024
  global_load_dwordx4 v[124:127], v[12:13], off offset:1152
  s_add_u32 s14, s31, 256
  s_mov_b32 m0, 20480
  s_nop 0
  buffer_load_dwordx4 v45, s[56:59], s14 offen lds
  s_mov_b32 m0, 21504
  s_nop 0
  buffer_load_dwordx4 v46, s[60:63], s14 offen lds
  s_add_u32 s14, s31, 10496
  s_mov_b32 m0, 22528
  s_nop 0
  buffer_load_dwordx4 v45, s[56:59], s14 offen lds
  s_mov_b32 m0, 23552
  s_nop 0
  buffer_load_dwordx4 v46, s[60:63], s14 offen lds
  s_add_u32 s14, s31, 20736
  s_mov_b32 m0, 24576
  s_nop 0
  buffer_load_dwordx4 v45, s[56:59], s14 offen lds
  s_mov_b32 m0, 25600
  s_nop 0
  buffer_load_dwordx4 v46, s[60:63], s14 offen lds
  s_add_u32 s14, s31, 30976
  s_mov_b32 m0, 26624
  s_nop 0
  buffer_load_dwordx4 v45, s[56:59], s14 offen lds
  s_mov_b32 m0, 27648
  s_nop 0
  buffer_load_dwordx4 v46, s[60:63], s14 offen lds
  s_add_u32 s14, s31, 41216
  s_mov_b32 m0, 28672
  s_nop 0
  buffer_load_dwordx4 v45, s[56:59], s14 offen lds
  s_mov_b32 m0, 29696
  s_nop 0
  buffer_load_dwordx4 v46, s[60:63], s14 offen lds
  s_add_u32 s14, s31, 384
  s_mov_b32 m0, 30720
  s_nop 0
  buffer_load_dwordx4 v45, s[56:59], s14 offen lds
  s_mov_b32 m0, 31744
  s_nop 0
  buffer_load_dwordx4 v46, s[60:63], s14 offen lds
  s_add_u32 s14, s31, 10624
  s_mov_b32 m0, 32768
  s_nop 0
  buffer_load_dwordx4 v45, s[56:59], s14 offen lds
  s_mov_b32 m0, 33792
  s_nop 0
  buffer_load_dwordx4 v46, s[60:63], s14 offen lds
  s_add_u32 s14, s31, 20864
  s_mov_b32 m0, 34816
  s_nop 0
  buffer_load_dwordx4 v45, s[56:59], s14 offen lds
  s_mov_b32 m0, 35840
  s_nop 0
  buffer_load_dwordx4 v46, s[60:63], s14 offen lds
  s_add_u32 s14, s31, 31104
  s_mov_b32 m0, 36864
  s_nop 0
  buffer_load_dwordx4 v45, s[56:59], s14 offen lds
  s_mov_b32 m0, 37888
  s_nop 0
  buffer_load_dwordx4 v46, s[60:63], s14 offen lds
  s_add_u32 s14, s31, 41344
  s_mov_b32 m0, 38912
  s_nop 0
  buffer_load_dwordx4 v45, s[56:59], s14 offen lds
  s_mov_b32 m0, 39936
  s_nop 0
  buffer_load_dwordx4 v46, s[60:63], s14 offen lds
  global_load_dwordx4 a[200:203], v247, s[26:27] nt
  global_load_dwordx4 a[204:207], v247, s[28:29] nt
  s_waitcnt vmcnt(46)
  s_lshl_b32 s12, s3, 4
  s_add_u32 s12, s12, s4
  s_lshl_b32 s12, s12, 7
  s_add_u32 s12, s12, 262144
  v_lshlrev_b32 v179, 1, v1
  v_dot2_f32_bf16 v180, v128, s2, 0
  v_dot2_f32_bf16 v182, v128, v128, 0
  v_dot2_f32_bf16 v180, v129, s2, v180
  v_dot2_f32_bf16 v182, v129, v129, v182
  v_dot2_f32_bf16 v180, v130, s2, v180
  v_dot2_f32_bf16 v182, v130, v130, v182
  v_dot2_f32_bf16 v180, v131, s2, v180
  v_dot2_f32_bf16 v182, v131, v131, v182
  v_dot2_f32_bf16 v180, v132, s2, v180
  v_dot2_f32_bf16 v182, v132, v132, v182
  v_dot2_f32_bf16 v180, v133, s2, v180
  v_dot2_f32_bf16 v182, v133, v133, v182
  v_dot2_f32_bf16 v180, v134, s2, v180
  v_dot2_f32_bf16 v182, v134, v134, v182
  v_dot2_f32_bf16 v180, v135, s2, v180
  v_dot2_f32_bf16 v182, v135, v135, v182
  v_dot2_f32_bf16 v180, v136, s2, v180
  v_dot2_f32_bf16 v182, v136, v136, v182
  v_dot2_f32_bf16 v180, v137, s2, v180
  v_dot2_f32_bf16 v182, v137, v137, v182
  v_dot2_f32_bf16 v180, v138, s2, v180
  v_dot2_f32_bf16 v182, v138, v138, v182
  v_dot2_f32_bf16 v180, v139, s2, v180
  v_dot2_f32_bf16 v182, v139, v139, v182
  v_dot2_f32_bf16 v180, v140, s2, v180
  v_dot2_f32_bf16 v182, v140, v140, v182
  v_dot2_f32_bf16 v180, v141, s2, v180
  v_dot2_f32_bf16 v182, v141, v141, v182
  v_dot2_f32_bf16 v180, v142, s2, v180
  v_dot2_f32_bf16 v182, v142, v142, v182
  v_dot2_f32_bf16 v180, v143, s2, v180
  v_dot2_f32_bf16 v182, v143, v143, v182
  v_dot2_f32_bf16 v180, v144, s2, v180
  v_dot2_f32_bf16 v182, v144, v144, v182
  v_dot2_f32_bf16 v180, v145, s2, v180
  v_dot2_f32_bf16 v182, v145, v145, v182
  v_dot2_f32_bf16 v180, v146, s2, v180
  v_dot2_f32_bf16 v182, v146, v146, v182
  v_dot2_f32_bf16 v180, v147, s2, v180
  v_dot2_f32_bf16 v182, v147, v147, v182
  v_dot2_f32_bf16 v180, v148, s2, v180
  v_dot2_f32_bf16 v182, v148, v148, v182
  v_dot2_f32_bf16 v180, v149, s2, v180
  v_dot2_f32_bf16 v182, v149, v149, v182
  v_dot2_f32_bf16 v180, v150, s2, v180
  v_dot2_f32_bf16 v182, v150, v150, v182
  v_dot2_f32_bf16 v180, v151, s2, v180
  v_dot2_f32_bf16 v182, v151, v151, v182
  v_dot2_f32_bf16 v180, v152, s2, v180
  v_dot2_f32_bf16 v182, v152, v152, v182
  v_dot2_f32_bf16 v180, v153, s2, v180
  v_dot2_f32_bf16 v182, v153, v153, v182
  v_dot2_f32_bf16 v180, v154, s2, v180
  v_dot2_f32_bf16 v182, v154, v154, v182
  v_dot2_f32_bf16 v180, v155, s2, v180
  v_dot2_f32_bf16 v182, v155, v155, v182
  v_dot2_f32_bf16 v180, v156, s2, v180
  v_dot2_f32_bf16 v182, v156, v156, v182
  v_dot2_f32_bf16 v180, v157, s2, v180
  v_dot2_f32_bf16 v182, v157, v157, v182
  v_dot2_f32_bf16 v180, v158, s2, v180
  v_dot2_f32_bf16 v182, v158, v158, v182
  v_dot2_f32_bf16 v180, v159, s2, v180
  v_dot2_f32_bf16 v182, v159, v159, v182
  v_dot2_f32_bf16 v180, v160, s2, v180
  v_dot2_f32_bf16 v182, v160, v160, v182
  v_dot2_f32_bf16 v180, v161, s2, v180
  v_dot2_f32_bf16 v182, v161, v161, v182
  v_dot2_f32_bf16 v180, v162, s2, v180
  v_dot2_f32_bf16 v182, v162, v162, v182
  v_dot2_f32_bf16 v180, v163, s2, v180
  v_dot2_f32_bf16 v182, v163, v163, v182
  v_dot2_f32_bf16 v180, v164, s2, v180
  v_dot2_f32_bf16 v182, v164, v164, v182
  v_dot2_f32_bf16 v180, v165, s2, v180
  v_dot2_f32_bf16 v182, v165, v165, v182
  v_dot2_f32_bf16 v180, v166, s2, v180
  v_dot2_f32_bf16 v182, v166, v166, v182
  v_dot2_f32_bf16 v180, v167, s2, v180
  v_dot2_f32_bf16 v182, v167, v167, v182
  s_nop 1
  v_add_f32_dpp v180, v180, v180 quad_perm:[1,0,3,2] row_mask:0xf bank_mask:0xf
  v_add_f32_dpp v182, v182, v182 quad_perm:[1,0,3,2] row_mask:0xf bank_mask:0xf
  s_nop 0
  v_add_f32_dpp v180, v180, v180 quad_perm:[2,3,0,1] row_mask:0xf bank_mask:0xf
  v_add_f32_dpp v182, v182, v182 quad_perm:[2,3,0,1] row_mask:0xf bank_mask:0xf
  s_nop 0
  v_add_f32_dpp v180, v180, v180 row_half_mirror row_mask:0xf bank_mask:0xf
  v_add_f32_dpp v182, v182, v182 row_half_mirror row_mask:0xf bank_mask:0xf
  v_mul_f32 v180, 0x3acccccd, v180
  v_mul_f32 v182, 0x3acccccd, v182
  v_fma_f32 v182, -v180, v180, v182
  v_max_f32 v182, 0, v182
  v_cvt_pk_bf16_f32 v180, v180, v180
  v_and_b32 v180, 0xffff0000, v180
  v_cvt_pk_bf16_f32 v182, v182, v182
  v_and_b32 v182, 0xffff0000, v182
  v_add_f32 v182, 0x3727c5ac, v182
  v_cvt_pk_bf16_f32 v182, v182, v182
  v_and_b32 v182, 0xffff0000, v182
  v_sqrt_f32 v182, v182
  s_nop 0
  v_cvt_pk_bf16_f32 v182, v182, v182
  v_and_b32 v182, 0xffff0000, v182
  v_rcp_f32 v181, v182
  v_mov_b32 v182, s8
  v_mov_b32_e64 v183, s8
  s_mov_b32 exec_lo, 0x01010101
  s_mov_b32 exec_hi, 0x01010101
  buffer_store_dwordx4 v[180:183], v179, s[52:55], s12 offen sc1
  s_mov_b64 exec, -1
  s_add_u32 s14, s31, 512
  s_mov_b32 m0, 40960
  s_nop 0
  buffer_load_dwordx4 v45, s[56:59], s14 offen lds
  s_mov_b32 m0, 41984
  s_nop 0
  buffer_load_dwordx4 v46, s[60:63], s14 offen lds
  s_add_u32 s14, s31, 10752
  s_mov_b32 m0, 43008
  s_nop 0
  buffer_load_dwordx4 v45, s[56:59], s14 offen lds
  s_mov_b32 m0, 44032
  s_nop 0
  buffer_load_dwordx4 v46, s[60:63], s14 offen lds
  s_add_u32 s14, s31, 20992
  s_mov_b32 m0, 45056
  s_nop 0
  buffer_load_dwordx4 v45, s[56:59], s14 offen lds
  s_mov_b32 m0, 46080
  s_nop 0
  buffer_load_dwordx4 v46, s[60:63], s14 offen lds
  s_add_u32 s14, s31, 31232
  s_mov_b32 m0, 47104
  s_nop 0
  buffer_load_dwordx4 v45, s[56:59], s14 offen lds
  s_mov_b32 m0, 48128
  s_nop 0
  buffer_load_dwordx4 v46, s[60:63], s14 offen lds
  s_add_u32 s14, s31, 41472
  s_mov_b32 m0, 49152
  s_nop 0
  buffer_load_dwordx4 v45, s[56:59], s14 offen lds
  s_mov_b32 m0, 50176
  s_nop 0
  buffer_load_dwordx4 v46, s[60:63], s14 offen lds
  s_add_u32 s14, s31, 640
  s_mov_b32 m0, 51200
  s_nop 0
  buffer_load_dwordx4 v45, s[56:59], s14 offen lds
  s_mov_b32 m0, 52224
  s_nop 0
  buffer_load_dwordx4 v46, s[60:63], s14 offen lds
  s_add_u32 s14, s31, 10880
  s_mov_b32 m0, 53248
  s_nop 0
  buffer_load_dwordx4 v45, s[56:59], s14 offen lds
  s_mov_b32 m0, 54272
  s_nop 0
  buffer_load_dwordx4 v46, s[60:63], s14 offen lds
  s_add_u32 s14, s31, 21120
  s_mov_b32 m0, 55296
  s_nop 0
  buffer_load_dwordx4 v45, s[56:59], s14 offen lds
  s_mov_b32 m0, 56320
  s_nop 0
  buffer_load_dwordx4 v46, s[60:63], s14 offen lds
  s_add_u32 s14, s31, 31360
  s_mov_b32 m0, 57344
  s_nop 0
  buffer_load_dwordx4 v45, s[56:59], s14 offen lds
  s_mov_b32 m0, 58368
  s_nop 0
  buffer_load_dwordx4 v46, s[60:63], s14 offen lds
  s_add_u32 s14, s31, 41600
  s_mov_b32 m0, 59392
  s_nop 0
  buffer_load_dwordx4 v45, s[56:59], s14 offen lds
  s_mov_b32 m0, 60416
  s_nop 0
  buffer_load_dwordx4 v46, s[60:63], s14 offen lds
  s_mul_i32 s12, s4, 640
  s_add_u32 s12, s12, 303104
  s_waitcnt vmcnt(43)
  v_dot2_f32_bf16 v12, v88, s2, 0
  v_dot2_f32_bf16 v12, v89, s2, v12
  v_dot2_f32_bf16 v12, v90, s2, v12
  v_dot2_f32_bf16 v12, v91, s2, v12
  v_dot2_f32_bf16 v12, v92, s2, v12
  v_dot2_f32_bf16 v12, v93, s2, v12
  v_dot2_f32_bf16 v12, v94, s2, v12
  v_dot2_f32_bf16 v12, v95, s2, v12
  v_dot2_f32_bf16 v12, v96, s2, v12
  v_dot2_f32_bf16 v12, v97, s2, v12
  v_dot2_f32_bf16 v12, v98, s2, v12
  v_dot2_f32_bf16 v12, v99, s2, v12
  v_dot2_f32_bf16 v12, v100, s2, v12
  v_dot2_f32_bf16 v12, v101, s2, v12
  v_dot2_f32_bf16 v12, v102, s2, v12
  v_dot2_f32_bf16 v12, v103, s2, v12
  v_dot2_f32_bf16 v12, v104, s2, v12
  v_dot2_f32_bf16 v12, v105, s2, v12
  v_dot2_f32_bf16 v12, v106, s2, v12
  v_dot2_f32_bf16 v12, v107, s2, v12
  v_dot2_f32_bf16 v12, v108, s2, v12
  v_dot2_f32_bf16 v12, v109, s2, v12
  v_dot2_f32_bf16 v12, v110, s2, v12
  v_dot2_f32_bf16 v12, v111, s2, v12
  v_dot2_f32_bf16 v12, v112, s2, v12
  v_dot2_f32_bf16 v12, v113, s2, v12
  v_dot2_f32_bf16 v12, v114, s2, v12
  v_dot2_f32_bf16 v12, v115, s2, v12
  v_dot2_f32_bf16 v12, v116, s2, v12
  v_dot2_f32_bf16 v12, v117, s2, v12
  v_dot2_f32_bf16 v12, v118, s2, v12
  v_dot2_f32_bf16 v12, v119, s2, v12
  v_dot2_f32_bf16 v12, v120, s2, v12
  v_dot2_f32_bf16 v12, v121, s2, v12
  v_dot2_f32_bf16 v12, v122, s2, v12
  v_dot2_f32_bf16 v12, v123, s2, v12
  v_dot2_f32_bf16 v12, v124, s2, v12
  v_dot2_f32_bf16 v12, v125, s2, v12
  v_dot2_f32_bf16 v12, v126, s2, v12
  v_dot2_f32_bf16 v12, v127, s2, v12
  s_nop 2
  v_add_f32_dpp v12, v12, v12 quad_perm:[1,0,3,2] row_mask:0xf bank_mask:0xf
  s_nop 1
  v_add_f32_dpp v12, v12, v12 quad_perm:[2,3,0,1] row_mask:0xf bank_mask:0xf
  s_nop 1
  v_add_f32_dpp v12, v12, v12 row_half_mirror row_mask:0xf bank_mask:0xf
  v_mov_b32 v13, s8
  s_mov_b32 exec_lo, 0x01010101
  s_mov_b32 exec_hi, 1
  buffer_store_dwordx2 v[12:13], v185, s[52:55], s12 offen sc1
  s_mov_b64 exec, -1
join_11:
  ds_read_b64 a[220:221], v187 offset:10240
  ds_read_b64 a[222:223], v187 offset:10272
  ds_read_b64 a[224:225], v187 offset:10304
  ds_read_b64 a[226:227], v187 offset:10336
  ds_read_b64 a[228:229], v187 offset:10368
  v_xor_b32 v15, s8, v81
  v_cmp_lt_u32 vcc, 15, v15
  s_cbranch_vccnz again_12
ok_13:
  s_or_b32 s13, s8, s11
  v_cmp_ne_u32 vcc, s13, v81
  s_cmp_eq_u64 vcc, 0
  s_cselect_b32 s9, 1, 0
  s_waitcnt lgkmcnt(0)
  s_cmp_eq_u32 s9, 0
  s_cbranch_scc1 slow_14
  buffer_store_dwordx4 v[192:195], v211, s[52:55], s36 offen
  s_add_u32 s36, s36, 4096
  buffer_store_dwordx4 v[196:199], v211, s[52:55], s36 offen
  s_add_u32 s36, s36, 4096
  buffer_store_dwordx4 v[200:203], v211, s[52:55], s36 offen
  s_add_u32 s36, s36, 4096
  buffer_store_dwordx4 v[204:207], v211, s[52:55], s36 offen
back_15:
  s_barrier
  ds_read_b128 v[128:131], v184 offset:0
  ds_read_b128 v[132:135], v184 offset:2048
  ds_read_b128 v[88:91], v5 offset:0
  ds_read_b128 v[92:95], v5 offset:2048
  ds_read_b128 v[96:99], v5 offset:4096
  ds_read_b128 v[100:103], v5 offset:6144
  ds_read_b128 v[104:107], v5 offset:8192
  s_waitcnt lgkmcnt(4)
  v_mfma_f32_16x16x32_bf16 v[48:51], v[128:131], v[88:91], 0
  ds_read_b128 v[136:139], v189 offset:0
  ds_read_b128 v[140:143], v189 offset:2048
  ds_read_b128 v[108:111], v6 offset:0
  v_mfma_f32_16x16x32_bf16 v[52:55], v[132:135], v[88:91], 0
  s_add_u32 m0, s19, 10240
  s_add_u32 s15, s18, 5376
  buffer_load_dwordx4 v186, s[80:83], s15 offen lds
  s_add_u32 m0, s19, 11264
  s_add_u32 s15, s18, 25856
  buffer_load_dwordx4 v186, s[80:83], s15 offen lds
  s_waitcnt lgkmcnt(6)
  v_mfma_f32_16x16x32_bf16 v[56:59], v[128:131], v[92:95], 0
  ds_read_b128 v[112:115], v6 offset:2048
  v_mfma_f32_16x16x32_bf16 v[60:63], v[132:135], v[92:95], 0
  s_add_u32 m0, s19, 12288
  s_add_u32 s15, s18, 384
  buffer_load_dwordx4 v186, s[80:83], s15 offen lds
  s_add_u32 m0, s19, 13312
  s_add_u32 s15, s18, 20864
  buffer_load_dwordx4 v186, s[80:83], s15 offen lds
  s_waitcnt lgkmcnt(6)
  v_mfma_f32_16x16x32_bf16 v[64:67], v[128:131], v[96:99], 0
  ds_read_b128 v[116:119], v6 offset:4096
  v_mfma_f32_16x16x32_bf16 v[68:71], v[132:135], v[96:99], 0
  v_lshrrev_b32 v11, 1, v3
  v_lshlrev_b32 v11, 5, v11
  s_waitcnt lgkmcnt(6)
  v_mfma_f32_16x16x32_bf16 v[72:75], v[128:131], v[100:103], 0
  ds_read_b128 v[120:123], v6 offset:6144
  v_mfma_f32_16x16x32_bf16 v[76:79], v[132:135], v[100:103], 0
  v_min_u32 v12, 39, v1
  v_lshlrev_b32 v12, 5, v12
  s_waitcnt lgkmcnt(6)
  v_mfma_f32_16x16x32_bf16 v[80:83], v[128:131], v[104:107], 0
  ds_read_b128 v[124:127], v6 offset:8192
  v_mfma_f32_16x16x32_bf16 v[84:87], v[132:135], v[104:107], 0
  v_add_u32 v11, 160000, v11
  v_add_u32 v12, 160000, v12
  s_waitcnt lgkmcnt(4)
  v_mfma_f32_16x16x32_bf16 v[48:51], v[136:139], v[108:111], v[48:51]
  ds_read_b128 v[128:131], v184 offset:4096
  ds_read_b128 v[132:135], v184 offset:6144
  ds_read_b128 v[88:91], v5 offset:10240
  v_mfma_f32_16x16x32_bf16 v[52:55], v[140:143], v[108:111], v[52:55]
  s_add_u32 m0, s19, 0
  s_add_u32 s15, s18, 5504
  buffer_load_dwordx4 v186, s[80:83], s15 offen lds
  s_add_u32 m0, s19, 1024
  s_add_u32 s15, s18, 25984
  buffer_load_dwordx4 v186, s[80:83], s15 offen lds
  s_waitcnt lgkmcnt(6)
  v_mfma_f32_16x16x32_bf16 v[56:59], v[136:139], v[112:115], v[56:59]
  ds_read_b128 v[92:95], v5 offset:12288
  v_mfma_f32_16x16x32_bf16 v[60:63], v[140:143], v[112:115], v[60:63]
  ds_read_b128 v[144:147], v11 offset:0
  ds_read_b128 v[148:151], v11 offset:256
  s_waitcnt lgkmcnt(8)
  v_mfma_f32_16x16x32_bf16 v[64:67], v[136:139], v[116:119], v[64:67]
  ds_read_b128 v[96:99], v5 offset:14336
  v_mfma_f32_16x16x32_bf16 v[68:71], v[140:143], v[116:119], v[68:71]
  ds_read_b128 v[152:155], v11 offset:512
  ds_read_b128 v[156:159], v11 offset:768
  s_waitcnt lgkmcnt(10)
  v_mfma_f32_16x16x32_bf16 v[72:75], v[136:139], v[120:123], v[72:75]
  ds_read_b128 v[100:103], v5 offset:16384
  v_mfma_f32_16x16x32_bf16 v[76:79], v[140:143], v[120:123], v[76:79]
  ds_read_b128 v[160:163], v11 offset:1024
  ds_read_b64 v[40:41], v12 offset:8
  s_waitcnt lgkmcnt(12)
  v_mfma_f32_16x16x32_bf16 v[80:83], v[136:139], v[124:127], v[80:83]
  ds_read_b128 v[104:107], v5 offset:18432
  v_mfma_f32_16x16x32_bf16 v[84:87], v[140:143], v[124:127], v[84:87]
  ds_read_b128 v[36:39], v12 offset:16
  s_waitcnt lgkmcnt(11)
  v_mfma_f32_16x16x32_bf16 v[48:51], v[128:131], v[88:91], v[48:51]
  ds_read_b128 v[136:139], v189 offset:4096
  ds_read_b128 v[140:143], v189 offset:6144
  ds_read_b128 v[108:111], v6 offset:10240
  v_mfma_f32_16x16x32_bf16 v[52:55], v[132:135], v[88:91], v[52:55]
  s_add_u32 m0, s19, 2048
  s_add_u32 s15, s18, 512
  buffer_load_dwordx4 v186, s[80:83], s15 offen lds
  s_waitcnt lgkmcnt(13)
  v_mfma_f32_16x16x32_bf16 v[56:59], v[128:131], v[92:95], v[56:59]
  ds_read_b128 v[112:115], v6 offset:12288
  v_mfma_f32_16x16x32_bf16 v[60:63], v[132:135], v[92:95], v[60:63]
  s_add_u32 m0, s19, 3072
  s_add_u32 s15, s18, 20992
  buffer_load_dwordx4 v186, s[80:83], s15 offen lds
  s_waitcnt lgkmcnt(11)
  v_mfma_f32_16x16x32_bf16 v[64:67], v[128:131], v[96:99], v[64:67]
  ds_read_b128 v[116:119], v6 offset:14336
  v_mfma_f32_16x16x32_bf16 v[68:71], v[132:135], v[96:99], v[68:71]
  s_waitcnt lgkmcnt(9)
  v_mfma_f32_16x16x32_bf16 v[72:75], v[128:131], v[100:103], v[72:75]
  ds_read_b128 v[120:123], v6 offset:16384
  v_mfma_f32_16x16x32_bf16 v[76:79], v[132:135], v[100:103], v[76:79]
  s_waitcnt lgkmcnt(7)
  v_mfma_f32_16x16x32_bf16 v[80:83], v[128:131], v[104:107], v[80:83]
  ds_read_b128 v[124:127], v6 offset:18432
  v_mfma_f32_16x16x32_bf16 v[84:87], v[132:135], v[104:107], v[84:87]
  s_waitcnt vmcnt(6)
  s_barrier
  s_add_u32 s12, s16, 28672
  v_mov_b32 v15, s8
  s_mov_b64 exec, 1
  s_cmp_eq_u32 s9, 0
  s_cbranch_scc1 slow_16
  buffer_store_dword v15, off, s[52:55], s12
back_17:
  s_mov_b64 exec, -1
  s_waitcnt lgkmcnt(4)
  v_mfma_f32_16x16x32_bf16 v[48:51], v[136:139], v[108:111], v[48:51]
  ds_read_b128 v[128:131], v184 offset:8192
  ds_read_b128 v[132:135], v184 offset:10240
  ds_read_b128 v[88:91], v5 offset:20480
  v_mfma_f32_16x16x32_bf16 v[52:55], v[140:143], v[108:111], v[52:55]
  s_add_u32 m0, s19, 4096
  s_add_u32 s15, s18, 5632
  buffer_load_dwordx4 v186, s[80:83], s15 offen lds
  s_add_u32 m0, s19, 5120
  s_add_u32 s15, s18, 26112
  buffer_load_dwordx4 v186, s[80:83], s15 offen lds
  s_waitcnt lgkmcnt(6)
  v_mfma_f32_16x16x32_bf16 v[56:59], v[136:139], v[112:115], v[56:59]
  ds_read_b128 v[92:95], v5 offset:22528
  v_mfma_f32_16x16x32_bf16 v[60:63], v[140:143], v[112:115], v[60:63]
  s_waitcnt lgkmcnt(11)
  v_and_b32 v13, 1, v3
  s_waitcnt lgkmcnt(6)
  v_mfma_f32_16x16x32_bf16 v[64:67], v[136:139], v[116:119], v[64:67]
  ds_read_b128 v[96:99], v5 offset:24576
  v_mfma_f32_16x16x32_bf16 v[68:71], v[140:143], v[116:119], v[68:71]
  v_lshlrev_b32 v13, 31, v13
  v_mov_b32 v16, v144
  s_waitcnt lgkmcnt(6)
  v_mfma_f32_16x16x32_bf16 v[72:75], v[136:139], v[120:123], v[72:75]
  ds_read_b128 v[100:103], v5 offset:26624
  v_mfma_f32_16x16x32_bf16 v[76:79], v[140:143], v[120:123], v[76:79]
  v_xor_b32 v21, v13, v145
  s_waitcnt lgkmcnt(6)
  v_mfma_f32_16x16x32_bf16 v[80:83], v[136:139], v[124:127], v[80:83]
  ds_read_b128 v[104:107], v5 offset:28672
  v_mfma_f32_16x16x32_bf16 v[84:87], v[140:143], v[124:127], v[84:87]
  v_xor_b32 v26, v13, v146
  s_waitcnt lgkmcnt(4)
  v_mfma_f32_16x16x32_bf16 v[48:51], v[128:131], v[88:91], v[48:51]
  ds_read_b128 v[136:139], v189 offset:8192
  ds_read_b128 v[140:143], v189 offset:10240
  ds_read_b128 v[108:111], v6 offset:20480
  v_mfma_f32_16x16x32_bf16 v[52:55], v[132:135], v[88:91], v[52:55]
  s_add_u32 m0, s19, 6144
  s_add_u32 s15, s18, 640
  buffer_load_dwordx4 v186, s[80:83], s15 offen lds
  s_add_u32 m0, s19, 7168
  s_add_u32 s15, s18, 21120
  buffer_load_dwordx4 v186, s[80:83], s15 offen lds
  s_add_u32 m0, s40, 61440
  s_add_u32 s14, s41, 768
  buffer_load_dwordx4 v47, s[64:67], s14 offen lds
  s_waitcnt lgkmcnt(6)
  v_mfma_f32_16x16x32_bf16 v[56:59], v[128:131], v[92:95], v[56:59]
  ds_read_b128 v[112:115], v6 offset:22528
  v_mfma_f32_16x16x32_bf16 v[60:63], v[132:135], v[92:95], v[60:63]
  s_add_u32 m0, s40, 63488
  s_add_u32 s14, s41, 11008
  buffer_load_dwordx4 v47, s[64:67], s14 offen lds
  s_add_u32 m0, s40, 65536
  s_add_u32 s14, s41, 21248
  buffer_load_dwordx4 v47, s[64:67], s14 offen lds
  buffer_store_dwordx4 a[200:203], v2, s[52:55], s38 offen sc1
  s_waitcnt lgkmcnt(6)
  v_mfma_f32_16x16x32_bf16 v[64:67], v[128:131], v[96:99], v[64:67]
  ds_read_b128 v[116:119], v6 offset:24576
  v_mfma_f32_16x16x32_bf16 v[68:71], v[132:135], v[96:99], v[68:71]
  s_add_u32 s38, s38, 5120
  buffer_store_dwordx4 a[204:207], v2, s[52:55], s38 offen sc1
  buffer_store_dwordx4 v[248:251], v222, s[52:55], s37 offen sc1
  s_add_u32 s37, s37, 380928
  buffer_store_dwordx4 v[248:251], v222, s[52:55], s37 offen sc1
  s_waitcnt lgkmcnt(6)
  v_mfma_f32_16x16x32_bf16 v[72:75], v[128:131], v[100:103], v[72:75]
  ds_read_b128 v[120:123], v6 offset:26624
  v_mfma_f32_16x16x32_bf16 v[76:79], v[132:135], v[100:103], v[76:79]
  v_xor_b32 v31, 0x80000000, v147
  v_mov_b32 v17, v148
  v_xor_b32 v22, v13, v149
  s_waitcnt lgkmcnt(6)
  v_mfma_f32_16x16x32_bf16 v[80:83], v[128:131], v[104:107], v[80:83]
  ds_read_b128 v[124:127], v6 offset:28672
  v_mfma_f32_16x16x32_bf16 v[84:87], v[132:135], v[104:107], v[84:87]
  v_xor_b32_e64 v27, v13, v150
  v_xor_b32 v32, 0x80000000, v151
  v_mov_b32 v18, v152
  s_waitcnt vmcnt(14)
  s_waitcnt lgkmcnt(4)
  v_mfma_f32_16x16x32_bf16 v[48:51], v[136:139], v[108:111], v[48:51]
  ds_read_b128 v[128:131], v184 offset:12288
  ds_read_b128 v[132:135], v184 offset:0
  ds_read_b128 v[88:91], v5 offset:30720
  v_mfma_f32_16x16x32_bf16 v[52:55], v[140:143], v[108:111], v[52:55]
  s_add_u32 m0, s19, 8192
  s_add_u32 s15, s18, 5760
  buffer_load_dwordx4 v186, s[80:83], s15 offen lds
  s_add_u32 m0, s19, 9216
  s_add_u32 s15, s18, 26240
  buffer_load_dwordx4 v186, s[80:83], s15 offen lds
  s_waitcnt lgkmcnt(6)
  v_mfma_f32_16x16x32_bf16 v[56:59], v[136:139], v[112:115], v[56:59]
  ds_read_b128 v[92:95], v5 offset:32768
  v_mfma_f32_16x16x32_bf16 v[60:63], v[140:143], v[112:115], v[60:63]
  s_add_u32 m0, s40, 67584
  s_add_u32 s14, s41, 31488
  buffer_load_dwordx4 v47, s[64:67], s14 offen lds
  s_add_u32 m0, s40, 69632
  s_add_u32 s14, s41, 41728
  buffer_load_dwordx4 v47, s[64:67], s14 offen lds
  s_waitcnt lgkmcnt(6)
  v_mfma_f32_16x16x32_bf16 v[64:67], v[136:139], v[116:119], v[64:67]
  ds_read_b128 v[96:99], v5 offset:34816
  v_mfma_f32_16x16x32_bf16 v[68:71], v[140:143], v[116:119], v[68:71]
  v_xor_b32 v23, v13, v153
  v_xor_b32 v28, v13, v154
  s_waitcnt lgkmcnt(6)
  v_mfma_f32_16x16x32_bf16 v[72:75], v[136:139], v[120:123], v[72:75]
  ds_read_b128 v[100:103], v5 offset:36864
  v_mfma_f32_16x16x32_bf16 v[76:79], v[140:143], v[120:123], v[76:79]
  v_xor_b32 v33, 0x80000000, v155
  v_mov_b32 v19, v156
  s_waitcnt lgkmcnt(6)
  v_mfma_f32_16x16x32_bf16 v[80:83], v[136:139], v[124:127], v[80:83]
  ds_read_b128 v[104:107], v5 offset:38912
  v_mfma_f32_16x16x32_bf16 v[84:87], v[140:143], v[124:127], v[84:87]
  v_xor_b32 v24, v13, v157
  v_xor_b32 v29, v13, v158
  s_waitcnt lgkmcnt(4)
  v_mfma_f32_16x16x32_bf16 v[48:51], v[128:131], v[88:91], v[48:51]
  ds_read_b128 v[136:139], v189 offset:12288
  ds_read_b128 v[140:143], v189 offset:0
  ds_read_b128 v[108:111], v6 offset:30720
  v_mfma_f32_16x16x32_bf16 v[52:55], v[132:135], v[88:91], v[52:55]
  s_add_u32 m0, s19, 10240
  s_add_u32 s15, s18, 768
  buffer_load_dwordx4 v186, s[80:83], s15 offen lds
  s_add_u32 m0, s19, 11264
  s_add_u32 s15, s18, 21248
  buffer_load_dwordx4 v186, s[80:83], s15 offen lds
  s_waitcnt lgkmcnt(6)
  v_mfma_f32_16x16x32_bf16 v[56:59], v[128:131], v[92:95], v[56:59]
  ds_read_b128 v[112:115], v6 offset:32768
  v_mfma_f32_16x16x32_bf16 v[60:63], v[132:135], v[92:95], v[60:63]
  v_xor_b32 v34, 0x80000000, v159
  v_mov_b32 v20, v160
  s_waitcnt lgkmcnt(6)
  v_mfma_f32_16x16x32_bf16 v[64:67], v[128:131], v[96:99], v[64:67]
  ds_read_b128 v[116:119], v6 offset:34816
  v_mfma_f32_16x16x32_bf16 v[68:71], v[132:135], v[96:99], v[68:71]
  v_xor_b32 v25, v13, v161
  s_waitcnt lgkmcnt(6)
  v_mfma_f32_16x16x32_bf16 v[72:75], v[128:131], v[100:103], v[72:75]
  ds_read_b128 v[120:123], v6 offset:36864
  v_mfma_f32_16x16x32_bf16 v[76:79], v[132:135], v[100:103], v[76:79]
  v_xor_b32 v30, v13, v162
  s_waitcnt lgkmcnt(6)
  v_mfma_f32_16x16x32_bf16 v[80:83], v[128:131], v[104:107], v[80:83]
  ds_read_b128 v[124:127], v6 offset:38912
  v_mfma_f32_16x16x32_bf16 v[84:87], v[132:135], v[104:107], v[84:87]
  v_xor_b32 v35, 0x80000000, v163
  s_waitcnt vmcnt(15)
  s_barrier
  s_waitcnt lgkmcnt(4)
  v_mfma_f32_16x16x32_bf16 v[48:51], v[136:139], v[108:111], v[48:51]
  ds_read_b128 v[128:131], v184 offset:2048
  ds_read_b128 v[132:135], v184 offset:4096
  ds_read_b128 v[88:91], v5 offset:40960
  v_mfma_f32_16x16x32_bf16 v[52:55], v[140:143], v[108:111], v[52:55]
  s_add_u32 m0, s19, 12288
  s_add_u32 s15, s18, 5888
  buffer_load_dwordx4 v186, s[80:83], s15 offen lds
  s_waitcnt lgkmcnt(6)
  v_mfma_f32_16x16x32_bf16 v[56:59], v[136:139], v[112:115], v[56:59]
  ds_read_b128 v[92:95], v5 offset:43008
  v_mfma_f32_16x16x32_bf16 v[60:63], v[140:143], v[112:115], v[60:63]
  s_add_u32 m0, s19, 13312
  s_add_u32 s15, s18, 26368
  buffer_load_dwordx4 v186, s[80:83], s15 offen lds
  s_waitcnt lgkmcnt(6)
  v_mfma_f32_16x16x32_bf16 v[64:67], v[136:139], v[116:119], v[64:67]
  ds_read_b128 v[96:99], v5 offset:45056
  v_mfma_f32_16x16x32_bf16 v[68:71], v[140:143], v[116:119], v[68:71]
  s_waitcnt lgkmcnt(6)
  v_mfma_f32_16x16x32_bf16 v[72:75], v[136:139], v[120:123], v[72:75]
  ds_read_b128 v[100:103], v5 offset:47104
  v_mfma_f32_16x16x32_bf16 v[76:79], v[140:143], v[120:123], v[76:79]
  s_waitcnt lgkmcnt(6)
  v_mfma_f32_16x16x32_bf16 v[80:83], v[136:139], v[124:127], v[80:83]
  ds_read_b128 v[104:107], v5 offset:49152
  v_mfma_f32_16x16x32_bf16 v[84:87], v[140:143], v[124:127], v[84:87]
  s_waitcnt lgkmcnt(4)
  v_mfma_f32_16x16x32_bf16 v[48:51], v[128:131], v[88:91], v[48:51]
  ds_read_b128 v[136:139], v189 offset:2048
  ds_read_b128 v[140:143], v189 offset:4096
  ds_read_b128 v[108:111], v6 offset:40960
  v_mfma_f32_16x16x32_bf16 v[52:55], v[132:135], v[88:91], v[52:55]
  s_add_u32 m0, s19, 0
  s_add_u32 s15, s18, 896
  buffer_load_dwordx4 v186, s[80:83], s15 offen lds
  s_waitcnt lgkmcnt(6)
  v_mfma_f32_16x16x32_bf16 v[56:59], v[128:131], v[92:95], v[56:59]
  ds_read_b128 v[112:115], v6 offset:43008
  v_mfma_f32_16x16x32_bf16 v[60:63], v[132:135], v[92:95], v[60:63]
  s_add_u32 m0, s19, 1024
  s_add_u32 s15, s18, 21376
  buffer_load_dwordx4 v186, s[80:83], s15 offen lds
  s_waitcnt lgkmcnt(6)
  v_mfma_f32_16x16x32_bf16 v[64:67], v[128:131], v[96:99], v[64:67]
  ds_read_b128 v[116:119], v6 offset:45056
  v_mfma_f32_16x16x32_bf16 v[68:71], v[132:135], v[96:99], v[68:71]
  s_add_u32 m0, s40, 81920
  s_add_u32 s14, s41, 1024
  buffer_load_dwordx4 v47, s[64:67], s14 offen lds
  s_waitcnt lgkmcnt(6)
  v_mfma_f32_16x16x32_bf16 v[72:75], v[128:131], v[100:103], v[72:75]
  ds_read_b128 v[120:123], v6 offset:47104
  v_mfma_f32_16x16x32_bf16 v[76:79], v[132:135], v[100:103], v[76:79]
  s_add_u32 m0, s40, 83968
  s_add_u32 s14, s41, 11264
  buffer_load_dwordx4 v47, s[64:67], s14 offen lds
  s_waitcnt lgkmcnt(6)
  v_mfma_f32_16x16x32_bf16 v[80:83], v[128:131], v[104:107], v[80:83]
  ds_read_b128 v[124:127], v6 offset:49152
  v_mfma_f32_16x16x32_bf16 v[84:87], v[132:135], v[104:107], v[84:87]
  s_add_u32 m0, s40, 86016
  s_add_u32 s14, s41, 21504
  buffer_load_dwordx4 v47, s[64:67], s14 offen lds
  s_waitcnt vmcnt(11)
  s_add_u32 s12, s17, 20480
  v_mov_b32 v15, s8
  s_mov_b64 exec, 1
  buffer_store_dword v15, off, s[52:55], s12 sc1
  s_mov_b64 exec, -1
  s_waitcnt lgkmcnt(4)
  v_mfma_f32_16x16x32_bf16 v[48:51], v[136:139], v[108:111], v[48:51]
  ds_read_b128 v[128:131], v184 offset:6144
  ds_read_b128 v[132:135], v184 offset:8192
  ds_read_b128 v[88:91], v7 offset:0
  v_mfma_f32_16x16x32_bf16 v[52:55], v[140:143], v[108:111], v[52:55]
  s_add_u32 m0, s19, 2048
  s_add_u32 s15, s18, 6016
  buffer_load_dwordx4 v186, s[80:83], s15 offen lds
  s_add_u32 m0, s19, 3072
  s_add_u32 s15, s18, 26496
  buffer_load_dwordx4 v186, s[80:83], s15 offen lds
  s_add_u32 m0, s40, 88064
  s_add_u32 s14, s41, 31744
  buffer_load_dwordx4 v47, s[64:67], s14 offen lds
  s_waitcnt lgkmcnt(6)
  v_mfma_f32_16x16x32_bf16 v[56:59], v[136:139], v[112:115], v[56:59]
  ds_read_b128 v[92:95], v7 offset:2048
  v_mfma_f32_16x16x32_bf16 v[60:63], v[140:143], v[112:115], v[60:63]
  s_add_u32 m0, s40, 90112
  s_add_u32 s14, s41, 41984
  buffer_load_dwordx4 v47, s[64:67], s14 offen lds
  s_lshl_b32 s96, s3, 11
  s_lshl_b32 s12, s7, 9
  s_waitcnt lgkmcnt(6)
  v_mfma_f32_16x16x32_bf16 v[64:67], v[136:139], v[116:119], v[64:67]
  ds_read_b128 v[96:99], v7 offset:4096
  v_mfma_f32_16x16x32_bf16 v[68:71], v[140:143], v[116:119], v[68:71]
  s_add_u32 s96, s96, s12
  s_add_u32 s96, s96, 262144
  s_waitcnt lgkmcnt(6)
  v_mfma_f32_16x16x32_bf16 v[72:75], v[136:139], v[120:123], v[72:75]
  ds_read_b128 v[100:103], v7 offset:6144
  v_mfma_f32_16x16x32_bf16 v[76:79], v[140:143], v[120:123], v[76:79]
  v_and_b32 v187, 7, v3
  v_lshlrev_b32 v187, 4, v187
  s_waitcnt lgkmcnt(6)
  v_mfma_f32_16x16x32_bf16 v[80:83], v[136:139], v[124:127], v[80:83]
  ds_read_b128 v[104:107], v7 offset:8192
  v_mfma_f32_16x16x32_bf16 v[84:87], v[140:143], v[124:127], v[84:87]
  v_lshl_add_u32 v187, v4, 7, v187
  s_and_b32 s13, s16, 0xe00
  s_add_u32 s13, s13, 28672
  buffer_load_dwordx4 v[212:215], v223, s[52:55], s13 offen sc1
  s_waitcnt lgkmcnt(4)
  v_mfma_f32_16x16x32_bf16 v[48:51], v[128:131], v[88:91], v[48:51]
  ds_read_b128 v[136:139], v189 offset:6144
  ds_read_b128 v[140:143], v189 offset:8192
  ds_read_b128 v[108:111], v8 offset:0
  v_mfma_f32_16x16x32_bf16 v[52:55], v[132:135], v[88:91], v[52:55]
  s_add_u32 m0, s19, 4096
  s_add_u32 s15, s18, 1024
  buffer_load_dwordx4 v186, s[80:83], s15 offen lds
  s_add_u32 m0, s19, 5120
  s_add_u32 s15, s18, 21504
  buffer_load_dwordx4 v186, s[80:83], s15 offen lds
  s_waitcnt lgkmcnt(6)
  v_mfma_f32_16x16x32_bf16 v[56:59], v[128:131], v[92:95], v[56:59]
  ds_read_b128 v[112:115], v8 offset:2048
  v_mfma_f32_16x16x32_bf16 v[60:63], v[132:135], v[92:95], v[60:63]
  s_mul_i32 s44, s4, 640
  s_waitcnt lgkmcnt(6)
  v_mfma_f32_16x16x32_bf16 v[64:67], v[128:131], v[96:99], v[64:67]
  ds_read_b128 v[116:119], v8 offset:4096
  v_mfma_f32_16x16x32_bf16 v[68:71], v[132:135], v[96:99], v[68:71]
  s_add_u32 s44, s44, 303104
  s_waitcnt lgkmcnt(6)
  v_mfma_f32_16x16x32_bf16 v[72:75], v[128:131], v[100:103], v[72:75]
  ds_read_b128 v[120:123], v8 offset:6144
  v_mfma_f32_16x16x32_bf16 v[76:79], v[132:135], v[100:103], v[76:79]
  v_lshlrev_b32 v185, 3, v1
  s_waitcnt lgkmcnt(6)
  v_mfma_f32_16x16x32_bf16 v[80:83], v[128:131], v[104:107], v[80:83]
  ds_read_b128 v[124:127], v8 offset:8192
  v_mfma_f32_16x16x32_bf16 v[84:87], v[132:135], v[104:107], v[84:87]
  v_lshlrev_b32 v188, 3, v3
  s_waitcnt vmcnt(13)
  s_barrier
  s_waitcnt lgkmcnt(4)
  v_mfma_f32_16x16x32_bf16 v[48:51], v[136:139], v[108:111], v[48:51]
  ds_read_b128 v[128:131], v184 offset:10240
  ds_read_b128 v[132:135], v184 offset:12288
  ds_read_b128 v[88:91], v7 offset:10240
  v_mfma_f32_16x16x32_bf16 v[52:55], v[140:143], v[108:111], v[52:55]
  s_add_u32 m0, s19, 6144
  s_add_u32 s15, s18, 6144
  buffer_load_dwordx4 v186, s[80:83], s15 offen lds
  s_waitcnt lgkmcnt(6)
  v_mfma_f32_16x16x32_bf16 v[56:59], v[136:139], v[112:115], v[56:59]
  ds_read_b128 v[92:95], v7 offset:12288
  v_mfma_f32_16x16x32_bf16 v[60:63], v[140:143], v[112:115], v[60:63]
  s_add_u32 m0, s19, 7168
  s_add_u32 s15, s18, 26624
  buffer_load_dwordx4 v186, s[80:83], s15 offen lds
  s_waitcnt lgkmcnt(6)
  v_mfma_f32_16x16x32_bf16 v[64:67], v[136:139], v[116:119], v[64:67]
  ds_read_b128 v[96:99], v7 offset:14336
  v_mfma_f32_16x16x32_bf16 v[68:71], v[140:143], v[116:119], v[68:71]
  buffer_load_dwordx3 v[224:226], v187, s[52:55], s96 offen sc1
  s_waitcnt lgkmcnt(6)
  v_mfma_f32_16x16x32_bf16 v[72:75], v[136:139], v[120:123], v[72:75]
  ds_read_b128 v[100:103], v7 offset:16384
  v_mfma_f32_16x16x32_bf16 v[76:79], v[140:143], v[120:123], v[76:79]
  buffer_load_dwordx2 v[228:229], v185, s[52:55], s44 offen sc1
  s_waitcnt lgkmcnt(6)
  v_mfma_f32_16x16x32_bf16 v[80:83], v[136:139], v[124:127], v[80:83]
  ds_read_b128 v[104:107], v7 offset:18432
  v_mfma_f32_16x16x32_bf16 v[84:87], v[140:143], v[124:127], v[84:87]
  buffer_load_dwordx2 v[230:231], v188, s[52:55], s44 offen offset:512 sc1
  s_waitcnt lgkmcnt(4)
  v_mfma_f32_16x16x32_bf16 v[48:51], v[128:131], v[88:91], v[48:51]
  ds_read_b128 v[136:139], v189 offset:10240
  ds_read_b128 v[140:143], v189 offset:12288
  ds_read_b128 v[108:111], v8 offset:10240
  v_mfma_f32_16x16x32_bf16 v[52:55], v[132:135], v[88:91], v[52:55]
  s_add_u32 m0, s19, 8192
  s_add_u32 s15, s18, 1152
  buffer_load_dwordx4 v186, s[80:83], s15 offen lds
  s_waitcnt lgkmcnt(6)
  v_mfma_f32_16x16x32_bf16 v[56:59], v[128:131], v[92:95], v[56:59]
  ds_read_b128 v[112:115], v8 offset:12288
  v_mfma_f32_16x16x32_bf16 v[60:63], v[132:135], v[92:95], v[60:63]
  s_add_u32 m0, s19, 9216
  s_add_u32 s15, s18, 21632
  buffer_load_dwordx4 v186, s[80:83], s15 offen lds
  s_waitcnt lgkmcnt(6)
  v_mfma_f32_16x16x32_bf16 v[64:67], v[128:131], v[96:99], v[64:67]
  ds_read_b128 v[116:119], v8 offset:14336
  v_mfma_f32_16x16x32_bf16 v[68:71], v[132:135], v[96:99], v[68:71]
  s_waitcnt vmcnt(9)
  v_xor_b32 v15, s8, v212
  v_xor_b32 v14, s8, v213
  v_or_b32 v15, v15, v14
  v_xor_b32 v14, s8, v214
  v_or_b32 v15, v15, v14
  v_xor_b32 v14, s8, v215
  v_or_b32 v15, v15, v14
  v_cmp_ne_u32 vcc, 0, v15
  s_cbranch_vccnz again_18
ok_19:
  s_waitcnt lgkmcnt(6)
  v_mfma_f32_16x16x32_bf16 v[72:75], v[128:131], v[100:103], v[72:75]
  ds_read_b128 v[120:123], v8 offset:16384
  v_mfma_f32_16x16x32_bf16 v[76:79], v[132:135], v[100:103], v[76:79]
  s_waitcnt lgkmcnt(6)
  v_mfma_f32_16x16x32_bf16 v[80:83], v[128:131], v[104:107], v[80:83]
  ds_read_b128 v[124:127], v8 offset:18432
  v_mfma_f32_16x16x32_bf16 v[84:87], v[132:135], v[104:107], v[84:87]
  s_waitcnt vmcnt(12)
  s_waitcnt lgkmcnt(4)
  v_mfma_f32_16x16x32_bf16 v[48:51], v[136:139], v[108:111], v[48:51]
  ds_read_b128 v[128:131], v184 offset:0
  ds_read_b128 v[132:135], v184 offset:2048
  ds_read_b128 v[88:91], v7 offset:20480
  v_mfma_f32_16x16x32_bf16 v[52:55], v[140:143], v[108:111], v[52:55]
  s_add_u32 m0, s19, 10240
  s_add_u32 s15, s18, 6272
  buffer_load_dwordx4 v186, s[80:83], s15 offen lds
  s_waitcnt lgkmcnt(6)
  v_mfma_f32_16x16x32_bf16 v[56:59], v[136:139], v[112:115], v[56:59]
  ds_read_b128 v[92:95], v7 offset:22528
  v_mfma_f32_16x16x32_bf16 v[60:63], v[140:143], v[112:115], v[60:63]
  s_add_u32 m0, s19, 11264
  s_add_u32 s15, s18, 26752
  buffer_load_dwordx4 v186, s[80:83], s15 offen lds
  s_waitcnt lgkmcnt(6)
  v_mfma_f32_16x16x32_bf16 v[64:67], v[136:139], v[116:119], v[64:67]
  ds_read_b128 v[96:99], v7 offset:24576
  v_mfma_f32_16x16x32_bf16 v[68:71], v[140:143], v[116:119], v[68:71]
  s_mul_i32 s14, s7, 6144
  s_add_u32 m0, s14, 0
  s_nop 0
  buffer_load_dwordx4 v216, s[52:55], s20 offen sc1 lds
  s_waitcnt lgkmcnt(6)
  v_mfma_f32_16x16x32_bf16 v[72:75], v[136:139], v[120:123], v[72:75]
  ds_read_b128 v[100:103], v7 offset:26624
  v_mfma_f32_16x16x32_bf16 v[76:79], v[140:143], v[120:123], v[76:79]
  s_mul_i32 s14, s7, 6144
  s_add_u32 m0, s14, 1024
  s_nop 0
  buffer_load_dwordx4 v217, s[52:55], s21 offen sc1 lds
  s_waitcnt lgkmcnt(6)
  v_mfma_f32_16x16x32_bf16 v[80:83], v[136:139], v[124:127], v[80:83]
  ds_read_b128 v[104:107], v7 offset:28672
  v_mfma_f32_16x16x32_bf16 v[84:87], v[140:143], v[124:127], v[84:87]
  s_waitcnt lgkmcnt(4)
  v_mfma_f32_16x16x32_bf16 v[48:51], v[128:131], v[88:91], v[48:51]
  ds_read_b128 v[136:139], v189 offset:0
  ds_read_b128 v[140:143], v189 offset:2048
  ds_read_b128 v[108:111], v8 offset:20480
  v_mfma_f32_16x16x32_bf16 v[52:55], v[132:135], v[88:91], v[52:55]
  s_mul_i32 s14, s7, 6144
  s_add_u32 m0, s14, 2048
  s_nop 0
  buffer_load_dwordx4 v218, s[52:55], s22 offen sc1 lds
  s_waitcnt lgkmcnt(6)
  v_mfma_f32_16x16x32_bf16 v[56:59], v[128:131], v[92:95], v[56:59]
  ds_read_b128 v[112:115], v8 offset:22528
  v_mfma_f32_16x16x32_bf16 v[60:63], v[132:135], v[92:95], v[60:63]
  s_mul_i32 s14, s7, 6144
  s_add_u32 m0, s14, 3072
  s_nop 0
  buffer_load_dwordx4 v219, s[52:55], s23 offen sc1 lds
  s_waitcnt lgkmcnt(6)
  v_mfma_f32_16x16x32_bf16 v[64:67], v[128:131], v[96:99], v[64:67]
  ds_read_b128 v[116:119], v8 offset:24576
  v_mfma_f32_16x16x32_bf16 v[68:71], v[132:135], v[96:99], v[68:71]
  s_waitcnt lgkmcnt(6)
  v_mfma_f32_16x16x32_bf16 v[72:75], v[128:131], v[100:103], v[72:75]
  ds_read_b128 v[120:123], v8 offset:26624
  v_mfma_f32_16x16x32_bf16 v[76:79], v[132:135], v[100:103], v[76:79]
  s_waitcnt lgkmcnt(6)
  v_mfma_f32_16x16x32_bf16 v[80:83], v[128:131], v[104:107], v[80:83]
  ds_read_b128 v[124:127], v8 offset:28672
  v_mfma_f32_16x16x32_bf16 v[84:87], v[132:135], v[104:107], v[84:87]
  s_waitcnt vmcnt(11)
  s_barrier
  s_waitcnt lgkmcnt(4)
  v_mfma_f32_16x16x32_bf16 v[48:51], v[136:139], v[108:111], v[48:51]
  ds_read_b128 v[128:131], v184 offset:4096
  ds_read_b128 v[132:135], v184 offset:6144
  ds_read_b128 v[88:91], v7 offset:30720
  v_mfma_f32_16x16x32_bf16 v[52:55], v[140:143], v[108:111], v[52:55]
  s_waitcnt vmcnt(8)
  v_min3_u32 v13, v226, v229, v231
  v_max3_u32 v14, v226, v229, v231
  v_xor_b32 v13, s8, v13
  v_xor_b32 v14, s8, v14
  v_or_b32 v13, v13, v14
  v_cmp_ne_u32 vcc, 0, v13
  s_cbranch_vccnz again_20
ok_21:
  s_waitcnt lgkmcnt(6)
  v_mfma_f32_16x16x32_bf16 v[56:59], v[136:139], v[112:115], v[56:59]
  ds_read_b128 v[92:95], v7 offset:32768
  v_mfma_f32_16x16x32_bf16 v[60:63], v[140:143], v[112:115], v[60:63]
  s_mul_i32 s14, s7, 6144
  s_add_u32 m0, s14, 4096
  s_nop 0
  buffer_load_dwordx4 v220, s[52:55], s24 offen sc1 lds
  s_waitcnt lgkmcnt(6)
  v_mfma_f32_16x16x32_bf16 v[64:67], v[136:139], v[116:119], v[64:67]
  ds_read_b128 v[96:99], v7 offset:34816
  v_mfma_f32_16x16x32_bf16 v[68:71], v[140:143], v[116:119], v[68:71]
  s_mul_i32 s14, s7, 6144
  s_add_u32 m0, s14, 5120
  s_nop 0
  buffer_load_dwordx4 v221, s[52:55], s25 offen sc1 lds
  s_waitcnt lgkmcnt(6)
  v_mfma_f32_16x16x32_bf16 v[72:75], v[136:139], v[120:123], v[72:75]
  ds_read_b128 v[100:103], v7 offset:36864
  v_mfma_f32_16x16x32_bf16 v[76:79], v[140:143], v[120:123], v[76:79]
  s_waitcnt lgkmcnt(6)
  v_mfma_f32_16x16x32_bf16 v[80:83], v[136:139], v[124:127], v[80:83]
  ds_read_b128 v[104:107], v7 offset:38912
  v_mfma_f32_16x16x32_bf16 v[84:87], v[140:143], v[124:127], v[84:87]
  s_waitcnt lgkmcnt(4)
  v_mfma_f32_16x16x32_bf16 v[48:51], v[128:131], v[88:91], v[48:51]
  ds_read_b128 v[136:139], v189 offset:4096
  ds_read_b128 v[140:143], v189 offset:6144
  ds_read_b128 v[108:111], v8 offset:30720
  v_mfma_f32_16x16x32_bf16 v[52:55], v[132:135], v[88:91], v[52:55]
  v_mov_b32_dpp v168, v224 row_newbcast:0 row_mask:0xf bank_mask:0xf
  v_mov_b32_dpp v176, v225 row_newbcast:0 row_mask:0xf bank_mask:0xf
  v_mov_b32_dpp v169, v224 row_newbcast:1 row_mask:0xf bank_mask:0xf
  s_waitcnt lgkmcnt(6)
  v_mfma_f32_16x16x32_bf16 v[56:59], v[128:131], v[92:95], v[56:59]
  ds_read_b128 v[112:115], v8 offset:32768
  v_mfma_f32_16x16x32_bf16 v[60:63], v[132:135], v[92:95], v[60:63]
  v_mov_b32_dpp v177, v225 row_newbcast:1 row_mask:0xf bank_mask:0xf
  v_mov_b32_dpp v170, v224 row_newbcast:2 row_mask:0xf bank_mask:0xf
  v_mov_b32_dpp v178, v225 row_newbcast:2 row_mask:0xf bank_mask:0xf
  s_waitcnt lgkmcnt(6)
  v_mfma_f32_16x16x32_bf16 v[64:67], v[128:131], v[96:99], v[64:67]
  ds_read_b128 v[116:119], v8 offset:34816
  v_mfma_f32_16x16x32_bf16 v[68:71], v[132:135], v[96:99], v[68:71]
  v_mov_b32_dpp v171, v224 row_newbcast:3 row_mask:0xf bank_mask:0xf
  v_mov_b32_dpp v179, v225 row_newbcast:3 row_mask:0xf bank_mask:0xf
  v_subrev_u32 v216, 64, v2
  s_waitcnt lgkmcnt(6)
  v_mfma_f32_16x16x32_bf16 v[72:75], v[128:131], v[100:103], v[72:75]
  ds_read_b128 v[120:123], v8 offset:36864
  v_mfma_f32_16x16x32_bf16 v[76:79], v[132:135], v[100:103], v[76:79]
  v_add_u32 v217, 944, v2
  buffer_load_dwordx4 v[192:195], v216, s[68:71], 0 offen offset:0 nt
  s_waitcnt lgkmcnt(6)
  v_mfma_f32_16x16x32_bf16 v[80:83], v[128:131], v[104:107], v[80:83]
  ds_read_b128 v[124:127], v8 offset:38912
  v_mfma_f32_16x16x32_bf16 v[84:87], v[132:135], v[104:107], v[84:87]
  buffer_load_dwordx4 v[196:199], v217, s[68:71], 0 offen offset:0 nt
  buffer_load_dwordx4 v[200:203], v217, s[68:71], 0 offen offset:1008 nt
  s_waitcnt vmcnt(9)
  s_waitcnt lgkmcnt(4)
  v_mfma_f32_16x16x32_bf16 v[48:51], v[136:139], v[108:111], v[48:51]
  ds_read_b128 v[128:131], v184 offset:8192
  ds_read_b128 v[132:135], v184 offset:10240
  ds_read_b128 v[88:91], v7 offset:40960
  v_mfma_f32_16x16x32_bf16 v[52:55], v[140:143], v[108:111], v[52:55]
  v_mov_b32_dpp v172, v224 row_newbcast:4 row_mask:0xf bank_mask:0xf
  v_mov_b32_dpp v180, v225 row_newbcast:4 row_mask:0xf bank_mask:0xf
  v_mov_b32_dpp v173, v224 row_newbcast:5 row_mask:0xf bank_mask:0xf
  s_waitcnt lgkmcnt(6)
  v_mfma_f32_16x16x32_bf16 v[56:59], v[136:139], v[112:115], v[56:59]
  ds_read_b128 v[92:95], v7 offset:43008
  v_mfma_f32_16x16x32_bf16 v[60:63], v[140:143], v[112:115], v[60:63]
  v_mov_b32_dpp v181, v225 row_newbcast:5 row_mask:0xf bank_mask:0xf
  v_mov_b32_dpp v174, v224 row_newbcast:6 row_mask:0xf bank_mask:0xf
  v_mov_b32_dpp v182, v225 row_newbcast:6 row_mask:0xf bank_mask:0xf
  s_waitcnt lgkmcnt(6)
  v_mfma_f32_16x16x32_bf16 v[64:67], v[136:139], v[116:119], v[64:67]
  ds_read_b128 v[96:99], v7 offset:45056
  v_mfma_f32_16x16x32_bf16 v[68:71], v[140:143], v[116:119], v[68:71]
  v_mov_b32_dpp v175, v224 row_newbcast:7 row_mask:0xf bank_mask:0xf
  v_mov_b32_dpp v183, v225 row_newbcast:7 row_mask:0xf bank_mask:0xf
  buffer_load_dwordx4 v[164:167], v217, s[68:71], 0 offen offset:2016 nt
  s_waitcnt lgkmcnt(6)
  v_mfma_f32_16x16x32_bf16 v[72:75], v[136:139], v[120:123], v[72:75]
  ds_read_b128 v[100:103], v7 offset:47104
  v_mfma_f32_16x16x32_bf16 v[76:79], v[140:143], v[120:123], v[76:79]
  s_and_b32 s96, s17, 0xe00
  s_add_u32 s96, s96, 20480
  v_mov_b32 v246, v223
  s_waitcnt lgkmcnt(6)
  v_mfma_f32_16x16x32_bf16 v[80:83], v[136:139], v[124:127], v[80:83]
  ds_read_b128 v[104:107], v7 offset:49152
  v_mfma_f32_16x16x32_bf16 v[84:87], v[140:143], v[124:127], v[84:87]
  buffer_load_dwordx4 v[204:207], v246, s[52:55], s96 offen sc1
  buffer_load_dwordx4 v[240:243], v217, s[68:71], 0 offen offset:3024 nt
  s_waitcnt lgkmcnt(4)
  v_mfma_f32_16x16x32_bf16 v[48:51], v[128:131], v[88:91], v[48:51]
  ds_read_b128 v[136:139], v189 offset:8192
  ds_read_b128 v[140:143], v189 offset:10240
  ds_read_b128 v[108:111], v8 offset:40960
  v_mfma_f32_16x16x32_bf16 v[52:55], v[132:135], v[88:91], v[52:55]
  v_mov_b32 v144, v228
  v_mov_b32 v146, v228
  s_waitcnt lgkmcnt(6)
  v_mfma_f32_16x16x32_bf16 v[56:59], v[128:131], v[92:95], v[56:59]
  ds_read_b128 v[112:115], v8 offset:43008
  v_mfma_f32_16x16x32_bf16 v[60:63], v[132:135], v[92:95], v[60:63]
  v_mov_b32 v152, v230
  v_permlane16_swap_b32 v144, v146
  s_waitcnt lgkmcnt(6)
  v_mfma_f32_16x16x32_bf16 v[64:67], v[128:131], v[96:99], v[64:67]
  ds_read_b128 v[116:119], v8 offset:45056
  v_mfma_f32_16x16x32_bf16 v[68:71], v[132:135], v[96:99], v[68:71]
  v_mov_b32 v148, v144
  v_mov_b32 v150, v146
  s_waitcnt lgkmcnt(6)
  v_mfma_f32_16x16x32_bf16 v[72:75], v[128:131], v[100:103], v[72:75]
  ds_read_b128 v[120:123], v8 offset:47104
  v_mfma_f32_16x16x32_bf16 v[76:79], v[132:135], v[100:103], v[76:79]
  v_permlane32_swap_b32 v144, v148
  s_waitcnt lgkmcnt(6)
  v_mfma_f32_16x16x32_bf16 v[80:83], v[128:131], v[104:107], v[80:83]
  ds_read_b128 v[124:127], v8 offset:49152
  v_mfma_f32_16x16x32_bf16 v[84:87], v[132:135], v[104:107], v[84:87]
  v_permlane32_swap_b32 v146, v150
  s_waitcnt lgkmcnt(4)
  v_mfma_f32_16x16x32_bf16 v[48:51], v[136:139], v[108:111], v[48:51]
  v_mfma_f32_16x16x32_bf16 v[52:55], v[140:143], v[108:111], v[52:55]
  s_waitcnt lgkmcnt(3)
  v_mfma_f32_16x16x32_bf16 v[56:59], v[136:139], v[112:115], v[56:59]
  v_mfma_f32_16x16x32_bf16 v[60:63], v[140:143], v[112:115], v[60:63]
  s_waitcnt lgkmcnt(2)
  v_mfma_f32_16x16x32_bf16 v[64:67], v[136:139], v[116:119], v[64:67]
  v_mfma_f32_16x16x32_bf16 v[68:71], v[140:143], v[116:119], v[68:71]
  s_waitcnt lgkmcnt(1)
  v_mfma_f32_16x16x32_bf16 v[72:75], v[136:139], v[120:123], v[72:75]
  v_mfma_f32_16x16x32_bf16 v[76:79], v[140:143], v[120:123], v[76:79]
  s_waitcnt lgkmcnt(0)
  v_mfma_f32_16x16x32_bf16 v[80:83], v[136:139], v[124:127], v[80:83]
  v_mfma_f32_16x16x32_bf16 v[84:87], v[140:143], v[124:127], v[84:87]
  v_pk_fma_f32 v[48:49], v[168:169], v[144:145], v[48:49] op_sel_hi:[1,0,1] neg_lo:[1,0,0] neg_hi:[1,0,0]
  v_pk_fma_f32 v[50:51], v[170:171], v[144:145], v[50:51] op_sel_hi:[1,0,1] neg_lo:[1,0,0] neg_hi:[1,0,0]
  v_pk_fma_f32 v[52:53], v[172:173], v[144:145], v[52:53] op_sel_hi:[1,0,1] neg_lo:[1,0,0] neg_hi:[1,0,0]
  v_pk_fma_f32 v[54:55], v[174:175], v[144:145], v[54:55] op_sel_hi:[1,0,1] neg_lo:[1,0,0] neg_hi:[1,0,0]
  v_pk_fma_f32 v[56:57], v[168:169], v[146:147], v[56:57] op_sel_hi:[1,0,1] neg_lo:[1,0,0] neg_hi:[1,0,0]
  v_pk_fma_f32 v[58:59], v[170:171], v[146:147], v[58:59] op_sel_hi:[1,0,1] neg_lo:[1,0,0] neg_hi:[1,0,0]
  v_pk_fma_f32 v[60:61], v[172:173], v[146:147], v[60:61] op_sel_hi:[1,0,1] neg_lo:[1,0,0] neg_hi:[1,0,0]
  v_pk_fma_f32 v[62:63], v[174:175], v[146:147], v[62:63] op_sel_hi:[1,0,1] neg_lo:[1,0,0] neg_hi:[1,0,0]
  v_pk_fma_f32 v[64:65], v[168:169], v[148:149], v[64:65] op_sel_hi:[1,0,1] neg_lo:[1,0,0] neg_hi:[1,0,0]
  v_pk_fma_f32 v[66:67], v[170:171], v[148:149], v[66:67] op_sel_hi:[1,0,1] neg_lo:[1,0,0] neg_hi:[1,0,0]
  v_pk_fma_f32 v[68:69], v[172:173], v[148:149], v[68:69] op_sel_hi:[1,0,1] neg_lo:[1,0,0] neg_hi:[1,0,0]
  v_pk_fma_f32 v[70:71], v[174:175], v[148:149], v[70:71] op_sel_hi:[1,0,1] neg_lo:[1,0,0] neg_hi:[1,0,0]
  v_pk_fma_f32 v[72:73], v[168:169], v[150:151], v[72:73] op_sel_hi:[1,0,1] neg_lo:[1,0,0] neg_hi:[1,0,0]
  v_pk_fma_f32 v[74:75], v[170:171], v[150:151], v[74:75] op_sel_hi:[1,0,1] neg_lo:[1,0,0] neg_hi:[1,0,0]
  v_pk_fma_f32 v[76:77], v[172:173], v[150:151], v[76:77] op_sel_hi:[1,0,1] neg_lo:[1,0,0] neg_hi:[1,0,0]
  v_pk_fma_f32 v[78:79], v[174:175], v[150:151], v[78:79] op_sel_hi:[1,0,1] neg_lo:[1,0,0] neg_hi:[1,0,0]
  v_pk_fma_f32 v[80:81], v[168:169], v[152:153], v[80:81] op_sel_hi:[1,0,1] neg_lo:[1,0,0] neg_hi:[1,0,0]
  v_pk_fma_f32 v[82:83], v[170:171], v[152:153], v[82:83] op_sel_hi:[1,0,1] neg_lo:[1,0,0] neg_hi:[1,0,0]
  v_pk_fma_f32 v[84:85], v[172:173], v[152:153], v[84:85] op_sel_hi:[1,0,1] neg_lo:[1,0,0] neg_hi:[1,0,0]
  v_pk_fma_f32 v[86:87], v[174:175], v[152:153], v[86:87] op_sel_hi:[1,0,1] neg_lo:[1,0,0] neg_hi:[1,0,0]
  v_pk_mul_f32 v[48:49], v[48:49], v[176:177]
  v_pk_mul_f32 v[50:51], v[50:51], v[178:179]
  v_pk_mul_f32 v[52:53], v[52:53], v[180:181]
  v_pk_mul_f32 v[54:55], v[54:55], v[182:183]
  v_pk_mul_f32 v[56:57], v[56:57], v[176:177]
  v_pk_mul_f32 v[58:59], v[58:59], v[178:179]
  v_pk_mul_f32 v[60:61], v[60:61], v[180:181]
  v_pk_mul_f32 v[62:63], v[62:63], v[182:183]
  v_pk_mul_f32 v[64:65], v[64:65], v[176:177]
  v_pk_mul_f32 v[66:67], v[66:67], v[178:179]
  v_pk_mul_f32 v[68:69], v[68:69], v[180:181]
  v_pk_mul_f32 v[70:71], v[70:71], v[182:183]
  v_pk_mul_f32 v[72:73], v[72:73], v[176:177]
  v_pk_mul_f32 v[74:75], v[74:75], v[178:179]
  v_pk_mul_f32 v[76:77], v[76:77], v[180:181]
  v_pk_mul_f32 v[78:79], v[78:79], v[182:183]
  v_pk_mul_f32 v[80:81], v[80:81], v[176:177]
  v_pk_mul_f32 v[82:83], v[82:83], v[178:179]
  v_pk_mul_f32 v[84:85], v[84:85], v[180:181]
  v_pk_mul_f32 v[86:87], v[86:87], v[182:183]
  v_fma_f32 v176, v16, v48, v49
  v_fma_f32 v177, v17, v56, v57
  v_fma_f32 v178, v18, v64, v65
  v_fma_f32 v179, v19, v72, v73
  v_fma_f32 v180, v20, v80, v81
  v_fmac_f32_dpp v176, -v48, v21 quad_perm:[1,0,3,2] row_mask:0xf bank_mask:0xf
  v_fmac_f32_dpp v177, -v56, v22 quad_perm:[1,0,3,2] row_mask:0xf bank_mask:0xf
  v_fmac_f32_dpp v178, -v64, v23 quad_perm:[1,0,3,2] row_mask:0xf bank_mask:0xf
  v_fmac_f32_dpp v179, -v72, v24 quad_perm:[1,0,3,2] row_mask:0xf bank_mask:0xf
  v_fmac_f32_dpp v180, -v80, v25 quad_perm:[1,0,3,2] row_mask:0xf bank_mask:0xf
  v_fma_f32 v182, v16, v176, v50
  v_fma_f32 v183, v17, v177, v58
  v_fma_f32 v184, v18, v178, v66
  v_fma_f32 v185, v19, v179, v74
  v_fma_f32 v186, v20, v180, v82
  v_fmac_f32_dpp v182, -v176, v21 quad_perm:[1,0,3,2] row_mask:0xf bank_mask:0xf
  v_fmac_f32_dpp v183, -v177, v22 quad_perm:[1,0,3,2] row_mask:0xf bank_mask:0xf
  v_fmac_f32_dpp v184, -v178, v23 quad_perm:[1,0,3,2] row_mask:0xf bank_mask:0xf
  v_fmac_f32_dpp v185, -v179, v24 quad_perm:[1,0,3,2] row_mask:0xf bank_mask:0xf
  v_fmac_f32_dpp v186, -v180, v25 quad_perm:[1,0,3,2] row_mask:0xf bank_mask:0xf
  v_fma_f32 v176, v16, v182, v51
  v_fma_f32 v177, v17, v183, v59
  v_fma_f32 v178, v18, v184, v67
  v_fma_f32 v179, v19, v185, v75
  v_fma_f32 v180, v20, v186, v83
  v_fmac_f32_dpp v176, -v182, v21 quad_perm:[1,0,3,2] row_mask:0xf bank_mask:0xf
  v_fmac_f32_dpp v177, -v183, v22 quad_perm:[1,0,3,2] row_mask:0xf bank_mask:0xf
  v_fmac_f32_dpp v178, -v184, v23 quad_perm:[1,0,3,2] row_mask:0xf bank_mask:0xf
  v_fmac_f32_dpp v179, -v185, v24 quad_perm:[1,0,3,2] row_mask:0xf bank_mask:0xf
  v_fmac_f32_dpp v180, -v186, v25 quad_perm:[1,0,3,2] row_mask:0xf bank_mask:0xf
  v_fma_f32 v182, v16, v176, v52
  v_fma_f32 v183, v17, v177, v60
  v_fma_f32 v184, v18, v178, v68
  v_fma_f32 v185, v19, v179, v76
  v_fma_f32 v186, v20, v180, v84
  v_fmac_f32_dpp v182, -v176, v21 quad_perm:[1,0,3,2] row_mask:0xf bank_mask:0xf
  v_fmac_f32_dpp v183, -v177, v22 quad_perm:[1,0,3,2] row_mask:0xf bank_mask:0xf
  v_fmac_f32_dpp v184, -v178, v23 quad_perm:[1,0,3,2] row_mask:0xf bank_mask:0xf
  v_fmac_f32_dpp v185, -v179, v24 quad_perm:[1,0,3,2] row_mask:0xf bank_mask:0xf
  v_fmac_f32_dpp v186, -v180, v25 quad_perm:[1,0,3,2] row_mask:0xf bank_mask:0xf
  v_fma_f32 v176, v16, v182, v53
  v_fma_f32 v177, v17, v183, v61
  v_fma_f32 v178, v18, v184, v69
  v_fma_f32 v179, v19, v185, v77
  v_fma_f32 v180, v20, v186, v85
  v_fmac_f32_dpp v176, -v182, v21 quad_perm:[1,0,3,2] row_mask:0xf bank_mask:0xf
  v_fmac_f32_dpp v177, -v183, v22 quad_perm:[1,0,3,2] row_mask:0xf bank_mask:0xf
  v_fmac_f32_dpp v178, -v184, v23 quad_perm:[1,0,3,2] row_mask:0xf bank_mask:0xf
  v_fmac_f32_dpp v179, -v185, v24 quad_perm:[1,0,3,2] row_mask:0xf bank_mask:0xf
  v_fmac_f32_dpp v180, -v186, v25 quad_perm:[1,0,3,2] row_mask:0xf bank_mask:0xf
  v_fma_f32 v182, v16, v176, v54
  v_fma_f32 v183, v17, v177, v62
  v_fma_f32 v184, v18, v178, v70
  v_fma_f32 v185, v19, v179, v78
  v_fma_f32 v186, v20, v180, v86
  v_fmac_f32_dpp v182, -v176, v21 quad_perm:[1,0,3,2] row_mask:0xf bank_mask:0xf
  v_fmac_f32_dpp v183, -v177, v22 quad_perm:[1,0,3,2] row_mask:0xf bank_mask:0xf
  v_fmac_f32_dpp v184, -v178, v23 quad_perm:[1,0,3,2] row_mask:0xf bank_mask:0xf
  v_fmac_f32_dpp v185, -v179, v24 quad_perm:[1,0,3,2] row_mask:0xf bank_mask:0xf
  v_fmac_f32_dpp v186, -v180, v25 quad_perm:[1,0,3,2] row_mask:0xf bank_mask:0xf
  v_fma_f32 v176, v16, v182, v55
  v_fma_f32 v177, v17, v183, v63
  v_fma_f32 v178, v18, v184, v71
  v_fma_f32 v179, v19, v185, v79
  v_fma_f32 v180, v20, v186, v87
  v_fmac_f32_dpp v176, -v182, v21 quad_perm:[1,0,3,2] row_mask:0xf bank_mask:0xf
  v_fmac_f32_dpp v177, -v183, v22 quad_perm:[1,0,3,2] row_mask:0xf bank_mask:0xf
  v_fmac_f32_dpp v178, -v184, v23 quad_perm:[1,0,3,2] row_mask:0xf bank_mask:0xf
  v_fmac_f32_dpp v179, -v185, v24 quad_perm:[1,0,3,2] row_mask:0xf bank_mask:0xf
  v_fmac_f32_dpp v180, -v186, v25 quad_perm:[1,0,3,2] row_mask:0xf bank_mask:0xf
  ds_write_b32 v9, v176 offset:0
  ds_write_b32 v9, v177 offset:1152
  ds_write_b32 v9, v178 offset:2304
  ds_write_b32 v9, v179 offset:3456
  ds_write_b32 v9, v180 offset:4608
  v_min_u32_e64 v11, 39, v1
  v_mul_u32_u24 v12, 144, v11
  v_add_u32 v12, 158080, v12
  s_cmp_lg_u32 s7, 2
  s_waitcnt lgkmcnt(0)
  s_barrier
  s_cbranch_scc1 skip_22
  ds_read_b128 v[208:211], v12 offset:0
  ds_read_b128 v[212:215], v12 offset:16
  ds_read_b128 v[216:219], v12 offset:32
  ds_read_b128 v[220:223], v12 offset:48
  ds_read_b128 v[224:227], v12 offset:64
  ds_read_b128 v[228:231], v12 offset:80
  ds_read_b128 v[232:235], v12 offset:96
  ds_read_b128 v[236:239], v12 offset:112
  v_lshlrev_b32_e64 v11, 4, v11
  s_add_u32 s12, s95, 11520
  v_mov_b32 v44, s8
  v_mov_b32 v45, s8
  s_waitcnt lgkmcnt(7)
  v_pk_fma_f32 v[42:43], v[208:209], v[36:37], v[210:211] op_sel:[1,1,0] op_sel_hi:[0,1,1] neg_lo:[0,1,0]
  v_pk_fma_f32 v[42:43], v[208:209], v[36:37], v[42:43] op_sel:[0,0,0] op_sel_hi:[1,0,1]
  s_waitcnt lgkmcnt(6)
  v_pk_fma_f32 v[46:47], v[42:43], v[36:37], v[212:213] op_sel:[1,1,0] op_sel_hi:[0,1,1] neg_lo:[0,1,0]
  v_pk_fma_f32 v[46:47], v[42:43], v[36:37], v[46:47] op_sel:[0,0,0] op_sel_hi:[1,0,1]
  v_pk_fma_f32 v[42:43], v[46:47], v[36:37], v[214:215] op_sel:[1,1,0] op_sel_hi:[0,1,1] neg_lo:[0,1,0]
  v_pk_fma_f32 v[42:43], v[46:47], v[36:37], v[42:43] op_sel:[0,0,0] op_sel_hi:[1,0,1]
  s_waitcnt lgkmcnt(5)
  v_pk_fma_f32 v[46:47], v[42:43], v[36:37], v[216:217] op_sel:[1,1,0] op_sel_hi:[0,1,1] neg_lo:[0,1,0]
  v_pk_fma_f32 v[46:47], v[42:43], v[36:37], v[46:47] op_sel:[0,0,0] op_sel_hi:[1,0,1]
  v_pk_fma_f32 v[42:43], v[46:47], v[36:37], v[218:219] op_sel:[1,1,0] op_sel_hi:[0,1,1] neg_lo:[0,1,0]
  v_pk_fma_f32 v[42:43], v[46:47], v[36:37], v[42:43] op_sel:[0,0,0] op_sel_hi:[1,0,1]
  s_waitcnt lgkmcnt(4)
  v_pk_fma_f32 v[46:47], v[42:43], v[36:37], v[220:221] op_sel:[1,1,0] op_sel_hi:[0,1,1] neg_lo:[0,1,0]
  v_pk_fma_f32 v[46:47], v[42:43], v[36:37], v[46:47] op_sel:[0,0,0] op_sel_hi:[1,0,1]
  v_pk_fma_f32 v[42:43], v[46:47], v[36:37], v[222:223] op_sel:[1,1,0] op_sel_hi:[0,1,1] neg_lo:[0,1,0]
  v_pk_fma_f32 v[42:43], v[46:47], v[36:37], v[42:43] op_sel:[0,0,0] op_sel_hi:[1,0,1]
  s_waitcnt lgkmcnt(3)
  v_pk_fma_f32 v[46:47], v[42:43], v[36:37], v[224:225] op_sel:[1,1,0] op_sel_hi:[0,1,1] neg_lo:[0,1,0]
  v_pk_fma_f32 v[46:47], v[42:43], v[36:37], v[46:47] op_sel:[0,0,0] op_sel_hi:[1,0,1]
  v_pk_fma_f32 v[42:43], v[46:47], v[36:37], v[226:227] op_sel:[1,1,0] op_sel_hi:[0,1,1] neg_lo:[0,1,0]
  v_pk_fma_f32 v[42:43], v[46:47], v[36:37], v[42:43] op_sel:[0,0,0] op_sel_hi:[1,0,1]
  s_waitcnt lgkmcnt(2)
  v_pk_fma_f32 v[46:47], v[42:43], v[36:37], v[228:229] op_sel:[1,1,0] op_sel_hi:[0,1,1] neg_lo:[0,1,0]
  v_pk_fma_f32 v[46:47], v[42:43], v[36:37], v[46:47] op_sel:[0,0,0] op_sel_hi:[1,0,1]
  v_pk_fma_f32 v[42:43], v[46:47], v[36:37], v[230:231] op_sel:[1,1,0] op_sel_hi:[0,1,1] neg_lo:[0,1,0]
  v_pk_fma_f32 v[42:43], v[46:47], v[36:37], v[42:43] op_sel:[0,0,0] op_sel_hi:[1,0,1]
  s_waitcnt lgkmcnt(1)
  v_pk_fma_f32 v[46:47], v[42:43], v[36:37], v[232:233] op_sel:[1,1,0] op_sel_hi:[0,1,1] neg_lo:[0,1,0]
  v_pk_fma_f32 v[46:47], v[42:43], v[36:37], v[46:47] op_sel:[0,0,0] op_sel_hi:[1,0,1]
  v_pk_fma_f32 v[42:43], v[46:47], v[36:37], v[234:235] op_sel:[1,1,0] op_sel_hi:[0,1,1] neg_lo:[0,1,0]
  v_pk_fma_f32 v[42:43], v[46:47], v[36:37], v[42:43] op_sel:[0,0,0] op_sel_hi:[1,0,1]
  s_waitcnt lgkmcnt(0)
  v_pk_fma_f32 v[46:47], v[42:43], v[36:37], v[236:237] op_sel:[1,1,0] op_sel_hi:[0,1,1] neg_lo:[0,1,0]
  v_pk_fma_f32 v[46:47], v[42:43], v[36:37], v[46:47] op_sel:[0,0,0] op_sel_hi:[1,0,1]
  v_pk_fma_f32 v[42:43], v[46:47], v[36:37], v[238:239] op_sel:[1,1,0] op_sel_hi:[0,1,1] neg_lo:[0,1,0]
  v_pk_fma_f32 v[42:43], v[46:47], v[36:37], v[42:43] op_sel:[0,0,0] op_sel_hi:[1,0,1]
  buffer_store_dwordx4 v[42:45], v11, s[52:55], s12 offen sc1
  v_pk_mul_f32 v[46:47], v[208:209], v[40:41] op_sel:[1,1] op_sel_hi:[0,1] neg_lo:[0,1] neg_hi:[0,1]
  v_pk_fma_f32 v[208:209], v[208:209], v[40:41], v[46:47] op_sel:[0,0,0] op_sel_hi:[1,0,1] neg_hi:[0,1,0]
  v_pk_mul_f32 v[46:47], v[210:211], v[40:41] op_sel:[1,1] op_sel_hi:[0,1] neg_lo:[0,1] neg_hi:[0,1]
  v_pk_fma_f32 v[210:211], v[210:211], v[40:41], v[46:47] op_sel:[0,0,0] op_sel_hi:[1,0,1] neg_hi:[0,1,0]
  v_pk_mul_f32 v[46:47], v[212:213], v[40:41] op_sel:[1,1] op_sel_hi:[0,1] neg_lo:[0,1] neg_hi:[0,1]
  v_pk_fma_f32 v[212:213], v[212:213], v[40:41], v[46:47] op_sel:[0,0,0] op_sel_hi:[1,0,1] neg_hi:[0,1,0]
  v_pk_mul_f32 v[46:47], v[214:215], v[40:41] op_sel:[1,1] op_sel_hi:[0,1] neg_lo:[0,1] neg_hi:[0,1]
  v_pk_fma_f32 v[214:215], v[214:215], v[40:41], v[46:47] op_sel:[0,0,0] op_sel_hi:[1,0,1] neg_hi:[0,1,0]
  v_pk_mul_f32 v[46:47], v[216:217], v[40:41] op_sel:[1,1] op_sel_hi:[0,1] neg_lo:[0,1] neg_hi:[0,1]
  v_pk_fma_f32 v[216:217], v[216:217], v[40:41], v[46:47] op_sel:[0,0,0] op_sel_hi:[1,0,1] neg_hi:[0,1,0]
  v_pk_mul_f32 v[46:47], v[218:219], v[40:41] op_sel:[1,1] op_sel_hi:[0,1] neg_lo:[0,1] neg_hi:[0,1]
  v_pk_fma_f32 v[218:219], v[218:219], v[40:41], v[46:47] op_sel:[0,0,0] op_sel_hi:[1,0,1] neg_hi:[0,1,0]
  v_pk_mul_f32 v[46:47], v[220:221], v[40:41] op_sel:[1,1] op_sel_hi:[0,1] neg_lo:[0,1] neg_hi:[0,1]
  v_pk_fma_f32 v[220:221], v[220:221], v[40:41], v[46:47] op_sel:[0,0,0] op_sel_hi:[1,0,1] neg_hi:[0,1,0]
  v_pk_mul_f32 v[46:47], v[222:223], v[40:41] op_sel:[1,1] op_sel_hi:[0,1] neg_lo:[0,1] neg_hi:[0,1]
  v_pk_fma_f32 v[222:223], v[222:223], v[40:41], v[46:47] op_sel:[0,0,0] op_sel_hi:[1,0,1] neg_hi:[0,1,0]
  v_pk_mul_f32 v[46:47], v[224:225], v[40:41] op_sel:[1,1] op_sel_hi:[0,1] neg_lo:[0,1] neg_hi:[0,1]
  v_pk_fma_f32 v[224:225], v[224:225], v[40:41], v[46:47] op_sel:[0,0,0] op_sel_hi:[1,0,1] neg_hi:[0,1,0]
  v_pk_mul_f32 v[46:47], v[226:227], v[40:41] op_sel:[1,1] op_sel_hi:[0,1] neg_lo:[0,1] neg_hi:[0,1]
  v_pk_fma_f32 v[226:227], v[226:227], v[40:41], v[46:47] op_sel:[0,0,0] op_sel_hi:[1,0,1] neg_hi:[0,1,0]
  v_pk_mul_f32 v[46:47], v[228:229], v[40:41] op_sel:[1,1] op_sel_hi:[0,1] neg_lo:[0,1] neg_hi:[0,1]
  v_pk_fma_f32 v[228:229], v[228:229], v[40:41], v[46:47] op_sel:[0,0,0] op_sel_hi:[1,0,1] neg_hi:[0,1,0]
  v_pk_mul_f32 v[46:47], v[230:231], v[40:41] op_sel:[1,1] op_sel_hi:[0,1] neg_lo:[0,1] neg_hi:[0,1]
  v_pk_fma_f32 v[230:231], v[230:231], v[40:41], v[46:47] op_sel:[0,0,0] op_sel_hi:[1,0,1] neg_hi:[0,1,0]
  v_pk_mul_f32 v[46:47], v[232:233], v[40:41] op_sel:[1,1] op_sel_hi:[0,1] neg_lo:[0,1] neg_hi:[0,1]
  v_pk_fma_f32 v[232:233], v[232:233], v[40:41], v[46:47] op_sel:[0,0,0] op_sel_hi:[1,0,1] neg_hi:[0,1,0]
  v_pk_mul_f32 v[46:47], v[234:235], v[40:41] op_sel:[1,1] op_sel_hi:[0,1] neg_lo:[0,1] neg_hi:[0,1]
  v_pk_fma_f32 v[234:235], v[234:235], v[40:41], v[46:47] op_sel:[0,0,0] op_sel_hi:[1,0,1] neg_hi:[0,1,0]
  v_pk_mul_f32 v[46:47], v[236:237], v[40:41] op_sel:[1,1] op_sel_hi:[0,1] neg_lo:[0,1] neg_hi:[0,1]
  v_pk_fma_f32 v[236:237], v[236:237], v[40:41], v[46:47] op_sel:[0,0,0] op_sel_hi:[1,0,1] neg_hi:[0,1,0]
  v_pk_mul_f32 v[46:47], v[238:239], v[40:41] op_sel:[1,1] op_sel_hi:[0,1] neg_lo:[0,1] neg_hi:[0,1]
  v_pk_fma_f32 v[238:239], v[238:239], v[40:41], v[46:47] op_sel:[0,0,0] op_sel_hi:[1,0,1] neg_hi:[0,1,0]
  s_add_u32 s80, s95, 0
  s_add_u32 s81, s95, 3840
  s_add_u32 s82, s95, 7680
skip_22:
  v_mul_f32 v88, v26, v48
  v_mul_f32 v89, v26, v49
  v_mul_f32 v90, v26, v50
  v_mul_f32 v91, v26, v51
  v_mul_f32 v92, v26, v52
  v_mul_f32 v93, v26, v53
  v_mul_f32 v94, v26, v54
  v_mul_f32_e64 v95, v26, v55
  v_fmac_f32_dpp v88, v48, v31 quad_perm:[1,0,3,2] row_mask:0xf bank_mask:0xf
  v_fmac_f32_dpp v89, v49, v31 quad_perm:[1,0,3,2] row_mask:0xf bank_mask:0xf
  v_fmac_f32_dpp v90, v50, v31 quad_perm:[1,0,3,2] row_mask:0xf bank_mask:0xf
  v_fmac_f32_dpp v91, v51, v31 quad_perm:[1,0,3,2] row_mask:0xf bank_mask:0xf
  v_fmac_f32_dpp v92, v52, v31 quad_perm:[1,0,3,2] row_mask:0xf bank_mask:0xf
  v_fmac_f32_dpp v93, v53, v31 quad_perm:[1,0,3,2] row_mask:0xf bank_mask:0xf
  v_fmac_f32_dpp v94, v54, v31 quad_perm:[1,0,3,2] row_mask:0xf bank_mask:0xf
  v_fmac_f32_dpp v95, v55, v31 quad_perm:[1,0,3,2] row_mask:0xf bank_mask:0xf
  v_mul_f32 v96, v27, v56
  v_mul_f32 v97, v27, v57
  v_mul_f32 v98, v27, v58
  v_mul_f32 v99, v27, v59
  v_mul_f32 v100, v27, v60
  v_mul_f32 v101, v27, v61
  v_mul_f32 v102, v27, v62
  v_mul_f32 v103, v27, v63
  v_fmac_f32_dpp v96, v56, v32 quad_perm:[1,0,3,2] row_mask:0xf bank_mask:0xf
  v_fmac_f32_dpp v97, v57, v32 quad_perm:[1,0,3,2] row_mask:0xf bank_mask:0xf
  v_fmac_f32_dpp v98, v58, v32 quad_perm:[1,0,3,2] row_mask:0xf bank_mask:0xf
  v_fmac_f32_dpp v99, v59, v32 quad_perm:[1,0,3,2] row_mask:0xf bank_mask:0xf
  v_fmac_f32_dpp v100, v60, v32 quad_perm:[1,0,3,2] row_mask:0xf bank_mask:0xf
  v_fmac_f32_dpp v101, v61, v32 quad_perm:[1,0,3,2] row_mask:0xf bank_mask:0xf
  v_fmac_f32_dpp v102, v62, v32 quad_perm:[1,0,3,2] row_mask:0xf bank_mask:0xf
  v_fmac_f32_dpp v103, v63, v32 quad_perm:[1,0,3,2] row_mask:0xf bank_mask:0xf
  v_mul_f32 v104, v28, v64
  v_mul_f32 v105, v28, v65
  v_mul_f32 v106, v28, v66
  v_mul_f32 v107, v28, v67
  v_mul_f32 v108, v28, v68
  v_mul_f32 v109, v28, v69
  v_mul_f32 v110, v28, v70
  v_mul_f32 v111, v28, v71
  v_fmac_f32_dpp v104, v64, v33 quad_perm:[1,0,3,2] row_mask:0xf bank_mask:0xf
  v_fmac_f32_dpp v105, v65, v33 quad_perm:[1,0,3,2] row_mask:0xf bank_mask:0xf
  v_fmac_f32_dpp v106, v66, v33 quad_perm:[1,0,3,2] row_mask:0xf bank_mask:0xf
  v_fmac_f32_dpp v107, v67, v33 quad_perm:[1,0,3,2] row_mask:0xf bank_mask:0xf
  v_fmac_f32_dpp v108, v68, v33 quad_perm:[1,0,3,2] row_mask:0xf bank_mask:0xf
  v_fmac_f32_dpp v109, v69, v33 quad_perm:[1,0,3,2] row_mask:0xf bank_mask:0xf
  v_fmac_f32_dpp v110, v70, v33 quad_perm:[1,0,3,2] row_mask:0xf bank_mask:0xf
  v_fmac_f32_dpp v111, v71, v33 quad_perm:[1,0,3,2] row_mask:0xf bank_mask:0xf
  v_mul_f32 v112, v29, v72
  v_mul_f32 v113, v29, v73
  v_mul_f32 v114, v29, v74
  v_mul_f32 v115, v29, v75
  v_mul_f32 v116, v29, v76
  v_mul_f32 v117, v29, v77
  v_mul_f32 v118, v29, v78
  v_mul_f32 v119, v29, v79
  v_fmac_f32_dpp v112, v72, v34 quad_perm:[1,0,3,2] row_mask:0xf bank_mask:0xf
  v_fmac_f32_dpp v113, v73, v34 quad_perm:[1,0,3,2] row_mask:0xf bank_mask:0xf
  v_fmac_f32_dpp v114, v74, v34 quad_perm:[1,0,3,2] row_mask:0xf bank_mask:0xf
  v_fmac_f32_dpp v115, v75, v34 quad_perm:[1,0,3,2] row_mask:0xf bank_mask:0xf
  v_fmac_f32_dpp v116, v76, v34 quad_perm:[1,0,3,2] row_mask:0xf bank_mask:0xf
  v_fmac_f32_dpp v117, v77, v34 quad_perm:[1,0,3,2] row_mask:0xf bank_mask:0xf
  v_fmac_f32_dpp v118, v78, v34 quad_perm:[1,0,3,2] row_mask:0xf bank_mask:0xf
  v_fmac_f32_dpp v119, v79, v34 quad_perm:[1,0,3,2] row_mask:0xf bank_mask:0xf
  v_mul_f32 v120, v30, v80
  v_mul_f32 v121, v30, v81
  v_mul_f32 v122, v30, v82
  v_mul_f32 v123, v30, v83
  v_mul_f32 v124, v30, v84
  v_mul_f32 v125, v30, v85
  v_mul_f32 v126, v30, v86
  v_mul_f32 v127, v30, v87
  v_fmac_f32_dpp v120, v80, v35 quad_perm:[1,0,3,2] row_mask:0xf bank_mask:0xf
  v_fmac_f32_dpp v121, v81, v35 quad_perm:[1,0,3,2] row_mask:0xf bank_mask:0xf
  v_fmac_f32_dpp v122, v82, v35 quad_perm:[1,0,3,2] row_mask:0xf bank_mask:0xf
  v_fmac_f32_dpp v123, v83, v35 quad_perm:[1,0,3,2] row_mask:0xf bank_mask:0xf
  v_fmac_f32_dpp v124, v84, v35 quad_perm:[1,0,3,2] row_mask:0xf bank_mask:0xf
  v_fmac_f32_dpp v125, v85, v35 quad_perm:[1,0,3,2] row_mask:0xf bank_mask:0xf
  v_fmac_f32_dpp v126, v86, v35 quad_perm:[1,0,3,2] row_mask:0xf bank_mask:0xf
  v_fmac_f32_dpp v127, v87, v35 quad_perm:[1,0,3,2] row_mask:0xf bank_mask:0xf
  s_mul_i32 s18, s6, 200
  s_mul_i32 s12, s7, 50
  s_add_u32 s18, s18, s12
  s_lshl_b32 s18, s18, 10
  s_add_u32 s18, s18, 23068672
  s_waitcnt vmcnt(1)
  v_xor_b32 v15, s8, v204
  v_xor_b32 v14, s8, v205
  v_or_b32 v15, v15, v14
  v_xor_b32 v14, s8, v206
  v_or_b32 v15, v15, v14
  v_xor_b32 v14, s8, v207
  v_or_b32 v15, v15, v14
  v_cmp_ne_u32 vcc, 0, v15
  s_cbranch_vccnz again_23
ok_24:
  buffer_load_dwordx4 a[0:3], v2, s[52:55], s18 offen offset:0 sc1
  buffer_load_dwordx4 a[4:7], v2, s[52:55], s18 offen offset:1024 sc1
  buffer_load_dwordx4 a[8:11], v2, s[52:55], s18 offen offset:2048 sc1
  buffer_load_dwordx4 a[12:15], v2, s[52:55], s18 offen offset:3072 sc1
  s_add_u32 s18, s18, 4096
  buffer_load_dwordx4 a[16:19], v2, s[52:55], s18 offen offset:0 sc1
  buffer_load_dwordx4 a[20:23], v2, s[52:55], s18 offen offset:1024 sc1
  buffer_load_dwordx4 a[24:27], v2, s[52:55], s18 offen offset:2048 sc1
  buffer_load_dwordx4 a[28:31], v2, s[52:55], s18 offen offset:3072 sc1
  s_add_u32 s18, s18, 4096
  buffer_load_dwordx4 a[32:35], v2, s[52:55], s18 offen offset:0 sc1
  buffer_load_dwordx4 a[36:39], v2, s[52:55], s18 offen offset:1024 sc1
  v_accvgpr_read_b32 v252, a208
  v_accvgpr_read_b32 v253, a209
  v_accvgpr_read_b32 v254, a210
  v_accvgpr_read_b32 v255, a211
  v_min_u32 v251, 39, v1
  v_mul_u32_u24 v247, 144, v251
  v_add_u32 v247, 158080, v247
  v_lshlrev_b32_e64 v251, 4, v251
  s_and_b32 s22, s72, 0xffff
  s_lshl_b32 s23, s72, 16
  s_lshr_b32 s24, s72, 16
  s_and_b32 s25, s72, 0xffff0000
  s_cmp_eq_u32 s7, 2
  s_cbranch_scc1 skip_25
  s_min_u32 s12, s7, 2
  s_mul_i32 s12, s12, 16640
  s_add_u32 s12, s12, 102400
  v_add_u32 v11, s12, v2
  s_waitcnt vmcnt(14)
  v_mov_b32_dpp v142, v192 wave_shl:1 row_mask:0xf bank_mask:0xf
  v_mov_b32_dpp v143, v193 wave_shl:1 row_mask:0xf bank_mask:0xf
  v_mov_b32 v140, v194
  v_mov_b32_e64 v141, v195
  v_alignbit_b32 v128, v193, v192, 16
  v_alignbit_b32 v129, v194, v193, 16
  v_alignbit_b32 v130, v195, v194, 16
  v_alignbit_b32 v131, v142, v195, 16
  v_mov_b32 v132, v193
  v_mov_b32 v133, v194
  v_mov_b32 v134, v195
  v_mov_b32 v135, v142
  v_alignbit_b32 v136, v194, v193, 16
  v_alignbit_b32 v137, v195, v194, 16
  v_alignbit_b32 v138, v142, v195, 16
  v_alignbit_b32 v139, v143, v142, 16
  s_mov_b32 exec_hi, 0x7fffffff
  ds_write_b128 v11, v[128:131] offset:0
  ds_write_b128 v11, v[132:135] offset:4160
  ds_write_b128 v11, v[136:139] offset:8320
  ds_write_b128 v11, v[140:143] offset:12480
  s_mov_b64 exec, -1
  s_waitcnt vmcnt(13)
  v_mov_b32_dpp v158, v196 wave_shl:1 row_mask:0xf bank_mask:0xf
  v_mov_b32_dpp v159, v197 wave_shl:1 row_mask:0xf bank_mask:0xf
  v_mov_b32 v156, v198
  v_mov_b32 v157, v199
  v_alignbit_b32 v144, v197, v196, 16
  v_alignbit_b32 v145, v198, v197, 16
  v_alignbit_b32 v146, v199, v198, 16
  v_alignbit_b32 v147, v158, v199, 16
  v_mov_b32 v148, v197
  v_mov_b32 v149, v198
  v_mov_b32 v150, v199
  v_mov_b32 v151, v158
  v_alignbit_b32 v152, v198, v197, 16
  v_alignbit_b32 v153, v199, v198, 16
  v_alignbit_b32 v154, v158, v199, 16
  v_alignbit_b32 v155, v159, v158, 16
  s_mov_b32 exec_hi, 0x7fffffff
  ds_write_b128 v11, v[144:147] offset:1008
  ds_write_b128 v11, v[148:151] offset:5168
  ds_write_b128 v11, v[152:155] offset:9328
  ds_write_b128 v11, v[156:159] offset:13488
  s_mov_b64 exec, -1
  s_waitcnt vmcnt(12)
  v_mov_b32_dpp v142, v200 wave_shl:1 row_mask:0xf bank_mask:0xf
  v_mov_b32_dpp v143, v201 wave_shl:1 row_mask:0xf bank_mask:0xf
  v_mov_b32 v140, v202
  v_mov_b32 v141, v203
  v_alignbit_b32 v128, v201, v200, 16
  v_alignbit_b32 v129, v202, v201, 16
  v_alignbit_b32 v130, v203, v202, 16
  v_alignbit_b32 v131, v142, v203, 16
  v_mov_b32 v132, v201
  v_mov_b32 v133, v202
  v_mov_b32 v134, v203
  v_mov_b32 v135, v142
  v_alignbit_b32 v136, v202, v201, 16
  v_alignbit_b32 v137, v203, v202, 16
  v_alignbit_b32 v138, v142, v203, 16
  v_alignbit_b32 v139, v143, v142, 16
  s_mov_b32 exec_hi, 0x7fffffff
  ds_write_b128 v11, v[128:131] offset:2016
  ds_write_b128 v11, v[132:135] offset:6176
  ds_write_b128 v11, v[136:139] offset:10336
  ds_write_b128 v11, v[140:143] offset:14496
  s_mov_b64 exec, -1
  s_waitcnt vmcnt(11)
  v_mov_b32_dpp v158, v164 wave_shl:1 row_mask:0xf bank_mask:0xf
  v_mov_b32_dpp v159, v165 wave_shl:1 row_mask:0xf bank_mask:0xf
  v_mov_b32 v156, v166
  v_mov_b32 v157, v167
  v_alignbit_b32 v144, v165, v164, 16
  v_alignbit_b32 v145, v166, v165, 16
  v_alignbit_b32 v146, v167, v166, 16
  v_alignbit_b32 v147, v158, v167, 16
  v_mov_b32 v148, v165
  v_mov_b32 v149, v166
  v_mov_b32 v150, v167
  v_mov_b32 v151, v158
  v_alignbit_b32 v152, v166, v165, 16
  v_alignbit_b32 v153, v167, v166, 16
  v_alignbit_b32 v154, v158, v167, 16
  v_alignbit_b32 v155, v159, v158, 16
  s_mov_b32 exec_hi, 0x7fffffff
  ds_write_b128 v11, v[144:147] offset:3024
  ds_write_b128 v11, v[148:151] offset:7184
  ds_write_b128 v11, v[152:155] offset:11344
  ds_write_b128 v11, v[156:159] offset:15504
  s_mov_b64 exec, -1
  s_waitcnt vmcnt(10)
  v_mov_b32_dpp v142, v240 wave_shl:1 row_mask:0xf bank_mask:0xf
  v_mov_b32_dpp v143, v241 wave_shl:1 row_mask:0xf bank_mask:0xf
  v_mov_b32 v140, v242
  v_mov_b32 v141, v243
  v_alignbit_b32 v128, v241, v240, 16
  v_alignbit_b32 v129, v242, v241, 16
  v_alignbit_b32 v130, v243, v242, 16
  v_alignbit_b32 v131, v142, v243, 16
  v_mov_b32 v132, v241
  v_mov_b32 v133, v242
  v_mov_b32 v134, v243
  v_mov_b32 v135, v142
  v_alignbit_b32 v136, v242, v241, 16
  v_alignbit_b32 v137, v243, v242, 16
  v_alignbit_b32 v138, v142, v243, 16
  v_alignbit_b32 v139, v143, v142, 16
  s_mov_b64 exec, 0xff
  ds_write_b128 v11, v[128:131] offset:4032
  ds_write_b128 v11, v[132:135] offset:8192
  ds_write_b128 v11, v[136:139] offset:12352
  ds_write_b128 v11, v[140:143] offset:16512
  s_mov_b64 exec, -1
skip_25:
  s_waitcnt vmcnt(11) lgkmcnt(0)
  s_barrier
  ds_read_b64 v[128:129], v252 offset:0
  ds_read_b64 v[130:131], v252 offset:8
  ds_read_b128 v[144:147], v254 offset:4608
  ds_read_b128 v[148:151], v254 offset:3072
  ds_read_b128 v[152:155], v254 offset:1536
  ds_read_b128 v[156:159], v254 offset:0
  ds_read_b64 v[132:133], v252 offset:1024
  ds_read_b64 v[134:135], v252 offset:1032
  ds_read_b64 v[136:137], v252 offset:2048
  ds_read_b64 v[138:139], v252 offset:2056
  ds_read_b64 v[140:141], v252 offset:3072
  ds_read_b64 v[142:143], v252 offset:3080
  s_waitcnt lgkmcnt(9)
  v_mfma_f32_16x16x32_bf16 v[192:195], v[128:131], v[144:147], 0
  ds_read_b64 v[160:161], v252 offset:64
  ds_read_b64 v[162:163], v252 offset:72
  s_waitcnt lgkmcnt(10)
  v_mfma_f32_16x16x32_bf16 v[196:199], v[128:131], v[148:151], 0
  ds_read_b128 v[176:179], v254 offset:4704
  ds_read_b128 v[180:183], v254 offset:3168
  s_waitcnt lgkmcnt(11)
  v_mfma_f32_16x16x32_bf16 v[200:203], v[128:131], v[152:155], 0
  ds_read_b128 v[184:187], v254 offset:1632
  ds_read_b128 v[188:191], v254 offset:96
  s_waitcnt lgkmcnt(12)
  v_mfma_f32_16x16x32_bf16 v[204:207], v[128:131], v[156:159], 0
  ds_read_b64 v[164:165], v252 offset:1088
  ds_read_b64 v[166:167], v252 offset:1096
  s_waitcnt lgkmcnt(12)
  v_mfma_f32_16x16x32_bf16 v[196:199], v[132:135], v[144:147], v[196:199]
  ds_read_b64 v[168:169], v252 offset:2112
  ds_read_b64 v[170:171], v252 offset:2120
  v_mfma_f32_16x16x32_bf16 v[200:203], v[132:135], v[148:151], v[200:203]
  ds_read_b64 v[172:173], v252 offset:3136
  ds_read_b64 v[174:175], v252 offset:3144
  v_mfma_f32_16x16x32_bf16 v[204:207], v[132:135], v[152:155], v[204:207]
  buffer_load_dwordx4 a[40:43], v2, s[52:55], s18 offen offset:2048 sc1
  s_waitcnt lgkmcnt(14)
  v_mfma_f32_16x16x32_bf16 v[200:203], v[136:139], v[144:147], v[200:203]
  buffer_load_dwordx4 a[44:47], v2, s[52:55], s18 offen offset:3072 sc1
  v_mfma_f32_16x16x32_bf16 v[204:207], v[136:139], v[148:151], v[204:207]
  s_add_u32 s18, s18, 4096
  buffer_load_dwordx4 a[48:51], v2, s[52:55], s18 offen offset:0 sc1
  s_waitcnt lgkmcnt(12)
  v_mfma_f32_16x16x32_bf16 v[204:207], v[140:143], v[144:147], v[204:207]
  s_waitcnt lgkmcnt(4)
  v_mfma_f32_16x16x32_bf16 v[192:195], v[160:163], v[176:179], v[192:195]
  ds_read_b64 v[128:129], v252 offset:128
  ds_read_b64 v[130:131], v252 offset:136
  v_mfma_f32_16x16x32_bf16 v[196:199], v[160:163], v[180:183], v[196:199]
  ds_read_b128 v[144:147], v254 offset:4800
  ds_read_b128 v[148:151], v254 offset:3264
  v_mfma_f32_16x16x32_bf16 v[200:203], v[160:163], v[184:187], v[200:203]
  ds_read_b128 v[152:155], v254 offset:1728
  ds_read_b128 v[156:159], v254 offset:192
  v_mfma_f32_16x16x32_bf16 v[204:207], v[160:163], v[188:191], v[204:207]
  ds_read_b64 v[132:133], v252 offset:1152
  ds_read_b64 v[134:135], v252 offset:1160
  v_mfma_f32_16x16x32_bf16 v[196:199], v[164:167], v[176:179], v[196:199]
  ds_read_b64 v[136:137], v252 offset:2176
  ds_read_b64 v[138:139], v252 offset:2184
  v_mfma_f32_16x16x32_bf16 v[200:203], v[164:167], v[180:183], v[200:203]
  ds_read_b64 v[140:141], v252 offset:3200
  ds_read_b64 v[142:143], v252 offset:3208
  v_mfma_f32_16x16x32_bf16 v[204:207], v[164:167], v[184:187], v[204:207]
  buffer_load_dwordx4 a[52:55], v2, s[52:55], s18 offen offset:1024 sc1
  s_waitcnt lgkmcnt(12)
  v_mfma_f32_16x16x32_bf16 v[200:203], v[168:171], v[176:179], v[200:203]
  buffer_load_dwordx4 a[56:59], v2, s[52:55], s18 offen offset:2048 sc1
  v_mfma_f32_16x16x32_bf16 v[204:207], v[168:171], v[180:183], v[204:207]
  v_mfma_f32_16x16x32_bf16 v[204:207], v[172:175], v[176:179], v[204:207]
  s_waitcnt lgkmcnt(4)
  v_mfma_f32_16x16x32_bf16 v[192:195], v[128:131], v[144:147], v[192:195]
  ds_read_b64 v[160:161], v252 offset:192
  ds_read_b64 v[162:163], v252 offset:200
  v_mfma_f32_16x16x32_bf16 v[196:199], v[128:131], v[148:151], v[196:199]
  ds_read_b128 v[176:179], v254 offset:4896
  ds_read_b128 v[180:183], v254 offset:3360
  v_mfma_f32_16x16x32_bf16 v[200:203], v[128:131], v[152:155], v[200:203]
  ds_read_b128 v[184:187], v254 offset:1824
  ds_read_b128 v[188:191], v254 offset:288
  v_mfma_f32_16x16x32_bf16 v[204:207], v[128:131], v[156:159], v[204:207]
  ds_read_b64 v[164:165], v252 offset:1216
  ds_read_b64 v[166:167], v252 offset:1224
  v_mfma_f32_16x16x32_bf16 v[196:199], v[132:135], v[144:147], v[196:199]
  ds_read_b64 v[168:169], v252 offset:2240
  ds_read_b64 v[170:171], v252 offset:2248
  v_mfma_f32_16x16x32_bf16 v[200:203], v[132:135], v[148:151], v[200:203]
  ds_read_b64 v[172:173], v252 offset:3264
  ds_read_b64 v[174:175], v252 offset:3272
  v_mfma_f32_16x16x32_bf16 v[204:207], v[132:135], v[152:155], v[204:207]
  s_mul_i32 s14, s6, 160
  v_lshl_add_u32 v11, v4, 3, s14
  s_waitcnt lgkmcnt(12)
  v_mfma_f32_16x16x32_bf16 v[200:203], v[136:139], v[144:147], v[200:203]
  s_lshl_b32 s12, s5, 10
  s_lshr_b32 s13, s7, 1
  v_mfma_f32_16x16x32_bf16 v[204:207], v[136:139], v[148:151], v[204:207]
  buffer_load_dwordx4 a[60:63], v2, s[52:55], s18 offen offset:3072 sc1
  v_mfma_f32_16x16x32_bf16 v[204:207], v[140:143], v[144:147], v[204:207]
  s_add_u32 s18, s18, 4096
  buffer_load_dwordx4 a[64:67], v2, s[52:55], s18 offen offset:0 sc1
  s_waitcnt lgkmcnt(4)
  v_mfma_f32_16x16x32_bf16 v[192:195], v[160:163], v[176:179], v[192:195]
  ds_read_b64 v[128:129], v252 offset:256
  ds_read_b64 v[130:131], v252 offset:264
  v_mfma_f32_16x16x32_bf16 v[196:199], v[160:163], v[180:183], v[196:199]
  ds_read_b128 v[144:147], v254 offset:4992
  ds_read_b128 v[148:151], v254 offset:3456
  v_mfma_f32_16x16x32_bf16 v[200:203], v[160:163], v[184:187], v[200:203]
  ds_read_b128 v[152:155], v254 offset:1920
  ds_read_b128 v[156:159], v254 offset:384
  v_mfma_f32_16x16x32_bf16 v[204:207], v[160:163], v[188:191], v[204:207]
  ds_read_b64 v[132:133], v252 offset:1280
  ds_read_b64 v[134:135], v252 offset:1288
  v_mfma_f32_16x16x32_bf16 v[196:199], v[164:167], v[176:179], v[196:199]
  ds_read_b64 v[136:137], v252 offset:2304
  ds_read_b64 v[138:139], v252 offset:2312
  v_mfma_f32_16x16x32_bf16 v[200:203], v[164:167], v[180:183], v[200:203]
  ds_read_b64 v[140:141], v252 offset:3328
  ds_read_b64 v[142:143], v252 offset:3336
  v_mfma_f32_16x16x32_bf16 v[204:207], v[164:167], v[184:187], v[204:207]
  s_lshl_b32 s13, s13, 9
  s_add_u32 s12, s12, s13
  s_waitcnt lgkmcnt(12)
  v_mfma_f32_16x16x32_bf16 v[200:203], v[168:171], v[176:179], v[200:203]
  s_and_b32 s13, s7, 1
  s_lshl_b32 s13, s13, 6
  v_mfma_f32_16x16x32_bf16 v[204:207], v[168:171], v[180:183], v[204:207]
  buffer_load_dwordx4 a[68:71], v2, s[52:55], s18 offen offset:1024 sc1
  v_mfma_f32_16x16x32_bf16 v[204:207], v[172:175], v[176:179], v[204:207]
  buffer_load_dwordx4 a[72:75], v2, s[52:55], s18 offen offset:2048 sc1
  s_waitcnt lgkmcnt(4)
  v_mfma_f32_16x16x32_bf16 v[192:195], v[128:131], v[144:147], v[192:195]
  ds_read_b64 v[160:161], v252 offset:320
  ds_read_b64 v[162:163], v252 offset:328
  v_mfma_f32_16x16x32_bf16 v[196:199], v[128:131], v[148:151], v[196:199]
  ds_read_b128 v[176:179], v254 offset:5088
  ds_read_b128 v[180:183], v254 offset:3552
  v_mfma_f32_16x16x32_bf16 v[200:203], v[128:131], v[152:155], v[200:203]
  ds_read_b128 v[184:187], v254 offset:2016
  ds_read_b128 v[188:191], v254 offset:480
  v_mfma_f32_16x16x32_bf16 v[204:207], v[128:131], v[156:159], v[204:207]
  ds_read_b64 v[164:165], v252 offset:1344
  ds_read_b64 v[166:167], v252 offset:1352
  v_mfma_f32_16x16x32_bf16 v[196:199], v[132:135], v[144:147], v[196:199]
  ds_read_b64 v[168:169], v252 offset:2368
  ds_read_b64 v[170:171], v252 offset:2376
  v_mfma_f32_16x16x32_bf16 v[200:203], v[132:135], v[148:151], v[200:203]
  ds_read_b64 v[172:173], v252 offset:3392
  ds_read_b64 v[174:175], v252 offset:3400
  v_mfma_f32_16x16x32_bf16 v[204:207], v[132:135], v[152:155], v[204:207]
  s_add_u32 s12, s12, s13
  s_add_u32 s12, s12, 262144
  s_waitcnt lgkmcnt(12)
  v_mfma_f32_16x16x32_bf16 v[200:203], v[136:139], v[144:147], v[200:203]
  v_lshrrev_b32 v12, 2, v3
  v_lshlrev_b32_e64 v12, 7, v12
  v_mfma_f32_16x16x32_bf16 v[204:207], v[136:139], v[148:151], v[204:207]
  buffer_load_dwordx4 a[76:79], v2, s[52:55], s18 offen offset:3072 sc1
  v_mfma_f32_16x16x32_bf16 v[204:207], v[140:143], v[144:147], v[204:207]
  s_add_u32 s18, s18, 4096
  buffer_load_dwordx4 a[80:83], v2, s[52:55], s18 offen offset:0 sc1
  s_waitcnt lgkmcnt(4)
  v_mfma_f32_16x16x32_bf16 v[192:195], v[160:163], v[176:179], v[192:195]
  ds_read_b64 v[128:129], v252 offset:384
  ds_read_b64 v[130:131], v252 offset:392
  v_mfma_f32_16x16x32_bf16 v[196:199], v[160:163], v[180:183], v[196:199]
  ds_read_b128 v[144:147], v254 offset:5184
  ds_read_b128 v[148:151], v254 offset:3648
  v_mfma_f32_16x16x32_bf16 v[200:203], v[160:163], v[184:187], v[200:203]
  ds_read_b128 v[152:155], v254 offset:2112
  ds_read_b128 v[156:159], v254 offset:576
  v_mfma_f32_16x16x32_bf16 v[204:207], v[160:163], v[188:191], v[204:207]
  ds_read_b64 v[132:133], v252 offset:1408
  ds_read_b64 v[134:135], v252 offset:1416
  v_mfma_f32_16x16x32_bf16 v[196:199], v[164:167], v[176:179], v[196:199]
  ds_read_b64 v[136:137], v252 offset:2432
  ds_read_b64 v[138:139], v252 offset:2440
  v_mfma_f32_16x16x32_bf16 v[200:203], v[164:167], v[180:183], v[200:203]
  ds_read_b64 v[140:141], v252 offset:3456
  ds_read_b64 v[142:143], v252 offset:3464
  v_mfma_f32_16x16x32_bf16 v[204:207], v[164:167], v[184:187], v[204:207]
  v_and_b32 v13, 3, v3
  v_lshl_add_u32 v12, v13, 4, v12
  s_waitcnt lgkmcnt(12)
  v_mfma_f32_16x16x32_bf16 v[200:203], v[168:171], v[176:179], v[200:203]
  buffer_load_dwordx2 a[230:231], v12, s[52:55], s12 offen sc1
  global_load_dwordx2 a[240:241], v11, s[32:33] offset:0
  v_mfma_f32_16x16x32_bf16 v[204:207], v[168:171], v[180:183], v[204:207]
  buffer_load_dwordx4 a[84:87], v2, s[52:55], s18 offen offset:1024 sc1
  v_mfma_f32_16x16x32_bf16 v[204:207], v[172:175], v[176:179], v[204:207]
  buffer_load_dwordx4 a[88:91], v2, s[52:55], s18 offen offset:2048 sc1
  s_waitcnt lgkmcnt(4)
  v_mfma_f32_16x16x32_bf16 v[192:195], v[128:131], v[144:147], v[192:195]
  ds_read_b64 v[160:161], v252 offset:448
  ds_read_b64 v[162:163], v252 offset:456
  v_mfma_f32_16x16x32_bf16 v[196:199], v[128:131], v[148:151], v[196:199]
  ds_read_b128 v[176:179], v254 offset:5280
  ds_read_b128 v[180:183], v254 offset:3744
  v_mfma_f32_16x16x32_bf16 v[200:203], v[128:131], v[152:155], v[200:203]
  ds_read_b128 v[184:187], v254 offset:2208
  ds_read_b128 v[188:191], v254 offset:672
  v_mfma_f32_16x16x32_bf16 v[204:207], v[128:131], v[156:159], v[204:207]
  ds_read_b64 v[164:165], v252 offset:1472
  ds_read_b64 v[166:167], v252 offset:1480
  v_mfma_f32_16x16x32_bf16 v[196:199], v[132:135], v[144:147], v[196:199]
  ds_read_b64 v[168:169], v252 offset:2496
  ds_read_b64 v[170:171], v252 offset:2504
  v_mfma_f32_16x16x32_bf16 v[200:203], v[132:135], v[148:151], v[200:203]
  ds_read_b64 v[172:173], v252 offset:3520
  ds_read_b64 v[174:175], v252 offset:3528
  v_mfma_f32_16x16x32_bf16 v[204:207], v[132:135], v[152:155], v[204:207]
  global_load_dwordx2 a[242:243], v11, s[32:33] offset:32
  global_load_dwordx2 a[244:245], v11, s[32:33] offset:64
  s_waitcnt lgkmcnt(12)
  v_mfma_f32_16x16x32_bf16 v[200:203], v[136:139], v[144:147], v[200:203]
  global_load_dwordx2 a[246:247], v11, s[32:33] offset:96
  global_load_dwordx2 a[248:249], v11, s[32:33] offset:128
  v_mfma_f32_16x16x32_bf16 v[204:207], v[136:139], v[148:151], v[204:207]
  buffer_load_dwordx4 a[92:95], v2, s[52:55], s18 offen offset:3072 sc1
  v_mfma_f32_16x16x32_bf16 v[204:207], v[140:143], v[144:147], v[204:207]
  s_add_u32 s18, s18, 4096
  buffer_load_dwordx4 a[96:99], v2, s[52:55], s18 offen offset:0 sc1
  s_waitcnt lgkmcnt(4)
  v_mfma_f32_16x16x32_bf16 v[192:195], v[160:163], v[176:179], v[192:195]
  ds_read_b64 v[128:129], v252 offset:512
  ds_read_b64 v[130:131], v252 offset:520
  v_mfma_f32_16x16x32_bf16 v[196:199], v[160:163], v[180:183], v[196:199]
  ds_read_b128 v[144:147], v254 offset:5376
  ds_read_b128 v[148:151], v254 offset:3840
  v_mfma_f32_16x16x32_bf16 v[200:203], v[160:163], v[184:187], v[200:203]
  ds_read_b128 v[152:155], v254 offset:2304
  ds_read_b128 v[156:159], v254 offset:768
  v_mfma_f32_16x16x32_bf16 v[204:207], v[160:163], v[188:191], v[204:207]
  ds_read_b64 v[132:133], v252 offset:1536
  ds_read_b64 v[134:135], v252 offset:1544
  v_mfma_f32_16x16x32_bf16 v[196:199], v[164:167], v[176:179], v[196:199]
  ds_read_b64 v[136:137], v252 offset:2560
  ds_read_b64 v[138:139], v252 offset:2568
  v_mfma_f32_16x16x32_bf16 v[200:203], v[164:167], v[180:183], v[200:203]
  ds_read_b64 v[140:141], v252 offset:3584
  ds_read_b64 v[142:143], v252 offset:3592
  v_mfma_f32_16x16x32_bf16 v[204:207], v[164:167], v[184:187], v[204:207]
  buffer_load_dwordx4 a[100:103], v2, s[52:55], s18 offen offset:1024 sc1
  s_waitcnt lgkmcnt(12)
  v_mfma_f32_16x16x32_bf16 v[200:203], v[168:171], v[176:179], v[200:203]
  buffer_load_dwordx4 a[104:107], v2, s[52:55], s18 offen offset:2048 sc1
  v_mfma_f32_16x16x32_bf16 v[204:207], v[168:171], v[180:183], v[204:207]
  v_mfma_f32_16x16x32_bf16 v[204:207], v[172:175], v[176:179], v[204:207]
  s_waitcnt lgkmcnt(4)
  v_mfma_f32_16x16x32_bf16 v[192:195], v[128:131], v[144:147], v[192:195]
  ds_read_b64 v[160:161], v252 offset:576
  ds_read_b64 v[162:163], v252 offset:584
  v_mfma_f32_16x16x32_bf16 v[196:199], v[128:131], v[148:151], v[196:199]
  ds_read_b128 v[176:179], v254 offset:5472
  ds_read_b128 v[180:183], v254 offset:3936
  v_mfma_f32_16x16x32_bf16 v[200:203], v[128:131], v[152:155], v[200:203]
  ds_read_b128 v[184:187], v254 offset:2400
  ds_read_b128 v[188:191], v254 offset:864
  v_mfma_f32_16x16x32_bf16 v[204:207], v[128:131], v[156:159], v[204:207]
  ds_read_b64 v[164:165], v252 offset:1600
  ds_read_b64 v[166:167], v252 offset:1608
  v_mfma_f32_16x16x32_bf16 v[196:199], v[132:135], v[144:147], v[196:199]
  ds_read_b64 v[168:169], v252 offset:2624
  ds_read_b64 v[170:171], v252 offset:2632
  v_mfma_f32_16x16x32_bf16 v[200:203], v[132:135], v[148:151], v[200:203]
  ds_read_b64 v[172:173], v252 offset:3648
  ds_read_b64 v[174:175], v252 offset:3656
  v_mfma_f32_16x16x32_bf16 v[204:207], v[132:135], v[152:155], v[204:207]
  buffer_load_dwordx4 a[108:111], v2, s[52:55], s18 offen offset:3072 sc1
  s_waitcnt lgkmcnt(12)
  v_mfma_f32_16x16x32_bf16 v[200:203], v[136:139], v[144:147], v[200:203]
  s_add_u32 s18, s18, 4096
  buffer_load_dwordx4 a[112:115], v2, s[52:55], s18 offen offset:0 sc1
  v_mfma_f32_16x16x32_bf16 v[204:207], v[136:139], v[148:151], v[204:207]
  v_mfma_f32_16x16x32_bf16 v[204:207], v[140:143], v[144:147], v[204:207]
  s_waitcnt lgkmcnt(4)
  v_mfma_f32_16x16x32_bf16 v[192:195], v[160:163], v[176:179], v[192:195]
  ds_read_b64 v[128:129], v252 offset:640
  ds_read_b64 v[130:131], v252 offset:648
  v_mfma_f32_16x16x32_bf16 v[196:199], v[160:163], v[180:183], v[196:199]
  ds_read_b128 v[144:147], v254 offset:5568
  ds_read_b128 v[148:151], v254 offset:4032
  v_mfma_f32_16x16x32_bf16 v[200:203], v[160:163], v[184:187], v[200:203]
  ds_read_b128 v[152:155], v254 offset:2496
  ds_read_b128 v[156:159], v254 offset:960
  v_mfma_f32_16x16x32_bf16 v[204:207], v[160:163], v[188:191], v[204:207]
  ds_read_b64 v[132:133], v252 offset:1664
  ds_read_b64 v[134:135], v252 offset:1672
  v_mfma_f32_16x16x32_bf16 v[196:199], v[164:167], v[176:179], v[196:199]
  ds_read_b64 v[136:137], v252 offset:2688
  ds_read_b64 v[138:139], v252 offset:2696
  v_mfma_f32_16x16x32_bf16 v[200:203], v[164:167], v[180:183], v[200:203]
  ds_read_b64 v[140:141], v252 offset:3712
  ds_read_b64 v[142:143], v252 offset:3720
  v_mfma_f32_16x16x32_bf16 v[204:207], v[164:167], v[184:187], v[204:207]
  buffer_load_dwordx4 a[116:119], v2, s[52:55], s18 offen offset:1024 sc1
  s_waitcnt lgkmcnt(12)
  v_mfma_f32_16x16x32_bf16 v[200:203], v[168:171], v[176:179], v[200:203]
  buffer_load_dwordx4 a[120:123], v2, s[52:55], s18 offen offset:2048 sc1
  v_mfma_f32_16x16x32_bf16 v[204:207], v[168:171], v[180:183], v[204:207]
  buffer_load_dwordx4 a[124:127], v2, s[52:55], s18 offen offset:3072 sc1
  v_mfma_f32_16x16x32_bf16 v[204:207], v[172:175], v[176:179], v[204:207]
  s_waitcnt lgkmcnt(4)
  v_mfma_f32_16x16x32_bf16 v[192:195], v[128:131], v[144:147], v[192:195]
  ds_read_b64 v[160:161], v252 offset:704
  ds_read_b64 v[162:163], v252 offset:712
  v_mfma_f32_16x16x32_bf16 v[196:199], v[128:131], v[148:151], v[196:199]
  ds_read_b128 v[176:179], v254 offset:5664
  ds_read_b128 v[180:183], v254 offset:4128
  v_mfma_f32_16x16x32_bf16 v[200:203], v[128:131], v[152:155], v[200:203]
  ds_read_b128 v[184:187], v254 offset:2592
  ds_read_b128 v[188:191], v254 offset:1056
  v_mfma_f32_16x16x32_bf16 v[204:207], v[128:131], v[156:159], v[204:207]
  ds_read_b64 v[164:165], v252 offset:1728
  ds_read_b64 v[166:167], v252 offset:1736
  v_mfma_f32_16x16x32_bf16 v[196:199], v[132:135], v[144:147], v[196:199]
  ds_read_b64 v[168:169], v252 offset:2752
  ds_read_b64 v[170:171], v252 offset:2760
  v_mfma_f32_16x16x32_bf16 v[200:203], v[132:135], v[148:151], v[200:203]
  ds_read_b64 v[172:173], v252 offset:3776
  ds_read_b64 v[174:175], v252 offset:3784
  v_mfma_f32_16x16x32_bf16 v[204:207], v[132:135], v[152:155], v[204:207]
  s_add_u32 s18, s18, 4096
  buffer_load_dwordx4 a[128:131], v2, s[52:55], s18 offen offset:0 sc1
  s_waitcnt lgkmcnt(12)
  v_mfma_f32_16x16x32_bf16 v[200:203], v[136:139], v[144:147], v[200:203]
  buffer_load_dwordx4 a[132:135], v2, s[52:55], s18 offen offset:1024 sc1
  v_mfma_f32_16x16x32_bf16 v[204:207], v[136:139], v[148:151], v[204:207]
  v_mfma_f32_16x16x32_bf16 v[204:207], v[140:143], v[144:147], v[204:207]
  s_waitcnt lgkmcnt(4)
  v_mfma_f32_16x16x32_bf16 v[192:195], v[160:163], v[176:179], v[192:195]
  ds_read_b64 v[128:129], v252 offset:768
  ds_read_b64 v[130:131], v252 offset:776
  v_mfma_f32_16x16x32_bf16 v[196:199], v[160:163], v[180:183], v[196:199]
  ds_read_b128 v[144:147], v254 offset:5760
  ds_read_b128 v[148:151], v254 offset:4224
  v_mfma_f32_16x16x32_bf16 v[200:203], v[160:163], v[184:187], v[200:203]
  ds_read_b128 v[152:155], v254 offset:2688
  ds_read_b128 v[156:159], v254 offset:1152
  v_mfma_f32_16x16x32_bf16 v[204:207], v[160:163], v[188:191], v[204:207]
  ds_read_b64 v[132:133], v252 offset:1792
  ds_read_b64 v[134:135], v252 offset:1800
  v_mfma_f32_16x16x32_bf16 v[196:199], v[164:167], v[176:179], v[196:199]
  ds_read_b64 v[136:137], v252 offset:2816
  ds_read_b64 v[138:139], v252 offset:2824
  v_mfma_f32_16x16x32_bf16 v[200:203], v[164:167], v[180:183], v[200:203]
  ds_read_b64 v[140:141], v252 offset:3840
  ds_read_b64 v[142:143], v252 offset:3848
  v_mfma_f32_16x16x32_bf16 v[204:207], v[164:167], v[184:187], v[204:207]
  buffer_load_dwordx4 a[136:139], v2, s[52:55], s18 offen offset:2048 sc1
  s_waitcnt lgkmcnt(12)
  v_mfma_f32_16x16x32_bf16 v[200:203], v[168:171], v[176:179], v[200:203]
  buffer_load_dwordx4 a[140:143], v2, s[52:55], s18 offen offset:3072 sc1
  v_mfma_f32_16x16x32_bf16 v[204:207], v[168:171], v[180:183], v[204:207]
  v_mfma_f32_16x16x32_bf16 v[204:207], v[172:175], v[176:179], v[204:207]
  s_waitcnt lgkmcnt(4)
  v_mfma_f32_16x16x32_bf16 v[192:195], v[128:131], v[144:147], v[192:195]
  ds_read_b64 v[160:161], v252 offset:832
  ds_read_b64 v[162:163], v252 offset:840
  v_mfma_f32_16x16x32_bf16 v[196:199], v[128:131], v[148:151], v[196:199]
  ds_read_b128 v[176:179], v254 offset:5856
  ds_read_b128 v[180:183], v254 offset:4320
  v_mfma_f32_16x16x32_bf16 v[200:203], v[128:131], v[152:155], v[200:203]
  ds_read_b128 v[184:187], v254 offset:2784
  ds_read_b128 v[188:191], v254 offset:1248
  v_mfma_f32_16x16x32_bf16 v[204:207], v[128:131], v[156:159], v[204:207]
  ds_read_b64 v[164:165], v252 offset:1856
  ds_read_b64 v[166:167], v252 offset:1864
  v_mfma_f32_16x16x32_bf16 v[196:199], v[132:135], v[144:147], v[196:199]
  ds_read_b64 v[168:169], v252 offset:2880
  ds_read_b64 v[170:171], v252 offset:2888
  v_mfma_f32_16x16x32_bf16 v[200:203], v[132:135], v[148:151], v[200:203]
  ds_read_b64 v[172:173], v252 offset:3904
  ds_read_b64 v[174:175], v252 offset:3912
  v_mfma_f32_16x16x32_bf16 v[204:207], v[132:135], v[152:155], v[204:207]
  s_add_u32 s18, s18, 4096
  buffer_load_dwordx4 a[144:147], v2, s[52:55], s18 offen offset:0 sc1
  s_waitcnt lgkmcnt(12)
  v_mfma_f32_16x16x32_bf16 v[200:203], v[136:139], v[144:147], v[200:203]
  buffer_load_dwordx4 a[148:151], v2, s[52:55], s18 offen offset:1024 sc1
  v_mfma_f32_16x16x32_bf16 v[204:207], v[136:139], v[148:151], v[204:207]
  v_mfma_f32_16x16x32_bf16 v[204:207], v[140:143], v[144:147], v[204:207]
  s_waitcnt lgkmcnt(4)
  v_mfma_f32_16x16x32_bf16 v[192:195], v[160:163], v[176:179], v[192:195]
  ds_read_b64 v[128:129], v252 offset:896
  ds_read_b64 v[130:131], v252 offset:904
  v_mfma_f32_16x16x32_bf16 v[196:199], v[160:163], v[180:183], v[196:199]
  ds_read_b128 v[144:147], v254 offset:5952
  ds_read_b128 v[148:151], v254 offset:4416
  v_mfma_f32_16x16x32_bf16 v[200:203], v[160:163], v[184:187], v[200:203]
  ds_read_b128 v[152:155], v254 offset:2880
  ds_read_b128 v[156:159], v254 offset:1344
  v_mfma_f32_16x16x32_bf16 v[204:207], v[160:163], v[188:191], v[204:207]
  ds_read_b64 v[132:133], v252 offset:1920
  ds_read_b64 v[134:135], v252 offset:1928
  v_mfma_f32_16x16x32_bf16 v[196:199], v[164:167], v[176:179], v[196:199]
  ds_read_b64 v[136:137], v252 offset:2944
  ds_read_b64 v[138:139], v252 offset:2952
  v_mfma_f32_16x16x32_bf16 v[200:203], v[164:167], v[180:183], v[200:203]
  ds_read_b64 v[140:141], v252 offset:3968
  ds_read_b64 v[142:143], v252 offset:3976
  v_mfma_f32_16x16x32_bf16 v[204:207], v[164:167], v[184:187], v[204:207]
  buffer_load_dwordx4 a[152:155], v2, s[52:55], s18 offen offset:2048 sc1
  s_waitcnt lgkmcnt(12)
  v_mfma_f32_16x16x32_bf16 v[200:203], v[168:171], v[176:179], v[200:203]
  buffer_load_dwordx4 a[156:159], v2, s[52:55], s18 offen offset:3072 sc1
  v_mfma_f32_16x16x32_bf16 v[204:207], v[168:171], v[180:183], v[204:207]
  v_mfma_f32_16x16x32_bf16 v[204:207], v[172:175], v[176:179], v[204:207]
  s_waitcnt lgkmcnt(4)
  v_mfma_f32_16x16x32_bf16 v[192:195], v[128:131], v[144:147], v[192:195]
  ds_read_b64 v[160:161], v252 offset:960
  ds_read_b64 v[162:163], v252 offset:968
  v_mfma_f32_16x16x32_bf16 v[196:199], v[128:131], v[148:151], v[196:199]
  ds_read_b128 v[176:179], v254 offset:6048
  ds_read_b128 v[180:183], v254 offset:4512
  v_mfma_f32_16x16x32_bf16 v[200:203], v[128:131], v[152:155], v[200:203]
  ds_read_b128 v[184:187], v254 offset:2976
  ds_read_b128 v[188:191], v254 offset:1440
  v_mfma_f32_16x16x32_bf16 v[204:207], v[128:131], v[156:159], v[204:207]
  ds_read_b64 v[164:165], v252 offset:1984
  ds_read_b64 v[166:167], v252 offset:1992
  v_mfma_f32_16x16x32_bf16 v[196:199], v[132:135], v[144:147], v[196:199]
  ds_read_b64 v[168:169], v252 offset:3008
  ds_read_b64 v[170:171], v252 offset:3016
  v_mfma_f32_16x16x32_bf16 v[200:203], v[132:135], v[148:151], v[200:203]
  ds_read_b64 v[172:173], v252 offset:4032
  ds_read_b64 v[174:175], v252 offset:4040
  v_mfma_f32_16x16x32_bf16 v[204:207], v[132:135], v[152:155], v[204:207]
  s_add_u32 s18, s18, 4096
  buffer_load_dwordx4 a[160:163], v2, s[52:55], s18 offen offset:0 sc1
  s_waitcnt lgkmcnt(12)
  v_mfma_f32_16x16x32_bf16 v[200:203], v[136:139], v[144:147], v[200:203]
  buffer_load_dwordx4 a[164:167], v2, s[52:55], s18 offen offset:1024 sc1
  v_mfma_f32_16x16x32_bf16 v[204:207], v[136:139], v[148:151], v[204:207]
  v_mfma_f32_16x16x32_bf16 v[204:207], v[140:143], v[144:147], v[204:207]
  s_waitcnt lgkmcnt(4)
  v_mfma_f32_16x16x32_bf16 v[192:195], v[160:163], v[176:179], v[192:195]
  ds_read_b64 v[128:129], v253 offset:0
  ds_read_b64 v[130:131], v253 offset:8
  v_mfma_f32_16x16x32_bf16 v[196:199], v[160:163], v[180:183], v[196:199]
  ds_read_b128 v[144:147], v255 offset:4608
  ds_read_b128 v[148:151], v255 offset:3072
  v_mfma_f32_16x16x32_bf16 v[200:203], v[160:163], v[184:187], v[200:203]
  ds_read_b128 v[152:155], v255 offset:1536
  ds_read_b128 v[156:159], v255 offset:0
  v_mfma_f32_16x16x32_bf16 v[204:207], v[160:163], v[188:191], v[204:207]
  ds_read_b64 v[132:133], v253 offset:1024
  ds_read_b64 v[134:135], v253 offset:1032
  v_mfma_f32_16x16x32_bf16 v[196:199], v[164:167], v[176:179], v[196:199]
  ds_read_b64 v[136:137], v253 offset:2048
  ds_read_b64 v[138:139], v253 offset:2056
  v_mfma_f32_16x16x32_bf16 v[200:203], v[164:167], v[180:183], v[200:203]
  ds_read_b64 v[140:141], v253 offset:3072
  ds_read_b64 v[142:143], v253 offset:3080
  v_mfma_f32_16x16x32_bf16 v[204:207], v[164:167], v[184:187], v[204:207]
  buffer_load_dwordx4 a[168:171], v2, s[52:55], s18 offen offset:2048 sc1
  s_waitcnt lgkmcnt(12)
  v_mfma_f32_16x16x32_bf16 v[200:203], v[168:171], v[176:179], v[200:203]
  buffer_load_dwordx4 a[172:175], v2, s[52:55], s18 offen offset:3072 sc1
  v_mfma_f32_16x16x32_bf16 v[204:207], v[168:171], v[180:183], v[204:207]
  v_mfma_f32_16x16x32_bf16 v[204:207], v[172:175], v[176:179], v[204:207]
  s_waitcnt lgkmcnt(4)
  v_mfma_f32_16x16x32_bf16 v[48:51], v[128:131], v[144:147], 0
  ds_read_b64 v[160:161], v253 offset:64
  ds_read_b64 v[162:163], v253 offset:72
  v_mfma_f32_16x16x32_bf16 v[52:55], v[128:131], v[148:151], 0
  ds_read_b128 v[176:179], v255 offset:4704
  ds_read_b128 v[180:183], v255 offset:3168
  v_mfma_f32_16x16x32_bf16 v[56:59], v[128:131], v[152:155], 0
  ds_read_b128 v[184:187], v255 offset:1632
  ds_read_b128 v[188:191], v255 offset:96
  v_mfma_f32_16x16x32_bf16 v[60:63], v[128:131], v[156:159], 0
  ds_read_b64 v[164:165], v253 offset:1088
  ds_read_b64 v[166:167], v253 offset:1096
  v_mfma_f32_16x16x32_bf16 v[52:55], v[132:135], v[144:147], v[52:55]
  ds_read_b64 v[168:169], v253 offset:2112
  ds_read_b64 v[170:171], v253 offset:2120
  v_mfma_f32_16x16x32_bf16 v[56:59], v[132:135], v[148:151], v[56:59]
  ds_read_b64 v[172:173], v253 offset:3136
  ds_read_b64 v[174:175], v253 offset:3144
  v_mfma_f32_16x16x32_bf16 v[60:63], v[132:135], v[152:155], v[60:63]
  s_add_u32 s18, s18, 4096
  buffer_load_dwordx4 a[176:179], v2, s[52:55], s18 offen offset:0 sc1
  s_waitcnt lgkmcnt(12)
  v_mfma_f32_16x16x32_bf16 v[56:59], v[136:139], v[144:147], v[56:59]
  buffer_load_dwordx4 a[180:183], v2, s[52:55], s18 offen offset:1024 sc1
  v_mfma_f32_16x16x32_bf16 v[60:63], v[136:139], v[148:151], v[60:63]
  v_mfma_f32_16x16x32_bf16 v[60:63], v[140:143], v[144:147], v[60:63]
  s_waitcnt lgkmcnt(4)
  v_mfma_f32_16x16x32_bf16 v[48:51], v[160:163], v[176:179], v[48:51]
  ds_read_b64 v[128:129], v253 offset:128
  ds_read_b64 v[130:131], v253 offset:136
  v_mfma_f32_16x16x32_bf16 v[52:55], v[160:163], v[180:183], v[52:55]
  ds_read_b128 v[144:147], v255 offset:4800
  ds_read_b128 v[148:151], v255 offset:3264
  v_mfma_f32_16x16x32_bf16 v[56:59], v[160:163], v[184:187], v[56:59]
  ds_read_b128 v[152:155], v255 offset:1728
  ds_read_b128 v[156:159], v255 offset:192
  v_mfma_f32_16x16x32_bf16 v[60:63], v[160:163], v[188:191], v[60:63]
  ds_read_b64 v[132:133], v253 offset:1152
  ds_read_b64 v[134:135], v253 offset:1160
  v_mfma_f32_16x16x32_bf16 v[52:55], v[164:167], v[176:179], v[52:55]
  ds_read_b64 v[136:137], v253 offset:2176
  ds_read_b64 v[138:139], v253 offset:2184
  v_mfma_f32_16x16x32_bf16 v[56:59], v[164:167], v[180:183], v[56:59]
  ds_read_b64 v[140:141], v253 offset:3200
  ds_read_b64 v[142:143], v253 offset:3208
  v_mfma_f32_16x16x32_bf16 v[60:63], v[164:167], v[184:187], v[60:63]
  buffer_load_dwordx4 a[184:187], v2, s[52:55], s18 offen offset:2048 sc1
  s_waitcnt lgkmcnt(12)
  v_mfma_f32_16x16x32_bf16 v[56:59], v[168:171], v[176:179], v[56:59]
  buffer_load_dwordx4 a[188:191], v2, s[52:55], s18 offen offset:3072 sc1
  v_mfma_f32_16x16x32_bf16 v[60:63], v[168:171], v[180:183], v[60:63]
  v_mfma_f32_16x16x32_bf16 v[60:63], v[172:175], v[176:179], v[60:63]
  s_waitcnt lgkmcnt(4)
  v_mfma_f32_16x16x32_bf16 v[48:51], v[128:131], v[144:147], v[48:51]
  ds_read_b64 v[160:161], v253 offset:192
  ds_read_b64 v[162:163], v253 offset:200
  v_mfma_f32_16x16x32_bf16 v[52:55], v[128:131], v[148:151], v[52:55]
  ds_read_b128 v[176:179], v255 offset:4896
  ds_read_b128 v[180:183], v255 offset:3360
  v_mfma_f32_16x16x32_bf16 v[56:59], v[128:131], v[152:155], v[56:59]
  ds_read_b128 v[184:187], v255 offset:1824
  ds_read_b128 v[188:191], v255 offset:288
  v_mfma_f32_16x16x32_bf16 v[60:63], v[128:131], v[156:159], v[60:63]
  ds_read_b64 v[164:165], v253 offset:1216
  ds_read_b64 v[166:167], v253 offset:1224
  v_mfma_f32_16x16x32_bf16 v[52:55], v[132:135], v[144:147], v[52:55]
  ds_read_b64 v[168:169], v253 offset:2240
  ds_read_b64 v[170:171], v253 offset:2248
  v_mfma_f32_16x16x32_bf16 v[56:59], v[132:135], v[148:151], v[56:59]
  ds_read_b64 v[172:173], v253 offset:3264
  ds_read_b64 v[174:175], v253 offset:3272
  v_mfma_f32_16x16x32_bf16 v[60:63], v[132:135], v[152:155], v[60:63]
  s_add_u32 s18, s18, 4096
  buffer_load_dwordx4 a[192:195], v2, s[52:55], s18 offen offset:0 sc1
  buffer_load_dwordx4 a[196:199], v2, s[52:55], s18 offen offset:1024 sc1
  s_waitcnt lgkmcnt(12)
  v_mfma_f32_16x16x32_bf16 v[56:59], v[136:139], v[144:147], v[56:59]
  v_accvgpr_read_b32 v11, a232
  v_accvgpr_read_b32 v12, a233
  v_mfma_f32_16x16x32_bf16 v[60:63], v[136:139], v[148:151], v[60:63]
  v_accvgpr_read_b32 v13, a235
  v_mfma_f32_16x16x32_bf16 v[60:63], v[140:143], v[144:147], v[60:63]
  v_accvgpr_read_b32 v14, a234
  s_waitcnt lgkmcnt(4)
  v_mfma_f32_16x16x32_bf16 v[48:51], v[160:163], v[176:179], v[48:51]
  ds_read_b64 v[64:65], v11 offset:4608
  v_mfma_f32_16x16x32_bf16 v[52:55], v[160:163], v[180:183], v[52:55]
  ds_read_b64 v[66:67], v11 offset:3072
  v_mfma_f32_16x16x32_bf16 v[56:59], v[160:163], v[184:187], v[56:59]
  ds_read_b64 v[68:69], v11 offset:1536
  v_mfma_f32_16x16x32_bf16 v[60:63], v[160:163], v[188:191], v[60:63]
  ds_read_b64 v[70:71], v11 offset:0
  v_mfma_f32_16x16x32_bf16 v[52:55], v[164:167], v[176:179], v[52:55]
  ds_read_b64 v[80:81], v12
  v_mfma_f32_16x16x32_bf16 v[56:59], v[164:167], v[180:183], v[56:59]
  v_mfma_f32_16x16x32_bf16 v[60:63], v[164:167], v[184:187], v[60:63]
  s_waitcnt lgkmcnt(5)
  v_mfma_f32_16x16x32_bf16 v[56:59], v[168:171], v[176:179], v[56:59]
  v_mfma_f32_16x16x32_bf16 v[60:63], v[168:171], v[180:183], v[60:63]
  v_mfma_f32_16x16x32_bf16 v[60:63], v[172:175], v[176:179], v[60:63]
  s_waitcnt lgkmcnt(0)
  s_barrier
  ds_write_b128 v13, v[48:51] offset:0
  ds_write_b128 v13, v[52:55] offset:1024
  s_nop 1
  ds_write_b128 v13, v[56:59] offset:2048
  s_nop 0
  ds_write_b128 v13, v[60:63] offset:3072
  s_cmp_lg_u32 s7, 2
  s_cbranch_scc1 skip_26
  buffer_load_dwordx3 v[128:130], v251, s[52:55], s80 offen offset:0 sc1
  buffer_load_dwordx3 v[132:134], v251, s[52:55], s80 offen offset:768 sc1
  buffer_load_dwordx3 v[136:138], v251, s[52:55], s80 offen offset:1536 sc1
  buffer_load_dwordx3 v[140:142], v251, s[52:55], s80 offen offset:2304 sc1
  buffer_load_dwordx3 v[144:146], v251, s[52:55], s80 offen offset:3072 sc1
  buffer_load_dwordx3 v[148:150], v251, s[52:55], s81 offen offset:0 sc1
  buffer_load_dwordx3 v[152:154], v251, s[52:55], s81 offen offset:768 sc1
  buffer_load_dwordx3 v[156:158], v251, s[52:55], s81 offen offset:1536 sc1
  buffer_load_dwordx3 v[160:162], v251, s[52:55], s81 offen offset:2304 sc1
  buffer_load_dwordx3 v[164:166], v251, s[52:55], s81 offen offset:3072 sc1
  buffer_load_dwordx3 v[168:170], v251, s[52:55], s82 offen offset:0 sc1
  buffer_load_dwordx3 v[172:174], v251, s[52:55], s82 offen offset:768 sc1
  buffer_load_dwordx3 v[240:242], v251, s[52:55], s82 offen offset:1536 sc1
  buffer_load_dwordx3 v[244:246], v251, s[52:55], s82 offen offset:2304 sc1
  buffer_load_dwordx3 v[248:250], v251, s[52:55], s82 offen offset:3072 sc1
skip_26:
  v_dot2_f32_bf16 v192, v65, s23, v192
  v_dot2_f32_bf16 v193, v65, s22, v193
  v_dot2_f32_bf16 v194, v64, s23, v194
  v_dot2_f32_bf16 v195, v64, s22, v195
  v_dot2_f32_bf16 v196, v67, s23, v196
  v_dot2_f32_bf16 v197, v67, s22, v197
  v_dot2_f32_bf16 v198, v66, s23, v198
  v_dot2_f32_bf16 v199, v66, s22, v199
  v_cvt_pk_bf16_f32 v72, v192, v193
  v_cvt_pk_bf16_f32 v73, v194, v195
  ds_write_b64 v14, v[72:73] offset:0
  v_dot2_f32_bf16 v200, v69, s23, v200
  v_dot2_f32_bf16 v201, v69, s22, v201
  v_dot2_f32_bf16 v202, v68, s23, v202
  v_dot2_f32_bf16 v203, v68, s22, v203
  v_cvt_pk_bf16_f32 v74, v196, v197
  v_cvt_pk_bf16_f32 v75, v198, v199
  ds_write_b64 v14, v[74:75] offset:1280
  v_dot2_f32_bf16 v204, v71, s23, v204
  v_dot2_f32_bf16 v205, v71, s22, v205
  v_dot2_f32_bf16 v206, v70, s23, v206
  v_dot2_f32_bf16 v207, v70, s22, v207
  v_cvt_pk_bf16_f32 v76, v200, v201
  v_cvt_pk_bf16_f32 v77, v202, v203
  ds_write_b64 v14, v[76:77] offset:2560
  v_cvt_pk_bf16_f32 v78, v204, v205
  v_cvt_pk_bf16_f32 v79, v206, v207
  ds_write_b64 v14, v[78:79] offset:3840
  v_accvgpr_read_b32 v11, a237
  v_accvgpr_read_b32 v12, a236
  v_accvgpr_read_b32 v13, a238
  v_accvgpr_read_b32 v14, a239
  v_accvgpr_read_b32 v15, a251
  s_waitcnt lgkmcnt(0)
  s_barrier
  ds_read_b128 v[64:67], v11 offset:0
  ds_read_b128 v[68:71], v11 offset:1280
  ds_read_b128 v[176:179], v12 offset:0
  ds_read_b128 v[180:183], v12 offset:4096
  ds_read_b128 v[184:187], v12 offset:8192
  ds_read_b128 v[188:191], v12 offset:12288
  v_accvgpr_read_b32 v252, a252
  v_accvgpr_read_b32 v253, a253
  v_accvgpr_read_b32 v254, a254
  s_waitcnt lgkmcnt(5)
  buffer_store_dwordx4 v[64:67], v2, s[52:55], s93 offen offset:0 sc1
  s_waitcnt lgkmcnt(4)
  buffer_store_dwordx4 v[68:71], v2, s[52:55], s93 offen offset:1024 sc1
  s_waitcnt lgkmcnt(0)
  v_pk_add_f32 v[176:177], v[176:177], v[180:181]
  v_pk_add_f32 v[184:185], v[184:185], v[188:189]
  v_pk_add_f32 v[178:179], v[178:179], v[182:183]
  v_pk_add_f32 v[186:187], v[186:187], v[190:191]
  v_pk_add_f32 v[176:177], v[176:177], v[184:185]
  v_pk_add_f32 v[178:179], v[178:179], v[186:187]
  v_dot2_f32_bf16 v176, v81, s25, v176
  v_dot2_f32_bf16 v177, v81, s24, v177
  v_dot2_f32_bf16 v178, v80, s25, v178
  v_dot2_f32_bf16 v179, v80, s24, v179
  s_nop 0
  v_cvt_pk_bf16_f32 v82, v176, v177
  s_nop 0
  v_cvt_pk_bf16_f32 v83, v178, v179
  ds_write_b64 v13, v[82:83]
  ds_read_b128 v[84:87], v14
  s_mov_b32 exec_hi, 0
  s_waitcnt lgkmcnt(0)
  buffer_store_dwordx4 v[84:87], v15, s[52:55], s92 offen sc1
  s_mov_b32 exec_hi, -1
  s_cmp_lg_u32 s7, 2
  s_cbranch_scc1 skip_27
aggpoll_28:
  s_waitcnt vmcnt(3)
  v_min3_u32 v13, v130, v134, v138
  v_max3_u32 v14, v130, v134, v138
  v_min3_u32 v13, v13, v142, v146
  v_max3_u32 v14, v14, v142, v146
  v_min3_u32 v13, v13, v150, v154
  v_max3_u32 v14, v14, v150, v154
  v_min3_u32 v13, v13, v158, v162
  v_max3_u32 v14, v14, v158, v162
  v_min3_u32 v13, v13, v166, v170
  v_max3_u32 v14, v14, v166, v170
  v_min3_u32 v13, v13, v174, v242
  v_max3_u32 v14, v14, v174, v242
  v_min3_u32 v13, v13, v246, v250
  v_max3_u32 v14, v14, v246, v250
  v_xor_b32 v13, s8, v13
  v_xor_b32 v14, s8, v14
  v_or_b32 v13, v13, v14
  v_cmp_ne_u32 vcc, 0, v13
  s_cbranch_vccnz retry_30
giveup_31:
  v_pk_fma_f32 v[42:43], v[128:129], v[38:39], v[132:133] op_sel:[1,1,0] op_sel_hi:[0,1,1] neg_lo:[0,1,0]
  v_pk_fma_f32 v[42:43], v[128:129], v[38:39], v[42:43] op_sel:[0,0,0] op_sel_hi:[1,0,1]
  v_pk_fma_f32 v[44:45], v[42:43], v[38:39], v[136:137] op_sel:[1,1,0] op_sel_hi:[0,1,1] neg_lo:[0,1,0]
  v_pk_fma_f32 v[44:45], v[42:43], v[38:39], v[44:45] op_sel:[0,0,0] op_sel_hi:[1,0,1]
  v_pk_fma_f32 v[42:43], v[44:45], v[38:39], v[140:141] op_sel:[1,1,0] op_sel_hi:[0,1,1] neg_lo:[0,1,0]
  v_pk_fma_f32 v[42:43], v[44:45], v[38:39], v[42:43] op_sel:[0,0,0] op_sel_hi:[1,0,1]
  v_pk_fma_f32 v[44:45], v[42:43], v[38:39], v[144:145] op_sel:[1,1,0] op_sel_hi:[0,1,1] neg_lo:[0,1,0]
  v_pk_fma_f32 v[44:45], v[42:43], v[38:39], v[44:45] op_sel:[0,0,0] op_sel_hi:[1,0,1]
  v_pk_fma_f32 v[42:43], v[44:45], v[38:39], v[148:149] op_sel:[1,1,0] op_sel_hi:[0,1,1] neg_lo:[0,1,0]
  v_pk_fma_f32 v[42:43], v[44:45], v[38:39], v[42:43] op_sel:[0,0,0] op_sel_hi:[1,0,1]
  v_pk_fma_f32 v[44:45], v[42:43], v[38:39], v[152:153] op_sel:[1,1,0] op_sel_hi:[0,1,1] neg_lo:[0,1,0]
  v_pk_fma_f32 v[44:45], v[42:43], v[38:39], v[44:45] op_sel:[0,0,0] op_sel_hi:[1,0,1]
  v_pk_fma_f32 v[42:43], v[44:45], v[38:39], v[156:157] op_sel:[1,1,0] op_sel_hi:[0,1,1] neg_lo:[0,1,0]
  v_pk_fma_f32 v[42:43], v[44:45], v[38:39], v[42:43] op_sel:[0,0,0] op_sel_hi:[1,0,1]
  v_pk_fma_f32 v[44:45], v[42:43], v[38:39], v[160:161] op_sel:[1,1,0] op_sel_hi:[0,1,1] neg_lo:[0,1,0]
  v_pk_fma_f32 v[44:45], v[42:43], v[38:39], v[44:45] op_sel:[0,0,0] op_sel_hi:[1,0,1]
  v_pk_fma_f32 v[42:43], v[44:45], v[38:39], v[164:165] op_sel:[1,1,0] op_sel_hi:[0,1,1] neg_lo:[0,1,0]
  v_pk_fma_f32 v[42:43], v[44:45], v[38:39], v[42:43] op_sel:[0,0,0] op_sel_hi:[1,0,1]
  v_pk_fma_f32 v[44:45], v[42:43], v[38:39], v[168:169] op_sel:[1,1,0] op_sel_hi:[0,1,1] neg_lo:[0,1,0]
  v_pk_fma_f32 v[44:45], v[42:43], v[38:39], v[44:45] op_sel:[0,0,0] op_sel_hi:[1,0,1]
  v_pk_fma_f32 v[42:43], v[44:45], v[38:39], v[172:173] op_sel:[1,1,0] op_sel_hi:[0,1,1] neg_lo:[0,1,0]
  v_pk_fma_f32 v[42:43], v[44:45], v[38:39], v[42:43] op_sel:[0,0,0] op_sel_hi:[1,0,1]
  v_pk_fma_f32 v[44:45], v[42:43], v[38:39], v[240:241] op_sel:[1,1,0] op_sel_hi:[0,1,1] neg_lo:[0,1,0]
  v_pk_fma_f32 v[44:45], v[42:43], v[38:39], v[44:45] op_sel:[0,0,0] op_sel_hi:[1,0,1]
  v_pk_fma_f32 v[42:43], v[44:45], v[38:39], v[244:245] op_sel:[1,1,0] op_sel_hi:[0,1,1] neg_lo:[0,1,0]
  v_pk_fma_f32 v[42:43], v[44:45], v[38:39], v[42:43] op_sel:[0,0,0] op_sel_hi:[1,0,1]
  v_pk_fma_f32 v[44:45], v[42:43], v[38:39], v[248:249] op_sel:[1,1,0] op_sel_hi:[0,1,1] neg_lo:[0,1,0]
  v_pk_fma_f32 v[44:45], v[42:43], v[38:39], v[44:45] op_sel:[0,0,0] op_sel_hi:[1,0,1]
  v_pk_mul_f32 v[46:47], v[44:45], v[40:41] op_sel:[1,1] op_sel_hi:[0,1] neg_lo:[0,1] neg_hi:[0,1]
  v_pk_fma_f32 v[128:129], v[44:45], v[40:41], v[46:47] op_sel:[0,0,0] op_sel_hi:[1,0,1] neg_hi:[0,1,0]
  s_mov_b32 exec_hi, 0xff
  v_pk_fma_f32 v[130:131], v[128:129], v[36:37], v[208:209] op_sel:[1,1,0] op_sel_hi:[0,1,1] neg_hi:[0,1,0]
  v_pk_fma_f32 v[130:131], v[128:129], v[36:37], v[130:131] op_sel:[0,0,0] op_sel_hi:[1,0,1]
  ds_write_b128 v247, v[128:131] offset:0
  v_pk_fma_f32 v[132:133], v[130:131], v[36:37], v[210:211] op_sel:[1,1,0] op_sel_hi:[0,1,1] neg_hi:[0,1,0]
  v_pk_fma_f32 v[132:133], v[130:131], v[36:37], v[132:133] op_sel:[0,0,0] op_sel_hi:[1,0,1]
  v_pk_fma_f32 v[134:135], v[132:133], v[36:37], v[212:213] op_sel:[1,1,0] op_sel_hi:[0,1,1] neg_hi:[0,1,0]
  v_pk_fma_f32 v[134:135], v[132:133], v[36:37], v[134:135] op_sel:[0,0,0] op_sel_hi:[1,0,1]
  ds_write_b128 v247, v[132:135] offset:16
  v_pk_fma_f32 v[136:137], v[134:135], v[36:37], v[214:215] op_sel:[1,1,0] op_sel_hi:[0,1,1] neg_hi:[0,1,0]
  v_pk_fma_f32 v[136:137], v[134:135], v[36:37], v[136:137] op_sel:[0,0,0] op_sel_hi:[1,0,1]
  v_pk_fma_f32 v[138:139], v[136:137], v[36:37], v[216:217] op_sel:[1,1,0] op_sel_hi:[0,1,1] neg_hi:[0,1,0]
  v_pk_fma_f32 v[138:139], v[136:137], v[36:37], v[138:139] op_sel:[0,0,0] op_sel_hi:[1,0,1]
  ds_write_b128 v247, v[136:139] offset:32
  v_pk_fma_f32 v[140:141], v[138:139], v[36:37], v[218:219] op_sel:[1,1,0] op_sel_hi:[0,1,1] neg_hi:[0,1,0]
  v_pk_fma_f32 v[140:141], v[138:139], v[36:37], v[140:141] op_sel:[0,0,0] op_sel_hi:[1,0,1]
  v_pk_fma_f32 v[142:143], v[140:141], v[36:37], v[220:221] op_sel:[1,1,0] op_sel_hi:[0,1,1] neg_hi:[0,1,0]
  v_pk_fma_f32 v[142:143], v[140:141], v[36:37], v[142:143] op_sel:[0,0,0] op_sel_hi:[1,0,1]
  ds_write_b128 v247, v[140:143] offset:48
  v_pk_fma_f32 v[144:145], v[142:143], v[36:37], v[222:223] op_sel:[1,1,0] op_sel_hi:[0,1,1] neg_hi:[0,1,0]
  v_pk_fma_f32 v[144:145], v[142:143], v[36:37], v[144:145] op_sel:[0,0,0] op_sel_hi:[1,0,1]
  v_pk_fma_f32 v[146:147], v[144:145], v[36:37], v[224:225] op_sel:[1,1,0] op_sel_hi:[0,1,1] neg_hi:[0,1,0]
  v_pk_fma_f32 v[146:147], v[144:145], v[36:37], v[146:147] op_sel:[0,0,0] op_sel_hi:[1,0,1]
  ds_write_b128 v247, v[144:147] offset:64
  v_pk_fma_f32 v[148:149], v[146:147], v[36:37], v[226:227] op_sel:[1,1,0] op_sel_hi:[0,1,1] neg_hi:[0,1,0]
  v_pk_fma_f32 v[148:149], v[146:147], v[36:37], v[148:149] op_sel:[0,0,0] op_sel_hi:[1,0,1]
  v_pk_fma_f32 v[150:151], v[148:149], v[36:37], v[228:229] op_sel:[1,1,0] op_sel_hi:[0,1,1] neg_hi:[0,1,0]
  v_pk_fma_f32 v[150:151], v[148:149], v[36:37], v[150:151] op_sel:[0,0,0] op_sel_hi:[1,0,1]
  ds_write_b128 v247, v[148:151] offset:80
  v_pk_fma_f32 v[152:153], v[150:151], v[36:37], v[230:231] op_sel:[1,1,0] op_sel_hi:[0,1,1] neg_hi:[0,1,0]
  v_pk_fma_f32 v[152:153], v[150:151], v[36:37], v[152:153] op_sel:[0,0,0] op_sel_hi:[1,0,1]
  v_pk_fma_f32 v[154:155], v[152:153], v[36:37], v[232:233] op_sel:[1,1,0] op_sel_hi:[0,1,1] neg_hi:[0,1,0]
  v_pk_fma_f32 v[154:155], v[152:153], v[36:37], v[154:155] op_sel:[0,0,0] op_sel_hi:[1,0,1]
  ds_write_b128 v247, v[152:155] offset:96
  v_pk_fma_f32 v[156:157], v[154:155], v[36:37], v[234:235] op_sel:[1,1,0] op_sel_hi:[0,1,1] neg_hi:[0,1,0]
  v_pk_fma_f32 v[156:157], v[154:155], v[36:37], v[156:157] op_sel:[0,0,0] op_sel_hi:[1,0,1]
  v_pk_fma_f32 v[158:159], v[156:157], v[36:37], v[236:237] op_sel:[1,1,0] op_sel_hi:[0,1,1] neg_hi:[0,1,0]
  v_pk_fma_f32 v[158:159], v[156:157], v[36:37], v[158:159] op_sel:[0,0,0] op_sel_hi:[1,0,1]
  ds_write_b128 v247, v[156:159] offset:112
  s_mov_b32 exec_hi, -1
skip_27:
  s_waitcnt lgkmcnt(0)
  s_barrier
  ds_read_b32 v48, v9 offset:0
  ds_read_b32 v49, v9 offset:1152
  ds_read_b32 v50, v9 offset:2304
  ds_read_b32 v51, v9 offset:3456
  ds_read_b32 v52, v9 offset:4608
  s_waitcnt lgkmcnt(0)
  v_fmac_f32 v88, v16, v48
  v_fmac_f32 v96, v17, v49
  v_fmac_f32 v104, v18, v50
  v_fmac_f32_dpp v88, v48, v21 quad_perm:[1,0,3,2] row_mask:0xf bank_mask:0xf
  v_fmac_f32_dpp v96, v49, v22 quad_perm:[1,0,3,2] row_mask:0xf bank_mask:0xf
  v_fmac_f32_dpp v104, v50, v23 quad_perm:[1,0,3,2] row_mask:0xf bank_mask:0xf
  v_fmac_f32 v89, v16, v88
  v_fmac_f32 v97, v17, v96
  v_fmac_f32_e64 v105, v18, v104
  v_fmac_f32_dpp v89, v88, v21 quad_perm:[1,0,3,2] row_mask:0xf bank_mask:0xf
  v_fmac_f32_dpp v97, v96, v22 quad_perm:[1,0,3,2] row_mask:0xf bank_mask:0xf
  v_fmac_f32_dpp v105, v104, v23 quad_perm:[1,0,3,2] row_mask:0xf bank_mask:0xf
  v_fmac_f32 v90, v16, v89
  v_fmac_f32 v98, v17, v97
  v_fmac_f32_e64 v106, v18, v105
  v_fmac_f32_dpp v90, v89, v21 quad_perm:[1,0,3,2] row_mask:0xf bank_mask:0xf
  v_fmac_f32_dpp v98, v97, v22 quad_perm:[1,0,3,2] row_mask:0xf bank_mask:0xf
  v_fmac_f32_dpp v106, v105, v23 quad_perm:[1,0,3,2] row_mask:0xf bank_mask:0xf
  v_fmac_f32 v91, v16, v90
  v_fmac_f32 v99, v17, v98
  v_fmac_f32_e64 v107, v18, v106
  v_fmac_f32_dpp v91, v90, v21 quad_perm:[1,0,3,2] row_mask:0xf bank_mask:0xf
  v_fmac_f32_dpp v99, v98, v22 quad_perm:[1,0,3,2] row_mask:0xf bank_mask:0xf
  v_fmac_f32_dpp v107, v106, v23 quad_perm:[1,0,3,2] row_mask:0xf bank_mask:0xf
  v_fmac_f32 v92, v16, v91
  v_fmac_f32 v100, v17, v99
  v_fmac_f32_e64 v108, v18, v107
  v_fmac_f32_dpp v92, v91, v21 quad_perm:[1,0,3,2] row_mask:0xf bank_mask:0xf
  v_fmac_f32_dpp v100, v99, v22 quad_perm:[1,0,3,2] row_mask:0xf bank_mask:0xf
  v_fmac_f32_dpp v108, v107, v23 quad_perm:[1,0,3,2] row_mask:0xf bank_mask:0xf
  v_fmac_f32 v93, v16, v92
  v_fmac_f32 v101, v17, v100
  v_fmac_f32_e64 v109, v18, v108
  v_fmac_f32_dpp v93, v92, v21 quad_perm:[1,0,3,2] row_mask:0xf bank_mask:0xf
  v_fmac_f32_dpp v101, v100, v22 quad_perm:[1,0,3,2] row_mask:0xf bank_mask:0xf
  v_fmac_f32_dpp v109, v108, v23 quad_perm:[1,0,3,2] row_mask:0xf bank_mask:0xf
  v_fmac_f32 v94, v16, v93
  v_fmac_f32 v102, v17, v101
  v_fmac_f32_e64 v110, v18, v109
  v_fmac_f32_dpp v94, v93, v21 quad_perm:[1,0,3,2] row_mask:0xf bank_mask:0xf
  v_fmac_f32_dpp v102, v101, v22 quad_perm:[1,0,3,2] row_mask:0xf bank_mask:0xf
  v_fmac_f32_dpp v110, v109, v23 quad_perm:[1,0,3,2] row_mask:0xf bank_mask:0xf
  v_fmac_f32 v95, v16, v94
  v_fmac_f32 v103, v17, v102
  v_fmac_f32_e64 v111, v18, v110
  v_fmac_f32_dpp v95, v94, v21 quad_perm:[1,0,3,2] row_mask:0xf bank_mask:0xf
  v_fmac_f32_dpp v103, v102, v22 quad_perm:[1,0,3,2] row_mask:0xf bank_mask:0xf
  v_fmac_f32_dpp v111, v110, v23 quad_perm:[1,0,3,2] row_mask:0xf bank_mask:0xf
  v_fmac_f32 v112, v19, v51
  v_fmac_f32 v120, v20, v52
  v_cvt_pk_bf16_f32 v56, v88, v89
  v_cvt_pk_bf16_f32 v57, v90, v91
  v_cvt_pk_bf16_f32 v58, v92, v93
  v_fmac_f32_dpp v112, v51, v24 quad_perm:[1,0,3,2] row_mask:0xf bank_mask:0xf
  v_fmac_f32_dpp v120, v52, v25 quad_perm:[1,0,3,2] row_mask:0xf bank_mask:0xf
  v_fmac_f32 v113, v19, v112
  v_fmac_f32 v121, v20, v120
  v_cvt_pk_bf16_f32 v59, v94, v95
  ds_write_b128 v252, v[56:59]
  ds_read_b64_tr_b16 v[68:69], v253
  v_fmac_f32_dpp v113, v112, v24 quad_perm:[1,0,3,2] row_mask:0xf bank_mask:0xf
  v_fmac_f32_dpp v121, v120, v25 quad_perm:[1,0,3,2] row_mask:0xf bank_mask:0xf
  v_fmac_f32 v114, v19, v113
  v_fmac_f32 v122, v20, v121
  ds_read_b64_tr_b16 v[70:71], v253 offset:640
  v_cvt_pk_bf16_f32 v60, v96, v97
  v_cvt_pk_bf16_f32 v61, v98, v99
  v_fmac_f32_dpp v114, v113, v24 quad_perm:[1,0,3,2] row_mask:0xf bank_mask:0xf
  v_fmac_f32_dpp v122, v121, v25 quad_perm:[1,0,3,2] row_mask:0xf bank_mask:0xf
  v_fmac_f32 v115, v19, v114
  v_fmac_f32 v123, v20, v122
  v_cvt_pk_bf16_f32 v62, v100, v101
  v_cvt_pk_bf16_f32 v63, v102, v103
  ds_write_b128 v252, v[60:63]
  v_fmac_f32_dpp v115, v114, v24 quad_perm:[1,0,3,2] row_mask:0xf bank_mask:0xf
  v_fmac_f32_dpp v123, v122, v25 quad_perm:[1,0,3,2] row_mask:0xf bank_mask:0xf
  v_fmac_f32 v116, v19, v115
  v_fmac_f32 v124, v20, v123
  ds_read_b64_tr_b16 v[72:73], v253
  ds_read_b64_tr_b16 v[74:75], v253 offset:640
  v_cvt_pk_bf16_f32 v64, v104, v105
  v_fmac_f32_dpp v116, v115, v24 quad_perm:[1,0,3,2] row_mask:0xf bank_mask:0xf
  v_fmac_f32_dpp v124, v123, v25 quad_perm:[1,0,3,2] row_mask:0xf bank_mask:0xf
  v_fmac_f32 v117, v19, v116
  v_fmac_f32 v125, v20, v124
  v_cvt_pk_bf16_f32 v65, v106, v107
  v_cvt_pk_bf16_f32 v66, v108, v109
  v_fmac_f32_dpp v117, v116, v24 quad_perm:[1,0,3,2] row_mask:0xf bank_mask:0xf
  v_fmac_f32_dpp v125, v124, v25 quad_perm:[1,0,3,2] row_mask:0xf bank_mask:0xf
  v_fmac_f32 v118, v19, v117
  v_fmac_f32 v126, v20, v125
  v_cvt_pk_bf16_f32 v67, v110, v111
  ds_write_b128 v252, v[64:67]
  v_fmac_f32_dpp v118, v117, v24 quad_perm:[1,0,3,2] row_mask:0xf bank_mask:0xf
  v_fmac_f32_dpp v126, v125, v25 quad_perm:[1,0,3,2] row_mask:0xf bank_mask:0xf
  v_fmac_f32 v119, v19, v118
  v_fmac_f32 v127, v20, v126
  ds_read_b64_tr_b16 v[76:77], v253
  ds_read_b64_tr_b16 v[78:79], v253 offset:640
  v_fmac_f32_dpp v119, v118, v24 quad_perm:[1,0,3,2] row_mask:0xf bank_mask:0xf
  v_fmac_f32_dpp v127, v126, v25 quad_perm:[1,0,3,2] row_mask:0xf bank_mask:0xf
  s_cmp_eq_u32 s9, 0
  s_cbranch_scc1 slow_32
  s_add_u32 s13, s75, 10485760
  s_waitcnt lgkmcnt(6)
  buffer_store_dwordx4 v[68:71], v254, s[52:55], s13 offen
  s_add_u32 s13, s76, 10485760
  s_waitcnt lgkmcnt(3)
  buffer_store_dwordx4 v[72:75], v254, s[52:55], s13 offen
  s_add_u32 s13, s77, 10485760
  s_waitcnt lgkmcnt(0)
  buffer_store_dwordx4 v[76:79], v254, s[52:55], s13 offen
back_33:
  v_cvt_pk_bf16_f32 v56, v112, v113
  v_cvt_pk_bf16_f32 v57, v114, v115
  v_cvt_pk_bf16_f32 v58, v116, v117
  v_cvt_pk_bf16_f32 v59, v118, v119
  ds_write_b128 v252, v[56:59]
  ds_read_b64_tr_b16 v[80:81], v253
  ds_read_b64_tr_b16 v[82:83], v253 offset:640
  v_cvt_pk_bf16_f32 v60, v120, v121
  v_cvt_pk_bf16_f32 v61, v122, v123
  v_cvt_pk_bf16_f32 v62, v124, v125
  v_cvt_pk_bf16_f32 v63, v126, v127
  ds_write_b128 v252, v[60:63]
  ds_read_b64_tr_b16 v[84:85], v253
  ds_read_b64_tr_b16 v[86:87], v253 offset:640
  s_cmp_eq_u32 s9, 0
  s_cbranch_scc1 slow_34
  s_add_u32 s13, s78, 10485760
  s_waitcnt lgkmcnt(3)
  buffer_store_dwordx4 v[80:83], v254, s[52:55], s13 offen
  s_add_u32 s13, s79, 10485760
  s_waitcnt lgkmcnt(0)
  buffer_store_dwordx4 v[84:87], v254, s[52:55], s13 offen
back_35:
  s_add_u32 s12, s73, 12288
  s_waitcnt vmcnt(0)
  v_mov_b32 v15, s8
  s_mov_b64 exec, 1
  s_cmp_eq_u32 s9, 0
  s_cbranch_scc1 slow_36
  buffer_store_dword v15, off, s[52:55], s12
back_37:
  s_mov_b64 exec, -1
  s_add_u32 s12, s16, 24576
  v_mov_b32 v15, s8
  s_mov_b64 exec, 1
  buffer_store_dword v15, off, s[52:55], s12 sc1
  s_mov_b64 exec, -1
  v_accvgpr_read_b32 v218, a230
  v_accvgpr_read_b32 v219, a231
  v_mul_f32_e64 v218, v218, v219
  v_accvgpr_read_b32 v208, a220
  v_accvgpr_read_b32 v228, a240
  v_accvgpr_read_b32 v209, a221
  v_accvgpr_read_b32 v229, a241
  v_lshlrev_b32_e64 v196, 16, v228
  v_and_b32 v197, 0xffff0000, v228
  v_lshlrev_b32_e64 v198, 16, v229
  v_and_b32 v199, 0xffff0000, v229
  v_lshlrev_b32_e64 v108, 16, v208
  v_and_b32 v109, 0xffff0000, v208
  v_lshlrev_b32_e64 v110, 16, v209
  v_and_b32 v111, 0xffff0000, v209
  v_pk_fma_f32 v[192:193], v[108:109], v[218:219], v[218:219] op_sel:[0,1,0] op_sel_hi:[1,1,0] neg_lo:[0,0,1] neg_hi:[0,0,1]
  v_pk_fma_f32 v[194:195], v[110:111], v[218:219], v[218:219] op_sel:[0,1,0] op_sel_hi:[1,1,0] neg_lo:[0,0,1] neg_hi:[0,0,1]
  v_pk_fma_f32 v[108:109], v[192:193], v[196:197], v[108:109]
  v_pk_fma_f32 v[110:111], v[194:195], v[198:199], v[110:111]
  v_accvgpr_read_b32 v208, a222
  v_accvgpr_read_b32 v228, a242
  v_accvgpr_read_b32 v209, a223
  v_accvgpr_read_b32 v229, a243
  v_lshlrev_b32_e64 v196, 16, v228
  v_and_b32 v197, 0xffff0000, v228
  v_lshlrev_b32_e64 v198, 16, v229
  v_and_b32 v199, 0xffff0000, v229
  v_lshlrev_b32_e64 v112, 16, v208
  v_and_b32 v113, 0xffff0000, v208
  v_lshlrev_b32_e64 v114, 16, v209
  v_and_b32 v115, 0xffff0000, v209
  v_pk_fma_f32 v[192:193], v[112:113], v[218:219], v[218:219] op_sel:[0,1,0] op_sel_hi:[1,1,0] neg_lo:[0,0,1] neg_hi:[0,0,1]
  v_pk_fma_f32 v[194:195], v[114:115], v[218:219], v[218:219] op_sel:[0,1,0] op_sel_hi:[1,1,0] neg_lo:[0,0,1] neg_hi:[0,0,1]
  v_pk_fma_f32 v[112:113], v[192:193], v[196:197], v[112:113]
  v_pk_fma_f32 v[114:115], v[194:195], v[198:199], v[114:115]
  v_accvgpr_read_b32 v208, a224
  v_accvgpr_read_b32 v228, a244
  v_accvgpr_read_b32 v209, a225
  v_accvgpr_read_b32 v229, a245
  v_lshlrev_b32_e64 v196, 16, v228
  v_and_b32 v197, 0xffff0000, v228
  v_lshlrev_b32_e64 v198, 16, v229
  v_and_b32 v199, 0xffff0000, v229
  v_lshlrev_b32_e64 v116, 16, v208
  v_and_b32 v117, 0xffff0000, v208
  v_lshlrev_b32_e64 v118, 16, v209
  v_and_b32 v119, 0xffff0000, v209
  v_pk_fma_f32 v[192:193], v[116:117], v[218:219], v[218:219] op_sel:[0,1,0] op_sel_hi:[1,1,0] neg_lo:[0,0,1] neg_hi:[0,0,1]
  v_pk_fma_f32 v[194:195], v[118:119], v[218:219], v[218:219] op_sel:[0,1,0] op_sel_hi:[1,1,0] neg_lo:[0,0,1] neg_hi:[0,0,1]
  v_pk_fma_f32 v[116:117], v[192:193], v[196:197], v[116:117]
  v_pk_fma_f32 v[118:119], v[194:195], v[198:199], v[118:119]
  v_accvgpr_read_b32 v208, a226
  v_accvgpr_read_b32 v228, a246
  v_accvgpr_read_b32 v209, a227
  v_accvgpr_read_b32 v229, a247
  v_lshlrev_b32_e64 v196, 16, v228
  v_and_b32 v197, 0xffff0000, v228
  v_lshlrev_b32_e64 v198, 16, v229
  v_and_b32 v199, 0xffff0000, v229
  v_lshlrev_b32_e64 v120, 16, v208
  v_and_b32 v121, 0xffff0000, v208
  v_lshlrev_b32_e64 v122, 16, v209
  v_and_b32 v123, 0xffff0000, v209
  v_pk_fma_f32 v[192:193], v[120:121], v[218:219], v[218:219] op_sel:[0,1,0] op_sel_hi:[1,1,0] neg_lo:[0,0,1] neg_hi:[0,0,1]
  v_pk_fma_f32 v[194:195], v[122:123], v[218:219], v[218:219] op_sel:[0,1,0] op_sel_hi:[1,1,0] neg_lo:[0,0,1] neg_hi:[0,0,1]
  v_pk_fma_f32 v[120:121], v[192:193], v[196:197], v[120:121]
  v_pk_fma_f32 v[122:123], v[194:195], v[198:199], v[122:123]
  v_accvgpr_read_b32 v208, a228
  v_accvgpr_read_b32 v228, a248
  v_accvgpr_read_b32 v209, a229
  v_accvgpr_read_b32 v229, a249
  v_lshlrev_b32_e64 v196, 16, v228
  v_and_b32 v197, 0xffff0000, v228
  v_lshlrev_b32_e64 v198, 16, v229
  v_and_b32 v199, 0xffff0000, v229
  v_lshlrev_b32_e64 v124, 16, v208
  v_and_b32 v125, 0xffff0000, v208
  v_lshlrev_b32_e64 v126, 16, v209
  v_and_b32 v127, 0xffff0000, v209
  v_pk_fma_f32 v[192:193], v[124:125], v[218:219], v[218:219] op_sel:[0,1,0] op_sel_hi:[1,1,0] neg_lo:[0,0,1] neg_hi:[0,0,1]
  v_pk_fma_f32 v[194:195], v[126:127], v[218:219], v[218:219] op_sel:[0,1,0] op_sel_hi:[1,1,0] neg_lo:[0,0,1] neg_hi:[0,0,1]
  v_pk_fma_f32 v[124:125], v[192:193], v[196:197], v[124:125]
  v_pk_fma_f32 v[126:127], v[194:195], v[198:199], v[126:127]
  v_lshrrev_b32 v11, 3, v1
  v_and_b32 v12, 7, v1
  v_lshrrev_b32 v13, 1, v11
  v_lshlrev_b32 v13, 1, v13
  s_movk_i32 s15, 0x78
  v_bfe_u32 v13, s15, v13, 2
  v_xor_b32 v12, v12, v13
  v_mul_u32_u24 v11, 1280, v11
  v_lshl_add_u32 v244, v12, 4, v11
  v_xor_b32_e64 v245, 64, v244
  s_mul_i32 s12, s4, 51200
  s_mul_i32 s23, s7, 6144
  s_mul_i32 s14, s7, 3
  s_add_u32 s14, s14, 0
  s_mul_i32 s15, s14, 205
  s_lshr_b32 s15, s15, 10
  s_mul_i32 s13, s15, 5
  s_sub_u32 s14, s14, s13
  s_mul_i32 s14, s14, 10240
  s_lshl_b32 s15, s15, 7
  s_add_u32 s14, s14, s15
  s_add_u32 s20, s14, s12
  s_mul_i32 s14, s7, 3
  s_add_u32 s14, s14, 1
  s_mul_i32 s15, s14, 205
  s_lshr_b32 s15, s15, 10
  s_mul_i32 s13, s15, 5
  s_sub_u32 s14, s14, s13
  s_mul_i32 s14, s14, 10240
  s_lshl_b32 s15, s15, 7
  s_add_u32 s14, s14, s15
  s_add_u32 s21, s14, s12
  s_mul_i32 s14, s7, 3
  s_add_u32 s14, s14, 2
  s_mul_i32 s15, s14, 205
  s_lshr_b32 s15, s15, 10
  s_mul_i32 s13, s15, 5
  s_sub_u32 s14, s14, s13
  s_mul_i32 s14, s14, 10240
  s_lshl_b32 s15, s15, 7
  s_add_u32 s14, s14, s15
  s_add_u32 s22, s14, s12
  s_mul_i32 s24, s6, 327680
  s_lshl_b32 s25, s5, 7
  s_add_u32 s24, s24, s25
  s_lshr_b32 s25, s7, 1
  s_lshl_b32 s25, s25, 6
  s_add_u32 s24, s24, s25
  s_add_u32 s24, s24, 19922944
  s_mul_i32 s25, s7, 6144
  v_lshrrev_b32 v205, 2, v1
  v_lshlrev_b32 v205, 12, v205
  v_and_b32 v12, 3, v1
  v_lshl_add_u32 v205, v12, 4, v205
  v_and_b32 v204, 31, v1
  v_lshlrev_b32 v204, 4, v204
  s_mul_i32 s13, s5, 163840
  s_mul_i32 s14, s7, 10240
  s_add_u32 s13, s13, s14
  s_add_u32 s13, s13, 10485760
  s_add_u32 s14, s7, 1
  s_and_b32 s14, s14, 3
  s_mul_i32 s15, s14, 40960
  s_add_u32 s36, s15, s13
  s_mul_i32 s15, s14, 15360
  s_add_u32 s15, s15, 102400
  v_add_u32 v44, s15, v2
  s_add_u32 s14, s7, 2
  s_and_b32 s14, s14, 3
  s_mul_i32 s15, s14, 40960
  s_add_u32 s37, s15, s13
  s_mul_i32 s15, s14, 15360
  s_add_u32 s15, s15, 107520
  v_add_u32 v45, s15, v2
  s_add_u32 s14, s7, 3
  s_and_b32 s14, s14, 3
  s_mul_i32 s15, s14, 40960
  s_add_u32 s38, s15, s13
  s_mul_i32 s15, s14, 15360
  s_add_u32 s15, s15, 112640
  v_add_u32 v46, s15, v2
  s_add_u32 s14, s7, 4
  s_and_b32 s14, s14, 3
  s_mul_i32 s15, s14, 40960
  s_add_u32 s39, s15, s13
  s_lshl_b32 s15, s3, 8
  s_lshl_b32 s13, s7, 6
  s_add_u32 s15, s15, s13
  s_and_b32 s13, s5, 1
  s_lshl_b32 s13, s13, 3
  s_add_u32 s15, s15, s13
  s_add_u32 s15, s15, 12288
  v_and_b32 v242, 3, v1
  v_lshlrev_b32 v242, 4, v242
  s_barrier
poll_38:
  buffer_load_dwordx2 v[42:43], v242, s[52:55], s15 offen sc1
  s_waitcnt vmcnt(0)
  v_xor_b32 v15, s8, v42
  v_xor_b32 v14, s8, v43
  v_or_b32 v15, v15, v14
  v_cmp_ne_u32 vcc, 0, v15
  s_cbranch_vccnz retry_39
giveup_40:
  buffer_load_dwordx4 v[128:131], v2, s[52:55], s36 offen offset:0 sc1
  buffer_load_dwordx4 v[132:135], v2, s[52:55], s36 offen offset:1024 sc1
  buffer_load_dwordx4 v[136:139], v2, s[52:55], s36 offen offset:2048 sc1
  buffer_load_dwordx4 v[140:143], v2, s[52:55], s36 offen offset:3072 sc1
  s_add_u32 s36, s36, 4096
  buffer_load_dwordx4 v[144:147], v2, s[52:55], s36 offen offset:0 sc1
  buffer_load_dwordx4 v[148:151], v2, s[52:55], s36 offen offset:1024 sc1
  buffer_load_dwordx4 v[152:155], v2, s[52:55], s36 offen offset:2048 sc1
  buffer_load_dwordx4 v[156:159], v2, s[52:55], s36 offen offset:3072 sc1
  s_waitcnt vmcnt(7)
  v_mfma_f32_16x16x32_bf16 v[48:51], a[0:3], v[128:131], 0
  s_add_u32 s36, s36, 4096
  buffer_load_dwordx4 v[160:163], v2, s[52:55], s36 offen offset:0 sc1
  v_mfma_f32_16x16x32_bf16 v[52:55], a[4:7], v[128:131], 0
  v_mfma_f32_16x16x32_bf16 v[56:59], a[8:11], v[128:131], 0
  v_mfma_f32_16x16x32_bf16 v[60:63], a[12:15], v[128:131], 0
  v_mfma_f32_16x16x32_bf16 v[64:67], a[16:19], v[128:131], 0
  s_waitcnt vmcnt(7)
  v_mfma_f32_16x16x32_bf16 v[48:51], a[20:23], v[132:135], v[48:51]
  buffer_load_dwordx4 v[164:167], v2, s[52:55], s36 offen offset:1024 sc1
  v_mfma_f32_16x16x32_bf16 v[52:55], a[24:27], v[132:135], v[52:55]
  v_mfma_f32_16x16x32_bf16 v[56:59], a[28:31], v[132:135], v[56:59]
  v_mfma_f32_16x16x32_bf16 v[60:63], a[32:35], v[132:135], v[60:63]
  v_mfma_f32_16x16x32_bf16 v[64:67], a[36:39], v[132:135], v[64:67]
  s_waitcnt vmcnt(7)
  v_mfma_f32_16x16x32_bf16 v[48:51], a[40:43], v[136:139], v[48:51]
  buffer_load_dwordx4 v[168:171], v2, s[52:55], s37 offen offset:0 sc1
  v_mfma_f32_16x16x32_bf16 v[52:55], a[44:47], v[136:139], v[52:55]
  v_mfma_f32_16x16x32_bf16 v[56:59], a[48:51], v[136:139], v[56:59]
  v_mfma_f32_16x16x32_bf16 v[60:63], a[52:55], v[136:139], v[60:63]
  v_mfma_f32_16x16x32_bf16 v[64:67], a[56:59], v[136:139], v[64:67]
  s_waitcnt vmcnt(7)
  v_mfma_f32_16x16x32_bf16 v[48:51], a[60:63], v[140:143], v[48:51]
  buffer_load_dwordx4 v[172:175], v2, s[52:55], s37 offen offset:1024 sc1
  v_mfma_f32_16x16x32_bf16 v[52:55], a[64:67], v[140:143], v[52:55]
  v_mfma_f32_16x16x32_bf16 v[56:59], a[68:71], v[140:143], v[56:59]
  v_mfma_f32_16x16x32_bf16 v[60:63], a[72:75], v[140:143], v[60:63]
  v_mfma_f32_16x16x32_bf16 v[64:67], a[76:79], v[140:143], v[64:67]
  s_waitcnt vmcnt(7)
  v_mfma_f32_16x16x32_bf16 v[48:51], a[80:83], v[144:147], v[48:51]
  buffer_load_dwordx4 v[176:179], v2, s[52:55], s37 offen offset:2048 sc1
  v_mfma_f32_16x16x32_bf16 v[52:55], a[84:87], v[144:147], v[52:55]
  v_mfma_f32_16x16x32_bf16 v[56:59], a[88:91], v[144:147], v[56:59]
  v_mfma_f32_16x16x32_bf16 v[60:63], a[92:95], v[144:147], v[60:63]
  v_mfma_f32_16x16x32_bf16 v[64:67], a[96:99], v[144:147], v[64:67]
  s_waitcnt vmcnt(7)
  v_mfma_f32_16x16x32_bf16 v[48:51], a[100:103], v[148:151], v[48:51]
  buffer_load_dwordx4 v[180:183], v2, s[52:55], s37 offen offset:3072 sc1
  v_mfma_f32_16x16x32_bf16 v[52:55], a[104:107], v[148:151], v[52:55]
  v_mfma_f32_16x16x32_bf16 v[56:59], a[108:111], v[148:151], v[56:59]
  v_mfma_f32_16x16x32_bf16 v[60:63], a[112:115], v[148:151], v[60:63]
  v_mfma_f32_16x16x32_bf16 v[64:67], a[116:119], v[148:151], v[64:67]
  s_waitcnt vmcnt(7)
  v_mfma_f32_16x16x32_bf16 v[48:51], a[120:123], v[152:155], v[48:51]
  s_add_u32 s37, s37, 4096
  buffer_load_dwordx4 v[184:187], v2, s[52:55], s37 offen offset:0 sc1
  v_mfma_f32_16x16x32_bf16 v[52:55], a[124:127], v[152:155], v[52:55]
  v_mfma_f32_16x16x32_bf16 v[56:59], a[128:131], v[152:155], v[56:59]
  v_mfma_f32_16x16x32_bf16 v[60:63], a[132:135], v[152:155], v[60:63]
  v_mfma_f32_16x16x32_bf16 v[64:67], a[136:139], v[152:155], v[64:67]
  s_waitcnt vmcnt(7)
  v_mfma_f32_16x16x32_bf16 v[48:51], a[140:143], v[156:159], v[48:51]
  buffer_load_dwordx4 v[188:191], v2, s[52:55], s37 offen offset:1024 sc1
  v_mfma_f32_16x16x32_bf16 v[52:55], a[144:147], v[156:159], v[52:55]
  v_mfma_f32_16x16x32_bf16 v[56:59], a[148:151], v[156:159], v[56:59]
  v_mfma_f32_16x16x32_bf16 v[60:63], a[152:155], v[156:159], v[60:63]
  v_mfma_f32_16x16x32_bf16 v[64:67], a[156:159], v[156:159], v[64:67]
  s_waitcnt vmcnt(7)
  v_mfma_f32_16x16x32_bf16 v[48:51], a[160:163], v[160:163], v[48:51]
  buffer_load_dwordx4 v[128:131], v2, s[52:55], s37 offen offset:2048 sc1
  v_mfma_f32_16x16x32_bf16 v[52:55], a[164:167], v[160:163], v[52:55]
  v_mfma_f32_16x16x32_bf16 v[56:59], a[168:171], v[160:163], v[56:59]
  v_mfma_f32_16x16x32_bf16 v[60:63], a[172:175], v[160:163], v[60:63]
  v_mfma_f32_16x16x32_bf16 v[64:67], a[176:179], v[160:163], v[64:67]
  s_waitcnt vmcnt(7)
  v_mfma_f32_16x16x32_bf16 v[48:51], a[180:183], v[164:167], v[48:51]
  buffer_load_dwordx4 v[132:135], v2, s[52:55], s37 offen offset:3072 sc1
  v_mfma_f32_16x16x32_bf16 v[52:55], a[184:187], v[164:167], v[52:55]
  v_mfma_f32_16x16x32_bf16 v[56:59], a[188:191], v[164:167], v[56:59]
  v_mfma_f32_16x16x32_bf16 v[60:63], a[192:195], v[164:167], v[60:63]
  v_mfma_f32_16x16x32_bf16 v[64:67], a[196:199], v[164:167], v[64:67]
  s_waitcnt vmcnt(7)
  v_mfma_f32_16x16x32_bf16 v[68:71], a[0:3], v[168:171], 0
  s_add_u32 s37, s37, 4096
  buffer_load_dwordx4 v[136:139], v2, s[52:55], s37 offen offset:0 sc1
  v_mfma_f32_16x16x32_bf16 v[72:75], a[4:7], v[168:171], 0
  v_mfma_f32_16x16x32_bf16 v[76:79], a[8:11], v[168:171], 0
  v_mfma_f32_16x16x32_bf16 v[80:83], a[12:15], v[168:171], 0
  v_mfma_f32_16x16x32_bf16 v[84:87], a[16:19], v[168:171], 0
  s_waitcnt vmcnt(7)
  v_mfma_f32_16x16x32_bf16 v[68:71], a[20:23], v[172:175], v[68:71]
  ds_write_b128 v44, v[48:51] offset:0
  buffer_load_dwordx4 v[140:143], v2, s[52:55], s37 offen offset:1024 sc1
  v_mfma_f32_16x16x32_bf16 v[72:75], a[24:27], v[172:175], v[72:75]
  ds_write_b128 v44, v[52:55] offset:1024
  v_mfma_f32_16x16x32_bf16 v[76:79], a[28:31], v[172:175], v[76:79]
  ds_write_b128 v44, v[56:59] offset:2048
  v_mfma_f32_16x16x32_bf16 v[80:83], a[32:35], v[172:175], v[80:83]
  ds_write_b128 v44, v[60:63] offset:3072
  v_mfma_f32_16x16x32_bf16 v[84:87], a[36:39], v[172:175], v[84:87]
  ds_write_b128 v44, v[64:67] offset:4096
  s_waitcnt vmcnt(7)
  v_mfma_f32_16x16x32_bf16 v[68:71], a[40:43], v[176:179], v[68:71]
  buffer_load_dwordx4 v[144:147], v2, s[52:55], s38 offen offset:0 sc1
  v_mfma_f32_16x16x32_bf16 v[72:75], a[44:47], v[176:179], v[72:75]
  v_mfma_f32_16x16x32_bf16 v[76:79], a[48:51], v[176:179], v[76:79]
  v_mfma_f32_16x16x32_bf16 v[80:83], a[52:55], v[176:179], v[80:83]
  v_mfma_f32_16x16x32_bf16 v[84:87], a[56:59], v[176:179], v[84:87]
  s_waitcnt vmcnt(7)
  v_mfma_f32_16x16x32_bf16 v[68:71], a[60:63], v[180:183], v[68:71]
  buffer_load_dwordx4 v[148:151], v2, s[52:55], s38 offen offset:1024 sc1
  v_mfma_f32_16x16x32_bf16 v[72:75], a[64:67], v[180:183], v[72:75]
  v_mfma_f32_16x16x32_bf16 v[76:79], a[68:71], v[180:183], v[76:79]
  v_mfma_f32_16x16x32_bf16 v[80:83], a[72:75], v[180:183], v[80:83]
  v_mfma_f32_16x16x32_bf16 v[84:87], a[76:79], v[180:183], v[84:87]
  s_waitcnt vmcnt(7)
  v_mfma_f32_16x16x32_bf16 v[68:71], a[80:83], v[184:187], v[68:71]
  buffer_load_dwordx4 v[152:155], v2, s[52:55], s38 offen offset:2048 sc1
  v_mfma_f32_16x16x32_bf16 v[72:75], a[84:87], v[184:187], v[72:75]
  v_mfma_f32_16x16x32_bf16 v[76:79], a[88:91], v[184:187], v[76:79]
  v_mfma_f32_16x16x32_bf16 v[80:83], a[92:95], v[184:187], v[80:83]
  v_mfma_f32_16x16x32_bf16 v[84:87], a[96:99], v[184:187], v[84:87]
  s_waitcnt vmcnt(7)
  v_mfma_f32_16x16x32_bf16 v[68:71], a[100:103], v[188:191], v[68:71]
  buffer_load_dwordx4 v[156:159], v2, s[52:55], s38 offen offset:3072 sc1
  v_mfma_f32_16x16x32_bf16 v[72:75], a[104:107], v[188:191], v[72:75]
  v_mfma_f32_16x16x32_bf16 v[76:79], a[108:111], v[188:191], v[76:79]
  v_mfma_f32_16x16x32_bf16 v[80:83], a[112:115], v[188:191], v[80:83]
  v_mfma_f32_16x16x32_bf16 v[84:87], a[116:119], v[188:191], v[84:87]
  s_waitcnt vmcnt(7)
  v_mfma_f32_16x16x32_bf16 v[68:71], a[120:123], v[128:131], v[68:71]
  s_add_u32 s38, s38, 4096
  buffer_load_dwordx4 v[160:163], v2, s[52:55], s38 offen offset:0 sc1
  v_mfma_f32_16x16x32_bf16 v[72:75], a[124:127], v[128:131], v[72:75]
  s_and_b32 s13, s17, 0xe00
  s_add_u32 s13, s13, 24576
  buffer_load_dwordx4 v[200:203], v204, s[52:55], s13 offen sc1
  v_mfma_f32_16x16x32_bf16 v[76:79], a[128:131], v[128:131], v[76:79]
  v_mfma_f32_16x16x32_bf16 v[80:83], a[132:135], v[128:131], v[80:83]
  v_mfma_f32_16x16x32_bf16 v[84:87], a[136:139], v[128:131], v[84:87]
  s_waitcnt vmcnt(8)
  v_mfma_f32_16x16x32_bf16 v[68:71], a[140:143], v[132:135], v[68:71]
  buffer_load_dwordx4 v[164:167], v2, s[52:55], s38 offen offset:1024 sc1
  v_mfma_f32_16x16x32_bf16 v[72:75], a[144:147], v[132:135], v[72:75]
  v_mfma_f32_16x16x32_bf16 v[76:79], a[148:151], v[132:135], v[76:79]
  v_mfma_f32_16x16x32_bf16 v[80:83], a[152:155], v[132:135], v[80:83]
  v_mfma_f32_16x16x32_bf16 v[84:87], a[156:159], v[132:135], v[84:87]
  s_waitcnt vmcnt(8)
  v_mfma_f32_16x16x32_bf16 v[68:71], a[160:163], v[136:139], v[68:71]
  buffer_load_dwordx4 v[168:171], v2, s[52:55], s38 offen offset:2048 sc1
  v_mfma_f32_16x16x32_bf16 v[72:75], a[164:167], v[136:139], v[72:75]
  v_mfma_f32_16x16x32_bf16 v[76:79], a[168:171], v[136:139], v[76:79]
  v_mfma_f32_16x16x32_bf16 v[80:83], a[172:175], v[136:139], v[80:83]
  v_mfma_f32_16x16x32_bf16 v[84:87], a[176:179], v[136:139], v[84:87]
  s_waitcnt vmcnt(8)
  v_mfma_f32_16x16x32_bf16 v[68:71], a[180:183], v[140:143], v[68:71]
  buffer_load_dwordx4 v[172:175], v2, s[52:55], s38 offen offset:3072 sc1
  v_mfma_f32_16x16x32_bf16 v[72:75], a[184:187], v[140:143], v[72:75]
  v_mfma_f32_16x16x32_bf16 v[76:79], a[188:191], v[140:143], v[76:79]
  v_mfma_f32_16x16x32_bf16 v[80:83], a[192:195], v[140:143], v[80:83]
  v_mfma_f32_16x16x32_bf16 v[84:87], a[196:199], v[140:143], v[84:87]
  s_waitcnt vmcnt(8)
  v_mfma_f32_16x16x32_bf16 v[48:51], a[0:3], v[144:147], 0
  s_add_u32 s38, s38, 4096
  buffer_load_dwordx4 v[176:179], v2, s[52:55], s38 offen offset:0 sc1
  v_mfma_f32_16x16x32_bf16 v[52:55], a[4:7], v[144:147], 0
  v_mfma_f32_16x16x32_bf16 v[56:59], a[8:11], v[144:147], 0
  v_mfma_f32_16x16x32_bf16 v[60:63], a[12:15], v[144:147], 0
  v_mfma_f32_16x16x32_bf16 v[64:67], a[16:19], v[144:147], 0
  s_waitcnt vmcnt(8)
  v_mfma_f32_16x16x32_bf16 v[48:51], a[20:23], v[148:151], v[48:51]
  ds_write_b128 v45, v[68:71] offset:0
  buffer_load_dwordx4 v[180:183], v2, s[52:55], s38 offen offset:1024 sc1
  v_mfma_f32_16x16x32_bf16 v[52:55], a[24:27], v[148:151], v[52:55]
  ds_write_b128 v45, v[72:75] offset:1024
  v_mfma_f32_16x16x32_bf16 v[56:59], a[28:31], v[148:151], v[56:59]
  ds_write_b128 v45, v[76:79] offset:2048
  v_mfma_f32_16x16x32_bf16 v[60:63], a[32:35], v[148:151], v[60:63]
  ds_write_b128 v45, v[80:83] offset:3072
  v_mfma_f32_16x16x32_bf16 v[64:67], a[36:39], v[148:151], v[64:67]
  ds_write_b128 v45, v[84:87] offset:4096
  s_waitcnt vmcnt(8)
  v_mfma_f32_16x16x32_bf16 v[48:51], a[40:43], v[152:155], v[48:51]
  buffer_load_dwordx4 v[184:187], v2, s[52:55], s39 offen offset:0 sc1
  v_mfma_f32_16x16x32_bf16 v[52:55], a[44:47], v[152:155], v[52:55]
  v_mfma_f32_16x16x32_bf16 v[56:59], a[48:51], v[152:155], v[56:59]
  v_mfma_f32_16x16x32_bf16 v[60:63], a[52:55], v[152:155], v[60:63]
  v_mfma_f32_16x16x32_bf16 v[64:67], a[56:59], v[152:155], v[64:67]
  s_waitcnt vmcnt(8)
  v_mfma_f32_16x16x32_bf16 v[48:51], a[60:63], v[156:159], v[48:51]
  buffer_load_dwordx4 v[188:191], v2, s[52:55], s39 offen offset:1024 sc1
  v_mfma_f32_16x16x32_bf16 v[52:55], a[64:67], v[156:159], v[52:55]
  v_mfma_f32_16x16x32_bf16 v[56:59], a[68:71], v[156:159], v[56:59]
  v_mfma_f32_16x16x32_bf16 v[60:63], a[72:75], v[156:159], v[60:63]
  v_mfma_f32_16x16x32_bf16 v[64:67], a[76:79], v[156:159], v[64:67]
  s_waitcnt vmcnt(8)
  v_mfma_f32_16x16x32_bf16 v[48:51], a[80:83], v[160:163], v[48:51]
  buffer_load_dwordx4 v[128:131], v2, s[52:55], s39 offen offset:2048 sc1
  v_mfma_f32_16x16x32_bf16 v[52:55], a[84:87], v[160:163], v[52:55]
  v_mfma_f32_16x16x32_bf16 v[56:59], a[88:91], v[160:163], v[56:59]
  v_mfma_f32_16x16x32_bf16 v[60:63], a[92:95], v[160:163], v[60:63]
  v_mfma_f32_16x16x32_bf16 v[64:67], a[96:99], v[160:163], v[64:67]
  s_waitcnt vmcnt(7)
  v_mfma_f32_16x16x32_bf16 v[48:51], a[100:103], v[164:167], v[48:51]
  buffer_load_dwordx4 v[132:135], v2, s[52:55], s39 offen offset:3072 sc1
  v_mfma_f32_16x16x32_bf16 v[52:55], a[104:107], v[164:167], v[52:55]
  v_mfma_f32_16x16x32_bf16 v[56:59], a[108:111], v[164:167], v[56:59]
  v_mfma_f32_16x16x32_bf16 v[60:63], a[112:115], v[164:167], v[60:63]
  v_mfma_f32_16x16x32_bf16 v[64:67], a[116:119], v[164:167], v[64:67]
  s_waitcnt vmcnt(7)
  v_mfma_f32_16x16x32_bf16 v[48:51], a[120:123], v[168:171], v[48:51]
  s_add_u32 s39, s39, 4096
  buffer_load_dwordx4 v[136:139], v2, s[52:55], s39 offen offset:0 sc1
  v_mfma_f32_16x16x32_bf16 v[52:55], a[124:127], v[168:171], v[52:55]
  v_mfma_f32_16x16x32_bf16 v[56:59], a[128:131], v[168:171], v[56:59]
  v_mfma_f32_16x16x32_bf16 v[60:63], a[132:135], v[168:171], v[60:63]
  v_mfma_f32_16x16x32_bf16 v[64:67], a[136:139], v[168:171], v[64:67]
  s_waitcnt vmcnt(7)
  v_mfma_f32_16x16x32_bf16 v[48:51], a[140:143], v[172:175], v[48:51]
  buffer_load_dwordx4 v[140:143], v2, s[52:55], s39 offen offset:1024 sc1
  v_mfma_f32_16x16x32_bf16 v[52:55], a[144:147], v[172:175], v[52:55]
  v_mfma_f32_16x16x32_bf16 v[56:59], a[148:151], v[172:175], v[56:59]
  v_mfma_f32_16x16x32_bf16 v[60:63], a[152:155], v[172:175], v[60:63]
  v_mfma_f32_16x16x32_bf16 v[64:67], a[156:159], v[172:175], v[64:67]
  s_waitcnt vmcnt(7)
  v_mfma_f32_16x16x32_bf16 v[48:51], a[160:163], v[176:179], v[48:51]
  buffer_load_dwordx4 v[144:147], v2, s[52:55], s39 offen offset:2048 sc1
  v_mfma_f32_16x16x32_bf16 v[52:55], a[164:167], v[176:179], v[52:55]
  v_mfma_f32_16x16x32_bf16 v[56:59], a[168:171], v[176:179], v[56:59]
  v_mfma_f32_16x16x32_bf16 v[60:63], a[172:175], v[176:179], v[60:63]
  v_mfma_f32_16x16x32_bf16 v[64:67], a[176:179], v[176:179], v[64:67]
  s_waitcnt vmcnt(7)
  v_mfma_f32_16x16x32_bf16 v[48:51], a[180:183], v[180:183], v[48:51]
  buffer_load_dwordx4 v[148:151], v2, s[52:55], s39 offen offset:3072 sc1
  v_mfma_f32_16x16x32_bf16 v[52:55], a[184:187], v[180:183], v[52:55]
  v_mfma_f32_16x16x32_bf16 v[56:59], a[188:191], v[180:183], v[56:59]
  v_mfma_f32_16x16x32_bf16 v[60:63], a[192:195], v[180:183], v[60:63]
  v_mfma_f32_16x16x32_bf16 v[64:67], a[196:199], v[180:183], v[64:67]
  s_waitcnt vmcnt(7)
  v_mfma_f32_16x16x32_bf16 v[68:71], a[0:3], v[184:187], v[108:111]
  s_add_u32 s39, s39, 4096
  buffer_load_dwordx4 v[152:155], v2, s[52:55], s39 offen offset:0 sc1
  v_mfma_f32_16x16x32_bf16 v[72:75], a[4:7], v[184:187], v[112:115]
  s_mul_i32 s15, s7, 15360
  v_mfma_f32_16x16x32_bf16 v[76:79], a[8:11], v[184:187], v[116:119]
  s_add_u32 s15, s15, 102400
  v_mfma_f32_16x16x32_bf16 v[80:83], a[12:15], v[184:187], v[120:123]
  v_add_u32_e64 v47, s15, v2
  v_mfma_f32_16x16x32_bf16 v[84:87], a[16:19], v[184:187], v[124:127]
  s_waitcnt vmcnt(7)
  v_mfma_f32_16x16x32_bf16 v[68:71], a[20:23], v[188:191], v[68:71]
  ds_write_b128 v46, v[48:51] offset:0
  buffer_load_dwordx4 v[156:159], v2, s[52:55], s39 offen offset:1024 sc1
  v_mfma_f32_16x16x32_bf16 v[72:75], a[24:27], v[188:191], v[72:75]
  ds_write_b128 v46, v[52:55] offset:1024
  v_mfma_f32_16x16x32_bf16 v[76:79], a[28:31], v[188:191], v[76:79]
  ds_write_b128 v46, v[56:59] offset:2048
  v_mfma_f32_16x16x32_bf16 v[80:83], a[32:35], v[188:191], v[80:83]
  ds_write_b128 v46, v[60:63] offset:3072
  v_mfma_f32_16x16x32_bf16 v[84:87], a[36:39], v[188:191], v[84:87]
  ds_write_b128 v46, v[64:67] offset:4096
  s_waitcnt vmcnt(7)
  v_mfma_f32_16x16x32_bf16 v[68:71], a[40:43], v[128:131], v[68:71]
  s_waitcnt vmcnt(15)
  v_xor_b32 v15, s8, v200
  v_xor_b32 v14, s8, v201
  v_or_b32 v15, v15, v14
  v_xor_b32 v14, s8, v202
  v_or_b32 v15, v15, v14
  v_xor_b32 v14, s8, v203
  v_or_b32 v15, v15, v14
  v_cmp_ne_u32 vcc, 0, v15
  s_cbranch_vccnz again_41
ok_42:
  v_mfma_f32_16x16x32_bf16 v[72:75], a[44:47], v[128:131], v[72:75]
  s_add_u32 m0, s25, 0
  s_nop 0
  buffer_load_dwordx4 v205, s[52:55], s24 offen sc1 lds
  s_add_u32 s24, s24, 65536
  v_mfma_f32_16x16x32_bf16 v[76:79], a[48:51], v[128:131], v[76:79]
  s_add_u32 m0, s25, 1024
  s_nop 0
  buffer_load_dwordx4 v205, s[52:55], s24 offen sc1 lds
  s_add_u32 s24, s24, 65536
  v_mfma_f32_16x16x32_bf16 v[80:83], a[52:55], v[128:131], v[80:83]
  s_add_u32 m0, s25, 2048
  s_nop 0
  buffer_load_dwordx4 v205, s[52:55], s24 offen sc1 lds
  s_add_u32 s24, s24, 65536
  v_mfma_f32_16x16x32_bf16 v[84:87], a[56:59], v[128:131], v[84:87]
  s_waitcnt vmcnt(9)
  v_mfma_f32_16x16x32_bf16 v[68:71], a[60:63], v[132:135], v[68:71]
  s_add_u32 m0, s25, 3072
  s_nop 0
  buffer_load_dwordx4 v205, s[52:55], s24 offen sc1 lds
  s_add_u32 s24, s24, 65536
  v_mfma_f32_16x16x32_bf16 v[72:75], a[64:67], v[132:135], v[72:75]
  s_add_u32 m0, s25, 4096
  s_nop 0
  buffer_load_dwordx4 v205, s[52:55], s24 offen sc1 lds
  s_add_u32 s24, s24, 65536
  v_mfma_f32_16x16x32_bf16 v[76:79], a[68:71], v[132:135], v[76:79]
  v_mfma_f32_16x16x32_bf16 v[80:83], a[72:75], v[132:135], v[80:83]
  v_mfma_f32_16x16x32_bf16 v[84:87], a[76:79], v[132:135], v[84:87]
  s_waitcnt vmcnt(10)
  v_mfma_f32_16x16x32_bf16 v[68:71], a[80:83], v[136:139], v[68:71]
  s_and_b32 s12, s7, 1
  s_lshl_b32 s12, s12, 3
  s_add_u32 s12, s12, s25
  v_mfma_f32_16x16x32_bf16 v[72:75], a[84:87], v[136:139], v[72:75]
  v_add_u32 v205, s12, v2
  s_waitcnt lgkmcnt(0)
  v_mfma_f32_16x16x32_bf16 v[76:79], a[88:91], v[136:139], v[76:79]
  s_barrier
  ds_read_b128 v[206:209], v47 offset:0
  v_mfma_f32_16x16x32_bf16 v[80:83], a[92:95], v[136:139], v[80:83]
  ds_read_b128 v[210:213], v47 offset:1024
  ds_read_b128 v[214:217], v47 offset:2048
  v_mfma_f32_16x16x32_bf16 v[84:87], a[96:99], v[136:139], v[84:87]
  ds_read_b128 v[218:221], v47 offset:3072
  ds_read_b128 v[222:225], v47 offset:4096
  s_waitcnt vmcnt(9)
  v_mfma_f32_16x16x32_bf16 v[68:71], a[100:103], v[140:143], v[68:71]
  ds_read_b128 v[160:163], v47 offset:5120
  ds_read_b128 v[164:167], v47 offset:6144
  v_mfma_f32_16x16x32_bf16 v[72:75], a[104:107], v[140:143], v[72:75]
  ds_read_b128 v[168:171], v47 offset:7168
  ds_read_b128 v[172:175], v47 offset:8192
  v_mfma_f32_16x16x32_bf16 v[76:79], a[108:111], v[140:143], v[76:79]
  ds_read_b128 v[176:179], v47 offset:9216
  v_mfma_f32_16x16x32_bf16 v[80:83], a[112:115], v[140:143], v[80:83]
  s_waitcnt lgkmcnt(0)
  v_mfma_f32_16x16x32_bf16 v[84:87], a[116:119], v[140:143], v[84:87]
  v_pk_add_f32 v[206:207], v[206:207], v[160:161]
  s_waitcnt vmcnt(8)
  v_mfma_f32_16x16x32_bf16 v[68:71], a[120:123], v[144:147], v[68:71]
  v_pk_add_f32 v[208:209], v[208:209], v[162:163]
  v_pk_add_f32 v[210:211], v[210:211], v[164:165]
  v_mfma_f32_16x16x32_bf16 v[72:75], a[124:127], v[144:147], v[72:75]
  v_pk_add_f32 v[212:213], v[212:213], v[166:167]
  v_pk_add_f32 v[214:215], v[214:215], v[168:169]
  v_mfma_f32_16x16x32_bf16 v[76:79], a[128:131], v[144:147], v[76:79]
  v_pk_add_f32 v[216:217], v[216:217], v[170:171]
  v_mfma_f32_16x16x32_bf16 v[80:83], a[132:135], v[144:147], v[80:83]
  v_pk_add_f32 v[218:219], v[218:219], v[172:173]
  v_mfma_f32_16x16x32_bf16 v[84:87], a[136:139], v[144:147], v[84:87]
  v_pk_add_f32 v[220:221], v[220:221], v[174:175]
  s_waitcnt vmcnt(7)
  v_mfma_f32_16x16x32_bf16 v[68:71], a[140:143], v[148:151], v[68:71]
  v_pk_add_f32 v[222:223], v[222:223], v[176:177]
  v_pk_add_f32 v[224:225], v[224:225], v[178:179]
  v_mfma_f32_16x16x32_bf16 v[72:75], a[144:147], v[148:151], v[72:75]
  ds_read_b128 v[160:163], v47 offset:10240
  ds_read_b128 v[164:167], v47 offset:11264
  v_mfma_f32_16x16x32_bf16 v[76:79], a[148:151], v[148:151], v[76:79]
  ds_read_b128 v[168:171], v47 offset:12288
  v_mfma_f32_16x16x32_bf16 v[80:83], a[152:155], v[148:151], v[80:83]
  ds_read_b128 v[172:175], v47 offset:13312
  v_mfma_f32_16x16x32_bf16 v[84:87], a[156:159], v[148:151], v[84:87]
  ds_read_b128 v[176:179], v47 offset:14336
  s_waitcnt vmcnt(6)
  v_mfma_f32_16x16x32_bf16 v[68:71], a[160:163], v[152:155], v[68:71]
  s_waitcnt lgkmcnt(0)
  v_pk_add_f32 v[206:207], v[206:207], v[160:161]
  v_mfma_f32_16x16x32_bf16 v[72:75], a[164:167], v[152:155], v[72:75]
  v_pk_add_f32 v[208:209], v[208:209], v[162:163]
  v_pk_add_f32 v[210:211], v[210:211], v[164:165]
  v_mfma_f32_16x16x32_bf16 v[76:79], a[168:171], v[152:155], v[76:79]
  v_pk_add_f32 v[212:213], v[212:213], v[166:167]
  v_mfma_f32_16x16x32_bf16 v[80:83], a[172:175], v[152:155], v[80:83]
  v_pk_add_f32 v[214:215], v[214:215], v[168:169]
  v_mfma_f32_16x16x32_bf16 v[84:87], a[176:179], v[152:155], v[84:87]
  v_pk_add_f32 v[216:217], v[216:217], v[170:171]
  s_waitcnt vmcnt(5)
  v_mfma_f32_16x16x32_bf16 v[68:71], a[180:183], v[156:159], v[68:71]
  v_pk_add_f32 v[218:219], v[218:219], v[172:173]
  v_mfma_f32_16x16x32_bf16 v[72:75], a[184:187], v[156:159], v[72:75]
  v_pk_add_f32 v[220:221], v[220:221], v[174:175]
  v_mfma_f32_16x16x32_bf16 v[76:79], a[188:191], v[156:159], v[76:79]
  v_pk_add_f32 v[222:223], v[222:223], v[176:177]
  v_mfma_f32_16x16x32_bf16 v[80:83], a[192:195], v[156:159], v[80:83]
  v_pk_add_f32 v[224:225], v[224:225], v[178:179]
  v_mfma_f32_16x16x32_bf16 v[84:87], a[196:199], v[156:159], v[84:87]
  v_pk_add_f32 v[68:69], v[68:69], v[206:207]
  v_pk_add_f32 v[70:71], v[70:71], v[208:209]
  v_pk_add_f32 v[72:73], v[72:73], v[210:211]
  v_pk_add_f32 v[74:75], v[74:75], v[212:213]
  v_pk_add_f32 v[76:77], v[76:77], v[214:215]
  v_pk_add_f32 v[78:79], v[78:79], v[216:217]
  v_pk_add_f32 v[80:81], v[80:81], v[218:219]
  v_pk_add_f32 v[82:83], v[82:83], v[220:221]
  v_pk_add_f32 v[84:85], v[84:85], v[222:223]
  v_pk_add_f32 v[86:87], v[86:87], v[224:225]
  s_lshl_b32 s12, s5, 15
  s_lshl_b32 s13, s7, 10
  s_add_u32 s12, s12, s13
  s_add_u32 s12, s12, 1310720
  s_lshl_b32 s13, s6, 12
  s_add_u32 s13, s13, s12
  v_pk_add_f32 v[228:229], v[68:69], v[70:71]
  v_pk_mul_f32 v[230:231], v[68:69], v[68:69]
  v_pk_fma_f32 v[230:231], v[70:71], v[70:71], v[230:231]
  v_pk_add_f32 v[228:229], v[228:229], v[72:73]
  v_pk_fma_f32 v[230:231], v[72:73], v[72:73], v[230:231]
  v_pk_add_f32 v[228:229], v[228:229], v[74:75]
  v_pk_fma_f32 v[230:231], v[74:75], v[74:75], v[230:231]
  v_pk_add_f32 v[228:229], v[228:229], v[76:77]
  v_pk_fma_f32 v[230:231], v[76:77], v[76:77], v[230:231]
  v_pk_add_f32 v[228:229], v[228:229], v[78:79]
  v_pk_fma_f32 v[230:231], v[78:79], v[78:79], v[230:231]
  v_pk_add_f32 v[228:229], v[228:229], v[80:81]
  v_pk_fma_f32 v[230:231], v[80:81], v[80:81], v[230:231]
  v_pk_add_f32 v[228:229], v[228:229], v[82:83]
  v_pk_fma_f32 v[230:231], v[82:83], v[82:83], v[230:231]
  v_pk_add_f32 v[228:229], v[228:229], v[84:85]
  v_pk_fma_f32 v[230:231], v[84:85], v[84:85], v[230:231]
  v_pk_add_f32 v[228:229], v[228:229], v[86:87]
  v_pk_fma_f32 v[230:231], v[86:87], v[86:87], v[230:231]
  s_waitcnt vmcnt(0)
  ds_read_b64_tr_b16 v[246:247], v205 offset:0
  ds_read_b64_tr_b16 v[248:249], v205 offset:1024
  ds_read_b64_tr_b16 v[250:251], v205 offset:2048
  ds_read_b64_tr_b16 v[252:253], v205 offset:3072
  ds_read_b64_tr_b16 v[254:255], v205 offset:4096
  s_waitcnt lgkmcnt(4)
  v_lshlrev_b32_e64 v88, 16, v246
  v_and_b32 v89, 0xffff0000, v246
  v_lshlrev_b32_e64 v90, 16, v247
  v_and_b32 v91, 0xffff0000, v247
  v_pk_mul_f32 v[160:161], v[68:69], v[88:89]
  v_pk_mul_f32 v[242:243], v[88:89], v[88:89]
  v_pk_mul_f32 v[234:235], v[160:161], v[68:69]
  v_pk_mul_f32 v[236:237], v[160:161], v[160:161]
  v_pk_mul_f32 v[238:239], v[160:161], v[88:89]
  v_pk_mul_f32 v[162:163], v[70:71], v[90:91]
  v_pk_add_f32 v[240:241], v[88:89], v[90:91]
  v_pk_fma_f32 v[242:243], v[90:91], v[90:91], v[242:243]
  v_pk_add_f32 v[232:233], v[160:161], v[162:163]
  v_pk_fma_f32 v[234:235], v[162:163], v[70:71], v[234:235]
  v_pk_fma_f32 v[236:237], v[162:163], v[162:163], v[236:237]
  v_pk_fma_f32 v[238:239], v[162:163], v[90:91], v[238:239]
  s_waitcnt lgkmcnt(0)
  v_lshlrev_b32 v92, 16, v248
  v_and_b32 v93, 0xffff0000, v248
  v_lshlrev_b32_e64 v94, 16, v249
  v_and_b32 v95, 0xffff0000, v249
  s_add_u32 m0, s23, 0
  s_nop 0
  buffer_load_dwordx4 v244, s[56:59], s20 offen lds
  v_pk_mul_f32 v[164:165], v[72:73], v[92:93]
  v_pk_add_f32 v[240:241], v[240:241], v[92:93]
  v_pk_fma_f32 v[242:243], v[92:93], v[92:93], v[242:243]
  v_pk_add_f32 v[232:233], v[232:233], v[164:165]
  v_pk_fma_f32 v[234:235], v[164:165], v[72:73], v[234:235]
  v_pk_fma_f32 v[236:237], v[164:165], v[164:165], v[236:237]
  v_pk_fma_f32 v[238:239], v[164:165], v[92:93], v[238:239]
  s_add_u32 m0, s23, 1024
  s_nop 0
  buffer_load_dwordx4 v245, s[60:63], s20 offen lds
  v_pk_mul_f32 v[166:167], v[74:75], v[94:95]
  v_pk_add_f32 v[240:241], v[240:241], v[94:95]
  v_pk_fma_f32 v[242:243], v[94:95], v[94:95], v[242:243]
  v_pk_add_f32 v[232:233], v[232:233], v[166:167]
  v_pk_fma_f32 v[234:235], v[166:167], v[74:75], v[234:235]
  v_pk_fma_f32 v[236:237], v[166:167], v[166:167], v[236:237]
  v_pk_fma_f32 v[238:239], v[166:167], v[94:95], v[238:239]
  s_waitcnt lgkmcnt(0)
  v_lshlrev_b32_e64 v96, 16, v250
  v_and_b32 v97, 0xffff0000, v250
  v_lshlrev_b32_e64 v98, 16, v251
  v_and_b32 v99, 0xffff0000, v251
  s_add_u32 m0, s23, 2048
  s_nop 0
  buffer_load_dwordx4 v244, s[56:59], s21 offen lds
  v_pk_mul_f32 v[168:169], v[76:77], v[96:97]
  v_pk_add_f32 v[240:241], v[240:241], v[96:97]
  v_pk_fma_f32 v[242:243], v[96:97], v[96:97], v[242:243]
  v_pk_add_f32 v[232:233], v[232:233], v[168:169]
  v_pk_fma_f32 v[234:235], v[168:169], v[76:77], v[234:235]
  v_pk_fma_f32 v[236:237], v[168:169], v[168:169], v[236:237]
  v_pk_fma_f32 v[238:239], v[168:169], v[96:97], v[238:239]
  s_add_u32 m0, s23, 3072
  s_nop 0
  buffer_load_dwordx4 v245, s[60:63], s21 offen lds
  v_pk_mul_f32 v[170:171], v[78:79], v[98:99]
  v_pk_add_f32 v[240:241], v[240:241], v[98:99]
  v_pk_fma_f32 v[242:243], v[98:99], v[98:99], v[242:243]
  v_pk_add_f32 v[232:233], v[232:233], v[170:171]
  v_pk_fma_f32 v[234:235], v[170:171], v[78:79], v[234:235]
  v_pk_fma_f32 v[236:237], v[170:171], v[170:171], v[236:237]
  v_pk_fma_f32 v[238:239], v[170:171], v[98:99], v[238:239]
  s_waitcnt lgkmcnt(0)
  v_lshlrev_b32 v100, 16, v252
  v_and_b32 v101, 0xffff0000, v252
  v_lshlrev_b32_e64 v102, 16, v253
  v_and_b32 v103, 0xffff0000, v253
  s_add_u32 m0, s23, 4096
  s_nop 0
  buffer_load_dwordx4 v244, s[56:59], s22 offen lds
  v_pk_mul_f32 v[172:173], v[80:81], v[100:101]
  v_pk_add_f32 v[240:241], v[240:241], v[100:101]
  v_pk_fma_f32 v[242:243], v[100:101], v[100:101], v[242:243]
  v_pk_add_f32 v[232:233], v[232:233], v[172:173]
  v_pk_fma_f32 v[234:235], v[172:173], v[80:81], v[234:235]
  v_pk_fma_f32 v[236:237], v[172:173], v[172:173], v[236:237]
  v_pk_fma_f32 v[238:239], v[172:173], v[100:101], v[238:239]
  s_add_u32 m0, s23, 5120
  s_nop 0
  buffer_load_dwordx4 v245, s[60:63], s22 offen lds
  v_pk_mul_f32 v[174:175], v[82:83], v[102:103]
  v_pk_add_f32 v[240:241], v[240:241], v[102:103]
  v_pk_fma_f32 v[242:243], v[102:103], v[102:103], v[242:243]
  v_pk_add_f32 v[232:233], v[232:233], v[174:175]
  v_pk_fma_f32 v[234:235], v[174:175], v[82:83], v[234:235]
  v_pk_fma_f32 v[236:237], v[174:175], v[174:175], v[236:237]
  v_pk_fma_f32 v[238:239], v[174:175], v[102:103], v[238:239]
  s_waitcnt lgkmcnt(0)
  v_lshlrev_b32 v104, 16, v254
  v_and_b32 v105, 0xffff0000, v254
  v_lshlrev_b32_e64 v106, 16, v255
  v_and_b32 v107, 0xffff0000, v255
  v_pk_mul_f32 v[176:177], v[84:85], v[104:105]
  v_pk_add_f32 v[240:241], v[240:241], v[104:105]
  v_pk_fma_f32 v[242:243], v[104:105], v[104:105], v[242:243]
  v_pk_add_f32 v[232:233], v[232:233], v[176:177]
  v_pk_fma_f32 v[234:235], v[176:177], v[84:85], v[234:235]
  v_pk_fma_f32 v[236:237], v[176:177], v[176:177], v[236:237]
  v_pk_fma_f32 v[238:239], v[176:177], v[104:105], v[238:239]
  v_pk_mul_f32 v[178:179], v[86:87], v[106:107]
  v_pk_add_f32 v[240:241], v[240:241], v[106:107]
  v_pk_fma_f32 v[242:243], v[106:107], v[106:107], v[242:243]
  v_pk_add_f32 v[232:233], v[232:233], v[178:179]
  v_pk_fma_f32 v[234:235], v[178:179], v[86:87], v[234:235]
  v_pk_fma_f32 v[236:237], v[178:179], v[178:179], v[236:237]
  v_pk_fma_f32 v[238:239], v[178:179], v[106:107], v[238:239]
  v_add_f32 v228, v228, v229
  v_add_f32 v230, v230, v231
  v_add_f32 v232, v232, v233
  v_add_f32 v234, v234, v235
  v_add_f32 v236, v236, v237
  v_add_f32 v238, v238, v239
  v_add_f32 v240, v240, v241
  v_add_f32 v242, v242, v243
  v_permlane16_swap_b32 v228, v236
  v_permlane16_swap_b32 v230, v238
  v_permlane16_swap_b32 v232, v240
  v_permlane16_swap_b32 v234, v242
  v_add_f32 v216, v228, v236
  v_add_f32 v217, v230, v238
  v_add_f32 v218, v232, v240
  v_add_f32 v219, v234, v242
  v_mov_b32 v228, v216
  v_mov_b32 v229, v217
  v_mov_b32 v230, v218
  v_mov_b32 v231, v219
  v_permlane32_swap_b32 v216, v228
  v_permlane32_swap_b32 v217, v229
  v_permlane32_swap_b32 v218, v230
  v_permlane32_swap_b32 v219, v231
  s_movk_i32 s14, 0xff
  v_add_f32 v216, v216, v228
  v_add_f32 v217, v217, v229
  v_add_f32 v218, v218, v230
  v_add_f32 v219, v219, v231
  s_lshr_b32 s15, s8, 0
  v_mov_b32_e64 v228, s15
  v_bfi_b32 v216, s14, v228, v216
  s_lshr_b32 s15, s8, 8
  v_mov_b32 v229, s15
  v_bfi_b32 v217, s14, v229, v217
  s_lshr_b32 s15, s8, 16
  v_mov_b32 v230, s15
  v_bfi_b32 v218, s14, v230, v218
  s_lshr_b32 s15, s8, 24
  v_mov_b32 v231, s15
  v_bfi_b32 v219, s14, v231, v219
  s_mov_b32 exec_hi, 0
  s_cmp_eq_u32 s9, 0
  s_cbranch_scc1 slow_43
  buffer_store_dwordx4 v[216:219], v2, s[52:55], s13 offen
back_44:
  s_mov_b32 exec_hi, -1
  v_accvgpr_write_b32 a208, v246
  v_accvgpr_write_b32 a209, v247
  v_accvgpr_write_b32 a210, v248
  v_accvgpr_write_b32 a211, v249
  v_accvgpr_write_b32 a212, v250
  v_accvgpr_write_b32 a213, v251
  v_accvgpr_write_b32 a214, v252
  v_accvgpr_write_b32 a215, v253
  v_accvgpr_write_b32 a216, v254
  v_accvgpr_write_b32 a217, v255
  v_lshrrev_b32_e64 v11, 2, v3
  v_mul_u32_u24 v11, 5120, v11
  v_and_b32_e64 v12, 3, v3
  v_lshl_add_u32 v11, v12, 4, v11
  v_lshrrev_b32_e64 v12, 1, v4
  v_lshl_add_u32 v11, v12, 6, v11
  v_and_b32_e64 v12, 1, v4
  v_lshl_add_u32 v47, v12, 3, v11
  s_lshl_b32 s96, s5, 2
  s_add_u32 s96, s96, s7
  s_mul_i32 s96, s96, 20480
  s_mul_i32 s14, s6, 640
  s_add_u32 s96, s96, s14
  v_accvgpr_read_b32 v190, a240
  v_accvgpr_read_b32 v191, a241
  v_accvgpr_read_b32 v192, a242
  v_accvgpr_read_b32 v193, a243
  v_accvgpr_read_b32 v194, a244
  v_accvgpr_read_b32 v195, a245
  v_accvgpr_read_b32 v196, a246
  v_accvgpr_read_b32 v197, a247
  v_accvgpr_read_b32 v198, a248
  v_accvgpr_read_b32 v199, a249
  v_lshlrev_b32 v108, 16, v190
  v_and_b32 v109, 0xffff0000, v190
  v_lshlrev_b32_e64 v110, 16, v191
  v_and_b32 v111, 0xffff0000, v191
  v_lshlrev_b32_e64 v112, 16, v192
  v_and_b32 v113, 0xffff0000, v192
  v_lshlrev_b32_e64 v114, 16, v193
  v_and_b32 v115, 0xffff0000, v193
  v_lshlrev_b32_e64 v116, 16, v194
  v_and_b32 v117, 0xffff0000, v194
  v_lshlrev_b32_e64 v118, 16, v195
  v_and_b32 v119, 0xffff0000, v195
  v_lshlrev_b32_e64 v120, 16, v196
  v_and_b32 v121, 0xffff0000, v196
  v_lshlrev_b32_e64 v122, 16, v197
  v_and_b32 v123, 0xffff0000, v197
  v_lshlrev_b32_e64 v124, 16, v198
  v_and_b32 v125, 0xffff0000, v198
  v_lshlrev_b32_e64 v126, 16, v199
  v_and_b32 v127, 0xffff0000, v199
  v_and_b32 v11, 31, v1
  v_lshlrev_b32 v11, 4, v11
  v_lshrrev_b32_e64 v12, 5, v1
  v_lshl_add_u32 v11, v12, 14, v11
  s_mov_b32 s14, 0x0c0c0400
  s_mov_b32 s15, 0x04000c0c
stpoll_45:
  s_add_u32 s13, s12, 0
  buffer_load_dwordx4 v[128:131], v11, s[52:55], s13 offen sc1
  s_add_u32 s13, s12, 4096
  buffer_load_dwordx4 v[132:135], v11, s[52:55], s13 offen sc1
  s_add_u32 s13, s12, 8192
  buffer_load_dwordx4 v[136:139], v11, s[52:55], s13 offen sc1
  s_add_u32 s13, s12, 12288
  buffer_load_dwordx4 v[140:143], v11, s[52:55], s13 offen sc1
  s_waitcnt vmcnt(0)
  v_perm_b32 v228, v129, v128, s14
  v_perm_b32 v229, v131, v130, s15
  v_perm_b32 v230, v133, v132, s14
  v_perm_b32 v231, v135, v134, s15
  v_perm_b32 v232, v137, v136, s14
  v_perm_b32 v233, v139, v138, s15
  v_perm_b32 v234, v141, v140, s14
  v_perm_b32 v235, v143, v142, s15
  v_or_b32 v228, v228, v229
  v_or_b32 v230, v230, v231
  v_or_b32 v232, v232, v233
  v_or_b32 v234, v234, v235
  v_min3_u32 v13, v228, v230, s8
  v_max3_u32 v14, v228, v230, s8
  v_min3_u32 v13, v13, v232, v234
  v_max3_u32 v14, v14, v232, v234
  v_cmp_ne_u32 vcc, v13, v14
  s_cbranch_vccnz retry_46
giveup_47:
  v_pk_add_f32 v[128:129], v[128:129], v[132:133]
  v_pk_add_f32 v[136:137], v[136:137], v[140:141]
  v_pk_add_f32 v[130:131], v[130:131], v[134:135]
  v_pk_add_f32 v[138:139], v[138:139], v[142:143]
  v_pk_add_f32 v[128:129], v[128:129], v[136:137]
  v_pk_add_f32 v[130:131], v[130:131], v[138:139]
  v_mov_b32 v132, v128
  v_mov_b32 v133, v129
  v_mov_b32 v134, v130
  v_mov_b32 v135, v131
  v_permlane32_swap_b32 v128, v132
  v_permlane32_swap_b32 v129, v133
  v_permlane32_swap_b32 v130, v134
  v_permlane32_swap_b32 v131, v135
  v_add_f32 v228, v128, v132
  v_add_f32 v229, v129, v133
  v_add_f32 v230, v130, v134
  v_add_f32 v231, v131, v135
  v_mov_b32 v232, v228
  v_mov_b32 v233, v229
  v_mov_b32 v234, v230
  v_mov_b32 v235, v231
  v_permlane16_swap_b32 v228, v232
  v_permlane16_swap_b32 v229, v233
  v_permlane16_swap_b32 v230, v234
  v_permlane16_swap_b32 v231, v235
  v_mul_f32 v208, 0x3acccccd, v228
  v_mul_f32 v212, 0x3acccccd, v229
  v_fma_f32 v212, -v208, v208, v212
  v_max_f32_e64 v212, 0, v212
  v_add_f32 v212, 0x3727c5ac, v212
  v_rsq_f32 v210, v212
  s_nop 0
  v_mul_f32_e64 v211, v208, v210
  v_fma_f32 v212, v210, v230, v228
  v_fma_f32 v212, -v211, v234, v212
  v_mul_f32_e64 v213, v210, v232
  v_fma_f32 v213, 2.0, v231, v213
  v_fma_f32 v213, v210, v213, v229
  v_fma_f32 v230, v210, v233, v230
  v_mul_f32_e64 v235, v211, v235
  v_fma_f32 v230, -2.0, v230, v235
  v_fma_f32 v213, v211, v230, v213
  v_mul_f32 v212, 0x3acccccd, v212
  v_mul_f32 v213, 0x3acccccd, v213
  v_fma_f32 v213, -v212, v212, v213
  v_max_f32_e64 v213, 0, v213
  v_add_f32 v213, 0x3727c5ac, v213
  v_rsq_f32 v214, v213
  s_nop 0
  v_mul_f32_e64 v215, v212, v214
  v_pk_fma_f32 v[160:161], v[68:69], v[210:211], v[210:211] op_sel:[0,0,1] op_sel_hi:[1,0,1] neg_lo:[0,0,1] neg_hi:[0,0,1]
  v_pk_fma_f32 v[162:163], v[70:71], v[210:211], v[210:211] op_sel:[0,0,1] op_sel_hi:[1,0,1] neg_lo:[0,0,1] neg_hi:[0,0,1]
  v_pk_fma_f32 v[164:165], v[72:73], v[210:211], v[210:211] op_sel:[0,0,1] op_sel_hi:[1,0,1] neg_lo:[0,0,1] neg_hi:[0,0,1]
  v_pk_fma_f32 v[166:167], v[74:75], v[210:211], v[210:211] op_sel:[0,0,1] op_sel_hi:[1,0,1] neg_lo:[0,0,1] neg_hi:[0,0,1]
  v_pk_fma_f32 v[168:169], v[76:77], v[210:211], v[210:211] op_sel:[0,0,1] op_sel_hi:[1,0,1] neg_lo:[0,0,1] neg_hi:[0,0,1]
  v_pk_fma_f32 v[170:171], v[78:79], v[210:211], v[210:211] op_sel:[0,0,1] op_sel_hi:[1,0,1] neg_lo:[0,0,1] neg_hi:[0,0,1]
  v_pk_fma_f32 v[172:173], v[80:81], v[210:211], v[210:211] op_sel:[0,0,1] op_sel_hi:[1,0,1] neg_lo:[0,0,1] neg_hi:[0,0,1]
  v_pk_fma_f32 v[174:175], v[82:83], v[210:211], v[210:211] op_sel:[0,0,1] op_sel_hi:[1,0,1] neg_lo:[0,0,1] neg_hi:[0,0,1]
  v_pk_fma_f32 v[176:177], v[84:85], v[210:211], v[210:211] op_sel:[0,0,1] op_sel_hi:[1,0,1] neg_lo:[0,0,1] neg_hi:[0,0,1]
  v_pk_fma_f32 v[178:179], v[86:87], v[210:211], v[210:211] op_sel:[0,0,1] op_sel_hi:[1,0,1] neg_lo:[0,0,1] neg_hi:[0,0,1]
  v_pk_fma_f32 v[68:69], v[160:161], v[88:89], v[68:69]
  v_pk_fma_f32 v[70:71], v[162:163], v[90:91], v[70:71]
  v_pk_fma_f32 v[72:73], v[164:165], v[92:93], v[72:73]
  v_pk_fma_f32 v[74:75], v[166:167], v[94:95], v[74:75]
  v_pk_fma_f32 v[76:77], v[168:169], v[96:97], v[76:77]
  v_pk_fma_f32 v[78:79], v[170:171], v[98:99], v[78:79]
  v_pk_fma_f32 v[80:81], v[172:173], v[100:101], v[80:81]
  v_pk_fma_f32 v[82:83], v[174:175], v[102:103], v[82:83]
  v_pk_fma_f32 v[84:85], v[176:177], v[104:105], v[84:85]
  v_pk_fma_f32 v[86:87], v[178:179], v[106:107], v[86:87]
  v_pk_fma_f32 v[160:161], v[68:69], v[214:215], v[214:215] op_sel:[0,0,1] op_sel_hi:[1,0,1] neg_lo:[0,0,1] neg_hi:[0,0,1]
  v_pk_fma_f32 v[162:163], v[70:71], v[214:215], v[214:215] op_sel:[0,0,1] op_sel_hi:[1,0,1] neg_lo:[0,0,1] neg_hi:[0,0,1]
  v_pk_fma_f32 v[164:165], v[72:73], v[214:215], v[214:215] op_sel:[0,0,1] op_sel_hi:[1,0,1] neg_lo:[0,0,1] neg_hi:[0,0,1]
  v_pk_fma_f32 v[166:167], v[74:75], v[214:215], v[214:215] op_sel:[0,0,1] op_sel_hi:[1,0,1] neg_lo:[0,0,1] neg_hi:[0,0,1]
  v_pk_fma_f32 v[168:169], v[76:77], v[214:215], v[214:215] op_sel:[0,0,1] op_sel_hi:[1,0,1] neg_lo:[0,0,1] neg_hi:[0,0,1]
  v_pk_fma_f32 v[170:171], v[78:79], v[214:215], v[214:215] op_sel:[0,0,1] op_sel_hi:[1,0,1] neg_lo:[0,0,1] neg_hi:[0,0,1]
  v_pk_fma_f32 v[172:173], v[80:81], v[214:215], v[214:215] op_sel:[0,0,1] op_sel_hi:[1,0,1] neg_lo:[0,0,1] neg_hi:[0,0,1]
  v_pk_fma_f32 v[174:175], v[82:83], v[214:215], v[214:215] op_sel:[0,0,1] op_sel_hi:[1,0,1] neg_lo:[0,0,1] neg_hi:[0,0,1]
  v_pk_fma_f32 v[176:177], v[84:85], v[214:215], v[214:215] op_sel:[0,0,1] op_sel_hi:[1,0,1] neg_lo:[0,0,1] neg_hi:[0,0,1]
  v_pk_fma_f32 v[178:179], v[86:87], v[214:215], v[214:215] op_sel:[0,0,1] op_sel_hi:[1,0,1] neg_lo:[0,0,1] neg_hi:[0,0,1]
  v_cvt_pk_bf16_f32 v180, v160, v161
  v_cvt_pk_bf16_f32 v181, v162, v163
  v_cvt_pk_bf16_f32 v182, v164, v165
  v_cvt_pk_bf16_f32 v183, v166, v167
  v_cvt_pk_bf16_f32 v184, v168, v169
  v_cvt_pk_bf16_f32 v185, v170, v171
  v_cvt_pk_bf16_f32 v186, v172, v173
  v_cvt_pk_bf16_f32 v187, v174, v175
  v_cvt_pk_bf16_f32 v188, v176, v177
  v_cvt_pk_bf16_f32 v189, v178, v179
  s_add_u32 s12, s96, 4194304
  s_cmp_eq_u32 s9, 0
  s_cbranch_scc1 slow_48
  buffer_store_dwordx2 v[180:181], v47, s[52:55], s12 offen offset:0
  buffer_store_dwordx2 v[182:183], v47, s[52:55], s12 offen offset:128
  buffer_store_dwordx2 v[184:185], v47, s[52:55], s12 offen offset:256
  buffer_store_dwordx2 v[186:187], v47, s[52:55], s12 offen offset:384
  buffer_store_dwordx2 v[188:189], v47, s[52:55], s12 offen offset:512
back_49:
  v_pk_fma_f32 v[68:69], v[160:161], v[108:109], v[68:69]
  v_pk_fma_f32 v[70:71], v[162:163], v[110:111], v[70:71]
  v_pk_fma_f32 v[72:73], v[164:165], v[112:113], v[72:73]
  v_pk_fma_f32 v[74:75], v[166:167], v[114:115], v[74:75]
  v_pk_fma_f32 v[76:77], v[168:169], v[116:117], v[76:77]
  v_pk_fma_f32 v[78:79], v[170:171], v[118:119], v[78:79]
  v_pk_fma_f32 v[80:81], v[172:173], v[120:121], v[80:81]
  v_pk_fma_f32 v[82:83], v[174:175], v[122:123], v[82:83]
  v_pk_fma_f32 v[84:85], v[176:177], v[124:125], v[84:85]
  v_pk_fma_f32 v[86:87], v[178:179], v[126:127], v[86:87]
  v_accvgpr_write_b32 a220, v68
  v_accvgpr_write_b32 a221, v69
  v_accvgpr_write_b32 a222, v70
  v_accvgpr_write_b32 a223, v71
  v_accvgpr_write_b32 a224, v72
  v_accvgpr_write_b32 a225, v73
  v_accvgpr_write_b32 a226, v74
  v_accvgpr_write_b32 a227, v75
  v_accvgpr_write_b32 a228, v76
  v_accvgpr_write_b32 a229, v77
  v_accvgpr_write_b32 a230, v78
  v_accvgpr_write_b32 a231, v79
  v_accvgpr_write_b32 a232, v80
  v_accvgpr_write_b32 a233, v81
  v_accvgpr_write_b32 a234, v82
  v_accvgpr_write_b32 a235, v83
  v_accvgpr_write_b32 a236, v84
  v_accvgpr_write_b32 a237, v85
  v_accvgpr_write_b32 a238, v86
  v_accvgpr_write_b32 a239, v87
  s_add_u32 s13, s73, 8192
  s_waitcnt vmcnt(0)
  v_mov_b32 v15, s8
  s_mov_b64 exec, 1
  s_cmp_eq_u32 s9, 0
  s_cbranch_scc1 slow_50
  buffer_store_dword v15, off, s[52:55], s13
back_51:
  s_mov_b64 exec, -1
  s_cmp_lg_u32 s35, 992
  s_cbranch_scc1 skip_52
  v_mov_b32 v15, s8
  s_mov_b64 exec, 1
  buffer_store_dword v15, off, s[52:55], 0 sc1
  s_mov_b64 exec, -1
skip_52:
  s_lshl_b32 s12, s3, 8
  s_lshr_b32 s13, s7, 1
  s_lshl_b32 s13, s13, 7
  s_add_u32 s12, s12, s13
  s_and_b32 s13, s7, 1
  s_lshl_b32 s13, s13, 3
  s_add_u32 s12, s12, s13
  s_add_u32 s12, s12, 8192
  v_and_b32 v11, 7, v1
  v_lshlrev_b32 v11, 4, v11
  s_lshl_b32 s18, s3, 2
  s_add_u32 s18, s18, s7
  s_mul_i32 s18, s18, 40960
  s_add_u32 s18, s18, 4194304
  s_add_u32 s19, s18, 20480
poll_53:
  buffer_load_dwordx2 v[42:43], v11, s[52:55], s12 offen sc1
  s_waitcnt vmcnt(0)
  v_xor_b32 v15, s8, v42
  v_xor_b32 v14, s8, v43
  v_or_b32 v15, v15, v14
  v_cmp_ne_u32 vcc, 0, v15
  s_cbranch_vccnz retry_54
giveup_55:
  buffer_load_dwordx4 v[128:131], v0, s[52:55], s18 offen offset:1536 sc1
  buffer_load_dwordx4 v[132:135], v0, s[52:55], s19 offen offset:1536 sc1
  buffer_load_dwordx4 v[136:139], v0, s[52:55], s18 offen offset:1792 sc1
  buffer_load_dwordx4 v[140:143], v0, s[52:55], s19 offen offset:1792 sc1
  buffer_load_dwordx4 v[144:147], v0, s[52:55], s18 offen offset:2048 sc1
  buffer_load_dwordx4 v[148:151], v0, s[52:55], s19 offen offset:2048 sc1
  buffer_load_dwordx4 v[152:155], v0, s[52:55], s18 offen offset:2304 sc1
  buffer_load_dwordx4 v[156:159], v0, s[52:55], s19 offen offset:2304 sc1
  ds_read_b128 v[88:91], v5 offset:30720
  ds_read_b128 v[92:95], v5 offset:32768
  ds_read_b128 v[96:99], v5 offset:34816
  ds_read_b128 v[100:103], v5 offset:36864
  ds_read_b128 v[104:107], v5 offset:38912
  s_waitcnt vmcnt(6)
  s_waitcnt lgkmcnt(4)
  v_mfma_f32_16x16x32_bf16 v[48:51], v[128:131], v[88:91], 0
  ds_read_b128 v[108:111], v6 offset:30720
  v_mfma_f32_16x16x32_bf16 v[52:55], v[132:135], v[88:91], 0
  buffer_load_dwordx4 v[160:163], v0, s[52:55], s18 offen offset:2560 sc1
  s_waitcnt lgkmcnt(4)
  v_mfma_f32_16x16x32_bf16 v[56:59], v[128:131], v[92:95], 0
  ds_read_b128 v[112:115], v6 offset:32768
  v_mfma_f32_16x16x32_bf16 v[60:63], v[132:135], v[92:95], 0
  buffer_load_dwordx4 v[164:167], v0, s[52:55], s19 offen offset:2560 sc1
  s_waitcnt lgkmcnt(4)
  v_mfma_f32_16x16x32_bf16 v[64:67], v[128:131], v[96:99], 0
  ds_read_b128 v[116:119], v6 offset:34816
  v_mfma_f32_16x16x32_bf16 v[68:71], v[132:135], v[96:99], 0
  s_waitcnt lgkmcnt(4)
  v_mfma_f32_16x16x32_bf16 v[72:75], v[128:131], v[100:103], 0
  ds_read_b128 v[120:123], v6 offset:36864
  v_mfma_f32_16x16x32_bf16 v[76:79], v[132:135], v[100:103], 0
  s_waitcnt lgkmcnt(4)
  v_mfma_f32_16x16x32_bf16 v[80:83], v[128:131], v[104:107], 0
  ds_read_b128 v[124:127], v6 offset:38912
  v_mfma_f32_16x16x32_bf16 v[84:87], v[132:135], v[104:107], 0
  s_waitcnt vmcnt(6)
  s_waitcnt lgkmcnt(4)
  v_mfma_f32_16x16x32_bf16 v[48:51], v[136:139], v[108:111], v[48:51]
  ds_read_b128 v[88:91], v5 offset:40960
  v_mfma_f32_16x16x32_bf16 v[52:55], v[140:143], v[108:111], v[52:55]
  buffer_load_dwordx4 v[168:171], v0, s[52:55], s18 offen offset:2816 sc1
  s_waitcnt lgkmcnt(4)
  v_mfma_f32_16x16x32_bf16 v[56:59], v[136:139], v[112:115], v[56:59]
  ds_read_b128 v[92:95], v5 offset:43008
  v_mfma_f32_16x16x32_bf16 v[60:63], v[140:143], v[112:115], v[60:63]
  buffer_load_dwordx4 v[172:175], v0, s[52:55], s19 offen offset:2816 sc1
  s_waitcnt lgkmcnt(4)
  v_mfma_f32_16x16x32_bf16 v[64:67], v[136:139], v[116:119], v[64:67]
  ds_read_b128 v[96:99], v5 offset:45056
  v_mfma_f32_16x16x32_bf16 v[68:71], v[140:143], v[116:119], v[68:71]
  s_waitcnt lgkmcnt(4)
  v_mfma_f32_16x16x32_bf16 v[72:75], v[136:139], v[120:123], v[72:75]
  ds_read_b128 v[100:103], v5 offset:47104
  v_mfma_f32_16x16x32_bf16 v[76:79], v[140:143], v[120:123], v[76:79]
  s_waitcnt lgkmcnt(4)
  v_mfma_f32_16x16x32_bf16 v[80:83], v[136:139], v[124:127], v[80:83]
  ds_read_b128 v[104:107], v5 offset:49152
  v_mfma_f32_16x16x32_bf16 v[84:87], v[140:143], v[124:127], v[84:87]
  s_waitcnt vmcnt(6)
  s_waitcnt lgkmcnt(4)
  v_mfma_f32_16x16x32_bf16 v[48:51], v[144:147], v[88:91], v[48:51]
  ds_read_b128 v[108:111], v6 offset:40960
  v_mfma_f32_16x16x32_bf16 v[52:55], v[148:151], v[88:91], v[52:55]
  buffer_load_dwordx4 v[176:179], v0, s[52:55], s18 offen offset:3072 sc1
  s_waitcnt lgkmcnt(4)
  v_mfma_f32_16x16x32_bf16 v[56:59], v[144:147], v[92:95], v[56:59]
  ds_read_b128 v[112:115], v6 offset:43008
  v_mfma_f32_16x16x32_bf16 v[60:63], v[148:151], v[92:95], v[60:63]
  buffer_load_dwordx4 v[180:183], v0, s[52:55], s19 offen offset:3072 sc1
  s_waitcnt lgkmcnt(4)
  v_mfma_f32_16x16x32_bf16 v[64:67], v[144:147], v[96:99], v[64:67]
  ds_read_b128 v[116:119], v6 offset:45056
  v_mfma_f32_16x16x32_bf16 v[68:71], v[148:151], v[96:99], v[68:71]
  s_waitcnt lgkmcnt(4)
  v_mfma_f32_16x16x32_bf16 v[72:75], v[144:147], v[100:103], v[72:75]
  ds_read_b128 v[120:123], v6 offset:47104
  v_mfma_f32_16x16x32_bf16 v[76:79], v[148:151], v[100:103], v[76:79]
  s_waitcnt lgkmcnt(4)
  v_mfma_f32_16x16x32_bf16 v[80:83], v[144:147], v[104:107], v[80:83]
  ds_read_b128 v[124:127], v6 offset:49152
  v_mfma_f32_16x16x32_bf16 v[84:87], v[148:151], v[104:107], v[84:87]
  s_waitcnt vmcnt(6)
  s_waitcnt lgkmcnt(4)
  v_mfma_f32_16x16x32_bf16 v[48:51], v[152:155], v[108:111], v[48:51]
  ds_read_b128 v[88:91], v7 offset:0
  v_mfma_f32_16x16x32_bf16 v[52:55], v[156:159], v[108:111], v[52:55]
  buffer_load_dwordx4 v[184:187], v0, s[52:55], s18 offen offset:3328 sc1
  s_waitcnt lgkmcnt(4)
  v_mfma_f32_16x16x32_bf16 v[56:59], v[152:155], v[112:115], v[56:59]
  ds_read_b128 v[92:95], v7 offset:2048
  v_mfma_f32_16x16x32_bf16 v[60:63], v[156:159], v[112:115], v[60:63]
  buffer_load_dwordx4 v[188:191], v0, s[52:55], s19 offen offset:3328 sc1
  s_waitcnt lgkmcnt(4)
  v_mfma_f32_16x16x32_bf16 v[64:67], v[152:155], v[116:119], v[64:67]
  ds_read_b128 v[96:99], v7 offset:4096
  v_mfma_f32_16x16x32_bf16 v[68:71], v[156:159], v[116:119], v[68:71]
  s_waitcnt lgkmcnt(4)
  v_mfma_f32_16x16x32_bf16 v[72:75], v[152:155], v[120:123], v[72:75]
  ds_read_b128 v[100:103], v7 offset:6144
  v_mfma_f32_16x16x32_bf16 v[76:79], v[156:159], v[120:123], v[76:79]
  s_waitcnt lgkmcnt(4)
  v_mfma_f32_16x16x32_bf16 v[80:83], v[152:155], v[124:127], v[80:83]
  ds_read_b128 v[104:107], v7 offset:8192
  v_mfma_f32_16x16x32_bf16 v[84:87], v[156:159], v[124:127], v[84:87]
  s_waitcnt vmcnt(6)
  s_waitcnt lgkmcnt(4)
  v_mfma_f32_16x16x32_bf16 v[48:51], v[160:163], v[88:91], v[48:51]
  ds_read_b128 v[108:111], v8 offset:0
  v_mfma_f32_16x16x32_bf16 v[52:55], v[164:167], v[88:91], v[52:55]
  buffer_load_dwordx4 v[128:131], v0, s[52:55], s18 offen offset:3584 sc1
  s_waitcnt lgkmcnt(4)
  v_mfma_f32_16x16x32_bf16 v[56:59], v[160:163], v[92:95], v[56:59]
  ds_read_b128 v[112:115], v8 offset:2048
  v_mfma_f32_16x16x32_bf16 v[60:63], v[164:167], v[92:95], v[60:63]
  buffer_load_dwordx4 v[132:135], v0, s[52:55], s19 offen offset:3584 sc1
  s_waitcnt lgkmcnt(4)
  v_mfma_f32_16x16x32_bf16 v[64:67], v[160:163], v[96:99], v[64:67]
  ds_read_b128 v[116:119], v8 offset:4096
  v_mfma_f32_16x16x32_bf16 v[68:71], v[164:167], v[96:99], v[68:71]
  s_waitcnt lgkmcnt(4)
  v_mfma_f32_16x16x32_bf16 v[72:75], v[160:163], v[100:103], v[72:75]
  ds_read_b128 v[120:123], v8 offset:6144
  v_mfma_f32_16x16x32_bf16 v[76:79], v[164:167], v[100:103], v[76:79]
  s_waitcnt lgkmcnt(4)
  v_mfma_f32_16x16x32_bf16 v[80:83], v[160:163], v[104:107], v[80:83]
  ds_read_b128 v[124:127], v8 offset:8192
  v_mfma_f32_16x16x32_bf16 v[84:87], v[164:167], v[104:107], v[84:87]
  s_waitcnt vmcnt(6)
  s_waitcnt lgkmcnt(4)
  v_mfma_f32_16x16x32_bf16 v[48:51], v[168:171], v[108:111], v[48:51]
  ds_read_b128 v[88:91], v7 offset:10240
  v_mfma_f32_16x16x32_bf16 v[52:55], v[172:175], v[108:111], v[52:55]
  buffer_load_dwordx4 v[136:139], v0, s[52:55], s18 offen offset:3840 sc1
  s_waitcnt lgkmcnt(4)
  v_mfma_f32_16x16x32_bf16 v[56:59], v[168:171], v[112:115], v[56:59]
  ds_read_b128 v[92:95], v7 offset:12288
  v_mfma_f32_16x16x32_bf16 v[60:63], v[172:175], v[112:115], v[60:63]
  buffer_load_dwordx4 v[140:143], v0, s[52:55], s19 offen offset:3840 sc1
  s_waitcnt lgkmcnt(4)
  v_mfma_f32_16x16x32_bf16 v[64:67], v[168:171], v[116:119], v[64:67]
  ds_read_b128 v[96:99], v7 offset:14336
  v_mfma_f32_16x16x32_bf16 v[68:71], v[172:175], v[116:119], v[68:71]
  s_waitcnt lgkmcnt(4)
  v_mfma_f32_16x16x32_bf16 v[72:75], v[168:171], v[120:123], v[72:75]
  ds_read_b128 v[100:103], v7 offset:16384
  v_mfma_f32_16x16x32_bf16 v[76:79], v[172:175], v[120:123], v[76:79]
  s_waitcnt lgkmcnt(4)
  v_mfma_f32_16x16x32_bf16 v[80:83], v[168:171], v[124:127], v[80:83]
  ds_read_b128 v[104:107], v7 offset:18432
  v_mfma_f32_16x16x32_bf16 v[84:87], v[172:175], v[124:127], v[84:87]
  s_waitcnt vmcnt(6)
  s_waitcnt lgkmcnt(4)
  v_mfma_f32_16x16x32_bf16 v[48:51], v[176:179], v[88:91], v[48:51]
  ds_read_b128 v[108:111], v8 offset:10240
  v_mfma_f32_16x16x32_bf16 v[52:55], v[180:183], v[88:91], v[52:55]
  s_add_u32 s18, s18, 4096
  buffer_load_dwordx4 v[144:147], v0, s[52:55], s18 offen offset:0 sc1
  s_waitcnt lgkmcnt(4)
  v_mfma_f32_16x16x32_bf16 v[56:59], v[176:179], v[92:95], v[56:59]
  ds_read_b128 v[112:115], v8 offset:12288
  v_mfma_f32_16x16x32_bf16 v[60:63], v[180:183], v[92:95], v[60:63]
  s_add_u32 s19, s19, 4096
  buffer_load_dwordx4 v[148:151], v0, s[52:55], s19 offen offset:0 sc1
  s_waitcnt lgkmcnt(4)
  v_mfma_f32_16x16x32_bf16 v[64:67], v[176:179], v[96:99], v[64:67]
  ds_read_b128 v[116:119], v8 offset:14336
  v_mfma_f32_16x16x32_bf16 v[68:71], v[180:183], v[96:99], v[68:71]
  s_waitcnt lgkmcnt(4)
  v_mfma_f32_16x16x32_bf16 v[72:75], v[176:179], v[100:103], v[72:75]
  ds_read_b128 v[120:123], v8 offset:16384
  v_mfma_f32_16x16x32_bf16 v[76:79], v[180:183], v[100:103], v[76:79]
  s_waitcnt lgkmcnt(4)
  v_mfma_f32_16x16x32_bf16 v[80:83], v[176:179], v[104:107], v[80:83]
  ds_read_b128 v[124:127], v8 offset:18432
  v_mfma_f32_16x16x32_bf16 v[84:87], v[180:183], v[104:107], v[84:87]
  s_waitcnt vmcnt(6)
  s_waitcnt lgkmcnt(4)
  v_mfma_f32_16x16x32_bf16 v[48:51], v[184:187], v[108:111], v[48:51]
  ds_read_b128 v[88:91], v7 offset:20480
  v_mfma_f32_16x16x32_bf16 v[52:55], v[188:191], v[108:111], v[52:55]
  buffer_load_dwordx4 v[152:155], v0, s[52:55], s18 offen offset:256 sc1
  s_waitcnt lgkmcnt(4)
  v_mfma_f32_16x16x32_bf16 v[56:59], v[184:187], v[112:115], v[56:59]
  ds_read_b128 v[92:95], v7 offset:22528
  v_mfma_f32_16x16x32_bf16 v[60:63], v[188:191], v[112:115], v[60:63]
  buffer_load_dwordx4 v[156:159], v0, s[52:55], s19 offen offset:256 sc1
  s_waitcnt lgkmcnt(4)
  v_mfma_f32_16x16x32_bf16 v[64:67], v[184:187], v[116:119], v[64:67]
  ds_read_b128 v[96:99], v7 offset:24576
  v_mfma_f32_16x16x32_bf16 v[68:71], v[188:191], v[116:119], v[68:71]
  s_waitcnt lgkmcnt(4)
  v_mfma_f32_16x16x32_bf16 v[72:75], v[184:187], v[120:123], v[72:75]
  ds_read_b128 v[100:103], v7 offset:26624
  v_mfma_f32_16x16x32_bf16 v[76:79], v[188:191], v[120:123], v[76:79]
  s_waitcnt lgkmcnt(4)
  v_mfma_f32_16x16x32_bf16 v[80:83], v[184:187], v[124:127], v[80:83]
  ds_read_b128 v[104:107], v7 offset:28672
  v_mfma_f32_16x16x32_bf16 v[84:87], v[188:191], v[124:127], v[84:87]
  s_waitcnt vmcnt(6)
  s_waitcnt lgkmcnt(4)
  v_mfma_f32_16x16x32_bf16 v[48:51], v[128:131], v[88:91], v[48:51]
  ds_read_b128 v[108:111], v8 offset:20480
  v_mfma_f32_16x16x32_bf16 v[52:55], v[132:135], v[88:91], v[52:55]
  buffer_load_dwordx4 v[160:163], v0, s[52:55], s18 offen offset:512 sc1
  s_waitcnt lgkmcnt(4)
  v_mfma_f32_16x16x32_bf16 v[56:59], v[128:131], v[92:95], v[56:59]
  ds_read_b128 v[112:115], v8 offset:22528
  v_mfma_f32_16x16x32_bf16 v[60:63], v[132:135], v[92:95], v[60:63]
  buffer_load_dwordx4 v[164:167], v0, s[52:55], s19 offen offset:512 sc1
  s_waitcnt lgkmcnt(4)
  v_mfma_f32_16x16x32_bf16 v[64:67], v[128:131], v[96:99], v[64:67]
  ds_read_b128 v[116:119], v8 offset:24576
  v_mfma_f32_16x16x32_bf16 v[68:71], v[132:135], v[96:99], v[68:71]
  s_waitcnt lgkmcnt(4)
  v_mfma_f32_16x16x32_bf16 v[72:75], v[128:131], v[100:103], v[72:75]
  ds_read_b128 v[120:123], v8 offset:26624
  v_mfma_f32_16x16x32_bf16 v[76:79], v[132:135], v[100:103], v[76:79]
  s_waitcnt lgkmcnt(4)
  v_mfma_f32_16x16x32_bf16 v[80:83], v[128:131], v[104:107], v[80:83]
  ds_read_b128 v[124:127], v8 offset:28672
  v_mfma_f32_16x16x32_bf16 v[84:87], v[132:135], v[104:107], v[84:87]
  s_waitcnt vmcnt(6)
  s_waitcnt lgkmcnt(4)
  v_mfma_f32_16x16x32_bf16 v[48:51], v[136:139], v[108:111], v[48:51]
  ds_read_b128 v[88:91], v7 offset:30720
  v_mfma_f32_16x16x32_bf16 v[52:55], v[140:143], v[108:111], v[52:55]
  buffer_load_dwordx4 v[168:171], v0, s[52:55], s18 offen offset:768 sc1
  s_waitcnt lgkmcnt(4)
  v_mfma_f32_16x16x32_bf16 v[56:59], v[136:139], v[112:115], v[56:59]
  ds_read_b128 v[92:95], v7 offset:32768
  v_mfma_f32_16x16x32_bf16 v[60:63], v[140:143], v[112:115], v[60:63]
  buffer_load_dwordx4 v[172:175], v0, s[52:55], s19 offen offset:768 sc1
  s_waitcnt lgkmcnt(4)
  v_mfma_f32_16x16x32_bf16 v[64:67], v[136:139], v[116:119], v[64:67]
  ds_read_b128 v[96:99], v7 offset:34816
  v_mfma_f32_16x16x32_bf16 v[68:71], v[140:143], v[116:119], v[68:71]
  s_waitcnt lgkmcnt(4)
  v_mfma_f32_16x16x32_bf16 v[72:75], v[136:139], v[120:123], v[72:75]
  ds_read_b128 v[100:103], v7 offset:36864
  v_mfma_f32_16x16x32_bf16 v[76:79], v[140:143], v[120:123], v[76:79]
  s_waitcnt lgkmcnt(4)
  v_mfma_f32_16x16x32_bf16 v[80:83], v[136:139], v[124:127], v[80:83]
  ds_read_b128 v[104:107], v7 offset:38912
  v_mfma_f32_16x16x32_bf16 v[84:87], v[140:143], v[124:127], v[84:87]
  s_waitcnt vmcnt(6)
  s_waitcnt lgkmcnt(4)
  v_mfma_f32_16x16x32_bf16 v[48:51], v[144:147], v[88:91], v[48:51]
  ds_read_b128 v[108:111], v8 offset:30720
  v_mfma_f32_16x16x32_bf16 v[52:55], v[148:151], v[88:91], v[52:55]
  s_sub_u32 s18, s18, 4096
  buffer_load_dwordx4 v[176:179], v0, s[52:55], s18 offen offset:0 sc1
  s_waitcnt lgkmcnt(4)
  v_mfma_f32_16x16x32_bf16 v[56:59], v[144:147], v[92:95], v[56:59]
  ds_read_b128 v[112:115], v8 offset:32768
  v_mfma_f32_16x16x32_bf16 v[60:63], v[148:151], v[92:95], v[60:63]
  s_sub_u32 s19, s19, 4096
  buffer_load_dwordx4 v[180:183], v0, s[52:55], s19 offen offset:0 sc1
  s_waitcnt lgkmcnt(4)
  v_mfma_f32_16x16x32_bf16 v[64:67], v[144:147], v[96:99], v[64:67]
  ds_read_b128 v[116:119], v8 offset:34816
  v_mfma_f32_16x16x32_bf16 v[68:71], v[148:151], v[96:99], v[68:71]
  s_waitcnt lgkmcnt(4)
  v_mfma_f32_16x16x32_bf16 v[72:75], v[144:147], v[100:103], v[72:75]
  ds_read_b128 v[120:123], v8 offset:36864
  v_mfma_f32_16x16x32_bf16 v[76:79], v[148:151], v[100:103], v[76:79]
  s_waitcnt lgkmcnt(4)
  v_mfma_f32_16x16x32_bf16 v[80:83], v[144:147], v[104:107], v[80:83]
  ds_read_b128 v[124:127], v8 offset:38912
  v_mfma_f32_16x16x32_bf16 v[84:87], v[148:151], v[104:107], v[84:87]
  s_waitcnt vmcnt(6)
  s_waitcnt lgkmcnt(4)
  v_mfma_f32_16x16x32_bf16 v[48:51], v[152:155], v[108:111], v[48:51]
  ds_read_b128 v[88:91], v7 offset:40960
  v_mfma_f32_16x16x32_bf16 v[52:55], v[156:159], v[108:111], v[52:55]
  buffer_load_dwordx4 v[184:187], v0, s[52:55], s18 offen offset:256 sc1
  s_waitcnt lgkmcnt(4)
  v_mfma_f32_16x16x32_bf16 v[56:59], v[152:155], v[112:115], v[56:59]
  ds_read_b128 v[92:95], v7 offset:43008
  v_mfma_f32_16x16x32_bf16 v[60:63], v[156:159], v[112:115], v[60:63]
  buffer_load_dwordx4 v[188:191], v0, s[52:55], s19 offen offset:256 sc1
  s_waitcnt lgkmcnt(4)
  v_mfma_f32_16x16x32_bf16 v[64:67], v[152:155], v[116:119], v[64:67]
  ds_read_b128 v[96:99], v7 offset:45056
  v_mfma_f32_16x16x32_bf16 v[68:71], v[156:159], v[116:119], v[68:71]
  s_waitcnt lgkmcnt(4)
  v_mfma_f32_16x16x32_bf16 v[72:75], v[152:155], v[120:123], v[72:75]
  ds_read_b128 v[100:103], v7 offset:47104
  v_mfma_f32_16x16x32_bf16 v[76:79], v[156:159], v[120:123], v[76:79]
  s_waitcnt lgkmcnt(4)
  v_mfma_f32_16x16x32_bf16 v[80:83], v[152:155], v[124:127], v[80:83]
  ds_read_b128 v[104:107], v7 offset:49152
  v_mfma_f32_16x16x32_bf16 v[84:87], v[156:159], v[124:127], v[84:87]
  s_waitcnt vmcnt(6)
  s_waitcnt lgkmcnt(4)
  v_mfma_f32_16x16x32_bf16 v[48:51], v[160:163], v[88:91], v[48:51]
  ds_read_b128 v[108:111], v8 offset:40960
  v_mfma_f32_16x16x32_bf16 v[52:55], v[164:167], v[88:91], v[52:55]
  buffer_load_dwordx4 v[128:131], v0, s[52:55], s18 offen offset:512 sc1
  s_waitcnt lgkmcnt(4)
  v_mfma_f32_16x16x32_bf16 v[56:59], v[160:163], v[92:95], v[56:59]
  ds_read_b128 v[112:115], v8 offset:43008
  v_mfma_f32_16x16x32_bf16 v[60:63], v[164:167], v[92:95], v[60:63]
  buffer_load_dwordx4 v[132:135], v0, s[52:55], s19 offen offset:512 sc1
  s_waitcnt lgkmcnt(4)
  v_mfma_f32_16x16x32_bf16 v[64:67], v[160:163], v[96:99], v[64:67]
  ds_read_b128 v[116:119], v8 offset:45056
  v_mfma_f32_16x16x32_bf16 v[68:71], v[164:167], v[96:99], v[68:71]
  s_waitcnt lgkmcnt(4)
  v_mfma_f32_16x16x32_bf16 v[72:75], v[160:163], v[100:103], v[72:75]
  ds_read_b128 v[120:123], v8 offset:47104
  v_mfma_f32_16x16x32_bf16 v[76:79], v[164:167], v[100:103], v[76:79]
  s_waitcnt lgkmcnt(4)
  v_mfma_f32_16x16x32_bf16 v[80:83], v[160:163], v[104:107], v[80:83]
  ds_read_b128 v[124:127], v8 offset:49152
  v_mfma_f32_16x16x32_bf16 v[84:87], v[164:167], v[104:107], v[84:87]
  s_waitcnt vmcnt(6)
  s_barrier
  s_waitcnt lgkmcnt(4)
  v_mfma_f32_16x16x32_bf16 v[48:51], v[168:171], v[108:111], v[48:51]
  ds_read_b128 v[88:91], v5 offset:0
  v_mfma_f32_16x16x32_bf16 v[52:55], v[172:175], v[108:111], v[52:55]
  buffer_load_dwordx4 v[136:139], v0, s[52:55], s18 offen offset:768 sc1
  s_waitcnt lgkmcnt(4)
  v_mfma_f32_16x16x32_bf16 v[56:59], v[168:171], v[112:115], v[56:59]
  ds_read_b128 v[92:95], v5 offset:2048
  v_mfma_f32_16x16x32_bf16 v[60:63], v[172:175], v[112:115], v[60:63]
  buffer_load_dwordx4 v[140:143], v0, s[52:55], s19 offen offset:768 sc1
  s_waitcnt lgkmcnt(4)
  v_mfma_f32_16x16x32_bf16 v[64:67], v[168:171], v[116:119], v[64:67]
  ds_read_b128 v[96:99], v5 offset:4096
  v_mfma_f32_16x16x32_bf16 v[68:71], v[172:175], v[116:119], v[68:71]
  s_waitcnt lgkmcnt(4)
  v_mfma_f32_16x16x32_bf16 v[72:75], v[168:171], v[120:123], v[72:75]
  ds_read_b128 v[100:103], v5 offset:6144
  v_mfma_f32_16x16x32_bf16 v[76:79], v[172:175], v[120:123], v[76:79]
  s_waitcnt lgkmcnt(4)
  v_mfma_f32_16x16x32_bf16 v[80:83], v[168:171], v[124:127], v[80:83]
  ds_read_b128 v[104:107], v5 offset:8192
  v_mfma_f32_16x16x32_bf16 v[84:87], v[172:175], v[124:127], v[84:87]
  s_waitcnt vmcnt(6)
  s_waitcnt lgkmcnt(4)
  v_mfma_f32_16x16x32_bf16 v[48:51], v[176:179], v[88:91], v[48:51]
  ds_read_b128 v[108:111], v6 offset:0
  v_mfma_f32_16x16x32_bf16 v[52:55], v[180:183], v[88:91], v[52:55]
  buffer_load_dwordx4 v[144:147], v0, s[52:55], s18 offen offset:1024 sc1
  s_waitcnt lgkmcnt(4)
  v_mfma_f32_16x16x32_bf16 v[56:59], v[176:179], v[92:95], v[56:59]
  ds_read_b128 v[112:115], v6 offset:2048
  v_mfma_f32_16x16x32_bf16 v[60:63], v[180:183], v[92:95], v[60:63]
  buffer_load_dwordx4 v[148:151], v0, s[52:55], s19 offen offset:1024 sc1
  s_waitcnt lgkmcnt(4)
  v_mfma_f32_16x16x32_bf16 v[64:67], v[176:179], v[96:99], v[64:67]
  ds_read_b128 v[116:119], v6 offset:4096
  v_mfma_f32_16x16x32_bf16 v[68:71], v[180:183], v[96:99], v[68:71]
  s_waitcnt lgkmcnt(4)
  v_mfma_f32_16x16x32_bf16 v[72:75], v[176:179], v[100:103], v[72:75]
  ds_read_b128 v[120:123], v6 offset:6144
  v_mfma_f32_16x16x32_bf16 v[76:79], v[180:183], v[100:103], v[76:79]
  s_waitcnt lgkmcnt(4)
  v_mfma_f32_16x16x32_bf16 v[80:83], v[176:179], v[104:107], v[80:83]
  ds_read_b128 v[124:127], v6 offset:8192
  v_mfma_f32_16x16x32_bf16 v[84:87], v[180:183], v[104:107], v[84:87]
  s_waitcnt vmcnt(6)
  s_waitcnt lgkmcnt(4)
  v_mfma_f32_16x16x32_bf16 v[48:51], v[184:187], v[108:111], v[48:51]
  ds_read_b128 v[88:91], v5 offset:10240
  v_mfma_f32_16x16x32_bf16 v[52:55], v[188:191], v[108:111], v[52:55]
  buffer_load_dwordx4 v[152:155], v0, s[52:55], s18 offen offset:1280 sc1
  s_waitcnt lgkmcnt(4)
  v_mfma_f32_16x16x32_bf16 v[56:59], v[184:187], v[112:115], v[56:59]
  ds_read_b128 v[92:95], v5 offset:12288
  v_mfma_f32_16x16x32_bf16 v[60:63], v[188:191], v[112:115], v[60:63]
  buffer_load_dwordx4 v[156:159], v0, s[52:55], s19 offen offset:1280 sc1
  s_waitcnt lgkmcnt(4)
  v_mfma_f32_16x16x32_bf16 v[64:67], v[184:187], v[116:119], v[64:67]
  ds_read_b128 v[96:99], v5 offset:14336
  v_mfma_f32_16x16x32_bf16 v[68:71], v[188:191], v[116:119], v[68:71]
  s_waitcnt lgkmcnt(4)
  v_mfma_f32_16x16x32_bf16 v[72:75], v[184:187], v[120:123], v[72:75]
  ds_read_b128 v[100:103], v5 offset:16384
  v_mfma_f32_16x16x32_bf16 v[76:79], v[188:191], v[120:123], v[76:79]
  s_waitcnt lgkmcnt(4)
  v_mfma_f32_16x16x32_bf16 v[80:83], v[184:187], v[124:127], v[80:83]
  ds_read_b128 v[104:107], v5 offset:18432
  v_mfma_f32_16x16x32_bf16 v[84:87], v[188:191], v[124:127], v[84:87]
  s_waitcnt vmcnt(6)
  s_waitcnt lgkmcnt(4)
  v_mfma_f32_16x16x32_bf16 v[48:51], v[128:131], v[88:91], v[48:51]
  ds_read_b128 v[108:111], v6 offset:10240
  v_mfma_f32_16x16x32_bf16 v[52:55], v[132:135], v[88:91], v[52:55]
  s_waitcnt lgkmcnt(4)
  v_mfma_f32_16x16x32_bf16 v[56:59], v[128:131], v[92:95], v[56:59]
  ds_read_b128 v[112:115], v6 offset:12288
  v_mfma_f32_16x16x32_bf16 v[60:63], v[132:135], v[92:95], v[60:63]
  s_waitcnt lgkmcnt(4)
  v_mfma_f32_16x16x32_bf16 v[64:67], v[128:131], v[96:99], v[64:67]
  ds_read_b128 v[116:119], v6 offset:14336
  v_mfma_f32_16x16x32_bf16 v[68:71], v[132:135], v[96:99], v[68:71]
  s_waitcnt lgkmcnt(4)
  v_mfma_f32_16x16x32_bf16 v[72:75], v[128:131], v[100:103], v[72:75]
  ds_read_b128 v[120:123], v6 offset:16384
  v_mfma_f32_16x16x32_bf16 v[76:79], v[132:135], v[100:103], v[76:79]
  s_waitcnt lgkmcnt(4)
  v_mfma_f32_16x16x32_bf16 v[80:83], v[128:131], v[104:107], v[80:83]
  ds_read_b128 v[124:127], v6 offset:18432
  v_mfma_f32_16x16x32_bf16 v[84:87], v[132:135], v[104:107], v[84:87]
  s_waitcnt vmcnt(4)
  s_waitcnt lgkmcnt(4)
  v_mfma_f32_16x16x32_bf16 v[48:51], v[136:139], v[108:111], v[48:51]
  ds_read_b128 v[88:91], v5 offset:20480
  v_mfma_f32_16x16x32_bf16 v[52:55], v[140:143], v[108:111], v[52:55]
  s_waitcnt lgkmcnt(4)
  v_mfma_f32_16x16x32_bf16 v[56:59], v[136:139], v[112:115], v[56:59]
  ds_read_b128 v[92:95], v5 offset:22528
  v_mfma_f32_16x16x32_bf16 v[60:63], v[140:143], v[112:115], v[60:63]
  s_waitcnt lgkmcnt(4)
  v_mfma_f32_16x16x32_bf16 v[64:67], v[136:139], v[116:119], v[64:67]
  ds_read_b128 v[96:99], v5 offset:24576
  v_mfma_f32_16x16x32_bf16 v[68:71], v[140:143], v[116:119], v[68:71]
  s_waitcnt lgkmcnt(4)
  v_mfma_f32_16x16x32_bf16 v[72:75], v[136:139], v[120:123], v[72:75]
  ds_read_b128 v[100:103], v5 offset:26624
  v_mfma_f32_16x16x32_bf16 v[76:79], v[140:143], v[120:123], v[76:79]
  s_waitcnt lgkmcnt(4)
  v_mfma_f32_16x16x32_bf16 v[80:83], v[136:139], v[124:127], v[80:83]
  ds_read_b128 v[104:107], v5 offset:28672
  v_mfma_f32_16x16x32_bf16 v[84:87], v[140:143], v[124:127], v[84:87]
  s_waitcnt vmcnt(2)
  s_waitcnt lgkmcnt(4)
  v_mfma_f32_16x16x32_bf16 v[48:51], v[144:147], v[88:91], v[48:51]
  ds_read_b128 v[108:111], v6 offset:20480
  v_mfma_f32_16x16x32_bf16 v[52:55], v[148:151], v[88:91], v[52:55]
  s_waitcnt lgkmcnt(4)
  v_mfma_f32_16x16x32_bf16 v[56:59], v[144:147], v[92:95], v[56:59]
  ds_read_b128 v[112:115], v6 offset:22528
  v_mfma_f32_16x16x32_bf16 v[60:63], v[148:151], v[92:95], v[60:63]
  s_waitcnt lgkmcnt(4)
  v_mfma_f32_16x16x32_bf16 v[64:67], v[144:147], v[96:99], v[64:67]
  ds_read_b128 v[116:119], v6 offset:24576
  v_mfma_f32_16x16x32_bf16 v[68:71], v[148:151], v[96:99], v[68:71]
  s_waitcnt lgkmcnt(4)
  v_mfma_f32_16x16x32_bf16 v[72:75], v[144:147], v[100:103], v[72:75]
  ds_read_b128 v[120:123], v6 offset:26624
  v_mfma_f32_16x16x32_bf16 v[76:79], v[148:151], v[100:103], v[76:79]
  s_waitcnt lgkmcnt(4)
  v_mfma_f32_16x16x32_bf16 v[80:83], v[144:147], v[104:107], v[80:83]
  ds_read_b128 v[124:127], v6 offset:28672
  v_mfma_f32_16x16x32_bf16 v[84:87], v[148:151], v[104:107], v[84:87]
  s_waitcnt vmcnt(0)
  s_waitcnt lgkmcnt(4)
  v_mfma_f32_16x16x32_bf16 v[48:51], v[152:155], v[108:111], v[48:51]
  v_mfma_f32_16x16x32_bf16 v[52:55], v[156:159], v[108:111], v[52:55]
  s_waitcnt lgkmcnt(3)
  v_mfma_f32_16x16x32_bf16 v[56:59], v[152:155], v[112:115], v[56:59]
  v_mfma_f32_16x16x32_bf16 v[60:63], v[156:159], v[112:115], v[60:63]
  s_waitcnt lgkmcnt(2)
  v_mfma_f32_16x16x32_bf16 v[64:67], v[152:155], v[116:119], v[64:67]
  v_mfma_f32_16x16x32_bf16 v[68:71], v[156:159], v[116:119], v[68:71]
  s_waitcnt lgkmcnt(1)
  v_mfma_f32_16x16x32_bf16 v[72:75], v[152:155], v[120:123], v[72:75]
  v_mfma_f32_16x16x32_bf16 v[76:79], v[156:159], v[120:123], v[76:79]
  s_waitcnt lgkmcnt(0)
  v_mfma_f32_16x16x32_bf16 v[80:83], v[152:155], v[124:127], v[80:83]
  v_mfma_f32_16x16x32_bf16 v[84:87], v[156:159], v[124:127], v[84:87]
  v_fma_f32 v176, v16, v48, v49
  v_fma_f32 v177, v17, v56, v57
  v_fma_f32 v178, v18, v64, v65
  s_nop 0
  v_fma_f32 v179, v19, v72, v73
  s_nop 1
  v_fma_f32 v180, v20, v80, v81
  v_fmac_f32_dpp v176, -v48, v21 quad_perm:[1,0,3,2] row_mask:0xf bank_mask:0xf
  v_fmac_f32_dpp v177, -v56, v22 quad_perm:[1,0,3,2] row_mask:0xf bank_mask:0xf
  v_fmac_f32_dpp v178, -v64, v23 quad_perm:[1,0,3,2] row_mask:0xf bank_mask:0xf
  v_fmac_f32_dpp v179, -v72, v24 quad_perm:[1,0,3,2] row_mask:0xf bank_mask:0xf
  v_fmac_f32_dpp v180, -v80, v25 quad_perm:[1,0,3,2] row_mask:0xf bank_mask:0xf
  v_fma_f32 v182, v16, v176, v50
  v_fma_f32 v183, v17, v177, v58
  v_fma_f32 v184, v18, v178, v66
  v_fma_f32 v185, v19, v179, v74
  v_fma_f32 v186, v20, v180, v82
  v_fmac_f32_dpp v182, -v176, v21 quad_perm:[1,0,3,2] row_mask:0xf bank_mask:0xf
  v_fmac_f32_dpp v183, -v177, v22 quad_perm:[1,0,3,2] row_mask:0xf bank_mask:0xf
  v_fmac_f32_dpp v184, -v178, v23 quad_perm:[1,0,3,2] row_mask:0xf bank_mask:0xf
  v_fmac_f32_dpp v185, -v179, v24 quad_perm:[1,0,3,2] row_mask:0xf bank_mask:0xf
  v_fmac_f32_dpp v186, -v180, v25 quad_perm:[1,0,3,2] row_mask:0xf bank_mask:0xf
  v_fma_f32 v176, v16, v182, v51
  v_fma_f32 v177, v17, v183, v59
  v_fma_f32 v178, v18, v184, v67
  v_fma_f32 v179, v19, v185, v75
  v_fma_f32 v180, v20, v186, v83
  v_fmac_f32_dpp v176, -v182, v21 quad_perm:[1,0,3,2] row_mask:0xf bank_mask:0xf
  v_fmac_f32_dpp v177, -v183, v22 quad_perm:[1,0,3,2] row_mask:0xf bank_mask:0xf
  v_fmac_f32_dpp v178, -v184, v23 quad_perm:[1,0,3,2] row_mask:0xf bank_mask:0xf
  v_fmac_f32_dpp v179, -v185, v24 quad_perm:[1,0,3,2] row_mask:0xf bank_mask:0xf
  v_fmac_f32_dpp v180, -v186, v25 quad_perm:[1,0,3,2] row_mask:0xf bank_mask:0xf
  v_fma_f32 v182, v16, v176, v52
  v_fma_f32 v183, v17, v177, v60
  v_fma_f32 v184, v18, v178, v68
  v_fma_f32 v185, v19, v179, v76
  v_fma_f32 v186, v20, v180, v84
  v_fmac_f32_dpp v182, -v176, v21 quad_perm:[1,0,3,2] row_mask:0xf bank_mask:0xf
  v_fmac_f32_dpp v183, -v177, v22 quad_perm:[1,0,3,2] row_mask:0xf bank_mask:0xf
  v_fmac_f32_dpp v184, -v178, v23 quad_perm:[1,0,3,2] row_mask:0xf bank_mask:0xf
  v_fmac_f32_dpp v185, -v179, v24 quad_perm:[1,0,3,2] row_mask:0xf bank_mask:0xf
  v_fmac_f32_dpp v186, -v180, v25 quad_perm:[1,0,3,2] row_mask:0xf bank_mask:0xf
  v_fma_f32 v176, v16, v182, v53
  v_fma_f32 v177, v17, v183, v61
  v_fma_f32 v178, v18, v184, v69
  v_fma_f32 v179, v19, v185, v77
  v_fma_f32 v180, v20, v186, v85
  v_fmac_f32_dpp v176, -v182, v21 quad_perm:[1,0,3,2] row_mask:0xf bank_mask:0xf
  v_fmac_f32_dpp v177, -v183, v22 quad_perm:[1,0,3,2] row_mask:0xf bank_mask:0xf
  v_fmac_f32_dpp v178, -v184, v23 quad_perm:[1,0,3,2] row_mask:0xf bank_mask:0xf
  v_fmac_f32_dpp v179, -v185, v24 quad_perm:[1,0,3,2] row_mask:0xf bank_mask:0xf
  v_fmac_f32_dpp v180, -v186, v25 quad_perm:[1,0,3,2] row_mask:0xf bank_mask:0xf
  v_fma_f32 v182, v16, v176, v54
  v_fma_f32 v183, v17, v177, v62
  v_fma_f32 v184, v18, v178, v70
  v_fma_f32 v185, v19, v179, v78
  v_fma_f32 v186, v20, v180, v86
  v_fmac_f32_dpp v182, -v176, v21 quad_perm:[1,0,3,2] row_mask:0xf bank_mask:0xf
  v_fmac_f32_dpp v183, -v177, v22 quad_perm:[1,0,3,2] row_mask:0xf bank_mask:0xf
  v_fmac_f32_dpp v184, -v178, v23 quad_perm:[1,0,3,2] row_mask:0xf bank_mask:0xf
  v_fmac_f32_dpp v185, -v179, v24 quad_perm:[1,0,3,2] row_mask:0xf bank_mask:0xf
  v_fmac_f32_dpp v186, -v180, v25 quad_perm:[1,0,3,2] row_mask:0xf bank_mask:0xf
  v_fma_f32 v176, v16, v182, v55
  v_fma_f32 v177, v17, v183, v63
  v_fma_f32 v178, v18, v184, v71
  v_fma_f32 v179, v19, v185, v79
  v_fma_f32 v180, v20, v186, v87
  v_fmac_f32_dpp v176, -v182, v21 quad_perm:[1,0,3,2] row_mask:0xf bank_mask:0xf
  v_fmac_f32_dpp v177, -v183, v22 quad_perm:[1,0,3,2] row_mask:0xf bank_mask:0xf
  v_fmac_f32_dpp v178, -v184, v23 quad_perm:[1,0,3,2] row_mask:0xf bank_mask:0xf
  v_fmac_f32_dpp v179, -v185, v24 quad_perm:[1,0,3,2] row_mask:0xf bank_mask:0xf
  v_fmac_f32_dpp v180, -v186, v25 quad_perm:[1,0,3,2] row_mask:0xf bank_mask:0xf
  ds_write_b32 v9, v176 offset:0
  ds_write_b32 v9, v177 offset:1152
  ds_write_b32 v9, v178 offset:2304
  ds_write_b32 v9, v179 offset:3456
  ds_write_b32 v9, v180 offset:4608
  v_min_u32_e64 v11, 39, v1
  v_mul_u32_u24 v12, 144, v11
  v_add_u32 v12, 158080, v12
  s_cmp_lg_u32 s7, 2
  s_waitcnt lgkmcnt(0)
  s_barrier
  s_cbranch_scc1 skip_56
  ds_read_b128 v[208:211], v12 offset:0
  ds_read_b128 v[212:215], v12 offset:16
  ds_read_b128 v[216:219], v12 offset:32
  ds_read_b128 v[220:223], v12 offset:48
  ds_read_b128 v[224:227], v12 offset:64
  ds_read_b128 v[228:231], v12 offset:80
  ds_read_b128 v[232:235], v12 offset:96
  ds_read_b128 v[236:239], v12 offset:112
  v_lshlrev_b32_e64 v11, 4, v11
  s_add_u32 s12, s95, 392448
  v_mov_b32 v44, s8
  v_mov_b32 v45, s8
  s_waitcnt lgkmcnt(7)
  v_pk_fma_f32 v[42:43], v[208:209], v[36:37], v[210:211] op_sel:[1,1,0] op_sel_hi:[0,1,1] neg_lo:[0,1,0]
  v_pk_fma_f32 v[42:43], v[208:209], v[36:37], v[42:43] op_sel:[0,0,0] op_sel_hi:[1,0,1]
  s_waitcnt lgkmcnt(6)
  v_pk_fma_f32 v[46:47], v[42:43], v[36:37], v[212:213] op_sel:[1,1,0] op_sel_hi:[0,1,1] neg_lo:[0,1,0]
  v_pk_fma_f32 v[46:47], v[42:43], v[36:37], v[46:47] op_sel:[0,0,0] op_sel_hi:[1,0,1]
  v_pk_fma_f32 v[42:43], v[46:47], v[36:37], v[214:215] op_sel:[1,1,0] op_sel_hi:[0,1,1] neg_lo:[0,1,0]
  v_pk_fma_f32 v[42:43], v[46:47], v[36:37], v[42:43] op_sel:[0,0,0] op_sel_hi:[1,0,1]
  s_waitcnt lgkmcnt(5)
  v_pk_fma_f32 v[46:47], v[42:43], v[36:37], v[216:217] op_sel:[1,1,0] op_sel_hi:[0,1,1] neg_lo:[0,1,0]
  v_pk_fma_f32 v[46:47], v[42:43], v[36:37], v[46:47] op_sel:[0,0,0] op_sel_hi:[1,0,1]
  v_pk_fma_f32 v[42:43], v[46:47], v[36:37], v[218:219] op_sel:[1,1,0] op_sel_hi:[0,1,1] neg_lo:[0,1,0]
  v_pk_fma_f32 v[42:43], v[46:47], v[36:37], v[42:43] op_sel:[0,0,0] op_sel_hi:[1,0,1]
  s_waitcnt lgkmcnt(4)
  v_pk_fma_f32 v[46:47], v[42:43], v[36:37], v[220:221] op_sel:[1,1,0] op_sel_hi:[0,1,1] neg_lo:[0,1,0]
  v_pk_fma_f32 v[46:47], v[42:43], v[36:37], v[46:47] op_sel:[0,0,0] op_sel_hi:[1,0,1]
  v_pk_fma_f32 v[42:43], v[46:47], v[36:37], v[222:223] op_sel:[1,1,0] op_sel_hi:[0,1,1] neg_lo:[0,1,0]
  v_pk_fma_f32 v[42:43], v[46:47], v[36:37], v[42:43] op_sel:[0,0,0] op_sel_hi:[1,0,1]
  s_waitcnt lgkmcnt(3)
  v_pk_fma_f32 v[46:47], v[42:43], v[36:37], v[224:225] op_sel:[1,1,0] op_sel_hi:[0,1,1] neg_lo:[0,1,0]
  v_pk_fma_f32 v[46:47], v[42:43], v[36:37], v[46:47] op_sel:[0,0,0] op_sel_hi:[1,0,1]
  v_pk_fma_f32 v[42:43], v[46:47], v[36:37], v[226:227] op_sel:[1,1,0] op_sel_hi:[0,1,1] neg_lo:[0,1,0]
  v_pk_fma_f32 v[42:43], v[46:47], v[36:37], v[42:43] op_sel:[0,0,0] op_sel_hi:[1,0,1]
  s_waitcnt lgkmcnt(2)
  v_pk_fma_f32 v[46:47], v[42:43], v[36:37], v[228:229] op_sel:[1,1,0] op_sel_hi:[0,1,1] neg_lo:[0,1,0]
  v_pk_fma_f32 v[46:47], v[42:43], v[36:37], v[46:47] op_sel:[0,0,0] op_sel_hi:[1,0,1]
  v_pk_fma_f32 v[42:43], v[46:47], v[36:37], v[230:231] op_sel:[1,1,0] op_sel_hi:[0,1,1] neg_lo:[0,1,0]
  v_pk_fma_f32 v[42:43], v[46:47], v[36:37], v[42:43] op_sel:[0,0,0] op_sel_hi:[1,0,1]
  s_waitcnt lgkmcnt(1)
  v_pk_fma_f32 v[46:47], v[42:43], v[36:37], v[232:233] op_sel:[1,1,0] op_sel_hi:[0,1,1] neg_lo:[0,1,0]
  v_pk_fma_f32 v[46:47], v[42:43], v[36:37], v[46:47] op_sel:[0,0,0] op_sel_hi:[1,0,1]
  v_pk_fma_f32 v[42:43], v[46:47], v[36:37], v[234:235] op_sel:[1,1,0] op_sel_hi:[0,1,1] neg_lo:[0,1,0]
  v_pk_fma_f32 v[42:43], v[46:47], v[36:37], v[42:43] op_sel:[0,0,0] op_sel_hi:[1,0,1]
  s_waitcnt lgkmcnt(0)
  v_pk_fma_f32 v[46:47], v[42:43], v[36:37], v[236:237] op_sel:[1,1,0] op_sel_hi:[0,1,1] neg_lo:[0,1,0]
  v_pk_fma_f32 v[46:47], v[42:43], v[36:37], v[46:47] op_sel:[0,0,0] op_sel_hi:[1,0,1]
  v_pk_fma_f32 v[42:43], v[46:47], v[36:37], v[238:239] op_sel:[1,1,0] op_sel_hi:[0,1,1] neg_lo:[0,1,0]
  v_pk_fma_f32 v[42:43], v[46:47], v[36:37], v[42:43] op_sel:[0,0,0] op_sel_hi:[1,0,1]
  buffer_store_dwordx4 v[42:45], v11, s[52:55], s12 offen sc1
  v_pk_mul_f32 v[46:47], v[208:209], v[40:41] op_sel:[1,1] op_sel_hi:[0,1] neg_lo:[0,1] neg_hi:[0,1]
  v_pk_fma_f32 v[208:209], v[208:209], v[40:41], v[46:47] op_sel:[0,0,0] op_sel_hi:[1,0,1] neg_hi:[0,1,0]
  v_pk_mul_f32 v[46:47], v[210:211], v[40:41] op_sel:[1,1] op_sel_hi:[0,1] neg_lo:[0,1] neg_hi:[0,1]
  v_pk_fma_f32 v[210:211], v[210:211], v[40:41], v[46:47] op_sel:[0,0,0] op_sel_hi:[1,0,1] neg_hi:[0,1,0]
  v_pk_mul_f32 v[46:47], v[212:213], v[40:41] op_sel:[1,1] op_sel_hi:[0,1] neg_lo:[0,1] neg_hi:[0,1]
  v_pk_fma_f32 v[212:213], v[212:213], v[40:41], v[46:47] op_sel:[0,0,0] op_sel_hi:[1,0,1] neg_hi:[0,1,0]
  v_pk_mul_f32 v[46:47], v[214:215], v[40:41] op_sel:[1,1] op_sel_hi:[0,1] neg_lo:[0,1] neg_hi:[0,1]
  v_pk_fma_f32 v[214:215], v[214:215], v[40:41], v[46:47] op_sel:[0,0,0] op_sel_hi:[1,0,1] neg_hi:[0,1,0]
  v_pk_mul_f32 v[46:47], v[216:217], v[40:41] op_sel:[1,1] op_sel_hi:[0,1] neg_lo:[0,1] neg_hi:[0,1]
  v_pk_fma_f32 v[216:217], v[216:217], v[40:41], v[46:47] op_sel:[0,0,0] op_sel_hi:[1,0,1] neg_hi:[0,1,0]
  v_pk_mul_f32 v[46:47], v[218:219], v[40:41] op_sel:[1,1] op_sel_hi:[0,1] neg_lo:[0,1] neg_hi:[0,1]
  v_pk_fma_f32 v[218:219], v[218:219], v[40:41], v[46:47] op_sel:[0,0,0] op_sel_hi:[1,0,1] neg_hi:[0,1,0]
  v_pk_mul_f32 v[46:47], v[220:221], v[40:41] op_sel:[1,1] op_sel_hi:[0,1] neg_lo:[0,1] neg_hi:[0,1]
  v_pk_fma_f32 v[220:221], v[220:221], v[40:41], v[46:47] op_sel:[0,0,0] op_sel_hi:[1,0,1] neg_hi:[0,1,0]
  v_pk_mul_f32 v[46:47], v[222:223], v[40:41] op_sel:[1,1] op_sel_hi:[0,1] neg_lo:[0,1] neg_hi:[0,1]
  v_pk_fma_f32 v[222:223], v[222:223], v[40:41], v[46:47] op_sel:[0,0,0] op_sel_hi:[1,0,1] neg_hi:[0,1,0]
  v_pk_mul_f32 v[46:47], v[224:225], v[40:41] op_sel:[1,1] op_sel_hi:[0,1] neg_lo:[0,1] neg_hi:[0,1]
  v_pk_fma_f32 v[224:225], v[224:225], v[40:41], v[46:47] op_sel:[0,0,0] op_sel_hi:[1,0,1] neg_hi:[0,1,0]
  v_pk_mul_f32 v[46:47], v[226:227], v[40:41] op_sel:[1,1] op_sel_hi:[0,1] neg_lo:[0,1] neg_hi:[0,1]
  v_pk_fma_f32 v[226:227], v[226:227], v[40:41], v[46:47] op_sel:[0,0,0] op_sel_hi:[1,0,1] neg_hi:[0,1,0]
  v_pk_mul_f32 v[46:47], v[228:229], v[40:41] op_sel:[1,1] op_sel_hi:[0,1] neg_lo:[0,1] neg_hi:[0,1]
  v_pk_fma_f32 v[228:229], v[228:229], v[40:41], v[46:47] op_sel:[0,0,0] op_sel_hi:[1,0,1] neg_hi:[0,1,0]
  v_pk_mul_f32 v[46:47], v[230:231], v[40:41] op_sel:[1,1] op_sel_hi:[0,1] neg_lo:[0,1] neg_hi:[0,1]
  v_pk_fma_f32 v[230:231], v[230:231], v[40:41], v[46:47] op_sel:[0,0,0] op_sel_hi:[1,0,1] neg_hi:[0,1,0]
  v_pk_mul_f32 v[46:47], v[232:233], v[40:41] op_sel:[1,1] op_sel_hi:[0,1] neg_lo:[0,1] neg_hi:[0,1]
  v_pk_fma_f32 v[232:233], v[232:233], v[40:41], v[46:47] op_sel:[0,0,0] op_sel_hi:[1,0,1] neg_hi:[0,1,0]
  v_pk_mul_f32 v[46:47], v[234:235], v[40:41] op_sel:[1,1] op_sel_hi:[0,1] neg_lo:[0,1] neg_hi:[0,1]
  v_pk_fma_f32 v[234:235], v[234:235], v[40:41], v[46:47] op_sel:[0,0,0] op_sel_hi:[1,0,1] neg_hi:[0,1,0]
  v_pk_mul_f32 v[46:47], v[236:237], v[40:41] op_sel:[1,1] op_sel_hi:[0,1] neg_lo:[0,1] neg_hi:[0,1]
  v_pk_fma_f32 v[236:237], v[236:237], v[40:41], v[46:47] op_sel:[0,0,0] op_sel_hi:[1,0,1] neg_hi:[0,1,0]
  v_pk_mul_f32 v[46:47], v[238:239], v[40:41] op_sel:[1,1] op_sel_hi:[0,1] neg_lo:[0,1] neg_hi:[0,1]
  v_pk_fma_f32 v[238:239], v[238:239], v[40:41], v[46:47] op_sel:[0,0,0] op_sel_hi:[1,0,1] neg_hi:[0,1,0]
  s_add_u32 s80, s95, 380928
  s_add_u32 s81, s95, 384768
  s_add_u32 s82, s95, 388608
skip_56:
  v_mul_f32 v88, v26, v48
  v_mul_f32 v89, v26, v49
  v_mul_f32 v90, v26, v50
  v_mul_f32 v91, v26, v51
  v_mul_f32 v92, v26, v52
  v_mul_f32 v93, v26, v53
  v_mul_f32 v94, v26, v54
  v_mul_f32 v95, v26, v55
  v_fmac_f32_dpp v88, v48, v31 quad_perm:[1,0,3,2] row_mask:0xf bank_mask:0xf
  v_fmac_f32_dpp v89, v49, v31 quad_perm:[1,0,3,2] row_mask:0xf bank_mask:0xf
  v_fmac_f32_dpp v90, v50, v31 quad_perm:[1,0,3,2] row_mask:0xf bank_mask:0xf
  v_fmac_f32_dpp v91, v51, v31 quad_perm:[1,0,3,2] row_mask:0xf bank_mask:0xf
  v_fmac_f32_dpp v92, v52, v31 quad_perm:[1,0,3,2] row_mask:0xf bank_mask:0xf
  v_fmac_f32_dpp v93, v53, v31 quad_perm:[1,0,3,2] row_mask:0xf bank_mask:0xf
  v_fmac_f32_dpp v94, v54, v31 quad_perm:[1,0,3,2] row_mask:0xf bank_mask:0xf
  v_fmac_f32_dpp v95, v55, v31 quad_perm:[1,0,3,2] row_mask:0xf bank_mask:0xf
  v_mul_f32 v96, v27, v56
  v_mul_f32 v97, v27, v57
  v_mul_f32 v98, v27, v58
  v_mul_f32 v99, v27, v59
  v_mul_f32 v100, v27, v60
  v_mul_f32 v101, v27, v61
  v_mul_f32 v102, v27, v62
  v_mul_f32 v103, v27, v63
  v_fmac_f32_dpp v96, v56, v32 quad_perm:[1,0,3,2] row_mask:0xf bank_mask:0xf
  v_fmac_f32_dpp v97, v57, v32 quad_perm:[1,0,3,2] row_mask:0xf bank_mask:0xf
  v_fmac_f32_dpp v98, v58, v32 quad_perm:[1,0,3,2] row_mask:0xf bank_mask:0xf
  v_fmac_f32_dpp v99, v59, v32 quad_perm:[1,0,3,2] row_mask:0xf bank_mask:0xf
  v_fmac_f32_dpp v100, v60, v32 quad_perm:[1,0,3,2] row_mask:0xf bank_mask:0xf
  v_fmac_f32_dpp v101, v61, v32 quad_perm:[1,0,3,2] row_mask:0xf bank_mask:0xf
  v_fmac_f32_dpp v102, v62, v32 quad_perm:[1,0,3,2] row_mask:0xf bank_mask:0xf
  v_fmac_f32_dpp v103, v63, v32 quad_perm:[1,0,3,2] row_mask:0xf bank_mask:0xf
  v_mul_f32 v104, v28, v64
  v_mul_f32 v105, v28, v65
  v_mul_f32 v106, v28, v66
  v_mul_f32 v107, v28, v67
  v_mul_f32 v108, v28, v68
  v_mul_f32 v109, v28, v69
  v_mul_f32 v110, v28, v70
  v_mul_f32 v111, v28, v71
  v_fmac_f32_dpp v104, v64, v33 quad_perm:[1,0,3,2] row_mask:0xf bank_mask:0xf
  v_fmac_f32_dpp v105, v65, v33 quad_perm:[1,0,3,2] row_mask:0xf bank_mask:0xf
  v_fmac_f32_dpp v106, v66, v33 quad_perm:[1,0,3,2] row_mask:0xf bank_mask:0xf
  v_fmac_f32_dpp v107, v67, v33 quad_perm:[1,0,3,2] row_mask:0xf bank_mask:0xf
  v_fmac_f32_dpp v108, v68, v33 quad_perm:[1,0,3,2] row_mask:0xf bank_mask:0xf
  v_fmac_f32_dpp v109, v69, v33 quad_perm:[1,0,3,2] row_mask:0xf bank_mask:0xf
  v_fmac_f32_dpp v110, v70, v33 quad_perm:[1,0,3,2] row_mask:0xf bank_mask:0xf
  v_fmac_f32_dpp v111, v71, v33 quad_perm:[1,0,3,2] row_mask:0xf bank_mask:0xf
  v_mul_f32 v112, v29, v72
  v_mul_f32 v113, v29, v73
  v_mul_f32 v114, v29, v74
  v_mul_f32 v115, v29, v75
  v_mul_f32 v116, v29, v76
  v_mul_f32 v117, v29, v77
  v_mul_f32 v118, v29, v78
  v_mul_f32 v119, v29, v79
  v_fmac_f32_dpp v112, v72, v34 quad_perm:[1,0,3,2] row_mask:0xf bank_mask:0xf
  v_fmac_f32_dpp v113, v73, v34 quad_perm:[1,0,3,2] row_mask:0xf bank_mask:0xf
  v_fmac_f32_dpp v114, v74, v34 quad_perm:[1,0,3,2] row_mask:0xf bank_mask:0xf
  v_fmac_f32_dpp v115, v75, v34 quad_perm:[1,0,3,2] row_mask:0xf bank_mask:0xf
  v_fmac_f32_dpp v116, v76, v34 quad_perm:[1,0,3,2] row_mask:0xf bank_mask:0xf
  v_fmac_f32_dpp v117, v77, v34 quad_perm:[1,0,3,2] row_mask:0xf bank_mask:0xf
  v_fmac_f32_dpp v118, v78, v34 quad_perm:[1,0,3,2] row_mask:0xf bank_mask:0xf
  v_fmac_f32_dpp v119, v79, v34 quad_perm:[1,0,3,2] row_mask:0xf bank_mask:0xf
  v_mul_f32 v120, v30, v80
  v_mul_f32 v121, v30, v81
  v_mul_f32 v122, v30, v82
  v_mul_f32 v123, v30, v83
  v_mul_f32 v124, v30, v84
  v_mul_f32 v125, v30, v85
  v_mul_f32 v126, v30, v86
  v_mul_f32 v127, v30, v87
  v_fmac_f32_dpp v120, v80, v35 quad_perm:[1,0,3,2] row_mask:0xf bank_mask:0xf
  v_fmac_f32_dpp v121, v81, v35 quad_perm:[1,0,3,2] row_mask:0xf bank_mask:0xf
  v_fmac_f32_dpp v122, v82, v35 quad_perm:[1,0,3,2] row_mask:0xf bank_mask:0xf
  v_fmac_f32_dpp v123, v83, v35 quad_perm:[1,0,3,2] row_mask:0xf bank_mask:0xf
  v_fmac_f32_dpp v124, v84, v35 quad_perm:[1,0,3,2] row_mask:0xf bank_mask:0xf
  v_fmac_f32_dpp v125, v85, v35 quad_perm:[1,0,3,2] row_mask:0xf bank_mask:0xf
  v_fmac_f32_dpp v126, v86, v35 quad_perm:[1,0,3,2] row_mask:0xf bank_mask:0xf
  v_fmac_f32_dpp v127, v87, v35 quad_perm:[1,0,3,2] row_mask:0xf bank_mask:0xf
  s_mul_i32 s12, s7, 1280
  s_add_u32 s12, s12, 152320
  v_mul_u32_u24 v11, 80, v3
  v_lshl_add_u32 v11, v4, 4, v11
  v_add_u32_e64 v252, s12, v11
  v_bfe_u32 v12, v1, 2, 2
  v_mul_u32_u24 v12, 160, v12
  v_and_b32_e64 v13, 3, v1
  v_lshl_add_u32 v12, v13, 4, v12
  v_lshrrev_b32_e64 v13, 1, v4
  v_mul_u32_u24 v14, 80, v13
  v_lshlrev_b32_e64 v13, 10, v13
  v_add3_u32 v12, v12, v14, s12
  v_and_b32_e64 v14, 1, v4
  v_lshl_add_u32 v253, v14, 3, v12
  v_mul_u32_u24 v14, 40960, v14
  v_lshl_add_u32 v13, v3, 4, v13
  v_add_u32 v254, v13, v14
  s_cmp_lg_u32 s7, 2
  s_cbranch_scc1 skip_57
  v_min_u32 v251, 39, v1
  v_mul_u32_u24 v247, 144, v251
  v_add_u32 v247, 158080, v247
  v_lshlrev_b32_e64 v251, 4, v251
aggpoll_58:
  buffer_load_dwordx3 v[128:130], v251, s[52:55], s80 offen offset:0 sc1
  buffer_load_dwordx3 v[132:134], v251, s[52:55], s80 offen offset:768 sc1
  buffer_load_dwordx3 v[136:138], v251, s[52:55], s80 offen offset:1536 sc1
  buffer_load_dwordx3 v[140:142], v251, s[52:55], s80 offen offset:2304 sc1
  buffer_load_dwordx3 v[144:146], v251, s[52:55], s80 offen offset:3072 sc1
  buffer_load_dwordx3 v[148:150], v251, s[52:55], s81 offen offset:0 sc1
  buffer_load_dwordx3 v[152:154], v251, s[52:55], s81 offen offset:768 sc1
  buffer_load_dwordx3 v[156:158], v251, s[52:55], s81 offen offset:1536 sc1
  buffer_load_dwordx3 v[160:162], v251, s[52:55], s81 offen offset:2304 sc1
  buffer_load_dwordx3 v[164:166], v251, s[52:55], s81 offen offset:3072 sc1
  buffer_load_dwordx3 v[168:170], v251, s[52:55], s82 offen offset:0 sc1
  buffer_load_dwordx3 v[172:174], v251, s[52:55], s82 offen offset:768 sc1
  buffer_load_dwordx3 v[240:242], v251, s[52:55], s82 offen offset:1536 sc1
  buffer_load_dwordx3 v[244:246], v251, s[52:55], s82 offen offset:2304 sc1
  buffer_load_dwordx3 v[248:250], v251, s[52:55], s82 offen offset:3072 sc1
  s_waitcnt vmcnt(0)
  v_min3_u32 v13, v130, v134, v138
  v_max3_u32 v14, v130, v134, v138
  v_min3_u32 v13, v13, v142, v146
  v_max3_u32 v14, v14, v142, v146
  v_min3_u32 v13, v13, v150, v154
  v_max3_u32 v14, v14, v150, v154
  v_min3_u32 v13, v13, v158, v162
  v_max3_u32 v14, v14, v158, v162
  v_min3_u32 v13, v13, v166, v170
  v_max3_u32 v14, v14, v166, v170
  v_min3_u32 v13, v13, v174, v242
  v_max3_u32 v14, v14, v174, v242
  v_min3_u32 v13, v13, v246, v250
  v_max3_u32 v14, v14, v246, v250
  v_xor_b32 v13, s8, v13
  v_xor_b32 v14, s8, v14
  v_or_b32 v13, v13, v14
  v_cmp_ne_u32 vcc, 0, v13
  s_cbranch_vccnz retry_60
giveup_61:
  v_pk_fma_f32 v[42:43], v[128:129], v[38:39], v[132:133] op_sel:[1,1,0] op_sel_hi:[0,1,1] neg_lo:[0,1,0]
  v_pk_fma_f32 v[42:43], v[128:129], v[38:39], v[42:43] op_sel:[0,0,0] op_sel_hi:[1,0,1]
  v_pk_fma_f32 v[44:45], v[42:43], v[38:39], v[136:137] op_sel:[1,1,0] op_sel_hi:[0,1,1] neg_lo:[0,1,0]
  v_pk_fma_f32 v[44:45], v[42:43], v[38:39], v[44:45] op_sel:[0,0,0] op_sel_hi:[1,0,1]
  v_pk_fma_f32 v[42:43], v[44:45], v[38:39], v[140:141] op_sel:[1,1,0] op_sel_hi:[0,1,1] neg_lo:[0,1,0]
  v_pk_fma_f32 v[42:43], v[44:45], v[38:39], v[42:43] op_sel:[0,0,0] op_sel_hi:[1,0,1]
  v_pk_fma_f32 v[44:45], v[42:43], v[38:39], v[144:145] op_sel:[1,1,0] op_sel_hi:[0,1,1] neg_lo:[0,1,0]
  v_pk_fma_f32 v[44:45], v[42:43], v[38:39], v[44:45] op_sel:[0,0,0] op_sel_hi:[1,0,1]
  v_pk_fma_f32 v[42:43], v[44:45], v[38:39], v[148:149] op_sel:[1,1,0] op_sel_hi:[0,1,1] neg_lo:[0,1,0]
  v_pk_fma_f32 v[42:43], v[44:45], v[38:39], v[42:43] op_sel:[0,0,0] op_sel_hi:[1,0,1]
  v_pk_fma_f32 v[44:45], v[42:43], v[38:39], v[152:153] op_sel:[1,1,0] op_sel_hi:[0,1,1] neg_lo:[0,1,0]
  v_pk_fma_f32 v[44:45], v[42:43], v[38:39], v[44:45] op_sel:[0,0,0] op_sel_hi:[1,0,1]
  v_pk_fma_f32 v[42:43], v[44:45], v[38:39], v[156:157] op_sel:[1,1,0] op_sel_hi:[0,1,1] neg_lo:[0,1,0]
  v_pk_fma_f32 v[42:43], v[44:45], v[38:39], v[42:43] op_sel:[0,0,0] op_sel_hi:[1,0,1]
  v_pk_fma_f32 v[44:45], v[42:43], v[38:39], v[160:161] op_sel:[1,1,0] op_sel_hi:[0,1,1] neg_lo:[0,1,0]
  v_pk_fma_f32 v[44:45], v[42:43], v[38:39], v[44:45] op_sel:[0,0,0] op_sel_hi:[1,0,1]
  v_pk_fma_f32 v[42:43], v[44:45], v[38:39], v[164:165] op_sel:[1,1,0] op_sel_hi:[0,1,1] neg_lo:[0,1,0]
  v_pk_fma_f32 v[42:43], v[44:45], v[38:39], v[42:43] op_sel:[0,0,0] op_sel_hi:[1,0,1]
  v_pk_fma_f32 v[44:45], v[42:43], v[38:39], v[168:169] op_sel:[1,1,0] op_sel_hi:[0,1,1] neg_lo:[0,1,0]
  v_pk_fma_f32 v[44:45], v[42:43], v[38:39], v[44:45] op_sel:[0,0,0] op_sel_hi:[1,0,1]
  v_pk_fma_f32 v[42:43], v[44:45], v[38:39], v[172:173] op_sel:[1,1,0] op_sel_hi:[0,1,1] neg_lo:[0,1,0]
  v_pk_fma_f32 v[42:43], v[44:45], v[38:39], v[42:43] op_sel:[0,0,0] op_sel_hi:[1,0,1]
  v_pk_fma_f32 v[44:45], v[42:43], v[38:39], v[240:241] op_sel:[1,1,0] op_sel_hi:[0,1,1] neg_lo:[0,1,0]
  v_pk_fma_f32 v[44:45], v[42:43], v[38:39], v[44:45] op_sel:[0,0,0] op_sel_hi:[1,0,1]
  v_pk_fma_f32 v[42:43], v[44:45], v[38:39], v[244:245] op_sel:[1,1,0] op_sel_hi:[0,1,1] neg_lo:[0,1,0]
  v_pk_fma_f32 v[42:43], v[44:45], v[38:39], v[42:43] op_sel:[0,0,0] op_sel_hi:[1,0,1]
  v_pk_fma_f32 v[44:45], v[42:43], v[38:39], v[248:249] op_sel:[1,1,0] op_sel_hi:[0,1,1] neg_lo:[0,1,0]
  v_pk_fma_f32 v[44:45], v[42:43], v[38:39], v[44:45] op_sel:[0,0,0] op_sel_hi:[1,0,1]
  v_pk_mul_f32 v[46:47], v[44:45], v[40:41] op_sel:[1,1] op_sel_hi:[0,1] neg_lo:[0,1] neg_hi:[0,1]
  v_pk_fma_f32 v[128:129], v[44:45], v[40:41], v[46:47] op_sel:[0,0,0] op_sel_hi:[1,0,1] neg_hi:[0,1,0]
  s_mov_b32 exec_hi, 0xff
  v_pk_fma_f32 v[130:131], v[128:129], v[36:37], v[208:209] op_sel:[1,1,0] op_sel_hi:[0,1,1] neg_hi:[0,1,0]
  v_pk_fma_f32 v[130:131], v[128:129], v[36:37], v[130:131] op_sel:[0,0,0] op_sel_hi:[1,0,1]
  ds_write_b128 v247, v[128:131] offset:0
  v_pk_fma_f32 v[132:133], v[130:131], v[36:37], v[210:211] op_sel:[1,1,0] op_sel_hi:[0,1,1] neg_hi:[0,1,0]
  v_pk_fma_f32 v[132:133], v[130:131], v[36:37], v[132:133] op_sel:[0,0,0] op_sel_hi:[1,0,1]
  v_pk_fma_f32 v[134:135], v[132:133], v[36:37], v[212:213] op_sel:[1,1,0] op_sel_hi:[0,1,1] neg_hi:[0,1,0]
  v_pk_fma_f32 v[134:135], v[132:133], v[36:37], v[134:135] op_sel:[0,0,0] op_sel_hi:[1,0,1]
  ds_write_b128 v247, v[132:135] offset:16
  v_pk_fma_f32 v[136:137], v[134:135], v[36:37], v[214:215] op_sel:[1,1,0] op_sel_hi:[0,1,1] neg_hi:[0,1,0]
  v_pk_fma_f32 v[136:137], v[134:135], v[36:37], v[136:137] op_sel:[0,0,0] op_sel_hi:[1,0,1]
  v_pk_fma_f32 v[138:139], v[136:137], v[36:37], v[216:217] op_sel:[1,1,0] op_sel_hi:[0,1,1] neg_hi:[0,1,0]
  v_pk_fma_f32 v[138:139], v[136:137], v[36:37], v[138:139] op_sel:[0,0,0] op_sel_hi:[1,0,1]
  ds_write_b128 v247, v[136:139] offset:32
  v_pk_fma_f32 v[140:141], v[138:139], v[36:37], v[218:219] op_sel:[1,1,0] op_sel_hi:[0,1,1] neg_hi:[0,1,0]
  v_pk_fma_f32 v[140:141], v[138:139], v[36:37], v[140:141] op_sel:[0,0,0] op_sel_hi:[1,0,1]
  v_pk_fma_f32 v[142:143], v[140:141], v[36:37], v[220:221] op_sel:[1,1,0] op_sel_hi:[0,1,1] neg_hi:[0,1,0]
  v_pk_fma_f32 v[142:143], v[140:141], v[36:37], v[142:143] op_sel:[0,0,0] op_sel_hi:[1,0,1]
  ds_write_b128 v247, v[140:143] offset:48
  v_pk_fma_f32 v[144:145], v[142:143], v[36:37], v[222:223] op_sel:[1,1,0] op_sel_hi:[0,1,1] neg_hi:[0,1,0]
  v_pk_fma_f32 v[144:145], v[142:143], v[36:37], v[144:145] op_sel:[0,0,0] op_sel_hi:[1,0,1]
  v_pk_fma_f32 v[146:147], v[144:145], v[36:37], v[224:225] op_sel:[1,1,0] op_sel_hi:[0,1,1] neg_hi:[0,1,0]
  v_pk_fma_f32 v[146:147], v[144:145], v[36:37], v[146:147] op_sel:[0,0,0] op_sel_hi:[1,0,1]
  ds_write_b128 v247, v[144:147] offset:64
  v_pk_fma_f32 v[148:149], v[146:147], v[36:37], v[226:227] op_sel:[1,1,0] op_sel_hi:[0,1,1] neg_hi:[0,1,0]
  v_pk_fma_f32 v[148:149], v[146:147], v[36:37], v[148:149] op_sel:[0,0,0] op_sel_hi:[1,0,1]
  v_pk_fma_f32 v[150:151], v[148:149], v[36:37], v[228:229] op_sel:[1,1,0] op_sel_hi:[0,1,1] neg_hi:[0,1,0]
  v_pk_fma_f32 v[150:151], v[148:149], v[36:37], v[150:151] op_sel:[0,0,0] op_sel_hi:[1,0,1]
  ds_write_b128 v247, v[148:151] offset:80
  v_pk_fma_f32 v[152:153], v[150:151], v[36:37], v[230:231] op_sel:[1,1,0] op_sel_hi:[0,1,1] neg_hi:[0,1,0]
  v_pk_fma_f32 v[152:153], v[150:151], v[36:37], v[152:153] op_sel:[0,0,0] op_sel_hi:[1,0,1]
  v_pk_fma_f32 v[154:155], v[152:153], v[36:37], v[232:233] op_sel:[1,1,0] op_sel_hi:[0,1,1] neg_hi:[0,1,0]
  v_pk_fma_f32 v[154:155], v[152:153], v[36:37], v[154:155] op_sel:[0,0,0] op_sel_hi:[1,0,1]
  ds_write_b128 v247, v[152:155] offset:96
  v_pk_fma_f32 v[156:157], v[154:155], v[36:37], v[234:235] op_sel:[1,1,0] op_sel_hi:[0,1,1] neg_hi:[0,1,0]
  v_pk_fma_f32 v[156:157], v[154:155], v[36:37], v[156:157] op_sel:[0,0,0] op_sel_hi:[1,0,1]
  v_pk_fma_f32 v[158:159], v[156:157], v[36:37], v[236:237] op_sel:[1,1,0] op_sel_hi:[0,1,1] neg_hi:[0,1,0]
  v_pk_fma_f32 v[158:159], v[156:157], v[36:37], v[158:159] op_sel:[0,0,0] op_sel_hi:[1,0,1]
  ds_write_b128 v247, v[156:159] offset:112
  s_mov_b32 exec_hi, -1
skip_57:
  s_waitcnt lgkmcnt(0)
  s_barrier
  ds_read_b32 v48, v9 offset:0
  ds_read_b32 v49, v9 offset:1152
  ds_read_b32 v50, v9 offset:2304
  ds_read_b32 v51, v9 offset:3456
  ds_read_b32 v52, v9 offset:4608
  s_waitcnt lgkmcnt(0)
  v_fmac_f32 v88, v16, v48
  v_fmac_f32 v96, v17, v49
  v_fmac_f32_e64 v104, v18, v50
  v_fmac_f32_dpp v88, v48, v21 quad_perm:[1,0,3,2] row_mask:0xf bank_mask:0xf
  v_fmac_f32_dpp v96, v49, v22 quad_perm:[1,0,3,2] row_mask:0xf bank_mask:0xf
  v_fmac_f32_dpp v104, v50, v23 quad_perm:[1,0,3,2] row_mask:0xf bank_mask:0xf
  v_fmac_f32 v89, v16, v88
  v_fmac_f32 v97, v17, v96
  v_fmac_f32_e64 v105, v18, v104
  v_fmac_f32_dpp v89, v88, v21 quad_perm:[1,0,3,2] row_mask:0xf bank_mask:0xf
  v_fmac_f32_dpp v97, v96, v22 quad_perm:[1,0,3,2] row_mask:0xf bank_mask:0xf
  v_fmac_f32_dpp v105, v104, v23 quad_perm:[1,0,3,2] row_mask:0xf bank_mask:0xf
  v_fmac_f32 v90, v16, v89
  v_fmac_f32 v98, v17, v97
  v_fmac_f32_e64 v106, v18, v105
  v_fmac_f32_dpp v90, v89, v21 quad_perm:[1,0,3,2] row_mask:0xf bank_mask:0xf
  v_fmac_f32_dpp v98, v97, v22 quad_perm:[1,0,3,2] row_mask:0xf bank_mask:0xf
  v_fmac_f32_dpp v106, v105, v23 quad_perm:[1,0,3,2] row_mask:0xf bank_mask:0xf
  v_fmac_f32 v91, v16, v90
  v_fmac_f32 v99, v17, v98
  v_fmac_f32_e64 v107, v18, v106
  v_fmac_f32_dpp v91, v90, v21 quad_perm:[1,0,3,2] row_mask:0xf bank_mask:0xf
  v_fmac_f32_dpp v99, v98, v22 quad_perm:[1,0,3,2] row_mask:0xf bank_mask:0xf
  v_fmac_f32_dpp v107, v106, v23 quad_perm:[1,0,3,2] row_mask:0xf bank_mask:0xf
  v_fmac_f32 v92, v16, v91
  v_fmac_f32 v100, v17, v99
  v_fmac_f32_e64 v108, v18, v107
  v_fmac_f32_dpp v92, v91, v21 quad_perm:[1,0,3,2] row_mask:0xf bank_mask:0xf
  v_fmac_f32_dpp v100, v99, v22 quad_perm:[1,0,3,2] row_mask:0xf bank_mask:0xf
  v_fmac_f32_dpp v108, v107, v23 quad_perm:[1,0,3,2] row_mask:0xf bank_mask:0xf
  v_fmac_f32 v93, v16, v92
  v_fmac_f32 v101, v17, v100
  v_fmac_f32_e64 v109, v18, v108
  v_fmac_f32_dpp v93, v92, v21 quad_perm:[1,0,3,2] row_mask:0xf bank_mask:0xf
  v_fmac_f32_dpp v101, v100, v22 quad_perm:[1,0,3,2] row_mask:0xf bank_mask:0xf
  v_fmac_f32_dpp v109, v108, v23 quad_perm:[1,0,3,2] row_mask:0xf bank_mask:0xf
  v_fmac_f32 v94, v16, v93
  v_fmac_f32 v102, v17, v101
  v_fmac_f32_e64 v110, v18, v109
  v_fmac_f32_dpp v94, v93, v21 quad_perm:[1,0,3,2] row_mask:0xf bank_mask:0xf
  v_fmac_f32_dpp v102, v101, v22 quad_perm:[1,0,3,2] row_mask:0xf bank_mask:0xf
  v_fmac_f32_dpp v110, v109, v23 quad_perm:[1,0,3,2] row_mask:0xf bank_mask:0xf
  v_fmac_f32 v95, v16, v94
  v_fmac_f32 v103, v17, v102
  v_fmac_f32_e64 v111, v18, v110
  v_fmac_f32_dpp v95, v94, v21 quad_perm:[1,0,3,2] row_mask:0xf bank_mask:0xf
  v_fmac_f32_dpp v103, v102, v22 quad_perm:[1,0,3,2] row_mask:0xf bank_mask:0xf
  v_fmac_f32_dpp v111, v110, v23 quad_perm:[1,0,3,2] row_mask:0xf bank_mask:0xf
  v_fmac_f32 v112, v19, v51
  v_fmac_f32 v120, v20, v52
  v_cvt_pk_bf16_f32 v56, v88, v89
  v_cvt_pk_bf16_f32 v57, v90, v91
  v_cvt_pk_bf16_f32 v58, v92, v93
  v_fmac_f32_dpp v112, v51, v24 quad_perm:[1,0,3,2] row_mask:0xf bank_mask:0xf
  v_fmac_f32_dpp v120, v52, v25 quad_perm:[1,0,3,2] row_mask:0xf bank_mask:0xf
  v_fmac_f32 v113, v19, v112
  v_fmac_f32 v121, v20, v120
  v_cvt_pk_bf16_f32 v59, v94, v95
  ds_write_b128 v252, v[56:59]
  ds_read_b64_tr_b16 v[68:69], v253
  v_fmac_f32_dpp v113, v112, v24 quad_perm:[1,0,3,2] row_mask:0xf bank_mask:0xf
  v_fmac_f32_dpp v121, v120, v25 quad_perm:[1,0,3,2] row_mask:0xf bank_mask:0xf
  v_fmac_f32 v114, v19, v113
  v_fmac_f32 v122, v20, v121
  ds_read_b64_tr_b16 v[70:71], v253 offset:640
  v_cvt_pk_bf16_f32 v60, v96, v97
  v_cvt_pk_bf16_f32 v61, v98, v99
  v_fmac_f32_dpp v114, v113, v24 quad_perm:[1,0,3,2] row_mask:0xf bank_mask:0xf
  v_fmac_f32_dpp v122, v121, v25 quad_perm:[1,0,3,2] row_mask:0xf bank_mask:0xf
  v_fmac_f32 v115, v19, v114
  v_fmac_f32 v123, v20, v122
  v_cvt_pk_bf16_f32 v62, v100, v101
  v_cvt_pk_bf16_f32 v63, v102, v103
  ds_write_b128 v252, v[60:63]
  v_fmac_f32_dpp v115, v114, v24 quad_perm:[1,0,3,2] row_mask:0xf bank_mask:0xf
  v_fmac_f32_dpp v123, v122, v25 quad_perm:[1,0,3,2] row_mask:0xf bank_mask:0xf
  v_fmac_f32 v116, v19, v115
  v_fmac_f32 v124, v20, v123
  ds_read_b64_tr_b16 v[72:73], v253
  ds_read_b64_tr_b16 v[74:75], v253 offset:640
  v_cvt_pk_bf16_f32 v64, v104, v105
  v_fmac_f32_dpp v116, v115, v24 quad_perm:[1,0,3,2] row_mask:0xf bank_mask:0xf
  v_fmac_f32_dpp v124, v123, v25 quad_perm:[1,0,3,2] row_mask:0xf bank_mask:0xf
  v_fmac_f32 v117, v19, v116
  v_fmac_f32 v125, v20, v124
  v_cvt_pk_bf16_f32 v65, v106, v107
  v_cvt_pk_bf16_f32 v66, v108, v109
  v_fmac_f32_dpp v117, v116, v24 quad_perm:[1,0,3,2] row_mask:0xf bank_mask:0xf
  v_fmac_f32_dpp v125, v124, v25 quad_perm:[1,0,3,2] row_mask:0xf bank_mask:0xf
  v_fmac_f32 v118, v19, v117
  v_fmac_f32 v126, v20, v125
  v_cvt_pk_bf16_f32 v67, v110, v111
  ds_write_b128 v252, v[64:67]
  v_fmac_f32_dpp v118, v117, v24 quad_perm:[1,0,3,2] row_mask:0xf bank_mask:0xf
  v_fmac_f32_dpp v126, v125, v25 quad_perm:[1,0,3,2] row_mask:0xf bank_mask:0xf
  v_fmac_f32 v119, v19, v118
  v_fmac_f32 v127, v20, v126
  ds_read_b64_tr_b16 v[76:77], v253
  ds_read_b64_tr_b16 v[78:79], v253 offset:640
  v_fmac_f32_dpp v119, v118, v24 quad_perm:[1,0,3,2] row_mask:0xf bank_mask:0xf
  v_fmac_f32_dpp v127, v126, v25 quad_perm:[1,0,3,2] row_mask:0xf bank_mask:0xf
  s_cmp_eq_u32 s9, 0
  s_cbranch_scc1 slow_62
  s_add_u32 s13, s75, 10485760
  s_waitcnt lgkmcnt(6)
  buffer_store_dwordx4 v[68:71], v254, s[52:55], s13 offen
  s_add_u32 s13, s76, 10485760
  s_waitcnt lgkmcnt(3)
  buffer_store_dwordx4 v[72:75], v254, s[52:55], s13 offen
  s_add_u32 s13, s77, 10485760
  s_waitcnt lgkmcnt(0)
  buffer_store_dwordx4 v[76:79], v254, s[52:55], s13 offen
back_63:
  v_cvt_pk_bf16_f32 v56, v112, v113
  v_cvt_pk_bf16_f32 v57, v114, v115
  v_cvt_pk_bf16_f32 v58, v116, v117
  v_cvt_pk_bf16_f32 v59, v118, v119
  ds_write_b128 v252, v[56:59]
  ds_read_b64_tr_b16 v[80:81], v253
  ds_read_b64_tr_b16 v[82:83], v253 offset:640
  v_cvt_pk_bf16_f32 v60, v120, v121
  v_cvt_pk_bf16_f32 v61, v122, v123
  v_cvt_pk_bf16_f32 v62, v124, v125
  v_cvt_pk_bf16_f32 v63, v126, v127
  ds_write_b128 v252, v[60:63]
  ds_read_b64_tr_b16 v[84:85], v253
  ds_read_b64_tr_b16 v[86:87], v253 offset:640
  s_cmp_eq_u32 s9, 0
  s_cbranch_scc1 slow_64
  s_add_u32 s13, s78, 10485760
  s_waitcnt lgkmcnt(3)
  buffer_store_dwordx4 v[80:83], v254, s[52:55], s13 offen
  s_add_u32 s13, s79, 10485760
  s_waitcnt lgkmcnt(0)
  buffer_store_dwordx4 v[84:87], v254, s[52:55], s13 offen
back_65:
  s_add_u32 s12, s73, 16384
  s_waitcnt vmcnt(0)
  v_mov_b32 v15, s8
  s_mov_b64 exec, 1
  s_cmp_eq_u32 s9, 0
  s_cbranch_scc1 slow_66
  buffer_store_dword v15, off, s[52:55], s12
back_67:
  s_mov_b64 exec, -1
  v_accvgpr_read_b32 v108, a220
  v_accvgpr_read_b32 v109, a221
  v_accvgpr_read_b32 v110, a222
  v_accvgpr_read_b32 v111, a223
  v_accvgpr_read_b32 v112, a224
  v_accvgpr_read_b32 v113, a225
  v_accvgpr_read_b32 v114, a226
  v_accvgpr_read_b32 v115, a227
  v_accvgpr_read_b32 v116, a228
  v_accvgpr_read_b32 v117, a229
  v_accvgpr_read_b32 v118, a230
  v_accvgpr_read_b32 v119, a231
  v_accvgpr_read_b32 v120, a232
  v_accvgpr_read_b32 v121, a233
  v_accvgpr_read_b32 v122, a234
  v_accvgpr_read_b32 v123, a235
  v_accvgpr_read_b32 v124, a236
  v_accvgpr_read_b32 v125, a237
  v_accvgpr_read_b32 v126, a238
  v_accvgpr_read_b32 v127, a239
  v_accvgpr_read_b32 v160, a208
  v_accvgpr_read_b32 v161, a209
  v_accvgpr_read_b32 v162, a210
  v_accvgpr_read_b32 v163, a211
  v_accvgpr_read_b32 v164, a212
  v_accvgpr_read_b32 v165, a213
  v_accvgpr_read_b32 v166, a214
  v_accvgpr_read_b32 v167, a215
  v_accvgpr_read_b32 v168, a216
  v_accvgpr_read_b32 v169, a217
  v_lshlrev_b32 v88, 16, v160
  v_and_b32 v89, 0xffff0000, v160
  v_lshlrev_b32_e64 v90, 16, v161
  v_and_b32 v91, 0xffff0000, v161
  v_lshlrev_b32_e64 v92, 16, v162
  v_and_b32 v93, 0xffff0000, v162
  v_lshlrev_b32_e64 v94, 16, v163
  v_and_b32 v95, 0xffff0000, v163
  v_lshlrev_b32_e64 v96, 16, v164
  v_and_b32 v97, 0xffff0000, v164
  v_lshlrev_b32_e64 v98, 16, v165
  v_and_b32 v99, 0xffff0000, v165
  v_lshlrev_b32_e64 v100, 16, v166
  v_and_b32 v101, 0xffff0000, v166
  v_lshlrev_b32_e64 v102, 16, v167
  v_and_b32 v103, 0xffff0000, v167
  v_lshlrev_b32_e64 v104, 16, v168
  v_and_b32 v105, 0xffff0000, v168
  v_lshlrev_b32_e64 v106, 16, v169
  v_and_b32 v107, 0xffff0000, v169
  s_mul_i32 s13, s5, 163840
  s_mul_i32 s14, s7, 10240
  s_add_u32 s13, s13, s14
  s_add_u32 s13, s13, 10485760
  s_add_u32 s14, s7, 1
  s_and_b32 s14, s14, 3
  s_mul_i32 s15, s14, 40960
  s_add_u32 s36, s15, s13
  s_mul_i32 s15, s14, 15360
  s_add_u32 s15, s15, 102400
  v_add_u32 v44, s15, v2
  s_add_u32 s14, s7, 2
  s_and_b32 s14, s14, 3
  s_mul_i32 s15, s14, 40960
  s_add_u32 s37, s15, s13
  s_mul_i32 s15, s14, 15360
  s_add_u32 s15, s15, 107520
  v_add_u32 v45, s15, v2
  s_add_u32 s14, s7, 3
  s_and_b32 s14, s14, 3
  s_mul_i32 s15, s14, 40960
  s_add_u32 s38, s15, s13
  s_mul_i32 s15, s14, 15360
  s_add_u32 s15, s15, 112640
  v_add_u32 v46, s15, v2
  s_add_u32 s14, s7, 4
  s_and_b32 s14, s14, 3
  s_mul_i32 s15, s14, 40960
  s_add_u32 s39, s15, s13
  s_lshl_b32 s15, s3, 8
  s_lshl_b32 s13, s7, 6
  s_add_u32 s15, s15, s13
  s_and_b32 s13, s5, 1
  s_lshl_b32 s13, s13, 3
  s_add_u32 s15, s15, s13
  s_add_u32 s15, s15, 16384
  v_and_b32 v242, 3, v1
  v_lshlrev_b32 v242, 4, v242
  s_barrier
poll_68:
  buffer_load_dwordx2 v[42:43], v242, s[52:55], s15 offen sc1
  s_waitcnt vmcnt(0)
  v_xor_b32 v15, s8, v42
  v_xor_b32 v14, s8, v43
  v_or_b32 v15, v15, v14
  v_cmp_ne_u32 vcc, 0, v15
  s_cbranch_vccnz retry_69
giveup_70:
  buffer_load_dwordx4 v[128:131], v2, s[52:55], s36 offen offset:0 sc1
  buffer_load_dwordx4 v[132:135], v2, s[52:55], s36 offen offset:1024 sc1
  buffer_load_dwordx4 v[136:139], v2, s[52:55], s36 offen offset:2048 sc1
  buffer_load_dwordx4 v[140:143], v2, s[52:55], s36 offen offset:3072 sc1
  s_add_u32 s36, s36, 4096
  buffer_load_dwordx4 v[144:147], v2, s[52:55], s36 offen offset:0 sc1
  buffer_load_dwordx4 v[148:151], v2, s[52:55], s36 offen offset:1024 sc1
  buffer_load_dwordx4 v[152:155], v2, s[52:55], s36 offen offset:2048 sc1
  buffer_load_dwordx4 v[156:159], v2, s[52:55], s36 offen offset:3072 sc1
  s_waitcnt vmcnt(7)
  v_mfma_f32_16x16x32_bf16 v[48:51], a[0:3], v[128:131], 0
  s_add_u32 s36, s36, 4096
  buffer_load_dwordx4 v[160:163], v2, s[52:55], s36 offen offset:0 sc1
  v_mfma_f32_16x16x32_bf16 v[52:55], a[4:7], v[128:131], 0
  v_mfma_f32_16x16x32_bf16 v[56:59], a[8:11], v[128:131], 0
  v_mfma_f32_16x16x32_bf16 v[60:63], a[12:15], v[128:131], 0
  v_mfma_f32_16x16x32_bf16 v[64:67], a[16:19], v[128:131], 0
  s_waitcnt vmcnt(7)
  v_mfma_f32_16x16x32_bf16 v[48:51], a[20:23], v[132:135], v[48:51]
  buffer_load_dwordx4 v[164:167], v2, s[52:55], s36 offen offset:1024 sc1
  v_mfma_f32_16x16x32_bf16 v[52:55], a[24:27], v[132:135], v[52:55]
  v_mfma_f32_16x16x32_bf16 v[56:59], a[28:31], v[132:135], v[56:59]
  v_mfma_f32_16x16x32_bf16 v[60:63], a[32:35], v[132:135], v[60:63]
  v_mfma_f32_16x16x32_bf16 v[64:67], a[36:39], v[132:135], v[64:67]
  s_waitcnt vmcnt(7)
  v_mfma_f32_16x16x32_bf16 v[48:51], a[40:43], v[136:139], v[48:51]
  buffer_load_dwordx4 v[168:171], v2, s[52:55], s37 offen offset:0 sc1
  v_mfma_f32_16x16x32_bf16 v[52:55], a[44:47], v[136:139], v[52:55]
  v_mfma_f32_16x16x32_bf16 v[56:59], a[48:51], v[136:139], v[56:59]
  v_mfma_f32_16x16x32_bf16 v[60:63], a[52:55], v[136:139], v[60:63]
  v_mfma_f32_16x16x32_bf16 v[64:67], a[56:59], v[136:139], v[64:67]
  s_waitcnt vmcnt(7)
  v_mfma_f32_16x16x32_bf16 v[48:51], a[60:63], v[140:143], v[48:51]
  buffer_load_dwordx4 v[172:175], v2, s[52:55], s37 offen offset:1024 sc1
  v_mfma_f32_16x16x32_bf16 v[52:55], a[64:67], v[140:143], v[52:55]
  v_mfma_f32_16x16x32_bf16 v[56:59], a[68:71], v[140:143], v[56:59]
  v_mfma_f32_16x16x32_bf16 v[60:63], a[72:75], v[140:143], v[60:63]
  v_mfma_f32_16x16x32_bf16 v[64:67], a[76:79], v[140:143], v[64:67]
  s_waitcnt vmcnt(7)
  v_mfma_f32_16x16x32_bf16 v[48:51], a[80:83], v[144:147], v[48:51]
  buffer_load_dwordx4 v[176:179], v2, s[52:55], s37 offen offset:2048 sc1
  v_mfma_f32_16x16x32_bf16 v[52:55], a[84:87], v[144:147], v[52:55]
  v_mfma_f32_16x16x32_bf16 v[56:59], a[88:91], v[144:147], v[56:59]
  v_mfma_f32_16x16x32_bf16 v[60:63], a[92:95], v[144:147], v[60:63]
  v_mfma_f32_16x16x32_bf16 v[64:67], a[96:99], v[144:147], v[64:67]
  s_waitcnt vmcnt(7)
  v_mfma_f32_16x16x32_bf16 v[48:51], a[100:103], v[148:151], v[48:51]
  buffer_load_dwordx4 v[180:183], v2, s[52:55], s37 offen offset:3072 sc1
  v_mfma_f32_16x16x32_bf16 v[52:55], a[104:107], v[148:151], v[52:55]
  v_mfma_f32_16x16x32_bf16 v[56:59], a[108:111], v[148:151], v[56:59]
  v_mfma_f32_16x16x32_bf16 v[60:63], a[112:115], v[148:151], v[60:63]
  v_mfma_f32_16x16x32_bf16 v[64:67], a[116:119], v[148:151], v[64:67]
  s_waitcnt vmcnt(7)
  v_mfma_f32_16x16x32_bf16 v[48:51], a[120:123], v[152:155], v[48:51]
  s_add_u32 s37, s37, 4096
  buffer_load_dwordx4 v[184:187], v2, s[52:55], s37 offen offset:0 sc1
  v_mfma_f32_16x16x32_bf16 v[52:55], a[124:127], v[152:155], v[52:55]
  v_mfma_f32_16x16x32_bf16 v[56:59], a[128:131], v[152:155], v[56:59]
  v_mfma_f32_16x16x32_bf16 v[60:63], a[132:135], v[152:155], v[60:63]
  v_mfma_f32_16x16x32_bf16 v[64:67], a[136:139], v[152:155], v[64:67]
  s_waitcnt vmcnt(7)
  v_mfma_f32_16x16x32_bf16 v[48:51], a[140:143], v[156:159], v[48:51]
  buffer_load_dwordx4 v[188:191], v2, s[52:55], s37 offen offset:1024 sc1
  v_mfma_f32_16x16x32_bf16 v[52:55], a[144:147], v[156:159], v[52:55]
  v_mfma_f32_16x16x32_bf16 v[56:59], a[148:151], v[156:159], v[56:59]
  v_mfma_f32_16x16x32_bf16 v[60:63], a[152:155], v[156:159], v[60:63]
  v_mfma_f32_16x16x32_bf16 v[64:67], a[156:159], v[156:159], v[64:67]
  s_waitcnt vmcnt(7)
  v_mfma_f32_16x16x32_bf16 v[48:51], a[160:163], v[160:163], v[48:51]
  buffer_load_dwordx4 v[128:131], v2, s[52:55], s37 offen offset:2048 sc1
  v_mfma_f32_16x16x32_bf16 v[52:55], a[164:167], v[160:163], v[52:55]
  v_mfma_f32_16x16x32_bf16 v[56:59], a[168:171], v[160:163], v[56:59]
  v_mfma_f32_16x16x32_bf16 v[60:63], a[172:175], v[160:163], v[60:63]
  v_mfma_f32_16x16x32_bf16 v[64:67], a[176:179], v[160:163], v[64:67]
  s_waitcnt vmcnt(7)
  v_mfma_f32_16x16x32_bf16 v[48:51], a[180:183], v[164:167], v[48:51]
  buffer_load_dwordx4 v[132:135], v2, s[52:55], s37 offen offset:3072 sc1
  v_mfma_f32_16x16x32_bf16 v[52:55], a[184:187], v[164:167], v[52:55]
  v_mfma_f32_16x16x32_bf16 v[56:59], a[188:191], v[164:167], v[56:59]
  v_mfma_f32_16x16x32_bf16 v[60:63], a[192:195], v[164:167], v[60:63]
  v_mfma_f32_16x16x32_bf16 v[64:67], a[196:199], v[164:167], v[64:67]
  s_waitcnt vmcnt(7)
  v_mfma_f32_16x16x32_bf16 v[68:71], a[0:3], v[168:171], 0
  s_add_u32 s37, s37, 4096
  buffer_load_dwordx4 v[136:139], v2, s[52:55], s37 offen offset:0 sc1
  v_mfma_f32_16x16x32_bf16 v[72:75], a[4:7], v[168:171], 0
  v_mfma_f32_16x16x32_bf16 v[76:79], a[8:11], v[168:171], 0
  v_mfma_f32_16x16x32_bf16 v[80:83], a[12:15], v[168:171], 0
  v_mfma_f32_16x16x32_bf16 v[84:87], a[16:19], v[168:171], 0
  s_waitcnt vmcnt(7)
  v_mfma_f32_16x16x32_bf16 v[68:71], a[20:23], v[172:175], v[68:71]
  ds_write_b128 v44, v[48:51] offset:0
  buffer_load_dwordx4 v[140:143], v2, s[52:55], s37 offen offset:1024 sc1
  v_mfma_f32_16x16x32_bf16 v[72:75], a[24:27], v[172:175], v[72:75]
  ds_write_b128 v44, v[52:55] offset:1024
  v_mfma_f32_16x16x32_bf16 v[76:79], a[28:31], v[172:175], v[76:79]
  ds_write_b128 v44, v[56:59] offset:2048
  v_mfma_f32_16x16x32_bf16 v[80:83], a[32:35], v[172:175], v[80:83]
  ds_write_b128 v44, v[60:63] offset:3072
  v_mfma_f32_16x16x32_bf16 v[84:87], a[36:39], v[172:175], v[84:87]
  ds_write_b128 v44, v[64:67] offset:4096
  s_waitcnt vmcnt(7)
  v_mfma_f32_16x16x32_bf16 v[68:71], a[40:43], v[176:179], v[68:71]
  buffer_load_dwordx4 v[144:147], v2, s[52:55], s38 offen offset:0 sc1
  v_mfma_f32_16x16x32_bf16 v[72:75], a[44:47], v[176:179], v[72:75]
  v_mfma_f32_16x16x32_bf16 v[76:79], a[48:51], v[176:179], v[76:79]
  v_mfma_f32_16x16x32_bf16 v[80:83], a[52:55], v[176:179], v[80:83]
  v_mfma_f32_16x16x32_bf16 v[84:87], a[56:59], v[176:179], v[84:87]
  s_waitcnt vmcnt(7)
  v_mfma_f32_16x16x32_bf16 v[68:71], a[60:63], v[180:183], v[68:71]
  buffer_load_dwordx4 v[148:151], v2, s[52:55], s38 offen offset:1024 sc1
  v_mfma_f32_16x16x32_bf16 v[72:75], a[64:67], v[180:183], v[72:75]
  v_mfma_f32_16x16x32_bf16 v[76:79], a[68:71], v[180:183], v[76:79]
  v_mfma_f32_16x16x32_bf16 v[80:83], a[72:75], v[180:183], v[80:83]
  v_mfma_f32_16x16x32_bf16 v[84:87], a[76:79], v[180:183], v[84:87]
  s_waitcnt vmcnt(7)
  v_mfma_f32_16x16x32_bf16 v[68:71], a[80:83], v[184:187], v[68:71]
  buffer_load_dwordx4 v[152:155], v2, s[52:55], s38 offen offset:2048 sc1
  v_mfma_f32_16x16x32_bf16 v[72:75], a[84:87], v[184:187], v[72:75]
  v_mfma_f32_16x16x32_bf16 v[76:79], a[88:91], v[184:187], v[76:79]
  v_mfma_f32_16x16x32_bf16 v[80:83], a[92:95], v[184:187], v[80:83]
  v_mfma_f32_16x16x32_bf16 v[84:87], a[96:99], v[184:187], v[84:87]
  s_waitcnt vmcnt(7)
  v_mfma_f32_16x16x32_bf16 v[68:71], a[100:103], v[188:191], v[68:71]
  buffer_load_dwordx4 v[156:159], v2, s[52:55], s38 offen offset:3072 sc1
  v_mfma_f32_16x16x32_bf16 v[72:75], a[104:107], v[188:191], v[72:75]
  v_mfma_f32_16x16x32_bf16 v[76:79], a[108:111], v[188:191], v[76:79]
  v_mfma_f32_16x16x32_bf16 v[80:83], a[112:115], v[188:191], v[80:83]
  v_mfma_f32_16x16x32_bf16 v[84:87], a[116:119], v[188:191], v[84:87]
  s_waitcnt vmcnt(7)
  v_mfma_f32_16x16x32_bf16 v[68:71], a[120:123], v[128:131], v[68:71]
  s_add_u32 s38, s38, 4096
  buffer_load_dwordx4 v[160:163], v2, s[52:55], s38 offen offset:0 sc1
  v_mfma_f32_16x16x32_bf16 v[72:75], a[124:127], v[128:131], v[72:75]
  v_mfma_f32_16x16x32_bf16 v[76:79], a[128:131], v[128:131], v[76:79]
  v_mfma_f32_16x16x32_bf16 v[80:83], a[132:135], v[128:131], v[80:83]
  v_mfma_f32_16x16x32_bf16 v[84:87], a[136:139], v[128:131], v[84:87]
  s_waitcnt vmcnt(7)
  v_mfma_f32_16x16x32_bf16 v[68:71], a[140:143], v[132:135], v[68:71]
  buffer_load_dwordx4 v[164:167], v2, s[52:55], s38 offen offset:1024 sc1
  v_mfma_f32_16x16x32_bf16 v[72:75], a[144:147], v[132:135], v[72:75]
  v_mfma_f32_16x16x32_bf16 v[76:79], a[148:151], v[132:135], v[76:79]
  v_mfma_f32_16x16x32_bf16 v[80:83], a[152:155], v[132:135], v[80:83]
  v_mfma_f32_16x16x32_bf16 v[84:87], a[156:159], v[132:135], v[84:87]
  s_waitcnt vmcnt(7)
  v_mfma_f32_16x16x32_bf16 v[68:71], a[160:163], v[136:139], v[68:71]
  buffer_load_dwordx4 v[168:171], v2, s[52:55], s38 offen offset:2048 sc1
  v_mfma_f32_16x16x32_bf16 v[72:75], a[164:167], v[136:139], v[72:75]
  v_mfma_f32_16x16x32_bf16 v[76:79], a[168:171], v[136:139], v[76:79]
  v_mfma_f32_16x16x32_bf16 v[80:83], a[172:175], v[136:139], v[80:83]
  v_mfma_f32_16x16x32_bf16 v[84:87], a[176:179], v[136:139], v[84:87]
  s_waitcnt vmcnt(7)
  v_mfma_f32_16x16x32_bf16 v[68:71], a[180:183], v[140:143], v[68:71]
  buffer_load_dwordx4 v[172:175], v2, s[52:55], s38 offen offset:3072 sc1
  v_mfma_f32_16x16x32_bf16 v[72:75], a[184:187], v[140:143], v[72:75]
  v_mfma_f32_16x16x32_bf16 v[76:79], a[188:191], v[140:143], v[76:79]
  v_mfma_f32_16x16x32_bf16 v[80:83], a[192:195], v[140:143], v[80:83]
  v_mfma_f32_16x16x32_bf16 v[84:87], a[196:199], v[140:143], v[84:87]
  s_waitcnt vmcnt(7)
  v_mfma_f32_16x16x32_bf16 v[48:51], a[0:3], v[144:147], 0
  s_add_u32 s38, s38, 4096
  buffer_load_dwordx4 v[176:179], v2, s[52:55], s38 offen offset:0 sc1
  v_mfma_f32_16x16x32_bf16 v[52:55], a[4:7], v[144:147], 0
  v_mfma_f32_16x16x32_bf16 v[56:59], a[8:11], v[144:147], 0
  v_mfma_f32_16x16x32_bf16 v[60:63], a[12:15], v[144:147], 0
  v_mfma_f32_16x16x32_bf16 v[64:67], a[16:19], v[144:147], 0
  s_waitcnt vmcnt(7)
  v_mfma_f32_16x16x32_bf16 v[48:51], a[20:23], v[148:151], v[48:51]
  ds_write_b128 v45, v[68:71] offset:0
  buffer_load_dwordx4 v[180:183], v2, s[52:55], s38 offen offset:1024 sc1
  v_mfma_f32_16x16x32_bf16 v[52:55], a[24:27], v[148:151], v[52:55]
  ds_write_b128 v45, v[72:75] offset:1024
  v_mfma_f32_16x16x32_bf16 v[56:59], a[28:31], v[148:151], v[56:59]
  ds_write_b128 v45, v[76:79] offset:2048
  v_mfma_f32_16x16x32_bf16 v[60:63], a[32:35], v[148:151], v[60:63]
  ds_write_b128 v45, v[80:83] offset:3072
  v_mfma_f32_16x16x32_bf16 v[64:67], a[36:39], v[148:151], v[64:67]
  ds_write_b128 v45, v[84:87] offset:4096
  s_waitcnt vmcnt(7)
  v_mfma_f32_16x16x32_bf16 v[48:51], a[40:43], v[152:155], v[48:51]
  buffer_load_dwordx4 v[184:187], v2, s[52:55], s39 offen offset:0 sc1
  v_mfma_f32_16x16x32_bf16 v[52:55], a[44:47], v[152:155], v[52:55]
  v_mfma_f32_16x16x32_bf16 v[56:59], a[48:51], v[152:155], v[56:59]
  v_mfma_f32_16x16x32_bf16 v[60:63], a[52:55], v[152:155], v[60:63]
  v_mfma_f32_16x16x32_bf16 v[64:67], a[56:59], v[152:155], v[64:67]
  s_waitcnt vmcnt(7)
  v_mfma_f32_16x16x32_bf16 v[48:51], a[60:63], v[156:159], v[48:51]
  buffer_load_dwordx4 v[188:191], v2, s[52:55], s39 offen offset:1024 sc1
  v_mfma_f32_16x16x32_bf16 v[52:55], a[64:67], v[156:159], v[52:55]
  v_mfma_f32_16x16x32_bf16 v[56:59], a[68:71], v[156:159], v[56:59]
  v_mfma_f32_16x16x32_bf16 v[60:63], a[72:75], v[156:159], v[60:63]
  v_mfma_f32_16x16x32_bf16 v[64:67], a[76:79], v[156:159], v[64:67]
  s_waitcnt vmcnt(7)
  v_mfma_f32_16x16x32_bf16 v[48:51], a[80:83], v[160:163], v[48:51]
  buffer_load_dwordx4 v[128:131], v2, s[52:55], s39 offen offset:2048 sc1
  v_mfma_f32_16x16x32_bf16 v[52:55], a[84:87], v[160:163], v[52:55]
  v_mfma_f32_16x16x32_bf16 v[56:59], a[88:91], v[160:163], v[56:59]
  v_mfma_f32_16x16x32_bf16 v[60:63], a[92:95], v[160:163], v[60:63]
  v_mfma_f32_16x16x32_bf16 v[64:67], a[96:99], v[160:163], v[64:67]
  s_waitcnt vmcnt(7)
  v_mfma_f32_16x16x32_bf16 v[48:51], a[100:103], v[164:167], v[48:51]
  buffer_load_dwordx4 v[132:135], v2, s[52:55], s39 offen offset:3072 sc1
  v_mfma_f32_16x16x32_bf16 v[52:55], a[104:107], v[164:167], v[52:55]
  v_mfma_f32_16x16x32_bf16 v[56:59], a[108:111], v[164:167], v[56:59]
  v_mfma_f32_16x16x32_bf16 v[60:63], a[112:115], v[164:167], v[60:63]
  v_mfma_f32_16x16x32_bf16 v[64:67], a[116:119], v[164:167], v[64:67]
  s_waitcnt vmcnt(7)
  v_mfma_f32_16x16x32_bf16 v[48:51], a[120:123], v[168:171], v[48:51]
  s_add_u32 s39, s39, 4096
  buffer_load_dwordx4 v[136:139], v2, s[52:55], s39 offen offset:0 sc1
  v_mfma_f32_16x16x32_bf16 v[52:55], a[124:127], v[168:171], v[52:55]
  v_mfma_f32_16x16x32_bf16 v[56:59], a[128:131], v[168:171], v[56:59]
  v_mfma_f32_16x16x32_bf16 v[60:63], a[132:135], v[168:171], v[60:63]
  v_mfma_f32_16x16x32_bf16 v[64:67], a[136:139], v[168:171], v[64:67]
  s_waitcnt vmcnt(7)
  v_mfma_f32_16x16x32_bf16 v[48:51], a[140:143], v[172:175], v[48:51]
  buffer_load_dwordx4 v[140:143], v2, s[52:55], s39 offen offset:1024 sc1
  v_mfma_f32_16x16x32_bf16 v[52:55], a[144:147], v[172:175], v[52:55]
  v_mfma_f32_16x16x32_bf16 v[56:59], a[148:151], v[172:175], v[56:59]
  v_mfma_f32_16x16x32_bf16 v[60:63], a[152:155], v[172:175], v[60:63]
  v_mfma_f32_16x16x32_bf16 v[64:67], a[156:159], v[172:175], v[64:67]
  s_waitcnt vmcnt(7)
  v_mfma_f32_16x16x32_bf16 v[48:51], a[160:163], v[176:179], v[48:51]
  buffer_load_dwordx4 v[144:147], v2, s[52:55], s39 offen offset:2048 sc1
  v_mfma_f32_16x16x32_bf16 v[52:55], a[164:167], v[176:179], v[52:55]
  v_mfma_f32_16x16x32_bf16 v[56:59], a[168:171], v[176:179], v[56:59]
  v_mfma_f32_16x16x32_bf16 v[60:63], a[172:175], v[176:179], v[60:63]
  v_mfma_f32_16x16x32_bf16 v[64:67], a[176:179], v[176:179], v[64:67]
  s_waitcnt vmcnt(7)
  v_mfma_f32_16x16x32_bf16 v[48:51], a[180:183], v[180:183], v[48:51]
  buffer_load_dwordx4 v[148:151], v2, s[52:55], s39 offen offset:3072 sc1
  v_mfma_f32_16x16x32_bf16 v[52:55], a[184:187], v[180:183], v[52:55]
  v_mfma_f32_16x16x32_bf16 v[56:59], a[188:191], v[180:183], v[56:59]
  v_mfma_f32_16x16x32_bf16 v[60:63], a[192:195], v[180:183], v[60:63]
  v_mfma_f32_16x16x32_bf16 v[64:67], a[196:199], v[180:183], v[64:67]
  s_waitcnt vmcnt(7)
  v_mfma_f32_16x16x32_bf16 v[68:71], a[0:3], v[184:187], v[108:111]
  s_add_u32 s39, s39, 4096
  buffer_load_dwordx4 v[152:155], v2, s[52:55], s39 offen offset:0 sc1
  v_mfma_f32_16x16x32_bf16 v[72:75], a[4:7], v[184:187], v[112:115]
  s_mul_i32 s15, s7, 15360
  v_mfma_f32_16x16x32_bf16 v[76:79], a[8:11], v[184:187], v[116:119]
  s_add_u32 s15, s15, 102400
  v_mfma_f32_16x16x32_bf16 v[80:83], a[12:15], v[184:187], v[120:123]
  v_add_u32_e64 v47, s15, v2
  v_mfma_f32_16x16x32_bf16 v[84:87], a[16:19], v[184:187], v[124:127]
  s_waitcnt vmcnt(7)
  v_mfma_f32_16x16x32_bf16 v[68:71], a[20:23], v[188:191], v[68:71]
  ds_write_b128 v46, v[48:51] offset:0
  buffer_load_dwordx4 v[156:159], v2, s[52:55], s39 offen offset:1024 sc1
  v_mfma_f32_16x16x32_bf16 v[72:75], a[24:27], v[188:191], v[72:75]
  ds_write_b128 v46, v[52:55] offset:1024
  v_mfma_f32_16x16x32_bf16 v[76:79], a[28:31], v[188:191], v[76:79]
  ds_write_b128 v46, v[56:59] offset:2048
  v_mfma_f32_16x16x32_bf16 v[80:83], a[32:35], v[188:191], v[80:83]
  ds_write_b128 v46, v[60:63] offset:3072
  v_mfma_f32_16x16x32_bf16 v[84:87], a[36:39], v[188:191], v[84:87]
  ds_write_b128 v46, v[64:67] offset:4096
  s_waitcnt vmcnt(7)
  v_mfma_f32_16x16x32_bf16 v[68:71], a[40:43], v[128:131], v[68:71]
  s_lshl_b32 vcc_lo, s1, 2
  s_add_u32 vcc_lo, vcc_lo, s7
  s_cmp_lg_u32 vcc_lo, 3
  s_cbranch_scc1 skip_71
  buffer_wbl2 sc1
skip_71:
  v_mfma_f32_16x16x32_bf16 v[72:75], a[44:47], v[128:131], v[72:75]
  v_mfma_f32_16x16x32_bf16 v[76:79], a[48:51], v[128:131], v[76:79]
  v_mfma_f32_16x16x32_bf16 v[80:83], a[52:55], v[128:131], v[80:83]
  v_mfma_f32_16x16x32_bf16 v[84:87], a[56:59], v[128:131], v[84:87]
  s_waitcnt vmcnt(6)
  v_mfma_f32_16x16x32_bf16 v[68:71], a[60:63], v[132:135], v[68:71]
  v_mfma_f32_16x16x32_bf16 v[72:75], a[64:67], v[132:135], v[72:75]
  v_mfma_f32_16x16x32_bf16 v[76:79], a[68:71], v[132:135], v[76:79]
  v_mfma_f32_16x16x32_bf16 v[80:83], a[72:75], v[132:135], v[80:83]
  v_mfma_f32_16x16x32_bf16 v[84:87], a[76:79], v[132:135], v[84:87]
  s_waitcnt vmcnt(5)
  v_mfma_f32_16x16x32_bf16 v[68:71], a[80:83], v[136:139], v[68:71]
  s_waitcnt lgkmcnt(0)
  s_barrier
  v_mfma_f32_16x16x32_bf16 v[72:75], a[84:87], v[136:139], v[72:75]
  ds_read_b128 v[206:209], v47 offset:0
  ds_read_b128 v[210:213], v47 offset:1024
  v_mfma_f32_16x16x32_bf16 v[76:79], a[88:91], v[136:139], v[76:79]
  ds_read_b128 v[214:217], v47 offset:2048
  v_mfma_f32_16x16x32_bf16 v[80:83], a[92:95], v[136:139], v[80:83]
  ds_read_b128 v[218:221], v47 offset:3072
  v_mfma_f32_16x16x32_bf16 v[84:87], a[96:99], v[136:139], v[84:87]
  ds_read_b128 v[222:225], v47 offset:4096
  s_waitcnt vmcnt(4)
  v_mfma_f32_16x16x32_bf16 v[68:71], a[100:103], v[140:143], v[68:71]
  ds_read_b128 v[160:163], v47 offset:5120
  ds_read_b128 v[164:167], v47 offset:6144
  v_mfma_f32_16x16x32_bf16 v[72:75], a[104:107], v[140:143], v[72:75]
  ds_read_b128 v[168:171], v47 offset:7168
  ds_read_b128 v[172:175], v47 offset:8192
  v_mfma_f32_16x16x32_bf16 v[76:79], a[108:111], v[140:143], v[76:79]
  ds_read_b128 v[176:179], v47 offset:9216
  v_mfma_f32_16x16x32_bf16 v[80:83], a[112:115], v[140:143], v[80:83]
  s_waitcnt lgkmcnt(0)
  v_mfma_f32_16x16x32_bf16 v[84:87], a[116:119], v[140:143], v[84:87]
  v_pk_add_f32 v[206:207], v[206:207], v[160:161]
  s_waitcnt vmcnt(3)
  v_mfma_f32_16x16x32_bf16 v[68:71], a[120:123], v[144:147], v[68:71]
  v_pk_add_f32 v[208:209], v[208:209], v[162:163]
  v_pk_add_f32 v[210:211], v[210:211], v[164:165]
  v_mfma_f32_16x16x32_bf16 v[72:75], a[124:127], v[144:147], v[72:75]
  v_pk_add_f32 v[212:213], v[212:213], v[166:167]
  v_pk_add_f32 v[214:215], v[214:215], v[168:169]
  v_mfma_f32_16x16x32_bf16 v[76:79], a[128:131], v[144:147], v[76:79]
  v_pk_add_f32 v[216:217], v[216:217], v[170:171]
  v_mfma_f32_16x16x32_bf16 v[80:83], a[132:135], v[144:147], v[80:83]
  v_pk_add_f32 v[218:219], v[218:219], v[172:173]
  v_mfma_f32_16x16x32_bf16 v[84:87], a[136:139], v[144:147], v[84:87]
  v_pk_add_f32 v[220:221], v[220:221], v[174:175]
  s_waitcnt vmcnt(2)
  v_mfma_f32_16x16x32_bf16 v[68:71], a[140:143], v[148:151], v[68:71]
  v_pk_add_f32 v[222:223], v[222:223], v[176:177]
  v_pk_add_f32 v[224:225], v[224:225], v[178:179]
  v_mfma_f32_16x16x32_bf16 v[72:75], a[144:147], v[148:151], v[72:75]
  ds_read_b128 v[160:163], v47 offset:10240
  ds_read_b128 v[164:167], v47 offset:11264
  v_mfma_f32_16x16x32_bf16 v[76:79], a[148:151], v[148:151], v[76:79]
  ds_read_b128 v[168:171], v47 offset:12288
  v_mfma_f32_16x16x32_bf16 v[80:83], a[152:155], v[148:151], v[80:83]
  ds_read_b128 v[172:175], v47 offset:13312
  v_mfma_f32_16x16x32_bf16 v[84:87], a[156:159], v[148:151], v[84:87]
  ds_read_b128 v[176:179], v47 offset:14336
  s_waitcnt vmcnt(1)
  v_mfma_f32_16x16x32_bf16 v[68:71], a[160:163], v[152:155], v[68:71]
  s_waitcnt lgkmcnt(0)
  v_pk_add_f32 v[206:207], v[206:207], v[160:161]
  v_mfma_f32_16x16x32_bf16 v[72:75], a[164:167], v[152:155], v[72:75]
  v_pk_add_f32 v[208:209], v[208:209], v[162:163]
  v_pk_add_f32 v[210:211], v[210:211], v[164:165]
  v_mfma_f32_16x16x32_bf16 v[76:79], a[168:171], v[152:155], v[76:79]
  v_pk_add_f32 v[212:213], v[212:213], v[166:167]
  v_mfma_f32_16x16x32_bf16 v[80:83], a[172:175], v[152:155], v[80:83]
  v_pk_add_f32 v[214:215], v[214:215], v[168:169]
  v_mfma_f32_16x16x32_bf16 v[84:87], a[176:179], v[152:155], v[84:87]
  v_pk_add_f32 v[216:217], v[216:217], v[170:171]
  s_waitcnt vmcnt(0)
  v_mfma_f32_16x16x32_bf16 v[68:71], a[180:183], v[156:159], v[68:71]
  v_pk_add_f32 v[218:219], v[218:219], v[172:173]
  v_mfma_f32_16x16x32_bf16 v[72:75], a[184:187], v[156:159], v[72:75]
  v_pk_add_f32 v[220:221], v[220:221], v[174:175]
  v_mfma_f32_16x16x32_bf16 v[76:79], a[188:191], v[156:159], v[76:79]
  v_pk_add_f32 v[222:223], v[222:223], v[176:177]
  v_mfma_f32_16x16x32_bf16 v[80:83], a[192:195], v[156:159], v[80:83]
  v_pk_add_f32 v[224:225], v[224:225], v[178:179]
  v_mfma_f32_16x16x32_bf16 v[84:87], a[196:199], v[156:159], v[84:87]
  v_pk_add_f32 v[68:69], v[68:69], v[206:207]
  v_pk_add_f32 v[70:71], v[70:71], v[208:209]
  v_pk_add_f32 v[72:73], v[72:73], v[210:211]
  v_pk_add_f32 v[74:75], v[74:75], v[212:213]
  v_pk_add_f32 v[76:77], v[76:77], v[214:215]
  v_pk_add_f32 v[78:79], v[78:79], v[216:217]
  v_pk_add_f32 v[80:81], v[80:81], v[218:219]
  v_pk_add_f32 v[82:83], v[82:83], v[220:221]
  v_pk_add_f32 v[84:85], v[84:85], v[222:223]
  v_pk_add_f32 v[86:87], v[86:87], v[224:225]
  s_lshl_b32 s12, s5, 15
  s_lshl_b32 s13, s7, 10
  s_add_u32 s12, s12, s13
  s_add_u32 s12, s12, 2359296
  s_lshl_b32 s13, s6, 12
  s_add_u32 s13, s13, s12
  v_pk_add_f32 v[228:229], v[68:69], v[70:71]
  v_pk_mul_f32 v[230:231], v[68:69], v[68:69]
  v_pk_fma_f32 v[230:231], v[70:71], v[70:71], v[230:231]
  v_pk_add_f32 v[228:229], v[228:229], v[72:73]
  v_pk_fma_f32 v[230:231], v[72:73], v[72:73], v[230:231]
  v_pk_add_f32 v[228:229], v[228:229], v[74:75]
  v_pk_fma_f32 v[230:231], v[74:75], v[74:75], v[230:231]
  v_pk_add_f32 v[228:229], v[228:229], v[76:77]
  v_pk_fma_f32 v[230:231], v[76:77], v[76:77], v[230:231]
  v_pk_add_f32 v[228:229], v[228:229], v[78:79]
  v_pk_fma_f32 v[230:231], v[78:79], v[78:79], v[230:231]
  v_pk_add_f32 v[228:229], v[228:229], v[80:81]
  v_pk_fma_f32 v[230:231], v[80:81], v[80:81], v[230:231]
  v_pk_add_f32 v[228:229], v[228:229], v[82:83]
  v_pk_fma_f32 v[230:231], v[82:83], v[82:83], v[230:231]
  v_pk_add_f32 v[228:229], v[228:229], v[84:85]
  v_pk_fma_f32 v[230:231], v[84:85], v[84:85], v[230:231]
  v_pk_add_f32 v[228:229], v[228:229], v[86:87]
  v_pk_fma_f32 v[230:231], v[86:87], v[86:87], v[230:231]
  v_add_f32 v216, v228, v229
  v_add_f32 v217, v230, v231
  v_mov_b32 v218, s8
  v_mov_b32 v219, s8
  v_mov_b32 v228, v216
  v_mov_b32 v229, v217
  s_nop 0
  v_permlane32_swap_b32 v216, v228
  v_permlane32_swap_b32 v217, v229
  v_add_f32 v216, v216, v228
  v_add_f32 v217, v217, v229
  v_mov_b32 v228, v216
  v_mov_b32 v229, v217
  s_nop 0
  v_permlane16_swap_b32 v216, v228
  v_permlane16_swap_b32 v217, v229
  v_add_f32 v216, v216, v228
  v_add_f32 v217, v217, v229
  s_mov_b64 exec, 0xffff
  s_cmp_eq_u32 s9, 0
  s_cbranch_scc1 slow_72
  buffer_store_dwordx4 v[216:219], v2, s[52:55], s13 offen
back_73:
  s_mov_b64 exec, -1
  v_lshlrev_b32 v11, 13, v4
  v_lshl_add_u32 v11, v3, 4, v11
  s_add_u32 s13, s12, 4096
  s_mul_i32 s14, s7, 15360
  s_add_u32 s14, s14, 102400
  v_mul_u32_u24 v44, 336, v3
  v_lshl_add_u32 v44, v4, 4, v44
  v_add_u32 v44, s14, v44
  s_lshl_b32 s15, s5, 6
  s_lshr_b32 s96, s7, 1
  s_lshl_b32 s96, s96, 5
  s_add_u32 s15, s15, s96
  s_and_b32 s96, s7, 1
  s_lshl_b32 s96, s96, 2
  s_add_u32 s15, s15, s96
  s_mul_i32 s15, s15, 2560
  s_mul_i32 s96, s6, 320
  s_add_u32 s15, s15, s96
  s_mov_b32 s64, s46
  s_and_b32 s65, s47, 0xffff
  s_mov_b32 s66, 5242880
  s_mov_b32 s67, 0x20000
  v_add_u32_e64 v12, 0, v1
  v_mul_u32_u24 v13, 205, v12
  v_lshrrev_b32 v13, 12, v13
  v_mul_u32_u24 v14, 20, v13
  v_sub_u32 v12, v12, v14
  v_lshlrev_b32 v12, 4, v12
  v_mul_u32_u24 v14, 336, v13
  v_add3_u32 v198, v14, v12, s14
  v_lshrrev_b32_e64 v14, 2, v13
  v_lshl_add_u32 v13, v14, 2, v13
  v_mul_u32_u24 v13, 2560, v13
  v_add_u32 v192, v13, v12
  v_add_u32 v12, 64, v1
  v_mul_u32_u24 v13, 205, v12
  v_lshrrev_b32 v13, 12, v13
  v_mul_u32_u24 v14, 20, v13
  v_sub_u32 v12, v12, v14
  v_lshlrev_b32 v12, 4, v12
  v_mul_u32_u24 v14, 336, v13
  v_add3_u32 v199, v14, v12, s14
  v_lshrrev_b32_e64 v14, 2, v13
  v_lshl_add_u32 v13, v14, 2, v13
  v_mul_u32_u24 v13, 2560, v13
  v_add_u32_e64 v193, v13, v12
  v_add_u32 v12, 128, v1
  v_mul_u32_u24 v13, 205, v12
  v_lshrrev_b32 v13, 12, v13
  v_mul_u32_u24 v14, 20, v13
  v_sub_u32 v12, v12, v14
  v_lshlrev_b32 v12, 4, v12
  v_mul_u32_u24 v14, 336, v13
  v_add3_u32 v200, v14, v12, s14
  v_lshrrev_b32_e64 v14, 2, v13
  v_lshl_add_u32 v13, v14, 2, v13
  v_mul_u32_u24 v13, 2560, v13
  v_add_u32_e64 v194, v13, v12
  v_add_u32 v12, 192, v1
  v_mul_u32_u24 v13, 205, v12
  v_lshrrev_b32 v13, 12, v13
  v_mul_u32_u24 v14, 20, v13
  v_sub_u32 v12, v12, v14
  v_lshlrev_b32 v12, 4, v12
  v_mul_u32_u24 v14, 336, v13
  v_add3_u32 v201, v14, v12, s14
  v_lshrrev_b32_e64 v14, 2, v13
  v_lshl_add_u32 v13, v14, 2, v13
  v_mul_u32_u24 v13, 2560, v13
  v_add_u32_e64 v195, v13, v12
  v_add_u32 v12, 256, v1
  v_mul_u32_u24 v13, 205, v12
  v_lshrrev_b32 v13, 12, v13
  v_mul_u32_u24 v14, 20, v13
  v_sub_u32 v12, v12, v14
  v_lshlrev_b32 v12, 4, v12
  v_mul_u32_u24 v14, 336, v13
  v_add3_u32 v202, v14, v12, s14
  v_lshrrev_b32_e64 v14, 2, v13
  v_lshl_add_u32 v13, v14, 2, v13
  v_mul_u32_u24 v13, 2560, v13
  v_add_u32_e64 v196, v13, v12
stpoll_74:
  buffer_load_dwordx3 v[128:130], v11, s[52:55], s12 offen sc1
  buffer_load_dwordx3 v[132:134], v11, s[52:55], s13 offen sc1
  s_waitcnt vmcnt(0)
  v_min3_u32 v13, v130, v134, s8
  v_max3_u32 v14, v130, v134, s8
  v_cmp_ne_u32 vcc, v13, v14
  s_cbranch_vccnz retry_75
giveup_76:
  v_pk_add_f32 v[128:129], v[128:129], v[132:133]
  v_mov_b32 v228, v128
  v_mov_b32 v229, v129
  s_nop 0
  v_permlane32_swap_b32 v128, v228
  v_permlane32_swap_b32 v129, v229
  v_add_f32 v128, v128, v228
  v_add_f32 v129, v129, v229
  v_mov_b32 v228, v128
  v_mov_b32 v229, v129
  s_nop 0
  v_permlane16_swap_b32 v128, v228
  v_permlane16_swap_b32 v129, v229
  v_add_f32 v128, v128, v228
  v_add_f32_e64 v129, v129, v229
  v_mul_f32 v128, 0x3acccccd, v128
  v_mul_f32 v212, 0x3acccccd, v129
  v_fma_f32 v212, -v128, v128, v212
  v_max_f32_e64 v212, 0, v212
  v_add_f32 v212, 0x3727c5ac, v212
  v_rsq_f32 v210, v212
  s_nop 0
  v_mul_f32_e64 v211, v128, v210
  v_pk_fma_f32 v[160:161], v[68:69], v[210:211], v[210:211] op_sel:[0,0,1] op_sel_hi:[1,0,1] neg_lo:[0,0,1] neg_hi:[0,0,1]
  v_pk_fma_f32 v[162:163], v[70:71], v[210:211], v[210:211] op_sel:[0,0,1] op_sel_hi:[1,0,1] neg_lo:[0,0,1] neg_hi:[0,0,1]
  v_pk_fma_f32 v[164:165], v[72:73], v[210:211], v[210:211] op_sel:[0,0,1] op_sel_hi:[1,0,1] neg_lo:[0,0,1] neg_hi:[0,0,1]
  v_pk_fma_f32 v[166:167], v[74:75], v[210:211], v[210:211] op_sel:[0,0,1] op_sel_hi:[1,0,1] neg_lo:[0,0,1] neg_hi:[0,0,1]
  v_pk_fma_f32 v[168:169], v[76:77], v[210:211], v[210:211] op_sel:[0,0,1] op_sel_hi:[1,0,1] neg_lo:[0,0,1] neg_hi:[0,0,1]
  v_pk_fma_f32 v[170:171], v[78:79], v[210:211], v[210:211] op_sel:[0,0,1] op_sel_hi:[1,0,1] neg_lo:[0,0,1] neg_hi:[0,0,1]
  v_pk_fma_f32 v[172:173], v[80:81], v[210:211], v[210:211] op_sel:[0,0,1] op_sel_hi:[1,0,1] neg_lo:[0,0,1] neg_hi:[0,0,1]
  v_pk_fma_f32 v[174:175], v[82:83], v[210:211], v[210:211] op_sel:[0,0,1] op_sel_hi:[1,0,1] neg_lo:[0,0,1] neg_hi:[0,0,1]
  v_pk_fma_f32 v[176:177], v[84:85], v[210:211], v[210:211] op_sel:[0,0,1] op_sel_hi:[1,0,1] neg_lo:[0,0,1] neg_hi:[0,0,1]
  v_pk_fma_f32 v[178:179], v[86:87], v[210:211], v[210:211] op_sel:[0,0,1] op_sel_hi:[1,0,1] neg_lo:[0,0,1] neg_hi:[0,0,1]
  v_pk_fma_f32 v[68:69], v[160:161], v[88:89], v[68:69]
  v_pk_fma_f32 v[70:71], v[162:163], v[90:91], v[70:71]
  ds_write_b128 v44, v[68:71] offset:0
  v_pk_fma_f32 v[72:73], v[164:165], v[92:93], v[72:73]
  v_pk_fma_f32 v[74:75], v[166:167], v[94:95], v[74:75]
  ds_write_b128 v44, v[72:75] offset:64
  v_pk_fma_f32 v[76:77], v[168:169], v[96:97], v[76:77]
  v_pk_fma_f32 v[78:79], v[170:171], v[98:99], v[78:79]
  ds_write_b128 v44, v[76:79] offset:128
  v_pk_fma_f32 v[80:81], v[172:173], v[100:101], v[80:81]
  v_pk_fma_f32 v[82:83], v[174:175], v[102:103], v[82:83]
  ds_write_b128 v44, v[80:83] offset:192
  v_pk_fma_f32 v[84:85], v[176:177], v[104:105], v[84:85]
  v_pk_fma_f32 v[86:87], v[178:179], v[106:107], v[86:87]
  ds_write_b128 v44, v[84:87] offset:256
  ds_read_b128 v[128:131], v198
  ds_read_b128 v[132:135], v199
  ds_read_b128 v[136:139], v200
  ds_read_b128 v[140:143], v201
  ds_read_b128 v[144:147], v202
  s_waitcnt lgkmcnt(4)
  buffer_store_dwordx4 v[128:131], v192, s[64:67], s15 offen sc1
  s_waitcnt lgkmcnt(3)
  buffer_store_dwordx4 v[132:135], v193, s[64:67], s15 offen sc1
  s_waitcnt lgkmcnt(2)
  buffer_store_dwordx4 v[136:139], v194, s[64:67], s15 offen sc1
  s_waitcnt lgkmcnt(1)
  buffer_store_dwordx4 v[140:143], v195, s[64:67], s15 offen sc1
  s_waitcnt lgkmcnt(0)
  buffer_store_dwordx4 v[144:147], v196, s[64:67], s15 offen sc1
L_end:
  s_endpgm
again_12:
  s_sub_u32 s10, s10, 1
  s_cmp_gt_i32 s10, 0
  s_cbranch_scc0 ok_13
  buffer_load_dword v81, v80, s[52:55], s96 offen sc1
  s_waitcnt vmcnt(0)
  v_xor_b32 v15, s8, v81
  v_cmp_lt_u32 vcc, 15, v15
  s_cbranch_vccz ok_13
  s_and_b32 s13, s10, 3
  s_cbranch_scc1 again_12
  buffer_load_dword v81, v80, s[52:55], s96 offen offset:128 sc1
  s_waitcnt vmcnt(0)
  v_xor_b32 v15, s8, v81
  v_cmp_lt_u32 vcc, 15, v15
  s_cbranch_vccnz again_12
  s_branch ok_13
slow_14:
  buffer_store_dwordx4 v[192:195], v211, s[52:55], s36 offen sc1
  s_add_u32 s36, s36, 4096
  buffer_store_dwordx4 v[196:199], v211, s[52:55], s36 offen sc1
  s_add_u32 s36, s36, 4096
  buffer_store_dwordx4 v[200:203], v211, s[52:55], s36 offen sc1
  s_add_u32 s36, s36, 4096
  buffer_store_dwordx4 v[204:207], v211, s[52:55], s36 offen sc1
  s_nop 1
  s_branch back_15
slow_16:
  buffer_store_dword v15, off, s[52:55], s12 sc1
  s_nop 1
  s_branch back_17
again_18:
  s_sub_u32 s10, s10, 1
  s_cmp_gt_i32 s10, 0
  s_cbranch_scc0 ok_19
  buffer_load_dwordx4 v[212:215], v223, s[52:55], s13 offen sc1
  s_waitcnt vmcnt(0)
  v_xor_b32 v15, s8, v212
  v_xor_b32 v14, s8, v213
  v_or_b32 v15, v15, v14
  v_xor_b32 v14, s8, v214
  v_or_b32 v15, v15, v14
  v_xor_b32 v14, s8, v215
  v_or_b32 v15, v15, v14
  v_cmp_ne_u32 vcc, 0, v15
  s_cbranch_vccnz again_18
  s_branch ok_19
again_20:
  s_sub_u32 s10, s10, 1
  s_cmp_gt_i32 s10, 0
  s_cbranch_scc0 ok_21
  buffer_load_dwordx3 v[224:226], v187, s[52:55], s96 offen sc1
  buffer_load_dwordx2 v[228:229], v185, s[52:55], s44 offen sc1
  buffer_load_dwordx2 v[230:231], v188, s[52:55], s44 offen offset:512 sc1
  s_waitcnt vmcnt(0)
  v_min3_u32 v13, v226, v229, v231
  v_max3_u32 v14, v226, v229, v231
  v_xor_b32 v13, s8, v13
  v_xor_b32 v14, s8, v14
  v_or_b32 v13, v13, v14
  v_cmp_ne_u32 vcc, 0, v13
  s_cbranch_vccnz again_20
  s_branch ok_21
again_23:
  s_sub_u32 s10, s10, 1
  s_cmp_gt_i32 s10, 0
  s_cbranch_scc0 ok_24
  buffer_load_dwordx4 v[204:207], v246, s[52:55], s96 offen sc1
  s_waitcnt vmcnt(0)
  v_xor_b32 v15, s8, v204
  v_xor_b32 v14, s8, v205
  v_or_b32 v15, v15, v14
  v_xor_b32 v14, s8, v206
  v_or_b32 v15, v15, v14
  v_xor_b32 v14, s8, v207
  v_or_b32 v15, v15, v14
  v_cmp_ne_u32 vcc, 0, v15
  s_cbranch_vccnz again_23
  s_branch ok_24
aggagain_29:
  buffer_load_dwordx3 v[128:130], v251, s[52:55], s80 offen offset:0 sc1
  buffer_load_dwordx3 v[132:134], v251, s[52:55], s80 offen offset:768 sc1
  buffer_load_dwordx3 v[136:138], v251, s[52:55], s80 offen offset:1536 sc1
  buffer_load_dwordx3 v[140:142], v251, s[52:55], s80 offen offset:2304 sc1
  buffer_load_dwordx3 v[144:146], v251, s[52:55], s80 offen offset:3072 sc1
  buffer_load_dwordx3 v[148:150], v251, s[52:55], s81 offen offset:0 sc1
  buffer_load_dwordx3 v[152:154], v251, s[52:55], s81 offen offset:768 sc1
  buffer_load_dwordx3 v[156:158], v251, s[52:55], s81 offen offset:1536 sc1
  buffer_load_dwordx3 v[160:162], v251, s[52:55], s81 offen offset:2304 sc1
  buffer_load_dwordx3 v[164:166], v251, s[52:55], s81 offen offset:3072 sc1
  buffer_load_dwordx3 v[168:170], v251, s[52:55], s82 offen offset:0 sc1
  buffer_load_dwordx3 v[172:174], v251, s[52:55], s82 offen offset:768 sc1
  buffer_load_dwordx3 v[240:242], v251, s[52:55], s82 offen offset:1536 sc1
  buffer_load_dwordx3 v[244:246], v251, s[52:55], s82 offen offset:2304 sc1
  buffer_load_dwordx3 v[248:250], v251, s[52:55], s82 offen offset:3072 sc1
  s_waitcnt vmcnt(0)
  s_branch aggpoll_28
retry_30:
  s_sub_u32 s10, s10, 1
  s_cmp_gt_i32 s10, 0
  s_cbranch_scc1 aggagain_29
  s_branch giveup_31
slow_32:
  s_add_u32 s13, s75, 10485760
  s_waitcnt lgkmcnt(6)
  buffer_store_dwordx4 v[68:71], v254, s[52:55], s13 offen sc1
  s_add_u32 s13, s76, 10485760
  s_waitcnt lgkmcnt(3)
  buffer_store_dwordx4 v[72:75], v254, s[52:55], s13 offen sc1
  s_add_u32 s13, s77, 10485760
  s_waitcnt lgkmcnt(0)
  buffer_store_dwordx4 v[76:79], v254, s[52:55], s13 offen sc1
  s_nop 1
  s_branch back_33
slow_34:
  s_add_u32 s13, s78, 10485760
  s_waitcnt lgkmcnt(3)
  buffer_store_dwordx4 v[80:83], v254, s[52:55], s13 offen sc1
  s_add_u32 s13, s79, 10485760
  s_waitcnt lgkmcnt(0)
  buffer_store_dwordx4 v[84:87], v254, s[52:55], s13 offen sc1
  s_nop 1
  s_branch back_35
slow_36:
  buffer_store_dword v15, off, s[52:55], s12 sc1
  s_nop 1
  s_branch back_37
retry_39:
  s_sub_u32 s10, s10, 1
  s_cmp_gt_i32 s10, 0
  s_cbranch_scc1 poll_38
  s_branch giveup_40
again_41:
  s_sub_u32 s10, s10, 1
  s_cmp_gt_i32 s10, 0
  s_cbranch_scc0 ok_42
  buffer_load_dwordx4 v[200:203], v204, s[52:55], s13 offen sc1
  s_waitcnt vmcnt(0)
  v_xor_b32 v15, s8, v200
  v_xor_b32 v14, s8, v201
  v_or_b32 v15, v15, v14
  v_xor_b32 v14, s8, v202
  v_or_b32 v15, v15, v14
  v_xor_b32 v14, s8, v203
  v_or_b32 v15, v15, v14
  v_cmp_ne_u32 vcc, 0, v15
  s_cbranch_vccnz again_41
  s_branch ok_42
slow_43:
  buffer_store_dwordx4 v[216:219], v2, s[52:55], s13 offen sc1
  s_nop 1
  s_branch back_44
retry_46:
  s_sub_u32 s10, s10, 1
  s_cmp_gt_i32 s10, 0
  s_cbranch_scc1 stpoll_45
  s_branch giveup_47
slow_48:
  buffer_store_dwordx2 v[180:181], v47, s[52:55], s12 offen offset:0 sc1
  buffer_store_dwordx2 v[182:183], v47, s[52:55], s12 offen offset:128 sc1
  buffer_store_dwordx2 v[184:185], v47, s[52:55], s12 offen offset:256 sc1
  buffer_store_dwordx2 v[186:187], v47, s[52:55], s12 offen offset:384 sc1
  buffer_store_dwordx2 v[188:189], v47, s[52:55], s12 offen offset:512 sc1
  s_nop 1
  s_branch back_49
slow_50:
  buffer_store_dword v15, off, s[52:55], s13 sc1
  s_nop 1
  s_branch back_51
retry_54:
  s_sub_u32 s10, s10, 1
  s_cmp_gt_i32 s10, 0
  s_cbranch_scc1 poll_53
  s_branch giveup_55
retry_60:
  s_sub_u32 s10, s10, 1
  s_cmp_gt_i32 s10, 0
  s_cbranch_scc1 aggpoll_58
  s_branch giveup_61
slow_62:
  s_add_u32 s13, s75, 10485760
  s_waitcnt lgkmcnt(6)
  buffer_store_dwordx4 v[68:71], v254, s[52:55], s13 offen sc1
  s_add_u32 s13, s76, 10485760
  s_waitcnt lgkmcnt(3)
  buffer_store_dwordx4 v[72:75], v254, s[52:55], s13 offen sc1
  s_add_u32 s13, s77, 10485760
  s_waitcnt lgkmcnt(0)
  buffer_store_dwordx4 v[76:79], v254, s[52:55], s13 offen sc1
  s_nop 1
  s_branch back_63
slow_64:
  s_add_u32 s13, s78, 10485760
  s_waitcnt lgkmcnt(3)
  buffer_store_dwordx4 v[80:83], v254, s[52:55], s13 offen sc1
  s_add_u32 s13, s79, 10485760
  s_waitcnt lgkmcnt(0)
  buffer_store_dwordx4 v[84:87], v254, s[52:55], s13 offen sc1
  s_nop 1
  s_branch back_65
slow_66:
  buffer_store_dword v15, off, s[52:55], s12 sc1
  s_nop 1
  s_branch back_67
retry_69:
  s_sub_u32 s10, s10, 1
  s_cmp_gt_i32 s10, 0
  s_cbranch_scc1 poll_68
  s_branch giveup_70
slow_72:
  buffer_store_dwordx4 v[216:219], v2, s[52:55], s13 offen sc1
  s_nop 1
  s_branch back_73
retry_75:
  s_sub_u32 s10, s10, 1
  s_cmp_gt_i32 s10, 0
  s_cbranch_scc1 stpoll_74
  s_branch giveup_76
  s_endpgm
L_codeend:
.section .rodata,"a"
.p2align 6
.amdhsa_kernel interleave_layers__ssm_conv_s5__ssm_conv_h3__prompt_kernel
  .amdhsa_next_free_vgpr 512
  .amdhsa_next_free_sgpr 102
  .amdhsa_accum_offset 256
  .amdhsa_group_segment_fixed_size 0
  .amdhsa_kernarg_size 144
  .amdhsa_user_sgpr_count 2
  .amdhsa_user_sgpr_kernarg_segment_ptr 1
  .amdhsa_system_sgpr_workgroup_id_x 1
.end_amdhsa_kernel
```

```asm
; @launch grid=(256,1,1) block=(256,1,1) lds=163840
.amdgcn_target "amdgcn-amd-amdhsa--gfx950"
.text
.globl interleave_layers__ssm_conv_s5__ssm_conv_h3__prompt_kernel
.p2align 8
.type interleave_layers__ssm_conv_s5__ssm_conv_h3__prompt_kernel,@function
interleave_layers__ssm_conv_s5__ssm_conv_h3__prompt_kernel:
  s_cmp_ge_u32 s2, 256
  s_cbranch_scc1 L_end
  s_load_dwordx16 s[16:31], s[0:1], 0
  s_load_dwordx16 s[32:47], s[0:1], 64
  s_load_dwordx4 s[48:51], s[0:1], 128
  v_and_b32 v1, 63, v0
  v_lshrrev_b32 v11, 6, v0
  v_lshlrev_b32 v2, 4, v1
  v_readfirstlane_b32 s7, v11
  v_and_b32 v3, 15, v1
  v_lshrrev_b32 v4, 4, v1
  s_and_b32 s12, s2, 7
  s_lshr_b32 s13, s2, 3
  s_and_b32 s4, s13, 15
  s_lshr_b32 s14, s13, 4
  s_lshl_b32 s3, s12, 1
  s_add_u32 s3, s3, s14
  s_lshr_b32 s14, s4, 3
  s_lshl_b32 s5, s3, 1
  s_add_u32 s5, s5, s14
  s_and_b32 s6, s4, 7
  s_mov_b32 s0, s12
  s_mov_b32 s1, s13
  s_getreg_b32 s11, hwreg(HW_REG_XCC_ID, 0, 4)
  s_mov_b32 s10, 524288
  s_mul_i32 s95, s4, 31
  s_add_u32 s95, s95, s3
  s_mul_i32 s95, s95, 768
  s_getpc_b64 s[98:99]
L_pc:
  s_and_b32 vcc_lo, s1, 7
  s_lshl_b32 vcc_lo, vcc_lo, 2
  s_add_u32 vcc_lo, vcc_lo, s7
  s_lshl_b32 vcc_lo, vcc_lo, 11
  v_lshl_add_u32 v15, v3, 7, vcc_lo
  v_min_u32 v15, L_codeend-L_pc-4, v15
  s_mov_b64 exec, 0xffff
  global_load_dword a250, v15, s[98:99]
  s_mov_b64 exec, -1
  s_mov_b32 s2, 0x3f803f80
  s_waitcnt lgkmcnt(0)
  s_load_dword s8, s[50:51], 0
  s_lshr_b32 s12, s1, 1
  s_mul_i32 s12, s12, 5
  s_mul_i32 s13, s0, 80
  s_add_u32 s12, s12, s13
  s_and_b32 s13, s1, 1
  s_lshl_b32 s13, s13, 1
  s_add_u32 s14, s13, s7
  s_cmp_lt_u32 s7, 2
  s_cselect_b32 s14, s14, 4
  s_add_u32 s74, s12, s14
  s_lshr_b32 s14, s7, 1
  s_add_u32 s14, s14, s13
  s_add_u32 s14, s14, s12
  s_lshl_b32 s14, s14, 1
  s_and_b32 s14, s14, 0xfffffffc
  s_load_dword s72, s[44:45], s14
  s_add_u32 s14, s12, 4
  s_lshl_b32 s14, s14, 1
  s_and_b32 s14, s14, 0xfffffffc
  s_load_dword s9, s[44:45], s14
  s_mov_b32 s97, s12
  s_mov_b32 s45, s13
  s_mul_i32 s34, s7, 4608
  s_add_u32 s34, s34, 61440
  s_lshl_b32 s73, s3, 8
  s_lshl_b32 s13, s4, 4
  s_add_u32 s73, s73, s13
  s_lshl_b32 s13, s7, 2
  s_add_u32 s73, s73, s13
  s_mov_b32 s80, s16
  s_and_b32 s81, s17, 0xffff
  s_mov_b32 s82, 2621440
  s_mov_b32 s83, 0x20000
  s_mov_b32 s52, s50
  s_and_b32 s53, s51, 0xffff
  s_mov_b32 s54, 41943040
  s_mov_b32 s55, 0x20000
  s_mov_b32 s56, s22
  s_and_b32 s57, s23, 0xffff
  s_mov_b32 s58, 819200
  s_mov_b32 s59, 0x20000
  s_mov_b32 s60, s24
  s_and_b32 s61, s25, 0xffff
  s_mov_b32 s62, 819200
  s_mov_b32 s63, 0x20000
  v_mov_b32 v185, 0
  s_cmp_lt_u32 s7, 2
  s_cbranch_scc1 ln_1
  s_cmp_eq_u32 s7, 2
  s_cbranch_scc1 w2_2
  s_mov_b32 s64, s36
  s_and_b32 s65, s37, 0xffff
  s_mov_b32 s66, 2621440
  s_mov_b32 s67, 0x20000
  s_mov_b32 s68, s38
  s_and_b32 s69, s39, 0xffff
  s_mov_b32 s70, 2621440
  s_mov_b32 s71, 0x20000
  s_mul_i32 s13, s1, 81920
  s_mul_i32 s14, s0, 160
  s_add_u32 s13, s13, s14
  v_mul_u32_u24 v11, 205, v1
  v_lshrrev_b32 v11, 11, v11
  v_mul_u32_u24 v11, 1120, v11
  v_add3_u32 v11, v11, v2, s13
  v_subrev_u32 v12, 3840, v11
  v_add_u32 v13, 3840, v11
  s_mov_b32 exec_hi, 0x0fffffff
  s_mov_b32 m0, 77824
  s_mov_b32 s12, 0
  buffer_load_dwordx4 v12, s[64:67], s12 offen lds
  s_mov_b32 m0, 89344
  s_mov_b32 s12, 0
  buffer_load_dwordx4 v11, s[68:71], s12 offen lds
  s_mov_b32 m0, 78784
  s_mov_b32 s12, 0
  buffer_load_dwordx4 v13, s[64:67], s12 offen lds
  s_mov_b32 m0, 90304
  s_mov_b32 s12, 7680
  buffer_load_dwordx4 v11, s[68:71], s12 offen lds
  s_mov_b32 m0, 79744
  s_mov_b32 s12, 7680
  buffer_load_dwordx4 v13, s[64:67], s12 offen lds
  s_mov_b32 m0, 91264
  s_mov_b32 s12, 15360
  buffer_load_dwordx4 v11, s[68:71], s12 offen lds
  s_mov_b32 m0, 80704
  s_mov_b32 s12, 15360
  buffer_load_dwordx4 v13, s[64:67], s12 offen lds
  s_mov_b32 m0, 92224
  s_mov_b32 s12, 23040
  buffer_load_dwordx4 v11, s[68:71], s12 offen lds
  s_mov_b32 m0, 81664
  s_mov_b32 s12, 23040
  buffer_load_dwordx4 v13, s[64:67], s12 offen lds
  s_mov_b32 m0, 93184
  s_mov_b32 s12, 30720
  buffer_load_dwordx4 v11, s[68:71], s12 offen lds
  s_mov_b32 m0, 82624
  s_mov_b32 s12, 30720
  buffer_load_dwordx4 v13, s[64:67], s12 offen lds
  s_mov_b32 m0, 94144
  s_mov_b32 s12, 38400
  buffer_load_dwordx4 v11, s[68:71], s12 offen lds
  s_mov_b32 m0, 83584
  s_mov_b32 s12, 38400
  buffer_load_dwordx4 v13, s[64:67], s12 offen lds
  s_mov_b32 m0, 95104
  s_mov_b32 s12, 46080
  buffer_load_dwordx4 v11, s[68:71], s12 offen lds
  s_mov_b32 m0, 84544
  s_mov_b32 s12, 46080
  buffer_load_dwordx4 v13, s[64:67], s12 offen lds
  s_mov_b32 m0, 96064
  s_mov_b32 s12, 53760
  buffer_load_dwordx4 v11, s[68:71], s12 offen lds
  s_mov_b32 m0, 85504
  s_mov_b32 s12, 53760
  buffer_load_dwordx4 v13, s[64:67], s12 offen lds
  s_mov_b32 m0, 97024
  s_mov_b32 s12, 61440
  buffer_load_dwordx4 v11, s[68:71], s12 offen lds
  s_mov_b32 m0, 86464
  s_mov_b32 s12, 61440
  buffer_load_dwordx4 v13, s[64:67], s12 offen lds
  s_mov_b32 m0, 97984
  s_mov_b32 s12, 69120
  buffer_load_dwordx4 v11, s[68:71], s12 offen lds
  s_mov_b32 exec_hi, 0x0fffffff
  s_mov_b32 m0, 87424
  s_mov_b32 s12, 69120
  buffer_load_dwordx4 v13, s[64:67], s12 offen lds
  s_mov_b32 exec_hi, 0xff
  s_mov_b32 m0, 98944
  s_mov_b32 s12, 76800
  buffer_load_dwordx4 v11, s[68:71], s12 offen lds
  s_mov_b32 s68, s40
  s_and_b32 s69, s41, 0xffff
  s_mov_b32 s70, 5120
  s_mov_b32 s71, 0x20000
  s_mul_i32 s13, s0, 640
  s_mov_b32 m0, 99904
  s_nop 0
  buffer_load_dwordx4 v2, s[68:71], s13 offen lds
  s_mov_b64 exec, 0x3ff
  s_mov_b32 m0, 88384
  s_mov_b32 s12, 76800
  buffer_load_dwordx4 v13, s[64:67], s12 offen lds
  s_mov_b64 exec, -1
  s_branch join_3
w2_2:
  v_min_u32 v11, 39, v1
  s_mul_i32 s12, s4, 80
  v_lshl_add_u32 v14, v11, 1, s12
  global_load_ushort v42, v14, s[18:19]
  global_load_ushort v43, v14, s[20:21]
  global_load_ushort v44, v14, s[30:31]
  s_branch join_3
ln_1:
  v_lshrrev_b32 v12, 1, v1
  v_and_b32 v11, 1, v1
  v_lshlrev_b32 v11, 7, v11
  v_lshl_add_u32 v11, v12, 12, v11
  s_lshl_b32 s12, s3, 8
  s_add_u32 s12, s12, 4096
  v_add_u32 v11, s12, v11
  s_lshl_b32 s12, s0, 9
  s_add_u32 s12, s12, 27648
  v_lshl_add_u32 v12, v1, 7, s12
  v_cmp_lt_u32 vcc, 7, v1
  s_lshl_b32 s12, s0, 8
  s_add_u32 s12, s12, 294912
  v_cndmask_b32 v11, v11, v12, vcc
  v_mov_b32 v12, s12
  v_cmp_lt_u32 vcc, 11, v1
  s_nop 1
  v_cndmask_b32 v11, v11, v12, vcc
  buffer_load_dword a250, v11, s[52:55], 0 offen
join_3:
  s_lshl_b32 s12, s5, 6
  s_lshr_b32 s13, s7, 1
  s_lshl_b32 s13, s13, 5
  s_add_u32 s12, s12, s13
  s_and_b32 s13, s7, 1
  s_lshl_b32 s13, s13, 2
  s_add_u32 s12, s12, s13
  s_mul_i32 s12, s12, 1280
  s_mul_i32 s13, s6, 160
  s_add_u32 s12, s12, s13
  v_add_u32_e64 v11, 0, v1
  v_mul_u32_u24 v12, 205, v11
  v_lshrrev_b32 v12, 11, v12
  v_lshrrev_b32 v13, 2, v12
  v_mul_u32_u24 v12, 1120, v12
  v_mul_u32_u24 v13, 5120, v13
  v_lshlrev_b32_e64 v11, 4, v11
  v_add3_u32 v11, v11, v12, v13
  v_add_u32 v174, s12, v11
  v_add_u32 v11, 64, v1
  v_mul_u32_u24 v12, 205, v11
  v_lshrrev_b32 v12, 11, v12
  v_lshrrev_b32 v13, 2, v12
  v_mul_u32_u24 v12, 1120, v12
  v_mul_u32_u24 v13, 5120, v13
  v_lshlrev_b32_e64 v11, 4, v11
  v_add3_u32 v11, v11, v12, v13
  v_add_u32_e64 v175, s12, v11
  v_add_u32 v11, 128, v1
  v_mul_u32_u24 v12, 205, v11
  v_lshrrev_b32 v12, 11, v12
  v_lshrrev_b32 v13, 2, v12
  v_mul_u32_u24 v12, 1120, v12
  v_mul_u32_u24 v13, 5120, v13
  v_lshlrev_b32_e64 v11, 4, v11
  v_add3_u32 v11, v11, v12, v13
  v_add_u32 v176, s12, v11
  s_mov_b32 s44, s7
  s_lshl_b32 s17, s6, 9
  s_lshl_b32 s13, s7, 2
  s_add_u32 s17, s17, s13
  s_lshl_b32 s13, s5, 4
  s_add_u32 s17, s17, s13
  s_lshl_b32 s16, s0, 9
  s_lshl_b32 s13, s7, 2
  s_add_u32 s16, s16, s13
  s_lshl_b32 s13, s1, 4
  s_add_u32 s16, s16, s13
  s_lshl_b32 s12, s5, 2
  s_add_u32 s12, s12, s7
  s_min_u32 s12, s12, 99
  s_mul_i32 s13, s12, 205
  s_lshr_b32 s13, s13, 10
  s_mul_i32 s14, s13, 5
  s_sub_u32 s14, s12, s14
  s_mul_i32 s96, s6, 200
  s_mul_i32 s15, s13, 10
  s_add_u32 s96, s96, s15
  s_add_u32 s96, s96, s14
  s_lshl_b32 s96, s96, 10
  s_add_u32 s96, s96, 23068672
  s_mul_i32 s15, s6, 5
  s_add_u32 s15, s15, s14
  s_mul_i32 s15, s15, 20480
  s_lshl_b32 s13, s13, 6
  s_add_u32 s15, s15, s13
  v_mul_u32_u24 v14, 1280, v3
  v_lshl_add_u32 v14, v4, 4, v14
  v_add_u32 v247, s15, v14
  v_lshrrev_b32 v11, 3, v1
  v_and_b32 v12, 7, v1
  v_lshrrev_b32 v13, 1, v11
  v_lshlrev_b32 v13, 1, v13
  s_movk_i32 s15, 0x78
  v_bfe_u32 v13, s15, v13, 2
  v_xor_b32 v12, v12, v13
  v_mul_u32_u24 v11, 1280, v11
  v_lshl_add_u32 v45, v12, 4, v11
  v_xor_b32 v46, 64, v45
  s_bitcmp1_b32 s7, 0
  s_cselect_b32 s64, s60, s56
  s_cselect_b32 s65, s61, s57
  s_mov_b32 s66, 819200
  s_mov_b32 s67, 0x20000
  s_cselect_b32 s30, 1024, 0
  s_cselect_b32 vcc_lo, -1, 0
  s_cselect_b32 vcc_hi, -1, 0
  s_mul_i32 s31, s4, 51200
  v_cndmask_b32 v47, v45, v46, vcc
  s_mul_i32 s12, s0, 80
  s_lshl_b32 s13, s44, 5
  s_add_u32 s12, s12, s13
  s_lshl_b32 s12, s12, 12
  s_lshl_b32 s13, s1, 7
  s_sub_u32 s12, s12, s13
  s_add_u32 s12, s12, 4198272
  s_cmp_lt_u32 s44, 3
  s_cselect_b32 s36, s12, 1879048192
  s_cmp_lt_u32 s44, 2
  s_cselect_b32 s13, 0, 1879048192
  v_cmp_lt_u32 vcc, 31, v1
  v_mov_b32 v13, s13
  s_nop 0
  v_cndmask_b32 v13, 0, v13, vcc
  s_cmp_lt_u32 s5, 25
  s_cselect_b32 s38, s96, 1879048192
  s_add_u32 s95, s95, 327680
  s_cmp_lt_u32 s3, 15
  s_cselect_b32 s37, s95, 1879048192
  v_lshrrev_b32 v11, 3, v1
  v_and_b32 v12, 7, v1
  v_lshlrev_b32_e64 v12, 4, v12
  v_lshl_add_u32 v211, v11, 14, v12
  v_add_u32 v211, v211, v13
  v_mov_b32 v248, 0
  v_mov_b32 v249, 0
  v_min_u32 v222, 39, v1
  v_lshlrev_b32 v222, 4, v222
  v_and_b32 v223, 31, v1
  v_lshlrev_b32 v223, 4, v223
  s_lshr_b32 s12, s7, 1
  s_mul_i32 s13, s12, 10240
  s_add_u32 s40, s30, s13
  s_lshl_b32 s12, s12, 7
  s_add_u32 s41, s31, s12
  s_mul_i32 s12, s7, 6
  s_add_u32 s12, s12, 0
  s_lshr_b32 s13, s12, 3
  s_and_b32 s12, s12, 7
  s_add_u32 s14, s13, s45
  s_cmp_lt_u32 s13, 2
  s_cselect_b32 s14, s14, 4
  s_add_u32 s14, s14, s97
  s_lshl_b32 s14, s14, 12
  s_add_u32 s14, s14, 4194304
  s_cmp_lt_u32 s12, 6
  s_cselect_b32 s20, s14, 1879048192
  s_lshl_b32 s12, s12, 6
  v_add_u32_e64 v11, s12, v1
  v_mul_u32_u24 v12, 171, v11
  v_lshrrev_b32 v12, 10, v12
  v_lshlrev_b32 v12, 1, v12
  v_sub_u32 v11, v11, v12
  v_lshlrev_b32 v216, 4, v11
  s_mul_i32 s12, s7, 6
  s_add_u32 s12, s12, 1
  s_lshr_b32 s13, s12, 3
  s_and_b32 s12, s12, 7
  s_add_u32 s14, s13, s45
  s_cmp_lt_u32 s13, 2
  s_cselect_b32 s14, s14, 4
  s_add_u32 s14, s14, s97
  s_lshl_b32 s14, s14, 12
  s_add_u32 s14, s14, 4194304
  s_cmp_lt_u32 s12, 6
  s_cselect_b32 s21, s14, 1879048192
  s_lshl_b32 s12, s12, 6
  v_add_u32 v11, s12, v1
  v_mul_u32_u24 v12, 171, v11
  v_lshrrev_b32 v12, 10, v12
  v_lshlrev_b32 v12, 1, v12
  v_sub_u32 v11, v11, v12
  v_lshlrev_b32 v217, 4, v11
  s_mul_i32 s12, s7, 6
  s_add_u32 s12, s12, 2
  s_lshr_b32 s13, s12, 3
  s_and_b32 s12, s12, 7
  s_add_u32 s14, s13, s45
  s_cmp_lt_u32 s13, 2
  s_cselect_b32 s14, s14, 4
  s_add_u32 s14, s14, s97
  s_lshl_b32 s14, s14, 12
  s_add_u32 s14, s14, 4194304
  s_cmp_lt_u32 s12, 6
  s_cselect_b32 s22, s14, 1879048192
  s_lshl_b32 s12, s12, 6
  v_add_u32 v11, s12, v1
  v_mul_u32_u24 v12, 171, v11
  v_lshrrev_b32 v12, 10, v12
  v_lshlrev_b32 v12, 1, v12
  v_sub_u32 v11, v11, v12
  v_lshlrev_b32 v218, 4, v11
  s_mul_i32 s12, s7, 6
  s_add_u32 s12, s12, 3
  s_lshr_b32 s13, s12, 3
  s_and_b32 s12, s12, 7
  s_add_u32 s14, s13, s45
  s_cmp_lt_u32 s13, 2
  s_cselect_b32 s14, s14, 4
  s_add_u32 s14, s14, s97
  s_lshl_b32 s14, s14, 12
  s_add_u32 s14, s14, 4194304
  s_cmp_lt_u32 s12, 6
  s_cselect_b32 s23, s14, 1879048192
  s_lshl_b32 s12, s12, 6
  v_add_u32 v11, s12, v1
  v_mul_u32_u24 v12, 171, v11
  v_lshrrev_b32 v12, 10, v12
  v_lshlrev_b32 v12, 1, v12
  v_sub_u32 v11, v11, v12
  v_lshlrev_b32 v219, 4, v11
  s_mul_i32 s12, s7, 6
  s_add_u32 s12, s12, 4
  s_lshr_b32 s13, s12, 3
  s_and_b32 s12, s12, 7
  s_add_u32 s14, s13, s45
  s_cmp_lt_u32 s13, 2
  s_cselect_b32 s14, s14, 4
  s_add_u32 s14, s14, s97
  s_lshl_b32 s14, s14, 12
  s_add_u32 s14, s14, 4194304
  s_cmp_lt_u32 s12, 6
  s_cselect_b32 s24, s14, 1879048192
  s_lshl_b32 s12, s12, 6
  v_add_u32 v11, s12, v1
  v_mul_u32_u24 v12, 171, v11
  v_lshrrev_b32 v12, 10, v12
  v_lshlrev_b32 v12, 1, v12
  v_sub_u32 v11, v11, v12
  v_lshlrev_b32 v220, 4, v11
  s_mul_i32 s12, s7, 6
  s_add_u32 s12, s12, 5
  s_lshr_b32 s13, s12, 3
  s_and_b32 s12, s12, 7
  s_add_u32 s14, s13, s45
  s_cmp_lt_u32 s13, 2
  s_cselect_b32 s14, s14, 4
  s_add_u32 s14, s14, s97
  s_lshl_b32 s14, s14, 12
  s_add_u32 s14, s14, 4194304
  s_cmp_lt_u32 s12, 6
  s_cselect_b32 s25, s14, 1879048192
  s_lshl_b32 s12, s12, 6
  v_add_u32 v11, s12, v1
  v_mul_u32_u24 v12, 171, v11
  v_lshrrev_b32 v12, 10, v12
  v_lshlrev_b32 v12, 1, v12
  v_sub_u32 v11, v11, v12
  v_lshlrev_b32 v221, 4, v11
  s_lshl_b32 s12, s74, 12
  s_add_u32 s68, s42, s12
  s_addc_u32 s69, s43, 0
  s_and_b32 s69, s69, 0xffff
  s_mov_b32 s70, 4096
  s_mov_b32 s71, 0x20000
  v_and_b32 v11, 1, v3
  v_lshrrev_b32 v12, 1, v3
  v_lshrrev_b32 v13, 2, v3
  v_lshlrev_b32 v13, 1, v13
  s_movk_i32 s15, 0x78
  v_bfe_u32 v13, s15, v13, 2
  v_xor_b32_e64 v13, v13, v4
  v_lshl_add_u32 v13, v11, 2, v13
  v_lshlrev_b32_e64 v13, 4, v13
  v_lshl_add_u32 v13, v12, 7, v13
  v_lshl_add_u32 v5, v11, 10, v13
  v_xor_b32_e64 v6, 64, v5
  v_add_u32 v7, 51200, v5
  v_add_u32 v8, 51200, v6
  v_mul_u32_u24 v9, 144, v12
  v_lshl_add_u32 v9, v11, 2, v9
  v_lshl_add_u32 v9, v4, 3, v9
  s_lshl_b32 s12, s7, 5
  s_add_u32 s12, s12, 158080
  v_add_u32 v9, s12, v9
  v_lshrrev_b32_e64 v11, 2, v3
  v_mul_u32_u24 v11, 5120, v11
  v_and_b32_e64 v12, 3, v3
  v_lshl_add_u32 v11, v12, 4, v11
  v_lshl_add_u32 v0, v4, 6, v11
  s_lshl_b32 s12, s3, 2
  s_add_u32 s12, s12, s7
  s_mul_i32 s12, s12, 81920
  s_mul_i32 s13, s4, 5
  s_add_u32 s14, s13, 0
  s_lshr_b32 s15, s14, 2
  s_lshl_b32 s15, s15, 11
  s_and_b32 s14, s14, 3
  s_lshl_b32 s14, s14, 8
  s_add_u32 s14, s14, s15
  s_add_u32 s75, s14, s12
  s_add_u32 s14, s13, 1
  s_lshr_b32 s15, s14, 2
  s_lshl_b32 s15, s15, 11
  s_and_b32 s14, s14, 3
  s_lshl_b32 s14, s14, 8
  s_add_u32 s14, s14, s15
  s_add_u32 s76, s14, s12
  s_add_u32 s14, s13, 2
  s_lshr_b32 s15, s14, 2
  s_lshl_b32 s15, s15, 11
  s_and_b32 s14, s14, 3
  s_lshl_b32 s14, s14, 8
  s_add_u32 s14, s14, s15
  s_add_u32 s77, s14, s12
  s_add_u32 s14, s13, 3
  s_lshr_b32 s15, s14, 2
  s_lshl_b32 s15, s15, 11
  s_and_b32 s14, s14, 3
  s_lshl_b32 s14, s14, 8
  s_add_u32 s14, s14, s15
  s_add_u32 s78, s14, s12
  s_add_u32 s14, s13, 4
  s_lshr_b32 s15, s14, 2
  s_lshl_b32 s15, s15, 11
  s_and_b32 s14, s14, 3
  s_lshl_b32 s14, s14, 8
  s_add_u32 s14, s14, s15
  s_add_u32 s79, s14, s12
  s_lshl_b32 s12, s5, 5
  s_lshl_b32 s13, s6, 2
  s_add_u32 s12, s12, s13
  s_add_u32 s35, s12, s7
  v_lshrrev_b32 v11, 3, v1
  v_and_b32 v12, 6, v11
  v_xor_b32 v12, v12, v1
  v_and_b32 v12, 7, v12
  v_lshrrev_b32_e64 v13, 2, v11
  v_lshl_add_u32 v11, v13, 2, v11
  v_mul_u32_u24 v11, 1280, v11
  v_lshl_add_u32 v186, v12, 4, v11
  s_mul_i32 s19, s7, 14336
  s_add_u32 s19, s19, 102400
  v_and_b32 v11, 6, v3
  v_xor_b32 v11, v11, v4
  v_lshlrev_b32_e64 v11, 4, v11
  v_lshl_add_u32 v11, v3, 7, v11
  v_add_u32 v184, s19, v11
  v_xor_b32 v189, 64, v184
  s_lshl_b32 s18, s3, 2
  s_add_u32 s18, s18, s7
  s_mul_i32 s18, s18, 40960
  v_mul_u32_u24 v187, 160, v3
  v_lshl_add_u32 v187, v4, 3, v187
  v_add_u32 v187, s19, v187
  s_cmp_lt_u32 s7, 2
  s_cbranch_scc1 ln_4
  s_cmp_eq_u32 s7, 2
  s_cbranch_scc1 w2_5
  s_lshl_b32 s12, s3, 4
  s_add_u32 s12, s12, s4
  s_mul_i32 s12, s12, 10240
  v_lshrrev_b32 v11, 3, v1
  v_mul_u32_u24 v11, 1280, v11
  v_and_b32_e64 v12, 7, v1
  v_lshl_add_u32 v11, v12, 4, v11
  buffer_load_dwordx4 v[128:131], v11, s[80:83], s12 offen offset:0
  buffer_load_dwordx4 v[132:135], v11, s[80:83], s12 offen offset:128
  buffer_load_dwordx4 v[136:139], v11, s[80:83], s12 offen offset:256
  buffer_load_dwordx4 v[140:143], v11, s[80:83], s12 offen offset:384
  buffer_load_dwordx4 v[144:147], v11, s[80:83], s12 offen offset:512
  buffer_load_dwordx4 v[148:151], v11, s[80:83], s12 offen offset:640
  buffer_load_dwordx4 v[152:155], v11, s[80:83], s12 offen offset:768
  buffer_load_dwordx4 v[156:159], v11, s[80:83], s12 offen offset:896
  buffer_load_dwordx4 v[160:163], v11, s[80:83], s12 offen offset:1024
  buffer_load_dwordx4 v[164:167], v11, s[80:83], s12 offen offset:1152
  s_waitcnt lgkmcnt(0)
  s_lshr_b32 s8, s8, 4
  s_mul_i32 s8, s8, 0x19660d
  s_add_u32 s8, s8, 0x3c6ef35f
  s_lshl_b32 s8, s8, 4
  s_lshr_b32 s12, s7, 1
  s_add_u32 s12, s12, s97
  s_bitcmp1_b32 s12, 0
  s_cselect_b32 s12, 16, 0
  s_lshr_b32 s72, s72, s12
  s_and_b32 s72, s72, 0xffff
  s_bitcmp1_b32 s97, 0
  s_cselect_b32 s12, 16, 0
  s_lshr_b32 s9, s9, s12
  s_lshl_b32 s9, s9, 16
  s_or_b32 s72, s72, s9
  s_branch join_6
w2_5:
  s_waitcnt lgkmcnt(0)
  s_lshr_b32 s8, s8, 4
  s_mul_i32 s8, s8, 0x19660d
  s_add_u32 s8, s8, 0x3c6ef35f
  s_lshl_b32 s8, s8, 4
  s_lshr_b32 s12, s7, 1
  s_add_u32 s12, s12, s97
  s_bitcmp1_b32 s12, 0
  s_cselect_b32 s12, 16, 0
  s_lshr_b32 s72, s72, s12
  s_and_b32 s72, s72, 0xffff
  s_bitcmp1_b32 s97, 0
  s_cselect_b32 s12, 16, 0
  s_lshr_b32 s9, s9, s12
  s_lshl_b32 s9, s9, 16
  s_or_b32 s72, s72, s9
  s_lshl_b32 s12, s0, 8
  s_lshl_b32 s13, s1, 2
  s_add_u32 s12, s12, s13
  s_add_u32 s12, s12, 294912
  s_or_b32 s13, s8, s11
  v_mov_b32 v15, s13
  s_mov_b64 exec, 1
  buffer_store_dword v15, off, s[52:55], s12 offset:128 sc1
  s_mov_b64 exec, -1
  s_waitcnt vmcnt(1)
  v_lshlrev_b32 v42, 16, v42
  v_lshlrev_b32 v43, 16, v43
  v_lshlrev_b32 v44, 16, v44
  v_mul_f32 v44, 0x3fb8aa3b, v44
  v_exp_f32 v44, v44
  s_nop 0
  v_cvt_pk_bf16_f32 v44, v44, v44
  v_and_b32 v44, 0xffff0000, v44
  v_mul_f32 v88, v44, v42
  v_mul_f32 v89, v44, v43
  v_mul_f32 v88, 0x3fb8aa3b, v88
  v_mul_f32 v89, 0x3e22f983, v89
  v_mul_f32 v90, 1.0, v88
  v_mul_f32 v91, 1.0, v89
  v_exp_f32 v90, v90
  v_fract_f32 v91, v91
  v_sin_f32 v92, v91
  v_cos_f32 v93, v91
  v_mul_f32 v97, v90, v92
  v_mul_f32_e64 v96, v90, v93
  v_mul_f32 v90, 0x41000000, v88
  v_mul_f32 v91, 0x41000000, v89
  v_exp_f32 v90, v90
  v_fract_f32 v91, v91
  v_sin_f32 v92, v91
  v_cos_f32 v93, v91
  v_mul_f32 v37, v90, v92
  v_mul_f32 v36, v90, v93
  v_mul_f32 v90, 0x43000000, v88
  v_mul_f32 v91, 0x43000000, v89
  v_exp_f32 v90, v90
  v_fract_f32 v91, v91
  v_sin_f32 v92, v91
  v_cos_f32 v93, v91
  v_mul_f32 v39, v90, v92
  v_mul_f32 v38, v90, v93
  v_mul_f32 v90, v42, v42
  v_fmac_f32 v90, v43, v43
  v_rcp_f32 v90, v90
  v_add_f32 v91, -1.0, v96
  v_add_f32 v90, v90, v90
  v_mul_f32 v92, v91, v42
  v_fmac_f32 v92, v97, v43
  v_mul_f32 v93, v97, v42
  v_fma_f32 v93, -v91, v43, v93
  v_mul_f32 v98, v90, v92
  v_mul_f32 v99, v90, v93
  v_min_u32 v11, 39, v1
  v_lshlrev_b32 v11, 5, v11
  v_add_u32 v11, 160000, v11
  ds_write_b128 v11, v[96:99]
  ds_write_b128 v11, v[36:39] offset:16
  s_waitcnt lgkmcnt(0)
  s_branch join_6
ln_4:
  s_cmp_eq_u32 s7, 0
  s_cbranch_scc1 skip_7
  s_add_u32 s14, s31, 0
  s_mov_b32 m0, 0
  s_nop 0
  buffer_load_dwordx4 v45, s[56:59], s14 offen lds
  s_mov_b32 m0, 1024
  s_nop 0
  buffer_load_dwordx4 v46, s[60:63], s14 offen lds
  s_add_u32 s14, s31, 10240
  s_mov_b32 m0, 2048
  s_nop 0
  buffer_load_dwordx4 v45, s[56:59], s14 offen lds
  s_mov_b32 m0, 3072
  s_nop 0
  buffer_load_dwordx4 v46, s[60:63], s14 offen lds
  s_add_u32 s14, s31, 20480
  s_mov_b32 m0, 4096
  s_nop 0
  buffer_load_dwordx4 v45, s[56:59], s14 offen lds
  s_mov_b32 m0, 5120
  s_nop 0
  buffer_load_dwordx4 v46, s[60:63], s14 offen lds
  s_add_u32 s14, s31, 30720
  s_mov_b32 m0, 6144
  s_nop 0
  buffer_load_dwordx4 v45, s[56:59], s14 offen lds
  s_mov_b32 m0, 7168
  s_nop 0
  buffer_load_dwordx4 v46, s[60:63], s14 offen lds
  s_add_u32 s14, s31, 40960
  s_mov_b32 m0, 8192
  s_nop 0
  buffer_load_dwordx4 v45, s[56:59], s14 offen lds
  s_mov_b32 m0, 9216
  s_nop 0
  buffer_load_dwordx4 v46, s[60:63], s14 offen lds
  s_add_u32 s14, s31, 128
  s_mov_b32 m0, 10240
  s_nop 0
  buffer_load_dwordx4 v45, s[56:59], s14 offen lds
  s_mov_b32 m0, 11264
  s_nop 0
  buffer_load_dwordx4 v46, s[60:63], s14 offen lds
  s_add_u32 s14, s31, 10368
  s_mov_b32 m0, 12288
  s_nop 0
  buffer_load_dwordx4 v45, s[56:59], s14 offen lds
  s_mov_b32 m0, 13312
  s_nop 0
  buffer_load_dwordx4 v46, s[60:63], s14 offen lds
  s_add_u32 s14, s31, 20608
  s_mov_b32 m0, 14336
  s_nop 0
  buffer_load_dwordx4 v45, s[56:59], s14 offen lds
  s_mov_b32 m0, 15360
  s_nop 0
  buffer_load_dwordx4 v46, s[60:63], s14 offen lds
  s_add_u32 s14, s31, 30848
  s_mov_b32 m0, 16384
  s_nop 0
  buffer_load_dwordx4 v45, s[56:59], s14 offen lds
  s_mov_b32 m0, 17408
  s_nop 0
  buffer_load_dwordx4 v46, s[60:63], s14 offen lds
  s_add_u32 s14, s31, 41088
  s_mov_b32 m0, 18432
  s_nop 0
  buffer_load_dwordx4 v45, s[56:59], s14 offen lds
  s_mov_b32 m0, 19456
  s_nop 0
  buffer_load_dwordx4 v46, s[60:63], s14 offen lds
skip_7:
  s_waitcnt lgkmcnt(0)
  s_lshr_b32 s8, s8, 4
  s_mul_i32 s8, s8, 0x19660d
  s_add_u32 s8, s8, 0x3c6ef35f
  s_lshl_b32 s8, s8, 4
  s_lshr_b32 s12, s7, 1
  s_add_u32 s12, s12, s97
  s_bitcmp1_b32 s12, 0
  s_cselect_b32 s12, 16, 0
  s_lshr_b32 s72, s72, s12
  s_and_b32 s72, s72, 0xffff
  s_bitcmp1_b32 s97, 0
  s_cselect_b32 s12, 16, 0
  s_lshr_b32 s9, s9, s12
  s_lshl_b32 s9, s9, 16
  s_or_b32 s72, s72, s9
  s_lshl_b32 s12, s0, 8
  s_lshl_b32 s13, s1, 2
  s_add_u32 s12, s12, s13
  s_add_u32 s12, s12, 294912
  s_or_b32 s13, s8, s11
  v_mov_b32 v15, s13
  s_mov_b64 exec, 1
  buffer_store_dword v15, off, s[52:55], s12
  s_mov_b64 exec, -1
join_6:
  v_mov_b32 v250, s8
  v_mov_b32 v251, s8
  v_and_b32 v80, 31, v1
  v_lshlrev_b32 v80, 2, v80
  s_lshl_b32 s96, s0, 8
  s_add_u32 s96, s96, 294912
  v_and_b32 v11, 3, v3
  v_mul_u32_u24 v11, 4160, v11
  v_lshrrev_b32_e64 v12, 2, v3
  v_lshl_add_u32 v11, v12, 3, v11
  v_lshlrev_b32 v12, 4, v4
  v_sub_u32 v12, 48, v12
  v_add_u32 v11, v11, v12
  v_sub_u32 v13, 15, v3
  v_mul_u32_u24 v13, 96, v13
  v_add_u32 v13, v13, v12
  s_lshr_b32 s12, s7, 1
  s_mul_i32 s13, s12, 16640
  s_and_b32 s14, s7, 1
  s_lshl_b32 s14, s14, 5
  s_add_u32 s13, s13, s14
  s_add_u32 s13, s13, 102400
  v_add_u32 v252, s13, v11
  s_lshl_b32 s12, s12, 13
  v_add_u32 v254, s12, v13
  s_and_b32 s14, s1, 1
  s_lshl_b32 s14, s14, 5
  s_lshl_b32 s13, s7, 8
  s_add_u32 s13, s13, s14
  s_add_u32 s13, s13, 135680
  v_add_u32_e64 v253, s13, v11
  s_mul_i32 s13, s7, 384
  s_add_u32 s13, s13, 16384
  v_add_u32_e64 v255, s13, v13
  v_accvgpr_write_b32 a208, v252
  v_accvgpr_write_b32 a209, v253
  v_accvgpr_write_b32 a210, v254
  v_accvgpr_write_b32 a211, v255
  v_sub_u32_e64 v11, 15, v3
  v_mul_u32_u24 v11, 96, v11
  v_lshlrev_b32 v12, 3, v4
  v_sub_u32 v11, v11, v12
  s_lshr_b32 s12, s7, 1
  s_and_b32 s13, s7, 1
  s_lshl_b32 s13, s13, 5
  s_lshl_b32 s14, s12, 13
  s_sub_u32 s14, s14, s13
  s_add_u32 s14, s14, 56
  v_add_u32_e64 v13, s14, v11
  v_accvgpr_write_b32 a232, v13
  s_and_b32 s14, s1, 1
  s_lshl_b32 s14, s14, 5
  s_mul_i32 s15, s7, 1536
  s_add_u32 s14, s14, s15
  s_sub_u32 s14, 21048, s14
  v_add_u32 v13, s14, v11
  v_accvgpr_write_b32 a233, v13
  v_mul_u32_u24 v11, 80, v3
  v_add_u32_e64 v11, v11, v12
  s_mul_i32 s14, s12, 5120
  s_add_u32 s14, s14, s13
  s_add_u32 s14, s14, 118784
  v_add_u32 v12, s14, v11
  v_accvgpr_write_b32 a234, v12
  s_lshl_b32 s14, s7, 12
  s_add_u32 s14, s14, 102400
  v_add_u32 v13, s14, v2
  v_accvgpr_write_b32 a235, v13
  s_lshl_b32 s14, s7, 10
  s_add_u32 s14, s14, 102400
  v_add_u32 v13, s14, v2
  v_accvgpr_write_b32 a236, v13
  v_lshrrev_b32_e64 v14, 2, v1
  v_mul_u32_u24 v14, 80, v14
  v_and_b32_e64 v12, 3, v1
  v_lshl_add_u32 v14, v12, 4, v14
  s_mul_i32 s14, s7, 2560
  s_add_u32 s14, s14, 118784
  v_add_u32_e64 v14, s14, v14
  v_accvgpr_write_b32 a237, v14
  s_mul_i32 s14, s7, 1280
  s_add_u32 s14, s14, 129024
  v_add_u32_e64 v11, s14, v11
  v_accvgpr_write_b32 a238, v11
  v_lshrrev_b32 v14, 1, v1
  v_and_b32 v12, 1, v1
  v_lshlrev_b32_e64 v12, 4, v12
  v_lshl_add_u32 v13, v14, 6, v12
  v_mul_u32_u24 v14, 80, v14
  v_add3_u32 v14, v14, v12, s14
  v_accvgpr_write_b32 a251, v13
  v_accvgpr_write_b32 a239, v14
  s_lshr_b32 s92, s1, 1
  s_mul_i32 s92, s92, 5
  s_mul_i32 s93, s0, 80
  s_add_u32 s92, s92, s93
  s_lshl_b32 s92, s92, 12
  s_add_u32 s92, s92, 19922944
  s_and_b32 s14, s1, 1
  s_lshl_b32 s93, s14, 13
  s_lshl_b32 s15, s7, 11
  s_add_u32 s93, s93, s15
  s_add_u32 s93, s93, s92
  s_lshl_b32 s14, s14, 5
  s_lshl_b32 s15, s7, 10
  s_add_u32 s92, s92, s14
  s_add_u32 s92, s92, s15
  s_add_u32 s92, s92, 16384
  s_mul_i32 s12, s7, 1280
  s_add_u32 s12, s12, 152320
  v_mul_u32_u24 v11, 80, v3
  v_lshl_add_u32 v11, v4, 4, v11
  v_add_u32 v252, s12, v11
  v_bfe_u32 v12, v1, 2, 2
  v_mul_u32_u24 v12, 160, v12
  v_and_b32_e64 v13, 3, v1
  v_lshl_add_u32 v12, v13, 4, v12
  v_lshrrev_b32_e64 v13, 1, v4
  v_mul_u32_u24 v14, 80, v13
  v_lshlrev_b32_e64 v13, 10, v13
  v_add3_u32 v12, v12, v14, s12
  v_and_b32_e64 v14, 1, v4
  v_lshl_add_u32 v253, v14, 3, v12
  v_mul_u32_u24 v14, 40960, v14
  v_lshl_add_u32 v13, v3, 4, v13
  v_add_u32_e64 v254, v13, v14
  v_accvgpr_write_b32 a252, v252
  v_accvgpr_write_b32 a253, v253
  v_accvgpr_write_b32 a254, v254
  s_cmp_lg_u32 s7, 3
  s_cbranch_scc1 skip_8
  s_waitcnt vmcnt(10)
skip_8:
  s_cmp_eq_u32 s7, 3
  s_cbranch_scc1 skip_9
  s_add_u32 m0, s19, 0
  s_add_u32 s15, s18, 0
  buffer_load_dwordx4 v186, s[80:83], s15 offen lds
  s_add_u32 m0, s19, 1024
  s_add_u32 s15, s18, 20480
  buffer_load_dwordx4 v186, s[80:83], s15 offen lds
  s_add_u32 m0, s19, 2048
  s_add_u32 s15, s18, 5120
  buffer_load_dwordx4 v186, s[80:83], s15 offen lds
  s_add_u32 m0, s19, 3072
  s_add_u32 s15, s18, 25600
  buffer_load_dwordx4 v186, s[80:83], s15 offen lds
  s_add_u32 m0, s19, 4096
  s_add_u32 s15, s18, 128
  buffer_load_dwordx4 v186, s[80:83], s15 offen lds
  s_add_u32 m0, s19, 5120
  s_add_u32 s15, s18, 20608
  buffer_load_dwordx4 v186, s[80:83], s15 offen lds
  s_add_u32 m0, s19, 6144
  s_add_u32 s15, s18, 5248
  buffer_load_dwordx4 v186, s[80:83], s15 offen lds
  s_add_u32 m0, s19, 7168
  s_add_u32 s15, s18, 25728
  buffer_load_dwordx4 v186, s[80:83], s15 offen lds
  s_add_u32 m0, s19, 8192
  s_add_u32 s15, s18, 256
  buffer_load_dwordx4 v186, s[80:83], s15 offen lds
  s_add_u32 m0, s19, 9216
  s_add_u32 s15, s18, 20736
  buffer_load_dwordx4 v186, s[80:83], s15 offen lds
skip_9:
  s_barrier
  s_cmp_eq_u32 s7, 3
  s_cbranch_scc1 w3_10
  v_lshrrev_b32 v11, 3, v1
  v_and_b32 v12, 7, v1
  v_mul_u32_u24 v11, 1280, v11
  v_lshl_add_u32 v11, v12, 3, v11
  s_lshl_b32 s12, s44, 6
  s_add_u32 s12, s12, 77824
  v_add_u32 v11, s12, v11
  s_lshl_b32 s12, s44, 8
  s_add_u32 s12, s12, 99904
  v_lshl_add_u32 v12, v12, 5, s12
  ds_read_b128 v[166:169], v12
  ds_read_b128 v[170:173], v12 offset:16
  ds_read_b64 v[128:129], v11 offset:0
  ds_read_b64 v[130:131], v11 offset:160
  ds_read_b64 v[132:133], v11 offset:320
  ds_read_b64 v[134:135], v11 offset:480
  ds_read_b64 v[136:137], v11 offset:640
  ds_read_b64 v[138:139], v11 offset:800
  ds_read_b64 v[140:141], v11 offset:960
  ds_read_b64 v[142:143], v11 offset:1120
  ds_read_b64 v[144:145], v11 offset:1280
  ds_read_b64 v[146:147], v11 offset:1440
  ds_read_b64 v[148:149], v11 offset:1600
  s_waitcnt lgkmcnt(11)
  ds_read_b64 v[150:151], v11 offset:11520
  ds_read_b64 v[152:153], v11 offset:11680
  ds_read_b64 v[154:155], v11 offset:11840
  ds_read_b64 v[156:157], v11 offset:12000
  ds_read_b64 v[158:159], v11 offset:12160
  ds_read_b64 v[160:161], v11 offset:12320
  ds_read_b64 v[162:163], v11 offset:12480
  ds_read_b64 v[164:165], v11 offset:12640
  v_lshlrev_b32_e64 v192, 16, v166
  v_and_b32 v196, 0xffff0000, v166
  v_lshlrev_b32_e64 v200, 16, v167
  v_and_b32 v204, 0xffff0000, v167
  v_lshlrev_b32_e64 v193, 16, v168
  v_and_b32 v197, 0xffff0000, v168
  v_lshlrev_b32_e64 v201, 16, v169
  v_and_b32 v205, 0xffff0000, v169
  v_lshlrev_b32_e64 v194, 16, v170
  v_and_b32 v198, 0xffff0000, v170
  v_lshlrev_b32_e64 v202, 16, v171
  v_and_b32 v206, 0xffff0000, v171
  v_lshlrev_b32_e64 v195, 16, v172
  v_and_b32 v199, 0xffff0000, v172
  v_lshlrev_b32_e64 v203, 16, v173
  v_and_b32 v207, 0xffff0000, v173
  s_waitcnt lgkmcnt(8)
  v_lshlrev_b32 v84, 16, v128
  v_and_b32 v85, 0xffff0000, v128
  v_lshlrev_b32_e64 v86, 16, v129
  v_and_b32 v87, 0xffff0000, v129
  v_lshlrev_b32_e64 v88, 16, v130
  v_and_b32 v89, 0xffff0000, v130
  v_lshlrev_b32_e64 v90, 16, v131
  v_and_b32 v91, 0xffff0000, v131
  v_lshlrev_b32_e64 v92, 16, v132
  v_and_b32 v93, 0xffff0000, v132
  v_lshlrev_b32_e64 v94, 16, v133
  v_and_b32 v95, 0xffff0000, v133
  s_add_u32 m0, s19, 10240
  s_nop 0
  buffer_load_dwordx4 v174, s[80:83], 0 offen lds
  v_lshlrev_b32 v96, 16, v134
  v_and_b32 v97, 0xffff0000, v134
  v_lshlrev_b32_e64 v98, 16, v135
  v_and_b32 v99, 0xffff0000, v135
  v_lshlrev_b32_e64 v100, 16, v136
  v_and_b32 v101, 0xffff0000, v136
  v_lshlrev_b32_e64 v102, 16, v137
  v_and_b32 v103, 0xffff0000, v137
  v_lshlrev_b32_e64 v104, 16, v138
  v_and_b32 v105, 0xffff0000, v138
  v_lshlrev_b32_e64 v106, 16, v139
  v_and_b32 v107, 0xffff0000, v139
  s_add_u32 m0, s19, 11264
  s_nop 0
  buffer_load_dwordx4 v175, s[80:83], 0 offen lds
  v_lshlrev_b32 v108, 16, v140
  v_and_b32 v109, 0xffff0000, v140
  v_lshlrev_b32_e64 v110, 16, v141
  v_and_b32 v111, 0xffff0000, v141
  v_lshlrev_b32_e64 v112, 16, v142
  v_and_b32 v113, 0xffff0000, v142
  v_lshlrev_b32_e64 v114, 16, v143
  v_and_b32 v115, 0xffff0000, v143
  v_lshlrev_b32_e64 v116, 16, v144
  v_and_b32 v117, 0xffff0000, v144
  v_lshlrev_b32_e64 v118, 16, v145
  v_and_b32 v119, 0xffff0000, v145
  s_add_u32 m0, s19, 12288
  s_mov_b32 exec_hi, 0
  buffer_load_dwordx4 v176, s[80:83], 0 offen lds
  s_mov_b32 exec_hi, -1
  v_lshlrev_b32_e64 v120, 16, v146
  v_and_b32 v121, 0xffff0000, v146
  v_lshlrev_b32_e64 v122, 16, v147
  v_and_b32 v123, 0xffff0000, v147
  v_lshlrev_b32_e64 v124, 16, v148
  v_and_b32 v125, 0xffff0000, v148
  v_lshlrev_b32_e64 v126, 16, v149
  v_and_b32 v127, 0xffff0000, v149
  s_waitcnt lgkmcnt(0)
  v_lshlrev_b32 v48, 16, v150
  v_and_b32 v49, 0xffff0000, v150
  v_lshlrev_b32_e64 v50, 16, v151
  buffer_load_dword v81, v80, s[52:55], s96 offen sc1
  v_and_b32 v51, 0xffff0000, v151
  v_lshlrev_b32_e64 v52, 16, v152
  v_and_b32 v53, 0xffff0000, v152
  v_lshlrev_b32_e64 v54, 16, v153
  v_and_b32 v55, 0xffff0000, v153
  v_lshlrev_b32_e64 v56, 16, v154
  v_and_b32 v57, 0xffff0000, v154
  v_lshlrev_b32_e64 v58, 16, v155
  v_and_b32 v59, 0xffff0000, v155
  v_lshlrev_b32_e64 v60, 16, v156
  v_and_b32 v61, 0xffff0000, v156
  v_lshlrev_b32_e64 v62, 16, v157
  global_load_dwordx4 a[200:203], v247, s[26:27]
  v_and_b32 v63, 0xffff0000, v157
  v_lshlrev_b32_e64 v64, 16, v158
  v_and_b32 v65, 0xffff0000, v158
  v_lshlrev_b32_e64 v66, 16, v159
  v_and_b32 v67, 0xffff0000, v159
  v_lshlrev_b32_e64 v68, 16, v160
  v_and_b32 v69, 0xffff0000, v160
  v_lshlrev_b32_e64 v70, 16, v161
  v_and_b32 v71, 0xffff0000, v161
  v_lshlrev_b32_e64 v72, 16, v162
  v_and_b32 v73, 0xffff0000, v162
  v_lshlrev_b32_e64 v74, 16, v163
  global_load_dwordx4 a[204:207], v247, s[28:29]
  v_and_b32 v75, 0xffff0000, v163
  v_lshlrev_b32_e64 v76, 16, v164
  v_and_b32 v77, 0xffff0000, v164
  v_lshlrev_b32_e64 v78, 16, v165
  v_and_b32 v79, 0xffff0000, v165
  v_pk_mul_f32 v[128:129], v[84:85], v[204:205]
  v_pk_mul_f32 v[130:131], v[86:87], v[206:207]
  v_pk_mul_f32 v[132:133], v[88:89], v[204:205]
  v_pk_mul_f32 v[134:135], v[90:91], v[206:207]
  v_pk_mul_f32 v[136:137], v[92:93], v[204:205]
  v_pk_mul_f32 v[138:139], v[94:95], v[206:207]
  v_pk_mul_f32 v[140:141], v[96:97], v[204:205]
  v_pk_mul_f32 v[142:143], v[98:99], v[206:207]
  v_pk_mul_f32 v[144:145], v[100:101], v[204:205]
  v_pk_mul_f32 v[146:147], v[102:103], v[206:207]
  v_pk_mul_f32 v[148:149], v[104:105], v[204:205]
  v_pk_mul_f32 v[150:151], v[106:107], v[206:207]
  v_pk_mul_f32 v[152:153], v[108:109], v[204:205]
  v_pk_mul_f32 v[154:155], v[110:111], v[206:207]
  v_pk_mul_f32 v[156:157], v[112:113], v[204:205]
  v_pk_mul_f32 v[158:159], v[114:115], v[206:207]
  v_pk_fma_f32 v[128:129], v[88:89], v[200:201], v[128:129]
  v_pk_fma_f32 v[130:131], v[90:91], v[202:203], v[130:131]
  v_pk_fma_f32 v[132:133], v[92:93], v[200:201], v[132:133]
  v_pk_fma_f32 v[134:135], v[94:95], v[202:203], v[134:135]
  v_pk_fma_f32 v[136:137], v[96:97], v[200:201], v[136:137]
  v_pk_fma_f32 v[138:139], v[98:99], v[202:203], v[138:139]
  v_pk_fma_f32 v[140:141], v[100:101], v[200:201], v[140:141]
  v_pk_fma_f32 v[142:143], v[102:103], v[202:203], v[142:143]
  v_pk_fma_f32 v[144:145], v[104:105], v[200:201], v[144:145]
  v_pk_fma_f32 v[146:147], v[106:107], v[202:203], v[146:147]
  v_pk_fma_f32 v[148:149], v[108:109], v[200:201], v[148:149]
  v_pk_fma_f32 v[150:151], v[110:111], v[202:203], v[150:151]
  v_pk_fma_f32 v[152:153], v[112:113], v[200:201], v[152:153]
  v_pk_fma_f32 v[154:155], v[114:115], v[202:203], v[154:155]
  v_pk_fma_f32 v[156:157], v[116:117], v[200:201], v[156:157]
  v_pk_fma_f32 v[158:159], v[118:119], v[202:203], v[158:159]
  v_pk_fma_f32 v[128:129], v[92:93], v[196:197], v[128:129]
  v_pk_fma_f32 v[130:131], v[94:95], v[198:199], v[130:131]
  v_pk_fma_f32 v[132:133], v[96:97], v[196:197], v[132:133]
  v_pk_fma_f32 v[134:135], v[98:99], v[198:199], v[134:135]
  v_pk_fma_f32 v[136:137], v[100:101], v[196:197], v[136:137]
  v_pk_fma_f32 v[138:139], v[102:103], v[198:199], v[138:139]
  v_pk_fma_f32 v[140:141], v[104:105], v[196:197], v[140:141]
  v_pk_fma_f32 v[142:143], v[106:107], v[198:199], v[142:143]
  v_pk_fma_f32 v[144:145], v[108:109], v[196:197], v[144:145]
  v_pk_fma_f32 v[146:147], v[110:111], v[198:199], v[146:147]
  v_pk_fma_f32 v[148:149], v[112:113], v[196:197], v[148:149]
  v_pk_fma_f32 v[150:151], v[114:115], v[198:199], v[150:151]
  v_pk_fma_f32 v[152:153], v[116:117], v[196:197], v[152:153]
  v_pk_fma_f32 v[154:155], v[118:119], v[198:199], v[154:155]
  v_pk_fma_f32 v[156:157], v[120:121], v[196:197], v[156:157]
  v_pk_fma_f32 v[158:159], v[122:123], v[198:199], v[158:159]
  v_pk_fma_f32 v[128:129], v[96:97], v[192:193], v[128:129]
  v_pk_fma_f32 v[130:131], v[98:99], v[194:195], v[130:131]
  v_pk_fma_f32 v[132:133], v[100:101], v[192:193], v[132:133]
  v_pk_fma_f32 v[134:135], v[102:103], v[194:195], v[134:135]
  v_pk_fma_f32 v[136:137], v[104:105], v[192:193], v[136:137]
  v_pk_fma_f32 v[138:139], v[106:107], v[194:195], v[138:139]
  v_pk_fma_f32 v[140:141], v[108:109], v[192:193], v[140:141]
  v_pk_fma_f32 v[142:143], v[110:111], v[194:195], v[142:143]
  v_pk_fma_f32 v[144:145], v[112:113], v[192:193], v[144:145]
  v_pk_fma_f32 v[146:147], v[114:115], v[194:195], v[146:147]
  v_pk_fma_f32 v[148:149], v[116:117], v[192:193], v[148:149]
  v_pk_fma_f32 v[150:151], v[118:119], v[194:195], v[150:151]
  v_pk_fma_f32 v[152:153], v[120:121], v[192:193], v[152:153]
  v_pk_fma_f32 v[154:155], v[122:123], v[194:195], v[154:155]
  v_pk_fma_f32 v[156:157], v[124:125], v[192:193], v[156:157]
  v_pk_fma_f32 v[158:159], v[126:127], v[194:195], v[158:159]
  v_pk_mul_f32 v[128:129], v[128:129], v[48:49]
  v_pk_mul_f32 v[130:131], v[130:131], v[50:51]
  v_pk_mul_f32 v[132:133], v[132:133], v[52:53]
  v_pk_mul_f32 v[134:135], v[134:135], v[54:55]
  v_pk_mul_f32 v[136:137], v[136:137], v[56:57]
  v_pk_mul_f32 v[138:139], v[138:139], v[58:59]
  v_pk_mul_f32 v[140:141], v[140:141], v[60:61]
  v_pk_mul_f32 v[142:143], v[142:143], v[62:63]
  v_pk_mul_f32 v[144:145], v[144:145], v[64:65]
  v_pk_mul_f32 v[146:147], v[146:147], v[66:67]
  v_pk_mul_f32 v[148:149], v[148:149], v[68:69]
  v_pk_mul_f32 v[150:151], v[150:151], v[70:71]
  v_pk_mul_f32 v[152:153], v[152:153], v[72:73]
  v_pk_mul_f32 v[154:155], v[154:155], v[74:75]
  v_pk_mul_f32 v[156:157], v[156:157], v[76:77]
  v_pk_mul_f32 v[158:159], v[158:159], v[78:79]
  v_cvt_pk_bf16_f32 v48, v156, v152
  v_cvt_pk_bf16_f32 v49, v148, v144
  v_cvt_pk_bf16_f32 v50, v140, v136
  v_cvt_pk_bf16_f32 v51, v132, v128
  v_cvt_pk_bf16_f32 v52, v157, v153
  v_cvt_pk_bf16_f32 v53, v149, v145
  v_cvt_pk_bf16_f32 v54, v141, v137
  v_cvt_pk_bf16_f32 v55, v133, v129
  v_cvt_pk_bf16_f32 v56, v158, v154
  v_cvt_pk_bf16_f32 v57, v150, v146
  v_cvt_pk_bf16_f32 v58, v142, v138
  v_cvt_pk_bf16_f32 v59, v134, v130
  v_cvt_pk_bf16_f32 v60, v159, v155
  v_cvt_pk_bf16_f32 v61, v151, v147
  v_cvt_pk_bf16_f32 v62, v143, v139
  v_cvt_pk_bf16_f32 v63, v135, v131
  v_lshrrev_b32 v11, 3, v1
  v_and_b32 v12, 7, v1
  v_sub_u32 v13, 7, v11
  v_lshlrev_b32 v13, 4, v13
  v_mul_u32_u24 v14, 144, v12
  v_add3_u32 v13, v13, v14, s34
  v_lshlrev_b32_e64 v12, 4, v12
  v_mul_u32_u24 v14, 144, v11
  v_add3_u32 v14, v14, v12, s34
  ds_write_b128 v13, v[48:51] offset:0
  ds_read_b128 v[192:195], v14 offset:0
  ds_write_b128 v13, v[52:55] offset:1152
  ds_read_b128 v[196:199], v14 offset:1152
  ds_write_b128 v13, v[56:59] offset:2304
  ds_read_b128 v[200:203], v14 offset:2304
  ds_write_b128 v13, v[60:63] offset:3456
  ds_read_b128 v[204:207], v14 offset:3456
  s_waitcnt vmcnt(2)
  s_branch join_11
w3_10:
  s_add_u32 m0, s19, 0
  s_add_u32 s15, s18, 0
  buffer_load_dwordx4 v186, s[80:83], s15 offen lds
  s_add_u32 m0, s19, 1024
  s_add_u32 s15, s18, 20480
  buffer_load_dwordx4 v186, s[80:83], s15 offen lds
  s_add_u32 m0, s19, 2048
  s_add_u32 s15, s18, 5120
  buffer_load_dwordx4 v186, s[80:83], s15 offen lds
  s_add_u32 m0, s19, 3072
  s_add_u32 s15, s18, 25600
  buffer_load_dwordx4 v186, s[80:83], s15 offen lds
  s_add_u32 m0, s19, 4096
  s_add_u32 s15, s18, 128
  buffer_load_dwordx4 v186, s[80:83], s15 offen lds
  s_add_u32 m0, s19, 5120
  s_add_u32 s15, s18, 20608
  buffer_load_dwordx4 v186, s[80:83], s15 offen lds
  s_add_u32 m0, s19, 6144
  s_add_u32 s15, s18, 5248
  buffer_load_dwordx4 v186, s[80:83], s15 offen lds
  s_add_u32 m0, s19, 7168
  s_add_u32 s15, s18, 25728
  buffer_load_dwordx4 v186, s[80:83], s15 offen lds
  s_add_u32 m0, s19, 8192
  s_add_u32 s15, s18, 256
  buffer_load_dwordx4 v186, s[80:83], s15 offen lds
  s_add_u32 m0, s19, 9216
  s_add_u32 s15, s18, 20736
  buffer_load_dwordx4 v186, s[80:83], s15 offen lds
  s_add_u32 m0, s19, 10240
  s_nop 0
  buffer_load_dwordx4 v174, s[80:83], 0 offen lds
  s_add_u32 m0, s19, 11264
  s_nop 0
  buffer_load_dwordx4 v175, s[80:83], 0 offen lds
  s_add_u32 m0, s19, 12288
  s_mov_b32 exec_hi, 0
  buffer_load_dwordx4 v176, s[80:83], 0 offen lds
  s_mov_b32 exec_hi, -1
  buffer_load_dword v81, v80, s[52:55], s96 offen sc1
  v_lshrrev_b32 v11, 3, v1
  v_min_u32 v11, 4, v11
  s_mul_i32 s12, s3, 5
  v_add_u32 v11, s12, v11
  v_and_b32 v12, 1, v11
  v_cmp_eq_u32 vcc, 1, v12
  v_lshlrev_b32 v185, 3, v11
  v_lshrrev_b32 v11, 1, v11
  s_mul_i32 s12, s4, 40
  v_add_u32 v11, s12, v11
  v_mul_u32_u24 v11, 1280, v11
  v_and_b32_e64 v12, 7, v1
  v_lshl_add_u32 v11, v12, 4, v11
  v_mov_b32 v12, s56
  v_mov_b32 v13, s57
  v_mov_b32 v14, s60
  v_mov_b32 v15, s61
  v_cndmask_b32 v12, v12, v14, vcc
  v_cndmask_b32 v13, v13, v15, vcc
  v_add_co_u32 v12, vcc, v12, v11
  s_nop 1
  v_addc_co_u32 v13, vcc, 0, v13, vcc
  global_load_dwordx4 v[88:91], v[12:13], off offset:0
  global_load_dwordx4 v[92:95], v[12:13], off offset:128
  global_load_dwordx4 v[96:99], v[12:13], off offset:256
  global_load_dwordx4 v[100:103], v[12:13], off offset:384
  global_load_dwordx4 v[104:107], v[12:13], off offset:512
  global_load_dwordx4 v[108:111], v[12:13], off offset:640
  global_load_dwordx4 v[112:115], v[12:13], off offset:768
  global_load_dwordx4 v[116:119], v[12:13], off offset:896
  global_load_dwordx4 v[120:123], v[12:13], off offset:1024
  global_load_dwordx4 v[124:127], v[12:13], off offset:1152
  s_add_u32 s14, s31, 256
  s_mov_b32 m0, 20480
  s_nop 0
  buffer_load_dwordx4 v45, s[56:59], s14 offen lds
  s_mov_b32 m0, 21504
  s_nop 0
  buffer_load_dwordx4 v46, s[60:63], s14 offen lds
  s_add_u32 s14, s31, 10496
  s_mov_b32 m0, 22528
  s_nop 0
  buffer_load_dwordx4 v45, s[56:59], s14 offen lds
  s_mov_b32 m0, 23552
  s_nop 0
  buffer_load_dwordx4 v46, s[60:63], s14 offen lds
  s_add_u32 s14, s31, 20736
  s_mov_b32 m0, 24576
  s_nop 0
  buffer_load_dwordx4 v45, s[56:59], s14 offen lds
  s_mov_b32 m0, 25600
  s_nop 0
  buffer_load_dwordx4 v46, s[60:63], s14 offen lds
  s_add_u32 s14, s31, 30976
  s_mov_b32 m0, 26624
  s_nop 0
  buffer_load_dwordx4 v45, s[56:59], s14 offen lds
  s_mov_b32 m0, 27648
  s_nop 0
  buffer_load_dwordx4 v46, s[60:63], s14 offen lds
  s_add_u32 s14, s31, 41216
  s_mov_b32 m0, 28672
  s_nop 0
  buffer_load_dwordx4 v45, s[56:59], s14 offen lds
  s_mov_b32 m0, 29696
  s_nop 0
  buffer_load_dwordx4 v46, s[60:63], s14 offen lds
  s_add_u32 s14, s31, 384
  s_mov_b32 m0, 30720
  s_nop 0
  buffer_load_dwordx4 v45, s[56:59], s14 offen lds
  s_mov_b32 m0, 31744
  s_nop 0
  buffer_load_dwordx4 v46, s[60:63], s14 offen lds
  s_add_u32 s14, s31, 10624
  s_mov_b32 m0, 32768
  s_nop 0
  buffer_load_dwordx4 v45, s[56:59], s14 offen lds
  s_mov_b32 m0, 33792
  s_nop 0
  buffer_load_dwordx4 v46, s[60:63], s14 offen lds
  s_add_u32 s14, s31, 20864
  s_mov_b32 m0, 34816
  s_nop 0
  buffer_load_dwordx4 v45, s[56:59], s14 offen lds
  s_mov_b32 m0, 35840
  s_nop 0
  buffer_load_dwordx4 v46, s[60:63], s14 offen lds
  s_add_u32 s14, s31, 31104
  s_mov_b32 m0, 36864
  s_nop 0
  buffer_load_dwordx4 v45, s[56:59], s14 offen lds
  s_mov_b32 m0, 37888
  s_nop 0
  buffer_load_dwordx4 v46, s[60:63], s14 offen lds
  s_add_u32 s14, s31, 41344
  s_mov_b32 m0, 38912
  s_nop 0
  buffer_load_dwordx4 v45, s[56:59], s14 offen lds
  s_mov_b32 m0, 39936
  s_nop 0
  buffer_load_dwordx4 v46, s[60:63], s14 offen lds
  global_load_dwordx4 a[200:203], v247, s[26:27]
  global_load_dwordx4 a[204:207], v247, s[28:29]
  s_waitcnt vmcnt(46)
  s_lshl_b32 s12, s3, 4
  s_add_u32 s12, s12, s4
  s_lshl_b32 s12, s12, 7
  s_add_u32 s12, s12, 262144
  v_lshlrev_b32 v179, 1, v1
  v_dot2_f32_bf16 v180, v128, s2, 0
  v_dot2_f32_bf16 v182, v128, v128, 0
  v_dot2_f32_bf16 v180, v129, s2, v180
  v_dot2_f32_bf16 v182, v129, v129, v182
  v_dot2_f32_bf16 v180, v130, s2, v180
  v_dot2_f32_bf16 v182, v130, v130, v182
  v_dot2_f32_bf16 v180, v131, s2, v180
  v_dot2_f32_bf16 v182, v131, v131, v182
  v_dot2_f32_bf16 v180, v132, s2, v180
  v_dot2_f32_bf16 v182, v132, v132, v182
  v_dot2_f32_bf16 v180, v133, s2, v180
  v_dot2_f32_bf16 v182, v133, v133, v182
  v_dot2_f32_bf16 v180, v134, s2, v180
  v_dot2_f32_bf16 v182, v134, v134, v182
  v_dot2_f32_bf16 v180, v135, s2, v180
  v_dot2_f32_bf16 v182, v135, v135, v182
  v_dot2_f32_bf16 v180, v136, s2, v180
  v_dot2_f32_bf16 v182, v136, v136, v182
  v_dot2_f32_bf16 v180, v137, s2, v180
  v_dot2_f32_bf16 v182, v137, v137, v182
  v_dot2_f32_bf16 v180, v138, s2, v180
  v_dot2_f32_bf16 v182, v138, v138, v182
  v_dot2_f32_bf16 v180, v139, s2, v180
  v_dot2_f32_bf16 v182, v139, v139, v182
  v_dot2_f32_bf16 v180, v140, s2, v180
  v_dot2_f32_bf16 v182, v140, v140, v182
  v_dot2_f32_bf16 v180, v141, s2, v180
  v_dot2_f32_bf16 v182, v141, v141, v182
  v_dot2_f32_bf16 v180, v142, s2, v180
  v_dot2_f32_bf16 v182, v142, v142, v182
  v_dot2_f32_bf16 v180, v143, s2, v180
  v_dot2_f32_bf16 v182, v143, v143, v182
  v_dot2_f32_bf16 v180, v144, s2, v180
  v_dot2_f32_bf16 v182, v144, v144, v182
  v_dot2_f32_bf16 v180, v145, s2, v180
  v_dot2_f32_bf16 v182, v145, v145, v182
  v_dot2_f32_bf16 v180, v146, s2, v180
  v_dot2_f32_bf16 v182, v146, v146, v182
  v_dot2_f32_bf16 v180, v147, s2, v180
  v_dot2_f32_bf16 v182, v147, v147, v182
  v_dot2_f32_bf16 v180, v148, s2, v180
  v_dot2_f32_bf16 v182, v148, v148, v182
  v_dot2_f32_bf16 v180, v149, s2, v180
  v_dot2_f32_bf16 v182, v149, v149, v182
  v_dot2_f32_bf16 v180, v150, s2, v180
  v_dot2_f32_bf16 v182, v150, v150, v182
  v_dot2_f32_bf16 v180, v151, s2, v180
  v_dot2_f32_bf16 v182, v151, v151, v182
  v_dot2_f32_bf16 v180, v152, s2, v180
  v_dot2_f32_bf16 v182, v152, v152, v182
  v_dot2_f32_bf16 v180, v153, s2, v180
  v_dot2_f32_bf16 v182, v153, v153, v182
  v_dot2_f32_bf16 v180, v154, s2, v180
  v_dot2_f32_bf16 v182, v154, v154, v182
  v_dot2_f32_bf16 v180, v155, s2, v180
  v_dot2_f32_bf16 v182, v155, v155, v182
  v_dot2_f32_bf16 v180, v156, s2, v180
  v_dot2_f32_bf16 v182, v156, v156, v182
  v_dot2_f32_bf16 v180, v157, s2, v180
  v_dot2_f32_bf16 v182, v157, v157, v182
  v_dot2_f32_bf16 v180, v158, s2, v180
  v_dot2_f32_bf16 v182, v158, v158, v182
  v_dot2_f32_bf16 v180, v159, s2, v180
  v_dot2_f32_bf16 v182, v159, v159, v182
  v_dot2_f32_bf16 v180, v160, s2, v180
  v_dot2_f32_bf16 v182, v160, v160, v182
  v_dot2_f32_bf16 v180, v161, s2, v180
  v_dot2_f32_bf16 v182, v161, v161, v182
  v_dot2_f32_bf16 v180, v162, s2, v180
  v_dot2_f32_bf16 v182, v162, v162, v182
  v_dot2_f32_bf16 v180, v163, s2, v180
  v_dot2_f32_bf16 v182, v163, v163, v182
  v_dot2_f32_bf16 v180, v164, s2, v180
  v_dot2_f32_bf16 v182, v164, v164, v182
  v_dot2_f32_bf16 v180, v165, s2, v180
  v_dot2_f32_bf16 v182, v165, v165, v182
  v_dot2_f32_bf16 v180, v166, s2, v180
  v_dot2_f32_bf16 v182, v166, v166, v182
  v_dot2_f32_bf16 v180, v167, s2, v180
  v_dot2_f32_bf16 v182, v167, v167, v182
  s_nop 1
  v_add_f32_dpp v180, v180, v180 quad_perm:[1,0,3,2] row_mask:0xf bank_mask:0xf
  v_add_f32_dpp v182, v182, v182 quad_perm:[1,0,3,2] row_mask:0xf bank_mask:0xf
  s_nop 0
  v_add_f32_dpp v180, v180, v180 quad_perm:[2,3,0,1] row_mask:0xf bank_mask:0xf
  v_add_f32_dpp v182, v182, v182 quad_perm:[2,3,0,1] row_mask:0xf bank_mask:0xf
  s_nop 0
  v_add_f32_dpp v180, v180, v180 row_half_mirror row_mask:0xf bank_mask:0xf
  v_add_f32_dpp v182, v182, v182 row_half_mirror row_mask:0xf bank_mask:0xf
  v_mul_f32 v180, 0x3acccccd, v180
  v_mul_f32 v182, 0x3acccccd, v182
  v_fma_f32 v182, -v180, v180, v182
  v_max_f32 v182, 0, v182
  v_cvt_pk_bf16_f32 v180, v180, v180
  v_and_b32 v180, 0xffff0000, v180
  v_cvt_pk_bf16_f32 v182, v182, v182
  v_and_b32 v182, 0xffff0000, v182
  v_add_f32 v182, 0x3727c5ac, v182
  v_cvt_pk_bf16_f32 v182, v182, v182
  v_and_b32 v182, 0xffff0000, v182
  v_sqrt_f32 v182, v182
  s_nop 0
  v_cvt_pk_bf16_f32 v182, v182, v182
  v_and_b32 v182, 0xffff0000, v182
  v_rcp_f32 v181, v182
  v_mov_b32 v182, s8
  v_mov_b32_e64 v183, s8
  s_mov_b32 exec_lo, 0x01010101
  s_mov_b32 exec_hi, 0x01010101
  buffer_store_dwordx4 v[180:183], v179, s[52:55], s12 offen sc1
  s_mov_b64 exec, -1
  s_add_u32 s14, s31, 512
  s_mov_b32 m0, 40960
  s_nop 0
  buffer_load_dwordx4 v45, s[56:59], s14 offen lds
  s_mov_b32 m0, 41984
  s_nop 0
  buffer_load_dwordx4 v46, s[60:63], s14 offen lds
  s_add_u32 s14, s31, 10752
  s_mov_b32 m0, 43008
  s_nop 0
  buffer_load_dwordx4 v45, s[56:59], s14 offen lds
  s_mov_b32 m0, 44032
  s_nop 0
  buffer_load_dwordx4 v46, s[60:63], s14 offen lds
  s_add_u32 s14, s31, 20992
  s_mov_b32 m0, 45056
  s_nop 0
  buffer_load_dwordx4 v45, s[56:59], s14 offen lds
  s_mov_b32 m0, 46080
  s_nop 0
  buffer_load_dwordx4 v46, s[60:63], s14 offen lds
  s_add_u32 s14, s31, 31232
  s_mov_b32 m0, 47104
  s_nop 0
  buffer_load_dwordx4 v45, s[56:59], s14 offen lds
  s_mov_b32 m0, 48128
  s_nop 0
  buffer_load_dwordx4 v46, s[60:63], s14 offen lds
  s_add_u32 s14, s31, 41472
  s_mov_b32 m0, 49152
  s_nop 0
  buffer_load_dwordx4 v45, s[56:59], s14 offen lds
  s_mov_b32 m0, 50176
  s_nop 0
  buffer_load_dwordx4 v46, s[60:63], s14 offen lds
  s_add_u32 s14, s31, 640
  s_mov_b32 m0, 51200
  s_nop 0
  buffer_load_dwordx4 v45, s[56:59], s14 offen lds
  s_mov_b32 m0, 52224
  s_nop 0
  buffer_load_dwordx4 v46, s[60:63], s14 offen lds
  s_add_u32 s14, s31, 10880
  s_mov_b32 m0, 53248
  s_nop 0
  buffer_load_dwordx4 v45, s[56:59], s14 offen lds
  s_mov_b32 m0, 54272
  s_nop 0
  buffer_load_dwordx4 v46, s[60:63], s14 offen lds
  s_add_u32 s14, s31, 21120
  s_mov_b32 m0, 55296
  s_nop 0
  buffer_load_dwordx4 v45, s[56:59], s14 offen lds
  s_mov_b32 m0, 56320
  s_nop 0
  buffer_load_dwordx4 v46, s[60:63], s14 offen lds
  s_add_u32 s14, s31, 31360
  s_mov_b32 m0, 57344
  s_nop 0
  buffer_load_dwordx4 v45, s[56:59], s14 offen lds
  s_mov_b32 m0, 58368
  s_nop 0
  buffer_load_dwordx4 v46, s[60:63], s14 offen lds
  s_add_u32 s14, s31, 41600
  s_mov_b32 m0, 59392
  s_nop 0
  buffer_load_dwordx4 v45, s[56:59], s14 offen lds
  s_mov_b32 m0, 60416
  s_nop 0
  buffer_load_dwordx4 v46, s[60:63], s14 offen lds
  s_mul_i32 s12, s4, 640
  s_add_u32 s12, s12, 303104
  s_waitcnt vmcnt(43)
  v_dot2_f32_bf16 v12, v88, s2, 0
  v_dot2_f32_bf16 v12, v89, s2, v12
  v_dot2_f32_bf16 v12, v90, s2, v12
  v_dot2_f32_bf16 v12, v91, s2, v12
  v_dot2_f32_bf16 v12, v92, s2, v12
  v_dot2_f32_bf16 v12, v93, s2, v12
  v_dot2_f32_bf16 v12, v94, s2, v12
  v_dot2_f32_bf16 v12, v95, s2, v12
  v_dot2_f32_bf16 v12, v96, s2, v12
  v_dot2_f32_bf16 v12, v97, s2, v12
  v_dot2_f32_bf16 v12, v98, s2, v12
  v_dot2_f32_bf16 v12, v99, s2, v12
  v_dot2_f32_bf16 v12, v100, s2, v12
  v_dot2_f32_bf16 v12, v101, s2, v12
  v_dot2_f32_bf16 v12, v102, s2, v12
  v_dot2_f32_bf16 v12, v103, s2, v12
  v_dot2_f32_bf16 v12, v104, s2, v12
  v_dot2_f32_bf16 v12, v105, s2, v12
  v_dot2_f32_bf16 v12, v106, s2, v12
  v_dot2_f32_bf16 v12, v107, s2, v12
  v_dot2_f32_bf16 v12, v108, s2, v12
  v_dot2_f32_bf16 v12, v109, s2, v12
  v_dot2_f32_bf16 v12, v110, s2, v12
  v_dot2_f32_bf16 v12, v111, s2, v12
  v_dot2_f32_bf16 v12, v112, s2, v12
  v_dot2_f32_bf16 v12, v113, s2, v12
  v_dot2_f32_bf16 v12, v114, s2, v12
  v_dot2_f32_bf16 v12, v115, s2, v12
  v_dot2_f32_bf16 v12, v116, s2, v12
  v_dot2_f32_bf16 v12, v117, s2, v12
  v_dot2_f32_bf16 v12, v118, s2, v12
  v_dot2_f32_bf16 v12, v119, s2, v12
  v_dot2_f32_bf16 v12, v120, s2, v12
  v_dot2_f32_bf16 v12, v121, s2, v12
  v_dot2_f32_bf16 v12, v122, s2, v12
  v_dot2_f32_bf16 v12, v123, s2, v12
  v_dot2_f32_bf16 v12, v124, s2, v12
  v_dot2_f32_bf16 v12, v125, s2, v12
  v_dot2_f32_bf16 v12, v126, s2, v12
  v_dot2_f32_bf16 v12, v127, s2, v12
  s_nop 2
  v_add_f32_dpp v12, v12, v12 quad_perm:[1,0,3,2] row_mask:0xf bank_mask:0xf
  s_nop 1
  v_add_f32_dpp v12, v12, v12 quad_perm:[2,3,0,1] row_mask:0xf bank_mask:0xf
  s_nop 1
  v_add_f32_dpp v12, v12, v12 row_half_mirror row_mask:0xf bank_mask:0xf
  v_mov_b32 v13, s8
  s_mov_b32 exec_lo, 0x01010101
  s_mov_b32 exec_hi, 1
  buffer_store_dwordx2 v[12:13], v185, s[52:55], s12 offen sc1
  s_mov_b64 exec, -1
join_11:
  ds_read_b64 a[220:221], v187 offset:10240
  ds_read_b64 a[222:223], v187 offset:10272
  ds_read_b64 a[224:225], v187 offset:10304
  ds_read_b64 a[226:227], v187 offset:10336
  ds_read_b64 a[228:229], v187 offset:10368
  v_xor_b32 v15, s8, v81
  v_cmp_lt_u32 vcc, 15, v15
  s_cbranch_vccnz again_12
ok_13:
  s_or_b32 s13, s8, s11
  v_cmp_ne_u32 vcc, s13, v81
  s_cmp_eq_u64 vcc, 0
  s_cselect_b32 s9, 1, 0
  s_waitcnt lgkmcnt(0)
  s_cmp_eq_u32 s9, 0
  s_cbranch_scc1 slow_14
  buffer_store_dwordx4 v[192:195], v211, s[52:55], s36 offen
  s_add_u32 s36, s36, 4096
  buffer_store_dwordx4 v[196:199], v211, s[52:55], s36 offen
  s_add_u32 s36, s36, 4096
  buffer_store_dwordx4 v[200:203], v211, s[52:55], s36 offen
  s_add_u32 s36, s36, 4096
  buffer_store_dwordx4 v[204:207], v211, s[52:55], s36 offen
back_15:
  s_barrier
  ds_read_b128 v[128:131], v184 offset:0
  ds_read_b128 v[132:135], v184 offset:2048
  ds_read_b128 v[88:91], v5 offset:0
  ds_read_b128 v[92:95], v5 offset:2048
  ds_read_b128 v[96:99], v5 offset:4096
  ds_read_b128 v[100:103], v5 offset:6144
  ds_read_b128 v[104:107], v5 offset:8192
  s_waitcnt lgkmcnt(4)
  v_mfma_f32_16x16x32_bf16 v[48:51], v[128:131], v[88:91], 0
  ds_read_b128 v[136:139], v189 offset:0
  ds_read_b128 v[140:143], v189 offset:2048
  ds_read_b128 v[108:111], v6 offset:0
  v_mfma_f32_16x16x32_bf16 v[52:55], v[132:135], v[88:91], 0
  s_add_u32 m0, s19, 10240
  s_add_u32 s15, s18, 5376
  buffer_load_dwordx4 v186, s[80:83], s15 offen lds
  s_add_u32 m0, s19, 11264
  s_add_u32 s15, s18, 25856
  buffer_load_dwordx4 v186, s[80:83], s15 offen lds
  s_waitcnt lgkmcnt(6)
  v_mfma_f32_16x16x32_bf16 v[56:59], v[128:131], v[92:95], 0
  ds_read_b128 v[112:115], v6 offset:2048
  v_mfma_f32_16x16x32_bf16 v[60:63], v[132:135], v[92:95], 0
  s_add_u32 m0, s19, 12288
  s_add_u32 s15, s18, 384
  buffer_load_dwordx4 v186, s[80:83], s15 offen lds
  s_add_u32 m0, s19, 13312
  s_add_u32 s15, s18, 20864
  buffer_load_dwordx4 v186, s[80:83], s15 offen lds
  s_waitcnt lgkmcnt(6)
  v_mfma_f32_16x16x32_bf16 v[64:67], v[128:131], v[96:99], 0
  ds_read_b128 v[116:119], v6 offset:4096
  v_mfma_f32_16x16x32_bf16 v[68:71], v[132:135], v[96:99], 0
  v_lshrrev_b32 v11, 1, v3
  v_lshlrev_b32 v11, 5, v11
  s_waitcnt lgkmcnt(6)
  v_mfma_f32_16x16x32_bf16 v[72:75], v[128:131], v[100:103], 0
  ds_read_b128 v[120:123], v6 offset:6144
  v_mfma_f32_16x16x32_bf16 v[76:79], v[132:135], v[100:103], 0
  v_min_u32 v12, 39, v1
  v_lshlrev_b32 v12, 5, v12
  s_waitcnt lgkmcnt(6)
  v_mfma_f32_16x16x32_bf16 v[80:83], v[128:131], v[104:107], 0
  ds_read_b128 v[124:127], v6 offset:8192
  v_mfma_f32_16x16x32_bf16 v[84:87], v[132:135], v[104:107], 0
  v_add_u32 v11, 160000, v11
  v_add_u32 v12, 160000, v12
  s_waitcnt lgkmcnt(4)
  v_mfma_f32_16x16x32_bf16 v[48:51], v[136:139], v[108:111], v[48:51]
  ds_read_b128 v[128:131], v184 offset:4096
  ds_read_b128 v[132:135], v184 offset:6144
  ds_read_b128 v[88:91], v5 offset:10240
  v_mfma_f32_16x16x32_bf16 v[52:55], v[140:143], v[108:111], v[52:55]
  s_add_u32 m0, s19, 0
  s_add_u32 s15, s18, 5504
  buffer_load_dwordx4 v186, s[80:83], s15 offen lds
  s_add_u32 m0, s19, 1024
  s_add_u32 s15, s18, 25984
  buffer_load_dwordx4 v186, s[80:83], s15 offen lds
  s_waitcnt lgkmcnt(6)
  v_mfma_f32_16x16x32_bf16 v[56:59], v[136:139], v[112:115], v[56:59]
  ds_read_b128 v[92:95], v5 offset:12288
  v_mfma_f32_16x16x32_bf16 v[60:63], v[140:143], v[112:115], v[60:63]
  ds_read_b128 v[144:147], v11 offset:0
  ds_read_b128 v[148:151], v11 offset:256
  s_waitcnt lgkmcnt(8)
  v_mfma_f32_16x16x32_bf16 v[64:67], v[136:139], v[116:119], v[64:67]
  ds_read_b128 v[96:99], v5 offset:14336
  v_mfma_f32_16x16x32_bf16 v[68:71], v[140:143], v[116:119], v[68:71]
  ds_read_b128 v[152:155], v11 offset:512
  ds_read_b128 v[156:159], v11 offset:768
  s_waitcnt lgkmcnt(10)
  v_mfma_f32_16x16x32_bf16 v[72:75], v[136:139], v[120:123], v[72:75]
  ds_read_b128 v[100:103], v5 offset:16384
  v_mfma_f32_16x16x32_bf16 v[76:79], v[140:143], v[120:123], v[76:79]
  ds_read_b128 v[160:163], v11 offset:1024
  ds_read_b64 v[40:41], v12 offset:8
  s_waitcnt lgkmcnt(12)
  v_mfma_f32_16x16x32_bf16 v[80:83], v[136:139], v[124:127], v[80:83]
  ds_read_b128 v[104:107], v5 offset:18432
  v_mfma_f32_16x16x32_bf16 v[84:87], v[140:143], v[124:127], v[84:87]
  ds_read_b128 v[36:39], v12 offset:16
  s_waitcnt lgkmcnt(11)
  v_mfma_f32_16x16x32_bf16 v[48:51], v[128:131], v[88:91], v[48:51]
  ds_read_b128 v[136:139], v189 offset:4096
  ds_read_b128 v[140:143], v189 offset:6144
  ds_read_b128 v[108:111], v6 offset:10240
  v_mfma_f32_16x16x32_bf16 v[52:55], v[132:135], v[88:91], v[52:55]
  s_add_u32 m0, s19, 2048
  s_add_u32 s15, s18, 512
  buffer_load_dwordx4 v186, s[80:83], s15 offen lds
  s_waitcnt lgkmcnt(13)
  v_mfma_f32_16x16x32_bf16 v[56:59], v[128:131], v[92:95], v[56:59]
  ds_read_b128 v[112:115], v6 offset:12288
  v_mfma_f32_16x16x32_bf16 v[60:63], v[132:135], v[92:95], v[60:63]
  s_add_u32 m0, s19, 3072
  s_add_u32 s15, s18, 20992
  buffer_load_dwordx4 v186, s[80:83], s15 offen lds
  s_waitcnt lgkmcnt(11)
  v_mfma_f32_16x16x32_bf16 v[64:67], v[128:131], v[96:99], v[64:67]
  ds_read_b128 v[116:119], v6 offset:14336
  v_mfma_f32_16x16x32_bf16 v[68:71], v[132:135], v[96:99], v[68:71]
  s_waitcnt lgkmcnt(9)
  v_mfma_f32_16x16x32_bf16 v[72:75], v[128:131], v[100:103], v[72:75]
  ds_read_b128 v[120:123], v6 offset:16384
  v_mfma_f32_16x16x32_bf16 v[76:79], v[132:135], v[100:103], v[76:79]
  s_waitcnt lgkmcnt(7)
  v_mfma_f32_16x16x32_bf16 v[80:83], v[128:131], v[104:107], v[80:83]
  ds_read_b128 v[124:127], v6 offset:18432
  v_mfma_f32_16x16x32_bf16 v[84:87], v[132:135], v[104:107], v[84:87]
  s_waitcnt vmcnt(6)
  s_barrier
  s_add_u32 s12, s16, 28672
  v_mov_b32 v15, s8
  s_mov_b64 exec, 1
  s_cmp_eq_u32 s9, 0
  s_cbranch_scc1 slow_16
  buffer_store_dword v15, off, s[52:55], s12
back_17:
  s_mov_b64 exec, -1
  s_waitcnt lgkmcnt(4)
  v_mfma_f32_16x16x32_bf16 v[48:51], v[136:139], v[108:111], v[48:51]
  ds_read_b128 v[128:131], v184 offset:8192
  ds_read_b128 v[132:135], v184 offset:10240
  ds_read_b128 v[88:91], v5 offset:20480
  v_mfma_f32_16x16x32_bf16 v[52:55], v[140:143], v[108:111], v[52:55]
  s_add_u32 m0, s19, 4096
  s_add_u32 s15, s18, 5632
  buffer_load_dwordx4 v186, s[80:83], s15 offen lds
  s_add_u32 m0, s19, 5120
  s_add_u32 s15, s18, 26112
  buffer_load_dwordx4 v186, s[80:83], s15 offen lds
  s_waitcnt lgkmcnt(6)
  v_mfma_f32_16x16x32_bf16 v[56:59], v[136:139], v[112:115], v[56:59]
  ds_read_b128 v[92:95], v5 offset:22528
  v_mfma_f32_16x16x32_bf16 v[60:63], v[140:143], v[112:115], v[60:63]
  s_waitcnt lgkmcnt(11)
  v_and_b32 v13, 1, v3
  s_waitcnt lgkmcnt(6)
  v_mfma_f32_16x16x32_bf16 v[64:67], v[136:139], v[116:119], v[64:67]
  ds_read_b128 v[96:99], v5 offset:24576
  v_mfma_f32_16x16x32_bf16 v[68:71], v[140:143], v[116:119], v[68:71]
  v_lshlrev_b32 v13, 31, v13
  v_mov_b32 v16, v144
  s_waitcnt lgkmcnt(6)
  v_mfma_f32_16x16x32_bf16 v[72:75], v[136:139], v[120:123], v[72:75]
  ds_read_b128 v[100:103], v5 offset:26624
  v_mfma_f32_16x16x32_bf16 v[76:79], v[140:143], v[120:123], v[76:79]
  v_xor_b32 v21, v13, v145
  s_waitcnt lgkmcnt(6)
  v_mfma_f32_16x16x32_bf16 v[80:83], v[136:139], v[124:127], v[80:83]
  ds_read_b128 v[104:107], v5 offset:28672
  v_mfma_f32_16x16x32_bf16 v[84:87], v[140:143], v[124:127], v[84:87]
  v_xor_b32 v26, v13, v146
  s_waitcnt lgkmcnt(4)
  v_mfma_f32_16x16x32_bf16 v[48:51], v[128:131], v[88:91], v[48:51]
  ds_read_b128 v[136:139], v189 offset:8192
  ds_read_b128 v[140:143], v189 offset:10240
  ds_read_b128 v[108:111], v6 offset:20480
  v_mfma_f32_16x16x32_bf16 v[52:55], v[132:135], v[88:91], v[52:55]
  s_add_u32 m0, s19, 6144
  s_add_u32 s15, s18, 640
  buffer_load_dwordx4 v186, s[80:83], s15 offen lds
  s_add_u32 m0, s19, 7168
  s_add_u32 s15, s18, 21120
  buffer_load_dwordx4 v186, s[80:83], s15 offen lds
  s_add_u32 m0, s40, 61440
  s_add_u32 s14, s41, 768
  buffer_load_dwordx4 v47, s[64:67], s14 offen lds
  s_waitcnt lgkmcnt(6)
  v_mfma_f32_16x16x32_bf16 v[56:59], v[128:131], v[92:95], v[56:59]
  ds_read_b128 v[112:115], v6 offset:22528
  v_mfma_f32_16x16x32_bf16 v[60:63], v[132:135], v[92:95], v[60:63]
  s_add_u32 m0, s40, 63488
  s_add_u32 s14, s41, 11008
  buffer_load_dwordx4 v47, s[64:67], s14 offen lds
  s_add_u32 m0, s40, 65536
  s_add_u32 s14, s41, 21248
  buffer_load_dwordx4 v47, s[64:67], s14 offen lds
  buffer_store_dwordx4 a[200:203], v2, s[52:55], s38 offen sc1
  s_waitcnt lgkmcnt(6)
  v_mfma_f32_16x16x32_bf16 v[64:67], v[128:131], v[96:99], v[64:67]
  ds_read_b128 v[116:119], v6 offset:24576
  v_mfma_f32_16x16x32_bf16 v[68:71], v[132:135], v[96:99], v[68:71]
  s_add_u32 s38, s38, 5120
  buffer_store_dwordx4 a[204:207], v2, s[52:55], s38 offen sc1
  buffer_store_dwordx4 v[248:251], v222, s[52:55], s37 offen sc1
  s_add_u32 s37, s37, 380928
  buffer_store_dwordx4 v[248:251], v222, s[52:55], s37 offen sc1
  s_waitcnt lgkmcnt(6)
  v_mfma_f32_16x16x32_bf16 v[72:75], v[128:131], v[100:103], v[72:75]
  ds_read_b128 v[120:123], v6 offset:26624
  v_mfma_f32_16x16x32_bf16 v[76:79], v[132:135], v[100:103], v[76:79]
  v_xor_b32 v31, 0x80000000, v147
  v_mov_b32 v17, v148
  v_xor_b32 v22, v13, v149
  s_waitcnt lgkmcnt(6)
  v_mfma_f32_16x16x32_bf16 v[80:83], v[128:131], v[104:107], v[80:83]
  ds_read_b128 v[124:127], v6 offset:28672
  v_mfma_f32_16x16x32_bf16 v[84:87], v[132:135], v[104:107], v[84:87]
  v_xor_b32_e64 v27, v13, v150
  v_xor_b32 v32, 0x80000000, v151
  v_mov_b32 v18, v152
  s_waitcnt vmcnt(14)
  s_waitcnt lgkmcnt(4)
  v_mfma_f32_16x16x32_bf16 v[48:51], v[136:139], v[108:111], v[48:51]
  ds_read_b128 v[128:131], v184 offset:12288
  ds_read_b128 v[132:135], v184 offset:0
  ds_read_b128 v[88:91], v5 offset:30720
  v_mfma_f32_16x16x32_bf16 v[52:55], v[140:143], v[108:111], v[52:55]
  s_add_u32 m0, s19, 8192
  s_add_u32 s15, s18, 5760
  buffer_load_dwordx4 v186, s[80:83], s15 offen lds
  s_add_u32 m0, s19, 9216
  s_add_u32 s15, s18, 26240
  buffer_load_dwordx4 v186, s[80:83], s15 offen lds
  s_waitcnt lgkmcnt(6)
  v_mfma_f32_16x16x32_bf16 v[56:59], v[136:139], v[112:115], v[56:59]
  ds_read_b128 v[92:95], v5 offset:32768
  v_mfma_f32_16x16x32_bf16 v[60:63], v[140:143], v[112:115], v[60:63]
  s_add_u32 m0, s40, 67584
  s_add_u32 s14, s41, 31488
  buffer_load_dwordx4 v47, s[64:67], s14 offen lds
  s_add_u32 m0, s40, 69632
  s_add_u32 s14, s41, 41728
  buffer_load_dwordx4 v47, s[64:67], s14 offen lds
  s_waitcnt lgkmcnt(6)
  v_mfma_f32_16x16x32_bf16 v[64:67], v[136:139], v[116:119], v[64:67]
  ds_read_b128 v[96:99], v5 offset:34816
  v_mfma_f32_16x16x32_bf16 v[68:71], v[140:143], v[116:119], v[68:71]
  v_xor_b32 v23, v13, v153
  v_xor_b32 v28, v13, v154
  s_waitcnt lgkmcnt(6)
  v_mfma_f32_16x16x32_bf16 v[72:75], v[136:139], v[120:123], v[72:75]
  ds_read_b128 v[100:103], v5 offset:36864
  v_mfma_f32_16x16x32_bf16 v[76:79], v[140:143], v[120:123], v[76:79]
  v_xor_b32 v33, 0x80000000, v155
  v_mov_b32 v19, v156
  s_waitcnt lgkmcnt(6)
  v_mfma_f32_16x16x32_bf16 v[80:83], v[136:139], v[124:127], v[80:83]
  ds_read_b128 v[104:107], v5 offset:38912
  v_mfma_f32_16x16x32_bf16 v[84:87], v[140:143], v[124:127], v[84:87]
  v_xor_b32 v24, v13, v157
  v_xor_b32 v29, v13, v158
  s_waitcnt lgkmcnt(4)
  v_mfma_f32_16x16x32_bf16 v[48:51], v[128:131], v[88:91], v[48:51]
  ds_read_b128 v[136:139], v189 offset:12288
  ds_read_b128 v[140:143], v189 offset:0
  ds_read_b128 v[108:111], v6 offset:30720
  v_mfma_f32_16x16x32_bf16 v[52:55], v[132:135], v[88:91], v[52:55]
  s_add_u32 m0, s19, 10240
  s_add_u32 s15, s18, 768
  buffer_load_dwordx4 v186, s[80:83], s15 offen lds
  s_add_u32 m0, s19, 11264
  s_add_u32 s15, s18, 21248
  buffer_load_dwordx4 v186, s[80:83], s15 offen lds
  s_waitcnt lgkmcnt(6)
  v_mfma_f32_16x16x32_bf16 v[56:59], v[128:131], v[92:95], v[56:59]
  ds_read_b128 v[112:115], v6 offset:32768
  v_mfma_f32_16x16x32_bf16 v[60:63], v[132:135], v[92:95], v[60:63]
  v_xor_b32 v34, 0x80000000, v159
  v_mov_b32 v20, v160
  s_waitcnt lgkmcnt(6)
  v_mfma_f32_16x16x32_bf16 v[64:67], v[128:131], v[96:99], v[64:67]
  ds_read_b128 v[116:119], v6 offset:34816
  v_mfma_f32_16x16x32_bf16 v[68:71], v[132:135], v[96:99], v[68:71]
  v_xor_b32 v25, v13, v161
  s_waitcnt lgkmcnt(6)
  v_mfma_f32_16x16x32_bf16 v[72:75], v[128:131], v[100:103], v[72:75]
  ds_read_b128 v[120:123], v6 offset:36864
  v_mfma_f32_16x16x32_bf16 v[76:79], v[132:135], v[100:103], v[76:79]
  v_xor_b32 v30, v13, v162
  s_waitcnt lgkmcnt(6)
  v_mfma_f32_16x16x32_bf16 v[80:83], v[128:131], v[104:107], v[80:83]
  ds_read_b128 v[124:127], v6 offset:38912
  v_mfma_f32_16x16x32_bf16 v[84:87], v[132:135], v[104:107], v[84:87]
  v_xor_b32 v35, 0x80000000, v163
  s_waitcnt vmcnt(15)
  s_barrier
  s_waitcnt lgkmcnt(4)
  v_mfma_f32_16x16x32_bf16 v[48:51], v[136:139], v[108:111], v[48:51]
  ds_read_b128 v[128:131], v184 offset:2048
  ds_read_b128 v[132:135], v184 offset:4096
  ds_read_b128 v[88:91], v5 offset:40960
  v_mfma_f32_16x16x32_bf16 v[52:55], v[140:143], v[108:111], v[52:55]
  s_add_u32 m0, s19, 12288
  s_add_u32 s15, s18, 5888
  buffer_load_dwordx4 v186, s[80:83], s15 offen lds
  s_waitcnt lgkmcnt(6)
  v_mfma_f32_16x16x32_bf16 v[56:59], v[136:139], v[112:115], v[56:59]
  ds_read_b128 v[92:95], v5 offset:43008
  v_mfma_f32_16x16x32_bf16 v[60:63], v[140:143], v[112:115], v[60:63]
  s_add_u32 m0, s19, 13312
  s_add_u32 s15, s18, 26368
  buffer_load_dwordx4 v186, s[80:83], s15 offen lds
  s_waitcnt lgkmcnt(6)
  v_mfma_f32_16x16x32_bf16 v[64:67], v[136:139], v[116:119], v[64:67]
  ds_read_b128 v[96:99], v5 offset:45056
  v_mfma_f32_16x16x32_bf16 v[68:71], v[140:143], v[116:119], v[68:71]
  s_waitcnt lgkmcnt(6)
  v_mfma_f32_16x16x32_bf16 v[72:75], v[136:139], v[120:123], v[72:75]
  ds_read_b128 v[100:103], v5 offset:47104
  v_mfma_f32_16x16x32_bf16 v[76:79], v[140:143], v[120:123], v[76:79]
  s_waitcnt lgkmcnt(6)
  v_mfma_f32_16x16x32_bf16 v[80:83], v[136:139], v[124:127], v[80:83]
  ds_read_b128 v[104:107], v5 offset:49152
  v_mfma_f32_16x16x32_bf16 v[84:87], v[140:143], v[124:127], v[84:87]
  s_waitcnt lgkmcnt(4)
  v_mfma_f32_16x16x32_bf16 v[48:51], v[128:131], v[88:91], v[48:51]
  ds_read_b128 v[136:139], v189 offset:2048
  ds_read_b128 v[140:143], v189 offset:4096
  ds_read_b128 v[108:111], v6 offset:40960
  v_mfma_f32_16x16x32_bf16 v[52:55], v[132:135], v[88:91], v[52:55]
  s_add_u32 m0, s19, 0
  s_add_u32 s15, s18, 896
  buffer_load_dwordx4 v186, s[80:83], s15 offen lds
  s_waitcnt lgkmcnt(6)
  v_mfma_f32_16x16x32_bf16 v[56:59], v[128:131], v[92:95], v[56:59]
  ds_read_b128 v[112:115], v6 offset:43008
  v_mfma_f32_16x16x32_bf16 v[60:63], v[132:135], v[92:95], v[60:63]
  s_add_u32 m0, s19, 1024
  s_add_u32 s15, s18, 21376
  buffer_load_dwordx4 v186, s[80:83], s15 offen lds
  s_waitcnt lgkmcnt(6)
  v_mfma_f32_16x16x32_bf16 v[64:67], v[128:131], v[96:99], v[64:67]
  ds_read_b128 v[116:119], v6 offset:45056
  v_mfma_f32_16x16x32_bf16 v[68:71], v[132:135], v[96:99], v[68:71]
  s_add_u32 m0, s40, 81920
  s_add_u32 s14, s41, 1024
  buffer_load_dwordx4 v47, s[64:67], s14 offen lds
  s_waitcnt lgkmcnt(6)
  v_mfma_f32_16x16x32_bf16 v[72:75], v[128:131], v[100:103], v[72:75]
  ds_read_b128 v[120:123], v6 offset:47104
  v_mfma_f32_16x16x32_bf16 v[76:79], v[132:135], v[100:103], v[76:79]
  s_add_u32 m0, s40, 83968
  s_add_u32 s14, s41, 11264
  buffer_load_dwordx4 v47, s[64:67], s14 offen lds
  s_waitcnt lgkmcnt(6)
  v_mfma_f32_16x16x32_bf16 v[80:83], v[128:131], v[104:107], v[80:83]
  ds_read_b128 v[124:127], v6 offset:49152
  v_mfma_f32_16x16x32_bf16 v[84:87], v[132:135], v[104:107], v[84:87]
  s_add_u32 m0, s40, 86016
  s_add_u32 s14, s41, 21504
  buffer_load_dwordx4 v47, s[64:67], s14 offen lds
  s_waitcnt vmcnt(11)
  s_add_u32 s12, s17, 20480
  v_mov_b32 v15, s8
  s_mov_b64 exec, 1
  buffer_store_dword v15, off, s[52:55], s12 sc1
  s_mov_b64 exec, -1
  s_waitcnt lgkmcnt(4)
  v_mfma_f32_16x16x32_bf16 v[48:51], v[136:139], v[108:111], v[48:51]
  ds_read_b128 v[128:131], v184 offset:6144
  ds_read_b128 v[132:135], v184 offset:8192
  ds_read_b128 v[88:91], v7 offset:0
  v_mfma_f32_16x16x32_bf16 v[52:55], v[140:143], v[108:111], v[52:55]
  s_add_u32 m0, s19, 2048
  s_add_u32 s15, s18, 6016
  buffer_load_dwordx4 v186, s[80:83], s15 offen lds
  s_add_u32 m0, s19, 3072
  s_add_u32 s15, s18, 26496
  buffer_load_dwordx4 v186, s[80:83], s15 offen lds
  s_add_u32 m0, s40, 88064
  s_add_u32 s14, s41, 31744
  buffer_load_dwordx4 v47, s[64:67], s14 offen lds
  s_waitcnt lgkmcnt(6)
  v_mfma_f32_16x16x32_bf16 v[56:59], v[136:139], v[112:115], v[56:59]
  ds_read_b128 v[92:95], v7 offset:2048
  v_mfma_f32_16x16x32_bf16 v[60:63], v[140:143], v[112:115], v[60:63]
  s_add_u32 m0, s40, 90112
  s_add_u32 s14, s41, 41984
  buffer_load_dwordx4 v47, s[64:67], s14 offen lds
  s_lshl_b32 s96, s3, 11
  s_lshl_b32 s12, s7, 9
  s_waitcnt lgkmcnt(6)
  v_mfma_f32_16x16x32_bf16 v[64:67], v[136:139], v[116:119], v[64:67]
  ds_read_b128 v[96:99], v7 offset:4096
  v_mfma_f32_16x16x32_bf16 v[68:71], v[140:143], v[116:119], v[68:71]
  s_add_u32 s96, s96, s12
  s_add_u32 s96, s96, 262144
  s_waitcnt lgkmcnt(6)
  v_mfma_f32_16x16x32_bf16 v[72:75], v[136:139], v[120:123], v[72:75]
  ds_read_b128 v[100:103], v7 offset:6144
  v_mfma_f32_16x16x32_bf16 v[76:79], v[140:143], v[120:123], v[76:79]
  v_and_b32 v187, 7, v3
  v_lshlrev_b32 v187, 4, v187
  s_waitcnt lgkmcnt(6)
  v_mfma_f32_16x16x32_bf16 v[80:83], v[136:139], v[124:127], v[80:83]
  ds_read_b128 v[104:107], v7 offset:8192
  v_mfma_f32_16x16x32_bf16 v[84:87], v[140:143], v[124:127], v[84:87]
  v_lshl_add_u32 v187, v4, 7, v187
  s_and_b32 s13, s16, 0xe00
  s_add_u32 s13, s13, 28672
  buffer_load_dwordx4 v[212:215], v223, s[52:55], s13 offen sc1
  s_waitcnt lgkmcnt(4)
  v_mfma_f32_16x16x32_bf16 v[48:51], v[128:131], v[88:91], v[48:51]
  ds_read_b128 v[136:139], v189 offset:6144
  ds_read_b128 v[140:143], v189 offset:8192
  ds_read_b128 v[108:111], v8 offset:0
  v_mfma_f32_16x16x32_bf16 v[52:55], v[132:135], v[88:91], v[52:55]
  s_add_u32 m0, s19, 4096
  s_add_u32 s15, s18, 1024
  buffer_load_dwordx4 v186, s[80:83], s15 offen lds
  s_add_u32 m0, s19, 5120
  s_add_u32 s15, s18, 21504
  buffer_load_dwordx4 v186, s[80:83], s15 offen lds
  s_waitcnt lgkmcnt(6)
  v_mfma_f32_16x16x32_bf16 v[56:59], v[128:131], v[92:95], v[56:59]
  ds_read_b128 v[112:115], v8 offset:2048
  v_mfma_f32_16x16x32_bf16 v[60:63], v[132:135], v[92:95], v[60:63]
  s_mul_i32 s44, s4, 640
  s_waitcnt lgkmcnt(6)
  v_mfma_f32_16x16x32_bf16 v[64:67], v[128:131], v[96:99], v[64:67]
  ds_read_b128 v[116:119], v8 offset:4096
  v_mfma_f32_16x16x32_bf16 v[68:71], v[132:135], v[96:99], v[68:71]
  s_add_u32 s44, s44, 303104
  s_waitcnt lgkmcnt(6)
  v_mfma_f32_16x16x32_bf16 v[72:75], v[128:131], v[100:103], v[72:75]
  ds_read_b128 v[120:123], v8 offset:6144
  v_mfma_f32_16x16x32_bf16 v[76:79], v[132:135], v[100:103], v[76:79]
  v_lshlrev_b32 v185, 3, v1
  s_waitcnt lgkmcnt(6)
  v_mfma_f32_16x16x32_bf16 v[80:83], v[128:131], v[104:107], v[80:83]
  ds_read_b128 v[124:127], v8 offset:8192
  v_mfma_f32_16x16x32_bf16 v[84:87], v[132:135], v[104:107], v[84:87]
  v_lshlrev_b32 v188, 3, v3
  s_waitcnt vmcnt(13)
  s_barrier
  s_waitcnt lgkmcnt(4)
  v_mfma_f32_16x16x32_bf16 v[48:51], v[136:139], v[108:111], v[48:51]
  ds_read_b128 v[128:131], v184 offset:10240
  ds_read_b128 v[132:135], v184 offset:12288
  ds_read_b128 v[88:91], v7 offset:10240
  v_mfma_f32_16x16x32_bf16 v[52:55], v[140:143], v[108:111], v[52:55]
  s_add_u32 m0, s19, 6144
  s_add_u32 s15, s18, 6144
  buffer_load_dwordx4 v186, s[80:83], s15 offen lds
  s_waitcnt lgkmcnt(6)
  v_mfma_f32_16x16x32_bf16 v[56:59], v[136:139], v[112:115], v[56:59]
  ds_read_b128 v[92:95], v7 offset:12288
  v_mfma_f32_16x16x32_bf16 v[60:63], v[140:143], v[112:115], v[60:63]
  s_add_u32 m0, s19, 7168
  s_add_u32 s15, s18, 26624
  buffer_load_dwordx4 v186, s[80:83], s15 offen lds
  s_waitcnt lgkmcnt(6)
  v_mfma_f32_16x16x32_bf16 v[64:67], v[136:139], v[116:119], v[64:67]
  ds_read_b128 v[96:99], v7 offset:14336
  v_mfma_f32_16x16x32_bf16 v[68:71], v[140:143], v[116:119], v[68:71]
  buffer_load_dwordx3 v[224:226], v187, s[52:55], s96 offen sc1
  s_waitcnt lgkmcnt(6)
  v_mfma_f32_16x16x32_bf16 v[72:75], v[136:139], v[120:123], v[72:75]
  ds_read_b128 v[100:103], v7 offset:16384
  v_mfma_f32_16x16x32_bf16 v[76:79], v[140:143], v[120:123], v[76:79]
  buffer_load_dwordx2 v[228:229], v185, s[52:55], s44 offen sc1
  s_waitcnt lgkmcnt(6)
  v_mfma_f32_16x16x32_bf16 v[80:83], v[136:139], v[124:127], v[80:83]
  ds_read_b128 v[104:107], v7 offset:18432
  v_mfma_f32_16x16x32_bf16 v[84:87], v[140:143], v[124:127], v[84:87]
  buffer_load_dwordx2 v[230:231], v188, s[52:55], s44 offen offset:512 sc1
  s_waitcnt lgkmcnt(4)
  v_mfma_f32_16x16x32_bf16 v[48:51], v[128:131], v[88:91], v[48:51]
  ds_read_b128 v[136:139], v189 offset:10240
  ds_read_b128 v[140:143], v189 offset:12288
  ds_read_b128 v[108:111], v8 offset:10240
  v_mfma_f32_16x16x32_bf16 v[52:55], v[132:135], v[88:91], v[52:55]
  s_add_u32 m0, s19, 8192
  s_add_u32 s15, s18, 1152
  buffer_load_dwordx4 v186, s[80:83], s15 offen lds
  s_waitcnt lgkmcnt(6)
  v_mfma_f32_16x16x32_bf16 v[56:59], v[128:131], v[92:95], v[56:59]
  ds_read_b128 v[112:115], v8 offset:12288
  v_mfma_f32_16x16x32_bf16 v[60:63], v[132:135], v[92:95], v[60:63]
  s_add_u32 m0, s19, 9216
  s_add_u32 s15, s18, 21632
  buffer_load_dwordx4 v186, s[80:83], s15 offen lds
  s_waitcnt lgkmcnt(6)
  v_mfma_f32_16x16x32_bf16 v[64:67], v[128:131], v[96:99], v[64:67]
  ds_read_b128 v[116:119], v8 offset:14336
  v_mfma_f32_16x16x32_bf16 v[68:71], v[132:135], v[96:99], v[68:71]
  s_waitcnt vmcnt(9)
  v_xor_b32 v15, s8, v212
  v_xor_b32 v14, s8, v213
  v_or_b32 v15, v15, v14
  v_xor_b32 v14, s8, v214
  v_or_b32 v15, v15, v14
  v_xor_b32 v14, s8, v215
  v_or_b32 v15, v15, v14
  v_cmp_ne_u32 vcc, 0, v15
  s_cbranch_vccnz again_18
ok_19:
  s_waitcnt lgkmcnt(6)
  v_mfma_f32_16x16x32_bf16 v[72:75], v[128:131], v[100:103], v[72:75]
  ds_read_b128 v[120:123], v8 offset:16384
  v_mfma_f32_16x16x32_bf16 v[76:79], v[132:135], v[100:103], v[76:79]
  s_waitcnt lgkmcnt(6)
  v_mfma_f32_16x16x32_bf16 v[80:83], v[128:131], v[104:107], v[80:83]
  ds_read_b128 v[124:127], v8 offset:18432
  v_mfma_f32_16x16x32_bf16 v[84:87], v[132:135], v[104:107], v[84:87]
  s_waitcnt vmcnt(12)
  s_waitcnt lgkmcnt(4)
  v_mfma_f32_16x16x32_bf16 v[48:51], v[136:139], v[108:111], v[48:51]
  ds_read_b128 v[128:131], v184 offset:0
  ds_read_b128 v[132:135], v184 offset:2048
  ds_read_b128 v[88:91], v7 offset:20480
  v_mfma_f32_16x16x32_bf16 v[52:55], v[140:143], v[108:111], v[52:55]
  s_add_u32 m0, s19, 10240
  s_add_u32 s15, s18, 6272
  buffer_load_dwordx4 v186, s[80:83], s15 offen lds
  s_waitcnt lgkmcnt(6)
  v_mfma_f32_16x16x32_bf16 v[56:59], v[136:139], v[112:115], v[56:59]
  ds_read_b128 v[92:95], v7 offset:22528
  v_mfma_f32_16x16x32_bf16 v[60:63], v[140:143], v[112:115], v[60:63]
  s_add_u32 m0, s19, 11264
  s_add_u32 s15, s18, 26752
  buffer_load_dwordx4 v186, s[80:83], s15 offen lds
  s_waitcnt lgkmcnt(6)
  v_mfma_f32_16x16x32_bf16 v[64:67], v[136:139], v[116:119], v[64:67]
  ds_read_b128 v[96:99], v7 offset:24576
  v_mfma_f32_16x16x32_bf16 v[68:71], v[140:143], v[116:119], v[68:71]
  s_mul_i32 s14, s7, 6144
  s_add_u32 m0, s14, 0
  s_nop 0
  buffer_load_dwordx4 v216, s[52:55], s20 offen sc1 lds
  s_waitcnt lgkmcnt(6)
  v_mfma_f32_16x16x32_bf16 v[72:75], v[136:139], v[120:123], v[72:75]
  ds_read_b128 v[100:103], v7 offset:26624
  v_mfma_f32_16x16x32_bf16 v[76:79], v[140:143], v[120:123], v[76:79]
  s_mul_i32 s14, s7, 6144
  s_add_u32 m0, s14, 1024
  s_nop 0
  buffer_load_dwordx4 v217, s[52:55], s21 offen sc1 lds
  s_waitcnt lgkmcnt(6)
  v_mfma_f32_16x16x32_bf16 v[80:83], v[136:139], v[124:127], v[80:83]
  ds_read_b128 v[104:107], v7 offset:28672
  v_mfma_f32_16x16x32_bf16 v[84:87], v[140:143], v[124:127], v[84:87]
  s_waitcnt lgkmcnt(4)
  v_mfma_f32_16x16x32_bf16 v[48:51], v[128:131], v[88:91], v[48:51]
  ds_read_b128 v[136:139], v189 offset:0
  ds_read_b128 v[140:143], v189 offset:2048
  ds_read_b128 v[108:111], v8 offset:20480
  v_mfma_f32_16x16x32_bf16 v[52:55], v[132:135], v[88:91], v[52:55]
  s_mul_i32 s14, s7, 6144
  s_add_u32 m0, s14, 2048
  s_nop 0
  buffer_load_dwordx4 v218, s[52:55], s22 offen sc1 lds
  s_waitcnt lgkmcnt(6)
  v_mfma_f32_16x16x32_bf16 v[56:59], v[128:131], v[92:95], v[56:59]
  ds_read_b128 v[112:115], v8 offset:22528
  v_mfma_f32_16x16x32_bf16 v[60:63], v[132:135], v[92:95], v[60:63]
  s_mul_i32 s14, s7, 6144
  s_add_u32 m0, s14, 3072
  s_nop 0
  buffer_load_dwordx4 v219, s[52:55], s23 offen sc1 lds
  s_waitcnt lgkmcnt(6)
  v_mfma_f32_16x16x32_bf16 v[64:67], v[128:131], v[96:99], v[64:67]
  ds_read_b128 v[116:119], v8 offset:24576
  v_mfma_f32_16x16x32_bf16 v[68:71], v[132:135], v[96:99], v[68:71]
  s_waitcnt lgkmcnt(6)
  v_mfma_f32_16x16x32_bf16 v[72:75], v[128:131], v[100:103], v[72:75]
  ds_read_b128 v[120:123], v8 offset:26624
  v_mfma_f32_16x16x32_bf16 v[76:79], v[132:135], v[100:103], v[76:79]
  s_waitcnt lgkmcnt(6)
  v_mfma_f32_16x16x32_bf16 v[80:83], v[128:131], v[104:107], v[80:83]
  ds_read_b128 v[124:127], v8 offset:28672
  v_mfma_f32_16x16x32_bf16 v[84:87], v[132:135], v[104:107], v[84:87]
  s_waitcnt vmcnt(11)
  s_barrier
  s_waitcnt lgkmcnt(4)
  v_mfma_f32_16x16x32_bf16 v[48:51], v[136:139], v[108:111], v[48:51]
  ds_read_b128 v[128:131], v184 offset:4096
  ds_read_b128 v[132:135], v184 offset:6144
  ds_read_b128 v[88:91], v7 offset:30720
  v_mfma_f32_16x16x32_bf16 v[52:55], v[140:143], v[108:111], v[52:55]
  s_waitcnt vmcnt(8)
  v_min3_u32 v13, v226, v229, v231
  v_max3_u32 v14, v226, v229, v231
  v_xor_b32 v13, s8, v13
  v_xor_b32 v14, s8, v14
  v_or_b32 v13, v13, v14
  v_cmp_ne_u32 vcc, 0, v13
  s_cbranch_vccnz again_20
ok_21:
  s_waitcnt lgkmcnt(6)
  v_mfma_f32_16x16x32_bf16 v[56:59], v[136:139], v[112:115], v[56:59]
  ds_read_b128 v[92:95], v7 offset:32768
  v_mfma_f32_16x16x32_bf16 v[60:63], v[140:143], v[112:115], v[60:63]
  s_mul_i32 s14, s7, 6144
  s_add_u32 m0, s14, 4096
  s_nop 0
  buffer_load_dwordx4 v220, s[52:55], s24 offen sc1 lds
  s_waitcnt lgkmcnt(6)
  v_mfma_f32_16x16x32_bf16 v[64:67], v[136:139], v[116:119], v[64:67]
  ds_read_b128 v[96:99], v7 offset:34816
  v_mfma_f32_16x16x32_bf16 v[68:71], v[140:143], v[116:119], v[68:71]
  s_mul_i32 s14, s7, 6144
  s_add_u32 m0, s14, 5120
  s_nop 0
  buffer_load_dwordx4 v221, s[52:55], s25 offen sc1 lds
  s_waitcnt lgkmcnt(6)
  v_mfma_f32_16x16x32_bf16 v[72:75], v[136:139], v[120:123], v[72:75]
  ds_read_b128 v[100:103], v7 offset:36864
  v_mfma_f32_16x16x32_bf16 v[76:79], v[140:143], v[120:123], v[76:79]
  s_waitcnt lgkmcnt(6)
  v_mfma_f32_16x16x32_bf16 v[80:83], v[136:139], v[124:127], v[80:83]
  ds_read_b128 v[104:107], v7 offset:38912
  v_mfma_f32_16x16x32_bf16 v[84:87], v[140:143], v[124:127], v[84:87]
  s_waitcnt lgkmcnt(4)
  v_mfma_f32_16x16x32_bf16 v[48:51], v[128:131], v[88:91], v[48:51]
  ds_read_b128 v[136:139], v189 offset:4096
  ds_read_b128 v[140:143], v189 offset:6144
  ds_read_b128 v[108:111], v8 offset:30720
  v_mfma_f32_16x16x32_bf16 v[52:55], v[132:135], v[88:91], v[52:55]
  v_mov_b32_dpp v168, v224 row_newbcast:0 row_mask:0xf bank_mask:0xf
  v_mov_b32_dpp v176, v225 row_newbcast:0 row_mask:0xf bank_mask:0xf
  v_mov_b32_dpp v169, v224 row_newbcast:1 row_mask:0xf bank_mask:0xf
  s_waitcnt lgkmcnt(6)
  v_mfma_f32_16x16x32_bf16 v[56:59], v[128:131], v[92:95], v[56:59]
  ds_read_b128 v[112:115], v8 offset:32768
  v_mfma_f32_16x16x32_bf16 v[60:63], v[132:135], v[92:95], v[60:63]
  v_mov_b32_dpp v177, v225 row_newbcast:1 row_mask:0xf bank_mask:0xf
  v_mov_b32_dpp v170, v224 row_newbcast:2 row_mask:0xf bank_mask:0xf
  v_mov_b32_dpp v178, v225 row_newbcast:2 row_mask:0xf bank_mask:0xf
  s_waitcnt lgkmcnt(6)
  v_mfma_f32_16x16x32_bf16 v[64:67], v[128:131], v[96:99], v[64:67]
  ds_read_b128 v[116:119], v8 offset:34816
  v_mfma_f32_16x16x32_bf16 v[68:71], v[132:135], v[96:99], v[68:71]
  v_mov_b32_dpp v171, v224 row_newbcast:3 row_mask:0xf bank_mask:0xf
  v_mov_b32_dpp v179, v225 row_newbcast:3 row_mask:0xf bank_mask:0xf
  v_subrev_u32 v216, 64, v2
  s_waitcnt lgkmcnt(6)
  v_mfma_f32_16x16x32_bf16 v[72:75], v[128:131], v[100:103], v[72:75]
  ds_read_b128 v[120:123], v8 offset:36864
  v_mfma_f32_16x16x32_bf16 v[76:79], v[132:135], v[100:103], v[76:79]
  v_add_u32 v217, 944, v2
  buffer_load_dwordx4 v[192:195], v216, s[68:71], 0 offen offset:0
  s_waitcnt lgkmcnt(6)
  v_mfma_f32_16x16x32_bf16 v[80:83], v[128:131], v[104:107], v[80:83]
  ds_read_b128 v[124:127], v8 offset:38912
  v_mfma_f32_16x16x32_bf16 v[84:87], v[132:135], v[104:107], v[84:87]
  buffer_load_dwordx4 v[196:199], v217, s[68:71], 0 offen offset:0
  buffer_load_dwordx4 v[200:203], v217, s[68:71], 0 offen offset:1008
  s_waitcnt vmcnt(9)
  s_waitcnt lgkmcnt(4)
  v_mfma_f32_16x16x32_bf16 v[48:51], v[136:139], v[108:111], v[48:51]
  ds_read_b128 v[128:131], v184 offset:8192
  ds_read_b128 v[132:135], v184 offset:10240
  ds_read_b128 v[88:91], v7 offset:40960
  v_mfma_f32_16x16x32_bf16 v[52:55], v[140:143], v[108:111], v[52:55]
  v_mov_b32_dpp v172, v224 row_newbcast:4 row_mask:0xf bank_mask:0xf
  v_mov_b32_dpp v180, v225 row_newbcast:4 row_mask:0xf bank_mask:0xf
  v_mov_b32_dpp v173, v224 row_newbcast:5 row_mask:0xf bank_mask:0xf
  s_waitcnt lgkmcnt(6)
  v_mfma_f32_16x16x32_bf16 v[56:59], v[136:139], v[112:115], v[56:59]
  ds_read_b128 v[92:95], v7 offset:43008
  v_mfma_f32_16x16x32_bf16 v[60:63], v[140:143], v[112:115], v[60:63]
  v_mov_b32_dpp v181, v225 row_newbcast:5 row_mask:0xf bank_mask:0xf
  v_mov_b32_dpp v174, v224 row_newbcast:6 row_mask:0xf bank_mask:0xf
  v_mov_b32_dpp v182, v225 row_newbcast:6 row_mask:0xf bank_mask:0xf
  s_waitcnt lgkmcnt(6)
  v_mfma_f32_16x16x32_bf16 v[64:67], v[136:139], v[116:119], v[64:67]
  ds_read_b128 v[96:99], v7 offset:45056
  v_mfma_f32_16x16x32_bf16 v[68:71], v[140:143], v[116:119], v[68:71]
  v_mov_b32_dpp v175, v224 row_newbcast:7 row_mask:0xf bank_mask:0xf
  v_mov_b32_dpp v183, v225 row_newbcast:7 row_mask:0xf bank_mask:0xf
  buffer_load_dwordx4 v[164:167], v217, s[68:71], 0 offen offset:2016
  s_waitcnt lgkmcnt(6)
  v_mfma_f32_16x16x32_bf16 v[72:75], v[136:139], v[120:123], v[72:75]
  ds_read_b128 v[100:103], v7 offset:47104
  v_mfma_f32_16x16x32_bf16 v[76:79], v[140:143], v[120:123], v[76:79]
  s_and_b32 s96, s17, 0xe00
  s_add_u32 s96, s96, 20480
  v_mov_b32 v246, v223
  s_waitcnt lgkmcnt(6)
  v_mfma_f32_16x16x32_bf16 v[80:83], v[136:139], v[124:127], v[80:83]
  ds_read_b128 v[104:107], v7 offset:49152
  v_mfma_f32_16x16x32_bf16 v[84:87], v[140:143], v[124:127], v[84:87]
  buffer_load_dwordx4 v[204:207], v246, s[52:55], s96 offen sc1
  buffer_load_dwordx4 v[240:243], v217, s[68:71], 0 offen offset:3024
  s_waitcnt lgkmcnt(4)
  v_mfma_f32_16x16x32_bf16 v[48:51], v[128:131], v[88:91], v[48:51]
  ds_read_b128 v[136:139], v189 offset:8192
  ds_read_b128 v[140:143], v189 offset:10240
  ds_read_b128 v[108:111], v8 offset:40960
  v_mfma_f32_16x16x32_bf16 v[52:55], v[132:135], v[88:91], v[52:55]
  v_mov_b32 v144, v228
  v_mov_b32 v146, v228
  s_waitcnt lgkmcnt(6)
  v_mfma_f32_16x16x32_bf16 v[56:59], v[128:131], v[92:95], v[56:59]
  ds_read_b128 v[112:115], v8 offset:43008
  v_mfma_f32_16x16x32_bf16 v[60:63], v[132:135], v[92:95], v[60:63]
  v_mov_b32 v152, v230
  v_permlane16_swap_b32 v144, v146
  s_waitcnt lgkmcnt(6)
  v_mfma_f32_16x16x32_bf16 v[64:67], v[128:131], v[96:99], v[64:67]
  ds_read_b128 v[116:119], v8 offset:45056
  v_mfma_f32_16x16x32_bf16 v[68:71], v[132:135], v[96:99], v[68:71]
  v_mov_b32 v148, v144
  v_mov_b32 v150, v146
  s_waitcnt lgkmcnt(6)
  v_mfma_f32_16x16x32_bf16 v[72:75], v[128:131], v[100:103], v[72:75]
  ds_read_b128 v[120:123], v8 offset:47104
  v_mfma_f32_16x16x32_bf16 v[76:79], v[132:135], v[100:103], v[76:79]
  v_permlane32_swap_b32 v144, v148
  s_waitcnt lgkmcnt(6)
  v_mfma_f32_16x16x32_bf16 v[80:83], v[128:131], v[104:107], v[80:83]
  ds_read_b128 v[124:127], v8 offset:49152
  v_mfma_f32_16x16x32_bf16 v[84:87], v[132:135], v[104:107], v[84:87]
  v_permlane32_swap_b32 v146, v150
  s_waitcnt lgkmcnt(4)
  v_mfma_f32_16x16x32_bf16 v[48:51], v[136:139], v[108:111], v[48:51]
  v_mfma_f32_16x16x32_bf16 v[52:55], v[140:143], v[108:111], v[52:55]
  s_waitcnt lgkmcnt(3)
  v_mfma_f32_16x16x32_bf16 v[56:59], v[136:139], v[112:115], v[56:59]
  v_mfma_f32_16x16x32_bf16 v[60:63], v[140:143], v[112:115], v[60:63]
  s_waitcnt lgkmcnt(2)
  v_mfma_f32_16x16x32_bf16 v[64:67], v[136:139], v[116:119], v[64:67]
  v_mfma_f32_16x16x32_bf16 v[68:71], v[140:143], v[116:119], v[68:71]
  s_waitcnt lgkmcnt(1)
  v_mfma_f32_16x16x32_bf16 v[72:75], v[136:139], v[120:123], v[72:75]
  v_mfma_f32_16x16x32_bf16 v[76:79], v[140:143], v[120:123], v[76:79]
  s_waitcnt lgkmcnt(0)
  v_mfma_f32_16x16x32_bf16 v[80:83], v[136:139], v[124:127], v[80:83]
  v_mfma_f32_16x16x32_bf16 v[84:87], v[140:143], v[124:127], v[84:87]
  v_pk_fma_f32 v[48:49], v[168:169], v[144:145], v[48:49] op_sel_hi:[1,0,1] neg_lo:[1,0,0] neg_hi:[1,0,0]
  v_pk_fma_f32 v[50:51], v[170:171], v[144:145], v[50:51] op_sel_hi:[1,0,1] neg_lo:[1,0,0] neg_hi:[1,0,0]
  v_pk_fma_f32 v[52:53], v[172:173], v[144:145], v[52:53] op_sel_hi:[1,0,1] neg_lo:[1,0,0] neg_hi:[1,0,0]
  v_pk_fma_f32 v[54:55], v[174:175], v[144:145], v[54:55] op_sel_hi:[1,0,1] neg_lo:[1,0,0] neg_hi:[1,0,0]
  v_pk_fma_f32 v[56:57], v[168:169], v[146:147], v[56:57] op_sel_hi:[1,0,1] neg_lo:[1,0,0] neg_hi:[1,0,0]
  v_pk_fma_f32 v[58:59], v[170:171], v[146:147], v[58:59] op_sel_hi:[1,0,1] neg_lo:[1,0,0] neg_hi:[1,0,0]
  v_pk_fma_f32 v[60:61], v[172:173], v[146:147], v[60:61] op_sel_hi:[1,0,1] neg_lo:[1,0,0] neg_hi:[1,0,0]
  v_pk_fma_f32 v[62:63], v[174:175], v[146:147], v[62:63] op_sel_hi:[1,0,1] neg_lo:[1,0,0] neg_hi:[1,0,0]
  v_pk_fma_f32 v[64:65], v[168:169], v[148:149], v[64:65] op_sel_hi:[1,0,1] neg_lo:[1,0,0] neg_hi:[1,0,0]
  v_pk_fma_f32 v[66:67], v[170:171], v[148:149], v[66:67] op_sel_hi:[1,0,1] neg_lo:[1,0,0] neg_hi:[1,0,0]
  v_pk_fma_f32 v[68:69], v[172:173], v[148:149], v[68:69] op_sel_hi:[1,0,1] neg_lo:[1,0,0] neg_hi:[1,0,0]
  v_pk_fma_f32 v[70:71], v[174:175], v[148:149], v[70:71] op_sel_hi:[1,0,1] neg_lo:[1,0,0] neg_hi:[1,0,0]
  v_pk_fma_f32 v[72:73], v[168:169], v[150:151], v[72:73] op_sel_hi:[1,0,1] neg_lo:[1,0,0] neg_hi:[1,0,0]
  v_pk_fma_f32 v[74:75], v[170:171], v[150:151], v[74:75] op_sel_hi:[1,0,1] neg_lo:[1,0,0] neg_hi:[1,0,0]
  v_pk_fma_f32 v[76:77], v[172:173], v[150:151], v[76:77] op_sel_hi:[1,0,1] neg_lo:[1,0,0] neg_hi:[1,0,0]
  v_pk_fma_f32 v[78:79], v[174:175], v[150:151], v[78:79] op_sel_hi:[1,0,1] neg_lo:[1,0,0] neg_hi:[1,0,0]
  v_pk_fma_f32 v[80:81], v[168:169], v[152:153], v[80:81] op_sel_hi:[1,0,1] neg_lo:[1,0,0] neg_hi:[1,0,0]
  v_pk_fma_f32 v[82:83], v[170:171], v[152:153], v[82:83] op_sel_hi:[1,0,1] neg_lo:[1,0,0] neg_hi:[1,0,0]
  v_pk_fma_f32 v[84:85], v[172:173], v[152:153], v[84:85] op_sel_hi:[1,0,1] neg_lo:[1,0,0] neg_hi:[1,0,0]
  v_pk_fma_f32 v[86:87], v[174:175], v[152:153], v[86:87] op_sel_hi:[1,0,1] neg_lo:[1,0,0] neg_hi:[1,0,0]
  v_pk_mul_f32 v[48:49], v[48:49], v[176:177]
  v_pk_mul_f32 v[50:51], v[50:51], v[178:179]
  v_pk_mul_f32 v[52:53], v[52:53], v[180:181]
  v_pk_mul_f32 v[54:55], v[54:55], v[182:183]
  v_pk_mul_f32 v[56:57], v[56:57], v[176:177]
  v_pk_mul_f32 v[58:59], v[58:59], v[178:179]
  v_pk_mul_f32 v[60:61], v[60:61], v[180:181]
  v_pk_mul_f32 v[62:63], v[62:63], v[182:183]
  v_pk_mul_f32 v[64:65], v[64:65], v[176:177]
  v_pk_mul_f32 v[66:67], v[66:67], v[178:179]
  v_pk_mul_f32 v[68:69], v[68:69], v[180:181]
  v_pk_mul_f32 v[70:71], v[70:71], v[182:183]
  v_pk_mul_f32 v[72:73], v[72:73], v[176:177]
  v_pk_mul_f32 v[74:75], v[74:75], v[178:179]
  v_pk_mul_f32 v[76:77], v[76:77], v[180:181]
  v_pk_mul_f32 v[78:79], v[78:79], v[182:183]
  v_pk_mul_f32 v[80:81], v[80:81], v[176:177]
  v_pk_mul_f32 v[82:83], v[82:83], v[178:179]
  v_pk_mul_f32 v[84:85], v[84:85], v[180:181]
  v_pk_mul_f32 v[86:87], v[86:87], v[182:183]
  v_fma_f32 v176, v16, v48, v49
  v_fma_f32 v177, v17, v56, v57
  v_fma_f32 v178, v18, v64, v65
  v_fma_f32 v179, v19, v72, v73
  v_fma_f32 v180, v20, v80, v81
  v_fmac_f32_dpp v176, -v48, v21 quad_perm:[1,0,3,2] row_mask:0xf bank_mask:0xf
  v_fmac_f32_dpp v177, -v56, v22 quad_perm:[1,0,3,2] row_mask:0xf bank_mask:0xf
  v_fmac_f32_dpp v178, -v64, v23 quad_perm:[1,0,3,2] row_mask:0xf bank_mask:0xf
  v_fmac_f32_dpp v179, -v72, v24 quad_perm:[1,0,3,2] row_mask:0xf bank_mask:0xf
  v_fmac_f32_dpp v180, -v80, v25 quad_perm:[1,0,3,2] row_mask:0xf bank_mask:0xf
  v_fma_f32 v182, v16, v176, v50
  v_fma_f32 v183, v17, v177, v58
  v_fma_f32 v184, v18, v178, v66
  v_fma_f32 v185, v19, v179, v74
  v_fma_f32 v186, v20, v180, v82
  v_fmac_f32_dpp v182, -v176, v21 quad_perm:[1,0,3,2] row_mask:0xf bank_mask:0xf
  v_fmac_f32_dpp v183, -v177, v22 quad_perm:[1,0,3,2] row_mask:0xf bank_mask:0xf
  v_fmac_f32_dpp v184, -v178, v23 quad_perm:[1,0,3,2] row_mask:0xf bank_mask:0xf
  v_fmac_f32_dpp v185, -v179, v24 quad_perm:[1,0,3,2] row_mask:0xf bank_mask:0xf
  v_fmac_f32_dpp v186, -v180, v25 quad_perm:[1,0,3,2] row_mask:0xf bank_mask:0xf
  v_fma_f32 v176, v16, v182, v51
  v_fma_f32 v177, v17, v183, v59
  v_fma_f32 v178, v18, v184, v67
  v_fma_f32 v179, v19, v185, v75
  v_fma_f32 v180, v20, v186, v83
  v_fmac_f32_dpp v176, -v182, v21 quad_perm:[1,0,3,2] row_mask:0xf bank_mask:0xf
  v_fmac_f32_dpp v177, -v183, v22 quad_perm:[1,0,3,2] row_mask:0xf bank_mask:0xf
  v_fmac_f32_dpp v178, -v184, v23 quad_perm:[1,0,3,2] row_mask:0xf bank_mask:0xf
  v_fmac_f32_dpp v179, -v185, v24 quad_perm:[1,0,3,2] row_mask:0xf bank_mask:0xf
  v_fmac_f32_dpp v180, -v186, v25 quad_perm:[1,0,3,2] row_mask:0xf bank_mask:0xf
  v_fma_f32 v182, v16, v176, v52
  v_fma_f32 v183, v17, v177, v60
  v_fma_f32 v184, v18, v178, v68
  v_fma_f32 v185, v19, v179, v76
  v_fma_f32 v186, v20, v180, v84
  v_fmac_f32_dpp v182, -v176, v21 quad_perm:[1,0,3,2] row_mask:0xf bank_mask:0xf
  v_fmac_f32_dpp v183, -v177, v22 quad_perm:[1,0,3,2] row_mask:0xf bank_mask:0xf
  v_fmac_f32_dpp v184, -v178, v23 quad_perm:[1,0,3,2] row_mask:0xf bank_mask:0xf
  v_fmac_f32_dpp v185, -v179, v24 quad_perm:[1,0,3,2] row_mask:0xf bank_mask:0xf
  v_fmac_f32_dpp v186, -v180, v25 quad_perm:[1,0,3,2] row_mask:0xf bank_mask:0xf
  v_fma_f32 v176, v16, v182, v53
  v_fma_f32 v177, v17, v183, v61
  v_fma_f32 v178, v18, v184, v69
  v_fma_f32 v179, v19, v185, v77
  v_fma_f32 v180, v20, v186, v85
  v_fmac_f32_dpp v176, -v182, v21 quad_perm:[1,0,3,2] row_mask:0xf bank_mask:0xf
  v_fmac_f32_dpp v177, -v183, v22 quad_perm:[1,0,3,2] row_mask:0xf bank_mask:0xf
  v_fmac_f32_dpp v178, -v184, v23 quad_perm:[1,0,3,2] row_mask:0xf bank_mask:0xf
  v_fmac_f32_dpp v179, -v185, v24 quad_perm:[1,0,3,2] row_mask:0xf bank_mask:0xf
  v_fmac_f32_dpp v180, -v186, v25 quad_perm:[1,0,3,2] row_mask:0xf bank_mask:0xf
  v_fma_f32 v182, v16, v176, v54
  v_fma_f32 v183, v17, v177, v62
  v_fma_f32 v184, v18, v178, v70
  v_fma_f32 v185, v19, v179, v78
  v_fma_f32 v186, v20, v180, v86
  v_fmac_f32_dpp v182, -v176, v21 quad_perm:[1,0,3,2] row_mask:0xf bank_mask:0xf
  v_fmac_f32_dpp v183, -v177, v22 quad_perm:[1,0,3,2] row_mask:0xf bank_mask:0xf
  v_fmac_f32_dpp v184, -v178, v23 quad_perm:[1,0,3,2] row_mask:0xf bank_mask:0xf
  v_fmac_f32_dpp v185, -v179, v24 quad_perm:[1,0,3,2] row_mask:0xf bank_mask:0xf
  v_fmac_f32_dpp v186, -v180, v25 quad_perm:[1,0,3,2] row_mask:0xf bank_mask:0xf
  v_fma_f32 v176, v16, v182, v55
  v_fma_f32 v177, v17, v183, v63
  v_fma_f32 v178, v18, v184, v71
  v_fma_f32 v179, v19, v185, v79
  v_fma_f32 v180, v20, v186, v87
  v_fmac_f32_dpp v176, -v182, v21 quad_perm:[1,0,3,2] row_mask:0xf bank_mask:0xf
  v_fmac_f32_dpp v177, -v183, v22 quad_perm:[1,0,3,2] row_mask:0xf bank_mask:0xf
  v_fmac_f32_dpp v178, -v184, v23 quad_perm:[1,0,3,2] row_mask:0xf bank_mask:0xf
  v_fmac_f32_dpp v179, -v185, v24 quad_perm:[1,0,3,2] row_mask:0xf bank_mask:0xf
  v_fmac_f32_dpp v180, -v186, v25 quad_perm:[1,0,3,2] row_mask:0xf bank_mask:0xf
  ds_write_b32 v9, v176 offset:0
  ds_write_b32 v9, v177 offset:1152
  ds_write_b32 v9, v178 offset:2304
  ds_write_b32 v9, v179 offset:3456
  ds_write_b32 v9, v180 offset:4608
  v_min_u32_e64 v11, 39, v1
  v_mul_u32_u24 v12, 144, v11
  v_add_u32 v12, 158080, v12
  s_cmp_lg_u32 s7, 2
  s_waitcnt lgkmcnt(0)
  s_barrier
  s_cbranch_scc1 skip_22
  ds_read_b128 v[208:211], v12 offset:0
  ds_read_b128 v[212:215], v12 offset:16
  ds_read_b128 v[216:219], v12 offset:32
  ds_read_b128 v[220:223], v12 offset:48
  ds_read_b128 v[224:227], v12 offset:64
  ds_read_b128 v[228:231], v12 offset:80
  ds_read_b128 v[232:235], v12 offset:96
  ds_read_b128 v[236:239], v12 offset:112
  v_lshlrev_b32_e64 v11, 4, v11
  s_add_u32 s12, s95, 11520
  v_mov_b32 v44, s8
  v_mov_b32 v45, s8
  s_waitcnt lgkmcnt(7)
  v_pk_fma_f32 v[42:43], v[208:209], v[36:37], v[210:211] op_sel:[1,1,0] op_sel_hi:[0,1,1] neg_lo:[0,1,0]
  v_pk_fma_f32 v[42:43], v[208:209], v[36:37], v[42:43] op_sel:[0,0,0] op_sel_hi:[1,0,1]
  s_waitcnt lgkmcnt(6)
  v_pk_fma_f32 v[46:47], v[42:43], v[36:37], v[212:213] op_sel:[1,1,0] op_sel_hi:[0,1,1] neg_lo:[0,1,0]
  v_pk_fma_f32 v[46:47], v[42:43], v[36:37], v[46:47] op_sel:[0,0,0] op_sel_hi:[1,0,1]
  v_pk_fma_f32 v[42:43], v[46:47], v[36:37], v[214:215] op_sel:[1,1,0] op_sel_hi:[0,1,1] neg_lo:[0,1,0]
  v_pk_fma_f32 v[42:43], v[46:47], v[36:37], v[42:43] op_sel:[0,0,0] op_sel_hi:[1,0,1]
  s_waitcnt lgkmcnt(5)
  v_pk_fma_f32 v[46:47], v[42:43], v[36:37], v[216:217] op_sel:[1,1,0] op_sel_hi:[0,1,1] neg_lo:[0,1,0]
  v_pk_fma_f32 v[46:47], v[42:43], v[36:37], v[46:47] op_sel:[0,0,0] op_sel_hi:[1,0,1]
  v_pk_fma_f32 v[42:43], v[46:47], v[36:37], v[218:219] op_sel:[1,1,0] op_sel_hi:[0,1,1] neg_lo:[0,1,0]
  v_pk_fma_f32 v[42:43], v[46:47], v[36:37], v[42:43] op_sel:[0,0,0] op_sel_hi:[1,0,1]
  s_waitcnt lgkmcnt(4)
  v_pk_fma_f32 v[46:47], v[42:43], v[36:37], v[220:221] op_sel:[1,1,0] op_sel_hi:[0,1,1] neg_lo:[0,1,0]
  v_pk_fma_f32 v[46:47], v[42:43], v[36:37], v[46:47] op_sel:[0,0,0] op_sel_hi:[1,0,1]
  v_pk_fma_f32 v[42:43], v[46:47], v[36:37], v[222:223] op_sel:[1,1,0] op_sel_hi:[0,1,1] neg_lo:[0,1,0]
  v_pk_fma_f32 v[42:43], v[46:47], v[36:37], v[42:43] op_sel:[0,0,0] op_sel_hi:[1,0,1]
  s_waitcnt lgkmcnt(3)
  v_pk_fma_f32 v[46:47], v[42:43], v[36:37], v[224:225] op_sel:[1,1,0] op_sel_hi:[0,1,1] neg_lo:[0,1,0]
  v_pk_fma_f32 v[46:47], v[42:43], v[36:37], v[46:47] op_sel:[0,0,0] op_sel_hi:[1,0,1]
  v_pk_fma_f32 v[42:43], v[46:47], v[36:37], v[226:227] op_sel:[1,1,0] op_sel_hi:[0,1,1] neg_lo:[0,1,0]
  v_pk_fma_f32 v[42:43], v[46:47], v[36:37], v[42:43] op_sel:[0,0,0] op_sel_hi:[1,0,1]
  s_waitcnt lgkmcnt(2)
  v_pk_fma_f32 v[46:47], v[42:43], v[36:37], v[228:229] op_sel:[1,1,0] op_sel_hi:[0,1,1] neg_lo:[0,1,0]
  v_pk_fma_f32 v[46:47], v[42:43], v[36:37], v[46:47] op_sel:[0,0,0] op_sel_hi:[1,0,1]
  v_pk_fma_f32 v[42:43], v[46:47], v[36:37], v[230:231] op_sel:[1,1,0] op_sel_hi:[0,1,1] neg_lo:[0,1,0]
  v_pk_fma_f32 v[42:43], v[46:47], v[36:37], v[42:43] op_sel:[0,0,0] op_sel_hi:[1,0,1]
  s_waitcnt lgkmcnt(1)
  v_pk_fma_f32 v[46:47], v[42:43], v[36:37], v[232:233] op_sel:[1,1,0] op_sel_hi:[0,1,1] neg_lo:[0,1,0]
  v_pk_fma_f32 v[46:47], v[42:43], v[36:37], v[46:47] op_sel:[0,0,0] op_sel_hi:[1,0,1]
  v_pk_fma_f32 v[42:43], v[46:47], v[36:37], v[234:235] op_sel:[1,1,0] op_sel_hi:[0,1,1] neg_lo:[0,1,0]
  v_pk_fma_f32 v[42:43], v[46:47], v[36:37], v[42:43] op_sel:[0,0,0] op_sel_hi:[1,0,1]
  s_waitcnt lgkmcnt(0)
  v_pk_fma_f32 v[46:47], v[42:43], v[36:37], v[236:237] op_sel:[1,1,0] op_sel_hi:[0,1,1] neg_lo:[0,1,0]
  v_pk_fma_f32 v[46:47], v[42:43], v[36:37], v[46:47] op_sel:[0,0,0] op_sel_hi:[1,0,1]
  v_pk_fma_f32 v[42:43], v[46:47], v[36:37], v[238:239] op_sel:[1,1,0] op_sel_hi:[0,1,1] neg_lo:[0,1,0]
  v_pk_fma_f32 v[42:43], v[46:47], v[36:37], v[42:43] op_sel:[0,0,0] op_sel_hi:[1,0,1]
  buffer_store_dwordx4 v[42:45], v11, s[52:55], s12 offen sc1
  v_pk_mul_f32 v[46:47], v[208:209], v[40:41] op_sel:[1,1] op_sel_hi:[0,1] neg_lo:[0,1] neg_hi:[0,1]
  v_pk_fma_f32 v[208:209], v[208:209], v[40:41], v[46:47] op_sel:[0,0,0] op_sel_hi:[1,0,1] neg_hi:[0,1,0]
  v_pk_mul_f32 v[46:47], v[210:211], v[40:41] op_sel:[1,1] op_sel_hi:[0,1] neg_lo:[0,1] neg_hi:[0,1]
  v_pk_fma_f32 v[210:211], v[210:211], v[40:41], v[46:47] op_sel:[0,0,0] op_sel_hi:[1,0,1] neg_hi:[0,1,0]
  v_pk_mul_f32 v[46:47], v[212:213], v[40:41] op_sel:[1,1] op_sel_hi:[0,1] neg_lo:[0,1] neg_hi:[0,1]
  v_pk_fma_f32 v[212:213], v[212:213], v[40:41], v[46:47] op_sel:[0,0,0] op_sel_hi:[1,0,1] neg_hi:[0,1,0]
  v_pk_mul_f32 v[46:47], v[214:215], v[40:41] op_sel:[1,1] op_sel_hi:[0,1] neg_lo:[0,1] neg_hi:[0,1]
  v_pk_fma_f32 v[214:215], v[214:215], v[40:41], v[46:47] op_sel:[0,0,0] op_sel_hi:[1,0,1] neg_hi:[0,1,0]
  v_pk_mul_f32 v[46:47], v[216:217], v[40:41] op_sel:[1,1] op_sel_hi:[0,1] neg_lo:[0,1] neg_hi:[0,1]
  v_pk_fma_f32 v[216:217], v[216:217], v[40:41], v[46:47] op_sel:[0,0,0] op_sel_hi:[1,0,1] neg_hi:[0,1,0]
  v_pk_mul_f32 v[46:47], v[218:219], v[40:41] op_sel:[1,1] op_sel_hi:[0,1] neg_lo:[0,1] neg_hi:[0,1]
  v_pk_fma_f32 v[218:219], v[218:219], v[40:41], v[46:47] op_sel:[0,0,0] op_sel_hi:[1,0,1] neg_hi:[0,1,0]
  v_pk_mul_f32 v[46:47], v[220:221], v[40:41] op_sel:[1,1] op_sel_hi:[0,1] neg_lo:[0,1] neg_hi:[0,1]
  v_pk_fma_f32 v[220:221], v[220:221], v[40:41], v[46:47] op_sel:[0,0,0] op_sel_hi:[1,0,1] neg_hi:[0,1,0]
  v_pk_mul_f32 v[46:47], v[222:223], v[40:41] op_sel:[1,1] op_sel_hi:[0,1] neg_lo:[0,1] neg_hi:[0,1]
  v_pk_fma_f32 v[222:223], v[222:223], v[40:41], v[46:47] op_sel:[0,0,0] op_sel_hi:[1,0,1] neg_hi:[0,1,0]
  v_pk_mul_f32 v[46:47], v[224:225], v[40:41] op_sel:[1,1] op_sel_hi:[0,1] neg_lo:[0,1] neg_hi:[0,1]
  v_pk_fma_f32 v[224:225], v[224:225], v[40:41], v[46:47] op_sel:[0,0,0] op_sel_hi:[1,0,1] neg_hi:[0,1,0]
  v_pk_mul_f32 v[46:47], v[226:227], v[40:41] op_sel:[1,1] op_sel_hi:[0,1] neg_lo:[0,1] neg_hi:[0,1]
  v_pk_fma_f32 v[226:227], v[226:227], v[40:41], v[46:47] op_sel:[0,0,0] op_sel_hi:[1,0,1] neg_hi:[0,1,0]
  v_pk_mul_f32 v[46:47], v[228:229], v[40:41] op_sel:[1,1] op_sel_hi:[0,1] neg_lo:[0,1] neg_hi:[0,1]
  v_pk_fma_f32 v[228:229], v[228:229], v[40:41], v[46:47] op_sel:[0,0,0] op_sel_hi:[1,0,1] neg_hi:[0,1,0]
  v_pk_mul_f32 v[46:47], v[230:231], v[40:41] op_sel:[1,1] op_sel_hi:[0,1] neg_lo:[0,1] neg_hi:[0,1]
  v_pk_fma_f32 v[230:231], v[230:231], v[40:41], v[46:47] op_sel:[0,0,0] op_sel_hi:[1,0,1] neg_hi:[0,1,0]
  v_pk_mul_f32 v[46:47], v[232:233], v[40:41] op_sel:[1,1] op_sel_hi:[0,1] neg_lo:[0,1] neg_hi:[0,1]
  v_pk_fma_f32 v[232:233], v[232:233], v[40:41], v[46:47] op_sel:[0,0,0] op_sel_hi:[1,0,1] neg_hi:[0,1,0]
  v_pk_mul_f32 v[46:47], v[234:235], v[40:41] op_sel:[1,1] op_sel_hi:[0,1] neg_lo:[0,1] neg_hi:[0,1]
  v_pk_fma_f32 v[234:235], v[234:235], v[40:41], v[46:47] op_sel:[0,0,0] op_sel_hi:[1,0,1] neg_hi:[0,1,0]
  v_pk_mul_f32 v[46:47], v[236:237], v[40:41] op_sel:[1,1] op_sel_hi:[0,1] neg_lo:[0,1] neg_hi:[0,1]
  v_pk_fma_f32 v[236:237], v[236:237], v[40:41], v[46:47] op_sel:[0,0,0] op_sel_hi:[1,0,1] neg_hi:[0,1,0]
  v_pk_mul_f32 v[46:47], v[238:239], v[40:41] op_sel:[1,1] op_sel_hi:[0,1] neg_lo:[0,1] neg_hi:[0,1]
  v_pk_fma_f32 v[238:239], v[238:239], v[40:41], v[46:47] op_sel:[0,0,0] op_sel_hi:[1,0,1] neg_hi:[0,1,0]
  s_add_u32 s80, s95, 0
  s_add_u32 s81, s95, 3840
  s_add_u32 s82, s95, 7680
skip_22:
  v_mul_f32 v88, v26, v48
  v_mul_f32 v89, v26, v49
  v_mul_f32 v90, v26, v50
  v_mul_f32 v91, v26, v51
  v_mul_f32 v92, v26, v52
  v_mul_f32 v93, v26, v53
  v_mul_f32 v94, v26, v54
  v_mul_f32_e64 v95, v26, v55
  v_fmac_f32_dpp v88, v48, v31 quad_perm:[1,0,3,2] row_mask:0xf bank_mask:0xf
  v_fmac_f32_dpp v89, v49, v31 quad_perm:[1,0,3,2] row_mask:0xf bank_mask:0xf
  v_fmac_f32_dpp v90, v50, v31 quad_perm:[1,0,3,2] row_mask:0xf bank_mask:0xf
  v_fmac_f32_dpp v91, v51, v31 quad_perm:[1,0,3,2] row_mask:0xf bank_mask:0xf
  v_fmac_f32_dpp v92, v52, v31 quad_perm:[1,0,3,2] row_mask:0xf bank_mask:0xf
  v_fmac_f32_dpp v93, v53, v31 quad_perm:[1,0,3,2] row_mask:0xf bank_mask:0xf
  v_fmac_f32_dpp v94, v54, v31 quad_perm:[1,0,3,2] row_mask:0xf bank_mask:0xf
  v_fmac_f32_dpp v95, v55, v31 quad_perm:[1,0,3,2] row_mask:0xf bank_mask:0xf
  v_mul_f32 v96, v27, v56
  v_mul_f32 v97, v27, v57
  v_mul_f32 v98, v27, v58
  v_mul_f32 v99, v27, v59
  v_mul_f32 v100, v27, v60
  v_mul_f32 v101, v27, v61
  v_mul_f32 v102, v27, v62
  v_mul_f32 v103, v27, v63
  v_fmac_f32_dpp v96, v56, v32 quad_perm:[1,0,3,2] row_mask:0xf bank_mask:0xf
  v_fmac_f32_dpp v97, v57, v32 quad_perm:[1,0,3,2] row_mask:0xf bank_mask:0xf
  v_fmac_f32_dpp v98, v58, v32 quad_perm:[1,0,3,2] row_mask:0xf bank_mask:0xf
  v_fmac_f32_dpp v99, v59, v32 quad_perm:[1,0,3,2] row_mask:0xf bank_mask:0xf
  v_fmac_f32_dpp v100, v60, v32 quad_perm:[1,0,3,2] row_mask:0xf bank_mask:0xf
  v_fmac_f32_dpp v101, v61, v32 quad_perm:[1,0,3,2] row_mask:0xf bank_mask:0xf
  v_fmac_f32_dpp v102, v62, v32 quad_perm:[1,0,3,2] row_mask:0xf bank_mask:0xf
  v_fmac_f32_dpp v103, v63, v32 quad_perm:[1,0,3,2] row_mask:0xf bank_mask:0xf
  v_mul_f32 v104, v28, v64
  v_mul_f32 v105, v28, v65
  v_mul_f32 v106, v28, v66
  v_mul_f32 v107, v28, v67
  v_mul_f32 v108, v28, v68
  v_mul_f32 v109, v28, v69
  v_mul_f32 v110, v28, v70
  v_mul_f32 v111, v28, v71
  v_fmac_f32_dpp v104, v64, v33 quad_perm:[1,0,3,2] row_mask:0xf bank_mask:0xf
  v_fmac_f32_dpp v105, v65, v33 quad_perm:[1,0,3,2] row_mask:0xf bank_mask:0xf
  v_fmac_f32_dpp v106, v66, v33 quad_perm:[1,0,3,2] row_mask:0xf bank_mask:0xf
  v_fmac_f32_dpp v107, v67, v33 quad_perm:[1,0,3,2] row_mask:0xf bank_mask:0xf
  v_fmac_f32_dpp v108, v68, v33 quad_perm:[1,0,3,2] row_mask:0xf bank_mask:0xf
  v_fmac_f32_dpp v109, v69, v33 quad_perm:[1,0,3,2] row_mask:0xf bank_mask:0xf
  v_fmac_f32_dpp v110, v70, v33 quad_perm:[1,0,3,2] row_mask:0xf bank_mask:0xf
  v_fmac_f32_dpp v111, v71, v33 quad_perm:[1,0,3,2] row_mask:0xf bank_mask:0xf
  v_mul_f32 v112, v29, v72
  v_mul_f32 v113, v29, v73
  v_mul_f32 v114, v29, v74
  v_mul_f32 v115, v29, v75
  v_mul_f32 v116, v29, v76
  v_mul_f32 v117, v29, v77
  v_mul_f32 v118, v29, v78
  v_mul_f32 v119, v29, v79
  v_fmac_f32_dpp v112, v72, v34 quad_perm:[1,0,3,2] row_mask:0xf bank_mask:0xf
  v_fmac_f32_dpp v113, v73, v34 quad_perm:[1,0,3,2] row_mask:0xf bank_mask:0xf
  v_fmac_f32_dpp v114, v74, v34 quad_perm:[1,0,3,2] row_mask:0xf bank_mask:0xf
  v_fmac_f32_dpp v115, v75, v34 quad_perm:[1,0,3,2] row_mask:0xf bank_mask:0xf
  v_fmac_f32_dpp v116, v76, v34 quad_perm:[1,0,3,2] row_mask:0xf bank_mask:0xf
  v_fmac_f32_dpp v117, v77, v34 quad_perm:[1,0,3,2] row_mask:0xf bank_mask:0xf
  v_fmac_f32_dpp v118, v78, v34 quad_perm:[1,0,3,2] row_mask:0xf bank_mask:0xf
  v_fmac_f32_dpp v119, v79, v34 quad_perm:[1,0,3,2] row_mask:0xf bank_mask:0xf
  v_mul_f32 v120, v30, v80
  v_mul_f32 v121, v30, v81
  v_mul_f32 v122, v30, v82
  v_mul_f32 v123, v30, v83
  v_mul_f32 v124, v30, v84
  v_mul_f32 v125, v30, v85
  v_mul_f32 v126, v30, v86
  v_mul_f32 v127, v30, v87
  v_fmac_f32_dpp v120, v80, v35 quad_perm:[1,0,3,2] row_mask:0xf bank_mask:0xf
  v_fmac_f32_dpp v121, v81, v35 quad_perm:[1,0,3,2] row_mask:0xf bank_mask:0xf
  v_fmac_f32_dpp v122, v82, v35 quad_perm:[1,0,3,2] row_mask:0xf bank_mask:0xf
  v_fmac_f32_dpp v123, v83, v35 quad_perm:[1,0,3,2] row_mask:0xf bank_mask:0xf
  v_fmac_f32_dpp v124, v84, v35 quad_perm:[1,0,3,2] row_mask:0xf bank_mask:0xf
  v_fmac_f32_dpp v125, v85, v35 quad_perm:[1,0,3,2] row_mask:0xf bank_mask:0xf
  v_fmac_f32_dpp v126, v86, v35 quad_perm:[1,0,3,2] row_mask:0xf bank_mask:0xf
  v_fmac_f32_dpp v127, v87, v35 quad_perm:[1,0,3,2] row_mask:0xf bank_mask:0xf
  s_mul_i32 s18, s6, 200
  s_mul_i32 s12, s7, 50
  s_add_u32 s18, s18, s12
  s_lshl_b32 s18, s18, 10
  s_add_u32 s18, s18, 23068672
  s_waitcnt vmcnt(1)
  v_xor_b32 v15, s8, v204
  v_xor_b32 v14, s8, v205
  v_or_b32 v15, v15, v14
  v_xor_b32 v14, s8, v206
  v_or_b32 v15, v15, v14
  v_xor_b32 v14, s8, v207
  v_or_b32 v15, v15, v14
  v_cmp_ne_u32 vcc, 0, v15
  s_cbranch_vccnz again_23
ok_24:
  buffer_load_dwordx4 a[0:3], v2, s[52:55], s18 offen offset:0 sc1
  buffer_load_dwordx4 a[4:7], v2, s[52:55], s18 offen offset:1024 sc1
  buffer_load_dwordx4 a[8:11], v2, s[52:55], s18 offen offset:2048 sc1
  buffer_load_dwordx4 a[12:15], v2, s[52:55], s18 offen offset:3072 sc1
  s_add_u32 s18, s18, 4096
  buffer_load_dwordx4 a[16:19], v2, s[52:55], s18 offen offset:0 sc1
  buffer_load_dwordx4 a[20:23], v2, s[52:55], s18 offen offset:1024 sc1
  buffer_load_dwordx4 a[24:27], v2, s[52:55], s18 offen offset:2048 sc1
  buffer_load_dwordx4 a[28:31], v2, s[52:55], s18 offen offset:3072 sc1
  s_add_u32 s18, s18, 4096
  buffer_load_dwordx4 a[32:35], v2, s[52:55], s18 offen offset:0 sc1
  buffer_load_dwordx4 a[36:39], v2, s[52:55], s18 offen offset:1024 sc1
  v_accvgpr_read_b32 v252, a208
  v_accvgpr_read_b32 v253, a209
  v_accvgpr_read_b32 v254, a210
  v_accvgpr_read_b32 v255, a211
  v_min_u32 v251, 39, v1
  v_mul_u32_u24 v247, 144, v251
  v_add_u32 v247, 158080, v247
  v_lshlrev_b32_e64 v251, 4, v251
  s_and_b32 s22, s72, 0xffff
  s_lshl_b32 s23, s72, 16
  s_lshr_b32 s24, s72, 16
  s_and_b32 s25, s72, 0xffff0000
  s_cmp_eq_u32 s7, 2
  s_cbranch_scc1 skip_25
  s_min_u32 s12, s7, 2
  s_mul_i32 s12, s12, 16640
  s_add_u32 s12, s12, 102400
  v_add_u32 v11, s12, v2
  s_waitcnt vmcnt(14)
  v_mov_b32_dpp v142, v192 wave_shl:1 row_mask:0xf bank_mask:0xf
  v_mov_b32_dpp v143, v193 wave_shl:1 row_mask:0xf bank_mask:0xf
  v_mov_b32 v140, v194
  v_mov_b32_e64 v141, v195
  v_alignbit_b32 v128, v193, v192, 16
  v_alignbit_b32 v129, v194, v193, 16
  v_alignbit_b32 v130, v195, v194, 16
  v_alignbit_b32 v131, v142, v195, 16
  v_mov_b32 v132, v193
  v_mov_b32 v133, v194
  v_mov_b32 v134, v195
  v_mov_b32 v135, v142
  v_alignbit_b32 v136, v194, v193, 16
  v_alignbit_b32 v137, v195, v194, 16
  v_alignbit_b32 v138, v142, v195, 16
  v_alignbit_b32 v139, v143, v142, 16
  s_mov_b32 exec_hi, 0x7fffffff
  ds_write_b128 v11, v[128:131] offset:0
  ds_write_b128 v11, v[132:135] offset:4160
  ds_write_b128 v11, v[136:139] offset:8320
  ds_write_b128 v11, v[140:143] offset:12480
  s_mov_b64 exec, -1
  s_waitcnt vmcnt(13)
  v_mov_b32_dpp v158, v196 wave_shl:1 row_mask:0xf bank_mask:0xf
  v_mov_b32_dpp v159, v197 wave_shl:1 row_mask:0xf bank_mask:0xf
  v_mov_b32 v156, v198
  v_mov_b32 v157, v199
  v_alignbit_b32 v144, v197, v196, 16
  v_alignbit_b32 v145, v198, v197, 16
  v_alignbit_b32 v146, v199, v198, 16
  v_alignbit_b32 v147, v158, v199, 16
  v_mov_b32 v148, v197
  v_mov_b32 v149, v198
  v_mov_b32 v150, v199
  v_mov_b32 v151, v158
  v_alignbit_b32 v152, v198, v197, 16
  v_alignbit_b32 v153, v199, v198, 16
  v_alignbit_b32 v154, v158, v199, 16
  v_alignbit_b32 v155, v159, v158, 16
  s_mov_b32 exec_hi, 0x7fffffff
  ds_write_b128 v11, v[144:147] offset:1008
  ds_write_b128 v11, v[148:151] offset:5168
  ds_write_b128 v11, v[152:155] offset:9328
  ds_write_b128 v11, v[156:159] offset:13488
  s_mov_b64 exec, -1
  s_waitcnt vmcnt(12)
  v_mov_b32_dpp v142, v200 wave_shl:1 row_mask:0xf bank_mask:0xf
  v_mov_b32_dpp v143, v201 wave_shl:1 row_mask:0xf bank_mask:0xf
  v_mov_b32 v140, v202
  v_mov_b32 v141, v203
  v_alignbit_b32 v128, v201, v200, 16
  v_alignbit_b32 v129, v202, v201, 16
  v_alignbit_b32 v130, v203, v202, 16
  v_alignbit_b32 v131, v142, v203, 16
  v_mov_b32 v132, v201
  v_mov_b32 v133, v202
  v_mov_b32 v134, v203
  v_mov_b32 v135, v142
  v_alignbit_b32 v136, v202, v201, 16
  v_alignbit_b32 v137, v203, v202, 16
  v_alignbit_b32 v138, v142, v203, 16
  v_alignbit_b32 v139, v143, v142, 16
  s_mov_b32 exec_hi, 0x7fffffff
  ds_write_b128 v11, v[128:131] offset:2016
  ds_write_b128 v11, v[132:135] offset:6176
  ds_write_b128 v11, v[136:139] offset:10336
  ds_write_b128 v11, v[140:143] offset:14496
  s_mov_b64 exec, -1
  s_waitcnt vmcnt(11)
  v_mov_b32_dpp v158, v164 wave_shl:1 row_mask:0xf bank_mask:0xf
  v_mov_b32_dpp v159, v165 wave_shl:1 row_mask:0xf bank_mask:0xf
  v_mov_b32 v156, v166
  v_mov_b32 v157, v167
  v_alignbit_b32 v144, v165, v164, 16
  v_alignbit_b32 v145, v166, v165, 16
  v_alignbit_b32 v146, v167, v166, 16
  v_alignbit_b32 v147, v158, v167, 16
  v_mov_b32 v148, v165
  v_mov_b32 v149, v166
  v_mov_b32 v150, v167
  v_mov_b32 v151, v158
  v_alignbit_b32 v152, v166, v165, 16
  v_alignbit_b32 v153, v167, v166, 16
  v_alignbit_b32 v154, v158, v167, 16
  v_alignbit_b32 v155, v159, v158, 16
  s_mov_b32 exec_hi, 0x7fffffff
  ds_write_b128 v11, v[144:147] offset:3024
  ds_write_b128 v11, v[148:151] offset:7184
  ds_write_b128 v11, v[152:155] offset:11344
  ds_write_b128 v11, v[156:159] offset:15504
  s_mov_b64 exec, -1
  s_waitcnt vmcnt(10)
  v_mov_b32_dpp v142, v240 wave_shl:1 row_mask:0xf bank_mask:0xf
  v_mov_b32_dpp v143, v241 wave_shl:1 row_mask:0xf bank_mask:0xf
  v_mov_b32 v140, v242
  v_mov_b32 v141, v243
  v_alignbit_b32 v128, v241, v240, 16
  v_alignbit_b32 v129, v242, v241, 16
  v_alignbit_b32 v130, v243, v242, 16
  v_alignbit_b32 v131, v142, v243, 16
  v_mov_b32 v132, v241
  v_mov_b32 v133, v242
  v_mov_b32 v134, v243
  v_mov_b32 v135, v142
  v_alignbit_b32 v136, v242, v241, 16
  v_alignbit_b32 v137, v243, v242, 16
  v_alignbit_b32 v138, v142, v243, 16
  v_alignbit_b32 v139, v143, v142, 16
  s_mov_b64 exec, 0xff
  ds_write_b128 v11, v[128:131] offset:4032
  ds_write_b128 v11, v[132:135] offset:8192
  ds_write_b128 v11, v[136:139] offset:12352
  ds_write_b128 v11, v[140:143] offset:16512
  s_mov_b64 exec, -1
skip_25:
  s_waitcnt vmcnt(11) lgkmcnt(0)
  s_barrier
  ds_read_b64 v[128:129], v252 offset:0
  ds_read_b64 v[130:131], v252 offset:8
  ds_read_b128 v[144:147], v254 offset:4608
  ds_read_b128 v[148:151], v254 offset:3072
  ds_read_b128 v[152:155], v254 offset:1536
  ds_read_b128 v[156:159], v254 offset:0
  ds_read_b64 v[132:133], v252 offset:1024
  ds_read_b64 v[134:135], v252 offset:1032
  ds_read_b64 v[136:137], v252 offset:2048
  ds_read_b64 v[138:139], v252 offset:2056
  ds_read_b64 v[140:141], v252 offset:3072
  ds_read_b64 v[142:143], v252 offset:3080
  s_waitcnt lgkmcnt(9)
  v_mfma_f32_16x16x32_bf16 v[192:195], v[128:131], v[144:147], 0
  ds_read_b64 v[160:161], v252 offset:64
  ds_read_b64 v[162:163], v252 offset:72
  s_waitcnt lgkmcnt(10)
  v_mfma_f32_16x16x32_bf16 v[196:199], v[128:131], v[148:151], 0
  ds_read_b128 v[176:179], v254 offset:4704
  ds_read_b128 v[180:183], v254 offset:3168
  s_waitcnt lgkmcnt(11)
  v_mfma_f32_16x16x32_bf16 v[200:203], v[128:131], v[152:155], 0
  ds_read_b128 v[184:187], v254 offset:1632
  ds_read_b128 v[188:191], v254 offset:96
  s_waitcnt lgkmcnt(12)
  v_mfma_f32_16x16x32_bf16 v[204:207], v[128:131], v[156:159], 0
  ds_read_b64 v[164:165], v252 offset:1088
  ds_read_b64 v[166:167], v252 offset:1096
  s_waitcnt lgkmcnt(12)
  v_mfma_f32_16x16x32_bf16 v[196:199], v[132:135], v[144:147], v[196:199]
  ds_read_b64 v[168:169], v252 offset:2112
  ds_read_b64 v[170:171], v252 offset:2120
  v_mfma_f32_16x16x32_bf16 v[200:203], v[132:135], v[148:151], v[200:203]
  ds_read_b64 v[172:173], v252 offset:3136
  ds_read_b64 v[174:175], v252 offset:3144
  v_mfma_f32_16x16x32_bf16 v[204:207], v[132:135], v[152:155], v[204:207]
  buffer_load_dwordx4 a[40:43], v2, s[52:55], s18 offen offset:2048 sc1
  s_waitcnt lgkmcnt(14)
  v_mfma_f32_16x16x32_bf16 v[200:203], v[136:139], v[144:147], v[200:203]
  buffer_load_dwordx4 a[44:47], v2, s[52:55], s18 offen offset:3072 sc1
  v_mfma_f32_16x16x32_bf16 v[204:207], v[136:139], v[148:151], v[204:207]
  s_add_u32 s18, s18, 4096
  buffer_load_dwordx4 a[48:51], v2, s[52:55], s18 offen offset:0 sc1
  s_waitcnt lgkmcnt(12)
  v_mfma_f32_16x16x32_bf16 v[204:207], v[140:143], v[144:147], v[204:207]
  s_waitcnt lgkmcnt(4)
  v_mfma_f32_16x16x32_bf16 v[192:195], v[160:163], v[176:179], v[192:195]
  ds_read_b64 v[128:129], v252 offset:128
  ds_read_b64 v[130:131], v252 offset:136
  v_mfma_f32_16x16x32_bf16 v[196:199], v[160:163], v[180:183], v[196:199]
  ds_read_b128 v[144:147], v254 offset:4800
  ds_read_b128 v[148:151], v254 offset:3264
  v_mfma_f32_16x16x32_bf16 v[200:203], v[160:163], v[184:187], v[200:203]
  ds_read_b128 v[152:155], v254 offset:1728
  ds_read_b128 v[156:159], v254 offset:192
  v_mfma_f32_16x16x32_bf16 v[204:207], v[160:163], v[188:191], v[204:207]
  ds_read_b64 v[132:133], v252 offset:1152
  ds_read_b64 v[134:135], v252 offset:1160
  v_mfma_f32_16x16x32_bf16 v[196:199], v[164:167], v[176:179], v[196:199]
  ds_read_b64 v[136:137], v252 offset:2176
  ds_read_b64 v[138:139], v252 offset:2184
  v_mfma_f32_16x16x32_bf16 v[200:203], v[164:167], v[180:183], v[200:203]
  ds_read_b64 v[140:141], v252 offset:3200
  ds_read_b64 v[142:143], v252 offset:3208
  v_mfma_f32_16x16x32_bf16 v[204:207], v[164:167], v[184:187], v[204:207]
  buffer_load_dwordx4 a[52:55], v2, s[52:55], s18 offen offset:1024 sc1
  s_waitcnt lgkmcnt(12)
  v_mfma_f32_16x16x32_bf16 v[200:203], v[168:171], v[176:179], v[200:203]
  buffer_load_dwordx4 a[56:59], v2, s[52:55], s18 offen offset:2048 sc1
  v_mfma_f32_16x16x32_bf16 v[204:207], v[168:171], v[180:183], v[204:207]
  v_mfma_f32_16x16x32_bf16 v[204:207], v[172:175], v[176:179], v[204:207]
  s_waitcnt lgkmcnt(4)
  v_mfma_f32_16x16x32_bf16 v[192:195], v[128:131], v[144:147], v[192:195]
  ds_read_b64 v[160:161], v252 offset:192
  ds_read_b64 v[162:163], v252 offset:200
  v_mfma_f32_16x16x32_bf16 v[196:199], v[128:131], v[148:151], v[196:199]
  ds_read_b128 v[176:179], v254 offset:4896
  ds_read_b128 v[180:183], v254 offset:3360
  v_mfma_f32_16x16x32_bf16 v[200:203], v[128:131], v[152:155], v[200:203]
  ds_read_b128 v[184:187], v254 offset:1824
  ds_read_b128 v[188:191], v254 offset:288
  v_mfma_f32_16x16x32_bf16 v[204:207], v[128:131], v[156:159], v[204:207]
  ds_read_b64 v[164:165], v252 offset:1216
  ds_read_b64 v[166:167], v252 offset:1224
  v_mfma_f32_16x16x32_bf16 v[196:199], v[132:135], v[144:147], v[196:199]
  ds_read_b64 v[168:169], v252 offset:2240
  ds_read_b64 v[170:171], v252 offset:2248
  v_mfma_f32_16x16x32_bf16 v[200:203], v[132:135], v[148:151], v[200:203]
  ds_read_b64 v[172:173], v252 offset:3264
  ds_read_b64 v[174:175], v252 offset:3272
  v_mfma_f32_16x16x32_bf16 v[204:207], v[132:135], v[152:155], v[204:207]
  s_mul_i32 s14, s6, 160
  v_lshl_add_u32 v11, v4, 3, s14
  s_waitcnt lgkmcnt(12)
  v_mfma_f32_16x16x32_bf16 v[200:203], v[136:139], v[144:147], v[200:203]
  s_lshl_b32 s12, s5, 10
  s_lshr_b32 s13, s7, 1
  v_mfma_f32_16x16x32_bf16 v[204:207], v[136:139], v[148:151], v[204:207]
  buffer_load_dwordx4 a[60:63], v2, s[52:55], s18 offen offset:3072 sc1
  v_mfma_f32_16x16x32_bf16 v[204:207], v[140:143], v[144:147], v[204:207]
  s_add_u32 s18, s18, 4096
  buffer_load_dwordx4 a[64:67], v2, s[52:55], s18 offen offset:0 sc1
  s_waitcnt lgkmcnt(4)
  v_mfma_f32_16x16x32_bf16 v[192:195], v[160:163], v[176:179], v[192:195]
  ds_read_b64 v[128:129], v252 offset:256
  ds_read_b64 v[130:131], v252 offset:264
  v_mfma_f32_16x16x32_bf16 v[196:199], v[160:163], v[180:183], v[196:199]
  ds_read_b128 v[144:147], v254 offset:4992
  ds_read_b128 v[148:151], v254 offset:3456
  v_mfma_f32_16x16x32_bf16 v[200:203], v[160:163], v[184:187], v[200:203]
  ds_read_b128 v[152:155], v254 offset:1920
  ds_read_b128 v[156:159], v254 offset:384
  v_mfma_f32_16x16x32_bf16 v[204:207], v[160:163], v[188:191], v[204:207]
  ds_read_b64 v[132:133], v252 offset:1280
  ds_read_b64 v[134:135], v252 offset:1288
  v_mfma_f32_16x16x32_bf16 v[196:199], v[164:167], v[176:179], v[196:199]
  ds_read_b64 v[136:137], v252 offset:2304
  ds_read_b64 v[138:139], v252 offset:2312
  v_mfma_f32_16x16x32_bf16 v[200:203], v[164:167], v[180:183], v[200:203]
  ds_read_b64 v[140:141], v252 offset:3328
  ds_read_b64 v[142:143], v252 offset:3336
  v_mfma_f32_16x16x32_bf16 v[204:207], v[164:167], v[184:187], v[204:207]
  s_lshl_b32 s13, s13, 9
  s_add_u32 s12, s12, s13
  s_waitcnt lgkmcnt(12)
  v_mfma_f32_16x16x32_bf16 v[200:203], v[168:171], v[176:179], v[200:203]
  s_and_b32 s13, s7, 1
  s_lshl_b32 s13, s13, 6
  v_mfma_f32_16x16x32_bf16 v[204:207], v[168:171], v[180:183], v[204:207]
  buffer_load_dwordx4 a[68:71], v2, s[52:55], s18 offen offset:1024 sc1
  v_mfma_f32_16x16x32_bf16 v[204:207], v[172:175], v[176:179], v[204:207]
  buffer_load_dwordx4 a[72:75], v2, s[52:55], s18 offen offset:2048 sc1
  s_waitcnt lgkmcnt(4)
  v_mfma_f32_16x16x32_bf16 v[192:195], v[128:131], v[144:147], v[192:195]
  ds_read_b64 v[160:161], v252 offset:320
  ds_read_b64 v[162:163], v252 offset:328
  v_mfma_f32_16x16x32_bf16 v[196:199], v[128:131], v[148:151], v[196:199]
  ds_read_b128 v[176:179], v254 offset:5088
  ds_read_b128 v[180:183], v254 offset:3552
  v_mfma_f32_16x16x32_bf16 v[200:203], v[128:131], v[152:155], v[200:203]
  ds_read_b128 v[184:187], v254 offset:2016
  ds_read_b128 v[188:191], v254 offset:480
  v_mfma_f32_16x16x32_bf16 v[204:207], v[128:131], v[156:159], v[204:207]
  ds_read_b64 v[164:165], v252 offset:1344
  ds_read_b64 v[166:167], v252 offset:1352
  v_mfma_f32_16x16x32_bf16 v[196:199], v[132:135], v[144:147], v[196:199]
  ds_read_b64 v[168:169], v252 offset:2368
  ds_read_b64 v[170:171], v252 offset:2376
  v_mfma_f32_16x16x32_bf16 v[200:203], v[132:135], v[148:151], v[200:203]
  ds_read_b64 v[172:173], v252 offset:3392
  ds_read_b64 v[174:175], v252 offset:3400
  v_mfma_f32_16x16x32_bf16 v[204:207], v[132:135], v[152:155], v[204:207]
  s_add_u32 s12, s12, s13
  s_add_u32 s12, s12, 262144
  s_waitcnt lgkmcnt(12)
  v_mfma_f32_16x16x32_bf16 v[200:203], v[136:139], v[144:147], v[200:203]
  v_lshrrev_b32 v12, 2, v3
  v_lshlrev_b32_e64 v12, 7, v12
  v_mfma_f32_16x16x32_bf16 v[204:207], v[136:139], v[148:151], v[204:207]
  buffer_load_dwordx4 a[76:79], v2, s[52:55], s18 offen offset:3072 sc1
  v_mfma_f32_16x16x32_bf16 v[204:207], v[140:143], v[144:147], v[204:207]
  s_add_u32 s18, s18, 4096
  buffer_load_dwordx4 a[80:83], v2, s[52:55], s18 offen offset:0 sc1
  s_waitcnt lgkmcnt(4)
  v_mfma_f32_16x16x32_bf16 v[192:195], v[160:163], v[176:179], v[192:195]
  ds_read_b64 v[128:129], v252 offset:384
  ds_read_b64 v[130:131], v252 offset:392
  v_mfma_f32_16x16x32_bf16 v[196:199], v[160:163], v[180:183], v[196:199]
  ds_read_b128 v[144:147], v254 offset:5184
  ds_read_b128 v[148:151], v254 offset:3648
  v_mfma_f32_16x16x32_bf16 v[200:203], v[160:163], v[184:187], v[200:203]
  ds_read_b128 v[152:155], v254 offset:2112
  ds_read_b128 v[156:159], v254 offset:576
  v_mfma_f32_16x16x32_bf16 v[204:207], v[160:163], v[188:191], v[204:207]
  ds_read_b64 v[132:133], v252 offset:1408
  ds_read_b64 v[134:135], v252 offset:1416
  v_mfma_f32_16x16x32_bf16 v[196:199], v[164:167], v[176:179], v[196:199]
  ds_read_b64 v[136:137], v252 offset:2432
  ds_read_b64 v[138:139], v252 offset:2440
  v_mfma_f32_16x16x32_bf16 v[200:203], v[164:167], v[180:183], v[200:203]
  ds_read_b64 v[140:141], v252 offset:3456
  ds_read_b64 v[142:143], v252 offset:3464
  v_mfma_f32_16x16x32_bf16 v[204:207], v[164:167], v[184:187], v[204:207]
  v_and_b32 v13, 3, v3
  v_lshl_add_u32 v12, v13, 4, v12
  s_waitcnt lgkmcnt(12)
  v_mfma_f32_16x16x32_bf16 v[200:203], v[168:171], v[176:179], v[200:203]
  buffer_load_dwordx2 a[230:231], v12, s[52:55], s12 offen sc1
  global_load_dwordx2 a[240:241], v11, s[32:33] offset:0
  v_mfma_f32_16x16x32_bf16 v[204:207], v[168:171], v[180:183], v[204:207]
  buffer_load_dwordx4 a[84:87], v2, s[52:55], s18 offen offset:1024 sc1
  v_mfma_f32_16x16x32_bf16 v[204:207], v[172:175], v[176:179], v[204:207]
  buffer_load_dwordx4 a[88:91], v2, s[52:55], s18 offen offset:2048 sc1
  s_waitcnt lgkmcnt(4)
  v_mfma_f32_16x16x32_bf16 v[192:195], v[128:131], v[144:147], v[192:195]
  ds_read_b64 v[160:161], v252 offset:448
  ds_read_b64 v[162:163], v252 offset:456
  v_mfma_f32_16x16x32_bf16 v[196:199], v[128:131], v[148:151], v[196:199]
  ds_read_b128 v[176:179], v254 offset:5280
  ds_read_b128 v[180:183], v254 offset:3744
  v_mfma_f32_16x16x32_bf16 v[200:203], v[128:131], v[152:155], v[200:203]
  ds_read_b128 v[184:187], v254 offset:2208
  ds_read_b128 v[188:191], v254 offset:672
  v_mfma_f32_16x16x32_bf16 v[204:207], v[128:131], v[156:159], v[204:207]
  ds_read_b64 v[164:165], v252 offset:1472
  ds_read_b64 v[166:167], v252 offset:1480
  v_mfma_f32_16x16x32_bf16 v[196:199], v[132:135], v[144:147], v[196:199]
  ds_read_b64 v[168:169], v252 offset:2496
  ds_read_b64 v[170:171], v252 offset:2504
  v_mfma_f32_16x16x32_bf16 v[200:203], v[132:135], v[148:151], v[200:203]
  ds_read_b64 v[172:173], v252 offset:3520
  ds_read_b64 v[174:175], v252 offset:3528
  v_mfma_f32_16x16x32_bf16 v[204:207], v[132:135], v[152:155], v[204:207]
  global_load_dwordx2 a[242:243], v11, s[32:33] offset:32
  global_load_dwordx2 a[244:245], v11, s[32:33] offset:64
  s_waitcnt lgkmcnt(12)
  v_mfma_f32_16x16x32_bf16 v[200:203], v[136:139], v[144:147], v[200:203]
  global_load_dwordx2 a[246:247], v11, s[32:33] offset:96
  global_load_dwordx2 a[248:249], v11, s[32:33] offset:128
  v_mfma_f32_16x16x32_bf16 v[204:207], v[136:139], v[148:151], v[204:207]
  buffer_load_dwordx4 a[92:95], v2, s[52:55], s18 offen offset:3072 sc1
  v_mfma_f32_16x16x32_bf16 v[204:207], v[140:143], v[144:147], v[204:207]
  s_add_u32 s18, s18, 4096
  buffer_load_dwordx4 a[96:99], v2, s[52:55], s18 offen offset:0 sc1
  s_waitcnt lgkmcnt(4)
  v_mfma_f32_16x16x32_bf16 v[192:195], v[160:163], v[176:179], v[192:195]
  ds_read_b64 v[128:129], v252 offset:512
  ds_read_b64 v[130:131], v252 offset:520
  v_mfma_f32_16x16x32_bf16 v[196:199], v[160:163], v[180:183], v[196:199]
  ds_read_b128 v[144:147], v254 offset:5376
  ds_read_b128 v[148:151], v254 offset:3840
  v_mfma_f32_16x16x32_bf16 v[200:203], v[160:163], v[184:187], v[200:203]
  ds_read_b128 v[152:155], v254 offset:2304
  ds_read_b128 v[156:159], v254 offset:768
  v_mfma_f32_16x16x32_bf16 v[204:207], v[160:163], v[188:191], v[204:207]
  ds_read_b64 v[132:133], v252 offset:1536
  ds_read_b64 v[134:135], v252 offset:1544
  v_mfma_f32_16x16x32_bf16 v[196:199], v[164:167], v[176:179], v[196:199]
  ds_read_b64 v[136:137], v252 offset:2560
  ds_read_b64 v[138:139], v252 offset:2568
  v_mfma_f32_16x16x32_bf16 v[200:203], v[164:167], v[180:183], v[200:203]
  ds_read_b64 v[140:141], v252 offset:3584
  ds_read_b64 v[142:143], v252 offset:3592
  v_mfma_f32_16x16x32_bf16 v[204:207], v[164:167], v[184:187], v[204:207]
  buffer_load_dwordx4 a[100:103], v2, s[52:55], s18 offen offset:1024 sc1
  s_waitcnt lgkmcnt(12)
  v_mfma_f32_16x16x32_bf16 v[200:203], v[168:171], v[176:179], v[200:203]
  buffer_load_dwordx4 a[104:107], v2, s[52:55], s18 offen offset:2048 sc1
  v_mfma_f32_16x16x32_bf16 v[204:207], v[168:171], v[180:183], v[204:207]
  v_mfma_f32_16x16x32_bf16 v[204:207], v[172:175], v[176:179], v[204:207]
  s_waitcnt lgkmcnt(4)
  v_mfma_f32_16x16x32_bf16 v[192:195], v[128:131], v[144:147], v[192:195]
  ds_read_b64 v[160:161], v252 offset:576
  ds_read_b64 v[162:163], v252 offset:584
  v_mfma_f32_16x16x32_bf16 v[196:199], v[128:131], v[148:151], v[196:199]
  ds_read_b128 v[176:179], v254 offset:5472
  ds_read_b128 v[180:183], v254 offset:3936
  v_mfma_f32_16x16x32_bf16 v[200:203], v[128:131], v[152:155], v[200:203]
  ds_read_b128 v[184:187], v254 offset:2400
  ds_read_b128 v[188:191], v254 offset:864
  v_mfma_f32_16x16x32_bf16 v[204:207], v[128:131], v[156:159], v[204:207]
  ds_read_b64 v[164:165], v252 offset:1600
  ds_read_b64 v[166:167], v252 offset:1608
  v_mfma_f32_16x16x32_bf16 v[196:199], v[132:135], v[144:147], v[196:199]
  ds_read_b64 v[168:169], v252 offset:2624
  ds_read_b64 v[170:171], v252 offset:2632
  v_mfma_f32_16x16x32_bf16 v[200:203], v[132:135], v[148:151], v[200:203]
  ds_read_b64 v[172:173], v252 offset:3648
  ds_read_b64 v[174:175], v252 offset:3656
  v_mfma_f32_16x16x32_bf16 v[204:207], v[132:135], v[152:155], v[204:207]
  buffer_load_dwordx4 a[108:111], v2, s[52:55], s18 offen offset:3072 sc1
  s_waitcnt lgkmcnt(12)
  v_mfma_f32_16x16x32_bf16 v[200:203], v[136:139], v[144:147], v[200:203]
  s_add_u32 s18, s18, 4096
  buffer_load_dwordx4 a[112:115], v2, s[52:55], s18 offen offset:0 sc1
  v_mfma_f32_16x16x32_bf16 v[204:207], v[136:139], v[148:151], v[204:207]
  v_mfma_f32_16x16x32_bf16 v[204:207], v[140:143], v[144:147], v[204:207]
  s_waitcnt lgkmcnt(4)
  v_mfma_f32_16x16x32_bf16 v[192:195], v[160:163], v[176:179], v[192:195]
  ds_read_b64 v[128:129], v252 offset:640
  ds_read_b64 v[130:131], v252 offset:648
  v_mfma_f32_16x16x32_bf16 v[196:199], v[160:163], v[180:183], v[196:199]
  ds_read_b128 v[144:147], v254 offset:5568
  ds_read_b128 v[148:151], v254 offset:4032
  v_mfma_f32_16x16x32_bf16 v[200:203], v[160:163], v[184:187], v[200:203]
  ds_read_b128 v[152:155], v254 offset:2496
  ds_read_b128 v[156:159], v254 offset:960
  v_mfma_f32_16x16x32_bf16 v[204:207], v[160:163], v[188:191], v[204:207]
  ds_read_b64 v[132:133], v252 offset:1664
  ds_read_b64 v[134:135], v252 offset:1672
  v_mfma_f32_16x16x32_bf16 v[196:199], v[164:167], v[176:179], v[196:199]
  ds_read_b64 v[136:137], v252 offset:2688
  ds_read_b64 v[138:139], v252 offset:2696
  v_mfma_f32_16x16x32_bf16 v[200:203], v[164:167], v[180:183], v[200:203]
  ds_read_b64 v[140:141], v252 offset:3712
  ds_read_b64 v[142:143], v252 offset:3720
  v_mfma_f32_16x16x32_bf16 v[204:207], v[164:167], v[184:187], v[204:207]
  buffer_load_dwordx4 a[116:119], v2, s[52:55], s18 offen offset:1024 sc1
  s_waitcnt lgkmcnt(12)
  v_mfma_f32_16x16x32_bf16 v[200:203], v[168:171], v[176:179], v[200:203]
  buffer_load_dwordx4 a[120:123], v2, s[52:55], s18 offen offset:2048 sc1
  v_mfma_f32_16x16x32_bf16 v[204:207], v[168:171], v[180:183], v[204:207]
  buffer_load_dwordx4 a[124:127], v2, s[52:55], s18 offen offset:3072 sc1
  v_mfma_f32_16x16x32_bf16 v[204:207], v[172:175], v[176:179], v[204:207]
  s_waitcnt lgkmcnt(4)
  v_mfma_f32_16x16x32_bf16 v[192:195], v[128:131], v[144:147], v[192:195]
  ds_read_b64 v[160:161], v252 offset:704
  ds_read_b64 v[162:163], v252 offset:712
  v_mfma_f32_16x16x32_bf16 v[196:199], v[128:131], v[148:151], v[196:199]
  ds_read_b128 v[176:179], v254 offset:5664
  ds_read_b128 v[180:183], v254 offset:4128
  v_mfma_f32_16x16x32_bf16 v[200:203], v[128:131], v[152:155], v[200:203]
  ds_read_b128 v[184:187], v254 offset:2592
  ds_read_b128 v[188:191], v254 offset:1056
  v_mfma_f32_16x16x32_bf16 v[204:207], v[128:131], v[156:159], v[204:207]
  ds_read_b64 v[164:165], v252 offset:1728
  ds_read_b64 v[166:167], v252 offset:1736
  v_mfma_f32_16x16x32_bf16 v[196:199], v[132:135], v[144:147], v[196:199]
  ds_read_b64 v[168:169], v252 offset:2752
  ds_read_b64 v[170:171], v252 offset:2760
  v_mfma_f32_16x16x32_bf16 v[200:203], v[132:135], v[148:151], v[200:203]
  ds_read_b64 v[172:173], v252 offset:3776
  ds_read_b64 v[174:175], v252 offset:3784
  v_mfma_f32_16x16x32_bf16 v[204:207], v[132:135], v[152:155], v[204:207]
  s_add_u32 s18, s18, 4096
  buffer_load_dwordx4 a[128:131], v2, s[52:55], s18 offen offset:0 sc1
  s_waitcnt lgkmcnt(12)
  v_mfma_f32_16x16x32_bf16 v[200:203], v[136:139], v[144:147], v[200:203]
  buffer_load_dwordx4 a[132:135], v2, s[52:55], s18 offen offset:1024 sc1
  v_mfma_f32_16x16x32_bf16 v[204:207], v[136:139], v[148:151], v[204:207]
  v_mfma_f32_16x16x32_bf16 v[204:207], v[140:143], v[144:147], v[204:207]
  s_waitcnt lgkmcnt(4)
  v_mfma_f32_16x16x32_bf16 v[192:195], v[160:163], v[176:179], v[192:195]
  ds_read_b64 v[128:129], v252 offset:768
  ds_read_b64 v[130:131], v252 offset:776
  v_mfma_f32_16x16x32_bf16 v[196:199], v[160:163], v[180:183], v[196:199]
  ds_read_b128 v[144:147], v254 offset:5760
  ds_read_b128 v[148:151], v254 offset:4224
  v_mfma_f32_16x16x32_bf16 v[200:203], v[160:163], v[184:187], v[200:203]
  ds_read_b128 v[152:155], v254 offset:2688
  ds_read_b128 v[156:159], v254 offset:1152
  v_mfma_f32_16x16x32_bf16 v[204:207], v[160:163], v[188:191], v[204:207]
  ds_read_b64 v[132:133], v252 offset:1792
  ds_read_b64 v[134:135], v252 offset:1800
  v_mfma_f32_16x16x32_bf16 v[196:199], v[164:167], v[176:179], v[196:199]
  ds_read_b64 v[136:137], v252 offset:2816
  ds_read_b64 v[138:139], v252 offset:2824
  v_mfma_f32_16x16x32_bf16 v[200:203], v[164:167], v[180:183], v[200:203]
  ds_read_b64 v[140:141], v252 offset:3840
  ds_read_b64 v[142:143], v252 offset:3848
  v_mfma_f32_16x16x32_bf16 v[204:207], v[164:167], v[184:187], v[204:207]
  buffer_load_dwordx4 a[136:139], v2, s[52:55], s18 offen offset:2048 sc1
  s_waitcnt lgkmcnt(12)
  v_mfma_f32_16x16x32_bf16 v[200:203], v[168:171], v[176:179], v[200:203]
  buffer_load_dwordx4 a[140:143], v2, s[52:55], s18 offen offset:3072 sc1
  v_mfma_f32_16x16x32_bf16 v[204:207], v[168:171], v[180:183], v[204:207]
  v_mfma_f32_16x16x32_bf16 v[204:207], v[172:175], v[176:179], v[204:207]
  s_waitcnt lgkmcnt(4)
  v_mfma_f32_16x16x32_bf16 v[192:195], v[128:131], v[144:147], v[192:195]
  ds_read_b64 v[160:161], v252 offset:832
  ds_read_b64 v[162:163], v252 offset:840
  v_mfma_f32_16x16x32_bf16 v[196:199], v[128:131], v[148:151], v[196:199]
  ds_read_b128 v[176:179], v254 offset:5856
  ds_read_b128 v[180:183], v254 offset:4320
  v_mfma_f32_16x16x32_bf16 v[200:203], v[128:131], v[152:155], v[200:203]
  ds_read_b128 v[184:187], v254 offset:2784
  ds_read_b128 v[188:191], v254 offset:1248
  v_mfma_f32_16x16x32_bf16 v[204:207], v[128:131], v[156:159], v[204:207]
  ds_read_b64 v[164:165], v252 offset:1856
  ds_read_b64 v[166:167], v252 offset:1864
  v_mfma_f32_16x16x32_bf16 v[196:199], v[132:135], v[144:147], v[196:199]
  ds_read_b64 v[168:169], v252 offset:2880
  ds_read_b64 v[170:171], v252 offset:2888
  v_mfma_f32_16x16x32_bf16 v[200:203], v[132:135], v[148:151], v[200:203]
  ds_read_b64 v[172:173], v252 offset:3904
  ds_read_b64 v[174:175], v252 offset:3912
  v_mfma_f32_16x16x32_bf16 v[204:207], v[132:135], v[152:155], v[204:207]
  s_add_u32 s18, s18, 4096
  buffer_load_dwordx4 a[144:147], v2, s[52:55], s18 offen offset:0 sc1
  s_waitcnt lgkmcnt(12)
  v_mfma_f32_16x16x32_bf16 v[200:203], v[136:139], v[144:147], v[200:203]
  buffer_load_dwordx4 a[148:151], v2, s[52:55], s18 offen offset:1024 sc1
  v_mfma_f32_16x16x32_bf16 v[204:207], v[136:139], v[148:151], v[204:207]
  v_mfma_f32_16x16x32_bf16 v[204:207], v[140:143], v[144:147], v[204:207]
  s_waitcnt lgkmcnt(4)
  v_mfma_f32_16x16x32_bf16 v[192:195], v[160:163], v[176:179], v[192:195]
  ds_read_b64 v[128:129], v252 offset:896
  ds_read_b64 v[130:131], v252 offset:904
  v_mfma_f32_16x16x32_bf16 v[196:199], v[160:163], v[180:183], v[196:199]
  ds_read_b128 v[144:147], v254 offset:5952
  ds_read_b128 v[148:151], v254 offset:4416
  v_mfma_f32_16x16x32_bf16 v[200:203], v[160:163], v[184:187], v[200:203]
  ds_read_b128 v[152:155], v254 offset:2880
  ds_read_b128 v[156:159], v254 offset:1344
  v_mfma_f32_16x16x32_bf16 v[204:207], v[160:163], v[188:191], v[204:207]
  ds_read_b64 v[132:133], v252 offset:1920
  ds_read_b64 v[134:135], v252 offset:1928
  v_mfma_f32_16x16x32_bf16 v[196:199], v[164:167], v[176:179], v[196:199]
  ds_read_b64 v[136:137], v252 offset:2944
  ds_read_b64 v[138:139], v252 offset:2952
  v_mfma_f32_16x16x32_bf16 v[200:203], v[164:167], v[180:183], v[200:203]
  ds_read_b64 v[140:141], v252 offset:3968
  ds_read_b64 v[142:143], v252 offset:3976
  v_mfma_f32_16x16x32_bf16 v[204:207], v[164:167], v[184:187], v[204:207]
  buffer_load_dwordx4 a[152:155], v2, s[52:55], s18 offen offset:2048 sc1
  s_waitcnt lgkmcnt(12)
  v_mfma_f32_16x16x32_bf16 v[200:203], v[168:171], v[176:179], v[200:203]
  buffer_load_dwordx4 a[156:159], v2, s[52:55], s18 offen offset:3072 sc1
  v_mfma_f32_16x16x32_bf16 v[204:207], v[168:171], v[180:183], v[204:207]
  v_mfma_f32_16x16x32_bf16 v[204:207], v[172:175], v[176:179], v[204:207]
  s_waitcnt lgkmcnt(4)
  v_mfma_f32_16x16x32_bf16 v[192:195], v[128:131], v[144:147], v[192:195]
  ds_read_b64 v[160:161], v252 offset:960
  ds_read_b64 v[162:163], v252 offset:968
  v_mfma_f32_16x16x32_bf16 v[196:199], v[128:131], v[148:151], v[196:199]
  ds_read_b128 v[176:179], v254 offset:6048
  ds_read_b128 v[180:183], v254 offset:4512
  v_mfma_f32_16x16x32_bf16 v[200:203], v[128:131], v[152:155], v[200:203]
  ds_read_b128 v[184:187], v254 offset:2976
  ds_read_b128 v[188:191], v254 offset:1440
  v_mfma_f32_16x16x32_bf16 v[204:207], v[128:131], v[156:159], v[204:207]
  ds_read_b64 v[164:165], v252 offset:1984
  ds_read_b64 v[166:167], v252 offset:1992
  v_mfma_f32_16x16x32_bf16 v[196:199], v[132:135], v[144:147], v[196:199]
  ds_read_b64 v[168:169], v252 offset:3008
  ds_read_b64 v[170:171], v252 offset:3016
  v_mfma_f32_16x16x32_bf16 v[200:203], v[132:135], v[148:151], v[200:203]
  ds_read_b64 v[172:173], v252 offset:4032
  ds_read_b64 v[174:175], v252 offset:4040
  v_mfma_f32_16x16x32_bf16 v[204:207], v[132:135], v[152:155], v[204:207]
  s_add_u32 s18, s18, 4096
  buffer_load_dwordx4 a[160:163], v2, s[52:55], s18 offen offset:0 sc1
  s_waitcnt lgkmcnt(12)
  v_mfma_f32_16x16x32_bf16 v[200:203], v[136:139], v[144:147], v[200:203]
  buffer_load_dwordx4 a[164:167], v2, s[52:55], s18 offen offset:1024 sc1
  v_mfma_f32_16x16x32_bf16 v[204:207], v[136:139], v[148:151], v[204:207]
  v_mfma_f32_16x16x32_bf16 v[204:207], v[140:143], v[144:147], v[204:207]
  s_waitcnt lgkmcnt(4)
  v_mfma_f32_16x16x32_bf16 v[192:195], v[160:163], v[176:179], v[192:195]
  ds_read_b64 v[128:129], v253 offset:0
  ds_read_b64 v[130:131], v253 offset:8
  v_mfma_f32_16x16x32_bf16 v[196:199], v[160:163], v[180:183], v[196:199]
  ds_read_b128 v[144:147], v255 offset:4608
  ds_read_b128 v[148:151], v255 offset:3072
  v_mfma_f32_16x16x32_bf16 v[200:203], v[160:163], v[184:187], v[200:203]
  ds_read_b128 v[152:155], v255 offset:1536
  ds_read_b128 v[156:159], v255 offset:0
  v_mfma_f32_16x16x32_bf16 v[204:207], v[160:163], v[188:191], v[204:207]
  ds_read_b64 v[132:133], v253 offset:1024
  ds_read_b64 v[134:135], v253 offset:1032
  v_mfma_f32_16x16x32_bf16 v[196:199], v[164:167], v[176:179], v[196:199]
  ds_read_b64 v[136:137], v253 offset:2048
  ds_read_b64 v[138:139], v253 offset:2056
  v_mfma_f32_16x16x32_bf16 v[200:203], v[164:167], v[180:183], v[200:203]
  ds_read_b64 v[140:141], v253 offset:3072
  ds_read_b64 v[142:143], v253 offset:3080
  v_mfma_f32_16x16x32_bf16 v[204:207], v[164:167], v[184:187], v[204:207]
  buffer_load_dwordx4 a[168:171], v2, s[52:55], s18 offen offset:2048 sc1
  s_waitcnt lgkmcnt(12)
  v_mfma_f32_16x16x32_bf16 v[200:203], v[168:171], v[176:179], v[200:203]
  buffer_load_dwordx4 a[172:175], v2, s[52:55], s18 offen offset:3072 sc1
  v_mfma_f32_16x16x32_bf16 v[204:207], v[168:171], v[180:183], v[204:207]
  v_mfma_f32_16x16x32_bf16 v[204:207], v[172:175], v[176:179], v[204:207]
  s_waitcnt lgkmcnt(4)
  v_mfma_f32_16x16x32_bf16 v[48:51], v[128:131], v[144:147], 0
  ds_read_b64 v[160:161], v253 offset:64
  ds_read_b64 v[162:163], v253 offset:72
  v_mfma_f32_16x16x32_bf16 v[52:55], v[128:131], v[148:151], 0
  ds_read_b128 v[176:179], v255 offset:4704
  ds_read_b128 v[180:183], v255 offset:3168
  v_mfma_f32_16x16x32_bf16 v[56:59], v[128:131], v[152:155], 0
  ds_read_b128 v[184:187], v255 offset:1632
  ds_read_b128 v[188:191], v255 offset:96
  v_mfma_f32_16x16x32_bf16 v[60:63], v[128:131], v[156:159], 0
  ds_read_b64 v[164:165], v253 offset:1088
  ds_read_b64 v[166:167], v253 offset:1096
  v_mfma_f32_16x16x32_bf16 v[52:55], v[132:135], v[144:147], v[52:55]
  ds_read_b64 v[168:169], v253 offset:2112
  ds_read_b64 v[170:171], v253 offset:2120
  v_mfma_f32_16x16x32_bf16 v[56:59], v[132:135], v[148:151], v[56:59]
  ds_read_b64 v[172:173], v253 offset:3136
  ds_read_b64 v[174:175], v253 offset:3144
  v_mfma_f32_16x16x32_bf16 v[60:63], v[132:135], v[152:155], v[60:63]
  s_add_u32 s18, s18, 4096
  buffer_load_dwordx4 a[176:179], v2, s[52:55], s18 offen offset:0 sc1
  s_waitcnt lgkmcnt(12)
  v_mfma_f32_16x16x32_bf16 v[56:59], v[136:139], v[144:147], v[56:59]
  buffer_load_dwordx4 a[180:183], v2, s[52:55], s18 offen offset:1024 sc1
  v_mfma_f32_16x16x32_bf16 v[60:63], v[136:139], v[148:151], v[60:63]
  v_mfma_f32_16x16x32_bf16 v[60:63], v[140:143], v[144:147], v[60:63]
  s_waitcnt lgkmcnt(4)
  v_mfma_f32_16x16x32_bf16 v[48:51], v[160:163], v[176:179], v[48:51]
  ds_read_b64 v[128:129], v253 offset:128
  ds_read_b64 v[130:131], v253 offset:136
  v_mfma_f32_16x16x32_bf16 v[52:55], v[160:163], v[180:183], v[52:55]
  ds_read_b128 v[144:147], v255 offset:4800
  ds_read_b128 v[148:151], v255 offset:3264
  v_mfma_f32_16x16x32_bf16 v[56:59], v[160:163], v[184:187], v[56:59]
  ds_read_b128 v[152:155], v255 offset:1728
  ds_read_b128 v[156:159], v255 offset:192
  v_mfma_f32_16x16x32_bf16 v[60:63], v[160:163], v[188:191], v[60:63]
  ds_read_b64 v[132:133], v253 offset:1152
  ds_read_b64 v[134:135], v253 offset:1160
  v_mfma_f32_16x16x32_bf16 v[52:55], v[164:167], v[176:179], v[52:55]
  ds_read_b64 v[136:137], v253 offset:2176
  ds_read_b64 v[138:139], v253 offset:2184
  v_mfma_f32_16x16x32_bf16 v[56:59], v[164:167], v[180:183], v[56:59]
  ds_read_b64 v[140:141], v253 offset:3200
  ds_read_b64 v[142:143], v253 offset:3208
  v_mfma_f32_16x16x32_bf16 v[60:63], v[164:167], v[184:187], v[60:63]
  buffer_load_dwordx4 a[184:187], v2, s[52:55], s18 offen offset:2048 sc1
  s_waitcnt lgkmcnt(12)
  v_mfma_f32_16x16x32_bf16 v[56:59], v[168:171], v[176:179], v[56:59]
  buffer_load_dwordx4 a[188:191], v2, s[52:55], s18 offen offset:3072 sc1
  v_mfma_f32_16x16x32_bf16 v[60:63], v[168:171], v[180:183], v[60:63]
  v_mfma_f32_16x16x32_bf16 v[60:63], v[172:175], v[176:179], v[60:63]
  s_waitcnt lgkmcnt(4)
  v_mfma_f32_16x16x32_bf16 v[48:51], v[128:131], v[144:147], v[48:51]
  ds_read_b64 v[160:161], v253 offset:192
  ds_read_b64 v[162:163], v253 offset:200
  v_mfma_f32_16x16x32_bf16 v[52:55], v[128:131], v[148:151], v[52:55]
  ds_read_b128 v[176:179], v255 offset:4896
  ds_read_b128 v[180:183], v255 offset:3360
  v_mfma_f32_16x16x32_bf16 v[56:59], v[128:131], v[152:155], v[56:59]
  ds_read_b128 v[184:187], v255 offset:1824
  ds_read_b128 v[188:191], v255 offset:288
  v_mfma_f32_16x16x32_bf16 v[60:63], v[128:131], v[156:159], v[60:63]
  ds_read_b64 v[164:165], v253 offset:1216
  ds_read_b64 v[166:167], v253 offset:1224
  v_mfma_f32_16x16x32_bf16 v[52:55], v[132:135], v[144:147], v[52:55]
  ds_read_b64 v[168:169], v253 offset:2240
  ds_read_b64 v[170:171], v253 offset:2248
  v_mfma_f32_16x16x32_bf16 v[56:59], v[132:135], v[148:151], v[56:59]
  ds_read_b64 v[172:173], v253 offset:3264
  ds_read_b64 v[174:175], v253 offset:3272
  v_mfma_f32_16x16x32_bf16 v[60:63], v[132:135], v[152:155], v[60:63]
  s_add_u32 s18, s18, 4096
  buffer_load_dwordx4 a[192:195], v2, s[52:55], s18 offen offset:0 sc1
  buffer_load_dwordx4 a[196:199], v2, s[52:55], s18 offen offset:1024 sc1
  s_waitcnt lgkmcnt(12)
  v_mfma_f32_16x16x32_bf16 v[56:59], v[136:139], v[144:147], v[56:59]
  v_accvgpr_read_b32 v11, a232
  v_accvgpr_read_b32 v12, a233
  v_mfma_f32_16x16x32_bf16 v[60:63], v[136:139], v[148:151], v[60:63]
  v_accvgpr_read_b32 v13, a235
  v_mfma_f32_16x16x32_bf16 v[60:63], v[140:143], v[144:147], v[60:63]
  v_accvgpr_read_b32 v14, a234
  s_waitcnt lgkmcnt(4)
  v_mfma_f32_16x16x32_bf16 v[48:51], v[160:163], v[176:179], v[48:51]
  ds_read_b64 v[64:65], v11 offset:4608
  v_mfma_f32_16x16x32_bf16 v[52:55], v[160:163], v[180:183], v[52:55]
  ds_read_b64 v[66:67], v11 offset:3072
  v_mfma_f32_16x16x32_bf16 v[56:59], v[160:163], v[184:187], v[56:59]
  ds_read_b64 v[68:69], v11 offset:1536
  v_mfma_f32_16x16x32_bf16 v[60:63], v[160:163], v[188:191], v[60:63]
  ds_read_b64 v[70:71], v11 offset:0
  v_mfma_f32_16x16x32_bf16 v[52:55], v[164:167], v[176:179], v[52:55]
  ds_read_b64 v[80:81], v12
  v_mfma_f32_16x16x32_bf16 v[56:59], v[164:167], v[180:183], v[56:59]
  v_mfma_f32_16x16x32_bf16 v[60:63], v[164:167], v[184:187], v[60:63]
  s_waitcnt lgkmcnt(5)
  v_mfma_f32_16x16x32_bf16 v[56:59], v[168:171], v[176:179], v[56:59]
  v_mfma_f32_16x16x32_bf16 v[60:63], v[168:171], v[180:183], v[60:63]
  v_mfma_f32_16x16x32_bf16 v[60:63], v[172:175], v[176:179], v[60:63]
  s_waitcnt lgkmcnt(0)
  s_barrier
  ds_write_b128 v13, v[48:51] offset:0
  ds_write_b128 v13, v[52:55] offset:1024
  s_nop 1
  ds_write_b128 v13, v[56:59] offset:2048
  s_nop 0
  ds_write_b128 v13, v[60:63] offset:3072
  s_cmp_lg_u32 s7, 2
  s_cbranch_scc1 skip_26
  buffer_load_dwordx3 v[128:130], v251, s[52:55], s80 offen offset:0 sc1
  buffer_load_dwordx3 v[132:134], v251, s[52:55], s80 offen offset:768 sc1
  buffer_load_dwordx3 v[136:138], v251, s[52:55], s80 offen offset:1536 sc1
  buffer_load_dwordx3 v[140:142], v251, s[52:55], s80 offen offset:2304 sc1
  buffer_load_dwordx3 v[144:146], v251, s[52:55], s80 offen offset:3072 sc1
  buffer_load_dwordx3 v[148:150], v251, s[52:55], s81 offen offset:0 sc1
  buffer_load_dwordx3 v[152:154], v251, s[52:55], s81 offen offset:768 sc1
  buffer_load_dwordx3 v[156:158], v251, s[52:55], s81 offen offset:1536 sc1
  buffer_load_dwordx3 v[160:162], v251, s[52:55], s81 offen offset:2304 sc1
  buffer_load_dwordx3 v[164:166], v251, s[52:55], s81 offen offset:3072 sc1
  buffer_load_dwordx3 v[168:170], v251, s[52:55], s82 offen offset:0 sc1
  buffer_load_dwordx3 v[172:174], v251, s[52:55], s82 offen offset:768 sc1
  buffer_load_dwordx3 v[240:242], v251, s[52:55], s82 offen offset:1536 sc1
  buffer_load_dwordx3 v[244:246], v251, s[52:55], s82 offen offset:2304 sc1
  buffer_load_dwordx3 v[248:250], v251, s[52:55], s82 offen offset:3072 sc1
skip_26:
  v_dot2_f32_bf16 v192, v65, s23, v192
  v_dot2_f32_bf16 v193, v65, s22, v193
  v_dot2_f32_bf16 v194, v64, s23, v194
  v_dot2_f32_bf16 v195, v64, s22, v195
  v_dot2_f32_bf16 v196, v67, s23, v196
  v_dot2_f32_bf16 v197, v67, s22, v197
  v_dot2_f32_bf16 v198, v66, s23, v198
  v_dot2_f32_bf16 v199, v66, s22, v199
  v_cvt_pk_bf16_f32 v72, v192, v193
  v_cvt_pk_bf16_f32 v73, v194, v195
  ds_write_b64 v14, v[72:73] offset:0
  v_dot2_f32_bf16 v200, v69, s23, v200
  v_dot2_f32_bf16 v201, v69, s22, v201
  v_dot2_f32_bf16 v202, v68, s23, v202
  v_dot2_f32_bf16 v203, v68, s22, v203
  v_cvt_pk_bf16_f32 v74, v196, v197
  v_cvt_pk_bf16_f32 v75, v198, v199
  ds_write_b64 v14, v[74:75] offset:1280
  v_dot2_f32_bf16 v204, v71, s23, v204
  v_dot2_f32_bf16 v205, v71, s22, v205
  v_dot2_f32_bf16 v206, v70, s23, v206
  v_dot2_f32_bf16 v207, v70, s22, v207
  v_cvt_pk_bf16_f32 v76, v200, v201
  v_cvt_pk_bf16_f32 v77, v202, v203
  ds_write_b64 v14, v[76:77] offset:2560
  v_cvt_pk_bf16_f32 v78, v204, v205
  v_cvt_pk_bf16_f32 v79, v206, v207
  ds_write_b64 v14, v[78:79] offset:3840
  v_accvgpr_read_b32 v11, a237
  v_accvgpr_read_b32 v12, a236
  v_accvgpr_read_b32 v13, a238
  v_accvgpr_read_b32 v14, a239
  v_accvgpr_read_b32 v15, a251
  s_waitcnt lgkmcnt(0)
  s_barrier
  ds_read_b128 v[64:67], v11 offset:0
  ds_read_b128 v[68:71], v11 offset:1280
  ds_read_b128 v[176:179], v12 offset:0
  ds_read_b128 v[180:183], v12 offset:4096
  ds_read_b128 v[184:187], v12 offset:8192
  ds_read_b128 v[188:191], v12 offset:12288
  v_accvgpr_read_b32 v252, a252
  v_accvgpr_read_b32 v253, a253
  v_accvgpr_read_b32 v254, a254
  s_waitcnt lgkmcnt(5)
  buffer_store_dwordx4 v[64:67], v2, s[52:55], s93 offen offset:0 sc1
  s_waitcnt lgkmcnt(4)
  buffer_store_dwordx4 v[68:71], v2, s[52:55], s93 offen offset:1024 sc1
  s_waitcnt lgkmcnt(0)
  v_pk_add_f32 v[176:177], v[176:177], v[180:181]
  v_pk_add_f32 v[184:185], v[184:185], v[188:189]
  v_pk_add_f32 v[178:179], v[178:179], v[182:183]
  v_pk_add_f32 v[186:187], v[186:187], v[190:191]
  v_pk_add_f32 v[176:177], v[176:177], v[184:185]
  v_pk_add_f32 v[178:179], v[178:179], v[186:187]
  v_dot2_f32_bf16 v176, v81, s25, v176
  v_dot2_f32_bf16 v177, v81, s24, v177
  v_dot2_f32_bf16 v178, v80, s25, v178
  v_dot2_f32_bf16 v179, v80, s24, v179
  s_nop 0
  v_cvt_pk_bf16_f32 v82, v176, v177
  s_nop 0
  v_cvt_pk_bf16_f32 v83, v178, v179
  ds_write_b64 v13, v[82:83]
  ds_read_b128 v[84:87], v14
  s_mov_b32 exec_hi, 0
  s_waitcnt lgkmcnt(0)
  buffer_store_dwordx4 v[84:87], v15, s[52:55], s92 offen sc1
  s_mov_b32 exec_hi, -1
  s_cmp_lg_u32 s7, 2
  s_cbranch_scc1 skip_27
aggpoll_28:
  s_waitcnt vmcnt(3)
  v_min3_u32 v13, v130, v134, v138
  v_max3_u32 v14, v130, v134, v138
  v_min3_u32 v13, v13, v142, v146
  v_max3_u32 v14, v14, v142, v146
  v_min3_u32 v13, v13, v150, v154
  v_max3_u32 v14, v14, v150, v154
  v_min3_u32 v13, v13, v158, v162
  v_max3_u32 v14, v14, v158, v162
  v_min3_u32 v13, v13, v166, v170
  v_max3_u32 v14, v14, v166, v170
  v_min3_u32 v13, v13, v174, v242
  v_max3_u32 v14, v14, v174, v242
  v_min3_u32 v13, v13, v246, v250
  v_max3_u32 v14, v14, v246, v250
  v_xor_b32 v13, s8, v13
  v_xor_b32 v14, s8, v14
  v_or_b32 v13, v13, v14
  v_cmp_ne_u32 vcc, 0, v13
  s_cbranch_vccnz retry_30
giveup_31:
  v_pk_fma_f32 v[42:43], v[128:129], v[38:39], v[132:133] op_sel:[1,1,0] op_sel_hi:[0,1,1] neg_lo:[0,1,0]
  v_pk_fma_f32 v[42:43], v[128:129], v[38:39], v[42:43] op_sel:[0,0,0] op_sel_hi:[1,0,1]
  v_pk_fma_f32 v[44:45], v[42:43], v[38:39], v[136:137] op_sel:[1,1,0] op_sel_hi:[0,1,1] neg_lo:[0,1,0]
  v_pk_fma_f32 v[44:45], v[42:43], v[38:39], v[44:45] op_sel:[0,0,0] op_sel_hi:[1,0,1]
  v_pk_fma_f32 v[42:43], v[44:45], v[38:39], v[140:141] op_sel:[1,1,0] op_sel_hi:[0,1,1] neg_lo:[0,1,0]
  v_pk_fma_f32 v[42:43], v[44:45], v[38:39], v[42:43] op_sel:[0,0,0] op_sel_hi:[1,0,1]
  v_pk_fma_f32 v[44:45], v[42:43], v[38:39], v[144:145] op_sel:[1,1,0] op_sel_hi:[0,1,1] neg_lo:[0,1,0]
  v_pk_fma_f32 v[44:45], v[42:43], v[38:39], v[44:45] op_sel:[0,0,0] op_sel_hi:[1,0,1]
  v_pk_fma_f32 v[42:43], v[44:45], v[38:39], v[148:149] op_sel:[1,1,0] op_sel_hi:[0,1,1] neg_lo:[0,1,0]
  v_pk_fma_f32 v[42:43], v[44:45], v[38:39], v[42:43] op_sel:[0,0,0] op_sel_hi:[1,0,1]
  v_pk_fma_f32 v[44:45], v[42:43], v[38:39], v[152:153] op_sel:[1,1,0] op_sel_hi:[0,1,1] neg_lo:[0,1,0]
  v_pk_fma_f32 v[44:45], v[42:43], v[38:39], v[44:45] op_sel:[0,0,0] op_sel_hi:[1,0,1]
  v_pk_fma_f32 v[42:43], v[44:45], v[38:39], v[156:157] op_sel:[1,1,0] op_sel_hi:[0,1,1] neg_lo:[0,1,0]
  v_pk_fma_f32 v[42:43], v[44:45], v[38:39], v[42:43] op_sel:[0,0,0] op_sel_hi:[1,0,1]
  v_pk_fma_f32 v[44:45], v[42:43], v[38:39], v[160:161] op_sel:[1,1,0] op_sel_hi:[0,1,1] neg_lo:[0,1,0]
  v_pk_fma_f32 v[44:45], v[42:43], v[38:39], v[44:45] op_sel:[0,0,0] op_sel_hi:[1,0,1]
  v_pk_fma_f32 v[42:43], v[44:45], v[38:39], v[164:165] op_sel:[1,1,0] op_sel_hi:[0,1,1] neg_lo:[0,1,0]
  v_pk_fma_f32 v[42:43], v[44:45], v[38:39], v[42:43] op_sel:[0,0,0] op_sel_hi:[1,0,1]
  v_pk_fma_f32 v[44:45], v[42:43], v[38:39], v[168:169] op_sel:[1,1,0] op_sel_hi:[0,1,1] neg_lo:[0,1,0]
  v_pk_fma_f32 v[44:45], v[42:43], v[38:39], v[44:45] op_sel:[0,0,0] op_sel_hi:[1,0,1]
  v_pk_fma_f32 v[42:43], v[44:45], v[38:39], v[172:173] op_sel:[1,1,0] op_sel_hi:[0,1,1] neg_lo:[0,1,0]
  v_pk_fma_f32 v[42:43], v[44:45], v[38:39], v[42:43] op_sel:[0,0,0] op_sel_hi:[1,0,1]
  v_pk_fma_f32 v[44:45], v[42:43], v[38:39], v[240:241] op_sel:[1,1,0] op_sel_hi:[0,1,1] neg_lo:[0,1,0]
  v_pk_fma_f32 v[44:45], v[42:43], v[38:39], v[44:45] op_sel:[0,0,0] op_sel_hi:[1,0,1]
  v_pk_fma_f32 v[42:43], v[44:45], v[38:39], v[244:245] op_sel:[1,1,0] op_sel_hi:[0,1,1] neg_lo:[0,1,0]
  v_pk_fma_f32 v[42:43], v[44:45], v[38:39], v[42:43] op_sel:[0,0,0] op_sel_hi:[1,0,1]
  v_pk_fma_f32 v[44:45], v[42:43], v[38:39], v[248:249] op_sel:[1,1,0] op_sel_hi:[0,1,1] neg_lo:[0,1,0]
  v_pk_fma_f32 v[44:45], v[42:43], v[38:39], v[44:45] op_sel:[0,0,0] op_sel_hi:[1,0,1]
  v_pk_mul_f32 v[46:47], v[44:45], v[40:41] op_sel:[1,1] op_sel_hi:[0,1] neg_lo:[0,1] neg_hi:[0,1]
  v_pk_fma_f32 v[128:129], v[44:45], v[40:41], v[46:47] op_sel:[0,0,0] op_sel_hi:[1,0,1] neg_hi:[0,1,0]
  s_mov_b32 exec_hi, 0xff
  v_pk_fma_f32 v[130:131], v[128:129], v[36:37], v[208:209] op_sel:[1,1,0] op_sel_hi:[0,1,1] neg_hi:[0,1,0]
  v_pk_fma_f32 v[130:131], v[128:129], v[36:37], v[130:131] op_sel:[0,0,0] op_sel_hi:[1,0,1]
  ds_write_b128 v247, v[128:131] offset:0
  v_pk_fma_f32 v[132:133], v[130:131], v[36:37], v[210:211] op_sel:[1,1,0] op_sel_hi:[0,1,1] neg_hi:[0,1,0]
  v_pk_fma_f32 v[132:133], v[130:131], v[36:37], v[132:133] op_sel:[0,0,0] op_sel_hi:[1,0,1]
  v_pk_fma_f32 v[134:135], v[132:133], v[36:37], v[212:213] op_sel:[1,1,0] op_sel_hi:[0,1,1] neg_hi:[0,1,0]
  v_pk_fma_f32 v[134:135], v[132:133], v[36:37], v[134:135] op_sel:[0,0,0] op_sel_hi:[1,0,1]
  ds_write_b128 v247, v[132:135] offset:16
  v_pk_fma_f32 v[136:137], v[134:135], v[36:37], v[214:215] op_sel:[1,1,0] op_sel_hi:[0,1,1] neg_hi:[0,1,0]
  v_pk_fma_f32 v[136:137], v[134:135], v[36:37], v[136:137] op_sel:[0,0,0] op_sel_hi:[1,0,1]
  v_pk_fma_f32 v[138:139], v[136:137], v[36:37], v[216:217] op_sel:[1,1,0] op_sel_hi:[0,1,1] neg_hi:[0,1,0]
  v_pk_fma_f32 v[138:139], v[136:137], v[36:37], v[138:139] op_sel:[0,0,0] op_sel_hi:[1,0,1]
  ds_write_b128 v247, v[136:139] offset:32
  v_pk_fma_f32 v[140:141], v[138:139], v[36:37], v[218:219] op_sel:[1,1,0] op_sel_hi:[0,1,1] neg_hi:[0,1,0]
  v_pk_fma_f32 v[140:141], v[138:139], v[36:37], v[140:141] op_sel:[0,0,0] op_sel_hi:[1,0,1]
  v_pk_fma_f32 v[142:143], v[140:141], v[36:37], v[220:221] op_sel:[1,1,0] op_sel_hi:[0,1,1] neg_hi:[0,1,0]
  v_pk_fma_f32 v[142:143], v[140:141], v[36:37], v[142:143] op_sel:[0,0,0] op_sel_hi:[1,0,1]
  ds_write_b128 v247, v[140:143] offset:48
  v_pk_fma_f32 v[144:145], v[142:143], v[36:37], v[222:223] op_sel:[1,1,0] op_sel_hi:[0,1,1] neg_hi:[0,1,0]
  v_pk_fma_f32 v[144:145], v[142:143], v[36:37], v[144:145] op_sel:[0,0,0] op_sel_hi:[1,0,1]
  v_pk_fma_f32 v[146:147], v[144:145], v[36:37], v[224:225] op_sel:[1,1,0] op_sel_hi:[0,1,1] neg_hi:[0,1,0]
  v_pk_fma_f32 v[146:147], v[144:145], v[36:37], v[146:147] op_sel:[0,0,0] op_sel_hi:[1,0,1]
  ds_write_b128 v247, v[144:147] offset:64
  v_pk_fma_f32 v[148:149], v[146:147], v[36:37], v[226:227] op_sel:[1,1,0] op_sel_hi:[0,1,1] neg_hi:[0,1,0]
  v_pk_fma_f32 v[148:149], v[146:147], v[36:37], v[148:149] op_sel:[0,0,0] op_sel_hi:[1,0,1]
  v_pk_fma_f32 v[150:151], v[148:149], v[36:37], v[228:229] op_sel:[1,1,0] op_sel_hi:[0,1,1] neg_hi:[0,1,0]
  v_pk_fma_f32 v[150:151], v[148:149], v[36:37], v[150:151] op_sel:[0,0,0] op_sel_hi:[1,0,1]
  ds_write_b128 v247, v[148:151] offset:80
  v_pk_fma_f32 v[152:153], v[150:151], v[36:37], v[230:231] op_sel:[1,1,0] op_sel_hi:[0,1,1] neg_hi:[0,1,0]
  v_pk_fma_f32 v[152:153], v[150:151], v[36:37], v[152:153] op_sel:[0,0,0] op_sel_hi:[1,0,1]
  v_pk_fma_f32 v[154:155], v[152:153], v[36:37], v[232:233] op_sel:[1,1,0] op_sel_hi:[0,1,1] neg_hi:[0,1,0]
  v_pk_fma_f32 v[154:155], v[152:153], v[36:37], v[154:155] op_sel:[0,0,0] op_sel_hi:[1,0,1]
  ds_write_b128 v247, v[152:155] offset:96
  v_pk_fma_f32 v[156:157], v[154:155], v[36:37], v[234:235] op_sel:[1,1,0] op_sel_hi:[0,1,1] neg_hi:[0,1,0]
  v_pk_fma_f32 v[156:157], v[154:155], v[36:37], v[156:157] op_sel:[0,0,0] op_sel_hi:[1,0,1]
  v_pk_fma_f32 v[158:159], v[156:157], v[36:37], v[236:237] op_sel:[1,1,0] op_sel_hi:[0,1,1] neg_hi:[0,1,0]
  v_pk_fma_f32 v[158:159], v[156:157], v[36:37], v[158:159] op_sel:[0,0,0] op_sel_hi:[1,0,1]
  ds_write_b128 v247, v[156:159] offset:112
  s_mov_b32 exec_hi, -1
skip_27:
  s_waitcnt lgkmcnt(0)
  s_barrier
  ds_read_b32 v48, v9 offset:0
  ds_read_b32 v49, v9 offset:1152
  ds_read_b32 v50, v9 offset:2304
  ds_read_b32 v51, v9 offset:3456
  ds_read_b32 v52, v9 offset:4608
  s_waitcnt lgkmcnt(0)
  v_fmac_f32 v88, v16, v48
  v_fmac_f32 v96, v17, v49
  v_fmac_f32 v104, v18, v50
  v_fmac_f32_dpp v88, v48, v21 quad_perm:[1,0,3,2] row_mask:0xf bank_mask:0xf
  v_fmac_f32_dpp v96, v49, v22 quad_perm:[1,0,3,2] row_mask:0xf bank_mask:0xf
  v_fmac_f32_dpp v104, v50, v23 quad_perm:[1,0,3,2] row_mask:0xf bank_mask:0xf
  v_fmac_f32 v89, v16, v88
  v_fmac_f32 v97, v17, v96
  v_fmac_f32_e64 v105, v18, v104
  v_fmac_f32_dpp v89, v88, v21 quad_perm:[1,0,3,2] row_mask:0xf bank_mask:0xf
  v_fmac_f32_dpp v97, v96, v22 quad_perm:[1,0,3,2] row_mask:0xf bank_mask:0xf
  v_fmac_f32_dpp v105, v104, v23 quad_perm:[1,0,3,2] row_mask:0xf bank_mask:0xf
  v_fmac_f32 v90, v16, v89
  v_fmac_f32 v98, v17, v97
  v_fmac_f32_e64 v106, v18, v105
  v_fmac_f32_dpp v90, v89, v21 quad_perm:[1,0,3,2] row_mask:0xf bank_mask:0xf
  v_fmac_f32_dpp v98, v97, v22 quad_perm:[1,0,3,2] row_mask:0xf bank_mask:0xf
  v_fmac_f32_dpp v106, v105, v23 quad_perm:[1,0,3,2] row_mask:0xf bank_mask:0xf
  v_fmac_f32 v91, v16, v90
  v_fmac_f32 v99, v17, v98
  v_fmac_f32_e64 v107, v18, v106
  v_fmac_f32_dpp v91, v90, v21 quad_perm:[1,0,3,2] row_mask:0xf bank_mask:0xf
  v_fmac_f32_dpp v99, v98, v22 quad_perm:[1,0,3,2] row_mask:0xf bank_mask:0xf
  v_fmac_f32_dpp v107, v106, v23 quad_perm:[1,0,3,2] row_mask:0xf bank_mask:0xf
  v_fmac_f32 v92, v16, v91
  v_fmac_f32 v100, v17, v99
  v_fmac_f32_e64 v108, v18, v107
  v_fmac_f32_dpp v92, v91, v21 quad_perm:[1,0,3,2] row_mask:0xf bank_mask:0xf
  v_fmac_f32_dpp v100, v99, v22 quad_perm:[1,0,3,2] row_mask:0xf bank_mask:0xf
  v_fmac_f32_dpp v108, v107, v23 quad_perm:[1,0,3,2] row_mask:0xf bank_mask:0xf
  v_fmac_f32 v93, v16, v92
  v_fmac_f32 v101, v17, v100
  v_fmac_f32_e64 v109, v18, v108
  v_fmac_f32_dpp v93, v92, v21 quad_perm:[1,0,3,2] row_mask:0xf bank_mask:0xf
  v_fmac_f32_dpp v101, v100, v22 quad_perm:[1,0,3,2] row_mask:0xf bank_mask:0xf
  v_fmac_f32_dpp v109, v108, v23 quad_perm:[1,0,3,2] row_mask:0xf bank_mask:0xf
  v_fmac_f32 v94, v16, v93
  v_fmac_f32 v102, v17, v101
  v_fmac_f32_e64 v110, v18, v109
  v_fmac_f32_dpp v94, v93, v21 quad_perm:[1,0,3,2] row_mask:0xf bank_mask:0xf
  v_fmac_f32_dpp v102, v101, v22 quad_perm:[1,0,3,2] row_mask:0xf bank_mask:0xf
  v_fmac_f32_dpp v110, v109, v23 quad_perm:[1,0,3,2] row_mask:0xf bank_mask:0xf
  v_fmac_f32 v95, v16, v94
  v_fmac_f32 v103, v17, v102
  v_fmac_f32_e64 v111, v18, v110
  v_fmac_f32_dpp v95, v94, v21 quad_perm:[1,0,3,2] row_mask:0xf bank_mask:0xf
  v_fmac_f32_dpp v103, v102, v22 quad_perm:[1,0,3,2] row_mask:0xf bank_mask:0xf
  v_fmac_f32_dpp v111, v110, v23 quad_perm:[1,0,3,2] row_mask:0xf bank_mask:0xf
  v_fmac_f32 v112, v19, v51
  v_fmac_f32 v120, v20, v52
  v_cvt_pk_bf16_f32 v56, v88, v89
  v_cvt_pk_bf16_f32 v57, v90, v91
  v_cvt_pk_bf16_f32 v58, v92, v93
  v_fmac_f32_dpp v112, v51, v24 quad_perm:[1,0,3,2] row_mask:0xf bank_mask:0xf
  v_fmac_f32_dpp v120, v52, v25 quad_perm:[1,0,3,2] row_mask:0xf bank_mask:0xf
  v_fmac_f32 v113, v19, v112
  v_fmac_f32 v121, v20, v120
  v_cvt_pk_bf16_f32 v59, v94, v95
  ds_write_b128 v252, v[56:59]
  ds_read_b64_tr_b16 v[68:69], v253
  v_fmac_f32_dpp v113, v112, v24 quad_perm:[1,0,3,2] row_mask:0xf bank_mask:0xf
  v_fmac_f32_dpp v121, v120, v25 quad_perm:[1,0,3,2] row_mask:0xf bank_mask:0xf
  v_fmac_f32 v114, v19, v113
  v_fmac_f32 v122, v20, v121
  ds_read_b64_tr_b16 v[70:71], v253 offset:640
  v_cvt_pk_bf16_f32 v60, v96, v97
  v_cvt_pk_bf16_f32 v61, v98, v99
  v_fmac_f32_dpp v114, v113, v24 quad_perm:[1,0,3,2] row_mask:0xf bank_mask:0xf
  v_fmac_f32_dpp v122, v121, v25 quad_perm:[1,0,3,2] row_mask:0xf bank_mask:0xf
  v_fmac_f32 v115, v19, v114
  v_fmac_f32 v123, v20, v122
  v_cvt_pk_bf16_f32 v62, v100, v101
  v_cvt_pk_bf16_f32 v63, v102, v103
  ds_write_b128 v252, v[60:63]
  v_fmac_f32_dpp v115, v114, v24 quad_perm:[1,0,3,2] row_mask:0xf bank_mask:0xf
  v_fmac_f32_dpp v123, v122, v25 quad_perm:[1,0,3,2] row_mask:0xf bank_mask:0xf
  v_fmac_f32 v116, v19, v115
  v_fmac_f32 v124, v20, v123
  ds_read_b64_tr_b16 v[72:73], v253
  ds_read_b64_tr_b16 v[74:75], v253 offset:640
  v_cvt_pk_bf16_f32 v64, v104, v105
  v_fmac_f32_dpp v116, v115, v24 quad_perm:[1,0,3,2] row_mask:0xf bank_mask:0xf
  v_fmac_f32_dpp v124, v123, v25 quad_perm:[1,0,3,2] row_mask:0xf bank_mask:0xf
  v_fmac_f32 v117, v19, v116
  v_fmac_f32 v125, v20, v124
  v_cvt_pk_bf16_f32 v65, v106, v107
  v_cvt_pk_bf16_f32 v66, v108, v109
  v_fmac_f32_dpp v117, v116, v24 quad_perm:[1,0,3,2] row_mask:0xf bank_mask:0xf
  v_fmac_f32_dpp v125, v124, v25 quad_perm:[1,0,3,2] row_mask:0xf bank_mask:0xf
  v_fmac_f32 v118, v19, v117
  v_fmac_f32 v126, v20, v125
  v_cvt_pk_bf16_f32 v67, v110, v111
  ds_write_b128 v252, v[64:67]
  v_fmac_f32_dpp v118, v117, v24 quad_perm:[1,0,3,2] row_mask:0xf bank_mask:0xf
  v_fmac_f32_dpp v126, v125, v25 quad_perm:[1,0,3,2] row_mask:0xf bank_mask:0xf
  v_fmac_f32 v119, v19, v118
  v_fmac_f32 v127, v20, v126
  ds_read_b64_tr_b16 v[76:77], v253
  ds_read_b64_tr_b16 v[78:79], v253 offset:640
  v_fmac_f32_dpp v119, v118, v24 quad_perm:[1,0,3,2] row_mask:0xf bank_mask:0xf
  v_fmac_f32_dpp v127, v126, v25 quad_perm:[1,0,3,2] row_mask:0xf bank_mask:0xf
  s_cmp_eq_u32 s9, 0
  s_cbranch_scc1 slow_32
  s_add_u32 s13, s75, 10485760
  s_waitcnt lgkmcnt(6)
  buffer_store_dwordx4 v[68:71], v254, s[52:55], s13 offen
  s_add_u32 s13, s76, 10485760
  s_waitcnt lgkmcnt(3)
  buffer_store_dwordx4 v[72:75], v254, s[52:55], s13 offen
  s_add_u32 s13, s77, 10485760
  s_waitcnt lgkmcnt(0)
  buffer_store_dwordx4 v[76:79], v254, s[52:55], s13 offen
back_33:
  v_cvt_pk_bf16_f32 v56, v112, v113
  v_cvt_pk_bf16_f32 v57, v114, v115
  v_cvt_pk_bf16_f32 v58, v116, v117
  v_cvt_pk_bf16_f32 v59, v118, v119
  ds_write_b128 v252, v[56:59]
  ds_read_b64_tr_b16 v[80:81], v253
  ds_read_b64_tr_b16 v[82:83], v253 offset:640
  v_cvt_pk_bf16_f32 v60, v120, v121
  v_cvt_pk_bf16_f32 v61, v122, v123
  v_cvt_pk_bf16_f32 v62, v124, v125
  v_cvt_pk_bf16_f32 v63, v126, v127
  ds_write_b128 v252, v[60:63]
  ds_read_b64_tr_b16 v[84:85], v253
  ds_read_b64_tr_b16 v[86:87], v253 offset:640
  s_cmp_eq_u32 s9, 0
  s_cbranch_scc1 slow_34
  s_add_u32 s13, s78, 10485760
  s_waitcnt lgkmcnt(3)
  buffer_store_dwordx4 v[80:83], v254, s[52:55], s13 offen
  s_add_u32 s13, s79, 10485760
  s_waitcnt lgkmcnt(0)
  buffer_store_dwordx4 v[84:87], v254, s[52:55], s13 offen
back_35:
  s_add_u32 s12, s73, 12288
  s_waitcnt vmcnt(0)
  v_mov_b32 v15, s8
  s_mov_b64 exec, 1
  s_cmp_eq_u32 s9, 0
  s_cbranch_scc1 slow_36
  buffer_store_dword v15, off, s[52:55], s12
back_37:
  s_mov_b64 exec, -1
  s_add_u32 s12, s16, 24576
  v_mov_b32 v15, s8
  s_mov_b64 exec, 1
  buffer_store_dword v15, off, s[52:55], s12 sc1
  s_mov_b64 exec, -1
  v_accvgpr_read_b32 v218, a230
  v_accvgpr_read_b32 v219, a231
  v_mul_f32_e64 v218, v218, v219
  v_accvgpr_read_b32 v208, a220
  v_accvgpr_read_b32 v228, a240
  v_accvgpr_read_b32 v209, a221
  v_accvgpr_read_b32 v229, a241
  v_lshlrev_b32_e64 v196, 16, v228
  v_and_b32 v197, 0xffff0000, v228
  v_lshlrev_b32_e64 v198, 16, v229
  v_and_b32 v199, 0xffff0000, v229
  v_lshlrev_b32_e64 v108, 16, v208
  v_and_b32 v109, 0xffff0000, v208
  v_lshlrev_b32_e64 v110, 16, v209
  v_and_b32 v111, 0xffff0000, v209
  v_pk_fma_f32 v[192:193], v[108:109], v[218:219], v[218:219] op_sel:[0,1,0] op_sel_hi:[1,1,0] neg_lo:[0,0,1] neg_hi:[0,0,1]
  v_pk_fma_f32 v[194:195], v[110:111], v[218:219], v[218:219] op_sel:[0,1,0] op_sel_hi:[1,1,0] neg_lo:[0,0,1] neg_hi:[0,0,1]
  v_pk_fma_f32 v[108:109], v[192:193], v[196:197], v[108:109]
  v_pk_fma_f32 v[110:111], v[194:195], v[198:199], v[110:111]
  v_accvgpr_read_b32 v208, a222
  v_accvgpr_read_b32 v228, a242
  v_accvgpr_read_b32 v209, a223
  v_accvgpr_read_b32 v229, a243
  v_lshlrev_b32_e64 v196, 16, v228
  v_and_b32 v197, 0xffff0000, v228
  v_lshlrev_b32_e64 v198, 16, v229
  v_and_b32 v199, 0xffff0000, v229
  v_lshlrev_b32_e64 v112, 16, v208
  v_and_b32 v113, 0xffff0000, v208
  v_lshlrev_b32_e64 v114, 16, v209
  v_and_b32 v115, 0xffff0000, v209
  v_pk_fma_f32 v[192:193], v[112:113], v[218:219], v[218:219] op_sel:[0,1,0] op_sel_hi:[1,1,0] neg_lo:[0,0,1] neg_hi:[0,0,1]
  v_pk_fma_f32 v[194:195], v[114:115], v[218:219], v[218:219] op_sel:[0,1,0] op_sel_hi:[1,1,0] neg_lo:[0,0,1] neg_hi:[0,0,1]
  v_pk_fma_f32 v[112:113], v[192:193], v[196:197], v[112:113]
  v_pk_fma_f32 v[114:115], v[194:195], v[198:199], v[114:115]
  v_accvgpr_read_b32 v208, a224
  v_accvgpr_read_b32 v228, a244
  v_accvgpr_read_b32 v209, a225
  v_accvgpr_read_b32 v229, a245
  v_lshlrev_b32_e64 v196, 16, v228
  v_and_b32 v197, 0xffff0000, v228
  v_lshlrev_b32_e64 v198, 16, v229
  v_and_b32 v199, 0xffff0000, v229
  v_lshlrev_b32_e64 v116, 16, v208
  v_and_b32 v117, 0xffff0000, v208
  v_lshlrev_b32_e64 v118, 16, v209
  v_and_b32 v119, 0xffff0000, v209
  v_pk_fma_f32 v[192:193], v[116:117], v[218:219], v[218:219] op_sel:[0,1,0] op_sel_hi:[1,1,0] neg_lo:[0,0,1] neg_hi:[0,0,1]
  v_pk_fma_f32 v[194:195], v[118:119], v[218:219], v[218:219] op_sel:[0,1,0] op_sel_hi:[1,1,0] neg_lo:[0,0,1] neg_hi:[0,0,1]
  v_pk_fma_f32 v[116:117], v[192:193], v[196:197], v[116:117]
  v_pk_fma_f32 v[118:119], v[194:195], v[198:199], v[118:119]
  v_accvgpr_read_b32 v208, a226
  v_accvgpr_read_b32 v228, a246
  v_accvgpr_read_b32 v209, a227
  v_accvgpr_read_b32 v229, a247
  v_lshlrev_b32_e64 v196, 16, v228
  v_and_b32 v197, 0xffff0000, v228
  v_lshlrev_b32_e64 v198, 16, v229
  v_and_b32 v199, 0xffff0000, v229
  v_lshlrev_b32_e64 v120, 16, v208
  v_and_b32 v121, 0xffff0000, v208
  v_lshlrev_b32_e64 v122, 16, v209
  v_and_b32 v123, 0xffff0000, v209
  v_pk_fma_f32 v[192:193], v[120:121], v[218:219], v[218:219] op_sel:[0,1,0] op_sel_hi:[1,1,0] neg_lo:[0,0,1] neg_hi:[0,0,1]
  v_pk_fma_f32 v[194:195], v[122:123], v[218:219], v[218:219] op_sel:[0,1,0] op_sel_hi:[1,1,0] neg_lo:[0,0,1] neg_hi:[0,0,1]
  v_pk_fma_f32 v[120:121], v[192:193], v[196:197], v[120:121]
  v_pk_fma_f32 v[122:123], v[194:195], v[198:199], v[122:123]
  v_accvgpr_read_b32 v208, a228
  v_accvgpr_read_b32 v228, a248
  v_accvgpr_read_b32 v209, a229
  v_accvgpr_read_b32 v229, a249
  v_lshlrev_b32_e64 v196, 16, v228
  v_and_b32 v197, 0xffff0000, v228
  v_lshlrev_b32_e64 v198, 16, v229
  v_and_b32 v199, 0xffff0000, v229
  v_lshlrev_b32_e64 v124, 16, v208
  v_and_b32 v125, 0xffff0000, v208
  v_lshlrev_b32_e64 v126, 16, v209
  v_and_b32 v127, 0xffff0000, v209
  v_pk_fma_f32 v[192:193], v[124:125], v[218:219], v[218:219] op_sel:[0,1,0] op_sel_hi:[1,1,0] neg_lo:[0,0,1] neg_hi:[0,0,1]
  v_pk_fma_f32 v[194:195], v[126:127], v[218:219], v[218:219] op_sel:[0,1,0] op_sel_hi:[1,1,0] neg_lo:[0,0,1] neg_hi:[0,0,1]
  v_pk_fma_f32 v[124:125], v[192:193], v[196:197], v[124:125]
  v_pk_fma_f32 v[126:127], v[194:195], v[198:199], v[126:127]
  v_lshrrev_b32 v11, 3, v1
  v_and_b32 v12, 7, v1
  v_lshrrev_b32 v13, 1, v11
  v_lshlrev_b32 v13, 1, v13
  s_movk_i32 s15, 0x78
  v_bfe_u32 v13, s15, v13, 2
  v_xor_b32 v12, v12, v13
  v_mul_u32_u24 v11, 1280, v11
  v_lshl_add_u32 v244, v12, 4, v11
  v_xor_b32_e64 v245, 64, v244
  s_mul_i32 s12, s4, 51200
  s_mul_i32 s23, s7, 6144
  s_mul_i32 s14, s7, 3
  s_add_u32 s14, s14, 0
  s_mul_i32 s15, s14, 205
  s_lshr_b32 s15, s15, 10
  s_mul_i32 s13, s15, 5
  s_sub_u32 s14, s14, s13
  s_mul_i32 s14, s14, 10240
  s_lshl_b32 s15, s15, 7
  s_add_u32 s14, s14, s15
  s_add_u32 s20, s14, s12
  s_mul_i32 s14, s7, 3
  s_add_u32 s14, s14, 1
  s_mul_i32 s15, s14, 205
  s_lshr_b32 s15, s15, 10
  s_mul_i32 s13, s15, 5
  s_sub_u32 s14, s14, s13
  s_mul_i32 s14, s14, 10240
  s_lshl_b32 s15, s15, 7
  s_add_u32 s14, s14, s15
  s_add_u32 s21, s14, s12
  s_mul_i32 s14, s7, 3
  s_add_u32 s14, s14, 2
  s_mul_i32 s15, s14, 205
  s_lshr_b32 s15, s15, 10
  s_mul_i32 s13, s15, 5
  s_sub_u32 s14, s14, s13
  s_mul_i32 s14, s14, 10240
  s_lshl_b32 s15, s15, 7
  s_add_u32 s14, s14, s15
  s_add_u32 s22, s14, s12
  s_mul_i32 s24, s6, 327680
  s_lshl_b32 s25, s5, 7
  s_add_u32 s24, s24, s25
  s_lshr_b32 s25, s7, 1
  s_lshl_b32 s25, s25, 6
  s_add_u32 s24, s24, s25
  s_add_u32 s24, s24, 19922944
  s_mul_i32 s25, s7, 6144
  v_lshrrev_b32 v205, 2, v1
  v_lshlrev_b32 v205, 12, v205
  v_and_b32 v12, 3, v1
  v_lshl_add_u32 v205, v12, 4, v205
  v_and_b32 v204, 31, v1
  v_lshlrev_b32 v204, 4, v204
  s_mul_i32 s13, s5, 163840
  s_mul_i32 s14, s7, 10240
  s_add_u32 s13, s13, s14
  s_add_u32 s13, s13, 10485760
  s_add_u32 s14, s7, 1
  s_and_b32 s14, s14, 3
  s_mul_i32 s15, s14, 40960
  s_add_u32 s36, s15, s13
  s_mul_i32 s15, s14, 15360
  s_add_u32 s15, s15, 102400
  v_add_u32 v44, s15, v2
  s_add_u32 s14, s7, 2
  s_and_b32 s14, s14, 3
  s_mul_i32 s15, s14, 40960
  s_add_u32 s37, s15, s13
  s_mul_i32 s15, s14, 15360
  s_add_u32 s15, s15, 107520
  v_add_u32 v45, s15, v2
  s_add_u32 s14, s7, 3
  s_and_b32 s14, s14, 3
  s_mul_i32 s15, s14, 40960
  s_add_u32 s38, s15, s13
  s_mul_i32 s15, s14, 15360
  s_add_u32 s15, s15, 112640
  v_add_u32 v46, s15, v2
  s_add_u32 s14, s7, 4
  s_and_b32 s14, s14, 3
  s_mul_i32 s15, s14, 40960
  s_add_u32 s39, s15, s13
  s_lshl_b32 s15, s3, 8
  s_lshl_b32 s13, s7, 6
  s_add_u32 s15, s15, s13
  s_and_b32 s13, s5, 1
  s_lshl_b32 s13, s13, 3
  s_add_u32 s15, s15, s13
  s_add_u32 s15, s15, 12288
  v_and_b32 v242, 3, v1
  v_lshlrev_b32 v242, 4, v242
  s_barrier
poll_38:
  buffer_load_dwordx2 v[42:43], v242, s[52:55], s15 offen sc1
  s_waitcnt vmcnt(0)
  v_xor_b32 v15, s8, v42
  v_xor_b32 v14, s8, v43
  v_or_b32 v15, v15, v14
  v_cmp_ne_u32 vcc, 0, v15
  s_cbranch_vccnz retry_39
giveup_40:
  buffer_load_dwordx4 v[128:131], v2, s[52:55], s36 offen offset:0 sc1
  buffer_load_dwordx4 v[132:135], v2, s[52:55], s36 offen offset:1024 sc1
  buffer_load_dwordx4 v[136:139], v2, s[52:55], s36 offen offset:2048 sc1
  buffer_load_dwordx4 v[140:143], v2, s[52:55], s36 offen offset:3072 sc1
  s_add_u32 s36, s36, 4096
  buffer_load_dwordx4 v[144:147], v2, s[52:55], s36 offen offset:0 sc1
  buffer_load_dwordx4 v[148:151], v2, s[52:55], s36 offen offset:1024 sc1
  buffer_load_dwordx4 v[152:155], v2, s[52:55], s36 offen offset:2048 sc1
  buffer_load_dwordx4 v[156:159], v2, s[52:55], s36 offen offset:3072 sc1
  s_waitcnt vmcnt(7)
  v_mfma_f32_16x16x32_bf16 v[48:51], a[0:3], v[128:131], 0
  s_add_u32 s36, s36, 4096
  buffer_load_dwordx4 v[160:163], v2, s[52:55], s36 offen offset:0 sc1
  v_mfma_f32_16x16x32_bf16 v[52:55], a[4:7], v[128:131], 0
  v_mfma_f32_16x16x32_bf16 v[56:59], a[8:11], v[128:131], 0
  v_mfma_f32_16x16x32_bf16 v[60:63], a[12:15], v[128:131], 0
  v_mfma_f32_16x16x32_bf16 v[64:67], a[16:19], v[128:131], 0
  s_waitcnt vmcnt(7)
  v_mfma_f32_16x16x32_bf16 v[48:51], a[20:23], v[132:135], v[48:51]
  buffer_load_dwordx4 v[164:167], v2, s[52:55], s36 offen offset:1024 sc1
  v_mfma_f32_16x16x32_bf16 v[52:55], a[24:27], v[132:135], v[52:55]
  v_mfma_f32_16x16x32_bf16 v[56:59], a[28:31], v[132:135], v[56:59]
  v_mfma_f32_16x16x32_bf16 v[60:63], a[32:35], v[132:135], v[60:63]
  v_mfma_f32_16x16x32_bf16 v[64:67], a[36:39], v[132:135], v[64:67]
  s_waitcnt vmcnt(7)
  v_mfma_f32_16x16x32_bf16 v[48:51], a[40:43], v[136:139], v[48:51]
  buffer_load_dwordx4 v[168:171], v2, s[52:55], s37 offen offset:0 sc1
  v_mfma_f32_16x16x32_bf16 v[52:55], a[44:47], v[136:139], v[52:55]
  v_mfma_f32_16x16x32_bf16 v[56:59], a[48:51], v[136:139], v[56:59]
  v_mfma_f32_16x16x32_bf16 v[60:63], a[52:55], v[136:139], v[60:63]
  v_mfma_f32_16x16x32_bf16 v[64:67], a[56:59], v[136:139], v[64:67]
  s_waitcnt vmcnt(7)
  v_mfma_f32_16x16x32_bf16 v[48:51], a[60:63], v[140:143], v[48:51]
  buffer_load_dwordx4 v[172:175], v2, s[52:55], s37 offen offset:1024 sc1
  v_mfma_f32_16x16x32_bf16 v[52:55], a[64:67], v[140:143], v[52:55]
  v_mfma_f32_16x16x32_bf16 v[56:59], a[68:71], v[140:143], v[56:59]
  v_mfma_f32_16x16x32_bf16 v[60:63], a[72:75], v[140:143], v[60:63]
  v_mfma_f32_16x16x32_bf16 v[64:67], a[76:79], v[140:143], v[64:67]
  s_waitcnt vmcnt(7)
  v_mfma_f32_16x16x32_bf16 v[48:51], a[80:83], v[144:147], v[48:51]
  buffer_load_dwordx4 v[176:179], v2, s[52:55], s37 offen offset:2048 sc1
  v_mfma_f32_16x16x32_bf16 v[52:55], a[84:87], v[144:147], v[52:55]
  v_mfma_f32_16x16x32_bf16 v[56:59], a[88:91], v[144:147], v[56:59]
  v_mfma_f32_16x16x32_bf16 v[60:63], a[92:95], v[144:147], v[60:63]
  v_mfma_f32_16x16x32_bf16 v[64:67], a[96:99], v[144:147], v[64:67]
  s_waitcnt vmcnt(7)
  v_mfma_f32_16x16x32_bf16 v[48:51], a[100:103], v[148:151], v[48:51]
  buffer_load_dwordx4 v[180:183], v2, s[52:55], s37 offen offset:3072 sc1
  v_mfma_f32_16x16x32_bf16 v[52:55], a[104:107], v[148:151], v[52:55]
  v_mfma_f32_16x16x32_bf16 v[56:59], a[108:111], v[148:151], v[56:59]
  v_mfma_f32_16x16x32_bf16 v[60:63], a[112:115], v[148:151], v[60:63]
  v_mfma_f32_16x16x32_bf16 v[64:67], a[116:119], v[148:151], v[64:67]
  s_waitcnt vmcnt(7)
  v_mfma_f32_16x16x32_bf16 v[48:51], a[120:123], v[152:155], v[48:51]
  s_add_u32 s37, s37, 4096
  buffer_load_dwordx4 v[184:187], v2, s[52:55], s37 offen offset:0 sc1
  v_mfma_f32_16x16x32_bf16 v[52:55], a[124:127], v[152:155], v[52:55]
  v_mfma_f32_16x16x32_bf16 v[56:59], a[128:131], v[152:155], v[56:59]
  v_mfma_f32_16x16x32_bf16 v[60:63], a[132:135], v[152:155], v[60:63]
  v_mfma_f32_16x16x32_bf16 v[64:67], a[136:139], v[152:155], v[64:67]
  s_waitcnt vmcnt(7)
  v_mfma_f32_16x16x32_bf16 v[48:51], a[140:143], v[156:159], v[48:51]
  buffer_load_dwordx4 v[188:191], v2, s[52:55], s37 offen offset:1024 sc1
  v_mfma_f32_16x16x32_bf16 v[52:55], a[144:147], v[156:159], v[52:55]
  v_mfma_f32_16x16x32_bf16 v[56:59], a[148:151], v[156:159], v[56:59]
  v_mfma_f32_16x16x32_bf16 v[60:63], a[152:155], v[156:159], v[60:63]
  v_mfma_f32_16x16x32_bf16 v[64:67], a[156:159], v[156:159], v[64:67]
  s_waitcnt vmcnt(7)
  v_mfma_f32_16x16x32_bf16 v[48:51], a[160:163], v[160:163], v[48:51]
  buffer_load_dwordx4 v[128:131], v2, s[52:55], s37 offen offset:2048 sc1
  v_mfma_f32_16x16x32_bf16 v[52:55], a[164:167], v[160:163], v[52:55]
  v_mfma_f32_16x16x32_bf16 v[56:59], a[168:171], v[160:163], v[56:59]
  v_mfma_f32_16x16x32_bf16 v[60:63], a[172:175], v[160:163], v[60:63]
  v_mfma_f32_16x16x32_bf16 v[64:67], a[176:179], v[160:163], v[64:67]
  s_waitcnt vmcnt(7)
  v_mfma_f32_16x16x32_bf16 v[48:51], a[180:183], v[164:167], v[48:51]
  buffer_load_dwordx4 v[132:135], v2, s[52:55], s37 offen offset:3072 sc1
  v_mfma_f32_16x16x32_bf16 v[52:55], a[184:187], v[164:167], v[52:55]
  v_mfma_f32_16x16x32_bf16 v[56:59], a[188:191], v[164:167], v[56:59]
  v_mfma_f32_16x16x32_bf16 v[60:63], a[192:195], v[164:167], v[60:63]
  v_mfma_f32_16x16x32_bf16 v[64:67], a[196:199], v[164:167], v[64:67]
  s_waitcnt vmcnt(7)
  v_mfma_f32_16x16x32_bf16 v[68:71], a[0:3], v[168:171], 0
  s_add_u32 s37, s37, 4096
  buffer_load_dwordx4 v[136:139], v2, s[52:55], s37 offen offset:0 sc1
  v_mfma_f32_16x16x32_bf16 v[72:75], a[4:7], v[168:171], 0
  v_mfma_f32_16x16x32_bf16 v[76:79], a[8:11], v[168:171], 0
  v_mfma_f32_16x16x32_bf16 v[80:83], a[12:15], v[168:171], 0
  v_mfma_f32_16x16x32_bf16 v[84:87], a[16:19], v[168:171], 0
  s_waitcnt vmcnt(7)
  v_mfma_f32_16x16x32_bf16 v[68:71], a[20:23], v[172:175], v[68:71]
  ds_write_b128 v44, v[48:51] offset:0
  buffer_load_dwordx4 v[140:143], v2, s[52:55], s37 offen offset:1024 sc1
  v_mfma_f32_16x16x32_bf16 v[72:75], a[24:27], v[172:175], v[72:75]
  ds_write_b128 v44, v[52:55] offset:1024
  v_mfma_f32_16x16x32_bf16 v[76:79], a[28:31], v[172:175], v[76:79]
  ds_write_b128 v44, v[56:59] offset:2048
  v_mfma_f32_16x16x32_bf16 v[80:83], a[32:35], v[172:175], v[80:83]
  ds_write_b128 v44, v[60:63] offset:3072
  v_mfma_f32_16x16x32_bf16 v[84:87], a[36:39], v[172:175], v[84:87]
  ds_write_b128 v44, v[64:67] offset:4096
  s_waitcnt vmcnt(7)
  v_mfma_f32_16x16x32_bf16 v[68:71], a[40:43], v[176:179], v[68:71]
  buffer_load_dwordx4 v[144:147], v2, s[52:55], s38 offen offset:0 sc1
  v_mfma_f32_16x16x32_bf16 v[72:75], a[44:47], v[176:179], v[72:75]
  v_mfma_f32_16x16x32_bf16 v[76:79], a[48:51], v[176:179], v[76:79]
  v_mfma_f32_16x16x32_bf16 v[80:83], a[52:55], v[176:179], v[80:83]
  v_mfma_f32_16x16x32_bf16 v[84:87], a[56:59], v[176:179], v[84:87]
  s_waitcnt vmcnt(7)
  v_mfma_f32_16x16x32_bf16 v[68:71], a[60:63], v[180:183], v[68:71]
  buffer_load_dwordx4 v[148:151], v2, s[52:55], s38 offen offset:1024 sc1
  v_mfma_f32_16x16x32_bf16 v[72:75], a[64:67], v[180:183], v[72:75]
  v_mfma_f32_16x16x32_bf16 v[76:79], a[68:71], v[180:183], v[76:79]
  v_mfma_f32_16x16x32_bf16 v[80:83], a[72:75], v[180:183], v[80:83]
  v_mfma_f32_16x16x32_bf16 v[84:87], a[76:79], v[180:183], v[84:87]
  s_waitcnt vmcnt(7)
  v_mfma_f32_16x16x32_bf16 v[68:71], a[80:83], v[184:187], v[68:71]
  buffer_load_dwordx4 v[152:155], v2, s[52:55], s38 offen offset:2048 sc1
  v_mfma_f32_16x16x32_bf16 v[72:75], a[84:87], v[184:187], v[72:75]
  v_mfma_f32_16x16x32_bf16 v[76:79], a[88:91], v[184:187], v[76:79]
  v_mfma_f32_16x16x32_bf16 v[80:83], a[92:95], v[184:187], v[80:83]
  v_mfma_f32_16x16x32_bf16 v[84:87], a[96:99], v[184:187], v[84:87]
  s_waitcnt vmcnt(7)
  v_mfma_f32_16x16x32_bf16 v[68:71], a[100:103], v[188:191], v[68:71]
  buffer_load_dwordx4 v[156:159], v2, s[52:55], s38 offen offset:3072 sc1
  v_mfma_f32_16x16x32_bf16 v[72:75], a[104:107], v[188:191], v[72:75]
  v_mfma_f32_16x16x32_bf16 v[76:79], a[108:111], v[188:191], v[76:79]
  v_mfma_f32_16x16x32_bf16 v[80:83], a[112:115], v[188:191], v[80:83]
  v_mfma_f32_16x16x32_bf16 v[84:87], a[116:119], v[188:191], v[84:87]
  s_waitcnt vmcnt(7)
  v_mfma_f32_16x16x32_bf16 v[68:71], a[120:123], v[128:131], v[68:71]
  s_add_u32 s38, s38, 4096
  buffer_load_dwordx4 v[160:163], v2, s[52:55], s38 offen offset:0 sc1
  v_mfma_f32_16x16x32_bf16 v[72:75], a[124:127], v[128:131], v[72:75]
  s_and_b32 s13, s17, 0xe00
  s_add_u32 s13, s13, 24576
  buffer_load_dwordx4 v[200:203], v204, s[52:55], s13 offen sc1
  v_mfma_f32_16x16x32_bf16 v[76:79], a[128:131], v[128:131], v[76:79]
  v_mfma_f32_16x16x32_bf16 v[80:83], a[132:135], v[128:131], v[80:83]
  v_mfma_f32_16x16x32_bf16 v[84:87], a[136:139], v[128:131], v[84:87]
  s_waitcnt vmcnt(8)
  v_mfma_f32_16x16x32_bf16 v[68:71], a[140:143], v[132:135], v[68:71]
  buffer_load_dwordx4 v[164:167], v2, s[52:55], s38 offen offset:1024 sc1
  v_mfma_f32_16x16x32_bf16 v[72:75], a[144:147], v[132:135], v[72:75]
  v_mfma_f32_16x16x32_bf16 v[76:79], a[148:151], v[132:135], v[76:79]
  v_mfma_f32_16x16x32_bf16 v[80:83], a[152:155], v[132:135], v[80:83]
  v_mfma_f32_16x16x32_bf16 v[84:87], a[156:159], v[132:135], v[84:87]
  s_waitcnt vmcnt(8)
  v_mfma_f32_16x16x32_bf16 v[68:71], a[160:163], v[136:139], v[68:71]
  buffer_load_dwordx4 v[168:171], v2, s[52:55], s38 offen offset:2048 sc1
  v_mfma_f32_16x16x32_bf16 v[72:75], a[164:167], v[136:139], v[72:75]
  v_mfma_f32_16x16x32_bf16 v[76:79], a[168:171], v[136:139], v[76:79]
  v_mfma_f32_16x16x32_bf16 v[80:83], a[172:175], v[136:139], v[80:83]
  v_mfma_f32_16x16x32_bf16 v[84:87], a[176:179], v[136:139], v[84:87]
  s_waitcnt vmcnt(8)
  v_mfma_f32_16x16x32_bf16 v[68:71], a[180:183], v[140:143], v[68:71]
  buffer_load_dwordx4 v[172:175], v2, s[52:55], s38 offen offset:3072 sc1
  v_mfma_f32_16x16x32_bf16 v[72:75], a[184:187], v[140:143], v[72:75]
  v_mfma_f32_16x16x32_bf16 v[76:79], a[188:191], v[140:143], v[76:79]
  v_mfma_f32_16x16x32_bf16 v[80:83], a[192:195], v[140:143], v[80:83]
  v_mfma_f32_16x16x32_bf16 v[84:87], a[196:199], v[140:143], v[84:87]
  s_waitcnt vmcnt(8)
  v_mfma_f32_16x16x32_bf16 v[48:51], a[0:3], v[144:147], 0
  s_add_u32 s38, s38, 4096
  buffer_load_dwordx4 v[176:179], v2, s[52:55], s38 offen offset:0 sc1
  v_mfma_f32_16x16x32_bf16 v[52:55], a[4:7], v[144:147], 0
  v_mfma_f32_16x16x32_bf16 v[56:59], a[8:11], v[144:147], 0
  v_mfma_f32_16x16x32_bf16 v[60:63], a[12:15], v[144:147], 0
  v_mfma_f32_16x16x32_bf16 v[64:67], a[16:19], v[144:147], 0
  s_waitcnt vmcnt(8)
  v_mfma_f32_16x16x32_bf16 v[48:51], a[20:23], v[148:151], v[48:51]
  ds_write_b128 v45, v[68:71] offset:0
  buffer_load_dwordx4 v[180:183], v2, s[52:55], s38 offen offset:1024 sc1
  v_mfma_f32_16x16x32_bf16 v[52:55], a[24:27], v[148:151], v[52:55]
  ds_write_b128 v45, v[72:75] offset:1024
  v_mfma_f32_16x16x32_bf16 v[56:59], a[28:31], v[148:151], v[56:59]
  ds_write_b128 v45, v[76:79] offset:2048
  v_mfma_f32_16x16x32_bf16 v[60:63], a[32:35], v[148:151], v[60:63]
  ds_write_b128 v45, v[80:83] offset:3072
  v_mfma_f32_16x16x32_bf16 v[64:67], a[36:39], v[148:151], v[64:67]
  ds_write_b128 v45, v[84:87] offset:4096
  s_waitcnt vmcnt(8)
  v_mfma_f32_16x16x32_bf16 v[48:51], a[40:43], v[152:155], v[48:51]
  buffer_load_dwordx4 v[184:187], v2, s[52:55], s39 offen offset:0 sc1
  v_mfma_f32_16x16x32_bf16 v[52:55], a[44:47], v[152:155], v[52:55]
  v_mfma_f32_16x16x32_bf16 v[56:59], a[48:51], v[152:155], v[56:59]
  v_mfma_f32_16x16x32_bf16 v[60:63], a[52:55], v[152:155], v[60:63]
  v_mfma_f32_16x16x32_bf16 v[64:67], a[56:59], v[152:155], v[64:67]
  s_waitcnt vmcnt(8)
  v_mfma_f32_16x16x32_bf16 v[48:51], a[60:63], v[156:159], v[48:51]
  buffer_load_dwordx4 v[188:191], v2, s[52:55], s39 offen offset:1024 sc1
  v_mfma_f32_16x16x32_bf16 v[52:55], a[64:67], v[156:159], v[52:55]
  v_mfma_f32_16x16x32_bf16 v[56:59], a[68:71], v[156:159], v[56:59]
  v_mfma_f32_16x16x32_bf16 v[60:63], a[72:75], v[156:159], v[60:63]
  v_mfma_f32_16x16x32_bf16 v[64:67], a[76:79], v[156:159], v[64:67]
  s_waitcnt vmcnt(8)
  v_mfma_f32_16x16x32_bf16 v[48:51], a[80:83], v[160:163], v[48:51]
  buffer_load_dwordx4 v[128:131], v2, s[52:55], s39 offen offset:2048 sc1
  v_mfma_f32_16x16x32_bf16 v[52:55], a[84:87], v[160:163], v[52:55]
  v_mfma_f32_16x16x32_bf16 v[56:59], a[88:91], v[160:163], v[56:59]
  v_mfma_f32_16x16x32_bf16 v[60:63], a[92:95], v[160:163], v[60:63]
  v_mfma_f32_16x16x32_bf16 v[64:67], a[96:99], v[160:163], v[64:67]
  s_waitcnt vmcnt(7)
  v_mfma_f32_16x16x32_bf16 v[48:51], a[100:103], v[164:167], v[48:51]
  buffer_load_dwordx4 v[132:135], v2, s[52:55], s39 offen offset:3072 sc1
  v_mfma_f32_16x16x32_bf16 v[52:55], a[104:107], v[164:167], v[52:55]
  v_mfma_f32_16x16x32_bf16 v[56:59], a[108:111], v[164:167], v[56:59]
  v_mfma_f32_16x16x32_bf16 v[60:63], a[112:115], v[164:167], v[60:63]
  v_mfma_f32_16x16x32_bf16 v[64:67], a[116:119], v[164:167], v[64:67]
  s_waitcnt vmcnt(7)
  v_mfma_f32_16x16x32_bf16 v[48:51], a[120:123], v[168:171], v[48:51]
  s_add_u32 s39, s39, 4096
  buffer_load_dwordx4 v[136:139], v2, s[52:55], s39 offen offset:0 sc1
  v_mfma_f32_16x16x32_bf16 v[52:55], a[124:127], v[168:171], v[52:55]
  v_mfma_f32_16x16x32_bf16 v[56:59], a[128:131], v[168:171], v[56:59]
  v_mfma_f32_16x16x32_bf16 v[60:63], a[132:135], v[168:171], v[60:63]
  v_mfma_f32_16x16x32_bf16 v[64:67], a[136:139], v[168:171], v[64:67]
  s_waitcnt vmcnt(7)
  v_mfma_f32_16x16x32_bf16 v[48:51], a[140:143], v[172:175], v[48:51]
  buffer_load_dwordx4 v[140:143], v2, s[52:55], s39 offen offset:1024 sc1
  v_mfma_f32_16x16x32_bf16 v[52:55], a[144:147], v[172:175], v[52:55]
  v_mfma_f32_16x16x32_bf16 v[56:59], a[148:151], v[172:175], v[56:59]
  v_mfma_f32_16x16x32_bf16 v[60:63], a[152:155], v[172:175], v[60:63]
  v_mfma_f32_16x16x32_bf16 v[64:67], a[156:159], v[172:175], v[64:67]
  s_waitcnt vmcnt(7)
  v_mfma_f32_16x16x32_bf16 v[48:51], a[160:163], v[176:179], v[48:51]
  buffer_load_dwordx4 v[144:147], v2, s[52:55], s39 offen offset:2048 sc1
  v_mfma_f32_16x16x32_bf16 v[52:55], a[164:167], v[176:179], v[52:55]
  v_mfma_f32_16x16x32_bf16 v[56:59], a[168:171], v[176:179], v[56:59]
  v_mfma_f32_16x16x32_bf16 v[60:63], a[172:175], v[176:179], v[60:63]
  v_mfma_f32_16x16x32_bf16 v[64:67], a[176:179], v[176:179], v[64:67]
  s_waitcnt vmcnt(7)
  v_mfma_f32_16x16x32_bf16 v[48:51], a[180:183], v[180:183], v[48:51]
  buffer_load_dwordx4 v[148:151], v2, s[52:55], s39 offen offset:3072 sc1
  v_mfma_f32_16x16x32_bf16 v[52:55], a[184:187], v[180:183], v[52:55]
  v_mfma_f32_16x16x32_bf16 v[56:59], a[188:191], v[180:183], v[56:59]
  v_mfma_f32_16x16x32_bf16 v[60:63], a[192:195], v[180:183], v[60:63]
  v_mfma_f32_16x16x32_bf16 v[64:67], a[196:199], v[180:183], v[64:67]
  s_waitcnt vmcnt(7)
  v_mfma_f32_16x16x32_bf16 v[68:71], a[0:3], v[184:187], v[108:111]
  s_add_u32 s39, s39, 4096
  buffer_load_dwordx4 v[152:155], v2, s[52:55], s39 offen offset:0 sc1
  v_mfma_f32_16x16x32_bf16 v[72:75], a[4:7], v[184:187], v[112:115]
  s_mul_i32 s15, s7, 15360
  v_mfma_f32_16x16x32_bf16 v[76:79], a[8:11], v[184:187], v[116:119]
  s_add_u32 s15, s15, 102400
  v_mfma_f32_16x16x32_bf16 v[80:83], a[12:15], v[184:187], v[120:123]
  v_add_u32_e64 v47, s15, v2
  v_mfma_f32_16x16x32_bf16 v[84:87], a[16:19], v[184:187], v[124:127]
  s_waitcnt vmcnt(7)
  v_mfma_f32_16x16x32_bf16 v[68:71], a[20:23], v[188:191], v[68:71]
  ds_write_b128 v46, v[48:51] offset:0
  buffer_load_dwordx4 v[156:159], v2, s[52:55], s39 offen offset:1024 sc1
  v_mfma_f32_16x16x32_bf16 v[72:75], a[24:27], v[188:191], v[72:75]
  ds_write_b128 v46, v[52:55] offset:1024
  v_mfma_f32_16x16x32_bf16 v[76:79], a[28:31], v[188:191], v[76:79]
  ds_write_b128 v46, v[56:59] offset:2048
  v_mfma_f32_16x16x32_bf16 v[80:83], a[32:35], v[188:191], v[80:83]
  ds_write_b128 v46, v[60:63] offset:3072
  v_mfma_f32_16x16x32_bf16 v[84:87], a[36:39], v[188:191], v[84:87]
  ds_write_b128 v46, v[64:67] offset:4096
  s_waitcnt vmcnt(7)
  v_mfma_f32_16x16x32_bf16 v[68:71], a[40:43], v[128:131], v[68:71]
  s_waitcnt vmcnt(15)
  v_xor_b32 v15, s8, v200
  v_xor_b32 v14, s8, v201
  v_or_b32 v15, v15, v14
  v_xor_b32 v14, s8, v202
  v_or_b32 v15, v15, v14
  v_xor_b32 v14, s8, v203
  v_or_b32 v15, v15, v14
  v_cmp_ne_u32 vcc, 0, v15
  s_cbranch_vccnz again_41
ok_42:
  v_mfma_f32_16x16x32_bf16 v[72:75], a[44:47], v[128:131], v[72:75]
  s_add_u32 m0, s25, 0
  s_nop 0
  buffer_load_dwordx4 v205, s[52:55], s24 offen sc1 lds
  s_add_u32 s24, s24, 65536
  v_mfma_f32_16x16x32_bf16 v[76:79], a[48:51], v[128:131], v[76:79]
  s_add_u32 m0, s25, 1024
  s_nop 0
  buffer_load_dwordx4 v205, s[52:55], s24 offen sc1 lds
  s_add_u32 s24, s24, 65536
  v_mfma_f32_16x16x32_bf16 v[80:83], a[52:55], v[128:131], v[80:83]
  s_add_u32 m0, s25, 2048
  s_nop 0
  buffer_load_dwordx4 v205, s[52:55], s24 offen sc1 lds
  s_add_u32 s24, s24, 65536
  v_mfma_f32_16x16x32_bf16 v[84:87], a[56:59], v[128:131], v[84:87]
  s_waitcnt vmcnt(9)
  v_mfma_f32_16x16x32_bf16 v[68:71], a[60:63], v[132:135], v[68:71]
  s_add_u32 m0, s25, 3072
  s_nop 0
  buffer_load_dwordx4 v205, s[52:55], s24 offen sc1 lds
  s_add_u32 s24, s24, 65536
  v_mfma_f32_16x16x32_bf16 v[72:75], a[64:67], v[132:135], v[72:75]
  s_add_u32 m0, s25, 4096
  s_nop 0
  buffer_load_dwordx4 v205, s[52:55], s24 offen sc1 lds
  s_add_u32 s24, s24, 65536
  v_mfma_f32_16x16x32_bf16 v[76:79], a[68:71], v[132:135], v[76:79]
  v_mfma_f32_16x16x32_bf16 v[80:83], a[72:75], v[132:135], v[80:83]
  v_mfma_f32_16x16x32_bf16 v[84:87], a[76:79], v[132:135], v[84:87]
  s_waitcnt vmcnt(10)
  v_mfma_f32_16x16x32_bf16 v[68:71], a[80:83], v[136:139], v[68:71]
  s_and_b32 s12, s7, 1
  s_lshl_b32 s12, s12, 3
  s_add_u32 s12, s12, s25
  v_mfma_f32_16x16x32_bf16 v[72:75], a[84:87], v[136:139], v[72:75]
  v_add_u32 v205, s12, v2
  s_waitcnt lgkmcnt(0)
  v_mfma_f32_16x16x32_bf16 v[76:79], a[88:91], v[136:139], v[76:79]
  s_barrier
  ds_read_b128 v[206:209], v47 offset:0
  v_mfma_f32_16x16x32_bf16 v[80:83], a[92:95], v[136:139], v[80:83]
  ds_read_b128 v[210:213], v47 offset:1024
  ds_read_b128 v[214:217], v47 offset:2048
  v_mfma_f32_16x16x32_bf16 v[84:87], a[96:99], v[136:139], v[84:87]
  ds_read_b128 v[218:221], v47 offset:3072
  ds_read_b128 v[222:225], v47 offset:4096
  s_waitcnt vmcnt(9)
  v_mfma_f32_16x16x32_bf16 v[68:71], a[100:103], v[140:143], v[68:71]
  ds_read_b128 v[160:163], v47 offset:5120
  ds_read_b128 v[164:167], v47 offset:6144
  v_mfma_f32_16x16x32_bf16 v[72:75], a[104:107], v[140:143], v[72:75]
  ds_read_b128 v[168:171], v47 offset:7168
  ds_read_b128 v[172:175], v47 offset:8192
  v_mfma_f32_16x16x32_bf16 v[76:79], a[108:111], v[140:143], v[76:79]
  ds_read_b128 v[176:179], v47 offset:9216
  v_mfma_f32_16x16x32_bf16 v[80:83], a[112:115], v[140:143], v[80:83]
  s_waitcnt lgkmcnt(0)
  v_mfma_f32_16x16x32_bf16 v[84:87], a[116:119], v[140:143], v[84:87]
  v_pk_add_f32 v[206:207], v[206:207], v[160:161]
  s_waitcnt vmcnt(8)
  v_mfma_f32_16x16x32_bf16 v[68:71], a[120:123], v[144:147], v[68:71]
  v_pk_add_f32 v[208:209], v[208:209], v[162:163]
  v_pk_add_f32 v[210:211], v[210:211], v[164:165]
  v_mfma_f32_16x16x32_bf16 v[72:75], a[124:127], v[144:147], v[72:75]
  v_pk_add_f32 v[212:213], v[212:213], v[166:167]
  v_pk_add_f32 v[214:215], v[214:215], v[168:169]
  v_mfma_f32_16x16x32_bf16 v[76:79], a[128:131], v[144:147], v[76:79]
  v_pk_add_f32 v[216:217], v[216:217], v[170:171]
  v_mfma_f32_16x16x32_bf16 v[80:83], a[132:135], v[144:147], v[80:83]
  v_pk_add_f32 v[218:219], v[218:219], v[172:173]
  v_mfma_f32_16x16x32_bf16 v[84:87], a[136:139], v[144:147], v[84:87]
  v_pk_add_f32 v[220:221], v[220:221], v[174:175]
  s_waitcnt vmcnt(7)
  v_mfma_f32_16x16x32_bf16 v[68:71], a[140:143], v[148:151], v[68:71]
  v_pk_add_f32 v[222:223], v[222:223], v[176:177]
  v_pk_add_f32 v[224:225], v[224:225], v[178:179]
  v_mfma_f32_16x16x32_bf16 v[72:75], a[144:147], v[148:151], v[72:75]
  ds_read_b128 v[160:163], v47 offset:10240
  ds_read_b128 v[164:167], v47 offset:11264
  v_mfma_f32_16x16x32_bf16 v[76:79], a[148:151], v[148:151], v[76:79]
  ds_read_b128 v[168:171], v47 offset:12288
  v_mfma_f32_16x16x32_bf16 v[80:83], a[152:155], v[148:151], v[80:83]
  ds_read_b128 v[172:175], v47 offset:13312
  v_mfma_f32_16x16x32_bf16 v[84:87], a[156:159], v[148:151], v[84:87]
  ds_read_b128 v[176:179], v47 offset:14336
  s_waitcnt vmcnt(6)
  v_mfma_f32_16x16x32_bf16 v[68:71], a[160:163], v[152:155], v[68:71]
  s_waitcnt lgkmcnt(0)
  v_pk_add_f32 v[206:207], v[206:207], v[160:161]
  v_mfma_f32_16x16x32_bf16 v[72:75], a[164:167], v[152:155], v[72:75]
  v_pk_add_f32 v[208:209], v[208:209], v[162:163]
  v_pk_add_f32 v[210:211], v[210:211], v[164:165]
  v_mfma_f32_16x16x32_bf16 v[76:79], a[168:171], v[152:155], v[76:79]
  v_pk_add_f32 v[212:213], v[212:213], v[166:167]
  v_mfma_f32_16x16x32_bf16 v[80:83], a[172:175], v[152:155], v[80:83]
  v_pk_add_f32 v[214:215], v[214:215], v[168:169]
  v_mfma_f32_16x16x32_bf16 v[84:87], a[176:179], v[152:155], v[84:87]
  v_pk_add_f32 v[216:217], v[216:217], v[170:171]
  s_waitcnt vmcnt(5)
  v_mfma_f32_16x16x32_bf16 v[68:71], a[180:183], v[156:159], v[68:71]
  v_pk_add_f32 v[218:219], v[218:219], v[172:173]
  v_mfma_f32_16x16x32_bf16 v[72:75], a[184:187], v[156:159], v[72:75]
  v_pk_add_f32 v[220:221], v[220:221], v[174:175]
  v_mfma_f32_16x16x32_bf16 v[76:79], a[188:191], v[156:159], v[76:79]
  v_pk_add_f32 v[222:223], v[222:223], v[176:177]
  v_mfma_f32_16x16x32_bf16 v[80:83], a[192:195], v[156:159], v[80:83]
  v_pk_add_f32 v[224:225], v[224:225], v[178:179]
  v_mfma_f32_16x16x32_bf16 v[84:87], a[196:199], v[156:159], v[84:87]
  v_pk_add_f32 v[68:69], v[68:69], v[206:207]
  v_pk_add_f32 v[70:71], v[70:71], v[208:209]
  v_pk_add_f32 v[72:73], v[72:73], v[210:211]
  v_pk_add_f32 v[74:75], v[74:75], v[212:213]
  v_pk_add_f32 v[76:77], v[76:77], v[214:215]
  v_pk_add_f32 v[78:79], v[78:79], v[216:217]
  v_pk_add_f32 v[80:81], v[80:81], v[218:219]
  v_pk_add_f32 v[82:83], v[82:83], v[220:221]
  v_pk_add_f32 v[84:85], v[84:85], v[222:223]
  v_pk_add_f32 v[86:87], v[86:87], v[224:225]
  s_lshl_b32 s12, s5, 15
  s_lshl_b32 s13, s7, 10
  s_add_u32 s12, s12, s13
  s_add_u32 s12, s12, 1310720
  s_lshl_b32 s13, s6, 12
  s_add_u32 s13, s13, s12
  v_pk_add_f32 v[228:229], v[68:69], v[70:71]
  v_pk_mul_f32 v[230:231], v[68:69], v[68:69]
  v_pk_fma_f32 v[230:231], v[70:71], v[70:71], v[230:231]
  v_pk_add_f32 v[228:229], v[228:229], v[72:73]
  v_pk_fma_f32 v[230:231], v[72:73], v[72:73], v[230:231]
  v_pk_add_f32 v[228:229], v[228:229], v[74:75]
  v_pk_fma_f32 v[230:231], v[74:75], v[74:75], v[230:231]
  v_pk_add_f32 v[228:229], v[228:229], v[76:77]
  v_pk_fma_f32 v[230:231], v[76:77], v[76:77], v[230:231]
  v_pk_add_f32 v[228:229], v[228:229], v[78:79]
  v_pk_fma_f32 v[230:231], v[78:79], v[78:79], v[230:231]
  v_pk_add_f32 v[228:229], v[228:229], v[80:81]
  v_pk_fma_f32 v[230:231], v[80:81], v[80:81], v[230:231]
  v_pk_add_f32 v[228:229], v[228:229], v[82:83]
  v_pk_fma_f32 v[230:231], v[82:83], v[82:83], v[230:231]
  v_pk_add_f32 v[228:229], v[228:229], v[84:85]
  v_pk_fma_f32 v[230:231], v[84:85], v[84:85], v[230:231]
  v_pk_add_f32 v[228:229], v[228:229], v[86:87]
  v_pk_fma_f32 v[230:231], v[86:87], v[86:87], v[230:231]
  s_waitcnt vmcnt(0)
  ds_read_b64_tr_b16 v[246:247], v205 offset:0
  ds_read_b64_tr_b16 v[248:249], v205 offset:1024
  ds_read_b64_tr_b16 v[250:251], v205 offset:2048
  ds_read_b64_tr_b16 v[252:253], v205 offset:3072
  ds_read_b64_tr_b16 v[254:255], v205 offset:4096
  s_waitcnt lgkmcnt(4)
  v_lshlrev_b32_e64 v88, 16, v246
  v_and_b32 v89, 0xffff0000, v246
  v_lshlrev_b32_e64 v90, 16, v247
  v_and_b32 v91, 0xffff0000, v247
  v_pk_mul_f32 v[160:161], v[68:69], v[88:89]
  v_pk_mul_f32 v[242:243], v[88:89], v[88:89]
  v_pk_mul_f32 v[234:235], v[160:161], v[68:69]
  v_pk_mul_f32 v[236:237], v[160:161], v[160:161]
  v_pk_mul_f32 v[238:239], v[160:161], v[88:89]
  v_pk_mul_f32 v[162:163], v[70:71], v[90:91]
  v_pk_add_f32 v[240:241], v[88:89], v[90:91]
  v_pk_fma_f32 v[242:243], v[90:91], v[90:91], v[242:243]
  v_pk_add_f32 v[232:233], v[160:161], v[162:163]
  v_pk_fma_f32 v[234:235], v[162:163], v[70:71], v[234:235]
  v_pk_fma_f32 v[236:237], v[162:163], v[162:163], v[236:237]
  v_pk_fma_f32 v[238:239], v[162:163], v[90:91], v[238:239]
  s_waitcnt lgkmcnt(0)
  v_lshlrev_b32 v92, 16, v248
  v_and_b32 v93, 0xffff0000, v248
  v_lshlrev_b32_e64 v94, 16, v249
  v_and_b32 v95, 0xffff0000, v249
  s_add_u32 m0, s23, 0
  s_nop 0
  buffer_load_dwordx4 v244, s[56:59], s20 offen lds
  v_pk_mul_f32 v[164:165], v[72:73], v[92:93]
  v_pk_add_f32 v[240:241], v[240:241], v[92:93]
  v_pk_fma_f32 v[242:243], v[92:93], v[92:93], v[242:243]
  v_pk_add_f32 v[232:233], v[232:233], v[164:165]
  v_pk_fma_f32 v[234:235], v[164:165], v[72:73], v[234:235]
  v_pk_fma_f32 v[236:237], v[164:165], v[164:165], v[236:237]
  v_pk_fma_f32 v[238:239], v[164:165], v[92:93], v[238:239]
  s_add_u32 m0, s23, 1024
  s_nop 0
  buffer_load_dwordx4 v245, s[60:63], s20 offen lds
  v_pk_mul_f32 v[166:167], v[74:75], v[94:95]
  v_pk_add_f32 v[240:241], v[240:241], v[94:95]
  v_pk_fma_f32 v[242:243], v[94:95], v[94:95], v[242:243]
  v_pk_add_f32 v[232:233], v[232:233], v[166:167]
  v_pk_fma_f32 v[234:235], v[166:167], v[74:75], v[234:235]
  v_pk_fma_f32 v[236:237], v[166:167], v[166:167], v[236:237]
  v_pk_fma_f32 v[238:239], v[166:167], v[94:95], v[238:239]
  s_waitcnt lgkmcnt(0)
  v_lshlrev_b32_e64 v96, 16, v250
  v_and_b32 v97, 0xffff0000, v250
  v_lshlrev_b32_e64 v98, 16, v251
  v_and_b32 v99, 0xffff0000, v251
  s_add_u32 m0, s23, 2048
  s_nop 0
  buffer_load_dwordx4 v244, s[56:59], s21 offen lds
  v_pk_mul_f32 v[168:169], v[76:77], v[96:97]
  v_pk_add_f32 v[240:241], v[240:241], v[96:97]
  v_pk_fma_f32 v[242:243], v[96:97], v[96:97], v[242:243]
  v_pk_add_f32 v[232:233], v[232:233], v[168:169]
  v_pk_fma_f32 v[234:235], v[168:169], v[76:77], v[234:235]
  v_pk_fma_f32 v[236:237], v[168:169], v[168:169], v[236:237]
  v_pk_fma_f32 v[238:239], v[168:169], v[96:97], v[238:239]
  s_add_u32 m0, s23, 3072
  s_nop 0
  buffer_load_dwordx4 v245, s[60:63], s21 offen lds
  v_pk_mul_f32 v[170:171], v[78:79], v[98:99]
  v_pk_add_f32 v[240:241], v[240:241], v[98:99]
  v_pk_fma_f32 v[242:243], v[98:99], v[98:99], v[242:243]
  v_pk_add_f32 v[232:233], v[232:233], v[170:171]
  v_pk_fma_f32 v[234:235], v[170:171], v[78:79], v[234:235]
  v_pk_fma_f32 v[236:237], v[170:171], v[170:171], v[236:237]
  v_pk_fma_f32 v[238:239], v[170:171], v[98:99], v[238:239]
  s_waitcnt lgkmcnt(0)
  v_lshlrev_b32 v100, 16, v252
  v_and_b32 v101, 0xffff0000, v252
  v_lshlrev_b32_e64 v102, 16, v253
  v_and_b32 v103, 0xffff0000, v253
  s_add_u32 m0, s23, 4096
  s_nop 0
  buffer_load_dwordx4 v244, s[56:59], s22 offen lds
  v_pk_mul_f32 v[172:173], v[80:81], v[100:101]
  v_pk_add_f32 v[240:241], v[240:241], v[100:101]
  v_pk_fma_f32 v[242:243], v[100:101], v[100:101], v[242:243]
  v_pk_add_f32 v[232:233], v[232:233], v[172:173]
  v_pk_fma_f32 v[234:235], v[172:173], v[80:81], v[234:235]
  v_pk_fma_f32 v[236:237], v[172:173], v[172:173], v[236:237]
  v_pk_fma_f32 v[238:239], v[172:173], v[100:101], v[238:239]
  s_add_u32 m0, s23, 5120
  s_nop 0
  buffer_load_dwordx4 v245, s[60:63], s22 offen lds
  v_pk_mul_f32 v[174:175], v[82:83], v[102:103]
  v_pk_add_f32 v[240:241], v[240:241], v[102:103]
  v_pk_fma_f32 v[242:243], v[102:103], v[102:103], v[242:243]
  v_pk_add_f32 v[232:233], v[232:233], v[174:175]
  v_pk_fma_f32 v[234:235], v[174:175], v[82:83], v[234:235]
  v_pk_fma_f32 v[236:237], v[174:175], v[174:175], v[236:237]
  v_pk_fma_f32 v[238:239], v[174:175], v[102:103], v[238:239]
  s_waitcnt lgkmcnt(0)
  v_lshlrev_b32 v104, 16, v254
  v_and_b32 v105, 0xffff0000, v254
  v_lshlrev_b32_e64 v106, 16, v255
  v_and_b32 v107, 0xffff0000, v255
  v_pk_mul_f32 v[176:177], v[84:85], v[104:105]
  v_pk_add_f32 v[240:241], v[240:241], v[104:105]
  v_pk_fma_f32 v[242:243], v[104:105], v[104:105], v[242:243]
  v_pk_add_f32 v[232:233], v[232:233], v[176:177]
  v_pk_fma_f32 v[234:235], v[176:177], v[84:85], v[234:235]
  v_pk_fma_f32 v[236:237], v[176:177], v[176:177], v[236:237]
  v_pk_fma_f32 v[238:239], v[176:177], v[104:105], v[238:239]
  v_pk_mul_f32 v[178:179], v[86:87], v[106:107]
  v_pk_add_f32 v[240:241], v[240:241], v[106:107]
  v_pk_fma_f32 v[242:243], v[106:107], v[106:107], v[242:243]
  v_pk_add_f32 v[232:233], v[232:233], v[178:179]
  v_pk_fma_f32 v[234:235], v[178:179], v[86:87], v[234:235]
  v_pk_fma_f32 v[236:237], v[178:179], v[178:179], v[236:237]
  v_pk_fma_f32 v[238:239], v[178:179], v[106:107], v[238:239]
  v_add_f32 v228, v228, v229
  v_add_f32 v230, v230, v231
  v_add_f32 v232, v232, v233
  v_add_f32 v234, v234, v235
  v_add_f32 v236, v236, v237
  v_add_f32 v238, v238, v239
  v_add_f32 v240, v240, v241
  v_add_f32 v242, v242, v243
  v_permlane16_swap_b32 v228, v236
  v_permlane16_swap_b32 v230, v238
  v_permlane16_swap_b32 v232, v240
  v_permlane16_swap_b32 v234, v242
  v_add_f32 v216, v228, v236
  v_add_f32 v217, v230, v238
  v_add_f32 v218, v232, v240
  v_add_f32 v219, v234, v242
  v_mov_b32 v228, v216
  v_mov_b32 v229, v217
  v_mov_b32 v230, v218
  v_mov_b32 v231, v219
  v_permlane32_swap_b32 v216, v228
  v_permlane32_swap_b32 v217, v229
  v_permlane32_swap_b32 v218, v230
  v_permlane32_swap_b32 v219, v231
  s_movk_i32 s14, 0xff
  v_add_f32 v216, v216, v228
  v_add_f32 v217, v217, v229
  v_add_f32 v218, v218, v230
  v_add_f32 v219, v219, v231
  s_lshr_b32 s15, s8, 0
  v_mov_b32_e64 v228, s15
  v_bfi_b32 v216, s14, v228, v216
  s_lshr_b32 s15, s8, 8
  v_mov_b32 v229, s15
  v_bfi_b32 v217, s14, v229, v217
  s_lshr_b32 s15, s8, 16
  v_mov_b32 v230, s15
  v_bfi_b32 v218, s14, v230, v218
  s_lshr_b32 s15, s8, 24
  v_mov_b32 v231, s15
  v_bfi_b32 v219, s14, v231, v219
  s_mov_b32 exec_hi, 0
  s_cmp_eq_u32 s9, 0
  s_cbranch_scc1 slow_43
  buffer_store_dwordx4 v[216:219], v2, s[52:55], s13 offen
back_44:
  s_mov_b32 exec_hi, -1
  v_accvgpr_write_b32 a208, v246
  v_accvgpr_write_b32 a209, v247
  v_accvgpr_write_b32 a210, v248
  v_accvgpr_write_b32 a211, v249
  v_accvgpr_write_b32 a212, v250
  v_accvgpr_write_b32 a213, v251
  v_accvgpr_write_b32 a214, v252
  v_accvgpr_write_b32 a215, v253
  v_accvgpr_write_b32 a216, v254
  v_accvgpr_write_b32 a217, v255
  v_lshrrev_b32_e64 v11, 2, v3
  v_mul_u32_u24 v11, 5120, v11
  v_and_b32_e64 v12, 3, v3
  v_lshl_add_u32 v11, v12, 4, v11
  v_lshrrev_b32_e64 v12, 1, v4
  v_lshl_add_u32 v11, v12, 6, v11
  v_and_b32_e64 v12, 1, v4
  v_lshl_add_u32 v47, v12, 3, v11
  s_lshl_b32 s96, s5, 2
  s_add_u32 s96, s96, s7
  s_mul_i32 s96, s96, 20480
  s_mul_i32 s14, s6, 640
  s_add_u32 s96, s96, s14
  v_accvgpr_read_b32 v190, a240
  v_accvgpr_read_b32 v191, a241
  v_accvgpr_read_b32 v192, a242
  v_accvgpr_read_b32 v193, a243
  v_accvgpr_read_b32 v194, a244
  v_accvgpr_read_b32 v195, a245
  v_accvgpr_read_b32 v196, a246
  v_accvgpr_read_b32 v197, a247
  v_accvgpr_read_b32 v198, a248
  v_accvgpr_read_b32 v199, a249
  v_lshlrev_b32 v108, 16, v190
  v_and_b32 v109, 0xffff0000, v190
  v_lshlrev_b32_e64 v110, 16, v191
  v_and_b32 v111, 0xffff0000, v191
  v_lshlrev_b32_e64 v112, 16, v192
  v_and_b32 v113, 0xffff0000, v192
  v_lshlrev_b32_e64 v114, 16, v193
  v_and_b32 v115, 0xffff0000, v193
  v_lshlrev_b32_e64 v116, 16, v194
  v_and_b32 v117, 0xffff0000, v194
  v_lshlrev_b32_e64 v118, 16, v195
  v_and_b32 v119, 0xffff0000, v195
  v_lshlrev_b32_e64 v120, 16, v196
  v_and_b32 v121, 0xffff0000, v196
  v_lshlrev_b32_e64 v122, 16, v197
  v_and_b32 v123, 0xffff0000, v197
  v_lshlrev_b32_e64 v124, 16, v198
  v_and_b32 v125, 0xffff0000, v198
  v_lshlrev_b32_e64 v126, 16, v199
  v_and_b32 v127, 0xffff0000, v199
  v_and_b32 v11, 31, v1
  v_lshlrev_b32 v11, 4, v11
  v_lshrrev_b32_e64 v12, 5, v1
  v_lshl_add_u32 v11, v12, 14, v11
  s_mov_b32 s14, 0x0c0c0400
  s_mov_b32 s15, 0x04000c0c
stpoll_45:
  s_add_u32 s13, s12, 0
  buffer_load_dwordx4 v[128:131], v11, s[52:55], s13 offen sc1
  s_add_u32 s13, s12, 4096
  buffer_load_dwordx4 v[132:135], v11, s[52:55], s13 offen sc1
  s_add_u32 s13, s12, 8192
  buffer_load_dwordx4 v[136:139], v11, s[52:55], s13 offen sc1
  s_add_u32 s13, s12, 12288
  buffer_load_dwordx4 v[140:143], v11, s[52:55], s13 offen sc1
  s_waitcnt vmcnt(0)
  v_perm_b32 v228, v129, v128, s14
  v_perm_b32 v229, v131, v130, s15
  v_perm_b32 v230, v133, v132, s14
  v_perm_b32 v231, v135, v134, s15
  v_perm_b32 v232, v137, v136, s14
  v_perm_b32 v233, v139, v138, s15
  v_perm_b32 v234, v141, v140, s14
  v_perm_b32 v235, v143, v142, s15
  v_or_b32 v228, v228, v229
  v_or_b32 v230, v230, v231
  v_or_b32 v232, v232, v233
  v_or_b32 v234, v234, v235
  v_min3_u32 v13, v228, v230, s8
  v_max3_u32 v14, v228, v230, s8
  v_min3_u32 v13, v13, v232, v234
  v_max3_u32 v14, v14, v232, v234
  v_cmp_ne_u32 vcc, v13, v14
  s_cbranch_vccnz retry_46
giveup_47:
  v_pk_add_f32 v[128:129], v[128:129], v[132:133]
  v_pk_add_f32 v[136:137], v[136:137], v[140:141]
  v_pk_add_f32 v[130:131], v[130:131], v[134:135]
  v_pk_add_f32 v[138:139], v[138:139], v[142:143]
  v_pk_add_f32 v[128:129], v[128:129], v[136:137]
  v_pk_add_f32 v[130:131], v[130:131], v[138:139]
  v_mov_b32 v132, v128
  v_mov_b32 v133, v129
  v_mov_b32 v134, v130
  v_mov_b32 v135, v131
  v_permlane32_swap_b32 v128, v132
  v_permlane32_swap_b32 v129, v133
  v_permlane32_swap_b32 v130, v134
  v_permlane32_swap_b32 v131, v135
  v_add_f32 v228, v128, v132
  v_add_f32 v229, v129, v133
  v_add_f32 v230, v130, v134
  v_add_f32 v231, v131, v135
  v_mov_b32 v232, v228
  v_mov_b32 v233, v229
  v_mov_b32 v234, v230
  v_mov_b32 v235, v231
  v_permlane16_swap_b32 v228, v232
  v_permlane16_swap_b32 v229, v233
  v_permlane16_swap_b32 v230, v234
  v_permlane16_swap_b32 v231, v235
  v_mul_f32 v208, 0x3acccccd, v228
  v_mul_f32 v212, 0x3acccccd, v229
  v_fma_f32 v212, -v208, v208, v212
  v_max_f32_e64 v212, 0, v212
  v_add_f32 v212, 0x3727c5ac, v212
  v_rsq_f32 v210, v212
  s_nop 0
  v_mul_f32_e64 v211, v208, v210
  v_fma_f32 v212, v210, v230, v228
  v_fma_f32 v212, -v211, v234, v212
  v_mul_f32_e64 v213, v210, v232
  v_fma_f32 v213, 2.0, v231, v213
  v_fma_f32 v213, v210, v213, v229
  v_fma_f32 v230, v210, v233, v230
  v_mul_f32_e64 v235, v211, v235
  v_fma_f32 v230, -2.0, v230, v235
  v_fma_f32 v213, v211, v230, v213
  v_mul_f32 v212, 0x3acccccd, v212
  v_mul_f32 v213, 0x3acccccd, v213
  v_fma_f32 v213, -v212, v212, v213
  v_max_f32_e64 v213, 0, v213
  v_add_f32 v213, 0x3727c5ac, v213
  v_rsq_f32 v214, v213
  s_nop 0
  v_mul_f32_e64 v215, v212, v214
  v_pk_fma_f32 v[160:161], v[68:69], v[210:211], v[210:211] op_sel:[0,0,1] op_sel_hi:[1,0,1] neg_lo:[0,0,1] neg_hi:[0,0,1]
  v_pk_fma_f32 v[162:163], v[70:71], v[210:211], v[210:211] op_sel:[0,0,1] op_sel_hi:[1,0,1] neg_lo:[0,0,1] neg_hi:[0,0,1]
  v_pk_fma_f32 v[164:165], v[72:73], v[210:211], v[210:211] op_sel:[0,0,1] op_sel_hi:[1,0,1] neg_lo:[0,0,1] neg_hi:[0,0,1]
  v_pk_fma_f32 v[166:167], v[74:75], v[210:211], v[210:211] op_sel:[0,0,1] op_sel_hi:[1,0,1] neg_lo:[0,0,1] neg_hi:[0,0,1]
  v_pk_fma_f32 v[168:169], v[76:77], v[210:211], v[210:211] op_sel:[0,0,1] op_sel_hi:[1,0,1] neg_lo:[0,0,1] neg_hi:[0,0,1]
  v_pk_fma_f32 v[170:171], v[78:79], v[210:211], v[210:211] op_sel:[0,0,1] op_sel_hi:[1,0,1] neg_lo:[0,0,1] neg_hi:[0,0,1]
  v_pk_fma_f32 v[172:173], v[80:81], v[210:211], v[210:211] op_sel:[0,0,1] op_sel_hi:[1,0,1] neg_lo:[0,0,1] neg_hi:[0,0,1]
  v_pk_fma_f32 v[174:175], v[82:83], v[210:211], v[210:211] op_sel:[0,0,1] op_sel_hi:[1,0,1] neg_lo:[0,0,1] neg_hi:[0,0,1]
  v_pk_fma_f32 v[176:177], v[84:85], v[210:211], v[210:211] op_sel:[0,0,1] op_sel_hi:[1,0,1] neg_lo:[0,0,1] neg_hi:[0,0,1]
  v_pk_fma_f32 v[178:179], v[86:87], v[210:211], v[210:211] op_sel:[0,0,1] op_sel_hi:[1,0,1] neg_lo:[0,0,1] neg_hi:[0,0,1]
  v_pk_fma_f32 v[68:69], v[160:161], v[88:89], v[68:69]
  v_pk_fma_f32 v[70:71], v[162:163], v[90:91], v[70:71]
  v_pk_fma_f32 v[72:73], v[164:165], v[92:93], v[72:73]
  v_pk_fma_f32 v[74:75], v[166:167], v[94:95], v[74:75]
  v_pk_fma_f32 v[76:77], v[168:169], v[96:97], v[76:77]
  v_pk_fma_f32 v[78:79], v[170:171], v[98:99], v[78:79]
  v_pk_fma_f32 v[80:81], v[172:173], v[100:101], v[80:81]
  v_pk_fma_f32 v[82:83], v[174:175], v[102:103], v[82:83]
  v_pk_fma_f32 v[84:85], v[176:177], v[104:105], v[84:85]
  v_pk_fma_f32 v[86:87], v[178:179], v[106:107], v[86:87]
  v_pk_fma_f32 v[160:161], v[68:69], v[214:215], v[214:215] op_sel:[0,0,1] op_sel_hi:[1,0,1] neg_lo:[0,0,1] neg_hi:[0,0,1]
  v_pk_fma_f32 v[162:163], v[70:71], v[214:215], v[214:215] op_sel:[0,0,1] op_sel_hi:[1,0,1] neg_lo:[0,0,1] neg_hi:[0,0,1]
  v_pk_fma_f32 v[164:165], v[72:73], v[214:215], v[214:215] op_sel:[0,0,1] op_sel_hi:[1,0,1] neg_lo:[0,0,1] neg_hi:[0,0,1]
  v_pk_fma_f32 v[166:167], v[74:75], v[214:215], v[214:215] op_sel:[0,0,1] op_sel_hi:[1,0,1] neg_lo:[0,0,1] neg_hi:[0,0,1]
  v_pk_fma_f32 v[168:169], v[76:77], v[214:215], v[214:215] op_sel:[0,0,1] op_sel_hi:[1,0,1] neg_lo:[0,0,1] neg_hi:[0,0,1]
  v_pk_fma_f32 v[170:171], v[78:79], v[214:215], v[214:215] op_sel:[0,0,1] op_sel_hi:[1,0,1] neg_lo:[0,0,1] neg_hi:[0,0,1]
  v_pk_fma_f32 v[172:173], v[80:81], v[214:215], v[214:215] op_sel:[0,0,1] op_sel_hi:[1,0,1] neg_lo:[0,0,1] neg_hi:[0,0,1]
  v_pk_fma_f32 v[174:175], v[82:83], v[214:215], v[214:215] op_sel:[0,0,1] op_sel_hi:[1,0,1] neg_lo:[0,0,1] neg_hi:[0,0,1]
  v_pk_fma_f32 v[176:177], v[84:85], v[214:215], v[214:215] op_sel:[0,0,1] op_sel_hi:[1,0,1] neg_lo:[0,0,1] neg_hi:[0,0,1]
  v_pk_fma_f32 v[178:179], v[86:87], v[214:215], v[214:215] op_sel:[0,0,1] op_sel_hi:[1,0,1] neg_lo:[0,0,1] neg_hi:[0,0,1]
  v_cvt_pk_bf16_f32 v180, v160, v161
  v_cvt_pk_bf16_f32 v181, v162, v163
  v_cvt_pk_bf16_f32 v182, v164, v165
  v_cvt_pk_bf16_f32 v183, v166, v167
  v_cvt_pk_bf16_f32 v184, v168, v169
  v_cvt_pk_bf16_f32 v185, v170, v171
  v_cvt_pk_bf16_f32 v186, v172, v173
  v_cvt_pk_bf16_f32 v187, v174, v175
  v_cvt_pk_bf16_f32 v188, v176, v177
  v_cvt_pk_bf16_f32 v189, v178, v179
  s_add_u32 s12, s96, 4194304
  s_cmp_eq_u32 s9, 0
  s_cbranch_scc1 slow_48
  buffer_store_dwordx2 v[180:181], v47, s[52:55], s12 offen offset:0
  buffer_store_dwordx2 v[182:183], v47, s[52:55], s12 offen offset:128
  buffer_store_dwordx2 v[184:185], v47, s[52:55], s12 offen offset:256
  buffer_store_dwordx2 v[186:187], v47, s[52:55], s12 offen offset:384
  buffer_store_dwordx2 v[188:189], v47, s[52:55], s12 offen offset:512
back_49:
  v_pk_fma_f32 v[68:69], v[160:161], v[108:109], v[68:69]
  v_pk_fma_f32 v[70:71], v[162:163], v[110:111], v[70:71]
  v_pk_fma_f32 v[72:73], v[164:165], v[112:113], v[72:73]
  v_pk_fma_f32 v[74:75], v[166:167], v[114:115], v[74:75]
  v_pk_fma_f32 v[76:77], v[168:169], v[116:117], v[76:77]
  v_pk_fma_f32 v[78:79], v[170:171], v[118:119], v[78:79]
  v_pk_fma_f32 v[80:81], v[172:173], v[120:121], v[80:81]
  v_pk_fma_f32 v[82:83], v[174:175], v[122:123], v[82:83]
  v_pk_fma_f32 v[84:85], v[176:177], v[124:125], v[84:85]
  v_pk_fma_f32 v[86:87], v[178:179], v[126:127], v[86:87]
  v_accvgpr_write_b32 a220, v68
  v_accvgpr_write_b32 a221, v69
  v_accvgpr_write_b32 a222, v70
  v_accvgpr_write_b32 a223, v71
  v_accvgpr_write_b32 a224, v72
  v_accvgpr_write_b32 a225, v73
  v_accvgpr_write_b32 a226, v74
  v_accvgpr_write_b32 a227, v75
  v_accvgpr_write_b32 a228, v76
  v_accvgpr_write_b32 a229, v77
  v_accvgpr_write_b32 a230, v78
  v_accvgpr_write_b32 a231, v79
  v_accvgpr_write_b32 a232, v80
  v_accvgpr_write_b32 a233, v81
  v_accvgpr_write_b32 a234, v82
  v_accvgpr_write_b32 a235, v83
  v_accvgpr_write_b32 a236, v84
  v_accvgpr_write_b32 a237, v85
  v_accvgpr_write_b32 a238, v86
  v_accvgpr_write_b32 a239, v87
  s_add_u32 s13, s73, 8192
  s_waitcnt vmcnt(0)
  v_mov_b32 v15, s8
  s_mov_b64 exec, 1
  s_cmp_eq_u32 s9, 0
  s_cbranch_scc1 slow_50
  buffer_store_dword v15, off, s[52:55], s13
back_51:
  s_mov_b64 exec, -1
  s_cmp_lg_u32 s35, 992
  s_cbranch_scc1 skip_52
  v_mov_b32 v15, s8
  s_mov_b64 exec, 1
  buffer_store_dword v15, off, s[52:55], 0 sc1
  s_mov_b64 exec, -1
skip_52:
  s_lshl_b32 s12, s3, 8
  s_lshr_b32 s13, s7, 1
  s_lshl_b32 s13, s13, 7
  s_add_u32 s12, s12, s13
  s_and_b32 s13, s7, 1
  s_lshl_b32 s13, s13, 3
  s_add_u32 s12, s12, s13
  s_add_u32 s12, s12, 8192
  v_and_b32 v11, 7, v1
  v_lshlrev_b32 v11, 4, v11
  s_lshl_b32 s18, s3, 2
  s_add_u32 s18, s18, s7
  s_mul_i32 s18, s18, 40960
  s_add_u32 s18, s18, 4194304
  s_add_u32 s19, s18, 20480
poll_53:
  buffer_load_dwordx2 v[42:43], v11, s[52:55], s12 offen sc1
  s_waitcnt vmcnt(0)
  v_xor_b32 v15, s8, v42
  v_xor_b32 v14, s8, v43
  v_or_b32 v15, v15, v14
  v_cmp_ne_u32 vcc, 0, v15
  s_cbranch_vccnz retry_54
giveup_55:
  buffer_load_dwordx4 v[128:131], v0, s[52:55], s18 offen offset:1536 sc1
  buffer_load_dwordx4 v[132:135], v0, s[52:55], s19 offen offset:1536 sc1
  buffer_load_dwordx4 v[136:139], v0, s[52:55], s18 offen offset:1792 sc1
  buffer_load_dwordx4 v[140:143], v0, s[52:55], s19 offen offset:1792 sc1
  buffer_load_dwordx4 v[144:147], v0, s[52:55], s18 offen offset:2048 sc1
  buffer_load_dwordx4 v[148:151], v0, s[52:55], s19 offen offset:2048 sc1
  buffer_load_dwordx4 v[152:155], v0, s[52:55], s18 offen offset:2304 sc1
  buffer_load_dwordx4 v[156:159], v0, s[52:55], s19 offen offset:2304 sc1
  ds_read_b128 v[88:91], v5 offset:30720
  ds_read_b128 v[92:95], v5 offset:32768
  ds_read_b128 v[96:99], v5 offset:34816
  ds_read_b128 v[100:103], v5 offset:36864
  ds_read_b128 v[104:107], v5 offset:38912
  s_waitcnt vmcnt(6)
  s_waitcnt lgkmcnt(4)
  v_mfma_f32_16x16x32_bf16 v[48:51], v[128:131], v[88:91], 0
  ds_read_b128 v[108:111], v6 offset:30720
  v_mfma_f32_16x16x32_bf16 v[52:55], v[132:135], v[88:91], 0
  buffer_load_dwordx4 v[160:163], v0, s[52:55], s18 offen offset:2560 sc1
  s_waitcnt lgkmcnt(4)
  v_mfma_f32_16x16x32_bf16 v[56:59], v[128:131], v[92:95], 0
  ds_read_b128 v[112:115], v6 offset:32768
  v_mfma_f32_16x16x32_bf16 v[60:63], v[132:135], v[92:95], 0
  buffer_load_dwordx4 v[164:167], v0, s[52:55], s19 offen offset:2560 sc1
  s_waitcnt lgkmcnt(4)
  v_mfma_f32_16x16x32_bf16 v[64:67], v[128:131], v[96:99], 0
  ds_read_b128 v[116:119], v6 offset:34816
  v_mfma_f32_16x16x32_bf16 v[68:71], v[132:135], v[96:99], 0
  s_waitcnt lgkmcnt(4)
  v_mfma_f32_16x16x32_bf16 v[72:75], v[128:131], v[100:103], 0
  ds_read_b128 v[120:123], v6 offset:36864
  v_mfma_f32_16x16x32_bf16 v[76:79], v[132:135], v[100:103], 0
  s_waitcnt lgkmcnt(4)
  v_mfma_f32_16x16x32_bf16 v[80:83], v[128:131], v[104:107], 0
  ds_read_b128 v[124:127], v6 offset:38912
  v_mfma_f32_16x16x32_bf16 v[84:87], v[132:135], v[104:107], 0
  s_waitcnt vmcnt(6)
  s_waitcnt lgkmcnt(4)
  v_mfma_f32_16x16x32_bf16 v[48:51], v[136:139], v[108:111], v[48:51]
  ds_read_b128 v[88:91], v5 offset:40960
  v_mfma_f32_16x16x32_bf16 v[52:55], v[140:143], v[108:111], v[52:55]
  buffer_load_dwordx4 v[168:171], v0, s[52:55], s18 offen offset:2816 sc1
  s_waitcnt lgkmcnt(4)
  v_mfma_f32_16x16x32_bf16 v[56:59], v[136:139], v[112:115], v[56:59]
  ds_read_b128 v[92:95], v5 offset:43008
  v_mfma_f32_16x16x32_bf16 v[60:63], v[140:143], v[112:115], v[60:63]
  buffer_load_dwordx4 v[172:175], v0, s[52:55], s19 offen offset:2816 sc1
  s_waitcnt lgkmcnt(4)
  v_mfma_f32_16x16x32_bf16 v[64:67], v[136:139], v[116:119], v[64:67]
  ds_read_b128 v[96:99], v5 offset:45056
  v_mfma_f32_16x16x32_bf16 v[68:71], v[140:143], v[116:119], v[68:71]
  s_waitcnt lgkmcnt(4)
  v_mfma_f32_16x16x32_bf16 v[72:75], v[136:139], v[120:123], v[72:75]
  ds_read_b128 v[100:103], v5 offset:47104
  v_mfma_f32_16x16x32_bf16 v[76:79], v[140:143], v[120:123], v[76:79]
  s_waitcnt lgkmcnt(4)
  v_mfma_f32_16x16x32_bf16 v[80:83], v[136:139], v[124:127], v[80:83]
  ds_read_b128 v[104:107], v5 offset:49152
  v_mfma_f32_16x16x32_bf16 v[84:87], v[140:143], v[124:127], v[84:87]
  s_waitcnt vmcnt(6)
  s_waitcnt lgkmcnt(4)
  v_mfma_f32_16x16x32_bf16 v[48:51], v[144:147], v[88:91], v[48:51]
  ds_read_b128 v[108:111], v6 offset:40960
  v_mfma_f32_16x16x32_bf16 v[52:55], v[148:151], v[88:91], v[52:55]
  buffer_load_dwordx4 v[176:179], v0, s[52:55], s18 offen offset:3072 sc1
  s_waitcnt lgkmcnt(4)
  v_mfma_f32_16x16x32_bf16 v[56:59], v[144:147], v[92:95], v[56:59]
  ds_read_b128 v[112:115], v6 offset:43008
  v_mfma_f32_16x16x32_bf16 v[60:63], v[148:151], v[92:95], v[60:63]
  buffer_load_dwordx4 v[180:183], v0, s[52:55], s19 offen offset:3072 sc1
  s_waitcnt lgkmcnt(4)
  v_mfma_f32_16x16x32_bf16 v[64:67], v[144:147], v[96:99], v[64:67]
  ds_read_b128 v[116:119], v6 offset:45056
  v_mfma_f32_16x16x32_bf16 v[68:71], v[148:151], v[96:99], v[68:71]
  s_waitcnt lgkmcnt(4)
  v_mfma_f32_16x16x32_bf16 v[72:75], v[144:147], v[100:103], v[72:75]
  ds_read_b128 v[120:123], v6 offset:47104
  v_mfma_f32_16x16x32_bf16 v[76:79], v[148:151], v[100:103], v[76:79]
  s_waitcnt lgkmcnt(4)
  v_mfma_f32_16x16x32_bf16 v[80:83], v[144:147], v[104:107], v[80:83]
  ds_read_b128 v[124:127], v6 offset:49152
  v_mfma_f32_16x16x32_bf16 v[84:87], v[148:151], v[104:107], v[84:87]
  s_waitcnt vmcnt(6)
  s_waitcnt lgkmcnt(4)
  v_mfma_f32_16x16x32_bf16 v[48:51], v[152:155], v[108:111], v[48:51]
  ds_read_b128 v[88:91], v7 offset:0
  v_mfma_f32_16x16x32_bf16 v[52:55], v[156:159], v[108:111], v[52:55]
  buffer_load_dwordx4 v[184:187], v0, s[52:55], s18 offen offset:3328 sc1
  s_waitcnt lgkmcnt(4)
  v_mfma_f32_16x16x32_bf16 v[56:59], v[152:155], v[112:115], v[56:59]
  ds_read_b128 v[92:95], v7 offset:2048
  v_mfma_f32_16x16x32_bf16 v[60:63], v[156:159], v[112:115], v[60:63]
  buffer_load_dwordx4 v[188:191], v0, s[52:55], s19 offen offset:3328 sc1
  s_waitcnt lgkmcnt(4)
  v_mfma_f32_16x16x32_bf16 v[64:67], v[152:155], v[116:119], v[64:67]
  ds_read_b128 v[96:99], v7 offset:4096
  v_mfma_f32_16x16x32_bf16 v[68:71], v[156:159], v[116:119], v[68:71]
  s_waitcnt lgkmcnt(4)
  v_mfma_f32_16x16x32_bf16 v[72:75], v[152:155], v[120:123], v[72:75]
  ds_read_b128 v[100:103], v7 offset:6144
  v_mfma_f32_16x16x32_bf16 v[76:79], v[156:159], v[120:123], v[76:79]
  s_waitcnt lgkmcnt(4)
  v_mfma_f32_16x16x32_bf16 v[80:83], v[152:155], v[124:127], v[80:83]
  ds_read_b128 v[104:107], v7 offset:8192
  v_mfma_f32_16x16x32_bf16 v[84:87], v[156:159], v[124:127], v[84:87]
  s_waitcnt vmcnt(6)
  s_waitcnt lgkmcnt(4)
  v_mfma_f32_16x16x32_bf16 v[48:51], v[160:163], v[88:91], v[48:51]
  ds_read_b128 v[108:111], v8 offset:0
  v_mfma_f32_16x16x32_bf16 v[52:55], v[164:167], v[88:91], v[52:55]
  buffer_load_dwordx4 v[128:131], v0, s[52:55], s18 offen offset:3584 sc1
  s_waitcnt lgkmcnt(4)
  v_mfma_f32_16x16x32_bf16 v[56:59], v[160:163], v[92:95], v[56:59]
  ds_read_b128 v[112:115], v8 offset:2048
  v_mfma_f32_16x16x32_bf16 v[60:63], v[164:167], v[92:95], v[60:63]
  buffer_load_dwordx4 v[132:135], v0, s[52:55], s19 offen offset:3584 sc1
  s_waitcnt lgkmcnt(4)
  v_mfma_f32_16x16x32_bf16 v[64:67], v[160:163], v[96:99], v[64:67]
  ds_read_b128 v[116:119], v8 offset:4096
  v_mfma_f32_16x16x32_bf16 v[68:71], v[164:167], v[96:99], v[68:71]
  s_waitcnt lgkmcnt(4)
  v_mfma_f32_16x16x32_bf16 v[72:75], v[160:163], v[100:103], v[72:75]
  ds_read_b128 v[120:123], v8 offset:6144
  v_mfma_f32_16x16x32_bf16 v[76:79], v[164:167], v[100:103], v[76:79]
  s_waitcnt lgkmcnt(4)
  v_mfma_f32_16x16x32_bf16 v[80:83], v[160:163], v[104:107], v[80:83]
  ds_read_b128 v[124:127], v8 offset:8192
  v_mfma_f32_16x16x32_bf16 v[84:87], v[164:167], v[104:107], v[84:87]
  s_waitcnt vmcnt(6)
  s_waitcnt lgkmcnt(4)
  v_mfma_f32_16x16x32_bf16 v[48:51], v[168:171], v[108:111], v[48:51]
  ds_read_b128 v[88:91], v7 offset:10240
  v_mfma_f32_16x16x32_bf16 v[52:55], v[172:175], v[108:111], v[52:55]
  buffer_load_dwordx4 v[136:139], v0, s[52:55], s18 offen offset:3840 sc1
  s_waitcnt lgkmcnt(4)
  v_mfma_f32_16x16x32_bf16 v[56:59], v[168:171], v[112:115], v[56:59]
  ds_read_b128 v[92:95], v7 offset:12288
  v_mfma_f32_16x16x32_bf16 v[60:63], v[172:175], v[112:115], v[60:63]
  buffer_load_dwordx4 v[140:143], v0, s[52:55], s19 offen offset:3840 sc1
  s_waitcnt lgkmcnt(4)
  v_mfma_f32_16x16x32_bf16 v[64:67], v[168:171], v[116:119], v[64:67]
  ds_read_b128 v[96:99], v7 offset:14336
  v_mfma_f32_16x16x32_bf16 v[68:71], v[172:175], v[116:119], v[68:71]
  s_waitcnt lgkmcnt(4)
  v_mfma_f32_16x16x32_bf16 v[72:75], v[168:171], v[120:123], v[72:75]
  ds_read_b128 v[100:103], v7 offset:16384
  v_mfma_f32_16x16x32_bf16 v[76:79], v[172:175], v[120:123], v[76:79]
  s_waitcnt lgkmcnt(4)
  v_mfma_f32_16x16x32_bf16 v[80:83], v[168:171], v[124:127], v[80:83]
  ds_read_b128 v[104:107], v7 offset:18432
  v_mfma_f32_16x16x32_bf16 v[84:87], v[172:175], v[124:127], v[84:87]
  s_waitcnt vmcnt(6)
  s_waitcnt lgkmcnt(4)
  v_mfma_f32_16x16x32_bf16 v[48:51], v[176:179], v[88:91], v[48:51]
  ds_read_b128 v[108:111], v8 offset:10240
  v_mfma_f32_16x16x32_bf16 v[52:55], v[180:183], v[88:91], v[52:55]
  s_add_u32 s18, s18, 4096
  buffer_load_dwordx4 v[144:147], v0, s[52:55], s18 offen offset:0 sc1
  s_waitcnt lgkmcnt(4)
  v_mfma_f32_16x16x32_bf16 v[56:59], v[176:179], v[92:95], v[56:59]
  ds_read_b128 v[112:115], v8 offset:12288
  v_mfma_f32_16x16x32_bf16 v[60:63], v[180:183], v[92:95], v[60:63]
  s_add_u32 s19, s19, 4096
  buffer_load_dwordx4 v[148:151], v0, s[52:55], s19 offen offset:0 sc1
  s_waitcnt lgkmcnt(4)
  v_mfma_f32_16x16x32_bf16 v[64:67], v[176:179], v[96:99], v[64:67]
  ds_read_b128 v[116:119], v8 offset:14336
  v_mfma_f32_16x16x32_bf16 v[68:71], v[180:183], v[96:99], v[68:71]
  s_waitcnt lgkmcnt(4)
  v_mfma_f32_16x16x32_bf16 v[72:75], v[176:179], v[100:103], v[72:75]
  ds_read_b128 v[120:123], v8 offset:16384
  v_mfma_f32_16x16x32_bf16 v[76:79], v[180:183], v[100:103], v[76:79]
  s_waitcnt lgkmcnt(4)
  v_mfma_f32_16x16x32_bf16 v[80:83], v[176:179], v[104:107], v[80:83]
  ds_read_b128 v[124:127], v8 offset:18432
  v_mfma_f32_16x16x32_bf16 v[84:87], v[180:183], v[104:107], v[84:87]
  s_waitcnt vmcnt(6)
  s_waitcnt lgkmcnt(4)
  v_mfma_f32_16x16x32_bf16 v[48:51], v[184:187], v[108:111], v[48:51]
  ds_read_b128 v[88:91], v7 offset:20480
  v_mfma_f32_16x16x32_bf16 v[52:55], v[188:191], v[108:111], v[52:55]
  buffer_load_dwordx4 v[152:155], v0, s[52:55], s18 offen offset:256 sc1
  s_waitcnt lgkmcnt(4)
  v_mfma_f32_16x16x32_bf16 v[56:59], v[184:187], v[112:115], v[56:59]
  ds_read_b128 v[92:95], v7 offset:22528
  v_mfma_f32_16x16x32_bf16 v[60:63], v[188:191], v[112:115], v[60:63]
  buffer_load_dwordx4 v[156:159], v0, s[52:55], s19 offen offset:256 sc1
  s_waitcnt lgkmcnt(4)
  v_mfma_f32_16x16x32_bf16 v[64:67], v[184:187], v[116:119], v[64:67]
  ds_read_b128 v[96:99], v7 offset:24576
  v_mfma_f32_16x16x32_bf16 v[68:71], v[188:191], v[116:119], v[68:71]
  s_waitcnt lgkmcnt(4)
  v_mfma_f32_16x16x32_bf16 v[72:75], v[184:187], v[120:123], v[72:75]
  ds_read_b128 v[100:103], v7 offset:26624
  v_mfma_f32_16x16x32_bf16 v[76:79], v[188:191], v[120:123], v[76:79]
  s_waitcnt lgkmcnt(4)
  v_mfma_f32_16x16x32_bf16 v[80:83], v[184:187], v[124:127], v[80:83]
  ds_read_b128 v[104:107], v7 offset:28672
  v_mfma_f32_16x16x32_bf16 v[84:87], v[188:191], v[124:127], v[84:87]
  s_waitcnt vmcnt(6)
  s_waitcnt lgkmcnt(4)
  v_mfma_f32_16x16x32_bf16 v[48:51], v[128:131], v[88:91], v[48:51]
  ds_read_b128 v[108:111], v8 offset:20480
  v_mfma_f32_16x16x32_bf16 v[52:55], v[132:135], v[88:91], v[52:55]
  buffer_load_dwordx4 v[160:163], v0, s[52:55], s18 offen offset:512 sc1
  s_waitcnt lgkmcnt(4)
  v_mfma_f32_16x16x32_bf16 v[56:59], v[128:131], v[92:95], v[56:59]
  ds_read_b128 v[112:115], v8 offset:22528
  v_mfma_f32_16x16x32_bf16 v[60:63], v[132:135], v[92:95], v[60:63]
  buffer_load_dwordx4 v[164:167], v0, s[52:55], s19 offen offset:512 sc1
  s_waitcnt lgkmcnt(4)
  v_mfma_f32_16x16x32_bf16 v[64:67], v[128:131], v[96:99], v[64:67]
  ds_read_b128 v[116:119], v8 offset:24576
  v_mfma_f32_16x16x32_bf16 v[68:71], v[132:135], v[96:99], v[68:71]
  s_waitcnt lgkmcnt(4)
  v_mfma_f32_16x16x32_bf16 v[72:75], v[128:131], v[100:103], v[72:75]
  ds_read_b128 v[120:123], v8 offset:26624
  v_mfma_f32_16x16x32_bf16 v[76:79], v[132:135], v[100:103], v[76:79]
  s_waitcnt lgkmcnt(4)
  v_mfma_f32_16x16x32_bf16 v[80:83], v[128:131], v[104:107], v[80:83]
  ds_read_b128 v[124:127], v8 offset:28672
  v_mfma_f32_16x16x32_bf16 v[84:87], v[132:135], v[104:107], v[84:87]
  s_waitcnt vmcnt(6)
  s_waitcnt lgkmcnt(4)
  v_mfma_f32_16x16x32_bf16 v[48:51], v[136:139], v[108:111], v[48:51]
  ds_read_b128 v[88:91], v7 offset:30720
  v_mfma_f32_16x16x32_bf16 v[52:55], v[140:143], v[108:111], v[52:55]
  buffer_load_dwordx4 v[168:171], v0, s[52:55], s18 offen offset:768 sc1
  s_waitcnt lgkmcnt(4)
  v_mfma_f32_16x16x32_bf16 v[56:59], v[136:139], v[112:115], v[56:59]
  ds_read_b128 v[92:95], v7 offset:32768
  v_mfma_f32_16x16x32_bf16 v[60:63], v[140:143], v[112:115], v[60:63]
  buffer_load_dwordx4 v[172:175], v0, s[52:55], s19 offen offset:768 sc1
  s_waitcnt lgkmcnt(4)
  v_mfma_f32_16x16x32_bf16 v[64:67], v[136:139], v[116:119], v[64:67]
  ds_read_b128 v[96:99], v7 offset:34816
  v_mfma_f32_16x16x32_bf16 v[68:71], v[140:143], v[116:119], v[68:71]
  s_waitcnt lgkmcnt(4)
  v_mfma_f32_16x16x32_bf16 v[72:75], v[136:139], v[120:123], v[72:75]
  ds_read_b128 v[100:103], v7 offset:36864
  v_mfma_f32_16x16x32_bf16 v[76:79], v[140:143], v[120:123], v[76:79]
  s_waitcnt lgkmcnt(4)
  v_mfma_f32_16x16x32_bf16 v[80:83], v[136:139], v[124:127], v[80:83]
  ds_read_b128 v[104:107], v7 offset:38912
  v_mfma_f32_16x16x32_bf16 v[84:87], v[140:143], v[124:127], v[84:87]
  s_waitcnt vmcnt(6)
  s_waitcnt lgkmcnt(4)
  v_mfma_f32_16x16x32_bf16 v[48:51], v[144:147], v[88:91], v[48:51]
  ds_read_b128 v[108:111], v8 offset:30720
  v_mfma_f32_16x16x32_bf16 v[52:55], v[148:151], v[88:91], v[52:55]
  s_sub_u32 s18, s18, 4096
  buffer_load_dwordx4 v[176:179], v0, s[52:55], s18 offen offset:0 sc1
  s_waitcnt lgkmcnt(4)
  v_mfma_f32_16x16x32_bf16 v[56:59], v[144:147], v[92:95], v[56:59]
  ds_read_b128 v[112:115], v8 offset:32768
  v_mfma_f32_16x16x32_bf16 v[60:63], v[148:151], v[92:95], v[60:63]
  s_sub_u32 s19, s19, 4096
  buffer_load_dwordx4 v[180:183], v0, s[52:55], s19 offen offset:0 sc1
  s_waitcnt lgkmcnt(4)
  v_mfma_f32_16x16x32_bf16 v[64:67], v[144:147], v[96:99], v[64:67]
  ds_read_b128 v[116:119], v8 offset:34816
  v_mfma_f32_16x16x32_bf16 v[68:71], v[148:151], v[96:99], v[68:71]
  s_waitcnt lgkmcnt(4)
  v_mfma_f32_16x16x32_bf16 v[72:75], v[144:147], v[100:103], v[72:75]
  ds_read_b128 v[120:123], v8 offset:36864
  v_mfma_f32_16x16x32_bf16 v[76:79], v[148:151], v[100:103], v[76:79]
  s_waitcnt lgkmcnt(4)
  v_mfma_f32_16x16x32_bf16 v[80:83], v[144:147], v[104:107], v[80:83]
  ds_read_b128 v[124:127], v8 offset:38912
  v_mfma_f32_16x16x32_bf16 v[84:87], v[148:151], v[104:107], v[84:87]
  s_waitcnt vmcnt(6)
  s_waitcnt lgkmcnt(4)
  v_mfma_f32_16x16x32_bf16 v[48:51], v[152:155], v[108:111], v[48:51]
  ds_read_b128 v[88:91], v7 offset:40960
  v_mfma_f32_16x16x32_bf16 v[52:55], v[156:159], v[108:111], v[52:55]
  buffer_load_dwordx4 v[184:187], v0, s[52:55], s18 offen offset:256 sc1
  s_waitcnt lgkmcnt(4)
  v_mfma_f32_16x16x32_bf16 v[56:59], v[152:155], v[112:115], v[56:59]
  ds_read_b128 v[92:95], v7 offset:43008
  v_mfma_f32_16x16x32_bf16 v[60:63], v[156:159], v[112:115], v[60:63]
  buffer_load_dwordx4 v[188:191], v0, s[52:55], s19 offen offset:256 sc1
  s_waitcnt lgkmcnt(4)
  v_mfma_f32_16x16x32_bf16 v[64:67], v[152:155], v[116:119], v[64:67]
  ds_read_b128 v[96:99], v7 offset:45056
  v_mfma_f32_16x16x32_bf16 v[68:71], v[156:159], v[116:119], v[68:71]
  s_waitcnt lgkmcnt(4)
  v_mfma_f32_16x16x32_bf16 v[72:75], v[152:155], v[120:123], v[72:75]
  ds_read_b128 v[100:103], v7 offset:47104
  v_mfma_f32_16x16x32_bf16 v[76:79], v[156:159], v[120:123], v[76:79]
  s_waitcnt lgkmcnt(4)
  v_mfma_f32_16x16x32_bf16 v[80:83], v[152:155], v[124:127], v[80:83]
  ds_read_b128 v[104:107], v7 offset:49152
  v_mfma_f32_16x16x32_bf16 v[84:87], v[156:159], v[124:127], v[84:87]
  s_waitcnt vmcnt(6)
  s_waitcnt lgkmcnt(4)
  v_mfma_f32_16x16x32_bf16 v[48:51], v[160:163], v[88:91], v[48:51]
  ds_read_b128 v[108:111], v8 offset:40960
  v_mfma_f32_16x16x32_bf16 v[52:55], v[164:167], v[88:91], v[52:55]
  buffer_load_dwordx4 v[128:131], v0, s[52:55], s18 offen offset:512 sc1
  s_waitcnt lgkmcnt(4)
  v_mfma_f32_16x16x32_bf16 v[56:59], v[160:163], v[92:95], v[56:59]
  ds_read_b128 v[112:115], v8 offset:43008
  v_mfma_f32_16x16x32_bf16 v[60:63], v[164:167], v[92:95], v[60:63]
  buffer_load_dwordx4 v[132:135], v0, s[52:55], s19 offen offset:512 sc1
  s_waitcnt lgkmcnt(4)
  v_mfma_f32_16x16x32_bf16 v[64:67], v[160:163], v[96:99], v[64:67]
  ds_read_b128 v[116:119], v8 offset:45056
  v_mfma_f32_16x16x32_bf16 v[68:71], v[164:167], v[96:99], v[68:71]
  s_waitcnt lgkmcnt(4)
  v_mfma_f32_16x16x32_bf16 v[72:75], v[160:163], v[100:103], v[72:75]
  ds_read_b128 v[120:123], v8 offset:47104
  v_mfma_f32_16x16x32_bf16 v[76:79], v[164:167], v[100:103], v[76:79]
  s_waitcnt lgkmcnt(4)
  v_mfma_f32_16x16x32_bf16 v[80:83], v[160:163], v[104:107], v[80:83]
  ds_read_b128 v[124:127], v8 offset:49152
  v_mfma_f32_16x16x32_bf16 v[84:87], v[164:167], v[104:107], v[84:87]
  s_waitcnt vmcnt(6)
  s_barrier
  s_waitcnt lgkmcnt(4)
  v_mfma_f32_16x16x32_bf16 v[48:51], v[168:171], v[108:111], v[48:51]
  ds_read_b128 v[88:91], v5 offset:0
  v_mfma_f32_16x16x32_bf16 v[52:55], v[172:175], v[108:111], v[52:55]
  buffer_load_dwordx4 v[136:139], v0, s[52:55], s18 offen offset:768 sc1
  s_waitcnt lgkmcnt(4)
  v_mfma_f32_16x16x32_bf16 v[56:59], v[168:171], v[112:115], v[56:59]
  ds_read_b128 v[92:95], v5 offset:2048
  v_mfma_f32_16x16x32_bf16 v[60:63], v[172:175], v[112:115], v[60:63]
  buffer_load_dwordx4 v[140:143], v0, s[52:55], s19 offen offset:768 sc1
  s_waitcnt lgkmcnt(4)
  v_mfma_f32_16x16x32_bf16 v[64:67], v[168:171], v[116:119], v[64:67]
  ds_read_b128 v[96:99], v5 offset:4096
  v_mfma_f32_16x16x32_bf16 v[68:71], v[172:175], v[116:119], v[68:71]
  s_waitcnt lgkmcnt(4)
  v_mfma_f32_16x16x32_bf16 v[72:75], v[168:171], v[120:123], v[72:75]
  ds_read_b128 v[100:103], v5 offset:6144
  v_mfma_f32_16x16x32_bf16 v[76:79], v[172:175], v[120:123], v[76:79]
  s_waitcnt lgkmcnt(4)
  v_mfma_f32_16x16x32_bf16 v[80:83], v[168:171], v[124:127], v[80:83]
  ds_read_b128 v[104:107], v5 offset:8192
  v_mfma_f32_16x16x32_bf16 v[84:87], v[172:175], v[124:127], v[84:87]
  s_waitcnt vmcnt(6)
  s_waitcnt lgkmcnt(4)
  v_mfma_f32_16x16x32_bf16 v[48:51], v[176:179], v[88:91], v[48:51]
  ds_read_b128 v[108:111], v6 offset:0
  v_mfma_f32_16x16x32_bf16 v[52:55], v[180:183], v[88:91], v[52:55]
  buffer_load_dwordx4 v[144:147], v0, s[52:55], s18 offen offset:1024 sc1
  s_waitcnt lgkmcnt(4)
  v_mfma_f32_16x16x32_bf16 v[56:59], v[176:179], v[92:95], v[56:59]
  ds_read_b128 v[112:115], v6 offset:2048
  v_mfma_f32_16x16x32_bf16 v[60:63], v[180:183], v[92:95], v[60:63]
  buffer_load_dwordx4 v[148:151], v0, s[52:55], s19 offen offset:1024 sc1
  s_waitcnt lgkmcnt(4)
  v_mfma_f32_16x16x32_bf16 v[64:67], v[176:179], v[96:99], v[64:67]
  ds_read_b128 v[116:119], v6 offset:4096
  v_mfma_f32_16x16x32_bf16 v[68:71], v[180:183], v[96:99], v[68:71]
  s_waitcnt lgkmcnt(4)
  v_mfma_f32_16x16x32_bf16 v[72:75], v[176:179], v[100:103], v[72:75]
  ds_read_b128 v[120:123], v6 offset:6144
  v_mfma_f32_16x16x32_bf16 v[76:79], v[180:183], v[100:103], v[76:79]
  s_waitcnt lgkmcnt(4)
  v_mfma_f32_16x16x32_bf16 v[80:83], v[176:179], v[104:107], v[80:83]
  ds_read_b128 v[124:127], v6 offset:8192
  v_mfma_f32_16x16x32_bf16 v[84:87], v[180:183], v[104:107], v[84:87]
  s_waitcnt vmcnt(6)
  s_waitcnt lgkmcnt(4)
  v_mfma_f32_16x16x32_bf16 v[48:51], v[184:187], v[108:111], v[48:51]
  ds_read_b128 v[88:91], v5 offset:10240
  v_mfma_f32_16x16x32_bf16 v[52:55], v[188:191], v[108:111], v[52:55]
  buffer_load_dwordx4 v[152:155], v0, s[52:55], s18 offen offset:1280 sc1
  s_waitcnt lgkmcnt(4)
  v_mfma_f32_16x16x32_bf16 v[56:59], v[184:187], v[112:115], v[56:59]
  ds_read_b128 v[92:95], v5 offset:12288
  v_mfma_f32_16x16x32_bf16 v[60:63], v[188:191], v[112:115], v[60:63]
  buffer_load_dwordx4 v[156:159], v0, s[52:55], s19 offen offset:1280 sc1
  s_waitcnt lgkmcnt(4)
  v_mfma_f32_16x16x32_bf16 v[64:67], v[184:187], v[116:119], v[64:67]
  ds_read_b128 v[96:99], v5 offset:14336
  v_mfma_f32_16x16x32_bf16 v[68:71], v[188:191], v[116:119], v[68:71]
  s_waitcnt lgkmcnt(4)
  v_mfma_f32_16x16x32_bf16 v[72:75], v[184:187], v[120:123], v[72:75]
  ds_read_b128 v[100:103], v5 offset:16384
  v_mfma_f32_16x16x32_bf16 v[76:79], v[188:191], v[120:123], v[76:79]
  s_waitcnt lgkmcnt(4)
  v_mfma_f32_16x16x32_bf16 v[80:83], v[184:187], v[124:127], v[80:83]
  ds_read_b128 v[104:107], v5 offset:18432
  v_mfma_f32_16x16x32_bf16 v[84:87], v[188:191], v[124:127], v[84:87]
  s_waitcnt vmcnt(6)
  s_waitcnt lgkmcnt(4)
  v_mfma_f32_16x16x32_bf16 v[48:51], v[128:131], v[88:91], v[48:51]
  ds_read_b128 v[108:111], v6 offset:10240
  v_mfma_f32_16x16x32_bf16 v[52:55], v[132:135], v[88:91], v[52:55]
  s_waitcnt lgkmcnt(4)
  v_mfma_f32_16x16x32_bf16 v[56:59], v[128:131], v[92:95], v[56:59]
  ds_read_b128 v[112:115], v6 offset:12288
  v_mfma_f32_16x16x32_bf16 v[60:63], v[132:135], v[92:95], v[60:63]
  s_waitcnt lgkmcnt(4)
  v_mfma_f32_16x16x32_bf16 v[64:67], v[128:131], v[96:99], v[64:67]
  ds_read_b128 v[116:119], v6 offset:14336
  v_mfma_f32_16x16x32_bf16 v[68:71], v[132:135], v[96:99], v[68:71]
  s_waitcnt lgkmcnt(4)
  v_mfma_f32_16x16x32_bf16 v[72:75], v[128:131], v[100:103], v[72:75]
  ds_read_b128 v[120:123], v6 offset:16384
  v_mfma_f32_16x16x32_bf16 v[76:79], v[132:135], v[100:103], v[76:79]
  s_waitcnt lgkmcnt(4)
  v_mfma_f32_16x16x32_bf16 v[80:83], v[128:131], v[104:107], v[80:83]
  ds_read_b128 v[124:127], v6 offset:18432
  v_mfma_f32_16x16x32_bf16 v[84:87], v[132:135], v[104:107], v[84:87]
  s_waitcnt vmcnt(4)
  s_waitcnt lgkmcnt(4)
  v_mfma_f32_16x16x32_bf16 v[48:51], v[136:139], v[108:111], v[48:51]
  ds_read_b128 v[88:91], v5 offset:20480
  v_mfma_f32_16x16x32_bf16 v[52:55], v[140:143], v[108:111], v[52:55]
  s_waitcnt lgkmcnt(4)
  v_mfma_f32_16x16x32_bf16 v[56:59], v[136:139], v[112:115], v[56:59]
  ds_read_b128 v[92:95], v5 offset:22528
  v_mfma_f32_16x16x32_bf16 v[60:63], v[140:143], v[112:115], v[60:63]
  s_waitcnt lgkmcnt(4)
  v_mfma_f32_16x16x32_bf16 v[64:67], v[136:139], v[116:119], v[64:67]
  ds_read_b128 v[96:99], v5 offset:24576
  v_mfma_f32_16x16x32_bf16 v[68:71], v[140:143], v[116:119], v[68:71]
  s_waitcnt lgkmcnt(4)
  v_mfma_f32_16x16x32_bf16 v[72:75], v[136:139], v[120:123], v[72:75]
  ds_read_b128 v[100:103], v5 offset:26624
  v_mfma_f32_16x16x32_bf16 v[76:79], v[140:143], v[120:123], v[76:79]
  s_waitcnt lgkmcnt(4)
  v_mfma_f32_16x16x32_bf16 v[80:83], v[136:139], v[124:127], v[80:83]
  ds_read_b128 v[104:107], v5 offset:28672
  v_mfma_f32_16x16x32_bf16 v[84:87], v[140:143], v[124:127], v[84:87]
  s_waitcnt vmcnt(2)
  s_waitcnt lgkmcnt(4)
  v_mfma_f32_16x16x32_bf16 v[48:51], v[144:147], v[88:91], v[48:51]
  ds_read_b128 v[108:111], v6 offset:20480
  v_mfma_f32_16x16x32_bf16 v[52:55], v[148:151], v[88:91], v[52:55]
  s_waitcnt lgkmcnt(4)
  v_mfma_f32_16x16x32_bf16 v[56:59], v[144:147], v[92:95], v[56:59]
  ds_read_b128 v[112:115], v6 offset:22528
  v_mfma_f32_16x16x32_bf16 v[60:63], v[148:151], v[92:95], v[60:63]
  s_waitcnt lgkmcnt(4)
  v_mfma_f32_16x16x32_bf16 v[64:67], v[144:147], v[96:99], v[64:67]
  ds_read_b128 v[116:119], v6 offset:24576
  v_mfma_f32_16x16x32_bf16 v[68:71], v[148:151], v[96:99], v[68:71]
  s_waitcnt lgkmcnt(4)
  v_mfma_f32_16x16x32_bf16 v[72:75], v[144:147], v[100:103], v[72:75]
  ds_read_b128 v[120:123], v6 offset:26624
  v_mfma_f32_16x16x32_bf16 v[76:79], v[148:151], v[100:103], v[76:79]
  s_waitcnt lgkmcnt(4)
  v_mfma_f32_16x16x32_bf16 v[80:83], v[144:147], v[104:107], v[80:83]
  ds_read_b128 v[124:127], v6 offset:28672
  v_mfma_f32_16x16x32_bf16 v[84:87], v[148:151], v[104:107], v[84:87]
  s_waitcnt vmcnt(0)
  s_waitcnt lgkmcnt(4)
  v_mfma_f32_16x16x32_bf16 v[48:51], v[152:155], v[108:111], v[48:51]
  v_mfma_f32_16x16x32_bf16 v[52:55], v[156:159], v[108:111], v[52:55]
  s_waitcnt lgkmcnt(3)
  v_mfma_f32_16x16x32_bf16 v[56:59], v[152:155], v[112:115], v[56:59]
  v_mfma_f32_16x16x32_bf16 v[60:63], v[156:159], v[112:115], v[60:63]
  s_waitcnt lgkmcnt(2)
  v_mfma_f32_16x16x32_bf16 v[64:67], v[152:155], v[116:119], v[64:67]
  v_mfma_f32_16x16x32_bf16 v[68:71], v[156:159], v[116:119], v[68:71]
  s_waitcnt lgkmcnt(1)
  v_mfma_f32_16x16x32_bf16 v[72:75], v[152:155], v[120:123], v[72:75]
  v_mfma_f32_16x16x32_bf16 v[76:79], v[156:159], v[120:123], v[76:79]
  s_waitcnt lgkmcnt(0)
  v_mfma_f32_16x16x32_bf16 v[80:83], v[152:155], v[124:127], v[80:83]
  v_mfma_f32_16x16x32_bf16 v[84:87], v[156:159], v[124:127], v[84:87]
  v_fma_f32 v176, v16, v48, v49
  v_fma_f32 v177, v17, v56, v57
  v_fma_f32 v178, v18, v64, v65
  s_nop 0
  v_fma_f32 v179, v19, v72, v73
  s_nop 1
  v_fma_f32 v180, v20, v80, v81
  v_fmac_f32_dpp v176, -v48, v21 quad_perm:[1,0,3,2] row_mask:0xf bank_mask:0xf
  v_fmac_f32_dpp v177, -v56, v22 quad_perm:[1,0,3,2] row_mask:0xf bank_mask:0xf
  v_fmac_f32_dpp v178, -v64, v23 quad_perm:[1,0,3,2] row_mask:0xf bank_mask:0xf
  v_fmac_f32_dpp v179, -v72, v24 quad_perm:[1,0,3,2] row_mask:0xf bank_mask:0xf
  v_fmac_f32_dpp v180, -v80, v25 quad_perm:[1,0,3,2] row_mask:0xf bank_mask:0xf
  v_fma_f32 v182, v16, v176, v50
  v_fma_f32 v183, v17, v177, v58
  v_fma_f32 v184, v18, v178, v66
  v_fma_f32 v185, v19, v179, v74
  v_fma_f32 v186, v20, v180, v82
  v_fmac_f32_dpp v182, -v176, v21 quad_perm:[1,0,3,2] row_mask:0xf bank_mask:0xf
  v_fmac_f32_dpp v183, -v177, v22 quad_perm:[1,0,3,2] row_mask:0xf bank_mask:0xf
  v_fmac_f32_dpp v184, -v178, v23 quad_perm:[1,0,3,2] row_mask:0xf bank_mask:0xf
  v_fmac_f32_dpp v185, -v179, v24 quad_perm:[1,0,3,2] row_mask:0xf bank_mask:0xf
  v_fmac_f32_dpp v186, -v180, v25 quad_perm:[1,0,3,2] row_mask:0xf bank_mask:0xf
  v_fma_f32 v176, v16, v182, v51
  v_fma_f32 v177, v17, v183, v59
  v_fma_f32 v178, v18, v184, v67
  v_fma_f32 v179, v19, v185, v75
  v_fma_f32 v180, v20, v186, v83
  v_fmac_f32_dpp v176, -v182, v21 quad_perm:[1,0,3,2] row_mask:0xf bank_mask:0xf
  v_fmac_f32_dpp v177, -v183, v22 quad_perm:[1,0,3,2] row_mask:0xf bank_mask:0xf
  v_fmac_f32_dpp v178, -v184, v23 quad_perm:[1,0,3,2] row_mask:0xf bank_mask:0xf
  v_fmac_f32_dpp v179, -v185, v24 quad_perm:[1,0,3,2] row_mask:0xf bank_mask:0xf
  v_fmac_f32_dpp v180, -v186, v25 quad_perm:[1,0,3,2] row_mask:0xf bank_mask:0xf
  v_fma_f32 v182, v16, v176, v52
  v_fma_f32 v183, v17, v177, v60
  v_fma_f32 v184, v18, v178, v68
  v_fma_f32 v185, v19, v179, v76
  v_fma_f32 v186, v20, v180, v84
  v_fmac_f32_dpp v182, -v176, v21 quad_perm:[1,0,3,2] row_mask:0xf bank_mask:0xf
  v_fmac_f32_dpp v183, -v177, v22 quad_perm:[1,0,3,2] row_mask:0xf bank_mask:0xf
  v_fmac_f32_dpp v184, -v178, v23 quad_perm:[1,0,3,2] row_mask:0xf bank_mask:0xf
  v_fmac_f32_dpp v185, -v179, v24 quad_perm:[1,0,3,2] row_mask:0xf bank_mask:0xf
  v_fmac_f32_dpp v186, -v180, v25 quad_perm:[1,0,3,2] row_mask:0xf bank_mask:0xf
  v_fma_f32 v176, v16, v182, v53
  v_fma_f32 v177, v17, v183, v61
  v_fma_f32 v178, v18, v184, v69
  v_fma_f32 v179, v19, v185, v77
  v_fma_f32 v180, v20, v186, v85
  v_fmac_f32_dpp v176, -v182, v21 quad_perm:[1,0,3,2] row_mask:0xf bank_mask:0xf
  v_fmac_f32_dpp v177, -v183, v22 quad_perm:[1,0,3,2] row_mask:0xf bank_mask:0xf
  v_fmac_f32_dpp v178, -v184, v23 quad_perm:[1,0,3,2] row_mask:0xf bank_mask:0xf
  v_fmac_f32_dpp v179, -v185, v24 quad_perm:[1,0,3,2] row_mask:0xf bank_mask:0xf
  v_fmac_f32_dpp v180, -v186, v25 quad_perm:[1,0,3,2] row_mask:0xf bank_mask:0xf
  v_fma_f32 v182, v16, v176, v54
  v_fma_f32 v183, v17, v177, v62
  v_fma_f32 v184, v18, v178, v70
  v_fma_f32 v185, v19, v179, v78
  v_fma_f32 v186, v20, v180, v86
  v_fmac_f32_dpp v182, -v176, v21 quad_perm:[1,0,3,2] row_mask:0xf bank_mask:0xf
  v_fmac_f32_dpp v183, -v177, v22 quad_perm:[1,0,3,2] row_mask:0xf bank_mask:0xf
  v_fmac_f32_dpp v184, -v178, v23 quad_perm:[1,0,3,2] row_mask:0xf bank_mask:0xf
  v_fmac_f32_dpp v185, -v179, v24 quad_perm:[1,0,3,2] row_mask:0xf bank_mask:0xf
  v_fmac_f32_dpp v186, -v180, v25 quad_perm:[1,0,3,2] row_mask:0xf bank_mask:0xf
  v_fma_f32 v176, v16, v182, v55
  v_fma_f32 v177, v17, v183, v63
  v_fma_f32 v178, v18, v184, v71
  v_fma_f32 v179, v19, v185, v79
  v_fma_f32 v180, v20, v186, v87
  v_fmac_f32_dpp v176, -v182, v21 quad_perm:[1,0,3,2] row_mask:0xf bank_mask:0xf
  v_fmac_f32_dpp v177, -v183, v22 quad_perm:[1,0,3,2] row_mask:0xf bank_mask:0xf
  v_fmac_f32_dpp v178, -v184, v23 quad_perm:[1,0,3,2] row_mask:0xf bank_mask:0xf
  v_fmac_f32_dpp v179, -v185, v24 quad_perm:[1,0,3,2] row_mask:0xf bank_mask:0xf
  v_fmac_f32_dpp v180, -v186, v25 quad_perm:[1,0,3,2] row_mask:0xf bank_mask:0xf
  ds_write_b32 v9, v176 offset:0
  ds_write_b32 v9, v177 offset:1152
  ds_write_b32 v9, v178 offset:2304
  ds_write_b32 v9, v179 offset:3456
  ds_write_b32 v9, v180 offset:4608
  v_min_u32_e64 v11, 39, v1
  v_mul_u32_u24 v12, 144, v11
  v_add_u32 v12, 158080, v12
  s_cmp_lg_u32 s7, 2
  s_waitcnt lgkmcnt(0)
  s_barrier
  s_cbranch_scc1 skip_56
  ds_read_b128 v[208:211], v12 offset:0
  ds_read_b128 v[212:215], v12 offset:16
  ds_read_b128 v[216:219], v12 offset:32
  ds_read_b128 v[220:223], v12 offset:48
  ds_read_b128 v[224:227], v12 offset:64
  ds_read_b128 v[228:231], v12 offset:80
  ds_read_b128 v[232:235], v12 offset:96
  ds_read_b128 v[236:239], v12 offset:112
  v_lshlrev_b32_e64 v11, 4, v11
  s_add_u32 s12, s95, 392448
  v_mov_b32 v44, s8
  v_mov_b32 v45, s8
  s_waitcnt lgkmcnt(7)
  v_pk_fma_f32 v[42:43], v[208:209], v[36:37], v[210:211] op_sel:[1,1,0] op_sel_hi:[0,1,1] neg_lo:[0,1,0]
  v_pk_fma_f32 v[42:43], v[208:209], v[36:37], v[42:43] op_sel:[0,0,0] op_sel_hi:[1,0,1]
  s_waitcnt lgkmcnt(6)
  v_pk_fma_f32 v[46:47], v[42:43], v[36:37], v[212:213] op_sel:[1,1,0] op_sel_hi:[0,1,1] neg_lo:[0,1,0]
  v_pk_fma_f32 v[46:47], v[42:43], v[36:37], v[46:47] op_sel:[0,0,0] op_sel_hi:[1,0,1]
  v_pk_fma_f32 v[42:43], v[46:47], v[36:37], v[214:215] op_sel:[1,1,0] op_sel_hi:[0,1,1] neg_lo:[0,1,0]
  v_pk_fma_f32 v[42:43], v[46:47], v[36:37], v[42:43] op_sel:[0,0,0] op_sel_hi:[1,0,1]
  s_waitcnt lgkmcnt(5)
  v_pk_fma_f32 v[46:47], v[42:43], v[36:37], v[216:217] op_sel:[1,1,0] op_sel_hi:[0,1,1] neg_lo:[0,1,0]
  v_pk_fma_f32 v[46:47], v[42:43], v[36:37], v[46:47] op_sel:[0,0,0] op_sel_hi:[1,0,1]
  v_pk_fma_f32 v[42:43], v[46:47], v[36:37], v[218:219] op_sel:[1,1,0] op_sel_hi:[0,1,1] neg_lo:[0,1,0]
  v_pk_fma_f32 v[42:43], v[46:47], v[36:37], v[42:43] op_sel:[0,0,0] op_sel_hi:[1,0,1]
  s_waitcnt lgkmcnt(4)
  v_pk_fma_f32 v[46:47], v[42:43], v[36:37], v[220:221] op_sel:[1,1,0] op_sel_hi:[0,1,1] neg_lo:[0,1,0]
  v_pk_fma_f32 v[46:47], v[42:43], v[36:37], v[46:47] op_sel:[0,0,0] op_sel_hi:[1,0,1]
  v_pk_fma_f32 v[42:43], v[46:47], v[36:37], v[222:223] op_sel:[1,1,0] op_sel_hi:[0,1,1] neg_lo:[0,1,0]
  v_pk_fma_f32 v[42:43], v[46:47], v[36:37], v[42:43] op_sel:[0,0,0] op_sel_hi:[1,0,1]
  s_waitcnt lgkmcnt(3)
  v_pk_fma_f32 v[46:47], v[42:43], v[36:37], v[224:225] op_sel:[1,1,0] op_sel_hi:[0,1,1] neg_lo:[0,1,0]
  v_pk_fma_f32 v[46:47], v[42:43], v[36:37], v[46:47] op_sel:[0,0,0] op_sel_hi:[1,0,1]
  v_pk_fma_f32 v[42:43], v[46:47], v[36:37], v[226:227] op_sel:[1,1,0] op_sel_hi:[0,1,1] neg_lo:[0,1,0]
  v_pk_fma_f32 v[42:43], v[46:47], v[36:37], v[42:43] op_sel:[0,0,0] op_sel_hi:[1,0,1]
  s_waitcnt lgkmcnt(2)
  v_pk_fma_f32 v[46:47], v[42:43], v[36:37], v[228:229] op_sel:[1,1,0] op_sel_hi:[0,1,1] neg_lo:[0,1,0]
  v_pk_fma_f32 v[46:47], v[42:43], v[36:37], v[46:47] op_sel:[0,0,0] op_sel_hi:[1,0,1]
  v_pk_fma_f32 v[42:43], v[46:47], v[36:37], v[230:231] op_sel:[1,1,0] op_sel_hi:[0,1,1] neg_lo:[0,1,0]
  v_pk_fma_f32 v[42:43], v[46:47], v[36:37], v[42:43] op_sel:[0,0,0] op_sel_hi:[1,0,1]
  s_waitcnt lgkmcnt(1)
  v_pk_fma_f32 v[46:47], v[42:43], v[36:37], v[232:233] op_sel:[1,1,0] op_sel_hi:[0,1,1] neg_lo:[0,1,0]
  v_pk_fma_f32 v[46:47], v[42:43], v[36:37], v[46:47] op_sel:[0,0,0] op_sel_hi:[1,0,1]
  v_pk_fma_f32 v[42:43], v[46:47], v[36:37], v[234:235] op_sel:[1,1,0] op_sel_hi:[0,1,1] neg_lo:[0,1,0]
  v_pk_fma_f32 v[42:43], v[46:47], v[36:37], v[42:43] op_sel:[0,0,0] op_sel_hi:[1,0,1]
  s_waitcnt lgkmcnt(0)
  v_pk_fma_f32 v[46:47], v[42:43], v[36:37], v[236:237] op_sel:[1,1,0] op_sel_hi:[0,1,1] neg_lo:[0,1,0]
  v_pk_fma_f32 v[46:47], v[42:43], v[36:37], v[46:47] op_sel:[0,0,0] op_sel_hi:[1,0,1]
  v_pk_fma_f32 v[42:43], v[46:47], v[36:37], v[238:239] op_sel:[1,1,0] op_sel_hi:[0,1,1] neg_lo:[0,1,0]
  v_pk_fma_f32 v[42:43], v[46:47], v[36:37], v[42:43] op_sel:[0,0,0] op_sel_hi:[1,0,1]
  buffer_store_dwordx4 v[42:45], v11, s[52:55], s12 offen sc1
  v_pk_mul_f32 v[46:47], v[208:209], v[40:41] op_sel:[1,1] op_sel_hi:[0,1] neg_lo:[0,1] neg_hi:[0,1]
  v_pk_fma_f32 v[208:209], v[208:209], v[40:41], v[46:47] op_sel:[0,0,0] op_sel_hi:[1,0,1] neg_hi:[0,1,0]
  v_pk_mul_f32 v[46:47], v[210:211], v[40:41] op_sel:[1,1] op_sel_hi:[0,1] neg_lo:[0,1] neg_hi:[0,1]
  v_pk_fma_f32 v[210:211], v[210:211], v[40:41], v[46:47] op_sel:[0,0,0] op_sel_hi:[1,0,1] neg_hi:[0,1,0]
  v_pk_mul_f32 v[46:47], v[212:213], v[40:41] op_sel:[1,1] op_sel_hi:[0,1] neg_lo:[0,1] neg_hi:[0,1]
  v_pk_fma_f32 v[212:213], v[212:213], v[40:41], v[46:47] op_sel:[0,0,0] op_sel_hi:[1,0,1] neg_hi:[0,1,0]
  v_pk_mul_f32 v[46:47], v[214:215], v[40:41] op_sel:[1,1] op_sel_hi:[0,1] neg_lo:[0,1] neg_hi:[0,1]
  v_pk_fma_f32 v[214:215], v[214:215], v[40:41], v[46:47] op_sel:[0,0,0] op_sel_hi:[1,0,1] neg_hi:[0,1,0]
  v_pk_mul_f32 v[46:47], v[216:217], v[40:41] op_sel:[1,1] op_sel_hi:[0,1] neg_lo:[0,1] neg_hi:[0,1]
  v_pk_fma_f32 v[216:217], v[216:217], v[40:41], v[46:47] op_sel:[0,0,0] op_sel_hi:[1,0,1] neg_hi:[0,1,0]
  v_pk_mul_f32 v[46:47], v[218:219], v[40:41] op_sel:[1,1] op_sel_hi:[0,1] neg_lo:[0,1] neg_hi:[0,1]
  v_pk_fma_f32 v[218:219], v[218:219], v[40:41], v[46:47] op_sel:[0,0,0] op_sel_hi:[1,0,1] neg_hi:[0,1,0]
  v_pk_mul_f32 v[46:47], v[220:221], v[40:41] op_sel:[1,1] op_sel_hi:[0,1] neg_lo:[0,1] neg_hi:[0,1]
  v_pk_fma_f32 v[220:221], v[220:221], v[40:41], v[46:47] op_sel:[0,0,0] op_sel_hi:[1,0,1] neg_hi:[0,1,0]
  v_pk_mul_f32 v[46:47], v[222:223], v[40:41] op_sel:[1,1] op_sel_hi:[0,1] neg_lo:[0,1] neg_hi:[0,1]
  v_pk_fma_f32 v[222:223], v[222:223], v[40:41], v[46:47] op_sel:[0,0,0] op_sel_hi:[1,0,1] neg_hi:[0,1,0]
  v_pk_mul_f32 v[46:47], v[224:225], v[40:41] op_sel:[1,1] op_sel_hi:[0,1] neg_lo:[0,1] neg_hi:[0,1]
  v_pk_fma_f32 v[224:225], v[224:225], v[40:41], v[46:47] op_sel:[0,0,0] op_sel_hi:[1,0,1] neg_hi:[0,1,0]
  v_pk_mul_f32 v[46:47], v[226:227], v[40:41] op_sel:[1,1] op_sel_hi:[0,1] neg_lo:[0,1] neg_hi:[0,1]
  v_pk_fma_f32 v[226:227], v[226:227], v[40:41], v[46:47] op_sel:[0,0,0] op_sel_hi:[1,0,1] neg_hi:[0,1,0]
  v_pk_mul_f32 v[46:47], v[228:229], v[40:41] op_sel:[1,1] op_sel_hi:[0,1] neg_lo:[0,1] neg_hi:[0,1]
  v_pk_fma_f32 v[228:229], v[228:229], v[40:41], v[46:47] op_sel:[0,0,0] op_sel_hi:[1,0,1] neg_hi:[0,1,0]
  v_pk_mul_f32 v[46:47], v[230:231], v[40:41] op_sel:[1,1] op_sel_hi:[0,1] neg_lo:[0,1] neg_hi:[0,1]
  v_pk_fma_f32 v[230:231], v[230:231], v[40:41], v[46:47] op_sel:[0,0,0] op_sel_hi:[1,0,1] neg_hi:[0,1,0]
  v_pk_mul_f32 v[46:47], v[232:233], v[40:41] op_sel:[1,1] op_sel_hi:[0,1] neg_lo:[0,1] neg_hi:[0,1]
  v_pk_fma_f32 v[232:233], v[232:233], v[40:41], v[46:47] op_sel:[0,0,0] op_sel_hi:[1,0,1] neg_hi:[0,1,0]
  v_pk_mul_f32 v[46:47], v[234:235], v[40:41] op_sel:[1,1] op_sel_hi:[0,1] neg_lo:[0,1] neg_hi:[0,1]
  v_pk_fma_f32 v[234:235], v[234:235], v[40:41], v[46:47] op_sel:[0,0,0] op_sel_hi:[1,0,1] neg_hi:[0,1,0]
  v_pk_mul_f32 v[46:47], v[236:237], v[40:41] op_sel:[1,1] op_sel_hi:[0,1] neg_lo:[0,1] neg_hi:[0,1]
  v_pk_fma_f32 v[236:237], v[236:237], v[40:41], v[46:47] op_sel:[0,0,0] op_sel_hi:[1,0,1] neg_hi:[0,1,0]
  v_pk_mul_f32 v[46:47], v[238:239], v[40:41] op_sel:[1,1] op_sel_hi:[0,1] neg_lo:[0,1] neg_hi:[0,1]
  v_pk_fma_f32 v[238:239], v[238:239], v[40:41], v[46:47] op_sel:[0,0,0] op_sel_hi:[1,0,1] neg_hi:[0,1,0]
  s_add_u32 s80, s95, 380928
  s_add_u32 s81, s95, 384768
  s_add_u32 s82, s95, 388608
skip_56:
  v_mul_f32 v88, v26, v48
  v_mul_f32 v89, v26, v49
  v_mul_f32 v90, v26, v50
  v_mul_f32 v91, v26, v51
  v_mul_f32 v92, v26, v52
  v_mul_f32 v93, v26, v53
  v_mul_f32 v94, v26, v54
  v_mul_f32 v95, v26, v55
  v_fmac_f32_dpp v88, v48, v31 quad_perm:[1,0,3,2] row_mask:0xf bank_mask:0xf
  v_fmac_f32_dpp v89, v49, v31 quad_perm:[1,0,3,2] row_mask:0xf bank_mask:0xf
  v_fmac_f32_dpp v90, v50, v31 quad_perm:[1,0,3,2] row_mask:0xf bank_mask:0xf
  v_fmac_f32_dpp v91, v51, v31 quad_perm:[1,0,3,2] row_mask:0xf bank_mask:0xf
  v_fmac_f32_dpp v92, v52, v31 quad_perm:[1,0,3,2] row_mask:0xf bank_mask:0xf
  v_fmac_f32_dpp v93, v53, v31 quad_perm:[1,0,3,2] row_mask:0xf bank_mask:0xf
  v_fmac_f32_dpp v94, v54, v31 quad_perm:[1,0,3,2] row_mask:0xf bank_mask:0xf
  v_fmac_f32_dpp v95, v55, v31 quad_perm:[1,0,3,2] row_mask:0xf bank_mask:0xf
  v_mul_f32 v96, v27, v56
  v_mul_f32 v97, v27, v57
  v_mul_f32 v98, v27, v58
  v_mul_f32 v99, v27, v59
  v_mul_f32 v100, v27, v60
  v_mul_f32 v101, v27, v61
  v_mul_f32 v102, v27, v62
  v_mul_f32 v103, v27, v63
  v_fmac_f32_dpp v96, v56, v32 quad_perm:[1,0,3,2] row_mask:0xf bank_mask:0xf
  v_fmac_f32_dpp v97, v57, v32 quad_perm:[1,0,3,2] row_mask:0xf bank_mask:0xf
  v_fmac_f32_dpp v98, v58, v32 quad_perm:[1,0,3,2] row_mask:0xf bank_mask:0xf
  v_fmac_f32_dpp v99, v59, v32 quad_perm:[1,0,3,2] row_mask:0xf bank_mask:0xf
  v_fmac_f32_dpp v100, v60, v32 quad_perm:[1,0,3,2] row_mask:0xf bank_mask:0xf
  v_fmac_f32_dpp v101, v61, v32 quad_perm:[1,0,3,2] row_mask:0xf bank_mask:0xf
  v_fmac_f32_dpp v102, v62, v32 quad_perm:[1,0,3,2] row_mask:0xf bank_mask:0xf
  v_fmac_f32_dpp v103, v63, v32 quad_perm:[1,0,3,2] row_mask:0xf bank_mask:0xf
  v_mul_f32 v104, v28, v64
  v_mul_f32 v105, v28, v65
  v_mul_f32 v106, v28, v66
  v_mul_f32 v107, v28, v67
  v_mul_f32 v108, v28, v68
  v_mul_f32 v109, v28, v69
  v_mul_f32 v110, v28, v70
  v_mul_f32 v111, v28, v71
  v_fmac_f32_dpp v104, v64, v33 quad_perm:[1,0,3,2] row_mask:0xf bank_mask:0xf
  v_fmac_f32_dpp v105, v65, v33 quad_perm:[1,0,3,2] row_mask:0xf bank_mask:0xf
  v_fmac_f32_dpp v106, v66, v33 quad_perm:[1,0,3,2] row_mask:0xf bank_mask:0xf
  v_fmac_f32_dpp v107, v67, v33 quad_perm:[1,0,3,2] row_mask:0xf bank_mask:0xf
  v_fmac_f32_dpp v108, v68, v33 quad_perm:[1,0,3,2] row_mask:0xf bank_mask:0xf
  v_fmac_f32_dpp v109, v69, v33 quad_perm:[1,0,3,2] row_mask:0xf bank_mask:0xf
  v_fmac_f32_dpp v110, v70, v33 quad_perm:[1,0,3,2] row_mask:0xf bank_mask:0xf
  v_fmac_f32_dpp v111, v71, v33 quad_perm:[1,0,3,2] row_mask:0xf bank_mask:0xf
  v_mul_f32 v112, v29, v72
  v_mul_f32 v113, v29, v73
  v_mul_f32 v114, v29, v74
  v_mul_f32 v115, v29, v75
  v_mul_f32 v116, v29, v76
  v_mul_f32 v117, v29, v77
  v_mul_f32 v118, v29, v78
  v_mul_f32 v119, v29, v79
  v_fmac_f32_dpp v112, v72, v34 quad_perm:[1,0,3,2] row_mask:0xf bank_mask:0xf
  v_fmac_f32_dpp v113, v73, v34 quad_perm:[1,0,3,2] row_mask:0xf bank_mask:0xf
  v_fmac_f32_dpp v114, v74, v34 quad_perm:[1,0,3,2] row_mask:0xf bank_mask:0xf
  v_fmac_f32_dpp v115, v75, v34 quad_perm:[1,0,3,2] row_mask:0xf bank_mask:0xf
  v_fmac_f32_dpp v116, v76, v34 quad_perm:[1,0,3,2] row_mask:0xf bank_mask:0xf
  v_fmac_f32_dpp v117, v77, v34 quad_perm:[1,0,3,2] row_mask:0xf bank_mask:0xf
  v_fmac_f32_dpp v118, v78, v34 quad_perm:[1,0,3,2] row_mask:0xf bank_mask:0xf
  v_fmac_f32_dpp v119, v79, v34 quad_perm:[1,0,3,2] row_mask:0xf bank_mask:0xf
  v_mul_f32 v120, v30, v80
  v_mul_f32 v121, v30, v81
  v_mul_f32 v122, v30, v82
  v_mul_f32 v123, v30, v83
  v_mul_f32 v124, v30, v84
  v_mul_f32 v125, v30, v85
  v_mul_f32 v126, v30, v86
  v_mul_f32 v127, v30, v87
  v_fmac_f32_dpp v120, v80, v35 quad_perm:[1,0,3,2] row_mask:0xf bank_mask:0xf
  v_fmac_f32_dpp v121, v81, v35 quad_perm:[1,0,3,2] row_mask:0xf bank_mask:0xf
  v_fmac_f32_dpp v122, v82, v35 quad_perm:[1,0,3,2] row_mask:0xf bank_mask:0xf
  v_fmac_f32_dpp v123, v83, v35 quad_perm:[1,0,3,2] row_mask:0xf bank_mask:0xf
  v_fmac_f32_dpp v124, v84, v35 quad_perm:[1,0,3,2] row_mask:0xf bank_mask:0xf
  v_fmac_f32_dpp v125, v85, v35 quad_perm:[1,0,3,2] row_mask:0xf bank_mask:0xf
  v_fmac_f32_dpp v126, v86, v35 quad_perm:[1,0,3,2] row_mask:0xf bank_mask:0xf
  v_fmac_f32_dpp v127, v87, v35 quad_perm:[1,0,3,2] row_mask:0xf bank_mask:0xf
  s_mul_i32 s12, s7, 1280
  s_add_u32 s12, s12, 152320
  v_mul_u32_u24 v11, 80, v3
  v_lshl_add_u32 v11, v4, 4, v11
  v_add_u32_e64 v252, s12, v11
  v_bfe_u32 v12, v1, 2, 2
  v_mul_u32_u24 v12, 160, v12
  v_and_b32_e64 v13, 3, v1
  v_lshl_add_u32 v12, v13, 4, v12
  v_lshrrev_b32_e64 v13, 1, v4
  v_mul_u32_u24 v14, 80, v13
  v_lshlrev_b32_e64 v13, 10, v13
  v_add3_u32 v12, v12, v14, s12
  v_and_b32_e64 v14, 1, v4
  v_lshl_add_u32 v253, v14, 3, v12
  v_mul_u32_u24 v14, 40960, v14
  v_lshl_add_u32 v13, v3, 4, v13
  v_add_u32 v254, v13, v14
  s_cmp_lg_u32 s7, 2
  s_cbranch_scc1 skip_57
  v_min_u32 v251, 39, v1
  v_mul_u32_u24 v247, 144, v251
  v_add_u32 v247, 158080, v247
  v_lshlrev_b32_e64 v251, 4, v251
aggpoll_58:
  buffer_load_dwordx3 v[128:130], v251, s[52:55], s80 offen offset:0 sc1
  buffer_load_dwordx3 v[132:134], v251, s[52:55], s80 offen offset:768 sc1
  buffer_load_dwordx3 v[136:138], v251, s[52:55], s80 offen offset:1536 sc1
  buffer_load_dwordx3 v[140:142], v251, s[52:55], s80 offen offset:2304 sc1
  buffer_load_dwordx3 v[144:146], v251, s[52:55], s80 offen offset:3072 sc1
  buffer_load_dwordx3 v[148:150], v251, s[52:55], s81 offen offset:0 sc1
  buffer_load_dwordx3 v[152:154], v251, s[52:55], s81 offen offset:768 sc1
  buffer_load_dwordx3 v[156:158], v251, s[52:55], s81 offen offset:1536 sc1
  buffer_load_dwordx3 v[160:162], v251, s[52:55], s81 offen offset:2304 sc1
  buffer_load_dwordx3 v[164:166], v251, s[52:55], s81 offen offset:3072 sc1
  buffer_load_dwordx3 v[168:170], v251, s[52:55], s82 offen offset:0 sc1
  buffer_load_dwordx3 v[172:174], v251, s[52:55], s82 offen offset:768 sc1
  buffer_load_dwordx3 v[240:242], v251, s[52:55], s82 offen offset:1536 sc1
  buffer_load_dwordx3 v[244:246], v251, s[52:55], s82 offen offset:2304 sc1
  buffer_load_dwordx3 v[248:250], v251, s[52:55], s82 offen offset:3072 sc1
  s_waitcnt vmcnt(0)
  v_min3_u32 v13, v130, v134, v138
  v_max3_u32 v14, v130, v134, v138
  v_min3_u32 v13, v13, v142, v146
  v_max3_u32 v14, v14, v142, v146
  v_min3_u32 v13, v13, v150, v154
  v_max3_u32 v14, v14, v150, v154
  v_min3_u32 v13, v13, v158, v162
  v_max3_u32 v14, v14, v158, v162
  v_min3_u32 v13, v13, v166, v170
  v_max3_u32 v14, v14, v166, v170
  v_min3_u32 v13, v13, v174, v242
  v_max3_u32 v14, v14, v174, v242
  v_min3_u32 v13, v13, v246, v250
  v_max3_u32 v14, v14, v246, v250
  v_xor_b32 v13, s8, v13
  v_xor_b32 v14, s8, v14
  v_or_b32 v13, v13, v14
  v_cmp_ne_u32 vcc, 0, v13
  s_cbranch_vccnz retry_60
giveup_61:
  v_pk_fma_f32 v[42:43], v[128:129], v[38:39], v[132:133] op_sel:[1,1,0] op_sel_hi:[0,1,1] neg_lo:[0,1,0]
  v_pk_fma_f32 v[42:43], v[128:129], v[38:39], v[42:43] op_sel:[0,0,0] op_sel_hi:[1,0,1]
  v_pk_fma_f32 v[44:45], v[42:43], v[38:39], v[136:137] op_sel:[1,1,0] op_sel_hi:[0,1,1] neg_lo:[0,1,0]
  v_pk_fma_f32 v[44:45], v[42:43], v[38:39], v[44:45] op_sel:[0,0,0] op_sel_hi:[1,0,1]
  v_pk_fma_f32 v[42:43], v[44:45], v[38:39], v[140:141] op_sel:[1,1,0] op_sel_hi:[0,1,1] neg_lo:[0,1,0]
  v_pk_fma_f32 v[42:43], v[44:45], v[38:39], v[42:43] op_sel:[0,0,0] op_sel_hi:[1,0,1]
  v_pk_fma_f32 v[44:45], v[42:43], v[38:39], v[144:145] op_sel:[1,1,0] op_sel_hi:[0,1,1] neg_lo:[0,1,0]
  v_pk_fma_f32 v[44:45], v[42:43], v[38:39], v[44:45] op_sel:[0,0,0] op_sel_hi:[1,0,1]
  v_pk_fma_f32 v[42:43], v[44:45], v[38:39], v[148:149] op_sel:[1,1,0] op_sel_hi:[0,1,1] neg_lo:[0,1,0]
  v_pk_fma_f32 v[42:43], v[44:45], v[38:39], v[42:43] op_sel:[0,0,0] op_sel_hi:[1,0,1]
  v_pk_fma_f32 v[44:45], v[42:43], v[38:39], v[152:153] op_sel:[1,1,0] op_sel_hi:[0,1,1] neg_lo:[0,1,0]
  v_pk_fma_f32 v[44:45], v[42:43], v[38:39], v[44:45] op_sel:[0,0,0] op_sel_hi:[1,0,1]
  v_pk_fma_f32 v[42:43], v[44:45], v[38:39], v[156:157] op_sel:[1,1,0] op_sel_hi:[0,1,1] neg_lo:[0,1,0]
  v_pk_fma_f32 v[42:43], v[44:45], v[38:39], v[42:43] op_sel:[0,0,0] op_sel_hi:[1,0,1]
  v_pk_fma_f32 v[44:45], v[42:43], v[38:39], v[160:161] op_sel:[1,1,0] op_sel_hi:[0,1,1] neg_lo:[0,1,0]
  v_pk_fma_f32 v[44:45], v[42:43], v[38:39], v[44:45] op_sel:[0,0,0] op_sel_hi:[1,0,1]
  v_pk_fma_f32 v[42:43], v[44:45], v[38:39], v[164:165] op_sel:[1,1,0] op_sel_hi:[0,1,1] neg_lo:[0,1,0]
  v_pk_fma_f32 v[42:43], v[44:45], v[38:39], v[42:43] op_sel:[0,0,0] op_sel_hi:[1,0,1]
  v_pk_fma_f32 v[44:45], v[42:43], v[38:39], v[168:169] op_sel:[1,1,0] op_sel_hi:[0,1,1] neg_lo:[0,1,0]
  v_pk_fma_f32 v[44:45], v[42:43], v[38:39], v[44:45] op_sel:[0,0,0] op_sel_hi:[1,0,1]
  v_pk_fma_f32 v[42:43], v[44:45], v[38:39], v[172:173] op_sel:[1,1,0] op_sel_hi:[0,1,1] neg_lo:[0,1,0]
  v_pk_fma_f32 v[42:43], v[44:45], v[38:39], v[42:43] op_sel:[0,0,0] op_sel_hi:[1,0,1]
  v_pk_fma_f32 v[44:45], v[42:43], v[38:39], v[240:241] op_sel:[1,1,0] op_sel_hi:[0,1,1] neg_lo:[0,1,0]
  v_pk_fma_f32 v[44:45], v[42:43], v[38:39], v[44:45] op_sel:[0,0,0] op_sel_hi:[1,0,1]
  v_pk_fma_f32 v[42:43], v[44:45], v[38:39], v[244:245] op_sel:[1,1,0] op_sel_hi:[0,1,1] neg_lo:[0,1,0]
  v_pk_fma_f32 v[42:43], v[44:45], v[38:39], v[42:43] op_sel:[0,0,0] op_sel_hi:[1,0,1]
  v_pk_fma_f32 v[44:45], v[42:43], v[38:39], v[248:249] op_sel:[1,1,0] op_sel_hi:[0,1,1] neg_lo:[0,1,0]
  v_pk_fma_f32 v[44:45], v[42:43], v[38:39], v[44:45] op_sel:[0,0,0] op_sel_hi:[1,0,1]
  v_pk_mul_f32 v[46:47], v[44:45], v[40:41] op_sel:[1,1] op_sel_hi:[0,1] neg_lo:[0,1] neg_hi:[0,1]
  v_pk_fma_f32 v[128:129], v[44:45], v[40:41], v[46:47] op_sel:[0,0,0] op_sel_hi:[1,0,1] neg_hi:[0,1,0]
  s_mov_b32 exec_hi, 0xff
  v_pk_fma_f32 v[130:131], v[128:129], v[36:37], v[208:209] op_sel:[1,1,0] op_sel_hi:[0,1,1] neg_hi:[0,1,0]
  v_pk_fma_f32 v[130:131], v[128:129], v[36:37], v[130:131] op_sel:[0,0,0] op_sel_hi:[1,0,1]
  ds_write_b128 v247, v[128:131] offset:0
  v_pk_fma_f32 v[132:133], v[130:131], v[36:37], v[210:211] op_sel:[1,1,0] op_sel_hi:[0,1,1] neg_hi:[0,1,0]
  v_pk_fma_f32 v[132:133], v[130:131], v[36:37], v[132:133] op_sel:[0,0,0] op_sel_hi:[1,0,1]
  v_pk_fma_f32 v[134:135], v[132:133], v[36:37], v[212:213] op_sel:[1,1,0] op_sel_hi:[0,1,1] neg_hi:[0,1,0]
  v_pk_fma_f32 v[134:135], v[132:133], v[36:37], v[134:135] op_sel:[0,0,0] op_sel_hi:[1,0,1]
  ds_write_b128 v247, v[132:135] offset:16
  v_pk_fma_f32 v[136:137], v[134:135], v[36:37], v[214:215] op_sel:[1,1,0] op_sel_hi:[0,1,1] neg_hi:[0,1,0]
  v_pk_fma_f32 v[136:137], v[134:135], v[36:37], v[136:137] op_sel:[0,0,0] op_sel_hi:[1,0,1]
  v_pk_fma_f32 v[138:139], v[136:137], v[36:37], v[216:217] op_sel:[1,1,0] op_sel_hi:[0,1,1] neg_hi:[0,1,0]
  v_pk_fma_f32 v[138:139], v[136:137], v[36:37], v[138:139] op_sel:[0,0,0] op_sel_hi:[1,0,1]
  ds_write_b128 v247, v[136:139] offset:32
  v_pk_fma_f32 v[140:141], v[138:139], v[36:37], v[218:219] op_sel:[1,1,0] op_sel_hi:[0,1,1] neg_hi:[0,1,0]
  v_pk_fma_f32 v[140:141], v[138:139], v[36:37], v[140:141] op_sel:[0,0,0] op_sel_hi:[1,0,1]
  v_pk_fma_f32 v[142:143], v[140:141], v[36:37], v[220:221] op_sel:[1,1,0] op_sel_hi:[0,1,1] neg_hi:[0,1,0]
  v_pk_fma_f32 v[142:143], v[140:141], v[36:37], v[142:143] op_sel:[0,0,0] op_sel_hi:[1,0,1]
  ds_write_b128 v247, v[140:143] offset:48
  v_pk_fma_f32 v[144:145], v[142:143], v[36:37], v[222:223] op_sel:[1,1,0] op_sel_hi:[0,1,1] neg_hi:[0,1,0]
  v_pk_fma_f32 v[144:145], v[142:143], v[36:37], v[144:145] op_sel:[0,0,0] op_sel_hi:[1,0,1]
  v_pk_fma_f32 v[146:147], v[144:145], v[36:37], v[224:225] op_sel:[1,1,0] op_sel_hi:[0,1,1] neg_hi:[0,1,0]
  v_pk_fma_f32 v[146:147], v[144:145], v[36:37], v[146:147] op_sel:[0,0,0] op_sel_hi:[1,0,1]
  ds_write_b128 v247, v[144:147] offset:64
  v_pk_fma_f32 v[148:149], v[146:147], v[36:37], v[226:227] op_sel:[1,1,0] op_sel_hi:[0,1,1] neg_hi:[0,1,0]
  v_pk_fma_f32 v[148:149], v[146:147], v[36:37], v[148:149] op_sel:[0,0,0] op_sel_hi:[1,0,1]
  v_pk_fma_f32 v[150:151], v[148:149], v[36:37], v[228:229] op_sel:[1,1,0] op_sel_hi:[0,1,1] neg_hi:[0,1,0]
  v_pk_fma_f32 v[150:151], v[148:149], v[36:37], v[150:151] op_sel:[0,0,0] op_sel_hi:[1,0,1]
  ds_write_b128 v247, v[148:151] offset:80
  v_pk_fma_f32 v[152:153], v[150:151], v[36:37], v[230:231] op_sel:[1,1,0] op_sel_hi:[0,1,1] neg_hi:[0,1,0]
  v_pk_fma_f32 v[152:153], v[150:151], v[36:37], v[152:153] op_sel:[0,0,0] op_sel_hi:[1,0,1]
  v_pk_fma_f32 v[154:155], v[152:153], v[36:37], v[232:233] op_sel:[1,1,0] op_sel_hi:[0,1,1] neg_hi:[0,1,0]
  v_pk_fma_f32 v[154:155], v[152:153], v[36:37], v[154:155] op_sel:[0,0,0] op_sel_hi:[1,0,1]
  ds_write_b128 v247, v[152:155] offset:96
  v_pk_fma_f32 v[156:157], v[154:155], v[36:37], v[234:235] op_sel:[1,1,0] op_sel_hi:[0,1,1] neg_hi:[0,1,0]
  v_pk_fma_f32 v[156:157], v[154:155], v[36:37], v[156:157] op_sel:[0,0,0] op_sel_hi:[1,0,1]
  v_pk_fma_f32 v[158:159], v[156:157], v[36:37], v[236:237] op_sel:[1,1,0] op_sel_hi:[0,1,1] neg_hi:[0,1,0]
  v_pk_fma_f32 v[158:159], v[156:157], v[36:37], v[158:159] op_sel:[0,0,0] op_sel_hi:[1,0,1]
  ds_write_b128 v247, v[156:159] offset:112
  s_mov_b32 exec_hi, -1
skip_57:
  s_waitcnt lgkmcnt(0)
  s_barrier
  ds_read_b32 v48, v9 offset:0
  ds_read_b32 v49, v9 offset:1152
  ds_read_b32 v50, v9 offset:2304
  ds_read_b32 v51, v9 offset:3456
  ds_read_b32 v52, v9 offset:4608
  s_waitcnt lgkmcnt(0)
  v_fmac_f32 v88, v16, v48
  v_fmac_f32 v96, v17, v49
  v_fmac_f32_e64 v104, v18, v50
  v_fmac_f32_dpp v88, v48, v21 quad_perm:[1,0,3,2] row_mask:0xf bank_mask:0xf
  v_fmac_f32_dpp v96, v49, v22 quad_perm:[1,0,3,2] row_mask:0xf bank_mask:0xf
  v_fmac_f32_dpp v104, v50, v23 quad_perm:[1,0,3,2] row_mask:0xf bank_mask:0xf
  v_fmac_f32 v89, v16, v88
  v_fmac_f32 v97, v17, v96
  v_fmac_f32_e64 v105, v18, v104
  v_fmac_f32_dpp v89, v88, v21 quad_perm:[1,0,3,2] row_mask:0xf bank_mask:0xf
  v_fmac_f32_dpp v97, v96, v22 quad_perm:[1,0,3,2] row_mask:0xf bank_mask:0xf
  v_fmac_f32_dpp v105, v104, v23 quad_perm:[1,0,3,2] row_mask:0xf bank_mask:0xf
  v_fmac_f32 v90, v16, v89
  v_fmac_f32 v98, v17, v97
  v_fmac_f32_e64 v106, v18, v105
  v_fmac_f32_dpp v90, v89, v21 quad_perm:[1,0,3,2] row_mask:0xf bank_mask:0xf
  v_fmac_f32_dpp v98, v97, v22 quad_perm:[1,0,3,2] row_mask:0xf bank_mask:0xf
  v_fmac_f32_dpp v106, v105, v23 quad_perm:[1,0,3,2] row_mask:0xf bank_mask:0xf
  v_fmac_f32 v91, v16, v90
  v_fmac_f32 v99, v17, v98
  v_fmac_f32_e64 v107, v18, v106
  v_fmac_f32_dpp v91, v90, v21 quad_perm:[1,0,3,2] row_mask:0xf bank_mask:0xf
  v_fmac_f32_dpp v99, v98, v22 quad_perm:[1,0,3,2] row_mask:0xf bank_mask:0xf
  v_fmac_f32_dpp v107, v106, v23 quad_perm:[1,0,3,2] row_mask:0xf bank_mask:0xf
  v_fmac_f32 v92, v16, v91
  v_fmac_f32 v100, v17, v99
  v_fmac_f32_e64 v108, v18, v107
  v_fmac_f32_dpp v92, v91, v21 quad_perm:[1,0,3,2] row_mask:0xf bank_mask:0xf
  v_fmac_f32_dpp v100, v99, v22 quad_perm:[1,0,3,2] row_mask:0xf bank_mask:0xf
  v_fmac_f32_dpp v108, v107, v23 quad_perm:[1,0,3,2] row_mask:0xf bank_mask:0xf
  v_fmac_f32 v93, v16, v92
  v_fmac_f32 v101, v17, v100
  v_fmac_f32_e64 v109, v18, v108
  v_fmac_f32_dpp v93, v92, v21 quad_perm:[1,0,3,2] row_mask:0xf bank_mask:0xf
  v_fmac_f32_dpp v101, v100, v22 quad_perm:[1,0,3,2] row_mask:0xf bank_mask:0xf
  v_fmac_f32_dpp v109, v108, v23 quad_perm:[1,0,3,2] row_mask:0xf bank_mask:0xf
  v_fmac_f32 v94, v16, v93
  v_fmac_f32 v102, v17, v101
  v_fmac_f32_e64 v110, v18, v109
  v_fmac_f32_dpp v94, v93, v21 quad_perm:[1,0,3,2] row_mask:0xf bank_mask:0xf
  v_fmac_f32_dpp v102, v101, v22 quad_perm:[1,0,3,2] row_mask:0xf bank_mask:0xf
  v_fmac_f32_dpp v110, v109, v23 quad_perm:[1,0,3,2] row_mask:0xf bank_mask:0xf
  v_fmac_f32 v95, v16, v94
  v_fmac_f32 v103, v17, v102
  v_fmac_f32_e64 v111, v18, v110
  v_fmac_f32_dpp v95, v94, v21 quad_perm:[1,0,3,2] row_mask:0xf bank_mask:0xf
  v_fmac_f32_dpp v103, v102, v22 quad_perm:[1,0,3,2] row_mask:0xf bank_mask:0xf
  v_fmac_f32_dpp v111, v110, v23 quad_perm:[1,0,3,2] row_mask:0xf bank_mask:0xf
  v_fmac_f32 v112, v19, v51
  v_fmac_f32 v120, v20, v52
  v_cvt_pk_bf16_f32 v56, v88, v89
  v_cvt_pk_bf16_f32 v57, v90, v91
  v_cvt_pk_bf16_f32 v58, v92, v93
  v_fmac_f32_dpp v112, v51, v24 quad_perm:[1,0,3,2] row_mask:0xf bank_mask:0xf
  v_fmac_f32_dpp v120, v52, v25 quad_perm:[1,0,3,2] row_mask:0xf bank_mask:0xf
  v_fmac_f32 v113, v19, v112
  v_fmac_f32 v121, v20, v120
  v_cvt_pk_bf16_f32 v59, v94, v95
  ds_write_b128 v252, v[56:59]
  ds_read_b64_tr_b16 v[68:69], v253
  v_fmac_f32_dpp v113, v112, v24 quad_perm:[1,0,3,2] row_mask:0xf bank_mask:0xf
  v_fmac_f32_dpp v121, v120, v25 quad_perm:[1,0,3,2] row_mask:0xf bank_mask:0xf
  v_fmac_f32 v114, v19, v113
  v_fmac_f32 v122, v20, v121
  ds_read_b64_tr_b16 v[70:71], v253 offset:640
  v_cvt_pk_bf16_f32 v60, v96, v97
  v_cvt_pk_bf16_f32 v61, v98, v99
  v_fmac_f32_dpp v114, v113, v24 quad_perm:[1,0,3,2] row_mask:0xf bank_mask:0xf
  v_fmac_f32_dpp v122, v121, v25 quad_perm:[1,0,3,2] row_mask:0xf bank_mask:0xf
  v_fmac_f32 v115, v19, v114
  v_fmac_f32 v123, v20, v122
  v_cvt_pk_bf16_f32 v62, v100, v101
  v_cvt_pk_bf16_f32 v63, v102, v103
  ds_write_b128 v252, v[60:63]
  v_fmac_f32_dpp v115, v114, v24 quad_perm:[1,0,3,2] row_mask:0xf bank_mask:0xf
  v_fmac_f32_dpp v123, v122, v25 quad_perm:[1,0,3,2] row_mask:0xf bank_mask:0xf
  v_fmac_f32 v116, v19, v115
  v_fmac_f32 v124, v20, v123
  ds_read_b64_tr_b16 v[72:73], v253
  ds_read_b64_tr_b16 v[74:75], v253 offset:640
  v_cvt_pk_bf16_f32 v64, v104, v105
  v_fmac_f32_dpp v116, v115, v24 quad_perm:[1,0,3,2] row_mask:0xf bank_mask:0xf
  v_fmac_f32_dpp v124, v123, v25 quad_perm:[1,0,3,2] row_mask:0xf bank_mask:0xf
  v_fmac_f32 v117, v19, v116
  v_fmac_f32 v125, v20, v124
  v_cvt_pk_bf16_f32 v65, v106, v107
  v_cvt_pk_bf16_f32 v66, v108, v109
  v_fmac_f32_dpp v117, v116, v24 quad_perm:[1,0,3,2] row_mask:0xf bank_mask:0xf
  v_fmac_f32_dpp v125, v124, v25 quad_perm:[1,0,3,2] row_mask:0xf bank_mask:0xf
  v_fmac_f32 v118, v19, v117
  v_fmac_f32 v126, v20, v125
  v_cvt_pk_bf16_f32 v67, v110, v111
  ds_write_b128 v252, v[64:67]
  v_fmac_f32_dpp v118, v117, v24 quad_perm:[1,0,3,2] row_mask:0xf bank_mask:0xf
  v_fmac_f32_dpp v126, v125, v25 quad_perm:[1,0,3,2] row_mask:0xf bank_mask:0xf
  v_fmac_f32 v119, v19, v118
  v_fmac_f32 v127, v20, v126
  ds_read_b64_tr_b16 v[76:77], v253
  ds_read_b64_tr_b16 v[78:79], v253 offset:640
  v_fmac_f32_dpp v119, v118, v24 quad_perm:[1,0,3,2] row_mask:0xf bank_mask:0xf
  v_fmac_f32_dpp v127, v126, v25 quad_perm:[1,0,3,2] row_mask:0xf bank_mask:0xf
  s_cmp_eq_u32 s9, 0
  s_cbranch_scc1 slow_62
  s_add_u32 s13, s75, 10485760
  s_waitcnt lgkmcnt(6)
  buffer_store_dwordx4 v[68:71], v254, s[52:55], s13 offen
  s_add_u32 s13, s76, 10485760
  s_waitcnt lgkmcnt(3)
  buffer_store_dwordx4 v[72:75], v254, s[52:55], s13 offen
  s_add_u32 s13, s77, 10485760
  s_waitcnt lgkmcnt(0)
  buffer_store_dwordx4 v[76:79], v254, s[52:55], s13 offen
back_63:
  v_cvt_pk_bf16_f32 v56, v112, v113
  v_cvt_pk_bf16_f32 v57, v114, v115
  v_cvt_pk_bf16_f32 v58, v116, v117
  v_cvt_pk_bf16_f32 v59, v118, v119
  ds_write_b128 v252, v[56:59]
  ds_read_b64_tr_b16 v[80:81], v253
  ds_read_b64_tr_b16 v[82:83], v253 offset:640
  v_cvt_pk_bf16_f32 v60, v120, v121
  v_cvt_pk_bf16_f32 v61, v122, v123
  v_cvt_pk_bf16_f32 v62, v124, v125
  v_cvt_pk_bf16_f32 v63, v126, v127
  ds_write_b128 v252, v[60:63]
  ds_read_b64_tr_b16 v[84:85], v253
  ds_read_b64_tr_b16 v[86:87], v253 offset:640
  s_cmp_eq_u32 s9, 0
  s_cbranch_scc1 slow_64
  s_add_u32 s13, s78, 10485760
  s_waitcnt lgkmcnt(3)
  buffer_store_dwordx4 v[80:83], v254, s[52:55], s13 offen
  s_add_u32 s13, s79, 10485760
  s_waitcnt lgkmcnt(0)
  buffer_store_dwordx4 v[84:87], v254, s[52:55], s13 offen
back_65:
  s_add_u32 s12, s73, 16384
  s_waitcnt vmcnt(0)
  v_mov_b32 v15, s8
  s_mov_b64 exec, 1
  s_cmp_eq_u32 s9, 0
  s_cbranch_scc1 slow_66
  buffer_store_dword v15, off, s[52:55], s12
back_67:
  s_mov_b64 exec, -1
  v_accvgpr_read_b32 v108, a220
  v_accvgpr_read_b32 v109, a221
  v_accvgpr_read_b32 v110, a222
  v_accvgpr_read_b32 v111, a223
  v_accvgpr_read_b32 v112, a224
  v_accvgpr_read_b32 v113, a225
  v_accvgpr_read_b32 v114, a226
  v_accvgpr_read_b32 v115, a227
  v_accvgpr_read_b32 v116, a228
  v_accvgpr_read_b32 v117, a229
  v_accvgpr_read_b32 v118, a230
  v_accvgpr_read_b32 v119, a231
  v_accvgpr_read_b32 v120, a232
  v_accvgpr_read_b32 v121, a233
  v_accvgpr_read_b32 v122, a234
  v_accvgpr_read_b32 v123, a235
  v_accvgpr_read_b32 v124, a236
  v_accvgpr_read_b32 v125, a237
  v_accvgpr_read_b32 v126, a238
  v_accvgpr_read_b32 v127, a239
  v_accvgpr_read_b32 v160, a208
  v_accvgpr_read_b32 v161, a209
  v_accvgpr_read_b32 v162, a210
  v_accvgpr_read_b32 v163, a211
  v_accvgpr_read_b32 v164, a212
  v_accvgpr_read_b32 v165, a213
  v_accvgpr_read_b32 v166, a214
  v_accvgpr_read_b32 v167, a215
  v_accvgpr_read_b32 v168, a216
  v_accvgpr_read_b32 v169, a217
  v_lshlrev_b32 v88, 16, v160
  v_and_b32 v89, 0xffff0000, v160
  v_lshlrev_b32_e64 v90, 16, v161
  v_and_b32 v91, 0xffff0000, v161
  v_lshlrev_b32_e64 v92, 16, v162
  v_and_b32 v93, 0xffff0000, v162
  v_lshlrev_b32_e64 v94, 16, v163
  v_and_b32 v95, 0xffff0000, v163
  v_lshlrev_b32_e64 v96, 16, v164
  v_and_b32 v97, 0xffff0000, v164
  v_lshlrev_b32_e64 v98, 16, v165
  v_and_b32 v99, 0xffff0000, v165
  v_lshlrev_b32_e64 v100, 16, v166
  v_and_b32 v101, 0xffff0000, v166
  v_lshlrev_b32_e64 v102, 16, v167
  v_and_b32 v103, 0xffff0000, v167
  v_lshlrev_b32_e64 v104, 16, v168
  v_and_b32 v105, 0xffff0000, v168
  v_lshlrev_b32_e64 v106, 16, v169
  v_and_b32 v107, 0xffff0000, v169
  s_mul_i32 s13, s5, 163840
  s_mul_i32 s14, s7, 10240
  s_add_u32 s13, s13, s14
  s_add_u32 s13, s13, 10485760
  s_add_u32 s14, s7, 1
  s_and_b32 s14, s14, 3
  s_mul_i32 s15, s14, 40960
  s_add_u32 s36, s15, s13
  s_mul_i32 s15, s14, 15360
  s_add_u32 s15, s15, 102400
  v_add_u32 v44, s15, v2
  s_add_u32 s14, s7, 2
  s_and_b32 s14, s14, 3
  s_mul_i32 s15, s14, 40960
  s_add_u32 s37, s15, s13
  s_mul_i32 s15, s14, 15360
  s_add_u32 s15, s15, 107520
  v_add_u32 v45, s15, v2
  s_add_u32 s14, s7, 3
  s_and_b32 s14, s14, 3
  s_mul_i32 s15, s14, 40960
  s_add_u32 s38, s15, s13
  s_mul_i32 s15, s14, 15360
  s_add_u32 s15, s15, 112640
  v_add_u32 v46, s15, v2
  s_add_u32 s14, s7, 4
  s_and_b32 s14, s14, 3
  s_mul_i32 s15, s14, 40960
  s_add_u32 s39, s15, s13
  s_lshl_b32 s15, s3, 8
  s_lshl_b32 s13, s7, 6
  s_add_u32 s15, s15, s13
  s_and_b32 s13, s5, 1
  s_lshl_b32 s13, s13, 3
  s_add_u32 s15, s15, s13
  s_add_u32 s15, s15, 16384
  v_and_b32 v242, 3, v1
  v_lshlrev_b32 v242, 4, v242
  s_barrier
poll_68:
  buffer_load_dwordx2 v[42:43], v242, s[52:55], s15 offen sc1
  s_waitcnt vmcnt(0)
  v_xor_b32 v15, s8, v42
  v_xor_b32 v14, s8, v43
  v_or_b32 v15, v15, v14
  v_cmp_ne_u32 vcc, 0, v15
  s_cbranch_vccnz retry_69
giveup_70:
  buffer_load_dwordx4 v[128:131], v2, s[52:55], s36 offen offset:0 sc1
  buffer_load_dwordx4 v[132:135], v2, s[52:55], s36 offen offset:1024 sc1
  buffer_load_dwordx4 v[136:139], v2, s[52:55], s36 offen offset:2048 sc1
  buffer_load_dwordx4 v[140:143], v2, s[52:55], s36 offen offset:3072 sc1
  s_add_u32 s36, s36, 4096
  buffer_load_dwordx4 v[144:147], v2, s[52:55], s36 offen offset:0 sc1
  buffer_load_dwordx4 v[148:151], v2, s[52:55], s36 offen offset:1024 sc1
  buffer_load_dwordx4 v[152:155], v2, s[52:55], s36 offen offset:2048 sc1
  buffer_load_dwordx4 v[156:159], v2, s[52:55], s36 offen offset:3072 sc1
  s_waitcnt vmcnt(7)
  v_mfma_f32_16x16x32_bf16 v[48:51], a[0:3], v[128:131], 0
  s_add_u32 s36, s36, 4096
  buffer_load_dwordx4 v[160:163], v2, s[52:55], s36 offen offset:0 sc1
  v_mfma_f32_16x16x32_bf16 v[52:55], a[4:7], v[128:131], 0
  v_mfma_f32_16x16x32_bf16 v[56:59], a[8:11], v[128:131], 0
  v_mfma_f32_16x16x32_bf16 v[60:63], a[12:15], v[128:131], 0
  v_mfma_f32_16x16x32_bf16 v[64:67], a[16:19], v[128:131], 0
  s_waitcnt vmcnt(7)
  v_mfma_f32_16x16x32_bf16 v[48:51], a[20:23], v[132:135], v[48:51]
  buffer_load_dwordx4 v[164:167], v2, s[52:55], s36 offen offset:1024 sc1
  v_mfma_f32_16x16x32_bf16 v[52:55], a[24:27], v[132:135], v[52:55]
  v_mfma_f32_16x16x32_bf16 v[56:59], a[28:31], v[132:135], v[56:59]
  v_mfma_f32_16x16x32_bf16 v[60:63], a[32:35], v[132:135], v[60:63]
  v_mfma_f32_16x16x32_bf16 v[64:67], a[36:39], v[132:135], v[64:67]
  s_waitcnt vmcnt(7)
  v_mfma_f32_16x16x32_bf16 v[48:51], a[40:43], v[136:139], v[48:51]
  buffer_load_dwordx4 v[168:171], v2, s[52:55], s37 offen offset:0 sc1
  v_mfma_f32_16x16x32_bf16 v[52:55], a[44:47], v[136:139], v[52:55]
  v_mfma_f32_16x16x32_bf16 v[56:59], a[48:51], v[136:139], v[56:59]
  v_mfma_f32_16x16x32_bf16 v[60:63], a[52:55], v[136:139], v[60:63]
  v_mfma_f32_16x16x32_bf16 v[64:67], a[56:59], v[136:139], v[64:67]
  s_waitcnt vmcnt(7)
  v_mfma_f32_16x16x32_bf16 v[48:51], a[60:63], v[140:143], v[48:51]
  buffer_load_dwordx4 v[172:175], v2, s[52:55], s37 offen offset:1024 sc1
  v_mfma_f32_16x16x32_bf16 v[52:55], a[64:67], v[140:143], v[52:55]
  v_mfma_f32_16x16x32_bf16 v[56:59], a[68:71], v[140:143], v[56:59]
  v_mfma_f32_16x16x32_bf16 v[60:63], a[72:75], v[140:143], v[60:63]
  v_mfma_f32_16x16x32_bf16 v[64:67], a[76:79], v[140:143], v[64:67]
  s_waitcnt vmcnt(7)
  v_mfma_f32_16x16x32_bf16 v[48:51], a[80:83], v[144:147], v[48:51]
  buffer_load_dwordx4 v[176:179], v2, s[52:55], s37 offen offset:2048 sc1
  v_mfma_f32_16x16x32_bf16 v[52:55], a[84:87], v[144:147], v[52:55]
  v_mfma_f32_16x16x32_bf16 v[56:59], a[88:91], v[144:147], v[56:59]
  v_mfma_f32_16x16x32_bf16 v[60:63], a[92:95], v[144:147], v[60:63]
  v_mfma_f32_16x16x32_bf16 v[64:67], a[96:99], v[144:147], v[64:67]
  s_waitcnt vmcnt(7)
  v_mfma_f32_16x16x32_bf16 v[48:51], a[100:103], v[148:151], v[48:51]
  buffer_load_dwordx4 v[180:183], v2, s[52:55], s37 offen offset:3072 sc1
  v_mfma_f32_16x16x32_bf16 v[52:55], a[104:107], v[148:151], v[52:55]
  v_mfma_f32_16x16x32_bf16 v[56:59], a[108:111], v[148:151], v[56:59]
  v_mfma_f32_16x16x32_bf16 v[60:63], a[112:115], v[148:151], v[60:63]
  v_mfma_f32_16x16x32_bf16 v[64:67], a[116:119], v[148:151], v[64:67]
  s_waitcnt vmcnt(7)
  v_mfma_f32_16x16x32_bf16 v[48:51], a[120:123], v[152:155], v[48:51]
  s_add_u32 s37, s37, 4096
  buffer_load_dwordx4 v[184:187], v2, s[52:55], s37 offen offset:0 sc1
  v_mfma_f32_16x16x32_bf16 v[52:55], a[124:127], v[152:155], v[52:55]
  v_mfma_f32_16x16x32_bf16 v[56:59], a[128:131], v[152:155], v[56:59]
  v_mfma_f32_16x16x32_bf16 v[60:63], a[132:135], v[152:155], v[60:63]
  v_mfma_f32_16x16x32_bf16 v[64:67], a[136:139], v[152:155], v[64:67]
  s_waitcnt vmcnt(7)
  v_mfma_f32_16x16x32_bf16 v[48:51], a[140:143], v[156:159], v[48:51]
  buffer_load_dwordx4 v[188:191], v2, s[52:55], s37 offen offset:1024 sc1
  v_mfma_f32_16x16x32_bf16 v[52:55], a[144:147], v[156:159], v[52:55]
  v_mfma_f32_16x16x32_bf16 v[56:59], a[148:151], v[156:159], v[56:59]
  v_mfma_f32_16x16x32_bf16 v[60:63], a[152:155], v[156:159], v[60:63]
  v_mfma_f32_16x16x32_bf16 v[64:67], a[156:159], v[156:159], v[64:67]
  s_waitcnt vmcnt(7)
  v_mfma_f32_16x16x32_bf16 v[48:51], a[160:163], v[160:163], v[48:51]
  buffer_load_dwordx4 v[128:131], v2, s[52:55], s37 offen offset:2048 sc1
  v_mfma_f32_16x16x32_bf16 v[52:55], a[164:167], v[160:163], v[52:55]
  v_mfma_f32_16x16x32_bf16 v[56:59], a[168:171], v[160:163], v[56:59]
  v_mfma_f32_16x16x32_bf16 v[60:63], a[172:175], v[160:163], v[60:63]
  v_mfma_f32_16x16x32_bf16 v[64:67], a[176:179], v[160:163], v[64:67]
  s_waitcnt vmcnt(7)
  v_mfma_f32_16x16x32_bf16 v[48:51], a[180:183], v[164:167], v[48:51]
  buffer_load_dwordx4 v[132:135], v2, s[52:55], s37 offen offset:3072 sc1
  v_mfma_f32_16x16x32_bf16 v[52:55], a[184:187], v[164:167], v[52:55]
  v_mfma_f32_16x16x32_bf16 v[56:59], a[188:191], v[164:167], v[56:59]
  v_mfma_f32_16x16x32_bf16 v[60:63], a[192:195], v[164:167], v[60:63]
  v_mfma_f32_16x16x32_bf16 v[64:67], a[196:199], v[164:167], v[64:67]
  s_waitcnt vmcnt(7)
  v_mfma_f32_16x16x32_bf16 v[68:71], a[0:3], v[168:171], 0
  s_add_u32 s37, s37, 4096
  buffer_load_dwordx4 v[136:139], v2, s[52:55], s37 offen offset:0 sc1
  v_mfma_f32_16x16x32_bf16 v[72:75], a[4:7], v[168:171], 0
  v_mfma_f32_16x16x32_bf16 v[76:79], a[8:11], v[168:171], 0
  v_mfma_f32_16x16x32_bf16 v[80:83], a[12:15], v[168:171], 0
  v_mfma_f32_16x16x32_bf16 v[84:87], a[16:19], v[168:171], 0
  s_waitcnt vmcnt(7)
  v_mfma_f32_16x16x32_bf16 v[68:71], a[20:23], v[172:175], v[68:71]
  ds_write_b128 v44, v[48:51] offset:0
  buffer_load_dwordx4 v[140:143], v2, s[52:55], s37 offen offset:1024 sc1
  v_mfma_f32_16x16x32_bf16 v[72:75], a[24:27], v[172:175], v[72:75]
  ds_write_b128 v44, v[52:55] offset:1024
  v_mfma_f32_16x16x32_bf16 v[76:79], a[28:31], v[172:175], v[76:79]
  ds_write_b128 v44, v[56:59] offset:2048
  v_mfma_f32_16x16x32_bf16 v[80:83], a[32:35], v[172:175], v[80:83]
  ds_write_b128 v44, v[60:63] offset:3072
  v_mfma_f32_16x16x32_bf16 v[84:87], a[36:39], v[172:175], v[84:87]
  ds_write_b128 v44, v[64:67] offset:4096
  s_waitcnt vmcnt(7)
  v_mfma_f32_16x16x32_bf16 v[68:71], a[40:43], v[176:179], v[68:71]
  buffer_load_dwordx4 v[144:147], v2, s[52:55], s38 offen offset:0 sc1
  v_mfma_f32_16x16x32_bf16 v[72:75], a[44:47], v[176:179], v[72:75]
  v_mfma_f32_16x16x32_bf16 v[76:79], a[48:51], v[176:179], v[76:79]
  v_mfma_f32_16x16x32_bf16 v[80:83], a[52:55], v[176:179], v[80:83]
  v_mfma_f32_16x16x32_bf16 v[84:87], a[56:59], v[176:179], v[84:87]
  s_waitcnt vmcnt(7)
  v_mfma_f32_16x16x32_bf16 v[68:71], a[60:63], v[180:183], v[68:71]
  buffer_load_dwordx4 v[148:151], v2, s[52:55], s38 offen offset:1024 sc1
  v_mfma_f32_16x16x32_bf16 v[72:75], a[64:67], v[180:183], v[72:75]
  v_mfma_f32_16x16x32_bf16 v[76:79], a[68:71], v[180:183], v[76:79]
  v_mfma_f32_16x16x32_bf16 v[80:83], a[72:75], v[180:183], v[80:83]
  v_mfma_f32_16x16x32_bf16 v[84:87], a[76:79], v[180:183], v[84:87]
  s_waitcnt vmcnt(7)
  v_mfma_f32_16x16x32_bf16 v[68:71], a[80:83], v[184:187], v[68:71]
  buffer_load_dwordx4 v[152:155], v2, s[52:55], s38 offen offset:2048 sc1
  v_mfma_f32_16x16x32_bf16 v[72:75], a[84:87], v[184:187], v[72:75]
  v_mfma_f32_16x16x32_bf16 v[76:79], a[88:91], v[184:187], v[76:79]
  v_mfma_f32_16x16x32_bf16 v[80:83], a[92:95], v[184:187], v[80:83]
  v_mfma_f32_16x16x32_bf16 v[84:87], a[96:99], v[184:187], v[84:87]
  s_waitcnt vmcnt(7)
  v_mfma_f32_16x16x32_bf16 v[68:71], a[100:103], v[188:191], v[68:71]
  buffer_load_dwordx4 v[156:159], v2, s[52:55], s38 offen offset:3072 sc1
  v_mfma_f32_16x16x32_bf16 v[72:75], a[104:107], v[188:191], v[72:75]
  v_mfma_f32_16x16x32_bf16 v[76:79], a[108:111], v[188:191], v[76:79]
  v_mfma_f32_16x16x32_bf16 v[80:83], a[112:115], v[188:191], v[80:83]
  v_mfma_f32_16x16x32_bf16 v[84:87], a[116:119], v[188:191], v[84:87]
  s_waitcnt vmcnt(7)
  v_mfma_f32_16x16x32_bf16 v[68:71], a[120:123], v[128:131], v[68:71]
  s_add_u32 s38, s38, 4096
  buffer_load_dwordx4 v[160:163], v2, s[52:55], s38 offen offset:0 sc1
  v_mfma_f32_16x16x32_bf16 v[72:75], a[124:127], v[128:131], v[72:75]
  v_mfma_f32_16x16x32_bf16 v[76:79], a[128:131], v[128:131], v[76:79]
  v_mfma_f32_16x16x32_bf16 v[80:83], a[132:135], v[128:131], v[80:83]
  v_mfma_f32_16x16x32_bf16 v[84:87], a[136:139], v[128:131], v[84:87]
  s_waitcnt vmcnt(7)
  v_mfma_f32_16x16x32_bf16 v[68:71], a[140:143], v[132:135], v[68:71]
  buffer_load_dwordx4 v[164:167], v2, s[52:55], s38 offen offset:1024 sc1
  v_mfma_f32_16x16x32_bf16 v[72:75], a[144:147], v[132:135], v[72:75]
  v_mfma_f32_16x16x32_bf16 v[76:79], a[148:151], v[132:135], v[76:79]
  v_mfma_f32_16x16x32_bf16 v[80:83], a[152:155], v[132:135], v[80:83]
  v_mfma_f32_16x16x32_bf16 v[84:87], a[156:159], v[132:135], v[84:87]
  s_waitcnt vmcnt(7)
  v_mfma_f32_16x16x32_bf16 v[68:71], a[160:163], v[136:139], v[68:71]
  buffer_load_dwordx4 v[168:171], v2, s[52:55], s38 offen offset:2048 sc1
  v_mfma_f32_16x16x32_bf16 v[72:75], a[164:167], v[136:139], v[72:75]
  v_mfma_f32_16x16x32_bf16 v[76:79], a[168:171], v[136:139], v[76:79]
  v_mfma_f32_16x16x32_bf16 v[80:83], a[172:175], v[136:139], v[80:83]
  v_mfma_f32_16x16x32_bf16 v[84:87], a[176:179], v[136:139], v[84:87]
  s_waitcnt vmcnt(7)
  v_mfma_f32_16x16x32_bf16 v[68:71], a[180:183], v[140:143], v[68:71]
  buffer_load_dwordx4 v[172:175], v2, s[52:55], s38 offen offset:3072 sc1
  v_mfma_f32_16x16x32_bf16 v[72:75], a[184:187], v[140:143], v[72:75]
  v_mfma_f32_16x16x32_bf16 v[76:79], a[188:191], v[140:143], v[76:79]
  v_mfma_f32_16x16x32_bf16 v[80:83], a[192:195], v[140:143], v[80:83]
  v_mfma_f32_16x16x32_bf16 v[84:87], a[196:199], v[140:143], v[84:87]
  s_waitcnt vmcnt(7)
  v_mfma_f32_16x16x32_bf16 v[48:51], a[0:3], v[144:147], 0
  s_add_u32 s38, s38, 4096
  buffer_load_dwordx4 v[176:179], v2, s[52:55], s38 offen offset:0 sc1
  v_mfma_f32_16x16x32_bf16 v[52:55], a[4:7], v[144:147], 0
  v_mfma_f32_16x16x32_bf16 v[56:59], a[8:11], v[144:147], 0
  v_mfma_f32_16x16x32_bf16 v[60:63], a[12:15], v[144:147], 0
  v_mfma_f32_16x16x32_bf16 v[64:67], a[16:19], v[144:147], 0
  s_waitcnt vmcnt(7)
  v_mfma_f32_16x16x32_bf16 v[48:51], a[20:23], v[148:151], v[48:51]
  ds_write_b128 v45, v[68:71] offset:0
  buffer_load_dwordx4 v[180:183], v2, s[52:55], s38 offen offset:1024 sc1
  v_mfma_f32_16x16x32_bf16 v[52:55], a[24:27], v[148:151], v[52:55]
  ds_write_b128 v45, v[72:75] offset:1024
  v_mfma_f32_16x16x32_bf16 v[56:59], a[28:31], v[148:151], v[56:59]
  ds_write_b128 v45, v[76:79] offset:2048
  v_mfma_f32_16x16x32_bf16 v[60:63], a[32:35], v[148:151], v[60:63]
  ds_write_b128 v45, v[80:83] offset:3072
  v_mfma_f32_16x16x32_bf16 v[64:67], a[36:39], v[148:151], v[64:67]
  ds_write_b128 v45, v[84:87] offset:4096
  s_waitcnt vmcnt(7)
  v_mfma_f32_16x16x32_bf16 v[48:51], a[40:43], v[152:155], v[48:51]
  buffer_load_dwordx4 v[184:187], v2, s[52:55], s39 offen offset:0 sc1
  v_mfma_f32_16x16x32_bf16 v[52:55], a[44:47], v[152:155], v[52:55]
  v_mfma_f32_16x16x32_bf16 v[56:59], a[48:51], v[152:155], v[56:59]
  v_mfma_f32_16x16x32_bf16 v[60:63], a[52:55], v[152:155], v[60:63]
  v_mfma_f32_16x16x32_bf16 v[64:67], a[56:59], v[152:155], v[64:67]
  s_waitcnt vmcnt(7)
  v_mfma_f32_16x16x32_bf16 v[48:51], a[60:63], v[156:159], v[48:51]
  buffer_load_dwordx4 v[188:191], v2, s[52:55], s39 offen offset:1024 sc1
  v_mfma_f32_16x16x32_bf16 v[52:55], a[64:67], v[156:159], v[52:55]
  v_mfma_f32_16x16x32_bf16 v[56:59], a[68:71], v[156:159], v[56:59]
  v_mfma_f32_16x16x32_bf16 v[60:63], a[72:75], v[156:159], v[60:63]
  v_mfma_f32_16x16x32_bf16 v[64:67], a[76:79], v[156:159], v[64:67]
  s_waitcnt vmcnt(7)
  v_mfma_f32_16x16x32_bf16 v[48:51], a[80:83], v[160:163], v[48:51]
  buffer_load_dwordx4 v[128:131], v2, s[52:55], s39 offen offset:2048 sc1
  v_mfma_f32_16x16x32_bf16 v[52:55], a[84:87], v[160:163], v[52:55]
  v_mfma_f32_16x16x32_bf16 v[56:59], a[88:91], v[160:163], v[56:59]
  v_mfma_f32_16x16x32_bf16 v[60:63], a[92:95], v[160:163], v[60:63]
  v_mfma_f32_16x16x32_bf16 v[64:67], a[96:99], v[160:163], v[64:67]
  s_waitcnt vmcnt(7)
  v_mfma_f32_16x16x32_bf16 v[48:51], a[100:103], v[164:167], v[48:51]
  buffer_load_dwordx4 v[132:135], v2, s[52:55], s39 offen offset:3072 sc1
  v_mfma_f32_16x16x32_bf16 v[52:55], a[104:107], v[164:167], v[52:55]
  v_mfma_f32_16x16x32_bf16 v[56:59], a[108:111], v[164:167], v[56:59]
  v_mfma_f32_16x16x32_bf16 v[60:63], a[112:115], v[164:167], v[60:63]
  v_mfma_f32_16x16x32_bf16 v[64:67], a[116:119], v[164:167], v[64:67]
  s_waitcnt vmcnt(7)
  v_mfma_f32_16x16x32_bf16 v[48:51], a[120:123], v[168:171], v[48:51]
  s_add_u32 s39, s39, 4096
  buffer_load_dwordx4 v[136:139], v2, s[52:55], s39 offen offset:0 sc1
  v_mfma_f32_16x16x32_bf16 v[52:55], a[124:127], v[168:171], v[52:55]
  v_mfma_f32_16x16x32_bf16 v[56:59], a[128:131], v[168:171], v[56:59]
  v_mfma_f32_16x16x32_bf16 v[60:63], a[132:135], v[168:171], v[60:63]
  v_mfma_f32_16x16x32_bf16 v[64:67], a[136:139], v[168:171], v[64:67]
  s_waitcnt vmcnt(7)
  v_mfma_f32_16x16x32_bf16 v[48:51], a[140:143], v[172:175], v[48:51]
  buffer_load_dwordx4 v[140:143], v2, s[52:55], s39 offen offset:1024 sc1
  v_mfma_f32_16x16x32_bf16 v[52:55], a[144:147], v[172:175], v[52:55]
  v_mfma_f32_16x16x32_bf16 v[56:59], a[148:151], v[172:175], v[56:59]
  v_mfma_f32_16x16x32_bf16 v[60:63], a[152:155], v[172:175], v[60:63]
  v_mfma_f32_16x16x32_bf16 v[64:67], a[156:159], v[172:175], v[64:67]
  s_waitcnt vmcnt(7)
  v_mfma_f32_16x16x32_bf16 v[48:51], a[160:163], v[176:179], v[48:51]
  buffer_load_dwordx4 v[144:147], v2, s[52:55], s39 offen offset:2048 sc1
  v_mfma_f32_16x16x32_bf16 v[52:55], a[164:167], v[176:179], v[52:55]
  v_mfma_f32_16x16x32_bf16 v[56:59], a[168:171], v[176:179], v[56:59]
  v_mfma_f32_16x16x32_bf16 v[60:63], a[172:175], v[176:179], v[60:63]
  v_mfma_f32_16x16x32_bf16 v[64:67], a[176:179], v[176:179], v[64:67]
  s_waitcnt vmcnt(7)
  v_mfma_f32_16x16x32_bf16 v[48:51], a[180:183], v[180:183], v[48:51]
  buffer_load_dwordx4 v[148:151], v2, s[52:55], s39 offen offset:3072 sc1
  v_mfma_f32_16x16x32_bf16 v[52:55], a[184:187], v[180:183], v[52:55]
  v_mfma_f32_16x16x32_bf16 v[56:59], a[188:191], v[180:183], v[56:59]
  v_mfma_f32_16x16x32_bf16 v[60:63], a[192:195], v[180:183], v[60:63]
  v_mfma_f32_16x16x32_bf16 v[64:67], a[196:199], v[180:183], v[64:67]
  s_waitcnt vmcnt(7)
  v_mfma_f32_16x16x32_bf16 v[68:71], a[0:3], v[184:187], v[108:111]
  s_add_u32 s39, s39, 4096
  buffer_load_dwordx4 v[152:155], v2, s[52:55], s39 offen offset:0 sc1
  v_mfma_f32_16x16x32_bf16 v[72:75], a[4:7], v[184:187], v[112:115]
  s_mul_i32 s15, s7, 15360
  v_mfma_f32_16x16x32_bf16 v[76:79], a[8:11], v[184:187], v[116:119]
  s_add_u32 s15, s15, 102400
  v_mfma_f32_16x16x32_bf16 v[80:83], a[12:15], v[184:187], v[120:123]
  v_add_u32_e64 v47, s15, v2
  v_mfma_f32_16x16x32_bf16 v[84:87], a[16:19], v[184:187], v[124:127]
  s_waitcnt vmcnt(7)
  v_mfma_f32_16x16x32_bf16 v[68:71], a[20:23], v[188:191], v[68:71]
  ds_write_b128 v46, v[48:51] offset:0
  buffer_load_dwordx4 v[156:159], v2, s[52:55], s39 offen offset:1024 sc1
  v_mfma_f32_16x16x32_bf16 v[72:75], a[24:27], v[188:191], v[72:75]
  ds_write_b128 v46, v[52:55] offset:1024
  v_mfma_f32_16x16x32_bf16 v[76:79], a[28:31], v[188:191], v[76:79]
  ds_write_b128 v46, v[56:59] offset:2048
  v_mfma_f32_16x16x32_bf16 v[80:83], a[32:35], v[188:191], v[80:83]
  ds_write_b128 v46, v[60:63] offset:3072
  v_mfma_f32_16x16x32_bf16 v[84:87], a[36:39], v[188:191], v[84:87]
  ds_write_b128 v46, v[64:67] offset:4096
  s_waitcnt vmcnt(7)
  v_mfma_f32_16x16x32_bf16 v[68:71], a[40:43], v[128:131], v[68:71]
  s_lshl_b32 vcc_lo, s1, 2
  s_add_u32 vcc_lo, vcc_lo, s7
  s_cmp_lg_u32 vcc_lo, 3
  s_cbranch_scc1 skip_71
  buffer_wbl2 sc1
skip_71:
  v_mfma_f32_16x16x32_bf16 v[72:75], a[44:47], v[128:131], v[72:75]
  v_mfma_f32_16x16x32_bf16 v[76:79], a[48:51], v[128:131], v[76:79]
  v_mfma_f32_16x16x32_bf16 v[80:83], a[52:55], v[128:131], v[80:83]
  v_mfma_f32_16x16x32_bf16 v[84:87], a[56:59], v[128:131], v[84:87]
  s_waitcnt vmcnt(6)
  v_mfma_f32_16x16x32_bf16 v[68:71], a[60:63], v[132:135], v[68:71]
  v_mfma_f32_16x16x32_bf16 v[72:75], a[64:67], v[132:135], v[72:75]
  v_mfma_f32_16x16x32_bf16 v[76:79], a[68:71], v[132:135], v[76:79]
  v_mfma_f32_16x16x32_bf16 v[80:83], a[72:75], v[132:135], v[80:83]
  v_mfma_f32_16x16x32_bf16 v[84:87], a[76:79], v[132:135], v[84:87]
  s_waitcnt vmcnt(5)
  v_mfma_f32_16x16x32_bf16 v[68:71], a[80:83], v[136:139], v[68:71]
  s_waitcnt lgkmcnt(0)
  s_barrier
  v_mfma_f32_16x16x32_bf16 v[72:75], a[84:87], v[136:139], v[72:75]
  ds_read_b128 v[206:209], v47 offset:0
  ds_read_b128 v[210:213], v47 offset:1024
  v_mfma_f32_16x16x32_bf16 v[76:79], a[88:91], v[136:139], v[76:79]
  ds_read_b128 v[214:217], v47 offset:2048
  v_mfma_f32_16x16x32_bf16 v[80:83], a[92:95], v[136:139], v[80:83]
  ds_read_b128 v[218:221], v47 offset:3072
  v_mfma_f32_16x16x32_bf16 v[84:87], a[96:99], v[136:139], v[84:87]
  ds_read_b128 v[222:225], v47 offset:4096
  s_waitcnt vmcnt(4)
  v_mfma_f32_16x16x32_bf16 v[68:71], a[100:103], v[140:143], v[68:71]
  ds_read_b128 v[160:163], v47 offset:5120
  ds_read_b128 v[164:167], v47 offset:6144
  v_mfma_f32_16x16x32_bf16 v[72:75], a[104:107], v[140:143], v[72:75]
  ds_read_b128 v[168:171], v47 offset:7168
  ds_read_b128 v[172:175], v47 offset:8192
  v_mfma_f32_16x16x32_bf16 v[76:79], a[108:111], v[140:143], v[76:79]
  ds_read_b128 v[176:179], v47 offset:9216
  v_mfma_f32_16x16x32_bf16 v[80:83], a[112:115], v[140:143], v[80:83]
  s_waitcnt lgkmcnt(0)
  v_mfma_f32_16x16x32_bf16 v[84:87], a[116:119], v[140:143], v[84:87]
  v_pk_add_f32 v[206:207], v[206:207], v[160:161]
  s_waitcnt vmcnt(3)
  v_mfma_f32_16x16x32_bf16 v[68:71], a[120:123], v[144:147], v[68:71]
  v_pk_add_f32 v[208:209], v[208:209], v[162:163]
  v_pk_add_f32 v[210:211], v[210:211], v[164:165]
  v_mfma_f32_16x16x32_bf16 v[72:75], a[124:127], v[144:147], v[72:75]
  v_pk_add_f32 v[212:213], v[212:213], v[166:167]
  v_pk_add_f32 v[214:215], v[214:215], v[168:169]
  v_mfma_f32_16x16x32_bf16 v[76:79], a[128:131], v[144:147], v[76:79]
  v_pk_add_f32 v[216:217], v[216:217], v[170:171]
  v_mfma_f32_16x16x32_bf16 v[80:83], a[132:135], v[144:147], v[80:83]
  v_pk_add_f32 v[218:219], v[218:219], v[172:173]
  v_mfma_f32_16x16x32_bf16 v[84:87], a[136:139], v[144:147], v[84:87]
  v_pk_add_f32 v[220:221], v[220:221], v[174:175]
  s_waitcnt vmcnt(2)
  v_mfma_f32_16x16x32_bf16 v[68:71], a[140:143], v[148:151], v[68:71]
  v_pk_add_f32 v[222:223], v[222:223], v[176:177]
  v_pk_add_f32 v[224:225], v[224:225], v[178:179]
  v_mfma_f32_16x16x32_bf16 v[72:75], a[144:147], v[148:151], v[72:75]
  ds_read_b128 v[160:163], v47 offset:10240
  ds_read_b128 v[164:167], v47 offset:11264
  v_mfma_f32_16x16x32_bf16 v[76:79], a[148:151], v[148:151], v[76:79]
  ds_read_b128 v[168:171], v47 offset:12288
  v_mfma_f32_16x16x32_bf16 v[80:83], a[152:155], v[148:151], v[80:83]
  ds_read_b128 v[172:175], v47 offset:13312
  v_mfma_f32_16x16x32_bf16 v[84:87], a[156:159], v[148:151], v[84:87]
  ds_read_b128 v[176:179], v47 offset:14336
  s_waitcnt vmcnt(1)
  v_mfma_f32_16x16x32_bf16 v[68:71], a[160:163], v[152:155], v[68:71]
  s_waitcnt lgkmcnt(0)
  v_pk_add_f32 v[206:207], v[206:207], v[160:161]
  v_mfma_f32_16x16x32_bf16 v[72:75], a[164:167], v[152:155], v[72:75]
  v_pk_add_f32 v[208:209], v[208:209], v[162:163]
  v_pk_add_f32 v[210:211], v[210:211], v[164:165]
  v_mfma_f32_16x16x32_bf16 v[76:79], a[168:171], v[152:155], v[76:79]
  v_pk_add_f32 v[212:213], v[212:213], v[166:167]
  v_mfma_f32_16x16x32_bf16 v[80:83], a[172:175], v[152:155], v[80:83]
  v_pk_add_f32 v[214:215], v[214:215], v[168:169]
  v_mfma_f32_16x16x32_bf16 v[84:87], a[176:179], v[152:155], v[84:87]
  v_pk_add_f32 v[216:217], v[216:217], v[170:171]
  s_waitcnt vmcnt(0)
  v_mfma_f32_16x16x32_bf16 v[68:71], a[180:183], v[156:159], v[68:71]
  v_pk_add_f32 v[218:219], v[218:219], v[172:173]
  v_mfma_f32_16x16x32_bf16 v[72:75], a[184:187], v[156:159], v[72:75]
  v_pk_add_f32 v[220:221], v[220:221], v[174:175]
  v_mfma_f32_16x16x32_bf16 v[76:79], a[188:191], v[156:159], v[76:79]
  v_pk_add_f32 v[222:223], v[222:223], v[176:177]
  v_mfma_f32_16x16x32_bf16 v[80:83], a[192:195], v[156:159], v[80:83]
  v_pk_add_f32 v[224:225], v[224:225], v[178:179]
  v_mfma_f32_16x16x32_bf16 v[84:87], a[196:199], v[156:159], v[84:87]
  v_pk_add_f32 v[68:69], v[68:69], v[206:207]
  v_pk_add_f32 v[70:71], v[70:71], v[208:209]
  v_pk_add_f32 v[72:73], v[72:73], v[210:211]
  v_pk_add_f32 v[74:75], v[74:75], v[212:213]
  v_pk_add_f32 v[76:77], v[76:77], v[214:215]
  v_pk_add_f32 v[78:79], v[78:79], v[216:217]
  v_pk_add_f32 v[80:81], v[80:81], v[218:219]
  v_pk_add_f32 v[82:83], v[82:83], v[220:221]
  v_pk_add_f32 v[84:85], v[84:85], v[222:223]
  v_pk_add_f32 v[86:87], v[86:87], v[224:225]
  s_lshl_b32 s12, s5, 15
  s_lshl_b32 s13, s7, 10
  s_add_u32 s12, s12, s13
  s_add_u32 s12, s12, 2359296
  s_lshl_b32 s13, s6, 12
  s_add_u32 s13, s13, s12
  v_pk_add_f32 v[228:229], v[68:69], v[70:71]
  v_pk_mul_f32 v[230:231], v[68:69], v[68:69]
  v_pk_fma_f32 v[230:231], v[70:71], v[70:71], v[230:231]
  v_pk_add_f32 v[228:229], v[228:229], v[72:73]
  v_pk_fma_f32 v[230:231], v[72:73], v[72:73], v[230:231]
  v_pk_add_f32 v[228:229], v[228:229], v[74:75]
  v_pk_fma_f32 v[230:231], v[74:75], v[74:75], v[230:231]
  v_pk_add_f32 v[228:229], v[228:229], v[76:77]
  v_pk_fma_f32 v[230:231], v[76:77], v[76:77], v[230:231]
  v_pk_add_f32 v[228:229], v[228:229], v[78:79]
  v_pk_fma_f32 v[230:231], v[78:79], v[78:79], v[230:231]
  v_pk_add_f32 v[228:229], v[228:229], v[80:81]
  v_pk_fma_f32 v[230:231], v[80:81], v[80:81], v[230:231]
  v_pk_add_f32 v[228:229], v[228:229], v[82:83]
  v_pk_fma_f32 v[230:231], v[82:83], v[82:83], v[230:231]
  v_pk_add_f32 v[228:229], v[228:229], v[84:85]
  v_pk_fma_f32 v[230:231], v[84:85], v[84:85], v[230:231]
  v_pk_add_f32 v[228:229], v[228:229], v[86:87]
  v_pk_fma_f32 v[230:231], v[86:87], v[86:87], v[230:231]
  v_add_f32 v216, v228, v229
  v_add_f32 v217, v230, v231
  v_mov_b32 v218, s8
  v_mov_b32 v219, s8
  v_mov_b32 v228, v216
  v_mov_b32 v229, v217
  s_nop 0
  v_permlane32_swap_b32 v216, v228
  v_permlane32_swap_b32 v217, v229
  v_add_f32 v216, v216, v228
  v_add_f32 v217, v217, v229
  v_mov_b32 v228, v216
  v_mov_b32 v229, v217
  s_nop 0
  v_permlane16_swap_b32 v216, v228
  v_permlane16_swap_b32 v217, v229
  v_add_f32 v216, v216, v228
  v_add_f32 v217, v217, v229
  s_mov_b64 exec, 0xffff
  s_cmp_eq_u32 s9, 0
  s_cbranch_scc1 slow_72
  buffer_store_dwordx4 v[216:219], v2, s[52:55], s13 offen
back_73:
  s_mov_b64 exec, -1
  v_lshlrev_b32 v11, 13, v4
  v_lshl_add_u32 v11, v3, 4, v11
  s_add_u32 s13, s12, 4096
  s_mul_i32 s14, s7, 15360
  s_add_u32 s14, s14, 102400
  v_mul_u32_u24 v44, 336, v3
  v_lshl_add_u32 v44, v4, 4, v44
  v_add_u32 v44, s14, v44
  s_lshl_b32 s15, s5, 6
  s_lshr_b32 s96, s7, 1
  s_lshl_b32 s96, s96, 5
  s_add_u32 s15, s15, s96
  s_and_b32 s96, s7, 1
  s_lshl_b32 s96, s96, 2
  s_add_u32 s15, s15, s96
  s_mul_i32 s15, s15, 2560
  s_mul_i32 s96, s6, 320
  s_add_u32 s15, s15, s96
  s_mov_b32 s64, s46
  s_and_b32 s65, s47, 0xffff
  s_mov_b32 s66, 5242880
  s_mov_b32 s67, 0x20000
  v_add_u32_e64 v12, 0, v1
  v_mul_u32_u24 v13, 205, v12
  v_lshrrev_b32 v13, 12, v13
  v_mul_u32_u24 v14, 20, v13
  v_sub_u32 v12, v12, v14
  v_lshlrev_b32 v12, 4, v12
  v_mul_u32_u24 v14, 336, v13
  v_add3_u32 v198, v14, v12, s14
  v_lshrrev_b32_e64 v14, 2, v13
  v_lshl_add_u32 v13, v14, 2, v13
  v_mul_u32_u24 v13, 2560, v13
  v_add_u32 v192, v13, v12
  v_add_u32 v12, 64, v1
  v_mul_u32_u24 v13, 205, v12
  v_lshrrev_b32 v13, 12, v13
  v_mul_u32_u24 v14, 20, v13
  v_sub_u32 v12, v12, v14
  v_lshlrev_b32 v12, 4, v12
  v_mul_u32_u24 v14, 336, v13
  v_add3_u32 v199, v14, v12, s14
  v_lshrrev_b32_e64 v14, 2, v13
  v_lshl_add_u32 v13, v14, 2, v13
  v_mul_u32_u24 v13, 2560, v13
  v_add_u32_e64 v193, v13, v12
  v_add_u32 v12, 128, v1
  v_mul_u32_u24 v13, 205, v12
  v_lshrrev_b32 v13, 12, v13
  v_mul_u32_u24 v14, 20, v13
  v_sub_u32 v12, v12, v14
  v_lshlrev_b32 v12, 4, v12
  v_mul_u32_u24 v14, 336, v13
  v_add3_u32 v200, v14, v12, s14
  v_lshrrev_b32_e64 v14, 2, v13
  v_lshl_add_u32 v13, v14, 2, v13
  v_mul_u32_u24 v13, 2560, v13
  v_add_u32_e64 v194, v13, v12
  v_add_u32 v12, 192, v1
  v_mul_u32_u24 v13, 205, v12
  v_lshrrev_b32 v13, 12, v13
  v_mul_u32_u24 v14, 20, v13
  v_sub_u32 v12, v12, v14
  v_lshlrev_b32 v12, 4, v12
  v_mul_u32_u24 v14, 336, v13
  v_add3_u32 v201, v14, v12, s14
  v_lshrrev_b32_e64 v14, 2, v13
  v_lshl_add_u32 v13, v14, 2, v13
  v_mul_u32_u24 v13, 2560, v13
  v_add_u32_e64 v195, v13, v12
  v_add_u32 v12, 256, v1
  v_mul_u32_u24 v13, 205, v12
  v_lshrrev_b32 v13, 12, v13
  v_mul_u32_u24 v14, 20, v13
  v_sub_u32 v12, v12, v14
  v_lshlrev_b32 v12, 4, v12
  v_mul_u32_u24 v14, 336, v13
  v_add3_u32 v202, v14, v12, s14
  v_lshrrev_b32_e64 v14, 2, v13
  v_lshl_add_u32 v13, v14, 2, v13
  v_mul_u32_u24 v13, 2560, v13
  v_add_u32_e64 v196, v13, v12
stpoll_74:
  buffer_load_dwordx3 v[128:130], v11, s[52:55], s12 offen sc1
  buffer_load_dwordx3 v[132:134], v11, s[52:55], s13 offen sc1
  s_waitcnt vmcnt(0)
  v_min3_u32 v13, v130, v134, s8
  v_max3_u32 v14, v130, v134, s8
  v_cmp_ne_u32 vcc, v13, v14
  s_cbranch_vccnz retry_75
giveup_76:
  v_pk_add_f32 v[128:129], v[128:129], v[132:133]
  v_mov_b32 v228, v128
  v_mov_b32 v229, v129
  s_nop 0
  v_permlane32_swap_b32 v128, v228
  v_permlane32_swap_b32 v129, v229
  v_add_f32 v128, v128, v228
  v_add_f32 v129, v129, v229
  v_mov_b32 v228, v128
  v_mov_b32 v229, v129
  s_nop 0
  v_permlane16_swap_b32 v128, v228
  v_permlane16_swap_b32 v129, v229
  v_add_f32 v128, v128, v228
  v_add_f32_e64 v129, v129, v229
  v_mul_f32 v128, 0x3acccccd, v128
  v_mul_f32 v212, 0x3acccccd, v129
  v_fma_f32 v212, -v128, v128, v212
  v_max_f32_e64 v212, 0, v212
  v_add_f32 v212, 0x3727c5ac, v212
  v_rsq_f32 v210, v212
  s_nop 0
  v_mul_f32_e64 v211, v128, v210
  v_pk_fma_f32 v[160:161], v[68:69], v[210:211], v[210:211] op_sel:[0,0,1] op_sel_hi:[1,0,1] neg_lo:[0,0,1] neg_hi:[0,0,1]
  v_pk_fma_f32 v[162:163], v[70:71], v[210:211], v[210:211] op_sel:[0,0,1] op_sel_hi:[1,0,1] neg_lo:[0,0,1] neg_hi:[0,0,1]
  v_pk_fma_f32 v[164:165], v[72:73], v[210:211], v[210:211] op_sel:[0,0,1] op_sel_hi:[1,0,1] neg_lo:[0,0,1] neg_hi:[0,0,1]
  v_pk_fma_f32 v[166:167], v[74:75], v[210:211], v[210:211] op_sel:[0,0,1] op_sel_hi:[1,0,1] neg_lo:[0,0,1] neg_hi:[0,0,1]
  v_pk_fma_f32 v[168:169], v[76:77], v[210:211], v[210:211] op_sel:[0,0,1] op_sel_hi:[1,0,1] neg_lo:[0,0,1] neg_hi:[0,0,1]
  v_pk_fma_f32 v[170:171], v[78:79], v[210:211], v[210:211] op_sel:[0,0,1] op_sel_hi:[1,0,1] neg_lo:[0,0,1] neg_hi:[0,0,1]
  v_pk_fma_f32 v[172:173], v[80:81], v[210:211], v[210:211] op_sel:[0,0,1] op_sel_hi:[1,0,1] neg_lo:[0,0,1] neg_hi:[0,0,1]
  v_pk_fma_f32 v[174:175], v[82:83], v[210:211], v[210:211] op_sel:[0,0,1] op_sel_hi:[1,0,1] neg_lo:[0,0,1] neg_hi:[0,0,1]
  v_pk_fma_f32 v[176:177], v[84:85], v[210:211], v[210:211] op_sel:[0,0,1] op_sel_hi:[1,0,1] neg_lo:[0,0,1] neg_hi:[0,0,1]
  v_pk_fma_f32 v[178:179], v[86:87], v[210:211], v[210:211] op_sel:[0,0,1] op_sel_hi:[1,0,1] neg_lo:[0,0,1] neg_hi:[0,0,1]
  v_pk_fma_f32 v[68:69], v[160:161], v[88:89], v[68:69]
  v_pk_fma_f32 v[70:71], v[162:163], v[90:91], v[70:71]
  ds_write_b128 v44, v[68:71] offset:0
  v_pk_fma_f32 v[72:73], v[164:165], v[92:93], v[72:73]
  v_pk_fma_f32 v[74:75], v[166:167], v[94:95], v[74:75]
  ds_write_b128 v44, v[72:75] offset:64
  v_pk_fma_f32 v[76:77], v[168:169], v[96:97], v[76:77]
  v_pk_fma_f32 v[78:79], v[170:171], v[98:99], v[78:79]
  ds_write_b128 v44, v[76:79] offset:128
  v_pk_fma_f32 v[80:81], v[172:173], v[100:101], v[80:81]
  v_pk_fma_f32 v[82:83], v[174:175], v[102:103], v[82:83]
  ds_write_b128 v44, v[80:83] offset:192
  v_pk_fma_f32 v[84:85], v[176:177], v[104:105], v[84:85]
  v_pk_fma_f32 v[86:87], v[178:179], v[106:107], v[86:87]
  ds_write_b128 v44, v[84:87] offset:256
  ds_read_b128 v[128:131], v198
  ds_read_b128 v[132:135], v199
  ds_read_b128 v[136:139], v200
  ds_read_b128 v[140:143], v201
  ds_read_b128 v[144:147], v202
  s_waitcnt lgkmcnt(4)
  buffer_store_dwordx4 v[128:131], v192, s[64:67], s15 offen sc1
  s_waitcnt lgkmcnt(3)
  buffer_store_dwordx4 v[132:135], v193, s[64:67], s15 offen sc1
  s_waitcnt lgkmcnt(2)
  buffer_store_dwordx4 v[136:139], v194, s[64:67], s15 offen sc1
  s_waitcnt lgkmcnt(1)
  buffer_store_dwordx4 v[140:143], v195, s[64:67], s15 offen sc1
  s_waitcnt lgkmcnt(0)
  buffer_store_dwordx4 v[144:147], v196, s[64:67], s15 offen sc1
L_end:
  s_endpgm
again_12:
  s_sub_u32 s10, s10, 1
  s_cmp_gt_i32 s10, 0
  s_cbranch_scc0 ok_13
  buffer_load_dword v81, v80, s[52:55], s96 offen sc1
  s_waitcnt vmcnt(0)
  v_xor_b32 v15, s8, v81
  v_cmp_lt_u32 vcc, 15, v15
  s_cbranch_vccz ok_13
  s_and_b32 s13, s10, 3
  s_cbranch_scc1 again_12
  buffer_load_dword v81, v80, s[52:55], s96 offen offset:128 sc1
  s_waitcnt vmcnt(0)
  v_xor_b32 v15, s8, v81
  v_cmp_lt_u32 vcc, 15, v15
  s_cbranch_vccnz again_12
  s_branch ok_13
slow_14:
  buffer_store_dwordx4 v[192:195], v211, s[52:55], s36 offen sc1
  s_add_u32 s36, s36, 4096
  buffer_store_dwordx4 v[196:199], v211, s[52:55], s36 offen sc1
  s_add_u32 s36, s36, 4096
  buffer_store_dwordx4 v[200:203], v211, s[52:55], s36 offen sc1
  s_add_u32 s36, s36, 4096
  buffer_store_dwordx4 v[204:207], v211, s[52:55], s36 offen sc1
  s_nop 1
  s_branch back_15
slow_16:
  buffer_store_dword v15, off, s[52:55], s12 sc1
  s_nop 1
  s_branch back_17
again_18:
  s_sub_u32 s10, s10, 1
  s_cmp_gt_i32 s10, 0
  s_cbranch_scc0 ok_19
  buffer_load_dwordx4 v[212:215], v223, s[52:55], s13 offen sc1
  s_waitcnt vmcnt(0)
  v_xor_b32 v15, s8, v212
  v_xor_b32 v14, s8, v213
  v_or_b32 v15, v15, v14
  v_xor_b32 v14, s8, v214
  v_or_b32 v15, v15, v14
  v_xor_b32 v14, s8, v215
  v_or_b32 v15, v15, v14
  v_cmp_ne_u32 vcc, 0, v15
  s_cbranch_vccnz again_18
  s_branch ok_19
again_20:
  s_sub_u32 s10, s10, 1
  s_cmp_gt_i32 s10, 0
  s_cbranch_scc0 ok_21
  buffer_load_dwordx3 v[224:226], v187, s[52:55], s96 offen sc1
  buffer_load_dwordx2 v[228:229], v185, s[52:55], s44 offen sc1
  buffer_load_dwordx2 v[230:231], v188, s[52:55], s44 offen offset:512 sc1
  s_waitcnt vmcnt(0)
  v_min3_u32 v13, v226, v229, v231
  v_max3_u32 v14, v226, v229, v231
  v_xor_b32 v13, s8, v13
  v_xor_b32 v14, s8, v14
  v_or_b32 v13, v13, v14
  v_cmp_ne_u32 vcc, 0, v13
  s_cbranch_vccnz again_20
  s_branch ok_21
again_23:
  s_sub_u32 s10, s10, 1
  s_cmp_gt_i32 s10, 0
  s_cbranch_scc0 ok_24
  buffer_load_dwordx4 v[204:207], v246, s[52:55], s96 offen sc1
  s_waitcnt vmcnt(0)
  v_xor_b32 v15, s8, v204
  v_xor_b32 v14, s8, v205
  v_or_b32 v15, v15, v14
  v_xor_b32 v14, s8, v206
  v_or_b32 v15, v15, v14
  v_xor_b32 v14, s8, v207
  v_or_b32 v15, v15, v14
  v_cmp_ne_u32 vcc, 0, v15
  s_cbranch_vccnz again_23
  s_branch ok_24
aggagain_29:
  buffer_load_dwordx3 v[128:130], v251, s[52:55], s80 offen offset:0 sc1
  buffer_load_dwordx3 v[132:134], v251, s[52:55], s80 offen offset:768 sc1
  buffer_load_dwordx3 v[136:138], v251, s[52:55], s80 offen offset:1536 sc1
  buffer_load_dwordx3 v[140:142], v251, s[52:55], s80 offen offset:2304 sc1
  buffer_load_dwordx3 v[144:146], v251, s[52:55], s80 offen offset:3072 sc1
  buffer_load_dwordx3 v[148:150], v251, s[52:55], s81 offen offset:0 sc1
  buffer_load_dwordx3 v[152:154], v251, s[52:55], s81 offen offset:768 sc1
  buffer_load_dwordx3 v[156:158], v251, s[52:55], s81 offen offset:1536 sc1
  buffer_load_dwordx3 v[160:162], v251, s[52:55], s81 offen offset:2304 sc1
  buffer_load_dwordx3 v[164:166], v251, s[52:55], s81 offen offset:3072 sc1
  buffer_load_dwordx3 v[168:170], v251, s[52:55], s82 offen offset:0 sc1
  buffer_load_dwordx3 v[172:174], v251, s[52:55], s82 offen offset:768 sc1
  buffer_load_dwordx3 v[240:242], v251, s[52:55], s82 offen offset:1536 sc1
  buffer_load_dwordx3 v[244:246], v251, s[52:55], s82 offen offset:2304 sc1
  buffer_load_dwordx3 v[248:250], v251, s[52:55], s82 offen offset:3072 sc1
  s_waitcnt vmcnt(0)
  s_branch aggpoll_28
retry_30:
  s_sub_u32 s10, s10, 1
  s_cmp_gt_i32 s10, 0
  s_cbranch_scc1 aggagain_29
  s_branch giveup_31
slow_32:
  s_add_u32 s13, s75, 10485760
  s_waitcnt lgkmcnt(6)
  buffer_store_dwordx4 v[68:71], v254, s[52:55], s13 offen sc1
  s_add_u32 s13, s76, 10485760
  s_waitcnt lgkmcnt(3)
  buffer_store_dwordx4 v[72:75], v254, s[52:55], s13 offen sc1
  s_add_u32 s13, s77, 10485760
  s_waitcnt lgkmcnt(0)
  buffer_store_dwordx4 v[76:79], v254, s[52:55], s13 offen sc1
  s_nop 1
  s_branch back_33
slow_34:
  s_add_u32 s13, s78, 10485760
  s_waitcnt lgkmcnt(3)
  buffer_store_dwordx4 v[80:83], v254, s[52:55], s13 offen sc1
  s_add_u32 s13, s79, 10485760
  s_waitcnt lgkmcnt(0)
  buffer_store_dwordx4 v[84:87], v254, s[52:55], s13 offen sc1
  s_nop 1
  s_branch back_35
slow_36:
  buffer_store_dword v15, off, s[52:55], s12 sc1
  s_nop 1
  s_branch back_37
retry_39:
  s_sub_u32 s10, s10, 1
  s_cmp_gt_i32 s10, 0
  s_cbranch_scc1 poll_38
  s_branch giveup_40
again_41:
  s_sub_u32 s10, s10, 1
  s_cmp_gt_i32 s10, 0
  s_cbranch_scc0 ok_42
  buffer_load_dwordx4 v[200:203], v204, s[52:55], s13 offen sc1
  s_waitcnt vmcnt(0)
  v_xor_b32 v15, s8, v200
  v_xor_b32 v14, s8, v201
  v_or_b32 v15, v15, v14
  v_xor_b32 v14, s8, v202
  v_or_b32 v15, v15, v14
  v_xor_b32 v14, s8, v203
  v_or_b32 v15, v15, v14
  v_cmp_ne_u32 vcc, 0, v15
  s_cbranch_vccnz again_41
  s_branch ok_42
slow_43:
  buffer_store_dwordx4 v[216:219], v2, s[52:55], s13 offen sc1
  s_nop 1
  s_branch back_44
retry_46:
  s_sub_u32 s10, s10, 1
  s_cmp_gt_i32 s10, 0
  s_cbranch_scc1 stpoll_45
  s_branch giveup_47
slow_48:
  buffer_store_dwordx2 v[180:181], v47, s[52:55], s12 offen offset:0 sc1
  buffer_store_dwordx2 v[182:183], v47, s[52:55], s12 offen offset:128 sc1
  buffer_store_dwordx2 v[184:185], v47, s[52:55], s12 offen offset:256 sc1
  buffer_store_dwordx2 v[186:187], v47, s[52:55], s12 offen offset:384 sc1
  buffer_store_dwordx2 v[188:189], v47, s[52:55], s12 offen offset:512 sc1
  s_nop 1
  s_branch back_49
slow_50:
  buffer_store_dword v15, off, s[52:55], s13 sc1
  s_nop 1
  s_branch back_51
retry_54:
  s_sub_u32 s10, s10, 1
  s_cmp_gt_i32 s10, 0
  s_cbranch_scc1 poll_53
  s_branch giveup_55
retry_60:
  s_sub_u32 s10, s10, 1
  s_cmp_gt_i32 s10, 0
  s_cbranch_scc1 aggpoll_58
  s_branch giveup_61
slow_62:
  s_add_u32 s13, s75, 10485760
  s_waitcnt lgkmcnt(6)
  buffer_store_dwordx4 v[68:71], v254, s[52:55], s13 offen sc1
  s_add_u32 s13, s76, 10485760
  s_waitcnt lgkmcnt(3)
  buffer_store_dwordx4 v[72:75], v254, s[52:55], s13 offen sc1
  s_add_u32 s13, s77, 10485760
  s_waitcnt lgkmcnt(0)
  buffer_store_dwordx4 v[76:79], v254, s[52:55], s13 offen sc1
  s_nop 1
  s_branch back_63
slow_64:
  s_add_u32 s13, s78, 10485760
  s_waitcnt lgkmcnt(3)
  buffer_store_dwordx4 v[80:83], v254, s[52:55], s13 offen sc1
  s_add_u32 s13, s79, 10485760
  s_waitcnt lgkmcnt(0)
  buffer_store_dwordx4 v[84:87], v254, s[52:55], s13 offen sc1
  s_nop 1
  s_branch back_65
slow_66:
  buffer_store_dword v15, off, s[52:55], s12 sc1
  s_nop 1
  s_branch back_67
retry_69:
  s_sub_u32 s10, s10, 1
  s_cmp_gt_i32 s10, 0
  s_cbranch_scc1 poll_68
  s_branch giveup_70
slow_72:
  buffer_store_dwordx4 v[216:219], v2, s[52:55], s13 offen sc1
  s_nop 1
  s_branch back_73
retry_75:
  s_sub_u32 s10, s10, 1
  s_cmp_gt_i32 s10, 0
  s_cbranch_scc1 stpoll_74
  s_branch giveup_76
  s_endpgm
L_codeend:
.section .rodata,"a"
.p2align 6
.amdhsa_kernel interleave_layers__ssm_conv_s5__ssm_conv_h3__prompt_kernel
  .amdhsa_next_free_vgpr 512
  .amdhsa_next_free_sgpr 102
  .amdhsa_accum_offset 256
  .amdhsa_group_segment_fixed_size 0
  .amdhsa_kernarg_size 144
  .amdhsa_user_sgpr_count 2
  .amdhsa_user_sgpr_kernarg_segment_ptr 1
  .amdhsa_system_sgpr_workgroup_id_x 1
.end_amdhsa_kernel
```

```asm
; @launch grid=(256,1,1) block=(256,1,1) lds=163840
.amdgcn_target "amdgcn-amd-amdhsa--gfx950"
.text
.globl interleave_layers__ssm_conv_s5__ssm_conv_h3__prompt_kernel
.p2align 8
.type interleave_layers__ssm_conv_s5__ssm_conv_h3__prompt_kernel,@function
interleave_layers__ssm_conv_s5__ssm_conv_h3__prompt_kernel:
  s_cmp_ge_u32 s2, 256
  s_cbranch_scc1 L_end
  s_load_dwordx16 s[16:31], s[0:1], 0
  s_load_dwordx16 s[32:47], s[0:1], 64
  s_load_dwordx4 s[48:51], s[0:1], 128
  v_and_b32 v1, 63, v0
  v_lshrrev_b32 v11, 6, v0
  v_lshlrev_b32 v2, 4, v1
  v_readfirstlane_b32 s7, v11
  v_and_b32 v3, 15, v1
  v_lshrrev_b32 v4, 4, v1
  s_and_b32 s12, s2, 7
  s_lshr_b32 s13, s2, 3
  s_getpc_b64 s[98:99]
L_pc:
  s_and_b32 s4, s13, 15
  s_lshr_b32 s14, s13, 4
  s_lshl_b32 s3, s12, 1
  s_add_u32 s3, s3, s14
  s_mov_b32 s0, s12
  s_mov_b32 s1, s13
  s_and_b32 vcc_lo, s1, 7
  s_lshl_b32 vcc_lo, vcc_lo, 2
  s_add_u32 vcc_lo, vcc_lo, s7
  s_lshl_b32 vcc_lo, vcc_lo, 11
  v_lshl_add_u32 v15, v3, 7, vcc_lo
  v_min_u32 v15, L_codeend-L_pc-4, v15
  s_mov_b64 exec, 0xffff
  global_load_dword a250, v15, s[98:99]
  s_mov_b64 exec, -1
  v_lshrrev_b32 v11, 3, v1
  v_and_b32_e64 v13, 7, v1
  v_mul_u32_u24 v150, 1280, v11
  v_lshl_add_u32 v150, v13, 4, v150
  s_mul_i32 s13, s1, 81920
  s_mul_i32 s12, s0, 160
  s_add_u32 s13, s13, s12
  s_sub_u32 s13, s13, 10240
  s_mul_i32 s12, s7, 6
  v_mul_u32_u24 v11, 205, v1
  v_lshrrev_b32_e64 v11, 11, v11
  v_mul_u32_u24 v12, 160, v11
  v_sub_u32 v12, v2, v12
  v_add_u32 v11, s12, v11
  v_cmp_lt_u32_e64 vcc, 8, v11
  v_mul_u32_u24 v13, 10240, v11
  v_add3_u32 v13, v13, v12, s13
  v_subrev_u32 v12, 90880, v13
  v_subrev_u32 v14, 9, v11
  v_cndmask_b32 v169, v13, v12, vcc
  v_cndmask_b32 v11, v11, v14, vcc
  v_cmp_eq_u32 vcc, 0, v11
  v_mov_b32 v14, 1879048192
  s_mul_i32 s95, s7, 960
  v_cndmask_b32 v170, v169, v14, vcc
  s_waitcnt lgkmcnt(0)
  s_load_dword s8, s[50:51], 0
  s_cmp_eq_u32 s7, 3
  s_cbranch_scc1 w3_1
  s_cmp_lg_u32 s7, 1
  s_cbranch_scc1 skip_3
  v_min_u32_e64 v11, 39, v1
  s_mul_i32 s12, s4, 80
  v_lshl_add_u32 v14, v11, 1, s12
  global_load_ushort v229, v14, s[18:19]
  global_load_ushort v230, v14, s[20:21]
  global_load_ushort v231, v14, s[30:31]
skip_3:
  s_mov_b32 s60, s36
  s_and_b32 s61, s37, 0xffff
  s_mov_b32 s62, 2621440
  s_mov_b32 s63, 0x20000
  s_mov_b32 s64, s38
  s_and_b32 s65, s39, 0xffff
  s_mov_b32 s66, 2621440
  s_mov_b32 s67, 0x20000
  s_mov_b32 exec_hi, 0x0fffffff
  s_add_u32 m0, s95, 126976
  s_nop 0
  buffer_load_dwordx4 v170, s[60:63], 0 offen lds
  s_add_u32 m0, s95, 138496
  s_nop 0
  buffer_load_dwordx4 v170, s[64:67], 0 offen lds
  s_add_u32 m0, s95, 129856
  s_movk_i32 s12, 2560
  buffer_load_dwordx4 v170, s[60:63], s12 offen lds
  s_add_u32 m0, s95, 141376
  s_nop 0
  buffer_load_dwordx4 v170, s[64:67], s12 offen lds
  s_add_u32 m0, s95, 132736
  s_movk_i32 s12, 5120
  buffer_load_dwordx4 v169, s[60:63], s12 offen lds
  s_add_u32 m0, s95, 144256
  s_nop 0
  buffer_load_dwordx4 v170, s[64:67], s12 offen lds
  s_add_u32 m0, s95, 135616
  s_movk_i32 s12, 7680
  buffer_load_dwordx4 v169, s[60:63], s12 offen lds
  s_add_u32 m0, s95, 147136
  s_nop 0
  buffer_load_dwordx4 v170, s[64:67], s12 offen lds
  s_mov_b32 exec_hi, -1
  s_branch join_2
w3_1:
  s_mov_b32 s60, s40
  s_and_b32 s61, s41, 0xffff
  s_mov_b32 s62, 5120
  s_mov_b32 s63, 0x20000
  s_mov_b32 s68, s16
  s_and_b32 s69, s17, 0xffff
  s_mov_b32 s70, 2621440
  s_mov_b32 s71, 0x20000
  s_mul_i32 s13, s0, 640
  s_mov_b32 m0, 150016
  s_lshl_b32 s12, s3, 4
  s_mov_b32 exec_hi, 0xff
  buffer_load_dwordx4 v2, s[60:63], s13 offen lds
  s_mov_b32 exec_hi, -1
  s_add_u32 s12, s12, s4
  s_mul_i32 s12, s12, 10240
  buffer_load_dwordx4 v[48:51], v150, s[68:71], s12 offen offset:0
  buffer_load_dwordx4 v[52:55], v150, s[68:71], s12 offen offset:128
  buffer_load_dwordx4 v[56:59], v150, s[68:71], s12 offen offset:256
  buffer_load_dwordx4 v[60:63], v150, s[68:71], s12 offen offset:384
  buffer_load_dwordx4 v[64:67], v150, s[68:71], s12 offen offset:512
  buffer_load_dwordx4 v[68:71], v150, s[68:71], s12 offen offset:640
  buffer_load_dwordx4 v[72:75], v150, s[68:71], s12 offen offset:768
  buffer_load_dwordx4 v[76:79], v150, s[68:71], s12 offen offset:896
  buffer_load_dwordx4 v[80:83], v150, s[68:71], s12 offen offset:1024
  buffer_load_dwordx4 v[84:87], v150, s[68:71], s12 offen offset:1152
join_2:
  s_lshr_b32 s12, s1, 1
  s_mul_i32 s12, s12, 5
  s_mul_i32 s13, s0, 80
  s_add_u32 s86, s12, s13
  s_and_b32 s13, s1, 1
  s_lshl_b32 s13, s13, 1
  s_lshr_b32 s12, s7, 1
  s_add_u32 s12, s12, s13
  s_add_u32 s12, s12, s86
  s_lshl_b32 s12, s12, 1
  s_and_b32 s12, s12, 0xfffffffc
  s_load_dword s72, s[44:45], s12
  s_add_u32 s12, s86, 4
  s_lshl_b32 s12, s12, 1
  s_and_b32 s12, s12, 0xfffffffc
  s_load_dword s73, s[44:45], s12
  s_getreg_b32 s11, hwreg(HW_REG_XCC_ID, 0, 4)
  s_mov_b32 s10, 262144
  s_mov_b32 s2, 0x3f803f80
  v_lshrrev_b32 v11, 3, v1
  v_and_b32 v12, 6, v11
  v_and_b32 v13, 7, v1
  s_movk_i32 s15, 0x78
  v_bfe_u32 v14, s15, v12, 2
  v_xor_b32 v14, v14, v13
  v_mul_u32_u24 v146, 1280, v11
  v_lshl_add_u32 v148, v14, 4, v146
  s_and_b32 s12, s7, 1
  s_lshl_b32 s13, s12, 6
  v_xor_b32_e64 v148, s13, v148
  v_add_u32 v149, 8192, v148
  v_xor_b32 v12, v12, v13
  v_and_b32 v11, 4, v11
  v_mul_u32_u24 v11, 1280, v11
  v_lshl_add_u32 v11, v12, 4, v11
  v_add_u32_e64 v146, v11, v146
  v_add_u32 v147, 19456, v146
  s_lshr_b32 s13, s7, 1
  s_mul_i32 s75, s13, 10240
  s_lshl_b32 s12, s12, 10
  s_add_u32 s75, s75, s12
  s_mul_i32 s74, s4, 51200
  s_lshl_b32 s13, s13, 7
  s_add_u32 s74, s74, s13
  s_lshl_b32 s76, s3, 2
  s_add_u32 s76, s76, s7
  s_mul_i32 s76, s76, 40960
  s_lshl_b32 s77, s7, 11
  s_add_u32 s77, s77, 102400
  s_bitcmp1_b32 s7, 0
  s_cselect_b32 s56, s24, s22
  s_cselect_b32 s57, s25, s23
  s_and_b32 s57, s57, 0xffff
  s_mov_b32 s58, 819200
  s_mov_b32 s59, 0x20000
  s_bitcmp1_b32 s3, 3
  s_cselect_b32 s60, s24, s22
  s_cselect_b32 s61, s25, s23
  s_and_b32 s61, s61, 0xffff
  s_mov_b32 s62, 819200
  s_mov_b32 s63, 0x20000
  s_mov_b32 s68, s16
  s_and_b32 s69, s17, 0xffff
  s_mov_b32 s70, 2621440
  s_mov_b32 s71, 0x20000
  s_mov_b32 s52, s50
  s_and_b32 s53, s51, 0xffff
  s_mov_b32 s54, 41943040
  s_mov_b32 s55, 0x20000
  s_lshr_b32 s14, s4, 3
  s_lshl_b32 s5, s3, 1
  s_add_u32 s5, s5, s14
  s_and_b32 s6, s4, 7
  s_lshl_b32 s84, s3, 8
  s_lshl_b32 s13, s4, 4
  s_add_u32 s84, s84, s13
  s_lshl_b32 s13, s7, 2
  s_add_u32 s84, s84, s13
  s_lshl_b32 s85, s0, 9
  s_add_u32 s85, s85, s13
  s_lshl_b32 s13, s1, 4
  s_add_u32 s85, s85, s13
  s_lshl_b32 s83, s4, 5
  s_add_u32 s83, s83, s3
  s_mul_i32 s83, s83, 640
  s_add_u32 s83, s83, 327680
  s_cmp_eq_u32 s7, 0
  s_cselect_b32 s96, -1, 0
  s_cselect_b32 s97, 0xff, 0
  s_lshl_b32 s12, s76, 1
  s_mul_i32 s13, s4, 5
  s_add_u32 s14, s13, 0
  s_lshr_b32 s15, s14, 2
  s_lshl_b32 s15, s15, 11
  s_and_b32 s14, s14, 3
  s_lshl_b32 s14, s14, 8
  s_add_u32 s14, s14, s15
  s_add_u32 s78, s14, s12
  s_add_u32 s14, s13, 1
  s_lshr_b32 s15, s14, 2
  s_lshl_b32 s15, s15, 11
  s_and_b32 s14, s14, 3
  s_lshl_b32 s14, s14, 8
  s_add_u32 s14, s14, s15
  s_add_u32 s79, s14, s12
  s_add_u32 s14, s13, 2
  s_lshr_b32 s15, s14, 2
  s_lshl_b32 s15, s15, 11
  s_and_b32 s14, s14, 3
  s_lshl_b32 s14, s14, 8
  s_add_u32 s14, s14, s15
  s_add_u32 s80, s14, s12
  s_add_u32 s14, s13, 3
  s_lshr_b32 s15, s14, 2
  s_lshl_b32 s15, s15, 11
  s_and_b32 s14, s14, 3
  s_lshl_b32 s14, s14, 8
  s_add_u32 s14, s14, s15
  s_add_u32 s81, s14, s12
  s_add_u32 s14, s13, 4
  s_lshr_b32 s15, s14, 2
  s_lshl_b32 s15, s15, 11
  s_and_b32 s14, s14, 3
  s_lshl_b32 s14, s14, 8
  s_add_u32 s14, s14, s15
  s_add_u32 s82, s14, s12
  s_mul_i32 s12, s7, 1280
  s_add_u32 s12, s12, 13824
  v_mul_u32_u24 v11, 80, v3
  v_lshl_add_u32 v11, v4, 4, v11
  v_add_u32_e64 v42, s12, v11
  v_bfe_u32 v12, v1, 2, 2
  v_mul_u32_u24 v12, 160, v12
  v_and_b32_e64 v13, 3, v1
  v_lshl_add_u32 v12, v13, 4, v12
  v_lshrrev_b32_e64 v13, 1, v4
  v_mul_u32_u24 v14, 80, v13
  v_lshlrev_b32_e64 v13, 10, v13
  v_add3_u32 v12, v12, v14, s12
  v_and_b32_e64 v14, 1, v4
  v_lshl_add_u32 v43, v14, 3, v12
  v_mul_u32_u24 v14, 40960, v14
  v_lshl_add_u32 v13, v3, 4, v13
  v_add_u32_e64 v44, v13, v14
  v_accvgpr_write_b32 a240, v42
  v_accvgpr_write_b32 a241, v43
  v_accvgpr_write_b32 a242, v44
  v_accvgpr_write_b32 a243, v148
  v_accvgpr_write_b32 a244, v149
  v_lshrrev_b32_e64 v11, 2, v3
  v_mul_u32_u24 v11, 5120, v11
  v_and_b32_e64 v12, 3, v3
  v_lshl_add_u32 v11, v12, 4, v11
  v_lshl_add_u32 v0, v4, 6, v11
  s_waitcnt lgkmcnt(0)
  s_lshr_b32 s8, s8, 4
  s_mul_i32 s8, s8, 0x19660d
  s_add_u32 s8, s8, 0x3c6ef35f
  s_lshl_b32 s8, s8, 4
  s_lshl_b32 s93, s3, 11
  s_lshl_b32 s12, s7, 9
  s_add_u32 s93, s93, s12
  s_add_u32 s93, s93, 262144
  v_and_b32 v160, 7, v3
  v_lshlrev_b32 v160, 4, v160
  v_lshl_add_u32 v160, v4, 7, v160
  s_mul_i32 s94, s4, 640
  s_add_u32 s94, s94, 303104
  v_lshlrev_b32 v161, 3, v1
  v_lshlrev_b32 v162, 3, v3
  v_and_b32 v187, 31, v1
  v_lshlrev_b32 v187, 4, v187
  s_lshl_b32 s88, s6, 9
  s_add_u32 s88, s88, 20480
  v_and_b32 v185, 31, v1
  v_lshlrev_b32 v185, 2, v185
  s_lshl_b32 s89, s0, 8
  s_add_u32 s89, s89, 294912
  v_add_u32 v11, 1, v3
  v_and_b32 v12, 1, v11
  v_mul_u32_u24 v12, 4160, v12
  v_lshrrev_b32_e64 v11, 1, v11
  v_lshl_add_u32 v12, v11, 2, v12
  v_lshl_add_u32 v12, v4, 4, v12
  v_sub_u32 v11, 15, v3
  v_lshlrev_b32 v11, 5, v11
  v_lshl_add_u32 v11, v4, 4, v11
  s_lshr_b32 s12, s7, 1
  s_and_b32 s13, s7, 1
  s_lshl_b32 s13, s13, 8
  s_mul_i32 s91, s12, 8320
  s_add_u32 s91, s91, s13
  s_add_u32 s91, s91, 102400
  v_add_u32_e64 v232, s91, v12
  s_mul_i32 s91, s12, 4608
  s_add_u32 s91, s91, s13
  v_add_u32 v240, s91, v11
  s_lshl_b32 s13, s7, 7
  s_add_u32 s91, s13, 119040
  v_add_u32 v236, s91, v12
  s_add_u32 s91, s13, 9216
  v_add_u32_e64 v241, s91, v11
  s_mul_i32 s13, s5, 163840
  s_mul_i32 s14, s7, 10240
  s_add_u32 s13, s13, s14
  s_add_u32 s13, s13, 10485760
  s_add_u32 s14, s7, 1
  s_and_b32 s14, s14, 3
  s_mul_i32 s15, s14, 40960
  s_add_u32 s16, s15, s13
  s_mul_i32 s15, s14, 10240
  s_add_u32 s15, s15, 102400
  v_add_u32 v44, s15, v2
  s_add_u32 s14, s7, 2
  s_and_b32 s14, s14, 3
  s_mul_i32 s15, s14, 40960
  s_add_u32 s17, s15, s13
  s_mul_i32 s15, s14, 10240
  s_add_u32 s15, s15, 107520
  v_add_u32 v45, s15, v2
  s_add_u32 s14, s7, 3
  s_and_b32 s14, s14, 3
  s_mul_i32 s15, s14, 40960
  s_add_u32 s18, s15, s13
  s_mul_i32 s15, s14, 5120
  v_add_u32 v46, s15, v2
  s_add_u32 s14, s7, 4
  s_and_b32 s14, s14, 3
  s_mul_i32 s15, s14, 40960
  s_add_u32 s19, s15, s13
  s_lshl_b32 s49, s3, 8
  s_lshl_b32 s13, s7, 6
  s_add_u32 s49, s49, s13
  s_and_b32 s13, s5, 1
  s_lshl_b32 s13, s13, 3
  s_add_u32 s49, s49, s13
  s_add_u32 s49, s49, 12288
  v_and_b32 v244, 3, v1
  v_lshlrev_b32 v244, 4, v244
  s_and_b32 s12, s1, 1
  s_lshl_b32 s12, s12, 1
  s_lshr_b32 s13, s7, 1
  s_add_u32 s12, s12, s13
  s_add_u32 s12, s12, s86
  s_bitcmp1_b32 s12, 0
  s_cselect_b32 s92, 16, 0
  s_lshr_b32 s72, s72, s92
  s_and_b32 s30, s72, 0xffff
  s_lshl_b32 s31, s72, 16
  s_bitcmp1_b32 s86, 0
  s_cselect_b32 s92, 16, 0
  s_lshr_b32 s73, s73, s92
  s_and_b32 s25, s73, 0xffff
  s_lshl_b32 s45, s73, 16
  s_lshl_b32 s50, s12, 12
  s_and_b32 s12, s7, 1
  s_lshl_b32 s12, s12, 11
  s_add_u32 s50, s50, s12
  s_add_u32 s50, s50, 19922944
  s_mul_i32 s13, s13, 4608
  s_sub_u32 s13, s13, s12
  s_add_u32 s13, s13, 2552
  v_lshlrev_b32_e64 v246, 5, v3
  v_lshl_add_u32 v246, v4, 3, v246
  v_sub_u32 v247, s13, v246
  s_bitcmp1_b32 s1, 0
  s_movk_i32 s12, 0x7421
  s_cselect_b32 s12, 0x6530, s12
  s_lshl_b32 s13, s7, 2
  s_lshr_b32 s12, s12, s13
  s_and_b32 s12, s12, 7
  s_lshl_b32 s12, s12, 9
  s_add_u32 s51, s86, 4
  s_lshl_b32 s51, s51, 12
  s_add_u32 s51, s51, s12
  s_add_u32 s51, s51, 19922944
  s_sub_u32 s12, 13304, s12
  v_sub_u32 v248, s12, v246
  s_lshl_b32 s12, s7, 12
  s_add_u32 s13, s12, 127360
  v_add_u32_e64 v252, s13, v2
  s_add_u32 s13, s12, 102400
  v_add_u32_e64 v249, s13, v2
  s_xor_b32 s13, s12, 4096
  s_add_u32 s13, s13, 102400
  v_add_u32 v250, s13, v2
  s_lshl_b32 s13, s7, 10
  s_add_u32 s13, s13, 127360
  v_add_u32_e64 v251, s13, v2
  v_accvgpr_write_b32 a200, v232
  v_accvgpr_write_b32 a201, v236
  v_accvgpr_write_b32 a202, v240
  v_accvgpr_write_b32 a203, v241
  v_accvgpr_write_b32 a204, v246
  v_accvgpr_write_b32 a205, v247
  v_accvgpr_write_b32 a206, v248
  v_accvgpr_write_b32 a207, v249
  v_accvgpr_write_b32 a208, v250
  v_accvgpr_write_b32 a209, v251
  v_accvgpr_write_b32 a210, v252
  v_accvgpr_write_b32 a211, v44
  v_accvgpr_write_b32 a212, v45
  v_accvgpr_write_b32 a213, v46
  v_accvgpr_write_b32 a214, v244
  s_lshl_b32 s12, s5, 6
  s_lshr_b32 s13, s7, 1
  s_lshl_b32 s13, s13, 5
  s_add_u32 s12, s12, s13
  s_and_b32 s13, s7, 1
  s_lshl_b32 s13, s13, 2
  s_add_u32 s12, s12, s13
  s_lshl_b32 s21, s12, 4
  s_add_u32 s21, s21, 262144
  s_mul_i32 s20, s12, 1280
  s_mul_i32 s13, s6, 160
  s_add_u32 s20, s20, s13
  s_lshl_b32 s48, s7, 12
  s_add_u32 s48, s48, 127360
  v_add_u32_e64 v11, 0, v1
  v_mul_u32_u24 v12, 205, v11
  v_lshrrev_b32 v12, 11, v12
  v_lshrrev_b32 v13, 2, v12
  v_mul_u32_u24 v12, 1120, v12
  v_mul_u32_u24 v13, 5120, v13
  v_lshlrev_b32_e64 v11, 4, v11
  v_add3_u32 v224, v11, v12, v13
  v_add_u32_e64 v11, 64, v1
  v_mul_u32_u24 v12, 205, v11
  v_lshrrev_b32 v12, 11, v12
  v_lshrrev_b32 v13, 2, v12
  v_mul_u32_u24 v12, 1120, v12
  v_mul_u32_u24 v13, 5120, v13
  v_lshlrev_b32_e64 v11, 4, v11
  v_add3_u32 v225, v11, v12, v13
  v_add_u32 v11, 128, v1
  v_mul_u32_u24 v12, 205, v11
  v_lshrrev_b32 v12, 11, v12
  v_lshrrev_b32 v13, 2, v12
  v_mul_u32_u24 v12, 1120, v12
  v_mul_u32_u24 v13, 5120, v13
  v_lshlrev_b32_e64 v11, 4, v11
  v_add3_u32 v226, v11, v12, v13
  v_lshl_add_u32 v228, v4, 3, s13
  v_lshrrev_b32 v12, 2, v3
  v_lshlrev_b32 v12, 7, v12
  v_and_b32_e64 v13, 3, v3
  v_lshl_add_u32 v227, v13, 4, v12
  v_mul_u32_u24 v242, 160, v3
  v_lshl_add_u32 v242, v4, 3, v242
  v_add_u32 v242, s48, v242
  v_and_b32 v11, 1, v3
  v_lshrrev_b32 v12, 1, v3
  v_and_b32 v13, 6, v12
  s_movk_i32 s15, 0x78
  v_bfe_u32 v13, s15, v13, 2
  v_xor_b32 v13, v13, v4
  v_lshl_add_u32 v13, v11, 2, v13
  v_lshlrev_b32_e64 v13, 4, v13
  v_lshl_add_u32 v13, v12, 7, v13
  v_lshl_add_u32 v5, v11, 10, v13
  v_xor_b32_e64 v6, 64, v5
  v_add_u32 v7, 51200, v5
  v_add_u32 v8, 51200, v6
  v_mul_u32_u24 v9, 144, v12
  v_lshl_add_u32 v9, v11, 2, v9
  v_lshl_add_u32 v9, v4, 3, v9
  s_lshl_b32 s12, s7, 5
  v_add_u32 v9, s12, v9
  v_and_b32 v11, 6, v3
  v_xor_b32 v11, v11, v4
  v_lshlrev_b32_e64 v11, 4, v11
  v_lshl_add_u32 v11, v3, 7, v11
  v_add_u32 v144, s77, v11
  v_xor_b32 v145, 64, v144
  v_mov_b32 v14, 1879048192
  v_lshrrev_b32 v11, 3, v1
  v_and_b32 v12, 7, v1
  v_mul_u32_u24 v13, 160, v12
  v_lshl_add_u32 v13, v11, 3, v13
  s_lshl_b32 s12, s7, 6
  s_add_u32 s12, s12, 126976
  v_add_u32 v172, s12, v13
  s_lshl_b32 s12, s7, 8
  s_add_u32 s12, s12, 150016
  v_lshl_add_u32 v173, v11, 5, s12
  v_sub_u32 v12, 7, v12
  v_lshlrev_b32_e64 v12, 4, v12
  v_lshl_add_u32 v12, v11, 14, v12
  s_cmp_lt_u32 s7, 2
  s_cselect_b32 s12, 64, 32
  v_cmp_gt_u32_e64 vcc, s12, v1
  s_mul_i32 s12, s0, 80
  s_lshl_b32 s13, s7, 5
  s_add_u32 s12, s12, s13
  s_lshl_b32 s12, s12, 12
  s_lshl_b32 s13, s1, 7
  s_sub_u32 s12, s12, s13
  s_add_u32 s87, s12, 4198272
  v_cndmask_b32 v171, v14, v12, vcc
  s_and_b32 s12, s1, 1
  s_lshl_b32 s12, s12, 1
  s_add_u32 s12, s12, s86
  s_lshl_b32 s12, s12, 12
  s_lshl_b32 s13, s7, 10
  s_add_u32 s90, s12, s13
  s_add_u32 s91, s90, 4096
  s_add_u32 s92, s86, 4
  s_lshl_b32 s92, s92, 12
  s_add_u32 s92, s92, s13
  s_add_u32 s13, s13, 102432
  v_add_u32 v186, s13, v2
  v_lshrrev_b32_e64 v11, 1, v1
  v_mul_u32_u24 v11, 4160, v11
  v_and_b32_e64 v12, 1, v1
  v_lshl_add_u32 v11, v12, 4, v11
  v_add_u32 v163, 102400, v11
  s_add_u32 m0, s75, 0
  s_add_u32 s14, s74, 0
  buffer_load_dwordx4 v148, s[56:59], s14 offen lds
  buffer_load_dwordx4 v149, s[56:59], s14 offen offset:2048 lds
  s_add_u32 m0, s75, 4096
  s_add_u32 s14, s74, 20480
  buffer_load_dwordx4 v148, s[56:59], s14 offen lds
  buffer_load_dwordx4 v149, s[56:59], s14 offen offset:2048 lds
  s_add_u32 m0, s75, 8192
  s_add_u32 s14, s74, 40960
  buffer_load_dwordx4 v148, s[56:59], s14 offen lds
  s_add_u32 m0, s77, 0
  s_add_u32 s15, s76, 0
  buffer_load_dwordx4 v146, s[68:71], s15 offen lds
  buffer_load_dwordx4 v147, s[68:71], s15 offen offset:1024 lds
  s_add_u32 m0, s77, 8192
  s_add_u32 s15, s76, 5120
  buffer_load_dwordx4 v146, s[68:71], s15 offen lds
  buffer_load_dwordx4 v147, s[68:71], s15 offen offset:1024 lds
  s_cmp_eq_u32 s7, 1
  s_cbranch_scc1 w1_5
  s_cmp_eq_u32 s7, 2
  s_cbranch_scc1 w2_6
  s_cmp_eq_u32 s7, 3
  s_cbranch_scc1 w3_7
  s_branch join_4
w1_5:
  s_waitcnt vmcnt(17)
  v_lshlrev_b32 v229, 16, v229
  v_lshlrev_b32 v230, 16, v230
  v_lshlrev_b32_e64 v231, 16, v231
  v_mul_f32 v231, 0x3fb8aa3b, v231
  v_exp_f32 v231, v231
  v_min_u32 v200, 39, v1
  v_mul_u32_u24 v198, 80, v200
  v_mul_u32_u24 v199, 176, v200
  v_cvt_pk_bf16_f32 v231, v231, v231
  v_and_b32 v231, 0xffff0000, v231
  v_mul_f32 v192, v231, v229
  v_mul_f32 v193, v231, v230
  v_mul_f32 v192, 0x3fb8aa3b, v192
  v_mul_f32 v193, 0x3e22f983, v193
  v_mul_f32 v194, 1.0, v192
  v_mul_f32 v195, 1.0, v193
  v_exp_f32 v194, v194
  v_fract_f32 v195, v195
  v_sin_f32 v196, v195
  v_cos_f32 v197, v195
  v_mul_f32 v203, v194, v196
  v_mul_f32_e64 v202, v194, v197
  v_mul_f32 v194, 0x41000000, v192
  v_mul_f32 v195, 0x41000000, v193
  v_exp_f32 v194, v194
  v_fract_f32 v195, v195
  v_sin_f32 v196, v195
  v_cos_f32 v197, v195
  v_mul_f32 v51, v194, v196
  v_mul_f32 v50, v194, v197
  v_mul_f32 v194, v229, v229
  v_fmac_f32 v194, v230, v230
  v_rcp_f32 v194, v194
  v_add_f32 v195, -1.0, v202
  v_add_f32 v194, v194, v194
  v_mul_f32 v196, v195, v229
  v_fmac_f32 v196, v203, v230
  v_mul_f32 v197, v203, v229
  v_fma_f32 v197, -v195, v230, v197
  v_mul_f32 v196, v194, v196
  v_mul_f32 v197, v194, v197
  v_and_b32 v194, 1, v200
  v_lshrrev_b32 v200, 1, v200
  v_lshlrev_b32_e64 v200, 4, v200
  v_lshl_add_u32 v200, v194, 2, v200
  v_add_u32 v200, 159744, v200
  v_add_u32 v198, 160640, v198
  v_add_u32 v199, 150784, v199
  ds_write2_b32 v200, v196, v197 offset0:0 offset1:2
  v_mov_b32 v48, 1.0
  v_mov_b32 v49, 0
  v_mov_b32 v84, 1.0
  v_mov_b32 v85, 0
  v_pk_mul_f32 v[52:53], v[50:51], v[50:51] op_sel:[1,1] op_sel_hi:[0,1] neg_lo:[0,1]
  v_pk_mul_f32 v[204:205], v[202:203], v[202:203] op_sel:[1,1] op_sel_hi:[0,1] neg_lo:[0,1]
  v_pk_fma_f32 v[52:53], v[50:51], v[50:51], v[52:53] op_sel:[0,0,0] op_sel_hi:[1,0,1]
  v_pk_fma_f32 v[204:205], v[202:203], v[202:203], v[204:205] op_sel:[0,0,0] op_sel_hi:[1,0,1]
  v_pk_mul_f32 v[54:55], v[52:53], v[50:51] op_sel:[1,1] op_sel_hi:[0,1] neg_lo:[0,1]
  v_pk_mul_f32 v[206:207], v[204:205], v[202:203] op_sel:[1,1] op_sel_hi:[0,1] neg_lo:[0,1]
  v_pk_fma_f32 v[54:55], v[52:53], v[50:51], v[54:55] op_sel:[0,0,0] op_sel_hi:[1,0,1]
  v_pk_fma_f32 v[206:207], v[204:205], v[202:203], v[206:207] op_sel:[0,0,0] op_sel_hi:[1,0,1]
  ds_write_b128 v199, v[48:51] offset:0
  v_pk_mul_f32 v[56:57], v[54:55], v[50:51] op_sel:[1,1] op_sel_hi:[0,1] neg_lo:[0,1]
  v_pk_mul_f32 v[208:209], v[206:207], v[202:203] op_sel:[1,1] op_sel_hi:[0,1] neg_lo:[0,1]
  v_pk_fma_f32 v[56:57], v[54:55], v[50:51], v[56:57] op_sel:[0,0,0] op_sel_hi:[1,0,1]
  v_pk_fma_f32 v[208:209], v[206:207], v[202:203], v[208:209] op_sel:[0,0,0] op_sel_hi:[1,0,1]
  v_pk_mul_f32 v[58:59], v[56:57], v[50:51] op_sel:[1,1] op_sel_hi:[0,1] neg_lo:[0,1]
  v_pk_mul_f32 v[210:211], v[208:209], v[202:203] op_sel:[1,1] op_sel_hi:[0,1] neg_lo:[0,1]
  v_pk_fma_f32 v[58:59], v[56:57], v[50:51], v[58:59] op_sel:[0,0,0] op_sel_hi:[1,0,1]
  v_pk_fma_f32 v[210:211], v[208:209], v[202:203], v[210:211] op_sel:[0,0,0] op_sel_hi:[1,0,1]
  ds_write_b128 v199, v[52:55] offset:16
  v_pk_mul_f32 v[60:61], v[58:59], v[50:51] op_sel:[1,1] op_sel_hi:[0,1] neg_lo:[0,1]
  v_pk_mul_f32 v[212:213], v[210:211], v[202:203] op_sel:[1,1] op_sel_hi:[0,1] neg_lo:[0,1]
  v_pk_fma_f32 v[60:61], v[58:59], v[50:51], v[60:61] op_sel:[0,0,0] op_sel_hi:[1,0,1]
  v_pk_fma_f32 v[212:213], v[210:211], v[202:203], v[212:213] op_sel:[0,0,0] op_sel_hi:[1,0,1]
  v_pk_mul_f32 v[62:63], v[60:61], v[50:51] op_sel:[1,1] op_sel_hi:[0,1] neg_lo:[0,1]
  v_pk_mul_f32 v[214:215], v[212:213], v[202:203] op_sel:[1,1] op_sel_hi:[0,1] neg_lo:[0,1]
  v_pk_fma_f32 v[62:63], v[60:61], v[50:51], v[62:63] op_sel:[0,0,0] op_sel_hi:[1,0,1]
  v_pk_fma_f32 v[214:215], v[212:213], v[202:203], v[214:215] op_sel:[0,0,0] op_sel_hi:[1,0,1]
  ds_write_b128 v199, v[56:59] offset:32
  v_pk_mul_f32 v[64:65], v[62:63], v[50:51] op_sel:[1,1] op_sel_hi:[0,1] neg_lo:[0,1]
  v_pk_fma_f32 v[64:65], v[62:63], v[50:51], v[64:65] op_sel:[0,0,0] op_sel_hi:[1,0,1]
  ds_write2_b32 v198, v202, v203 offset0:0 offset1:8
  v_pk_mul_f32 v[66:67], v[64:65], v[50:51] op_sel:[1,1] op_sel_hi:[0,1] neg_lo:[0,1]
  v_pk_fma_f32 v[66:67], v[64:65], v[50:51], v[66:67] op_sel:[0,0,0] op_sel_hi:[1,0,1]
  ds_write2_b32 v198, v204, v205 offset0:1 offset1:9
  ds_write_b128 v199, v[60:63] offset:48
  v_pk_mul_f32 v[68:69], v[66:67], v[50:51] op_sel:[1,1] op_sel_hi:[0,1] neg_lo:[0,1]
  v_pk_fma_f32 v[68:69], v[66:67], v[50:51], v[68:69] op_sel:[0,0,0] op_sel_hi:[1,0,1]
  ds_write2_b32 v198, v206, v207 offset0:2 offset1:10
  v_pk_mul_f32 v[70:71], v[68:69], v[50:51] op_sel:[1,1] op_sel_hi:[0,1] neg_lo:[0,1]
  v_pk_fma_f32 v[70:71], v[68:69], v[50:51], v[70:71] op_sel:[0,0,0] op_sel_hi:[1,0,1]
  ds_write2_b32 v198, v208, v209 offset0:3 offset1:11
  ds_write_b128 v199, v[64:67] offset:64
  v_pk_mul_f32 v[72:73], v[70:71], v[50:51] op_sel:[1,1] op_sel_hi:[0,1] neg_lo:[0,1]
  v_pk_fma_f32 v[72:73], v[70:71], v[50:51], v[72:73] op_sel:[0,0,0] op_sel_hi:[1,0,1]
  ds_write2_b32 v198, v210, v211 offset0:4 offset1:12
  v_pk_mul_f32 v[74:75], v[72:73], v[50:51] op_sel:[1,1] op_sel_hi:[0,1] neg_lo:[0,1]
  v_pk_fma_f32 v[74:75], v[72:73], v[50:51], v[74:75] op_sel:[0,0,0] op_sel_hi:[1,0,1]
  ds_write2_b32 v198, v212, v213 offset0:5 offset1:13
  ds_write_b128 v199, v[68:71] offset:80
  v_pk_mul_f32 v[76:77], v[74:75], v[50:51] op_sel:[1,1] op_sel_hi:[0,1] neg_lo:[0,1]
  v_pk_fma_f32 v[76:77], v[74:75], v[50:51], v[76:77] op_sel:[0,0,0] op_sel_hi:[1,0,1]
  ds_write2_b32 v198, v214, v215 offset0:6 offset1:14
  v_pk_mul_f32 v[78:79], v[76:77], v[50:51] op_sel:[1,1] op_sel_hi:[0,1] neg_lo:[0,1]
  v_pk_fma_f32 v[78:79], v[76:77], v[50:51], v[78:79] op_sel:[0,0,0] op_sel_hi:[1,0,1]
  ds_write_b128 v199, v[72:75] offset:96
  v_pk_mul_f32 v[80:81], v[78:79], v[50:51] op_sel:[1,1] op_sel_hi:[0,1] neg_lo:[0,1]
  v_pk_fma_f32 v[80:81], v[78:79], v[50:51], v[80:81] op_sel:[0,0,0] op_sel_hi:[1,0,1]
  ds_write2_b32 v198, v50, v51 offset0:7 offset1:15
  ds_write_b128 v199, v[76:79] offset:112
  v_pk_mul_f32 v[194:195], v[80:81], v[80:81] op_sel:[1,1] op_sel_hi:[0,1] neg_lo:[0,1]
  v_pk_fma_f32 v[194:195], v[80:81], v[80:81], v[194:195] op_sel:[0,0,0] op_sel_hi:[1,0,1]
  v_pk_mul_f32 v[86:87], v[194:195], v[194:195] op_sel:[1,1] op_sel_hi:[0,1] neg_lo:[0,1]
  v_pk_fma_f32 v[86:87], v[194:195], v[194:195], v[86:87] op_sel:[0,0,0] op_sel_hi:[1,0,1]
  v_pk_mul_f32 v[88:89], v[86:87], v[86:87] op_sel:[1,1] op_sel_hi:[0,1] neg_lo:[0,1]
  v_pk_fma_f32 v[88:89], v[86:87], v[86:87], v[88:89] op_sel:[0,0,0] op_sel_hi:[1,0,1]
  v_pk_mul_f32 v[90:91], v[88:89], v[86:87] op_sel:[1,1] op_sel_hi:[0,1] neg_lo:[0,1]
  v_pk_fma_f32 v[90:91], v[88:89], v[86:87], v[90:91] op_sel:[0,0,0] op_sel_hi:[1,0,1]
  ds_write_b64 v199, v[80:81] offset:128
  ds_write_b128 v199, v[84:87] offset:144
  ds_write_b128 v199, v[88:91] offset:160
  s_branch join_4
w2_6:
  v_lshrrev_b32 v12, 1, v1
  v_and_b32 v11, 1, v1
  v_lshlrev_b32 v11, 7, v11
  v_lshl_add_u32 v11, v12, 12, v11
  s_lshl_b32 s12, s3, 8
  s_add_u32 s12, s12, 8192
  v_add_u32 v11, s12, v11
  s_lshl_b32 s12, s0, 9
  s_add_u32 s12, s12, 27904
  v_lshl_add_u32 v12, v1, 7, s12
  v_cmp_lt_u32 vcc, 5, v1
  s_lshl_b32 s12, s0, 8
  s_add_u32 s12, s12, 294912
  v_cndmask_b32 v11, v11, v12, vcc
  v_mov_b32 v12, s12
  v_cmp_lt_u32 vcc, 9, v1
  v_mov_b32 v88, 0
  s_nop 0
  v_cndmask_b32 v11, v11, v12, vcc
  buffer_load_dword a250, v11, s[52:55], 0 offen
  s_lshl_b32 s12, s0, 8
  s_lshl_b32 s13, s1, 2
  s_add_u32 s12, s12, s13
  s_add_u32 s12, s12, 294912
  s_or_b32 s13, s8, s11
  v_mov_b32 v15, s13
  s_mov_b64 exec, 1
  buffer_store_dword v15, off, s[52:55], s12
  s_mov_b64 exec, -1
  s_lshl_b32 s12, s0, 8
  s_lshl_b32 s13, s1, 2
  s_add_u32 s12, s12, s13
  s_add_u32 s12, s12, 294912
  s_or_b32 s13, s8, s11
  v_mov_b32 v15, s13
  s_mov_b64 exec, 1
  buffer_store_dword v15, off, s[52:55], s12 offset:128 sc1
  s_mov_b64 exec, -1
  v_mov_b32 v89, 0
  v_mov_b32 v90, s8
  v_mov_b32 v91, s8
  s_add_u32 s12, s83, 327680
  s_mov_b32 exec_hi, 0xff
  buffer_store_dwordx4 v[88:91], v2, s[52:55], s83 offen sc1
  buffer_store_dwordx4 v[88:91], v2, s[52:55], s12 offen sc1
  s_mov_b32 exec_hi, -1
  s_branch join_4
w3_7:
  s_waitcnt vmcnt(9)
  v_dot2_f32_bf16 v88, v48, s2, 0
  v_dot2_f32_bf16 v90, v48, v48, 0
  v_dot2_f32_bf16 v88, v49, s2, v88
  v_dot2_f32_bf16 v90, v49, v49, v90
  v_dot2_f32_bf16 v88, v50, s2, v88
  v_dot2_f32_bf16 v90, v50, v50, v90
  v_dot2_f32_bf16 v88, v51, s2, v88
  v_dot2_f32_bf16 v90, v51, v51, v90
  v_dot2_f32_bf16 v88, v52, s2, v88
  v_dot2_f32_bf16 v90, v52, v52, v90
  v_dot2_f32_bf16 v88, v53, s2, v88
  v_dot2_f32_bf16 v90, v53, v53, v90
  v_dot2_f32_bf16 v88, v54, s2, v88
  v_dot2_f32_bf16 v90, v54, v54, v90
  v_dot2_f32_bf16 v88, v55, s2, v88
  v_dot2_f32_bf16 v90, v55, v55, v90
  v_dot2_f32_bf16 v88, v56, s2, v88
  v_dot2_f32_bf16 v90, v56, v56, v90
  v_dot2_f32_bf16 v88, v57, s2, v88
  v_dot2_f32_bf16 v90, v57, v57, v90
  v_dot2_f32_bf16 v88, v58, s2, v88
  v_dot2_f32_bf16 v90, v58, v58, v90
  v_dot2_f32_bf16 v88, v59, s2, v88
  v_dot2_f32_bf16 v90, v59, v59, v90
  v_dot2_f32_bf16 v88, v60, s2, v88
  v_dot2_f32_bf16 v90, v60, v60, v90
  v_dot2_f32_bf16 v88, v61, s2, v88
  v_dot2_f32_bf16 v90, v61, v61, v90
  v_dot2_f32_bf16 v88, v62, s2, v88
  v_dot2_f32_bf16 v90, v62, v62, v90
  v_dot2_f32_bf16 v88, v63, s2, v88
  v_dot2_f32_bf16 v90, v63, v63, v90
  v_dot2_f32_bf16 v88, v64, s2, v88
  v_dot2_f32_bf16 v90, v64, v64, v90
  v_dot2_f32_bf16 v88, v65, s2, v88
  v_dot2_f32_bf16 v90, v65, v65, v90
  v_dot2_f32_bf16 v88, v66, s2, v88
  v_dot2_f32_bf16 v90, v66, v66, v90
  v_dot2_f32_bf16 v88, v67, s2, v88
  v_dot2_f32_bf16 v90, v67, v67, v90
  v_dot2_f32_bf16 v88, v68, s2, v88
  v_dot2_f32_bf16 v90, v68, v68, v90
  v_dot2_f32_bf16 v88, v69, s2, v88
  v_dot2_f32_bf16 v90, v69, v69, v90
  v_dot2_f32_bf16 v88, v70, s2, v88
  v_dot2_f32_bf16 v90, v70, v70, v90
  v_dot2_f32_bf16 v88, v71, s2, v88
  v_dot2_f32_bf16 v90, v71, v71, v90
  v_dot2_f32_bf16 v88, v72, s2, v88
  v_dot2_f32_bf16 v90, v72, v72, v90
  v_dot2_f32_bf16 v88, v73, s2, v88
  v_dot2_f32_bf16 v90, v73, v73, v90
  v_dot2_f32_bf16 v88, v74, s2, v88
  v_dot2_f32_bf16 v90, v74, v74, v90
  v_dot2_f32_bf16 v88, v75, s2, v88
  v_dot2_f32_bf16 v90, v75, v75, v90
  v_dot2_f32_bf16 v88, v76, s2, v88
  v_dot2_f32_bf16 v90, v76, v76, v90
  v_dot2_f32_bf16 v88, v77, s2, v88
  v_dot2_f32_bf16 v90, v77, v77, v90
  v_dot2_f32_bf16 v88, v78, s2, v88
  v_dot2_f32_bf16 v90, v78, v78, v90
  v_dot2_f32_bf16 v88, v79, s2, v88
  v_dot2_f32_bf16 v90, v79, v79, v90
  v_dot2_f32_bf16 v88, v80, s2, v88
  v_dot2_f32_bf16 v90, v80, v80, v90
  v_dot2_f32_bf16 v88, v81, s2, v88
  v_dot2_f32_bf16 v90, v81, v81, v90
  v_dot2_f32_bf16 v88, v82, s2, v88
  v_dot2_f32_bf16 v90, v82, v82, v90
  v_dot2_f32_bf16 v88, v83, s2, v88
  v_dot2_f32_bf16 v90, v83, v83, v90
  v_dot2_f32_bf16 v88, v84, s2, v88
  v_dot2_f32_bf16 v90, v84, v84, v90
  v_dot2_f32_bf16 v88, v85, s2, v88
  v_dot2_f32_bf16 v90, v85, v85, v90
  v_dot2_f32_bf16 v88, v86, s2, v88
  v_dot2_f32_bf16 v90, v86, v86, v90
  v_dot2_f32_bf16 v88, v87, s2, v88
  v_dot2_f32_bf16 v90, v87, v87, v90
  s_nop 1
  v_add_f32_dpp v88, v88, v88 quad_perm:[1,0,3,2] row_mask:0xf bank_mask:0xf
  v_add_f32_dpp v90, v90, v90 quad_perm:[1,0,3,2] row_mask:0xf bank_mask:0xf
  s_nop 0
  v_add_f32_dpp v88, v88, v88 quad_perm:[2,3,0,1] row_mask:0xf bank_mask:0xf
  v_add_f32_dpp v90, v90, v90 quad_perm:[2,3,0,1] row_mask:0xf bank_mask:0xf
  s_nop 0
  v_add_f32_dpp v88, v88, v88 row_half_mirror row_mask:0xf bank_mask:0xf
  v_add_f32_dpp v90, v90, v90 row_half_mirror row_mask:0xf bank_mask:0xf
  v_mul_f32 v88, 0x3acccccd, v88
  v_mul_f32 v90, 0x3acccccd, v90
  v_fma_f32 v90, -v88, v88, v90
  v_max_f32_e64 v90, 0, v90
  v_cvt_pk_bf16_f32 v88, v88, v88
  v_and_b32 v88, 0xffff0000, v88
  v_cvt_pk_bf16_f32 v90, v90, v90
  v_and_b32 v90, 0xffff0000, v90
  v_add_f32 v90, 0x3727c5ac, v90
  v_cvt_pk_bf16_f32 v90, v90, v90
  v_and_b32 v90, 0xffff0000, v90
  v_sqrt_f32 v90, v90
  s_nop 0
  v_cvt_pk_bf16_f32 v90, v90, v90
  v_and_b32 v90, 0xffff0000, v90
  v_rcp_f32 v89, v90
  v_mov_b32 v90, s8
  v_mov_b32 v91, s8
  v_lshlrev_b32 v11, 1, v1
  s_lshl_b32 s12, s3, 4
  s_add_u32 s12, s12, s4
  s_lshl_b32 s12, s12, 7
  s_add_u32 s12, s12, 262144
  s_mov_b32 exec_lo, 0x01010101
  s_mov_b32 exec_hi, 0x01010101
  buffer_store_dwordx4 v[88:91], v11, s[52:55], s12 offen sc1
  s_mov_b64 exec, -1
join_4:
  v_mul_u32_u24 v11, 171, v1
  v_lshrrev_b32 v11, 11, v11
  v_mul_u32_u24 v12, 12, v11
  v_sub_u32 v12, v1, v12
  s_mul_i32 s12, s4, 5
  v_min_u32 v13, 4, v11
  v_add_u32 v13, s12, v13
  s_mul_i32 s13, s7, 12
  v_add_u32 v12, s13, v12
  v_cmp_gt_u32_e64 vcc, 40, v12
  v_cmp_gt_u32 s[14:15], 5, v11
  s_lshr_b32 s13, s1, 4
  s_mul_i32 s13, s13, 40
  v_min_u32 v12, 39, v12
  s_and_b64 vcc, vcc, s[14:15]
  v_add_u32_e64 v12, s13, v12
  s_mul_i32 s14, s0, 102400
  v_mul_u32_u24 v14, 1280, v12
  v_lshl_add_u32 v14, v13, 4, v14
  v_add_u32_e64 v14, s14, v14
  global_load_dwordx4 v[176:179], v14, s[26:27]
  global_load_dwordx4 v[180:183], v14, s[28:29]
  v_lshrrev_b32_e64 v14, 2, v13
  v_mul_u32_u24 v14, 10240, v14
  v_and_b32_e64 v13, 3, v13
  v_lshl_add_u32 v14, v13, 8, v14
  v_lshrrev_b32_e64 v13, 4, v12
  v_lshl_add_u32 v14, v13, 10, v14
  v_and_b32_e64 v12, 15, v12
  v_lshl_add_u32 v14, v12, 4, v14
  v_mov_b32 v13, 1879048192
  v_cndmask_b32 v174, v13, v14, vcc
  v_min_u32 v11, 4, v11
  v_lshlrev_b32_e64 v11, 6, v11
  v_add_u32 v175, 159744, v11
  s_waitcnt vmcnt(11)
  s_waitcnt lgkmcnt(0)
  s_barrier
  buffer_load_dword v184, v185, s[52:55], s89 offen sc1
  v_lshrrev_b32 v11, 1, v3
  v_mul_u32_u24 v12, 176, v11
  v_mul_u32_u24 v11, 80, v11
  v_and_b32_e64 v13, 1, v3
  v_lshl_add_u32 v12, v13, 2, v12
  v_lshl_add_u32 v12, v4, 3, v12
  s_lshl_b32 s12, s7, 5
  s_add_u32 s12, s12, 150784
  v_add_u32 v12, s12, v12
  v_add_u32 v11, 160640, v11
  v_cvt_f32_u32 v151, v13
  v_min_u32 v13, 39, v1
  v_mul_u32_u24 v13, 176, v13
  v_fma_f32 v151, 2.0, v151, -1.0
  v_add_u32 v13, 150784, v13
  s_lshl_b32 s12, s7, 3
  ds_read_b32 v16, v11 offset:0
  ds_read_b32 v21, v11 offset:32
  ds_read_b32 v26, v12 offset:0
  ds_read_b32 v17, v11 offset:640
  ds_read_b32 v22, v11 offset:672
  ds_read_b32 v28, v12 offset:1408
  ds_read_b32 v18, v11 offset:1280
  ds_read_b32 v23, v11 offset:1312
  ds_read_b32 v30, v12 offset:2816
  ds_read_b32 v19, v11 offset:1920
  ds_read_b32 v24, v11 offset:1952
  ds_read_b32 v32, v12 offset:4224
  ds_read_b32 v20, v11 offset:2560
  ds_read_b32 v25, v11 offset:2592
  ds_read_b32 v34, v12 offset:5632
  ds_read_b64 v[36:37], v13 offset:8
  ds_read_b64 v[38:39], v13 offset:128
  v_add_u32 v13, s12, v13
  ds_read_b64 v[40:41], v13 offset:144
  s_cmp_eq_u32 s7, 3
  s_cbranch_scc1 w3_8
  ds_read_b128 v[88:91], v173
  ds_read_b128 v[92:95], v173 offset:16
  ds_read_b64 v[48:49], v172 offset:7200
  ds_read_b64 v[50:51], v172 offset:8640
  ds_read_b64 v[52:53], v172 offset:10080
  ds_read_b64 v[54:55], v172 offset:160
  ds_read_b64 v[56:57], v172 offset:1600
  ds_read_b64 v[58:59], v172 offset:3040
  ds_read_b64 v[60:61], v172 offset:4480
  ds_read_b64 v[62:63], v172 offset:5920
  ds_read_b64 v[64:65], v172 offset:7360
  ds_read_b64 v[66:67], v172 offset:8800
  ds_read_b64 v[68:69], v172 offset:10240
  ds_read_b64 v[70:71], v172 offset:11680
  ds_read_b64 v[72:73], v172 offset:13120
  ds_read_b64 v[74:75], v172 offset:14560
  ds_read_b64 v[76:77], v172 offset:16000
  ds_read_b64 v[78:79], v172 offset:17440
  ds_read_b64 v[80:81], v172 offset:18880
  ds_read_b64 v[82:83], v172 offset:20320
  ds_read_b64 v[84:85], v172 offset:21760
  s_waitcnt lgkmcnt(15)
  v_lshlrev_b32 v96, 16, v88
  v_and_b32 v100, 0xffff0000, v88
  v_lshlrev_b32_e64 v104, 16, v89
  v_and_b32 v108, 0xffff0000, v89
  v_lshlrev_b32_e64 v97, 16, v90
  v_and_b32 v101, 0xffff0000, v90
  v_lshlrev_b32_e64 v105, 16, v91
  v_and_b32 v109, 0xffff0000, v91
  v_lshlrev_b32_e64 v98, 16, v92
  v_and_b32 v102, 0xffff0000, v92
  v_lshlrev_b32_e64 v106, 16, v93
  v_and_b32 v110, 0xffff0000, v93
  v_lshlrev_b32_e64 v99, 16, v94
  v_and_b32 v103, 0xffff0000, v94
  v_lshlrev_b32_e64 v107, 16, v95
  v_and_b32 v111, 0xffff0000, v95
  s_waitcnt lgkmcnt(8)
  v_lshlrev_b32 v216, 16, v48
  v_and_b32 v217, 0xffff0000, v48
  v_pk_mul_f32 v[112:113], v[216:217], v[108:109]
  v_lshlrev_b32_e64 v218, 16, v50
  v_and_b32 v219, 0xffff0000, v50
  v_pk_mul_f32 v[114:115], v[218:219], v[108:109]
  v_lshlrev_b32_e64 v216, 16, v52
  v_and_b32 v217, 0xffff0000, v52
  v_pk_fma_f32 v[112:113], v[218:219], v[104:105], v[112:113]
  v_pk_mul_f32 v[116:117], v[216:217], v[108:109]
  v_lshlrev_b32_e64 v218, 16, v54
  v_and_b32 v219, 0xffff0000, v54
  v_pk_fma_f32 v[114:115], v[216:217], v[104:105], v[114:115]
  v_pk_fma_f32 v[112:113], v[216:217], v[100:101], v[112:113]
  v_pk_mul_f32 v[118:119], v[218:219], v[108:109]
  v_lshlrev_b32_e64 v216, 16, v56
  v_and_b32 v217, 0xffff0000, v56
  v_pk_fma_f32 v[116:117], v[218:219], v[104:105], v[116:117]
  v_pk_fma_f32 v[114:115], v[218:219], v[100:101], v[114:115]
  v_pk_fma_f32 v[112:113], v[218:219], v[96:97], v[112:113]
  v_pk_mul_f32 v[120:121], v[216:217], v[108:109]
  v_lshlrev_b32_e64 v218, 16, v58
  v_and_b32 v219, 0xffff0000, v58
  v_pk_fma_f32 v[118:119], v[216:217], v[104:105], v[118:119]
  v_pk_fma_f32 v[116:117], v[216:217], v[100:101], v[116:117]
  v_pk_fma_f32 v[114:115], v[216:217], v[96:97], v[114:115]
  v_pk_mul_f32 v[122:123], v[218:219], v[108:109]
  v_lshlrev_b32_e64 v216, 16, v60
  v_and_b32 v217, 0xffff0000, v60
  v_pk_fma_f32 v[120:121], v[218:219], v[104:105], v[120:121]
  v_pk_fma_f32 v[118:119], v[218:219], v[100:101], v[118:119]
  v_pk_fma_f32 v[116:117], v[218:219], v[96:97], v[116:117]
  v_pk_mul_f32 v[124:125], v[216:217], v[108:109]
  v_lshlrev_b32_e64 v218, 16, v62
  v_and_b32 v219, 0xffff0000, v62
  v_pk_fma_f32 v[122:123], v[216:217], v[104:105], v[122:123]
  v_pk_fma_f32 v[120:121], v[216:217], v[100:101], v[120:121]
  v_pk_fma_f32 v[118:119], v[216:217], v[96:97], v[118:119]
  v_pk_mul_f32 v[126:127], v[218:219], v[108:109]
  v_lshlrev_b32_e64 v216, 16, v64
  v_and_b32 v217, 0xffff0000, v64
  v_pk_fma_f32 v[124:125], v[218:219], v[104:105], v[124:125]
  v_pk_fma_f32 v[122:123], v[218:219], v[100:101], v[122:123]
  v_pk_fma_f32 v[120:121], v[218:219], v[96:97], v[120:121]
  v_pk_fma_f32 v[126:127], v[216:217], v[104:105], v[126:127]
  v_lshlrev_b32_e64 v218, 16, v66
  v_and_b32 v219, 0xffff0000, v66
  v_pk_fma_f32 v[124:125], v[216:217], v[100:101], v[124:125]
  v_pk_fma_f32 v[122:123], v[216:217], v[96:97], v[122:123]
  v_pk_fma_f32 v[126:127], v[218:219], v[100:101], v[126:127]
  v_lshlrev_b32_e64 v216, 16, v68
  v_and_b32 v217, 0xffff0000, v68
  v_pk_fma_f32 v[124:125], v[218:219], v[96:97], v[124:125]
  v_pk_fma_f32 v[126:127], v[216:217], v[96:97], v[126:127]
  s_waitcnt lgkmcnt(0)
  v_lshlrev_b32 v220, 16, v70
  v_and_b32 v221, 0xffff0000, v70
  v_lshlrev_b32_e64 v222, 16, v72
  v_and_b32 v223, 0xffff0000, v72
  v_pk_mul_f32 v[112:113], v[112:113], v[220:221]
  v_lshlrev_b32_e64 v220, 16, v74
  v_and_b32 v221, 0xffff0000, v74
  v_pk_mul_f32 v[114:115], v[114:115], v[222:223]
  v_lshlrev_b32_e64 v222, 16, v76
  v_and_b32 v223, 0xffff0000, v76
  v_pk_mul_f32 v[116:117], v[116:117], v[220:221]
  v_lshlrev_b32_e64 v220, 16, v78
  v_and_b32 v221, 0xffff0000, v78
  v_pk_mul_f32 v[118:119], v[118:119], v[222:223]
  v_lshlrev_b32_e64 v222, 16, v80
  v_and_b32 v223, 0xffff0000, v80
  v_pk_mul_f32 v[120:121], v[120:121], v[220:221]
  v_lshlrev_b32_e64 v220, 16, v82
  v_and_b32 v221, 0xffff0000, v82
  v_pk_mul_f32 v[122:123], v[122:123], v[222:223]
  v_lshlrev_b32_e64 v222, 16, v84
  v_and_b32 v223, 0xffff0000, v84
  v_pk_mul_f32 v[124:125], v[124:125], v[220:221]
  v_pk_mul_f32 v[126:127], v[126:127], v[222:223]
  v_cvt_pk_bf16_f32 v232, v126, v124
  v_cvt_pk_bf16_f32 v233, v122, v120
  v_cvt_pk_bf16_f32 v234, v118, v116
  v_cvt_pk_bf16_f32 v235, v114, v112
  v_cvt_pk_bf16_f32 v236, v127, v125
  v_cvt_pk_bf16_f32 v237, v123, v121
  v_cvt_pk_bf16_f32 v238, v119, v117
  v_cvt_pk_bf16_f32 v239, v115, v113
  v_lshlrev_b32_e64 v216, 16, v49
  v_and_b32 v217, 0xffff0000, v49
  v_pk_mul_f32 v[112:113], v[216:217], v[110:111]
  v_lshlrev_b32_e64 v218, 16, v51
  v_and_b32 v219, 0xffff0000, v51
  v_pk_mul_f32 v[114:115], v[218:219], v[110:111]
  v_lshlrev_b32_e64 v216, 16, v53
  v_and_b32 v217, 0xffff0000, v53
  v_pk_fma_f32 v[112:113], v[218:219], v[106:107], v[112:113]
  v_pk_mul_f32 v[116:117], v[216:217], v[110:111]
  v_lshlrev_b32_e64 v218, 16, v55
  v_and_b32 v219, 0xffff0000, v55
  v_pk_fma_f32 v[114:115], v[216:217], v[106:107], v[114:115]
  v_pk_fma_f32 v[112:113], v[216:217], v[102:103], v[112:113]
  v_pk_mul_f32 v[118:119], v[218:219], v[110:111]
  v_lshlrev_b32_e64 v216, 16, v57
  v_and_b32 v217, 0xffff0000, v57
  v_pk_fma_f32 v[116:117], v[218:219], v[106:107], v[116:117]
  v_pk_fma_f32 v[114:115], v[218:219], v[102:103], v[114:115]
  v_pk_fma_f32 v[112:113], v[218:219], v[98:99], v[112:113]
  v_pk_mul_f32 v[120:121], v[216:217], v[110:111]
  v_lshlrev_b32_e64 v218, 16, v59
  v_and_b32 v219, 0xffff0000, v59
  v_pk_fma_f32 v[118:119], v[216:217], v[106:107], v[118:119]
  v_pk_fma_f32 v[116:117], v[216:217], v[102:103], v[116:117]
  v_pk_fma_f32 v[114:115], v[216:217], v[98:99], v[114:115]
  v_pk_mul_f32 v[122:123], v[218:219], v[110:111]
  v_lshlrev_b32_e64 v216, 16, v61
  v_and_b32 v217, 0xffff0000, v61
  v_pk_fma_f32 v[120:121], v[218:219], v[106:107], v[120:121]
  v_pk_fma_f32 v[118:119], v[218:219], v[102:103], v[118:119]
  v_pk_fma_f32 v[116:117], v[218:219], v[98:99], v[116:117]
  v_pk_mul_f32 v[124:125], v[216:217], v[110:111]
  v_lshlrev_b32_e64 v218, 16, v63
  v_and_b32 v219, 0xffff0000, v63
  v_pk_fma_f32 v[122:123], v[216:217], v[106:107], v[122:123]
  v_pk_fma_f32 v[120:121], v[216:217], v[102:103], v[120:121]
  v_pk_fma_f32 v[118:119], v[216:217], v[98:99], v[118:119]
  v_pk_mul_f32 v[126:127], v[218:219], v[110:111]
  v_lshlrev_b32_e64 v216, 16, v65
  v_and_b32 v217, 0xffff0000, v65
  v_pk_fma_f32 v[124:125], v[218:219], v[106:107], v[124:125]
  v_pk_fma_f32 v[122:123], v[218:219], v[102:103], v[122:123]
  v_pk_fma_f32 v[120:121], v[218:219], v[98:99], v[120:121]
  v_pk_fma_f32 v[126:127], v[216:217], v[106:107], v[126:127]
  v_lshlrev_b32_e64 v218, 16, v67
  v_and_b32 v219, 0xffff0000, v67
  v_pk_fma_f32 v[124:125], v[216:217], v[102:103], v[124:125]
  v_pk_fma_f32 v[122:123], v[216:217], v[98:99], v[122:123]
  v_pk_fma_f32 v[126:127], v[218:219], v[102:103], v[126:127]
  v_lshlrev_b32_e64 v216, 16, v69
  v_and_b32 v217, 0xffff0000, v69
  v_pk_fma_f32 v[124:125], v[218:219], v[98:99], v[124:125]
  v_pk_fma_f32 v[126:127], v[216:217], v[98:99], v[126:127]
  v_lshlrev_b32_e64 v220, 16, v71
  v_and_b32 v221, 0xffff0000, v71
  v_lshlrev_b32_e64 v222, 16, v73
  v_and_b32 v223, 0xffff0000, v73
  v_pk_mul_f32 v[112:113], v[112:113], v[220:221]
  v_lshlrev_b32_e64 v220, 16, v75
  v_and_b32 v221, 0xffff0000, v75
  v_pk_mul_f32 v[114:115], v[114:115], v[222:223]
  v_lshlrev_b32_e64 v222, 16, v77
  v_and_b32 v223, 0xffff0000, v77
  v_pk_mul_f32 v[116:117], v[116:117], v[220:221]
  v_lshlrev_b32_e64 v220, 16, v79
  v_and_b32 v221, 0xffff0000, v79
  v_pk_mul_f32 v[118:119], v[118:119], v[222:223]
  v_lshlrev_b32_e64 v222, 16, v81
  v_and_b32 v223, 0xffff0000, v81
  v_pk_mul_f32 v[120:121], v[120:121], v[220:221]
  v_lshlrev_b32_e64 v220, 16, v83
  v_and_b32 v221, 0xffff0000, v83
  v_pk_mul_f32 v[122:123], v[122:123], v[222:223]
  v_lshlrev_b32_e64 v222, 16, v85
  v_and_b32 v223, 0xffff0000, v85
  v_pk_mul_f32 v[124:125], v[124:125], v[220:221]
  v_pk_mul_f32 v[126:127], v[126:127], v[222:223]
  v_cvt_pk_bf16_f32 v88, v126, v124
  v_cvt_pk_bf16_f32 v89, v122, v120
  v_cvt_pk_bf16_f32 v90, v118, v116
  v_cvt_pk_bf16_f32 v91, v114, v112
  v_cvt_pk_bf16_f32 v92, v127, v125
  v_cvt_pk_bf16_f32 v93, v123, v121
  v_cvt_pk_bf16_f32 v94, v119, v117
  v_cvt_pk_bf16_f32 v95, v115, v113
  s_waitcnt vmcnt(0)
  v_xor_b32 v15, s8, v184
  v_cmp_lt_u32 vcc, 15, v15
  s_cbranch_vccnz again_10
ok_11:
  s_or_b32 s13, s8, s11
  v_cmp_ne_u32 vcc, s13, v184
  s_cmp_eq_u64 vcc, 0
  s_cselect_b32 s9, 1, 0
  s_cmp_eq_u32 s9, 0
  s_cbranch_scc1 slow_12
  buffer_store_dwordx4 v[232:235], v171, s[52:55], s87 offen
  s_add_u32 s87, s87, 4096
  buffer_store_dwordx4 v[236:239], v171, s[52:55], s87 offen
  s_add_u32 s87, s87, 4096
  buffer_store_dwordx4 v[88:91], v171, s[52:55], s87 offen
  s_add_u32 s87, s87, 4096
  buffer_store_dwordx4 v[92:95], v171, s[52:55], s87 offen
back_13:
  s_branch join_9
w3_8:
  s_lshl_b32 s12, s4, 3
  s_and_b32 s13, s3, 7
  s_add_u32 s12, s12, s13
  s_mul_i32 s12, s12, 6400
  s_mov_b32 exec_hi, 0xff
  buffer_load_dwordx4 v[48:51], v150, s[60:63], s12 offen offset:0
  buffer_load_dwordx4 v[52:55], v150, s[60:63], s12 offen offset:128
  buffer_load_dwordx4 v[56:59], v150, s[60:63], s12 offen offset:256
  buffer_load_dwordx4 v[60:63], v150, s[60:63], s12 offen offset:384
  buffer_load_dwordx4 v[64:67], v150, s[60:63], s12 offen offset:512
  buffer_load_dwordx4 v[68:71], v150, s[60:63], s12 offen offset:640
  buffer_load_dwordx4 v[72:75], v150, s[60:63], s12 offen offset:768
  buffer_load_dwordx4 v[76:79], v150, s[60:63], s12 offen offset:896
  buffer_load_dwordx4 v[80:83], v150, s[60:63], s12 offen offset:1024
  buffer_load_dwordx4 v[84:87], v150, s[60:63], s12 offen offset:1152
  s_mov_b32 exec_hi, -1
  s_mov_b32 s64, s22
  s_and_b32 s65, s23, 0xffff
  s_mov_b32 s66, 819200
  s_mov_b32 s67, 0x20000
  v_xor_b32 v11, 64, v148
  v_xor_b32 v12, 64, v149
  s_mul_i32 s15, s4, 51200
  s_add_u32 s14, s15, 256
  s_mov_b32 m0, 20480
  s_nop 0
  buffer_load_dwordx4 v11, s[64:67], s14 offen lds
  buffer_load_dwordx4 v12, s[64:67], s14 offen offset:2048 lds
  s_mov_b32 m0, 21504
  s_nop 0
  buffer_load_dwordx4 v148, s[56:59], s14 offen lds
  buffer_load_dwordx4 v149, s[56:59], s14 offen offset:2048 lds
  s_add_u32 s14, s15, 20736
  s_mov_b32 m0, 24576
  s_nop 0
  buffer_load_dwordx4 v11, s[64:67], s14 offen lds
  buffer_load_dwordx4 v12, s[64:67], s14 offen offset:2048 lds
  s_mov_b32 m0, 25600
  s_nop 0
  buffer_load_dwordx4 v148, s[56:59], s14 offen lds
  buffer_load_dwordx4 v149, s[56:59], s14 offen offset:2048 lds
  s_add_u32 s14, s15, 41216
  s_mov_b32 m0, 28672
  s_nop 0
  buffer_load_dwordx4 v11, s[64:67], s14 offen lds
  s_mov_b32 m0, 29696
  s_nop 0
  buffer_load_dwordx4 v148, s[56:59], s14 offen lds
  s_add_u32 s14, s15, 384
  s_mov_b32 m0, 30720
  s_nop 0
  buffer_load_dwordx4 v11, s[64:67], s14 offen lds
  buffer_load_dwordx4 v12, s[64:67], s14 offen offset:2048 lds
  s_mov_b32 m0, 31744
  s_nop 0
  buffer_load_dwordx4 v148, s[56:59], s14 offen lds
  buffer_load_dwordx4 v149, s[56:59], s14 offen offset:2048 lds
  s_add_u32 s14, s15, 20864
  s_mov_b32 m0, 34816
  s_nop 0
  buffer_load_dwordx4 v11, s[64:67], s14 offen lds
  buffer_load_dwordx4 v12, s[64:67], s14 offen offset:2048 lds
  s_mov_b32 m0, 35840
  s_nop 0
  buffer_load_dwordx4 v148, s[56:59], s14 offen lds
  buffer_load_dwordx4 v149, s[56:59], s14 offen offset:2048 lds
  s_add_u32 s14, s15, 41344
  s_mov_b32 m0, 38912
  s_nop 0
  buffer_load_dwordx4 v11, s[64:67], s14 offen lds
  s_mov_b32 m0, 39936
  s_nop 0
  buffer_load_dwordx4 v148, s[56:59], s14 offen lds
  v_mov_b32 v92, -1
  v_mov_b32 v93, -1
  v_mov_b32 v94, -1
  v_mov_b32 v95, -1
  s_sub_u32 s12, s50, 6144
  s_add_u32 s13, s12, 4096
  s_bitcmp1_b32 s1, 0
  s_movk_i32 s14, 0x7421
  s_cselect_b32 s14, 0x6530, s14
  v_lshrrev_b32 v11, 5, v1
  v_lshlrev_b32 v11, 2, v11
  v_lshrrev_b32 v11, v11, s14
  v_and_b32 v12, 31, v1
  v_lshlrev_b32 v12, 4, v12
  v_bfe_u32 v13, v11, 8, 3
  v_and_b32_e64 v11, 7, v11
  v_lshl_add_u32 v11, v11, 9, v12
  v_lshl_add_u32 v12, v13, 9, v12
  s_add_u32 s14, s86, 4
  s_lshl_b32 s14, s14, 12
  s_add_u32 s14, s14, 19922944
  buffer_store_dwordx4 v[92:95], v2, s[52:55], s12 offen offset:0 sc1
  buffer_store_dwordx4 v[92:95], v2, s[52:55], s12 offen offset:1024 sc1
  buffer_store_dwordx4 v[92:95], v2, s[52:55], s12 offen offset:2048 sc1
  buffer_store_dwordx4 v[92:95], v2, s[52:55], s12 offen offset:3072 sc1
  buffer_store_dwordx4 v[92:95], v2, s[52:55], s13 offen offset:0 sc1
  buffer_store_dwordx4 v[92:95], v2, s[52:55], s13 offen offset:1024 sc1
  buffer_store_dwordx4 v[92:95], v2, s[52:55], s13 offen offset:2048 sc1
  buffer_store_dwordx4 v[92:95], v2, s[52:55], s13 offen offset:3072 sc1
  buffer_store_dwordx4 v[92:95], v11, s[52:55], s14 offen sc1
  buffer_store_dwordx4 v[92:95], v12, s[52:55], s14 offen sc1
  s_waitcnt vmcnt(40)
  v_xor_b32 v15, s8, v184
  v_cmp_lt_u32 vcc, 15, v15
  s_cbranch_vccnz again_14
ok_15:
  s_or_b32 s13, s8, s11
  v_cmp_ne_u32 vcc, s13, v184
  s_cmp_eq_u64 vcc, 0
  s_cselect_b32 s9, 1, 0
  s_waitcnt vmcnt(30)
  v_dot2_f32_bf16 v88, v48, s2, 0
  v_dot2_f32_bf16 v89, v49, s2, 0
  v_dot2_f32_bf16 v88, v50, s2, v88
  v_dot2_f32_bf16 v89, v51, s2, v89
  v_dot2_f32_bf16 v88, v52, s2, v88
  v_dot2_f32_bf16 v89, v53, s2, v89
  v_dot2_f32_bf16 v88, v54, s2, v88
  v_dot2_f32_bf16 v89, v55, s2, v89
  v_dot2_f32_bf16 v88, v56, s2, v88
  v_dot2_f32_bf16 v89, v57, s2, v89
  v_dot2_f32_bf16 v88, v58, s2, v88
  v_dot2_f32_bf16 v89, v59, s2, v89
  v_dot2_f32_bf16 v88, v60, s2, v88
  v_dot2_f32_bf16 v89, v61, s2, v89
  v_dot2_f32_bf16 v88, v62, s2, v88
  v_dot2_f32_bf16 v89, v63, s2, v89
  v_dot2_f32_bf16 v88, v64, s2, v88
  v_dot2_f32_bf16 v89, v65, s2, v89
  v_dot2_f32_bf16 v88, v66, s2, v88
  v_dot2_f32_bf16 v89, v67, s2, v89
  v_dot2_f32_bf16 v88, v68, s2, v88
  v_dot2_f32_bf16 v89, v69, s2, v89
  v_dot2_f32_bf16 v88, v70, s2, v88
  v_dot2_f32_bf16 v89, v71, s2, v89
  v_dot2_f32_bf16 v88, v72, s2, v88
  v_dot2_f32_bf16 v89, v73, s2, v89
  v_dot2_f32_bf16 v88, v74, s2, v88
  v_dot2_f32_bf16 v89, v75, s2, v89
  v_dot2_f32_bf16 v88, v76, s2, v88
  v_dot2_f32_bf16 v89, v77, s2, v89
  v_dot2_f32_bf16 v88, v78, s2, v88
  v_dot2_f32_bf16 v89, v79, s2, v89
  v_dot2_f32_bf16 v88, v80, s2, v88
  v_dot2_f32_bf16 v89, v81, s2, v89
  v_dot2_f32_bf16 v88, v82, s2, v88
  v_dot2_f32_bf16 v89, v83, s2, v89
  v_dot2_f32_bf16 v88, v84, s2, v88
  v_dot2_f32_bf16 v89, v85, s2, v89
  v_dot2_f32_bf16 v88, v86, s2, v88
  v_dot2_f32_bf16 v89, v87, s2, v89
  s_nop 2
  v_add_f32 v88, v88, v89
  s_nop 1
  v_add_f32_dpp v88, v88, v88 quad_perm:[1,0,3,2] row_mask:0xf bank_mask:0xf
  s_nop 1
  v_add_f32_dpp v88, v88, v88 quad_perm:[2,3,0,1] row_mask:0xf bank_mask:0xf
  s_nop 1
  v_add_f32_dpp v88, v88, v88 row_half_mirror row_mask:0xf bank_mask:0xf
  v_mov_b32 v89, s8
  v_lshlrev_b32 v11, 1, v1
  s_lshl_b32 s12, s4, 3
  s_and_b32 s13, s3, 7
  s_add_u32 s12, s12, s13
  s_mul_i32 s12, s12, 80
  s_and_b32 s13, s3, 8
  s_add_u32 s12, s12, s13
  s_add_u32 s12, s12, 303104
  s_mov_b32 exec_lo, 0x01010101
  s_mov_b32 exec_hi, 1
  buffer_store_dwordx2 v[88:89], v11, s[52:55], s12 offen sc1
  s_mov_b64 exec, -1
join_9:
  s_waitcnt lgkmcnt(0)
  v_mul_f32_e64 v21, v151, v21
  v_mul_f32_dpp v27, v26, v151 quad_perm:[1,0,3,2] row_mask:0xf bank_mask:0xf
  v_mul_f32_e64 v22, v151, v22
  v_mul_f32_dpp v29, v28, v151 quad_perm:[1,0,3,2] row_mask:0xf bank_mask:0xf
  v_mul_f32_e64 v23, v151, v23
  v_mul_f32_dpp v31, v30, v151 quad_perm:[1,0,3,2] row_mask:0xf bank_mask:0xf
  v_mul_f32_e64 v24, v151, v24
  v_mul_f32_dpp v33, v32, v151 quad_perm:[1,0,3,2] row_mask:0xf bank_mask:0xf
  v_mul_f32_e64 v25, v151, v25
  v_mul_f32_dpp v35, v34, v151 quad_perm:[1,0,3,2] row_mask:0xf bank_mask:0xf
  s_waitcnt vmcnt(7)
  s_barrier
  ds_read_b128 v[128:131], v144 offset:0
  ds_read_b128 v[132:135], v144 offset:8192
  ds_read_b128 v[88:91], v5 offset:0
  ds_read_b128 v[92:95], v5 offset:2048
  ds_read_b128 v[96:99], v5 offset:4096
  ds_read_b128 v[100:103], v5 offset:6144
  ds_read_b128 v[104:107], v5 offset:8192
  s_add_u32 m0, s77, 16384
  s_add_u32 s15, s76, 128
  buffer_load_dwordx4 v146, s[68:71], s15 offen lds
  buffer_load_dwordx4 v147, s[68:71], s15 offen offset:1024 lds
  s_add_u32 m0, s77, 24576
  s_add_u32 s15, s76, 5248
  buffer_load_dwordx4 v146, s[68:71], s15 offen lds
  buffer_load_dwordx4 v147, s[68:71], s15 offen offset:1024 lds
  s_waitcnt lgkmcnt(4)
  v_mfma_f32_16x16x32_bf16 v[48:51], v[128:131], v[88:91], 0
  ds_read_b128 v[136:139], v145 offset:0
  ds_read_b128 v[140:143], v145 offset:8192
  ds_read_b128 v[108:111], v6 offset:0
  s_add_u32 m0, s77, 32768
  s_add_u32 s15, s76, 256
  buffer_load_dwordx4 v146, s[68:71], s15 offen lds
  buffer_load_dwordx4 v147, s[68:71], s15 offen offset:1024 lds
  v_mfma_f32_16x16x32_bf16 v[52:55], v[132:135], v[88:91], 0
  s_add_u32 m0, s77, 40960
  s_add_u32 s15, s76, 5376
  buffer_load_dwordx4 v146, s[68:71], s15 offen lds
  buffer_load_dwordx4 v147, s[68:71], s15 offen offset:1024 lds
  s_waitcnt lgkmcnt(6)
  v_mfma_f32_16x16x32_bf16 v[56:59], v[128:131], v[92:95], 0
  ds_read_b128 v[112:115], v6 offset:2048
  s_add_u32 m0, s75, 40960
  s_add_u32 s14, s74, 512
  buffer_load_dwordx4 v148, s[56:59], s14 offen lds
  buffer_load_dwordx4 v149, s[56:59], s14 offen offset:2048 lds
  v_mfma_f32_16x16x32_bf16 v[60:63], v[132:135], v[92:95], 0
  s_add_u32 m0, s75, 45056
  s_add_u32 s14, s74, 20992
  buffer_load_dwordx4 v148, s[56:59], s14 offen lds
  buffer_load_dwordx4 v149, s[56:59], s14 offen offset:2048 lds
  s_waitcnt lgkmcnt(6)
  v_mfma_f32_16x16x32_bf16 v[64:67], v[128:131], v[96:99], 0
  ds_read_b128 v[116:119], v6 offset:4096
  v_mfma_f32_16x16x32_bf16 v[68:71], v[132:135], v[96:99], 0
  s_waitcnt lgkmcnt(6)
  v_mfma_f32_16x16x32_bf16 v[72:75], v[128:131], v[100:103], 0
  ds_read_b128 v[120:123], v6 offset:6144
  v_mfma_f32_16x16x32_bf16 v[76:79], v[132:135], v[100:103], 0
  s_waitcnt lgkmcnt(6)
  v_mfma_f32_16x16x32_bf16 v[80:83], v[128:131], v[104:107], 0
  ds_read_b128 v[124:127], v6 offset:8192
  v_mfma_f32_16x16x32_bf16 v[84:87], v[132:135], v[104:107], 0
  s_waitcnt vmcnt(8)
  s_waitcnt lgkmcnt(2)
  v_mfma_f32_16x16x32_bf16 v[48:51], v[136:139], v[108:111], v[48:51]
  ds_read_b128 v[128:131], v144 offset:16384
  ds_read_b128 v[132:135], v144 offset:24576
  ds_read_b128 v[88:91], v5 offset:10240
  ds_read_b128 v[192:195], v175 offset:0
  ds_read_b128 v[196:199], v175 offset:16
  v_mfma_f32_16x16x32_bf16 v[52:55], v[140:143], v[108:111], v[52:55]
  ds_read_b128 v[200:203], v175 offset:32
  ds_read_b128 v[204:207], v175 offset:48
  v_mfma_f32_16x16x32_bf16 v[56:59], v[136:139], v[112:115], v[56:59]
  ds_read_b128 v[92:95], v5 offset:12288
  s_waitcnt lgkmcnt(1)
  v_lshlrev_b32_e64 v152, 16, v176
  v_mfma_f32_16x16x32_bf16 v[60:63], v[140:143], v[112:115], v[60:63]
  v_and_b32 v153, 0xffff0000, v176
  v_lshlrev_b32_e64 v154, 16, v180
  v_mfma_f32_16x16x32_bf16 v[64:67], v[136:139], v[116:119], v[64:67]
  ds_read_b128 v[96:99], v5 offset:14336
  v_and_b32 v155, 0xffff0000, v180
  v_pk_mul_f32 v[156:157], v[152:153], v[192:193]
  v_mfma_f32_16x16x32_bf16 v[68:71], v[140:143], v[116:119], v[68:71]
  v_pk_mul_f32 v[158:159], v[152:153], v[194:195] neg_lo:[0,1] neg_hi:[0,1]
  v_pk_fma_f32 v[156:157], v[154:155], v[194:195], v[156:157] neg_lo:[0,1,0] neg_hi:[0,1,0]
  v_mfma_f32_16x16x32_bf16 v[72:75], v[136:139], v[120:123], v[72:75]
  ds_read_b128 v[100:103], v5 offset:16384
  v_pk_fma_f32 v[158:159], v[154:155], v[192:193], v[158:159] neg_lo:[0,1,0] neg_hi:[0,1,0]
  v_cvt_pk_bf16_f32 v176, v156, v157
  v_mfma_f32_16x16x32_bf16 v[76:79], v[140:143], v[120:123], v[76:79]
  s_add_u32 m0, s77, 49152
  s_add_u32 s15, s76, 384
  buffer_load_dwordx4 v146, s[68:71], s15 offen lds
  buffer_load_dwordx4 v147, s[68:71], s15 offen offset:1024 lds
  s_add_u32 m0, s77, 0
  s_add_u32 s15, s76, 5504
  buffer_load_dwordx4 v146, s[68:71], s15 offen lds
  buffer_load_dwordx4 v147, s[68:71], s15 offen offset:1024 lds
  v_mfma_f32_16x16x32_bf16 v[80:83], v[136:139], v[124:127], v[80:83]
  ds_read_b128 v[104:107], v5 offset:18432
  s_add_u32 m0, s75, 49152
  s_add_u32 s14, s74, 41472
  buffer_load_dwordx4 v148, s[56:59], s14 offen lds
  s_add_u32 m0, s75, 61440
  s_add_u32 s14, s74, 768
  buffer_load_dwordx4 v148, s[56:59], s14 offen lds
  buffer_load_dwordx4 v149, s[56:59], s14 offen offset:2048 lds
  v_mfma_f32_16x16x32_bf16 v[84:87], v[140:143], v[124:127], v[84:87]
  s_add_u32 m0, s75, 65536
  s_add_u32 s14, s74, 21248
  buffer_load_dwordx4 v148, s[56:59], s14 offen lds
  buffer_load_dwordx4 v149, s[56:59], s14 offen offset:2048 lds
  s_waitcnt lgkmcnt(2)
  v_mfma_f32_16x16x32_bf16 v[48:51], v[128:131], v[88:91], v[48:51]
  ds_read_b128 v[136:139], v145 offset:16384
  ds_read_b128 v[140:143], v145 offset:24576
  ds_read_b128 v[108:111], v6 offset:10240
  v_cvt_pk_bf16_f32 v180, v158, v159
  v_lshlrev_b32_e64 v152, 16, v177
  v_mfma_f32_16x16x32_bf16 v[52:55], v[132:135], v[88:91], v[52:55]
  v_and_b32 v153, 0xffff0000, v177
  v_lshlrev_b32_e64 v154, 16, v181
  v_mfma_f32_16x16x32_bf16 v[56:59], v[128:131], v[92:95], v[56:59]
  ds_read_b128 v[112:115], v6 offset:12288
  v_and_b32 v155, 0xffff0000, v181
  v_pk_mul_f32 v[156:157], v[152:153], v[196:197]
  v_mfma_f32_16x16x32_bf16 v[60:63], v[132:135], v[92:95], v[60:63]
  v_pk_mul_f32 v[158:159], v[152:153], v[198:199] neg_lo:[0,1] neg_hi:[0,1]
  v_pk_fma_f32 v[156:157], v[154:155], v[198:199], v[156:157] neg_lo:[0,1,0] neg_hi:[0,1,0]
  v_mfma_f32_16x16x32_bf16 v[64:67], v[128:131], v[96:99], v[64:67]
  ds_read_b128 v[116:119], v6 offset:14336
  v_pk_fma_f32 v[158:159], v[154:155], v[196:197], v[158:159] neg_lo:[0,1,0] neg_hi:[0,1,0]
  v_cvt_pk_bf16_f32 v177, v156, v157
  v_mfma_f32_16x16x32_bf16 v[68:71], v[132:135], v[96:99], v[68:71]
  v_cvt_pk_bf16_f32 v181, v158, v159
  v_lshlrev_b32 v152, 16, v178
  s_waitcnt lgkmcnt(5)
  v_mfma_f32_16x16x32_bf16 v[72:75], v[128:131], v[100:103], v[72:75]
  ds_read_b128 v[120:123], v6 offset:16384
  v_and_b32 v153, 0xffff0000, v178
  v_mfma_f32_16x16x32_bf16 v[76:79], v[132:135], v[100:103], v[76:79]
  v_lshlrev_b32_e64 v154, 16, v182
  v_mfma_f32_16x16x32_bf16 v[80:83], v[128:131], v[104:107], v[80:83]
  ds_read_b128 v[124:127], v6 offset:18432
  s_add_u32 m0, s77, 8192
  s_add_u32 s15, s76, 512
  buffer_load_dwordx4 v146, s[68:71], s15 offen lds
  buffer_load_dwordx4 v147, s[68:71], s15 offen offset:1024 lds
  v_mfma_f32_16x16x32_bf16 v[84:87], v[132:135], v[104:107], v[84:87]
  s_add_u32 m0, s75, 69632
  s_add_u32 s14, s74, 41728
  buffer_load_dwordx4 v148, s[56:59], s14 offen lds
  s_waitcnt vmcnt(16)
  s_barrier
  s_waitcnt lgkmcnt(2)
  v_mfma_f32_16x16x32_bf16 v[48:51], v[136:139], v[108:111], v[48:51]
  ds_read_b128 v[128:131], v144 offset:32768
  ds_read_b128 v[132:135], v144 offset:40960
  ds_read_b128 v[88:91], v5 offset:20480
  v_and_b32 v155, 0xffff0000, v182
  v_pk_mul_f32 v[156:157], v[152:153], v[200:201]
  v_mfma_f32_16x16x32_bf16 v[52:55], v[140:143], v[108:111], v[52:55]
  v_pk_mul_f32 v[158:159], v[152:153], v[202:203] neg_lo:[0,1] neg_hi:[0,1]
  v_pk_fma_f32 v[156:157], v[154:155], v[202:203], v[156:157] neg_lo:[0,1,0] neg_hi:[0,1,0]
  v_mfma_f32_16x16x32_bf16 v[56:59], v[136:139], v[112:115], v[56:59]
  ds_read_b128 v[92:95], v5 offset:22528
  v_pk_fma_f32 v[158:159], v[154:155], v[200:201], v[158:159] neg_lo:[0,1,0] neg_hi:[0,1,0]
  v_cvt_pk_bf16_f32 v178, v156, v157
  v_mfma_f32_16x16x32_bf16 v[60:63], v[140:143], v[112:115], v[60:63]
  v_cvt_pk_bf16_f32 v182, v158, v159
  v_lshlrev_b32 v152, 16, v179
  v_mfma_f32_16x16x32_bf16 v[64:67], v[136:139], v[116:119], v[64:67]
  ds_read_b128 v[96:99], v5 offset:24576
  v_and_b32 v153, 0xffff0000, v179
  v_lshlrev_b32_e64 v154, 16, v183
  v_mfma_f32_16x16x32_bf16 v[68:71], v[140:143], v[116:119], v[68:71]
  v_and_b32 v155, 0xffff0000, v183
  v_pk_mul_f32 v[156:157], v[152:153], v[204:205]
  s_waitcnt lgkmcnt(5)
  v_mfma_f32_16x16x32_bf16 v[72:75], v[136:139], v[120:123], v[72:75]
  ds_read_b128 v[100:103], v5 offset:26624
  v_pk_mul_f32 v[158:159], v[152:153], v[206:207] neg_lo:[0,1] neg_hi:[0,1]
  v_pk_fma_f32 v[156:157], v[154:155], v[206:207], v[156:157] neg_lo:[0,1,0] neg_hi:[0,1,0]
  v_mfma_f32_16x16x32_bf16 v[76:79], v[140:143], v[120:123], v[76:79]
  s_add_u32 m0, s77, 16384
  s_add_u32 s15, s76, 5632
  buffer_load_dwordx4 v146, s[68:71], s15 offen lds
  buffer_load_dwordx4 v147, s[68:71], s15 offen offset:1024 lds
  v_mfma_f32_16x16x32_bf16 v[80:83], v[136:139], v[124:127], v[80:83]
  ds_read_b128 v[104:107], v5 offset:28672
  s_add_u32 m0, s75, 81920
  s_add_u32 s14, s74, 1024
  buffer_load_dwordx4 v148, s[56:59], s14 offen lds
  buffer_load_dwordx4 v149, s[56:59], s14 offen offset:2048 lds
  v_mfma_f32_16x16x32_bf16 v[84:87], v[140:143], v[124:127], v[84:87]
  s_add_u32 m0, s75, 86016
  s_add_u32 s14, s74, 21504
  buffer_load_dwordx4 v148, s[56:59], s14 offen lds
  buffer_load_dwordx4 v149, s[56:59], s14 offen offset:2048 lds
  s_waitcnt lgkmcnt(2)
  v_mfma_f32_16x16x32_bf16 v[48:51], v[128:131], v[88:91], v[48:51]
  ds_read_b128 v[136:139], v145 offset:32768
  ds_read_b128 v[140:143], v145 offset:40960
  ds_read_b128 v[108:111], v6 offset:20480
  v_pk_fma_f32 v[158:159], v[154:155], v[204:205], v[158:159] neg_lo:[0,1,0] neg_hi:[0,1,0]
  v_mfma_f32_16x16x32_bf16 v[52:55], v[132:135], v[88:91], v[52:55]
  v_cvt_pk_bf16_f32 v179, v156, v157
  v_mfma_f32_16x16x32_bf16 v[56:59], v[128:131], v[92:95], v[56:59]
  ds_read_b128 v[112:115], v6 offset:22528
  v_cvt_pk_bf16_f32 v183, v158, v159
  v_mfma_f32_16x16x32_bf16 v[60:63], v[132:135], v[92:95], v[60:63]
  s_mul_i32 s12, s0, 204800
  s_add_u32 s12, s12, 23068672
  s_add_u32 s13, s12, 5120
  buffer_store_dwordx4 v[176:179], v174, s[52:55], s12 offen sc1
  buffer_store_dwordx4 v[180:183], v174, s[52:55], s13 offen sc1
  v_mfma_f32_16x16x32_bf16 v[64:67], v[128:131], v[96:99], v[64:67]
  ds_read_b128 v[116:119], v6 offset:24576
  s_add_u32 m0, s77, 24576
  s_add_u32 s15, s76, 640
  buffer_load_dwordx4 v146, s[68:71], s15 offen lds
  buffer_load_dwordx4 v147, s[68:71], s15 offen offset:1024 lds
  v_mfma_f32_16x16x32_bf16 v[68:71], v[132:135], v[96:99], v[68:71]
  s_add_u32 m0, s75, 90112
  s_add_u32 s14, s74, 41984
  buffer_load_dwordx4 v148, s[56:59], s14 offen lds
  s_waitcnt lgkmcnt(5)
  v_mfma_f32_16x16x32_bf16 v[72:75], v[128:131], v[100:103], v[72:75]
  ds_read_b128 v[120:123], v6 offset:26624
  v_mfma_f32_16x16x32_bf16 v[76:79], v[132:135], v[100:103], v[76:79]
  v_mfma_f32_16x16x32_bf16 v[80:83], v[128:131], v[104:107], v[80:83]
  ds_read_b128 v[124:127], v6 offset:28672
  v_mfma_f32_16x16x32_bf16 v[84:87], v[132:135], v[104:107], v[84:87]
  s_waitcnt vmcnt(19)
  s_waitcnt lgkmcnt(2)
  v_mfma_f32_16x16x32_bf16 v[48:51], v[136:139], v[108:111], v[48:51]
  ds_read_b128 v[128:131], v144 offset:49152
  ds_read_b128 v[132:135], v144 offset:0
  ds_read_b128 v[88:91], v5 offset:30720
  s_add_u32 m0, s77, 32768
  s_add_u32 s15, s76, 5760
  buffer_load_dwordx4 v146, s[68:71], s15 offen lds
  buffer_load_dwordx4 v147, s[68:71], s15 offen offset:1024 lds
  v_mfma_f32_16x16x32_bf16 v[52:55], v[140:143], v[108:111], v[52:55]
  s_add_u32 s12, s85, 28672
  v_mov_b32 v15, s8
  s_mov_b64 exec, 1
  s_cmp_eq_u32 s9, 0
  s_cbranch_scc1 slow_16
  buffer_store_dword v15, off, s[52:55], s12
back_17:
  s_mov_b64 exec, -1
  v_mfma_f32_16x16x32_bf16 v[56:59], v[136:139], v[112:115], v[56:59]
  ds_read_b128 v[92:95], v5 offset:32768
  v_mfma_f32_16x16x32_bf16 v[60:63], v[140:143], v[112:115], v[60:63]
  v_mfma_f32_16x16x32_bf16 v[64:67], v[136:139], v[116:119], v[64:67]
  ds_read_b128 v[96:99], v5 offset:34816
  v_mfma_f32_16x16x32_bf16 v[68:71], v[140:143], v[116:119], v[68:71]
  s_waitcnt lgkmcnt(5)
  v_mfma_f32_16x16x32_bf16 v[72:75], v[136:139], v[120:123], v[72:75]
  ds_read_b128 v[100:103], v5 offset:36864
  v_mfma_f32_16x16x32_bf16 v[76:79], v[140:143], v[120:123], v[76:79]
  v_mfma_f32_16x16x32_bf16 v[80:83], v[136:139], v[124:127], v[80:83]
  ds_read_b128 v[104:107], v5 offset:38912
  v_mfma_f32_16x16x32_bf16 v[84:87], v[140:143], v[124:127], v[84:87]
  s_waitcnt lgkmcnt(2)
  v_mfma_f32_16x16x32_bf16 v[48:51], v[128:131], v[88:91], v[48:51]
  ds_read_b128 v[136:139], v145 offset:49152
  ds_read_b128 v[140:143], v145 offset:0
  ds_read_b128 v[108:111], v6 offset:30720
  s_add_u32 m0, s77, 40960
  s_add_u32 s15, s76, 768
  buffer_load_dwordx4 v146, s[68:71], s15 offen lds
  buffer_load_dwordx4 v147, s[68:71], s15 offen offset:1024 lds
  v_mfma_f32_16x16x32_bf16 v[52:55], v[132:135], v[88:91], v[52:55]
  v_mfma_f32_16x16x32_bf16 v[56:59], v[128:131], v[92:95], v[56:59]
  ds_read_b128 v[112:115], v6 offset:32768
  v_mfma_f32_16x16x32_bf16 v[60:63], v[132:135], v[92:95], v[60:63]
  v_mfma_f32_16x16x32_bf16 v[64:67], v[128:131], v[96:99], v[64:67]
  ds_read_b128 v[116:119], v6 offset:34816
  v_mfma_f32_16x16x32_bf16 v[68:71], v[132:135], v[96:99], v[68:71]
  s_waitcnt lgkmcnt(5)
  v_mfma_f32_16x16x32_bf16 v[72:75], v[128:131], v[100:103], v[72:75]
  ds_read_b128 v[120:123], v6 offset:36864
  v_mfma_f32_16x16x32_bf16 v[76:79], v[132:135], v[100:103], v[76:79]
  v_mfma_f32_16x16x32_bf16 v[80:83], v[128:131], v[104:107], v[80:83]
  ds_read_b128 v[124:127], v6 offset:38912
  v_mfma_f32_16x16x32_bf16 v[84:87], v[132:135], v[104:107], v[84:87]
  s_waitcnt vmcnt(14)
  s_barrier
  s_waitcnt lgkmcnt(2)
  v_mfma_f32_16x16x32_bf16 v[48:51], v[136:139], v[108:111], v[48:51]
  ds_read_b128 v[128:131], v144 offset:8192
  ds_read_b128 v[132:135], v144 offset:16384
  ds_read_b128 v[88:91], v5 offset:40960
  s_add_u32 m0, s77, 49152
  s_add_u32 s15, s76, 5888
  buffer_load_dwordx4 v146, s[68:71], s15 offen lds
  buffer_load_dwordx4 v147, s[68:71], s15 offen offset:1024 lds
  v_mfma_f32_16x16x32_bf16 v[52:55], v[140:143], v[108:111], v[52:55]
  v_mfma_f32_16x16x32_bf16 v[56:59], v[136:139], v[112:115], v[56:59]
  ds_read_b128 v[92:95], v5 offset:43008
  v_mfma_f32_16x16x32_bf16 v[60:63], v[140:143], v[112:115], v[60:63]
  v_mfma_f32_16x16x32_bf16 v[64:67], v[136:139], v[116:119], v[64:67]
  ds_read_b128 v[96:99], v5 offset:45056
  v_mfma_f32_16x16x32_bf16 v[68:71], v[140:143], v[116:119], v[68:71]
  s_waitcnt lgkmcnt(5)
  v_mfma_f32_16x16x32_bf16 v[72:75], v[136:139], v[120:123], v[72:75]
  ds_read_b128 v[100:103], v5 offset:47104
  v_mfma_f32_16x16x32_bf16 v[76:79], v[140:143], v[120:123], v[76:79]
  v_mfma_f32_16x16x32_bf16 v[80:83], v[136:139], v[124:127], v[80:83]
  ds_read_b128 v[104:107], v5 offset:49152
  v_mfma_f32_16x16x32_bf16 v[84:87], v[140:143], v[124:127], v[84:87]
  s_waitcnt lgkmcnt(2)
  v_mfma_f32_16x16x32_bf16 v[48:51], v[128:131], v[88:91], v[48:51]
  ds_read_b128 v[136:139], v145 offset:8192
  ds_read_b128 v[140:143], v145 offset:16384
  ds_read_b128 v[108:111], v6 offset:40960
  s_mov_b32 s64, s42
  s_and_b32 s65, s43, 0xffff
  s_mov_b32 s66, 2621440
  s_mov_b32 s67, 0x20000
  buffer_load_dwordx4 v[192:195], v2, s[64:67], s90 offen
  v_mfma_f32_16x16x32_bf16 v[52:55], v[132:135], v[88:91], v[52:55]
  buffer_load_dwordx4 v[204:207], v2, s[64:67], s90 offen offset:4
  s_add_u32 m0, s77, 0
  s_add_u32 s15, s76, 896
  buffer_load_dwordx4 v146, s[68:71], s15 offen lds
  buffer_load_dwordx4 v147, s[68:71], s15 offen offset:1024 lds
  v_mfma_f32_16x16x32_bf16 v[56:59], v[128:131], v[92:95], v[56:59]
  ds_read_b128 v[112:115], v6 offset:43008
  v_lshrrev_b32_e64 v11, 5, v1
  v_mul_u32_u24 v11, 4096, v11
  v_mfma_f32_16x16x32_bf16 v[60:63], v[132:135], v[92:95], v[60:63]
  v_add_u32_e64 v11, v11, v2
  v_mfma_f32_16x16x32_bf16 v[64:67], v[128:131], v[96:99], v[64:67]
  ds_read_b128 v[116:119], v6 offset:45056
  v_mov_b32_e64 v216, 0
  v_mfma_f32_16x16x32_bf16 v[68:71], v[132:135], v[96:99], v[68:71]
  v_mov_b32 v217, 0
  s_waitcnt lgkmcnt(5)
  v_mfma_f32_16x16x32_bf16 v[72:75], v[128:131], v[100:103], v[72:75]
  ds_read_b128 v[120:123], v6 offset:47104
  v_mov_b32_e64 v218, 0
  v_mfma_f32_16x16x32_bf16 v[76:79], v[132:135], v[100:103], v[76:79]
  v_mov_b32_e64 v219, 0
  v_mfma_f32_16x16x32_bf16 v[80:83], v[128:131], v[104:107], v[80:83]
  ds_read_b128 v[124:127], v6 offset:49152
  ds_write_b128 v11, v[216:219] offset:4096
  v_mfma_f32_16x16x32_bf16 v[84:87], v[132:135], v[104:107], v[84:87]
  ds_write_b128 v11, v[216:219] offset:8704
  s_waitcnt vmcnt(9)
  s_waitcnt lgkmcnt(4)
  v_mfma_f32_16x16x32_bf16 v[48:51], v[136:139], v[108:111], v[48:51]
  ds_read_b128 v[128:131], v144 offset:24576
  ds_read_b128 v[132:135], v144 offset:32768
  ds_read_b128 v[88:91], v7 offset:0
  buffer_load_dwordx4 v[196:199], v2, s[64:67], s91 offen
  v_mfma_f32_16x16x32_bf16 v[52:55], v[140:143], v[108:111], v[52:55]
  buffer_load_dwordx4 v[208:211], v2, s[64:67], s91 offen offset:4
  v_mfma_f32_16x16x32_bf16 v[56:59], v[136:139], v[112:115], v[56:59]
  ds_read_b128 v[92:95], v7 offset:2048
  buffer_load_dwordx4 v[200:203], v2, s[64:67], s92 offen
  v_mfma_f32_16x16x32_bf16 v[60:63], v[140:143], v[112:115], v[60:63]
  s_add_u32 m0, s77, 8192
  s_add_u32 s15, s76, 6016
  buffer_load_dwordx4 v146, s[68:71], s15 offen lds
  buffer_load_dwordx4 v147, s[68:71], s15 offen offset:1024 lds
  v_mfma_f32_16x16x32_bf16 v[64:67], v[136:139], v[116:119], v[64:67]
  ds_read_b128 v[96:99], v7 offset:4096
  s_add_u32 s12, s85, 20480
  v_mov_b32 v15, s8
  s_mov_b64 exec, 1
  buffer_store_dword v15, off, s[52:55], s12 sc1
  s_mov_b64 exec, -1
  v_mfma_f32_16x16x32_bf16 v[68:71], v[140:143], v[116:119], v[68:71]
  s_waitcnt lgkmcnt(7)
  v_mfma_f32_16x16x32_bf16 v[72:75], v[136:139], v[120:123], v[72:75]
  ds_read_b128 v[100:103], v7 offset:6144
  v_mfma_f32_16x16x32_bf16 v[76:79], v[140:143], v[120:123], v[76:79]
  v_mfma_f32_16x16x32_bf16 v[80:83], v[136:139], v[124:127], v[80:83]
  ds_read_b128 v[104:107], v7 offset:8192
  v_mfma_f32_16x16x32_bf16 v[84:87], v[140:143], v[124:127], v[84:87]
  s_waitcnt lgkmcnt(2)
  v_mfma_f32_16x16x32_bf16 v[48:51], v[128:131], v[88:91], v[48:51]
  ds_read_b128 v[136:139], v145 offset:24576
  ds_read_b128 v[140:143], v145 offset:32768
  ds_read_b128 v[108:111], v8 offset:0
  buffer_load_dwordx4 v[212:215], v2, s[64:67], s92 offen offset:4
  v_mfma_f32_16x16x32_bf16 v[52:55], v[132:135], v[88:91], v[52:55]
  s_add_u32 m0, s77, 16384
  s_add_u32 s15, s76, 1024
  buffer_load_dwordx4 v146, s[68:71], s15 offen lds
  buffer_load_dwordx4 v147, s[68:71], s15 offen offset:1024 lds
  v_mfma_f32_16x16x32_bf16 v[56:59], v[128:131], v[92:95], v[56:59]
  ds_read_b128 v[112:115], v8 offset:2048
  s_and_b32 s87, s85, 0xe00
  s_add_u32 s87, s87, 28672
  buffer_load_dwordx4 v[188:191], v187, s[52:55], s87 offen sc1
  v_mfma_f32_16x16x32_bf16 v[60:63], v[132:135], v[92:95], v[60:63]
  v_mfma_f32_16x16x32_bf16 v[64:67], v[128:131], v[96:99], v[64:67]
  ds_read_b128 v[116:119], v8 offset:4096
  v_mfma_f32_16x16x32_bf16 v[68:71], v[132:135], v[96:99], v[68:71]
  s_waitcnt lgkmcnt(5)
  v_mfma_f32_16x16x32_bf16 v[72:75], v[128:131], v[100:103], v[72:75]
  ds_read_b128 v[120:123], v8 offset:6144
  v_mfma_f32_16x16x32_bf16 v[76:79], v[132:135], v[100:103], v[76:79]
  v_mfma_f32_16x16x32_bf16 v[80:83], v[128:131], v[104:107], v[80:83]
  ds_read_b128 v[124:127], v8 offset:8192
  v_mfma_f32_16x16x32_bf16 v[84:87], v[132:135], v[104:107], v[84:87]
  s_waitcnt vmcnt(14)
  s_barrier
  s_waitcnt lgkmcnt(2)
  v_mfma_f32_16x16x32_bf16 v[48:51], v[136:139], v[108:111], v[48:51]
  ds_read_b128 v[128:131], v144 offset:40960
  ds_read_b128 v[132:135], v144 offset:49152
  ds_read_b128 v[88:91], v7 offset:10240
  s_add_u32 m0, s77, 24576
  s_add_u32 s15, s76, 6144
  buffer_load_dwordx4 v146, s[68:71], s15 offen lds
  buffer_load_dwordx4 v147, s[68:71], s15 offen offset:1024 lds
  v_mfma_f32_16x16x32_bf16 v[52:55], v[140:143], v[108:111], v[52:55]
  v_mfma_f32_16x16x32_bf16 v[56:59], v[136:139], v[112:115], v[56:59]
  ds_read_b128 v[92:95], v7 offset:12288
  v_mfma_f32_16x16x32_bf16 v[60:63], v[140:143], v[112:115], v[60:63]
  v_mfma_f32_16x16x32_bf16 v[64:67], v[136:139], v[116:119], v[64:67]
  ds_read_b128 v[96:99], v7 offset:14336
  v_mfma_f32_16x16x32_bf16 v[68:71], v[140:143], v[116:119], v[68:71]
  s_waitcnt lgkmcnt(5)
  v_mfma_f32_16x16x32_bf16 v[72:75], v[136:139], v[120:123], v[72:75]
  ds_read_b128 v[100:103], v7 offset:16384
  v_mfma_f32_16x16x32_bf16 v[76:79], v[140:143], v[120:123], v[76:79]
  v_mfma_f32_16x16x32_bf16 v[80:83], v[136:139], v[124:127], v[80:83]
  ds_read_b128 v[104:107], v7 offset:18432
  v_mfma_f32_16x16x32_bf16 v[84:87], v[140:143], v[124:127], v[84:87]
  s_waitcnt lgkmcnt(2)
  v_mfma_f32_16x16x32_bf16 v[48:51], v[128:131], v[88:91], v[48:51]
  ds_read_b128 v[136:139], v145 offset:40960
  ds_read_b128 v[140:143], v145 offset:49152
  ds_read_b128 v[108:111], v8 offset:10240
  s_add_u32 m0, s77, 32768
  s_add_u32 s15, s76, 1152
  buffer_load_dwordx4 v146, s[68:71], s15 offen lds
  buffer_load_dwordx4 v147, s[68:71], s15 offen offset:1024 lds
  v_mfma_f32_16x16x32_bf16 v[52:55], v[132:135], v[88:91], v[52:55]
  s_waitcnt vmcnt(4)
  v_min3_u32 v15, v188, v189, s8
  v_max3_u32 v14, v188, v189, s8
  v_min3_u32 v15, v15, v190, v191
  v_max3_u32 v14, v14, v190, v191
  v_cmp_ne_u32 vcc, v15, v14
  s_cbranch_vccnz again_18
ok_19:
  s_add_u32 s12, s90, 4194304
  s_lshl_b32 m0, s7, 10
  s_nop 0
  buffer_load_dwordx4 v2, s[52:55], s12 offen sc1 lds
  s_add_u32 s12, s91, 4194304
  s_lshl_b32 m0, s7, 10
  s_add_u32 m0, m0, 4608
  s_nop 0
  buffer_load_dwordx4 v2, s[52:55], s12 offen sc1 lds
  s_add_u32 s12, s92, 4194304
  s_lshl_b32 m0, s7, 10
  s_add_u32 m0, m0, 9216
  s_nop 0
  buffer_load_dwordx4 v2, s[52:55], s12 offen sc1 lds
  v_mfma_f32_16x16x32_bf16 v[56:59], v[128:131], v[92:95], v[56:59]
  ds_read_b128 v[112:115], v8 offset:12288
  v_mfma_f32_16x16x32_bf16 v[60:63], v[132:135], v[92:95], v[60:63]
  v_mfma_f32_16x16x32_bf16 v[64:67], v[128:131], v[96:99], v[64:67]
  ds_read_b128 v[116:119], v8 offset:14336
  v_mfma_f32_16x16x32_bf16 v[68:71], v[132:135], v[96:99], v[68:71]
  s_waitcnt lgkmcnt(5)
  v_mfma_f32_16x16x32_bf16 v[72:75], v[128:131], v[100:103], v[72:75]
  ds_read_b128 v[120:123], v8 offset:16384
  v_mfma_f32_16x16x32_bf16 v[76:79], v[132:135], v[100:103], v[76:79]
  v_mfma_f32_16x16x32_bf16 v[80:83], v[128:131], v[104:107], v[80:83]
  ds_read_b128 v[124:127], v8 offset:18432
  v_mfma_f32_16x16x32_bf16 v[84:87], v[132:135], v[104:107], v[84:87]
  s_waitcnt lgkmcnt(2)
  v_mfma_f32_16x16x32_bf16 v[48:51], v[136:139], v[108:111], v[48:51]
  ds_read_b128 v[128:131], v144 offset:0
  ds_read_b128 v[132:135], v144 offset:8192
  ds_read_b128 v[88:91], v7 offset:20480
  s_add_u32 m0, s77, 40960
  s_add_u32 s15, s76, 6272
  buffer_load_dwordx4 v146, s[68:71], s15 offen lds
  buffer_load_dwordx4 v147, s[68:71], s15 offen offset:1024 lds
  v_mfma_f32_16x16x32_bf16 v[52:55], v[140:143], v[108:111], v[52:55]
  buffer_load_dwordx3 v[152:154], v160, s[52:55], s93 offen sc1
  v_mfma_f32_16x16x32_bf16 v[56:59], v[136:139], v[112:115], v[56:59]
  ds_read_b128 v[92:95], v7 offset:22528
  buffer_load_dwordx2 v[156:157], v161, s[52:55], s94 offen sc1
  v_mfma_f32_16x16x32_bf16 v[60:63], v[140:143], v[112:115], v[60:63]
  buffer_load_dwordx2 v[158:159], v162, s[52:55], s94 offen offset:512 sc1
  v_mfma_f32_16x16x32_bf16 v[64:67], v[136:139], v[116:119], v[64:67]
  ds_read_b128 v[96:99], v7 offset:24576
  v_mfma_f32_16x16x32_bf16 v[68:71], v[140:143], v[116:119], v[68:71]
  s_waitcnt lgkmcnt(5)
  v_mfma_f32_16x16x32_bf16 v[72:75], v[136:139], v[120:123], v[72:75]
  ds_read_b128 v[100:103], v7 offset:26624
  v_mfma_f32_16x16x32_bf16 v[76:79], v[140:143], v[120:123], v[76:79]
  v_mfma_f32_16x16x32_bf16 v[80:83], v[136:139], v[124:127], v[80:83]
  ds_read_b128 v[104:107], v7 offset:28672
  v_mfma_f32_16x16x32_bf16 v[84:87], v[140:143], v[124:127], v[84:87]
  s_waitcnt lgkmcnt(2)
  v_mfma_f32_16x16x32_bf16 v[48:51], v[128:131], v[88:91], v[48:51]
  ds_read_b128 v[136:139], v145 offset:0
  ds_read_b128 v[140:143], v145 offset:8192
  ds_read_b128 v[108:111], v8 offset:20480
  buffer_load_dwordx2 a[226:227], v227, s[52:55], s21 offen sc1
  v_mfma_f32_16x16x32_bf16 v[52:55], v[132:135], v[88:91], v[52:55]
  global_load_dwordx2 a[230:231], v228, s[32:33] offset:0
  v_mfma_f32_16x16x32_bf16 v[56:59], v[128:131], v[92:95], v[56:59]
  ds_read_b128 v[112:115], v8 offset:22528
  global_load_dwordx2 a[232:233], v228, s[32:33] offset:32
  v_mfma_f32_16x16x32_bf16 v[60:63], v[132:135], v[92:95], v[60:63]
  buffer_load_dwordx4 v[188:191], v187, s[52:55], s88 offen sc1
  v_mfma_f32_16x16x32_bf16 v[64:67], v[128:131], v[96:99], v[64:67]
  ds_read_b128 v[116:119], v8 offset:24576
  v_mfma_f32_16x16x32_bf16 v[68:71], v[132:135], v[96:99], v[68:71]
  s_waitcnt lgkmcnt(5)
  v_mfma_f32_16x16x32_bf16 v[72:75], v[128:131], v[100:103], v[72:75]
  ds_read_b128 v[120:123], v8 offset:26624
  v_mfma_f32_16x16x32_bf16 v[76:79], v[132:135], v[100:103], v[76:79]
  v_mfma_f32_16x16x32_bf16 v[80:83], v[128:131], v[104:107], v[80:83]
  ds_read_b128 v[124:127], v8 offset:28672
  v_mfma_f32_16x16x32_bf16 v[84:87], v[132:135], v[104:107], v[84:87]
  s_waitcnt vmcnt(14)
  s_barrier
  s_waitcnt lgkmcnt(2)
  v_mfma_f32_16x16x32_bf16 v[48:51], v[136:139], v[108:111], v[48:51]
  ds_read_b128 v[128:131], v144 offset:16384
  ds_read_b128 v[132:135], v144 offset:24576
  ds_read_b128 v[88:91], v7 offset:30720
  global_load_dwordx2 a[234:235], v228, s[32:33] offset:64
  v_mfma_f32_16x16x32_bf16 v[52:55], v[140:143], v[108:111], v[52:55]
  global_load_dwordx2 a[236:237], v228, s[32:33] offset:96
  v_mfma_f32_16x16x32_bf16 v[56:59], v[136:139], v[112:115], v[56:59]
  ds_read_b128 v[92:95], v7 offset:32768
  global_load_dwordx2 a[238:239], v228, s[32:33] offset:128
  v_mfma_f32_16x16x32_bf16 v[60:63], v[140:143], v[112:115], v[60:63]
  v_mfma_f32_16x16x32_bf16 v[64:67], v[136:139], v[116:119], v[64:67]
  ds_read_b128 v[96:99], v7 offset:34816
  v_mfma_f32_16x16x32_bf16 v[68:71], v[140:143], v[116:119], v[68:71]
  s_waitcnt lgkmcnt(5)
  v_mfma_f32_16x16x32_bf16 v[72:75], v[136:139], v[120:123], v[72:75]
  ds_read_b128 v[100:103], v7 offset:36864
  v_mfma_f32_16x16x32_bf16 v[76:79], v[140:143], v[120:123], v[76:79]
  v_mfma_f32_16x16x32_bf16 v[80:83], v[136:139], v[124:127], v[80:83]
  ds_read_b128 v[104:107], v7 offset:38912
  v_mfma_f32_16x16x32_bf16 v[84:87], v[140:143], v[124:127], v[84:87]
  s_waitcnt lgkmcnt(2)
  v_mfma_f32_16x16x32_bf16 v[48:51], v[128:131], v[88:91], v[48:51]
  ds_read_b128 v[136:139], v145 offset:16384
  ds_read_b128 v[140:143], v145 offset:24576
  ds_read_b128 v[108:111], v8 offset:30720
  v_mfma_f32_16x16x32_bf16 v[52:55], v[132:135], v[88:91], v[52:55]
  v_mfma_f32_16x16x32_bf16 v[56:59], v[128:131], v[92:95], v[56:59]
  ds_read_b128 v[112:115], v8 offset:32768
  v_mfma_f32_16x16x32_bf16 v[60:63], v[132:135], v[92:95], v[60:63]
  v_mfma_f32_16x16x32_bf16 v[64:67], v[128:131], v[96:99], v[64:67]
  ds_read_b128 v[116:119], v8 offset:34816
  v_mfma_f32_16x16x32_bf16 v[68:71], v[132:135], v[96:99], v[68:71]
  s_waitcnt lgkmcnt(5)
  v_mfma_f32_16x16x32_bf16 v[72:75], v[128:131], v[100:103], v[72:75]
  ds_read_b128 v[120:123], v8 offset:36864
  v_mfma_f32_16x16x32_bf16 v[76:79], v[132:135], v[100:103], v[76:79]
  v_mfma_f32_16x16x32_bf16 v[80:83], v[128:131], v[104:107], v[80:83]
  ds_read_b128 v[124:127], v8 offset:38912
  v_mfma_f32_16x16x32_bf16 v[84:87], v[132:135], v[104:107], v[84:87]
  s_waitcnt vmcnt(10)
  s_waitcnt lgkmcnt(2)
  v_mfma_f32_16x16x32_bf16 v[48:51], v[136:139], v[108:111], v[48:51]
  ds_read_b128 v[128:131], v144 offset:32768
  ds_read_b128 v[132:135], v144 offset:40960
  ds_read_b128 v[88:91], v7 offset:40960
  s_waitcnt vmcnt(3)
  v_min3_u32 v15, v188, v189, s8
  v_max3_u32 v14, v188, v189, s8
  v_min3_u32 v15, v15, v190, v191
  v_max3_u32 v14, v14, v190, v191
  v_cmp_ne_u32 vcc, v15, v14
  s_cbranch_vccnz again_20
ok_21:
  s_mul_i32 s34, s6, 200
  s_mul_i32 s12, s7, 50
  s_add_u32 s34, s34, s12
  s_lshl_b32 s34, s34, 10
  s_add_u32 s34, s34, 23068672
  v_mfma_f32_16x16x32_bf16 v[52:55], v[140:143], v[108:111], v[52:55]
  buffer_load_dwordx4 a[0:3], v2, s[52:55], s34 offen offset:0 sc1
  v_mfma_f32_16x16x32_bf16 v[56:59], v[136:139], v[112:115], v[56:59]
  ds_read_b128 v[92:95], v7 offset:43008
  buffer_load_dwordx4 a[4:7], v2, s[52:55], s34 offen offset:1024 sc1
  v_mfma_f32_16x16x32_bf16 v[60:63], v[140:143], v[112:115], v[60:63]
  buffer_load_dwordx4 a[8:11], v2, s[52:55], s34 offen offset:2048 sc1
  v_mfma_f32_16x16x32_bf16 v[64:67], v[136:139], v[116:119], v[64:67]
  ds_read_b128 v[96:99], v7 offset:45056
  v_mfma_f32_16x16x32_bf16 v[68:71], v[140:143], v[116:119], v[68:71]
  s_waitcnt lgkmcnt(5)
  v_mfma_f32_16x16x32_bf16 v[72:75], v[136:139], v[120:123], v[72:75]
  ds_read_b128 v[100:103], v7 offset:47104
  v_mfma_f32_16x16x32_bf16 v[76:79], v[140:143], v[120:123], v[76:79]
  v_mfma_f32_16x16x32_bf16 v[80:83], v[136:139], v[124:127], v[80:83]
  ds_read_b128 v[104:107], v7 offset:49152
  v_mfma_f32_16x16x32_bf16 v[84:87], v[140:143], v[124:127], v[84:87]
  s_waitcnt lgkmcnt(2)
  v_mfma_f32_16x16x32_bf16 v[48:51], v[128:131], v[88:91], v[48:51]
  ds_read_b128 v[136:139], v145 offset:32768
  ds_read_b128 v[140:143], v145 offset:40960
  ds_read_b128 v[108:111], v8 offset:40960
  v_min3_u32 v15, v154, v154, s8
  v_max3_u32 v14, v154, v154, s8
  v_min3_u32 v15, v15, v157, v159
  v_max3_u32 v14, v14, v157, v159
  v_cmp_ne_u32 vcc, v15, v14
  s_cbranch_vccnz again_22
ok_23:
  v_mfma_f32_16x16x32_bf16 v[52:55], v[132:135], v[88:91], v[52:55]
  buffer_load_dwordx4 a[12:15], v2, s[52:55], s34 offen offset:3072 sc1
  v_mfma_f32_16x16x32_bf16 v[56:59], v[128:131], v[92:95], v[56:59]
  ds_read_b128 v[112:115], v8 offset:43008
  s_add_u32 s34, s34, 4096
  buffer_load_dwordx4 a[16:19], v2, s[52:55], s34 offen offset:0 sc1
  v_mfma_f32_16x16x32_bf16 v[60:63], v[132:135], v[92:95], v[60:63]
  buffer_load_dwordx4 a[20:23], v2, s[52:55], s34 offen offset:1024 sc1
  v_mfma_f32_16x16x32_bf16 v[64:67], v[128:131], v[96:99], v[64:67]
  ds_read_b128 v[116:119], v8 offset:45056
  v_mfma_f32_16x16x32_bf16 v[68:71], v[132:135], v[96:99], v[68:71]
  s_waitcnt lgkmcnt(5)
  v_mfma_f32_16x16x32_bf16 v[72:75], v[128:131], v[100:103], v[72:75]
  ds_read_b128 v[120:123], v8 offset:47104
  v_mfma_f32_16x16x32_bf16 v[76:79], v[132:135], v[100:103], v[76:79]
  v_mfma_f32_16x16x32_bf16 v[80:83], v[128:131], v[104:107], v[80:83]
  ds_read_b128 v[124:127], v8 offset:49152
  v_mfma_f32_16x16x32_bf16 v[84:87], v[132:135], v[104:107], v[84:87]
  s_waitcnt lgkmcnt(2)
  s_barrier
  v_mfma_f32_16x16x32_bf16 v[48:51], v[136:139], v[108:111], v[48:51]
  buffer_load_dwordx4 a[24:27], v2, s[52:55], s34 offen offset:2048 sc1
  buffer_load_dwordx4 a[28:31], v2, s[52:55], s34 offen offset:3072 sc1
  v_mov_b32_e64 v246, v156
  v_mfma_f32_16x16x32_bf16 v[52:55], v[140:143], v[108:111], v[52:55]
  v_mov_b32 v247, v156
  v_mov_b32 v250, v158
  s_nop 0
  v_permlane16_swap_b32 v246, v247
  v_mfma_f32_16x16x32_bf16 v[56:59], v[136:139], v[112:115], v[56:59]
  v_mov_b32 v248, v246
  v_mov_b32 v249, v247
  s_nop 0
  v_permlane32_swap_b32 v246, v248
  v_mfma_f32_16x16x32_bf16 v[60:63], v[140:143], v[112:115], v[60:63]
  v_permlane32_swap_b32 v247, v249
  v_mov_b32_dpp v88, v152 row_newbcast:0 row_mask:0xf bank_mask:0xf
  v_mov_b32_dpp v96, v153 row_newbcast:0 row_mask:0xf bank_mask:0xf
  v_mfma_f32_16x16x32_bf16 v[64:67], v[136:139], v[116:119], v[64:67]
  v_mov_b32_dpp v89, v152 row_newbcast:1 row_mask:0xf bank_mask:0xf
  v_mov_b32_dpp v97, v153 row_newbcast:1 row_mask:0xf bank_mask:0xf
  v_mov_b32_dpp v90, v152 row_newbcast:2 row_mask:0xf bank_mask:0xf
  v_mfma_f32_16x16x32_bf16 v[68:71], v[140:143], v[116:119], v[68:71]
  v_mov_b32_dpp v98, v153 row_newbcast:2 row_mask:0xf bank_mask:0xf
  v_mov_b32_dpp v91, v152 row_newbcast:3 row_mask:0xf bank_mask:0xf
  v_mov_b32_dpp v99, v153 row_newbcast:3 row_mask:0xf bank_mask:0xf
  s_waitcnt lgkmcnt(0)
  v_mfma_f32_16x16x32_bf16 v[72:75], v[136:139], v[120:123], v[72:75]
  v_mov_b32_dpp v92, v152 row_newbcast:4 row_mask:0xf bank_mask:0xf
  v_mov_b32_dpp v100, v153 row_newbcast:4 row_mask:0xf bank_mask:0xf
  v_mfma_f32_16x16x32_bf16 v[76:79], v[140:143], v[120:123], v[76:79]
  v_mov_b32_dpp v93, v152 row_newbcast:5 row_mask:0xf bank_mask:0xf
  v_mov_b32_dpp v101, v153 row_newbcast:5 row_mask:0xf bank_mask:0xf
  v_mfma_f32_16x16x32_bf16 v[80:83], v[136:139], v[124:127], v[80:83]
  v_mov_b32_dpp v94, v152 row_newbcast:6 row_mask:0xf bank_mask:0xf
  v_mov_b32_dpp v102, v153 row_newbcast:6 row_mask:0xf bank_mask:0xf
  v_mfma_f32_16x16x32_bf16 v[84:87], v[140:143], v[124:127], v[84:87]
  v_mov_b32_dpp v95, v152 row_newbcast:7 row_mask:0xf bank_mask:0xf
  v_mov_b32_dpp v103, v153 row_newbcast:7 row_mask:0xf bank_mask:0xf
  v_pk_fma_f32 v[48:49], v[88:89], v[246:247], v[48:49] op_sel_hi:[1,0,1] neg_lo:[1,0,0] neg_hi:[1,0,0]
  v_pk_fma_f32 v[50:51], v[90:91], v[246:247], v[50:51] op_sel_hi:[1,0,1] neg_lo:[1,0,0] neg_hi:[1,0,0]
  v_pk_fma_f32 v[52:53], v[92:93], v[246:247], v[52:53] op_sel_hi:[1,0,1] neg_lo:[1,0,0] neg_hi:[1,0,0]
  v_pk_fma_f32 v[54:55], v[94:95], v[246:247], v[54:55] op_sel_hi:[1,0,1] neg_lo:[1,0,0] neg_hi:[1,0,0]
  v_pk_fma_f32 v[56:57], v[88:89], v[246:247], v[56:57] op_sel:[0,1,0] op_sel_hi:[1,1,1] neg_lo:[1,0,0] neg_hi:[1,0,0]
  v_pk_fma_f32 v[58:59], v[90:91], v[246:247], v[58:59] op_sel:[0,1,0] op_sel_hi:[1,1,1] neg_lo:[1,0,0] neg_hi:[1,0,0]
  v_pk_fma_f32 v[60:61], v[92:93], v[246:247], v[60:61] op_sel:[0,1,0] op_sel_hi:[1,1,1] neg_lo:[1,0,0] neg_hi:[1,0,0]
  v_pk_fma_f32 v[62:63], v[94:95], v[246:247], v[62:63] op_sel:[0,1,0] op_sel_hi:[1,1,1] neg_lo:[1,0,0] neg_hi:[1,0,0]
  v_pk_fma_f32 v[64:65], v[88:89], v[248:249], v[64:65] op_sel_hi:[1,0,1] neg_lo:[1,0,0] neg_hi:[1,0,0]
  v_pk_fma_f32 v[66:67], v[90:91], v[248:249], v[66:67] op_sel_hi:[1,0,1] neg_lo:[1,0,0] neg_hi:[1,0,0]
  v_pk_fma_f32 v[68:69], v[92:93], v[248:249], v[68:69] op_sel_hi:[1,0,1] neg_lo:[1,0,0] neg_hi:[1,0,0]
  v_pk_fma_f32 v[70:71], v[94:95], v[248:249], v[70:71] op_sel_hi:[1,0,1] neg_lo:[1,0,0] neg_hi:[1,0,0]
  v_pk_fma_f32 v[72:73], v[88:89], v[248:249], v[72:73] op_sel:[0,1,0] op_sel_hi:[1,1,1] neg_lo:[1,0,0] neg_hi:[1,0,0]
  v_pk_fma_f32 v[74:75], v[90:91], v[248:249], v[74:75] op_sel:[0,1,0] op_sel_hi:[1,1,1] neg_lo:[1,0,0] neg_hi:[1,0,0]
  v_pk_fma_f32 v[76:77], v[92:93], v[248:249], v[76:77] op_sel:[0,1,0] op_sel_hi:[1,1,1] neg_lo:[1,0,0] neg_hi:[1,0,0]
  v_pk_fma_f32 v[78:79], v[94:95], v[248:249], v[78:79] op_sel:[0,1,0] op_sel_hi:[1,1,1] neg_lo:[1,0,0] neg_hi:[1,0,0]
  v_pk_fma_f32 v[80:81], v[88:89], v[250:251], v[80:81] op_sel_hi:[1,0,1] neg_lo:[1,0,0] neg_hi:[1,0,0]
  v_pk_fma_f32 v[82:83], v[90:91], v[250:251], v[82:83] op_sel_hi:[1,0,1] neg_lo:[1,0,0] neg_hi:[1,0,0]
  v_pk_fma_f32 v[84:85], v[92:93], v[250:251], v[84:85] op_sel_hi:[1,0,1] neg_lo:[1,0,0] neg_hi:[1,0,0]
  v_pk_fma_f32 v[86:87], v[94:95], v[250:251], v[86:87] op_sel_hi:[1,0,1] neg_lo:[1,0,0] neg_hi:[1,0,0]
  v_pk_mul_f32 v[48:49], v[48:49], v[96:97]
  v_pk_mul_f32 v[50:51], v[50:51], v[98:99]
  v_pk_mul_f32 v[52:53], v[52:53], v[100:101]
  v_pk_mul_f32 v[54:55], v[54:55], v[102:103]
  v_pk_mul_f32 v[56:57], v[56:57], v[96:97]
  v_pk_mul_f32 v[58:59], v[58:59], v[98:99]
  v_pk_mul_f32 v[60:61], v[60:61], v[100:101]
  v_pk_mul_f32 v[62:63], v[62:63], v[102:103]
  v_pk_mul_f32 v[64:65], v[64:65], v[96:97]
  v_pk_mul_f32 v[66:67], v[66:67], v[98:99]
  v_pk_mul_f32 v[68:69], v[68:69], v[100:101]
  v_pk_mul_f32 v[70:71], v[70:71], v[102:103]
  v_pk_mul_f32 v[72:73], v[72:73], v[96:97]
  v_pk_mul_f32 v[74:75], v[74:75], v[98:99]
  v_pk_mul_f32 v[76:77], v[76:77], v[100:101]
  v_pk_mul_f32 v[78:79], v[78:79], v[102:103]
  v_pk_mul_f32 v[80:81], v[80:81], v[96:97]
  v_pk_mul_f32 v[82:83], v[82:83], v[98:99]
  v_pk_mul_f32 v[84:85], v[84:85], v[100:101]
  v_pk_mul_f32 v[86:87], v[86:87], v[102:103]
  ds_write_b128 v186, v[192:195] offset:0
  s_add_u32 s34, s34, 4096
  buffer_load_dwordx4 a[32:35], v2, s[52:55], s34 offen offset:0 sc1
  v_fmac_f32 v49, v16, v48
  v_fmac_f32 v57, v17, v56
  v_fmac_f32 v65, v18, v64
  v_fmac_f32 v73, v19, v72
  v_fmac_f32_e64 v81, v20, v80
  v_fmac_f32_dpp v49, v48, v21 quad_perm:[1,0,3,2] row_mask:0xf bank_mask:0xf
  v_fmac_f32_dpp v57, v56, v22 quad_perm:[1,0,3,2] row_mask:0xf bank_mask:0xf
  v_fmac_f32_dpp v65, v64, v23 quad_perm:[1,0,3,2] row_mask:0xf bank_mask:0xf
  v_fmac_f32_dpp v73, v72, v24 quad_perm:[1,0,3,2] row_mask:0xf bank_mask:0xf
  v_fmac_f32_dpp v81, v80, v25 quad_perm:[1,0,3,2] row_mask:0xf bank_mask:0xf
  v_alignbit_b32 v204, v204, v192, 16
  v_alignbit_b32 v205, v205, v193, 16
  v_alignbit_b32 v206, v206, v194, 16
  v_alignbit_b32 v207, v207, v195, 16
  ds_write_b128 v186, v[204:207] offset:4160
  ds_write_b128 v186, v[196:199] offset:8320
  buffer_load_dwordx4 a[36:39], v2, s[52:55], s34 offen offset:1024 sc1
  v_fmac_f32 v50, v16, v49
  v_fmac_f32 v58, v17, v57
  v_fmac_f32 v66, v18, v65
  v_fmac_f32 v74, v19, v73
  v_fmac_f32_e64 v82, v20, v81
  v_fmac_f32_dpp v50, v49, v21 quad_perm:[1,0,3,2] row_mask:0xf bank_mask:0xf
  v_fmac_f32_dpp v58, v57, v22 quad_perm:[1,0,3,2] row_mask:0xf bank_mask:0xf
  v_fmac_f32_dpp v66, v65, v23 quad_perm:[1,0,3,2] row_mask:0xf bank_mask:0xf
  v_fmac_f32_dpp v74, v73, v24 quad_perm:[1,0,3,2] row_mask:0xf bank_mask:0xf
  v_fmac_f32_dpp v82, v81, v25 quad_perm:[1,0,3,2] row_mask:0xf bank_mask:0xf
  v_alignbit_b32 v208, v208, v196, 16
  v_alignbit_b32 v209, v209, v197, 16
  v_alignbit_b32 v210, v210, v198, 16
  v_alignbit_b32 v211, v211, v199, 16
  ds_write_b128 v186, v[208:211] offset:12480
  ds_write_b128 v186, v[200:203] offset:16640
  buffer_load_dwordx4 a[40:43], v2, s[52:55], s34 offen offset:2048 sc1
  v_fmac_f32 v51, v16, v50
  v_fmac_f32 v59, v17, v58
  v_fmac_f32 v67, v18, v66
  v_fmac_f32 v75, v19, v74
  v_fmac_f32_e64 v83, v20, v82
  v_fmac_f32_dpp v51, v50, v21 quad_perm:[1,0,3,2] row_mask:0xf bank_mask:0xf
  v_fmac_f32_dpp v59, v58, v22 quad_perm:[1,0,3,2] row_mask:0xf bank_mask:0xf
  v_fmac_f32_dpp v67, v66, v23 quad_perm:[1,0,3,2] row_mask:0xf bank_mask:0xf
  v_fmac_f32_dpp v75, v74, v24 quad_perm:[1,0,3,2] row_mask:0xf bank_mask:0xf
  v_fmac_f32_dpp v83, v82, v25 quad_perm:[1,0,3,2] row_mask:0xf bank_mask:0xf
  v_alignbit_b32 v212, v212, v200, 16
  v_alignbit_b32 v213, v213, v201, 16
  v_alignbit_b32 v214, v214, v202, 16
  v_alignbit_b32 v215, v215, v203, 16
  ds_write_b128 v186, v[212:215] offset:20800
  buffer_load_dwordx4 a[44:47], v2, s[52:55], s34 offen offset:3072 sc1
  v_fmac_f32 v52, v16, v51
  v_fmac_f32 v60, v17, v59
  v_fmac_f32 v68, v18, v67
  v_fmac_f32 v76, v19, v75
  v_fmac_f32_e64 v84, v20, v83
  v_fmac_f32_dpp v52, v51, v21 quad_perm:[1,0,3,2] row_mask:0xf bank_mask:0xf
  v_fmac_f32_dpp v60, v59, v22 quad_perm:[1,0,3,2] row_mask:0xf bank_mask:0xf
  v_fmac_f32_dpp v68, v67, v23 quad_perm:[1,0,3,2] row_mask:0xf bank_mask:0xf
  v_fmac_f32_dpp v76, v75, v24 quad_perm:[1,0,3,2] row_mask:0xf bank_mask:0xf
  v_fmac_f32_dpp v84, v83, v25 quad_perm:[1,0,3,2] row_mask:0xf bank_mask:0xf
  s_cmp_lg_u32 s7, 0
  s_cbranch_scc1 skip_24
  v_mov_b32 v216, 0
  v_mov_b32 v217, 0
  v_mov_b32 v218, 0
  v_mov_b32 v219, 0
  s_mov_b64 exec, 0xfff
  ds_write_b128 v163, v[216:219]
  s_mov_b64 exec, 1
  ds_write_b16 v163, v192 offset:4190
  ds_write_b16 v163, v196 offset:12510
  ds_write_b16 v163, v200 offset:20830
  s_mov_b64 exec, -1
skip_24:
  s_add_u32 s34, s34, 4096
  buffer_load_dwordx4 a[48:51], v2, s[52:55], s34 offen offset:0 sc1
  v_fmac_f32 v53, v16, v52
  v_fmac_f32 v61, v17, v60
  v_fmac_f32 v69, v18, v68
  v_fmac_f32 v77, v19, v76
  v_fmac_f32_e64 v85, v20, v84
  v_fmac_f32_dpp v53, v52, v21 quad_perm:[1,0,3,2] row_mask:0xf bank_mask:0xf
  v_fmac_f32_dpp v61, v60, v22 quad_perm:[1,0,3,2] row_mask:0xf bank_mask:0xf
  v_fmac_f32_dpp v69, v68, v23 quad_perm:[1,0,3,2] row_mask:0xf bank_mask:0xf
  v_fmac_f32_dpp v77, v76, v24 quad_perm:[1,0,3,2] row_mask:0xf bank_mask:0xf
  v_fmac_f32_dpp v85, v84, v25 quad_perm:[1,0,3,2] row_mask:0xf bank_mask:0xf
  buffer_load_dwordx4 a[52:55], v2, s[52:55], s34 offen offset:1024 sc1
  v_fmac_f32 v54, v16, v53
  v_fmac_f32 v62, v17, v61
  v_fmac_f32 v70, v18, v69
  v_fmac_f32 v78, v19, v77
  v_fmac_f32_e64 v86, v20, v85
  v_fmac_f32_dpp v54, v53, v21 quad_perm:[1,0,3,2] row_mask:0xf bank_mask:0xf
  v_fmac_f32_dpp v62, v61, v22 quad_perm:[1,0,3,2] row_mask:0xf bank_mask:0xf
  v_fmac_f32_dpp v70, v69, v23 quad_perm:[1,0,3,2] row_mask:0xf bank_mask:0xf
  v_fmac_f32_dpp v78, v77, v24 quad_perm:[1,0,3,2] row_mask:0xf bank_mask:0xf
  v_fmac_f32_dpp v86, v85, v25 quad_perm:[1,0,3,2] row_mask:0xf bank_mask:0xf
  buffer_load_dwordx4 a[56:59], v2, s[52:55], s34 offen offset:2048 sc1
  v_fmac_f32 v55, v16, v54
  v_fmac_f32 v63, v17, v62
  v_fmac_f32 v71, v18, v70
  v_fmac_f32 v79, v19, v78
  v_fmac_f32_e64 v87, v20, v86
  v_fmac_f32_dpp v55, v54, v21 quad_perm:[1,0,3,2] row_mask:0xf bank_mask:0xf
  v_fmac_f32_dpp v63, v62, v22 quad_perm:[1,0,3,2] row_mask:0xf bank_mask:0xf
  v_fmac_f32_dpp v71, v70, v23 quad_perm:[1,0,3,2] row_mask:0xf bank_mask:0xf
  v_fmac_f32_dpp v79, v78, v24 quad_perm:[1,0,3,2] row_mask:0xf bank_mask:0xf
  v_fmac_f32_dpp v87, v86, v25 quad_perm:[1,0,3,2] row_mask:0xf bank_mask:0xf
  v_add_u32 v11, 152320, v9
  v_min_u32 v12, 39, v1
  v_lshlrev_b32 v44, 3, v12
  v_add_u32 v44, 158400, v44
  v_mov_b32 v42, 0
  v_mov_b32 v43, 0
  ds_write_b32 v11, v55 offset:0
  ds_write_b32 v11, v63 offset:1152
  ds_write_b32 v11, v71 offset:2304
  ds_write_b32 v11, v79 offset:3456
  ds_write_b32 v11, v87 offset:4608
  ds_write_b64 v44, v[42:43]
  v_mul_u32_u24 v46, 144, v12
  v_add_u32 v46, 152320, v46
  s_waitcnt lgkmcnt(0)
  s_barrier
  ds_read_b128 v[88:91], v46 offset:0
  ds_read_b128 v[92:95], v46 offset:16
  ds_read_b128 v[96:99], v46 offset:32
  ds_read_b128 v[100:103], v46 offset:48
  ds_read_b128 v[104:107], v46 offset:64
  ds_read_b128 v[108:111], v46 offset:80
  ds_read_b128 v[112:115], v46 offset:96
  ds_read_b128 v[116:119], v46 offset:112
  s_waitcnt lgkmcnt(7)
  v_pk_fma_f32 v[90:91], v[88:89], v[36:37], v[90:91] op_sel:[1,1,0] op_sel_hi:[0,1,1] neg_lo:[0,1,0]
  v_pk_fma_f32 v[90:91], v[88:89], v[36:37], v[90:91] op_sel:[0,0,0] op_sel_hi:[1,0,1]
  buffer_load_dwordx4 a[60:63], v2, s[52:55], s34 offen offset:3072 sc1
  s_waitcnt lgkmcnt(6)
  v_pk_fma_f32 v[92:93], v[90:91], v[36:37], v[92:93] op_sel:[1,1,0] op_sel_hi:[0,1,1] neg_lo:[0,1,0]
  v_pk_fma_f32 v[92:93], v[90:91], v[36:37], v[92:93] op_sel:[0,0,0] op_sel_hi:[1,0,1]
  v_pk_fma_f32 v[94:95], v[92:93], v[36:37], v[94:95] op_sel:[1,1,0] op_sel_hi:[0,1,1] neg_lo:[0,1,0]
  v_pk_fma_f32 v[94:95], v[92:93], v[36:37], v[94:95] op_sel:[0,0,0] op_sel_hi:[1,0,1]
  s_waitcnt lgkmcnt(5)
  s_add_u32 s34, s34, 4096
  buffer_load_dwordx4 a[64:67], v2, s[52:55], s34 offen offset:0 sc1
  v_pk_fma_f32 v[96:97], v[94:95], v[36:37], v[96:97] op_sel:[1,1,0] op_sel_hi:[0,1,1] neg_lo:[0,1,0]
  v_pk_fma_f32 v[96:97], v[94:95], v[36:37], v[96:97] op_sel:[0,0,0] op_sel_hi:[1,0,1]
  v_pk_fma_f32 v[98:99], v[96:97], v[36:37], v[98:99] op_sel:[1,1,0] op_sel_hi:[0,1,1] neg_lo:[0,1,0]
  v_pk_fma_f32 v[98:99], v[96:97], v[36:37], v[98:99] op_sel:[0,0,0] op_sel_hi:[1,0,1]
  s_waitcnt lgkmcnt(4)
  v_pk_fma_f32 v[100:101], v[98:99], v[36:37], v[100:101] op_sel:[1,1,0] op_sel_hi:[0,1,1] neg_lo:[0,1,0]
  buffer_load_dwordx4 a[68:71], v2, s[52:55], s34 offen offset:1024 sc1
  v_pk_fma_f32 v[100:101], v[98:99], v[36:37], v[100:101] op_sel:[0,0,0] op_sel_hi:[1,0,1]
  v_pk_fma_f32 v[102:103], v[100:101], v[36:37], v[102:103] op_sel:[1,1,0] op_sel_hi:[0,1,1] neg_lo:[0,1,0]
  v_pk_fma_f32 v[102:103], v[100:101], v[36:37], v[102:103] op_sel:[0,0,0] op_sel_hi:[1,0,1]
  s_waitcnt lgkmcnt(3)
  v_pk_fma_f32 v[104:105], v[102:103], v[36:37], v[104:105] op_sel:[1,1,0] op_sel_hi:[0,1,1] neg_lo:[0,1,0]
  v_pk_fma_f32 v[104:105], v[102:103], v[36:37], v[104:105] op_sel:[0,0,0] op_sel_hi:[1,0,1]
  buffer_load_dwordx4 a[72:75], v2, s[52:55], s34 offen offset:2048 sc1
  v_pk_fma_f32 v[106:107], v[104:105], v[36:37], v[106:107] op_sel:[1,1,0] op_sel_hi:[0,1,1] neg_lo:[0,1,0]
  v_pk_fma_f32 v[106:107], v[104:105], v[36:37], v[106:107] op_sel:[0,0,0] op_sel_hi:[1,0,1]
  s_waitcnt lgkmcnt(2)
  v_pk_fma_f32 v[108:109], v[106:107], v[36:37], v[108:109] op_sel:[1,1,0] op_sel_hi:[0,1,1] neg_lo:[0,1,0]
  v_pk_fma_f32 v[108:109], v[106:107], v[36:37], v[108:109] op_sel:[0,0,0] op_sel_hi:[1,0,1]
  v_pk_fma_f32 v[110:111], v[108:109], v[36:37], v[110:111] op_sel:[1,1,0] op_sel_hi:[0,1,1] neg_lo:[0,1,0]
  buffer_load_dwordx4 a[76:79], v2, s[52:55], s34 offen offset:3072 sc1
  v_pk_fma_f32 v[110:111], v[108:109], v[36:37], v[110:111] op_sel:[0,0,0] op_sel_hi:[1,0,1]
  s_waitcnt lgkmcnt(1)
  v_pk_fma_f32 v[112:113], v[110:111], v[36:37], v[112:113] op_sel:[1,1,0] op_sel_hi:[0,1,1] neg_lo:[0,1,0]
  v_pk_fma_f32 v[112:113], v[110:111], v[36:37], v[112:113] op_sel:[0,0,0] op_sel_hi:[1,0,1]
  v_pk_fma_f32 v[114:115], v[112:113], v[36:37], v[114:115] op_sel:[1,1,0] op_sel_hi:[0,1,1] neg_lo:[0,1,0]
  v_pk_fma_f32 v[114:115], v[112:113], v[36:37], v[114:115] op_sel:[0,0,0] op_sel_hi:[1,0,1]
  s_waitcnt lgkmcnt(0)
  v_pk_fma_f32 v[116:117], v[114:115], v[36:37], v[116:117] op_sel:[1,1,0] op_sel_hi:[0,1,1] neg_lo:[0,1,0]
  v_pk_fma_f32 v[116:117], v[114:115], v[36:37], v[116:117] op_sel:[0,0,0] op_sel_hi:[1,0,1]
  v_pk_fma_f32 v[118:119], v[116:117], v[36:37], v[118:119] op_sel:[1,1,0] op_sel_hi:[0,1,1] neg_lo:[0,1,0]
  v_pk_fma_f32 v[118:119], v[116:117], v[36:37], v[118:119] op_sel:[0,0,0] op_sel_hi:[1,0,1]
  v_mov_b32 v120, s8
  v_mov_b32 v121, s8
  s_add_u32 s12, s83, 10240
  s_mov_b64 exec, s[96:97]
  buffer_store_dwordx4 v[118:121], v2, s[52:55], s12 offen sc1
  s_mov_b64 exec, -1
  v_accvgpr_read_b32 v232, a200
  v_accvgpr_read_b32 v236, a201
  v_accvgpr_read_b32 v240, a202
  v_accvgpr_read_b32 v241, a203
  v_add_u32 v233, 1024, v232
  v_add_u32 v234, 2048, v232
  v_add_u32 v235, 3072, v232
  v_add_u32 v237, 1024, v236
  v_add_u32 v238, 2048, v236
  v_add_u32 v239, 3072, v236
  ds_read2_b32 v[156:157], v235 offset0:128 offset1:129
  ds_read2_b32 v[158:159], v235 offset0:130 offset1:131
  ds_read_b128 v[160:163], v240 offset:3584
  ds_read2_b32 v[152:153], v235 offset0:0 offset1:1
  ds_read2_b32 v[154:155], v235 offset0:2 offset1:3
  ds_read_b128 v[164:167], v240 offset:3072
  ds_read2_b32 v[148:149], v234 offset0:128 offset1:129
  ds_read2_b32 v[150:151], v234 offset0:130 offset1:131
  s_waitcnt lgkmcnt(5)
  v_mfma_f32_16x16x32_bf16 v[220:223], v[156:159], v[160:163], 0
  ds_read_b128 v[168:171], v240 offset:2560
  s_waitcnt lgkmcnt(4)
  v_mfma_f32_16x16x32_bf16 v[216:219], v[152:155], v[160:163], 0
  ds_read2_b32 v[144:145], v234 offset0:0 offset1:1
  ds_read2_b32 v[146:147], v234 offset0:2 offset1:3
  s_waitcnt lgkmcnt(5)
  v_mfma_f32_16x16x32_bf16 v[220:223], v[152:155], v[164:167], v[220:223]
  ds_read_b128 v[172:175], v240 offset:2048
  s_waitcnt lgkmcnt(4)
  v_mfma_f32_16x16x32_bf16 v[212:215], v[148:151], v[160:163], 0
  ds_read2_b32 v[140:141], v233 offset0:128 offset1:129
  ds_read2_b32 v[142:143], v233 offset0:130 offset1:131
  v_subrev_u32 v46, 8576, v46
  ds_write_b64 v46, v[42:43] offset:8
  ds_write_b128 v46, v[88:91] offset:16
  s_add_u32 s34, s34, 4096
  buffer_load_dwordx4 a[80:83], v2, s[52:55], s34 offen offset:0 sc1
  s_add_u32 m0, s48, 0
  s_nop 0
  buffer_load_dwordx4 v224, s[68:71], s20 offen lds
  v_mfma_f32_16x16x32_bf16 v[216:219], v[148:151], v[164:167], v[216:219]
  ds_read_b128 v[176:179], v240 offset:1536
  s_waitcnt lgkmcnt(8)
  v_mfma_f32_16x16x32_bf16 v[220:223], v[148:151], v[168:171], v[220:223]
  ds_read2_b32 v[136:137], v233 offset0:0 offset1:1
  ds_read2_b32 v[138:139], v233 offset0:2 offset1:3
  s_waitcnt lgkmcnt(8)
  v_mfma_f32_16x16x32_bf16 v[208:211], v[144:147], v[160:163], 0
  ds_read_b128 v[180:183], v240 offset:1024
  v_mfma_f32_16x16x32_bf16 v[212:215], v[144:147], v[164:167], v[212:215]
  ds_read2_b32 v[132:133], v232 offset0:128 offset1:129
  ds_read2_b32 v[134:135], v232 offset0:130 offset1:131
  ds_write_b128 v46, v[92:95] offset:32
  ds_write_b128 v46, v[96:99] offset:48
  ds_write_b128 v46, v[100:103] offset:64
  buffer_load_dwordx4 a[84:87], v2, s[52:55], s34 offen offset:1024 sc1
  s_add_u32 m0, s48, 1024
  s_nop 0
  buffer_load_dwordx4 v225, s[68:71], s20 offen lds
  v_mfma_f32_16x16x32_bf16 v[216:219], v[144:147], v[168:171], v[216:219]
  ds_write_b128 v46, v[104:107] offset:80
  ds_write_b128 v46, v[108:111] offset:96
  s_waitcnt lgkmcnt(15)
  v_mfma_f32_16x16x32_bf16 v[220:223], v[144:147], v[172:175], v[220:223]
  ds_write_b128 v46, v[112:115] offset:112
  s_waitcnt lgkmcnt(14)
  v_mfma_f32_16x16x32_bf16 v[204:207], v[140:143], v[160:163], 0
  buffer_load_dwordx4 a[88:91], v2, s[52:55], s34 offen offset:2048 sc1
  v_mfma_f32_16x16x32_bf16 v[208:211], v[140:143], v[164:167], v[208:211]
  s_add_u32 m0, s48, 2048
  s_mov_b32 exec_hi, 0
  buffer_load_dwordx4 v226, s[68:71], s20 offen lds
  s_mov_b32 exec_hi, -1
  v_mfma_f32_16x16x32_bf16 v[212:215], v[140:143], v[168:171], v[212:215]
  ds_write_b128 v46, v[116:119] offset:128
  v_mfma_f32_16x16x32_bf16 v[216:219], v[140:143], v[172:175], v[216:219]
  ds_read_b128 v[184:187], v240 offset:512
  s_waitcnt lgkmcnt(13)
  v_mfma_f32_16x16x32_bf16 v[220:223], v[140:143], v[176:179], v[220:223]
  ds_read2_b32 v[128:129], v232 offset0:0 offset1:1
  ds_read2_b32 v[130:131], v232 offset0:2 offset1:3
  s_waitcnt lgkmcnt(13)
  v_mfma_f32_16x16x32_bf16 v[200:203], v[136:139], v[160:163], 0
  v_add_u32 v46, 143752, v9
  ds_read_b32 v244, v46 offset:0
  buffer_load_dwordx4 a[92:95], v2, s[52:55], s34 offen offset:3072 sc1
  v_mfma_f32_16x16x32_bf16 v[204:207], v[136:139], v[164:167], v[204:207]
  ds_read_b32 v246, v46 offset:1152
  v_mfma_f32_16x16x32_bf16 v[208:211], v[136:139], v[168:171], v[208:211]
  ds_read_b32 v248, v46 offset:2304
  v_mfma_f32_16x16x32_bf16 v[212:215], v[136:139], v[172:175], v[212:215]
  ds_read_b32 v250, v46 offset:3456
  v_mfma_f32_16x16x32_bf16 v[216:219], v[136:139], v[176:179], v[216:219]
  s_waitcnt lgkmcnt(15)
  v_mfma_f32_16x16x32_bf16 v[220:223], v[136:139], v[180:183], v[220:223]
  ds_read_b32 v252, v46 offset:4608
  s_waitcnt lgkmcnt(15)
  v_mfma_f32_16x16x32_bf16 v[196:199], v[132:135], v[160:163], 0
  ds_read_b128 v[188:191], v240 offset:0
  v_mfma_f32_16x16x32_bf16 v[200:203], v[132:135], v[164:167], v[200:203]
  ds_read2_b32 v[156:157], v235 offset0:144 offset1:145
  ds_read2_b32 v[158:159], v235 offset0:146 offset1:147
  v_mfma_f32_16x16x32_bf16 v[204:207], v[132:135], v[168:171], v[204:207]
  ds_read2_b32 v[152:153], v235 offset0:16 offset1:17
  ds_read2_b32 v[154:155], v235 offset0:18 offset1:19
  v_and_b32 v43, 1, v3
  v_cvt_f32_u32_e64 v43, v43
  s_add_u32 s34, s34, 4096
  buffer_load_dwordx4 a[96:99], v2, s[52:55], s34 offen offset:0 sc1
  v_mfma_f32_16x16x32_bf16 v[208:211], v[132:135], v[172:175], v[208:211]
  v_fma_f32 v43, 2.0, v43, -1.0
  v_mfma_f32_16x16x32_bf16 v[212:215], v[132:135], v[176:179], v[212:215]
  ds_read2_b32 v[148:149], v234 offset0:144 offset1:145
  ds_read2_b32 v[150:151], v234 offset0:146 offset1:147
  v_mfma_f32_16x16x32_bf16 v[216:219], v[132:135], v[180:183], v[216:219]
  s_waitcnt lgkmcnt(7)
  v_mul_f32_dpp v245, v244, v43 quad_perm:[1,0,3,2] row_mask:0xf bank_mask:0xf
  v_mfma_f32_16x16x32_bf16 v[220:223], v[132:135], v[184:187], v[220:223]
  buffer_load_dwordx4 a[100:103], v2, s[52:55], s34 offen offset:1024 sc1
  v_mfma_f32_16x16x32_bf16 v[192:195], v[128:131], v[160:163], 0
  ds_read_b128 v[160:163], v240 offset:3648
  v_mfma_f32_16x16x32_bf16 v[196:199], v[128:131], v[164:167], v[196:199]
  ds_read2_b32 v[144:145], v234 offset0:16 offset1:17
  ds_read2_b32 v[146:147], v234 offset0:18 offset1:19
  v_mfma_f32_16x16x32_bf16 v[200:203], v[128:131], v[168:171], v[200:203]
  ds_read_b128 v[164:167], v240 offset:3136
  v_mfma_f32_16x16x32_bf16 v[204:207], v[128:131], v[172:175], v[204:207]
  ds_read_b128 v[168:171], v240 offset:2624
  v_mul_f32_dpp v247, v246, v43 quad_perm:[1,0,3,2] row_mask:0xf bank_mask:0xf
  v_mul_f32_dpp v249, v248, v43 quad_perm:[1,0,3,2] row_mask:0xf bank_mask:0xf
  v_mul_f32_dpp v251, v250, v43 quad_perm:[1,0,3,2] row_mask:0xf bank_mask:0xf
  buffer_load_dwordx4 a[104:107], v2, s[52:55], s34 offen offset:2048 sc1
  v_mfma_f32_16x16x32_bf16 v[208:211], v[128:131], v[176:179], v[208:211]
  ds_read_b128 v[172:175], v240 offset:2112
  v_mfma_f32_16x16x32_bf16 v[212:215], v[128:131], v[180:183], v[212:215]
  ds_read2_b32 v[140:141], v233 offset0:144 offset1:145
  ds_read2_b32 v[142:143], v233 offset0:146 offset1:147
  v_mfma_f32_16x16x32_bf16 v[216:219], v[128:131], v[184:187], v[216:219]
  v_mul_f32_dpp v253, v252, v43 quad_perm:[1,0,3,2] row_mask:0xf bank_mask:0xf
  s_waitcnt lgkmcnt(14)
  v_mfma_f32_16x16x32_bf16 v[220:223], v[128:131], v[188:191], v[220:223]
  s_waitcnt lgkmcnt(7)
  v_mfma_f32_16x16x32_bf16 v[220:223], v[156:159], v[160:163], v[220:223]
  ds_read_b128 v[176:179], v240 offset:1600
  v_mfma_f32_16x16x32_bf16 v[216:219], v[152:155], v[160:163], v[216:219]
  ds_read2_b32 v[136:137], v233 offset0:16 offset1:17
  ds_read2_b32 v[138:139], v233 offset0:18 offset1:19
  s_waitcnt lgkmcnt(7)
  v_mfma_f32_16x16x32_bf16 v[220:223], v[152:155], v[164:167], v[220:223]
  buffer_load_dwordx4 a[108:111], v2, s[52:55], s34 offen offset:3072 sc1
  v_mfma_f32_16x16x32_bf16 v[212:215], v[148:151], v[160:163], v[212:215]
  v_mfma_f32_16x16x32_bf16 v[216:219], v[148:151], v[164:167], v[216:219]
  s_add_u32 s34, s34, 4096
  buffer_load_dwordx4 a[112:115], v2, s[52:55], s34 offen offset:0 sc1
  s_waitcnt lgkmcnt(6)
  v_mfma_f32_16x16x32_bf16 v[220:223], v[148:151], v[168:171], v[220:223]
  s_and_b32 vcc_lo, s1, 7
  s_lshl_b32 vcc_lo, vcc_lo, 2
  s_add_u32 vcc_lo, vcc_lo, s7
  s_lshl_b32 vcc_lo, vcc_lo, 11
  v_lshl_add_u32 v15, v3, 7, vcc_lo
  v_min_u32 v15, L_codeend-L_pc-4, v15
  s_mov_b64 exec, 0xffff
  global_load_dword a250, v15, s[98:99]
  s_mov_b64 exec, -1
  v_mfma_f32_16x16x32_bf16 v[208:211], v[144:147], v[160:163], v[208:211]
  ds_read_b128 v[180:183], v240 offset:1088
  v_mfma_f32_16x16x32_bf16 v[212:215], v[144:147], v[164:167], v[212:215]
  ds_read2_b32 v[132:133], v232 offset0:144 offset1:145
  ds_read2_b32 v[134:135], v232 offset0:146 offset1:147
  v_mfma_f32_16x16x32_bf16 v[216:219], v[144:147], v[168:171], v[216:219]
  buffer_load_dwordx4 a[116:119], v2, s[52:55], s34 offen offset:1024 sc1
  s_waitcnt lgkmcnt(8)
  v_mfma_f32_16x16x32_bf16 v[220:223], v[144:147], v[172:175], v[220:223]
  s_waitcnt lgkmcnt(6)
  v_mfma_f32_16x16x32_bf16 v[204:207], v[140:143], v[160:163], v[204:207]
  v_mfma_f32_16x16x32_bf16 v[208:211], v[140:143], v[164:167], v[208:211]
  v_mfma_f32_16x16x32_bf16 v[212:215], v[140:143], v[168:171], v[212:215]
  v_mfma_f32_16x16x32_bf16 v[216:219], v[140:143], v[172:175], v[216:219]
  ds_read_b128 v[184:187], v240 offset:576
  s_waitcnt lgkmcnt(6)
  v_mfma_f32_16x16x32_bf16 v[220:223], v[140:143], v[176:179], v[220:223]
  ds_read2_b32 v[128:129], v232 offset0:16 offset1:17
  ds_read2_b32 v[130:131], v232 offset0:18 offset1:19
  s_waitcnt lgkmcnt(6)
  v_mfma_f32_16x16x32_bf16 v[200:203], v[136:139], v[160:163], v[200:203]
  v_mfma_f32_16x16x32_bf16 v[204:207], v[136:139], v[164:167], v[204:207]
  buffer_load_dwordx4 a[120:123], v2, s[52:55], s34 offen offset:2048 sc1
  v_mfma_f32_16x16x32_bf16 v[208:211], v[136:139], v[168:171], v[208:211]
  v_mfma_f32_16x16x32_bf16 v[212:215], v[136:139], v[172:175], v[212:215]
  v_mfma_f32_16x16x32_bf16 v[216:219], v[136:139], v[176:179], v[216:219]
  s_waitcnt lgkmcnt(5)
  v_mfma_f32_16x16x32_bf16 v[220:223], v[136:139], v[180:183], v[220:223]
  buffer_load_dwordx4 a[124:127], v2, s[52:55], s34 offen offset:3072 sc1
  s_waitcnt lgkmcnt(3)
  v_mfma_f32_16x16x32_bf16 v[196:199], v[132:135], v[160:163], v[196:199]
  ds_read_b128 v[188:191], v240 offset:64
  v_mfma_f32_16x16x32_bf16 v[200:203], v[132:135], v[164:167], v[200:203]
  ds_read2_b32 v[156:157], v235 offset0:160 offset1:161
  ds_read2_b32 v[158:159], v235 offset0:162 offset1:163
  v_mfma_f32_16x16x32_bf16 v[204:207], v[132:135], v[168:171], v[204:207]
  ds_read2_b32 v[152:153], v235 offset0:32 offset1:33
  ds_read2_b32 v[154:155], v235 offset0:34 offset1:35
  v_mfma_f32_16x16x32_bf16 v[208:211], v[132:135], v[172:175], v[208:211]
  s_add_u32 s34, s34, 4096
  buffer_load_dwordx4 a[128:131], v2, s[52:55], s34 offen offset:0 sc1
  v_mfma_f32_16x16x32_bf16 v[212:215], v[132:135], v[176:179], v[212:215]
  ds_read2_b32 v[148:149], v234 offset0:160 offset1:161
  ds_read2_b32 v[150:151], v234 offset0:162 offset1:163
  v_mfma_f32_16x16x32_bf16 v[216:219], v[132:135], v[180:183], v[216:219]
  s_waitcnt lgkmcnt(9)
  v_mfma_f32_16x16x32_bf16 v[220:223], v[132:135], v[184:187], v[220:223]
  s_waitcnt lgkmcnt(7)
  v_mfma_f32_16x16x32_bf16 v[192:195], v[128:131], v[160:163], v[192:195]
  ds_read_b128 v[160:163], v240 offset:3712
  v_mfma_f32_16x16x32_bf16 v[196:199], v[128:131], v[164:167], v[196:199]
  ds_read2_b32 v[144:145], v234 offset0:32 offset1:33
  ds_read2_b32 v[146:147], v234 offset0:34 offset1:35
  v_mfma_f32_16x16x32_bf16 v[200:203], v[128:131], v[168:171], v[200:203]
  ds_read_b128 v[164:167], v240 offset:3200
  v_mfma_f32_16x16x32_bf16 v[204:207], v[128:131], v[172:175], v[204:207]
  ds_read_b128 v[168:171], v240 offset:2688
  v_mfma_f32_16x16x32_bf16 v[208:211], v[128:131], v[176:179], v[208:211]
  ds_read_b128 v[172:175], v240 offset:2176
  v_mfma_f32_16x16x32_bf16 v[212:215], v[128:131], v[180:183], v[212:215]
  ds_read2_b32 v[140:141], v233 offset0:160 offset1:161
  ds_read2_b32 v[142:143], v233 offset0:162 offset1:163
  v_mfma_f32_16x16x32_bf16 v[216:219], v[128:131], v[184:187], v[216:219]
  buffer_load_dwordx4 a[132:135], v2, s[52:55], s34 offen offset:1024 sc1
  s_waitcnt lgkmcnt(14)
  v_mfma_f32_16x16x32_bf16 v[220:223], v[128:131], v[188:191], v[220:223]
  s_waitcnt lgkmcnt(7)
  v_mfma_f32_16x16x32_bf16 v[220:223], v[156:159], v[160:163], v[220:223]
  ds_read_b128 v[176:179], v240 offset:1664
  v_mfma_f32_16x16x32_bf16 v[216:219], v[152:155], v[160:163], v[216:219]
  ds_read2_b32 v[136:137], v233 offset0:32 offset1:33
  ds_read2_b32 v[138:139], v233 offset0:34 offset1:35
  s_waitcnt lgkmcnt(7)
  v_mfma_f32_16x16x32_bf16 v[220:223], v[152:155], v[164:167], v[220:223]
  buffer_load_dwordx4 a[136:139], v2, s[52:55], s34 offen offset:2048 sc1
  v_mfma_f32_16x16x32_bf16 v[212:215], v[148:151], v[160:163], v[212:215]
  v_mfma_f32_16x16x32_bf16 v[216:219], v[148:151], v[164:167], v[216:219]
  buffer_load_dwordx4 a[140:143], v2, s[52:55], s34 offen offset:3072 sc1
  s_waitcnt lgkmcnt(6)
  v_mfma_f32_16x16x32_bf16 v[220:223], v[148:151], v[168:171], v[220:223]
  v_mfma_f32_16x16x32_bf16 v[208:211], v[144:147], v[160:163], v[208:211]
  ds_read_b128 v[180:183], v240 offset:1152
  v_mfma_f32_16x16x32_bf16 v[212:215], v[144:147], v[164:167], v[212:215]
  ds_read2_b32 v[132:133], v232 offset0:160 offset1:161
  ds_read2_b32 v[134:135], v232 offset0:162 offset1:163
  v_mfma_f32_16x16x32_bf16 v[216:219], v[144:147], v[168:171], v[216:219]
  s_add_u32 s34, s34, 4096
  buffer_load_dwordx4 a[144:147], v2, s[52:55], s34 offen offset:0 sc1
  s_waitcnt vmcnt(14)
  s_waitcnt lgkmcnt(8)
  v_mfma_f32_16x16x32_bf16 v[220:223], v[144:147], v[172:175], v[220:223]
  ds_read_b64 a[216:217], v242 offset:0
  ds_read_b64 a[218:219], v242 offset:32
  s_waitcnt lgkmcnt(8)
  v_mfma_f32_16x16x32_bf16 v[204:207], v[140:143], v[160:163], v[204:207]
  ds_read_b64 a[220:221], v242 offset:64
  ds_read_b64 a[222:223], v242 offset:96
  v_mfma_f32_16x16x32_bf16 v[208:211], v[140:143], v[164:167], v[208:211]
  ds_read_b64 a[224:225], v242 offset:128
  v_mfma_f32_16x16x32_bf16 v[212:215], v[140:143], v[168:171], v[212:215]
  v_mfma_f32_16x16x32_bf16 v[216:219], v[140:143], v[172:175], v[216:219]
  ds_read_b128 v[184:187], v240 offset:640
  s_waitcnt lgkmcnt(11)
  v_mfma_f32_16x16x32_bf16 v[220:223], v[140:143], v[176:179], v[220:223]
  ds_read2_b32 v[128:129], v232 offset0:32 offset1:33
  ds_read2_b32 v[130:131], v232 offset0:34 offset1:35
  s_waitcnt lgkmcnt(11)
  v_mfma_f32_16x16x32_bf16 v[200:203], v[136:139], v[160:163], v[200:203]
  v_mfma_f32_16x16x32_bf16 v[204:207], v[136:139], v[164:167], v[204:207]
  buffer_load_dwordx4 a[148:151], v2, s[52:55], s34 offen offset:1024 sc1
  v_mfma_f32_16x16x32_bf16 v[208:211], v[136:139], v[168:171], v[208:211]
  v_mfma_f32_16x16x32_bf16 v[212:215], v[136:139], v[172:175], v[212:215]
  v_mfma_f32_16x16x32_bf16 v[216:219], v[136:139], v[176:179], v[216:219]
  s_waitcnt lgkmcnt(10)
  v_mfma_f32_16x16x32_bf16 v[220:223], v[136:139], v[180:183], v[220:223]
  buffer_load_dwordx4 a[152:155], v2, s[52:55], s34 offen offset:2048 sc1
  s_waitcnt lgkmcnt(8)
  v_mfma_f32_16x16x32_bf16 v[196:199], v[132:135], v[160:163], v[196:199]
  ds_read_b128 v[188:191], v240 offset:128
  v_mfma_f32_16x16x32_bf16 v[200:203], v[132:135], v[164:167], v[200:203]
  ds_read2_b32 v[156:157], v235 offset0:176 offset1:177
  ds_read2_b32 v[158:159], v235 offset0:178 offset1:179
  v_mfma_f32_16x16x32_bf16 v[204:207], v[132:135], v[168:171], v[204:207]
  ds_read2_b32 v[152:153], v235 offset0:48 offset1:49
  ds_read2_b32 v[154:155], v235 offset0:50 offset1:51
  v_mfma_f32_16x16x32_bf16 v[208:211], v[132:135], v[172:175], v[208:211]
  buffer_load_dwordx4 a[156:159], v2, s[52:55], s34 offen offset:3072 sc1
  v_mfma_f32_16x16x32_bf16 v[212:215], v[132:135], v[176:179], v[212:215]
  ds_read2_b32 v[148:149], v234 offset0:176 offset1:177
  ds_read2_b32 v[150:151], v234 offset0:178 offset1:179
  v_mfma_f32_16x16x32_bf16 v[216:219], v[132:135], v[180:183], v[216:219]
  s_waitcnt lgkmcnt(9)
  v_mfma_f32_16x16x32_bf16 v[220:223], v[132:135], v[184:187], v[220:223]
  s_waitcnt lgkmcnt(7)
  v_mfma_f32_16x16x32_bf16 v[192:195], v[128:131], v[160:163], v[192:195]
  ds_read_b128 v[160:163], v240 offset:3776
  v_mfma_f32_16x16x32_bf16 v[196:199], v[128:131], v[164:167], v[196:199]
  ds_read2_b32 v[144:145], v234 offset0:48 offset1:49
  ds_read2_b32 v[146:147], v234 offset0:50 offset1:51
  v_mfma_f32_16x16x32_bf16 v[200:203], v[128:131], v[168:171], v[200:203]
  ds_read_b128 v[164:167], v240 offset:3264
  v_mfma_f32_16x16x32_bf16 v[204:207], v[128:131], v[172:175], v[204:207]
  ds_read_b128 v[168:171], v240 offset:2752
  v_mfma_f32_16x16x32_bf16 v[208:211], v[128:131], v[176:179], v[208:211]
  ds_read_b128 v[172:175], v240 offset:2240
  v_mfma_f32_16x16x32_bf16 v[212:215], v[128:131], v[180:183], v[212:215]
  ds_read2_b32 v[140:141], v233 offset0:176 offset1:177
  ds_read2_b32 v[142:143], v233 offset0:178 offset1:179
  v_mfma_f32_16x16x32_bf16 v[216:219], v[128:131], v[184:187], v[216:219]
  s_add_u32 s34, s34, 4096
  buffer_load_dwordx4 a[160:163], v2, s[52:55], s34 offen offset:0 sc1
  s_waitcnt lgkmcnt(14)
  v_mfma_f32_16x16x32_bf16 v[220:223], v[128:131], v[188:191], v[220:223]
  s_waitcnt lgkmcnt(7)
  v_mfma_f32_16x16x32_bf16 v[220:223], v[156:159], v[160:163], v[220:223]
  ds_read_b128 v[176:179], v240 offset:1728
  v_mfma_f32_16x16x32_bf16 v[216:219], v[152:155], v[160:163], v[216:219]
  ds_read2_b32 v[136:137], v233 offset0:48 offset1:49
  ds_read2_b32 v[138:139], v233 offset0:50 offset1:51
  s_waitcnt lgkmcnt(7)
  v_mfma_f32_16x16x32_bf16 v[220:223], v[152:155], v[164:167], v[220:223]
  buffer_load_dwordx4 a[164:167], v2, s[52:55], s34 offen offset:1024 sc1
  v_mfma_f32_16x16x32_bf16 v[212:215], v[148:151], v[160:163], v[212:215]
  v_mfma_f32_16x16x32_bf16 v[216:219], v[148:151], v[164:167], v[216:219]
  buffer_load_dwordx4 a[168:171], v2, s[52:55], s34 offen offset:2048 sc1
  s_waitcnt lgkmcnt(6)
  v_mfma_f32_16x16x32_bf16 v[220:223], v[148:151], v[168:171], v[220:223]
  v_mfma_f32_16x16x32_bf16 v[208:211], v[144:147], v[160:163], v[208:211]
  ds_read_b128 v[180:183], v240 offset:1216
  v_mfma_f32_16x16x32_bf16 v[212:215], v[144:147], v[164:167], v[212:215]
  ds_read2_b32 v[132:133], v232 offset0:176 offset1:177
  ds_read2_b32 v[134:135], v232 offset0:178 offset1:179
  v_mfma_f32_16x16x32_bf16 v[216:219], v[144:147], v[168:171], v[216:219]
  s_lshl_b32 s90, s7, 2
  s_waitcnt lgkmcnt(8)
  v_mfma_f32_16x16x32_bf16 v[220:223], v[144:147], v[172:175], v[220:223]
  s_sub_u32 s90, 12, s90
  s_waitcnt lgkmcnt(6)
  v_mfma_f32_16x16x32_bf16 v[204:207], v[140:143], v[160:163], v[204:207]
  s_mul_i32 s90, s90, 640
  v_mfma_f32_16x16x32_bf16 v[208:211], v[140:143], v[164:167], v[208:211]
  s_add_u32 s90, s90, s83
  v_mfma_f32_16x16x32_bf16 v[212:215], v[140:143], v[168:171], v[212:215]
  buffer_load_dwordx4 a[172:175], v2, s[52:55], s34 offen offset:3072 sc1
  v_mfma_f32_16x16x32_bf16 v[216:219], v[140:143], v[172:175], v[216:219]
  ds_read_b128 v[184:187], v240 offset:704
  s_waitcnt lgkmcnt(6)
  v_mfma_f32_16x16x32_bf16 v[220:223], v[140:143], v[176:179], v[220:223]
  ds_read2_b32 v[128:129], v232 offset0:48 offset1:49
  ds_read2_b32 v[130:131], v232 offset0:50 offset1:51
  s_waitcnt lgkmcnt(6)
  v_mfma_f32_16x16x32_bf16 v[200:203], v[136:139], v[160:163], v[200:203]
  s_add_u32 s90, s90, 0
  v_min_u32 v42, 39, v1
  v_lshlrev_b32_e64 v42, 4, v42
  v_mfma_f32_16x16x32_bf16 v[204:207], v[136:139], v[164:167], v[204:207]
  s_add_u32 s34, s34, 4096
  buffer_load_dwordx4 a[176:179], v2, s[52:55], s34 offen offset:0 sc1
  v_mfma_f32_16x16x32_bf16 v[208:211], v[136:139], v[168:171], v[208:211]
  buffer_load_dwordx3 v[88:90], v42, s[52:55], s90 offen offset:0 sc1
  v_mfma_f32_16x16x32_bf16 v[212:215], v[136:139], v[172:175], v[212:215]
  buffer_load_dwordx3 v[92:94], v42, s[52:55], s90 offen offset:640 sc1
  v_mfma_f32_16x16x32_bf16 v[216:219], v[136:139], v[176:179], v[216:219]
  s_waitcnt lgkmcnt(5)
  v_mfma_f32_16x16x32_bf16 v[220:223], v[136:139], v[180:183], v[220:223]
  buffer_load_dwordx4 a[180:183], v2, s[52:55], s34 offen offset:1024 sc1
  s_waitcnt lgkmcnt(3)
  v_mfma_f32_16x16x32_bf16 v[196:199], v[132:135], v[160:163], v[196:199]
  ds_read_b128 v[188:191], v240 offset:192
  v_mfma_f32_16x16x32_bf16 v[200:203], v[132:135], v[164:167], v[200:203]
  buffer_load_dwordx3 v[96:98], v42, s[52:55], s90 offen offset:1280 sc1
  v_mfma_f32_16x16x32_bf16 v[204:207], v[132:135], v[168:171], v[204:207]
  buffer_load_dwordx3 v[100:102], v42, s[52:55], s90 offen offset:1920 sc1
  v_mfma_f32_16x16x32_bf16 v[208:211], v[132:135], v[172:175], v[208:211]
  v_mfma_f32_16x16x32_bf16 v[212:215], v[132:135], v[176:179], v[212:215]
  v_mfma_f32_16x16x32_bf16 v[216:219], v[132:135], v[180:183], v[216:219]
  s_waitcnt lgkmcnt(3)
  v_mfma_f32_16x16x32_bf16 v[220:223], v[132:135], v[184:187], v[220:223]
  s_waitcnt lgkmcnt(1)
  v_mfma_f32_16x16x32_bf16 v[192:195], v[128:131], v[160:163], v[192:195]
  v_mfma_f32_16x16x32_bf16 v[196:199], v[128:131], v[164:167], v[196:199]
  v_mfma_f32_16x16x32_bf16 v[200:203], v[128:131], v[168:171], v[200:203]
  v_mfma_f32_16x16x32_bf16 v[204:207], v[128:131], v[172:175], v[204:207]
  v_mfma_f32_16x16x32_bf16 v[208:211], v[128:131], v[176:179], v[208:211]
  v_mfma_f32_16x16x32_bf16 v[212:215], v[128:131], v[180:183], v[212:215]
  v_mfma_f32_16x16x32_bf16 v[216:219], v[128:131], v[184:187], v[216:219]
  s_waitcnt lgkmcnt(0)
  v_mfma_f32_16x16x32_bf16 v[220:223], v[128:131], v[188:191], v[220:223]
  v_lshrrev_b32 v11, 1, v3
  v_mul_u32_u24 v12, 80, v11
  v_add_u32 v12, 160640, v12
  v_lshlrev_b32_e64 v11, 3, v11
  v_add_u32 v11, 158400, v11
  ds_read_b128 v[128:131], v12 offset:0
  ds_read_b128 v[132:135], v12 offset:16
  ds_read_b128 v[136:139], v12 offset:32
  ds_read_b128 v[140:143], v12 offset:48
  ds_read_b128 v[144:147], v12 offset:640
  ds_read_b128 v[148:151], v12 offset:656
  ds_read_b128 v[152:155], v12 offset:672
  ds_read_b128 v[156:159], v12 offset:688
  ds_read_b128 v[160:163], v12 offset:1280
  ds_read_b128 v[164:167], v12 offset:1296
  ds_read_b128 v[168:171], v12 offset:1312
  ds_read_b128 v[172:175], v12 offset:1328
  ds_read_b128 v[176:179], v12 offset:1920
  ds_read_b128 v[180:183], v12 offset:1936
  ds_read_b128 v[184:187], v12 offset:1952
  ds_read_b128 v[188:191], v12 offset:1968
  ds_read_b128 v[104:107], v12 offset:2560
  ds_read_b128 v[108:111], v12 offset:2576
  ds_read_b128 v[112:115], v12 offset:2592
  ds_read_b128 v[116:119], v12 offset:2608
  v_accvgpr_read_b32 v254, a240
  v_accvgpr_read_b32 v255, a241
  v_accvgpr_read_b32 v47, a242
  s_waitcnt vmcnt(0)
  v_min3_u32 v14, v90, v94, s8
  v_max3_u32 v15, v90, v94, s8
  v_min3_u32 v14, v14, v98, v102
  v_max3_u32 v15, v15, v98, v102
  v_cmp_ne_u32 vcc, v14, v15
  s_cbranch_vccz ok_26
again_25:
  buffer_load_dwordx3 v[88:90], v42, s[52:55], s90 offen offset:0 sc1
  buffer_load_dwordx3 v[92:94], v42, s[52:55], s90 offen offset:640 sc1
  buffer_load_dwordx3 v[96:98], v42, s[52:55], s90 offen offset:1280 sc1
  buffer_load_dwordx3 v[100:102], v42, s[52:55], s90 offen offset:1920 sc1
  s_sub_u32 s10, s10, 1
  s_cmp_gt_i32 s10, 0
  s_waitcnt vmcnt(0)
  v_min3_u32 v14, v90, v94, s8
  v_max3_u32 v15, v90, v94, s8
  v_min3_u32 v14, v14, v98, v102
  v_max3_u32 v15, v15, v98, v102
  v_cmp_ne_u32 vcc, v14, v15
  s_cbranch_scc0 out_27
  s_cbranch_vccnz again_25
out_27:
ok_26:
  v_pk_fma_f32 v[92:93], v[88:89], v[38:39], v[92:93] op_sel:[1,1,0] op_sel_hi:[0,1,1] neg_lo:[0,1,0]
  v_pk_fma_f32 v[92:93], v[88:89], v[38:39], v[92:93] op_sel:[0,0,0] op_sel_hi:[1,0,1]
  v_pk_fma_f32 v[96:97], v[92:93], v[38:39], v[96:97] op_sel:[1,1,0] op_sel_hi:[0,1,1] neg_lo:[0,1,0]
  v_pk_fma_f32 v[96:97], v[92:93], v[38:39], v[96:97] op_sel:[0,0,0] op_sel_hi:[1,0,1]
  v_pk_fma_f32 v[100:101], v[96:97], v[38:39], v[100:101] op_sel:[1,1,0] op_sel_hi:[0,1,1] neg_lo:[0,1,0]
  v_pk_fma_f32 v[100:101], v[96:97], v[38:39], v[100:101] op_sel:[0,0,0] op_sel_hi:[1,0,1]
  v_pk_mul_f32 v[88:89], v[100:101], v[40:41] op_sel:[1,1] op_sel_hi:[0,1] neg_lo:[0,1]
  v_pk_fma_f32 v[88:89], v[100:101], v[40:41], v[88:89] op_sel:[0,0,0] op_sel_hi:[1,0,1]
  s_mov_b32 exec_hi, 0xff
  ds_add_f32 v44, v88
  ds_add_f32 v44, v89 offset:4
  s_mov_b32 exec_hi, -1
  s_waitcnt lgkmcnt(0)
  s_barrier
  ds_read_b64 v[88:89], v11 offset:0
  ds_read_b64 v[90:91], v11 offset:64
  ds_read_b64 v[92:93], v11 offset:128
  ds_read_b64 v[94:95], v11 offset:192
  ds_read_b64 v[96:97], v11 offset:256
  s_waitcnt lgkmcnt(4)
  v_pk_fma_f32 v[244:245], v[26:27], v[88:89], v[244:245] op_sel:[0,0,0] op_sel_hi:[1,0,1]
  v_pk_fma_f32 v[244:245], v[26:27], v[88:89], v[244:245] op_sel:[1,1,0] op_sel_hi:[0,1,1] neg_hi:[1,0,0]
  s_waitcnt lgkmcnt(3)
  v_pk_fma_f32 v[246:247], v[28:29], v[90:91], v[246:247] op_sel:[0,0,0] op_sel_hi:[1,0,1]
  v_pk_fma_f32 v[246:247], v[28:29], v[90:91], v[246:247] op_sel:[1,1,0] op_sel_hi:[0,1,1] neg_hi:[1,0,0]
  v_pk_fma_f32 v[48:49], v[128:129], v[244:245], v[48:49] op_sel:[0,0,0] op_sel_hi:[1,0,1]
  v_pk_fma_f32 v[50:51], v[130:131], v[244:245], v[50:51] op_sel:[0,0,0] op_sel_hi:[1,0,1]
  v_pk_fma_f32 v[52:53], v[132:133], v[244:245], v[52:53] op_sel:[0,0,0] op_sel_hi:[1,0,1]
  v_pk_fma_f32 v[54:55], v[134:135], v[244:245], v[54:55] op_sel:[0,0,0] op_sel_hi:[1,0,1]
  v_pk_fma_f32 v[48:49], v[136:137], v[244:245], v[48:49] op_sel:[0,1,0] op_sel_hi:[1,1,1]
  v_pk_fma_f32 v[50:51], v[138:139], v[244:245], v[50:51] op_sel:[0,1,0] op_sel_hi:[1,1,1]
  v_pk_fma_f32 v[52:53], v[140:141], v[244:245], v[52:53] op_sel:[0,1,0] op_sel_hi:[1,1,1]
  v_pk_fma_f32 v[54:55], v[142:143], v[244:245], v[54:55] op_sel:[0,1,0] op_sel_hi:[1,1,1]
  v_cvt_pk_bf16_f32 v98, v48, v49
  v_cvt_pk_bf16_f32 v99, v50, v51
  v_cvt_pk_bf16_f32 v100, v52, v53
  v_cvt_pk_bf16_f32 v101, v54, v55
  ds_write_b128 v254, v[98:101]
  ds_read_b64_tr_b16 v[52:53], v255
  ds_read_b64_tr_b16 v[54:55], v255 offset:640
  s_waitcnt lgkmcnt(5)
  v_pk_fma_f32 v[248:249], v[30:31], v[92:93], v[248:249] op_sel:[0,0,0] op_sel_hi:[1,0,1]
  v_pk_fma_f32 v[248:249], v[30:31], v[92:93], v[248:249] op_sel:[1,1,0] op_sel_hi:[0,1,1] neg_hi:[1,0,0]
  v_pk_fma_f32 v[56:57], v[144:145], v[246:247], v[56:57] op_sel:[0,0,0] op_sel_hi:[1,0,1]
  v_pk_fma_f32 v[58:59], v[146:147], v[246:247], v[58:59] op_sel:[0,0,0] op_sel_hi:[1,0,1]
  v_pk_fma_f32 v[60:61], v[148:149], v[246:247], v[60:61] op_sel:[0,0,0] op_sel_hi:[1,0,1]
  v_pk_fma_f32 v[62:63], v[150:151], v[246:247], v[62:63] op_sel:[0,0,0] op_sel_hi:[1,0,1]
  v_pk_fma_f32 v[56:57], v[152:153], v[246:247], v[56:57] op_sel:[0,1,0] op_sel_hi:[1,1,1]
  v_pk_fma_f32 v[58:59], v[154:155], v[246:247], v[58:59] op_sel:[0,1,0] op_sel_hi:[1,1,1]
  v_pk_fma_f32 v[60:61], v[156:157], v[246:247], v[60:61] op_sel:[0,1,0] op_sel_hi:[1,1,1]
  v_pk_fma_f32 v[62:63], v[158:159], v[246:247], v[62:63] op_sel:[0,1,0] op_sel_hi:[1,1,1]
  v_cvt_pk_bf16_f32 v120, v56, v57
  v_cvt_pk_bf16_f32 v121, v58, v59
  v_cvt_pk_bf16_f32 v122, v60, v61
  v_cvt_pk_bf16_f32 v123, v62, v63
  ds_write_b128 v254, v[120:123]
  ds_read_b64_tr_b16 v[60:61], v255
  ds_read_b64_tr_b16 v[62:63], v255 offset:640
  s_waitcnt lgkmcnt(7)
  v_pk_fma_f32 v[250:251], v[32:33], v[94:95], v[250:251] op_sel:[0,0,0] op_sel_hi:[1,0,1]
  v_pk_fma_f32 v[250:251], v[32:33], v[94:95], v[250:251] op_sel:[1,1,0] op_sel_hi:[0,1,1] neg_hi:[1,0,0]
  v_pk_fma_f32 v[64:65], v[160:161], v[248:249], v[64:65] op_sel:[0,0,0] op_sel_hi:[1,0,1]
  v_pk_fma_f32 v[66:67], v[162:163], v[248:249], v[66:67] op_sel:[0,0,0] op_sel_hi:[1,0,1]
  v_pk_fma_f32 v[68:69], v[164:165], v[248:249], v[68:69] op_sel:[0,0,0] op_sel_hi:[1,0,1]
  v_pk_fma_f32 v[70:71], v[166:167], v[248:249], v[70:71] op_sel:[0,0,0] op_sel_hi:[1,0,1]
  v_pk_fma_f32 v[64:65], v[168:169], v[248:249], v[64:65] op_sel:[0,1,0] op_sel_hi:[1,1,1]
  v_pk_fma_f32 v[66:67], v[170:171], v[248:249], v[66:67] op_sel:[0,1,0] op_sel_hi:[1,1,1]
  v_pk_fma_f32 v[68:69], v[172:173], v[248:249], v[68:69] op_sel:[0,1,0] op_sel_hi:[1,1,1]
  v_pk_fma_f32 v[70:71], v[174:175], v[248:249], v[70:71] op_sel:[0,1,0] op_sel_hi:[1,1,1]
  v_cvt_pk_bf16_f32 v98, v64, v65
  v_cvt_pk_bf16_f32 v99, v66, v67
  v_cvt_pk_bf16_f32 v100, v68, v69
  v_cvt_pk_bf16_f32 v101, v70, v71
  ds_write_b128 v254, v[98:101]
  ds_read_b64_tr_b16 v[68:69], v255
  ds_read_b64_tr_b16 v[70:71], v255 offset:640
  s_waitcnt lgkmcnt(9)
  v_pk_fma_f32 v[252:253], v[34:35], v[96:97], v[252:253] op_sel:[0,0,0] op_sel_hi:[1,0,1]
  v_pk_fma_f32 v[252:253], v[34:35], v[96:97], v[252:253] op_sel:[1,1,0] op_sel_hi:[0,1,1] neg_hi:[1,0,0]
  s_add_u32 s13, s78, 10485760
  s_waitcnt lgkmcnt(6)
  s_cmp_eq_u32 s9, 0
  s_cbranch_scc1 slow_28
  buffer_store_dwordx4 v[52:55], v47, s[52:55], s13 offen
back_29:
  v_pk_fma_f32 v[72:73], v[176:177], v[250:251], v[72:73] op_sel:[0,0,0] op_sel_hi:[1,0,1]
  v_pk_fma_f32 v[74:75], v[178:179], v[250:251], v[74:75] op_sel:[0,0,0] op_sel_hi:[1,0,1]
  v_pk_fma_f32 v[76:77], v[180:181], v[250:251], v[76:77] op_sel:[0,0,0] op_sel_hi:[1,0,1]
  v_pk_fma_f32 v[78:79], v[182:183], v[250:251], v[78:79] op_sel:[0,0,0] op_sel_hi:[1,0,1]
  v_pk_fma_f32 v[72:73], v[184:185], v[250:251], v[72:73] op_sel:[0,1,0] op_sel_hi:[1,1,1]
  v_pk_fma_f32 v[74:75], v[186:187], v[250:251], v[74:75] op_sel:[0,1,0] op_sel_hi:[1,1,1]
  v_pk_fma_f32 v[76:77], v[188:189], v[250:251], v[76:77] op_sel:[0,1,0] op_sel_hi:[1,1,1]
  v_pk_fma_f32 v[78:79], v[190:191], v[250:251], v[78:79] op_sel:[0,1,0] op_sel_hi:[1,1,1]
  v_cvt_pk_bf16_f32 v120, v72, v73
  v_cvt_pk_bf16_f32 v121, v74, v75
  v_cvt_pk_bf16_f32 v122, v76, v77
  v_cvt_pk_bf16_f32 v123, v78, v79
  ds_write_b128 v254, v[120:123]
  ds_read_b64_tr_b16 v[76:77], v255
  ds_read_b64_tr_b16 v[78:79], v255 offset:640
  s_add_u32 s13, s79, 10485760
  s_waitcnt lgkmcnt(6)
  s_cmp_eq_u32 s9, 0
  s_cbranch_scc1 slow_30
  buffer_store_dwordx4 v[60:63], v47, s[52:55], s13 offen
back_31:
  v_pk_fma_f32 v[80:81], v[104:105], v[252:253], v[80:81] op_sel:[0,0,0] op_sel_hi:[1,0,1]
  v_pk_fma_f32 v[82:83], v[106:107], v[252:253], v[82:83] op_sel:[0,0,0] op_sel_hi:[1,0,1]
  v_pk_fma_f32 v[84:85], v[108:109], v[252:253], v[84:85] op_sel:[0,0,0] op_sel_hi:[1,0,1]
  v_pk_fma_f32 v[86:87], v[110:111], v[252:253], v[86:87] op_sel:[0,0,0] op_sel_hi:[1,0,1]
  v_pk_fma_f32 v[80:81], v[112:113], v[252:253], v[80:81] op_sel:[0,1,0] op_sel_hi:[1,1,1]
  v_pk_fma_f32 v[82:83], v[114:115], v[252:253], v[82:83] op_sel:[0,1,0] op_sel_hi:[1,1,1]
  v_pk_fma_f32 v[84:85], v[116:117], v[252:253], v[84:85] op_sel:[0,1,0] op_sel_hi:[1,1,1]
  v_pk_fma_f32 v[86:87], v[118:119], v[252:253], v[86:87] op_sel:[0,1,0] op_sel_hi:[1,1,1]
  v_cvt_pk_bf16_f32 v98, v80, v81
  v_cvt_pk_bf16_f32 v99, v82, v83
  v_cvt_pk_bf16_f32 v100, v84, v85
  v_cvt_pk_bf16_f32 v101, v86, v87
  ds_write_b128 v254, v[98:101]
  ds_read_b64_tr_b16 v[84:85], v255
  ds_read_b64_tr_b16 v[86:87], v255 offset:640
  s_add_u32 s13, s80, 10485760
  s_waitcnt lgkmcnt(6)
  s_cmp_eq_u32 s9, 0
  s_cbranch_scc1 slow_32
  buffer_store_dwordx4 v[68:71], v47, s[52:55], s13 offen
back_33:
  v_accvgpr_read_b32 v246, a204
  v_accvgpr_read_b32 v247, a205
  v_accvgpr_read_b32 v248, a206
  v_accvgpr_read_b32 v249, a207
  v_accvgpr_read_b32 v250, a208
  v_accvgpr_read_b32 v251, a209
  v_accvgpr_read_b32 v252, a210
  v_accvgpr_read_b32 v44, a211
  v_accvgpr_read_b32 v45, a212
  v_accvgpr_read_b32 v46, a213
  v_accvgpr_read_b32 v244, a214
  ds_read_b64 v[88:89], v247 offset:1536
  ds_read_b64 v[90:91], v247 offset:1024
  ds_read_b64 v[92:93], v247 offset:512
  ds_read_b64 v[94:95], v247 offset:0
  ds_read_b64 v[96:97], v248
  s_add_u32 s13, s81, 10485760
  s_waitcnt lgkmcnt(8)
  s_cmp_eq_u32 s9, 0
  s_cbranch_scc1 slow_34
  buffer_store_dwordx4 v[76:79], v47, s[52:55], s13 offen
back_35:
  s_add_u32 s13, s82, 10485760
  s_waitcnt lgkmcnt(5)
  s_cmp_eq_u32 s9, 0
  s_cbranch_scc1 slow_36
  buffer_store_dwordx4 v[84:87], v47, s[52:55], s13 offen
back_37:
  s_bitcmp1_b32 s7, 0
  s_cbranch_scc1 odd_38
  ds_write_b128 v249, v[208:211] offset:0
  ds_write_b128 v249, v[212:215] offset:1024
  ds_write_b128 v249, v[216:219] offset:2048
  ds_write_b128 v249, v[220:223] offset:3072
  s_branch join_39
odd_38:
  ds_write_b128 v249, v[192:195] offset:0
  ds_write_b128 v249, v[196:199] offset:1024
  ds_write_b128 v249, v[200:203] offset:2048
  ds_write_b128 v249, v[204:207] offset:3072
  v_pk_mov_b32 v[192:193], v[208:209], v[208:209] op_sel:[0,1]
  v_pk_mov_b32 v[194:195], v[210:211], v[210:211] op_sel:[0,1]
  v_pk_mov_b32 v[196:197], v[212:213], v[212:213] op_sel:[0,1]
  v_pk_mov_b32 v[198:199], v[214:215], v[214:215] op_sel:[0,1]
  v_pk_mov_b32 v[200:201], v[216:217], v[216:217] op_sel:[0,1]
  v_pk_mov_b32 v[202:203], v[218:219], v[218:219] op_sel:[0,1]
  v_pk_mov_b32 v[204:205], v[220:221], v[220:221] op_sel:[0,1]
  v_pk_mov_b32 v[206:207], v[222:223], v[222:223] op_sel:[0,1]
join_39:
  s_waitcnt lgkmcnt(4)
  v_dot2_f32_bf16 v192, v89, s31, v192
  v_dot2_f32_bf16 v193, v89, s30, v193
  v_dot2_f32_bf16 v194, v88, s31, v194
  v_dot2_f32_bf16 v195, v88, s30, v195
  v_dot2_f32_bf16 v196, v91, s31, v196
  v_dot2_f32_bf16 v197, v91, s30, v197
  v_dot2_f32_bf16 v198, v90, s31, v198
  v_dot2_f32_bf16 v199, v90, s30, v199
  v_dot2_f32_bf16 v200, v93, s31, v200
  v_dot2_f32_bf16 v201, v93, s30, v201
  v_dot2_f32_bf16 v202, v92, s31, v202
  v_dot2_f32_bf16 v203, v92, s30, v203
  v_dot2_f32_bf16 v204, v95, s31, v204
  v_dot2_f32_bf16 v205, v95, s30, v205
  v_dot2_f32_bf16 v206, v94, s31, v206
  v_dot2_f32_bf16 v207, v94, s30, v207
  s_bitcmp1_b32 s1, 0
  s_cbranch_scc1 type_40
  ds_read2_b32 v[156:157], v239 offset0:128 offset1:129
  ds_read2_b32 v[158:159], v239 offset0:130 offset1:131
  ds_read_b128 v[160:163], v241 offset:3584
  ds_read2_b32 v[152:153], v239 offset0:0 offset1:1
  ds_read2_b32 v[154:155], v239 offset0:2 offset1:3
  ds_read_b128 v[164:167], v241 offset:3072
  ds_read2_b32 v[148:149], v238 offset0:128 offset1:129
  ds_read2_b32 v[150:151], v238 offset0:130 offset1:131
  ds_read_b128 v[168:171], v241 offset:2560
  ds_read2_b32 v[144:145], v238 offset0:0 offset1:1
  ds_read2_b32 v[146:147], v238 offset0:2 offset1:3
  s_waitcnt lgkmcnt(8)
  v_mfma_f32_16x16x32_bf16 v[116:119], v[156:159], v[160:163], 0
  ds_read_b128 v[172:175], v241 offset:2048
  s_waitcnt lgkmcnt(6)
  v_mfma_f32_16x16x32_bf16 v[116:119], v[152:155], v[164:167], v[116:119]
  ds_read2_b32 v[140:141], v237 offset0:128 offset1:129
  ds_read2_b32 v[142:143], v237 offset0:130 offset1:131
  s_waitcnt lgkmcnt(5)
  v_mfma_f32_16x16x32_bf16 v[116:119], v[148:151], v[168:171], v[116:119]
  ds_read_b128 v[176:179], v241 offset:1536
  s_waitcnt lgkmcnt(4)
  v_mfma_f32_16x16x32_bf16 v[112:115], v[144:147], v[160:163], 0
  ds_read2_b32 v[136:137], v237 offset0:0 offset1:1
  ds_read2_b32 v[138:139], v237 offset0:2 offset1:3
  buffer_load_dwordx4 a[184:187], v2, s[52:55], s34 offen offset:2048 sc1
  s_waitcnt lgkmcnt(5)
  v_mfma_f32_16x16x32_bf16 v[116:119], v[144:147], v[172:175], v[116:119]
  ds_read_b128 v[180:183], v241 offset:1024
  s_waitcnt lgkmcnt(4)
  v_mfma_f32_16x16x32_bf16 v[112:115], v[140:143], v[164:167], v[112:115]
  ds_read2_b32 v[132:133], v236 offset0:128 offset1:129
  ds_read2_b32 v[134:135], v236 offset0:130 offset1:131
  s_waitcnt lgkmcnt(5)
  v_mfma_f32_16x16x32_bf16 v[116:119], v[140:143], v[176:179], v[116:119]
  ds_read_b128 v[184:187], v241 offset:512
  s_waitcnt lgkmcnt(4)
  v_mfma_f32_16x16x32_bf16 v[108:111], v[136:139], v[160:163], 0
  ds_read2_b32 v[128:129], v236 offset0:0 offset1:1
  ds_read2_b32 v[130:131], v236 offset0:2 offset1:3
  s_waitcnt vmcnt(1)
  s_add_u32 s14, s84, 12288
  v_mov_b32 v15, s8
  s_mov_b64 exec, 1
  s_cmp_eq_u32 s9, 0
  s_cbranch_scc1 slow_42
  buffer_store_dword v15, off, s[52:55], s14
back_43:
  s_mov_b64 exec, -1
  v_mfma_f32_16x16x32_bf16 v[112:115], v[136:139], v[168:171], v[112:115]
  ds_read_b128 v[188:191], v241 offset:0
  s_waitcnt lgkmcnt(6)
  v_mfma_f32_16x16x32_bf16 v[116:119], v[136:139], v[180:183], v[116:119]
  ds_read2_b32 v[156:157], v239 offset0:144 offset1:145
  ds_read2_b32 v[158:159], v239 offset0:146 offset1:147
  s_waitcnt lgkmcnt(6)
  v_mfma_f32_16x16x32_bf16 v[104:107], v[132:135], v[160:163], 0
  ds_read2_b32 v[152:153], v239 offset0:16 offset1:17
  ds_read2_b32 v[154:155], v239 offset0:18 offset1:19
  v_mfma_f32_16x16x32_bf16 v[108:111], v[132:135], v[164:167], v[108:111]
  ds_read2_b32 v[148:149], v238 offset0:144 offset1:145
  ds_read2_b32 v[150:151], v238 offset0:146 offset1:147
  buffer_load_dwordx4 a[188:191], v2, s[52:55], s34 offen offset:3072 sc1
  v_mfma_f32_16x16x32_bf16 v[112:115], v[132:135], v[172:175], v[112:115]
  ds_read2_b32 v[144:145], v238 offset0:16 offset1:17
  ds_read2_b32 v[146:147], v238 offset0:18 offset1:19
  s_waitcnt lgkmcnt(11)
  v_mfma_f32_16x16x32_bf16 v[116:119], v[132:135], v[184:187], v[116:119]
  ds_read2_b32 v[140:141], v237 offset0:144 offset1:145
  ds_read2_b32 v[142:143], v237 offset0:146 offset1:147
  s_waitcnt lgkmcnt(11)
  v_mfma_f32_16x16x32_bf16 v[104:107], v[128:131], v[164:167], v[104:107]
  ds_read_b128 v[160:163], v241 offset:3648
  v_mfma_f32_16x16x32_bf16 v[108:111], v[128:131], v[168:171], v[108:111]
  ds_read2_b32 v[136:137], v237 offset0:16 offset1:17
  ds_read2_b32 v[138:139], v237 offset0:18 offset1:19
  v_mfma_f32_16x16x32_bf16 v[112:115], v[128:131], v[176:179], v[112:115]
  ds_read_b128 v[172:175], v241 offset:2112
  s_waitcnt lgkmcnt(14)
  v_mfma_f32_16x16x32_bf16 v[116:119], v[128:131], v[188:191], v[116:119]
  ds_read_b128 v[180:183], v241 offset:1088
  ds_read_b128 v[164:167], v241 offset:3136
  s_waitcnt lgkmcnt(5)
  v_mfma_f32_16x16x32_bf16 v[116:119], v[156:159], v[160:163], v[116:119]
  ds_read2_b32 v[132:133], v236 offset0:144 offset1:145
  ds_read2_b32 v[134:135], v236 offset0:146 offset1:147
  ds_read_b128 v[168:171], v241 offset:2624
  s_waitcnt lgkmcnt(3)
  v_mfma_f32_16x16x32_bf16 v[116:119], v[152:155], v[164:167], v[116:119]
  ds_read_b128 v[176:179], v241 offset:1600
  s_add_u32 s34, s34, 4096
  buffer_load_dwordx4 a[192:195], v2, s[52:55], s34 offen offset:0 sc1
  s_waitcnt lgkmcnt(1)
  v_mfma_f32_16x16x32_bf16 v[116:119], v[148:151], v[168:171], v[116:119]
  ds_read_b128 v[184:187], v241 offset:576
  v_mfma_f32_16x16x32_bf16 v[112:115], v[144:147], v[160:163], v[112:115]
  ds_read2_b32 v[128:129], v236 offset0:16 offset1:17
  ds_read2_b32 v[130:131], v236 offset0:18 offset1:19
  v_mfma_f32_16x16x32_bf16 v[116:119], v[144:147], v[172:175], v[116:119]
  ds_read_b128 v[188:191], v241 offset:64
  v_mfma_f32_16x16x32_bf16 v[112:115], v[140:143], v[164:167], v[112:115]
  s_waitcnt lgkmcnt(4)
  v_mfma_f32_16x16x32_bf16 v[116:119], v[140:143], v[176:179], v[116:119]
  buffer_load_dwordx4 a[196:199], v2, s[52:55], s34 offen offset:1024 sc1
  v_mfma_f32_16x16x32_bf16 v[108:111], v[136:139], v[160:163], v[108:111]
  buffer_load_dwordx2 v[42:43], v244, s[52:55], s49 offen sc1
  v_mfma_f32_16x16x32_bf16 v[112:115], v[136:139], v[168:171], v[112:115]
  v_mfma_f32_16x16x32_bf16 v[116:119], v[136:139], v[180:183], v[116:119]
  v_mfma_f32_16x16x32_bf16 v[104:107], v[132:135], v[160:163], v[104:107]
  v_mfma_f32_16x16x32_bf16 v[108:111], v[132:135], v[164:167], v[108:111]
  v_mfma_f32_16x16x32_bf16 v[112:115], v[132:135], v[172:175], v[112:115]
  s_waitcnt lgkmcnt(3)
  v_mfma_f32_16x16x32_bf16 v[116:119], v[132:135], v[184:187], v[116:119]
  s_waitcnt lgkmcnt(1)
  v_mfma_f32_16x16x32_bf16 v[104:107], v[128:131], v[164:167], v[104:107]
  v_mfma_f32_16x16x32_bf16 v[108:111], v[128:131], v[168:171], v[108:111]
  v_mfma_f32_16x16x32_bf16 v[112:115], v[128:131], v[176:179], v[112:115]
  s_waitcnt lgkmcnt(0)
  v_mfma_f32_16x16x32_bf16 v[116:119], v[128:131], v[188:191], v[116:119]
  s_branch join_41
type_40:
  ds_read2_b32 v[152:153], v239 offset0:0 offset1:1
  ds_read2_b32 v[154:155], v239 offset0:2 offset1:3
  ds_read_b128 v[160:163], v241 offset:3584
  ds_read2_b32 v[148:149], v238 offset0:128 offset1:129
  ds_read2_b32 v[150:151], v238 offset0:130 offset1:131
  ds_read_b128 v[164:167], v241 offset:3072
  ds_read2_b32 v[144:145], v238 offset0:0 offset1:1
  ds_read2_b32 v[146:147], v238 offset0:2 offset1:3
  s_waitcnt lgkmcnt(5)
  v_mfma_f32_16x16x32_bf16 v[116:119], v[152:155], v[160:163], 0
  ds_read_b128 v[168:171], v241 offset:2560
  s_waitcnt lgkmcnt(4)
  v_mfma_f32_16x16x32_bf16 v[112:115], v[148:151], v[160:163], 0
  ds_read2_b32 v[140:141], v237 offset0:128 offset1:129
  ds_read2_b32 v[142:143], v237 offset0:130 offset1:131
  s_waitcnt lgkmcnt(5)
  v_mfma_f32_16x16x32_bf16 v[116:119], v[148:151], v[164:167], v[116:119]
  ds_read_b128 v[172:175], v241 offset:2048
  s_waitcnt lgkmcnt(4)
  v_mfma_f32_16x16x32_bf16 v[112:115], v[144:147], v[164:167], v[112:115]
  ds_read2_b32 v[136:137], v237 offset0:0 offset1:1
  ds_read2_b32 v[138:139], v237 offset0:2 offset1:3
  buffer_load_dwordx4 a[184:187], v2, s[52:55], s34 offen offset:2048 sc1
  s_waitcnt lgkmcnt(5)
  v_mfma_f32_16x16x32_bf16 v[116:119], v[144:147], v[168:171], v[116:119]
  ds_read_b128 v[176:179], v241 offset:1536
  s_waitcnt lgkmcnt(4)
  v_mfma_f32_16x16x32_bf16 v[108:111], v[140:143], v[160:163], 0
  ds_read2_b32 v[132:133], v236 offset0:128 offset1:129
  ds_read2_b32 v[134:135], v236 offset0:130 offset1:131
  v_mfma_f32_16x16x32_bf16 v[112:115], v[140:143], v[168:171], v[112:115]
  ds_read_b128 v[180:183], v241 offset:1024
  s_waitcnt lgkmcnt(6)
  v_mfma_f32_16x16x32_bf16 v[116:119], v[140:143], v[172:175], v[116:119]
  ds_read2_b32 v[128:129], v236 offset0:0 offset1:1
  ds_read2_b32 v[130:131], v236 offset0:2 offset1:3
  s_waitcnt vmcnt(1)
  s_add_u32 s14, s84, 12288
  v_mov_b32 v15, s8
  s_mov_b64 exec, 1
  s_cmp_eq_u32 s9, 0
  s_cbranch_scc1 slow_44
  buffer_store_dword v15, off, s[52:55], s14
back_45:
  s_mov_b64 exec, -1
  s_waitcnt lgkmcnt(6)
  v_mfma_f32_16x16x32_bf16 v[108:111], v[136:139], v[164:167], v[108:111]
  ds_read_b128 v[184:187], v241 offset:512
  v_mfma_f32_16x16x32_bf16 v[112:115], v[136:139], v[172:175], v[112:115]
  ds_read2_b32 v[152:153], v239 offset0:16 offset1:17
  ds_read2_b32 v[154:155], v239 offset0:18 offset1:19
  s_waitcnt lgkmcnt(8)
  v_mfma_f32_16x16x32_bf16 v[116:119], v[136:139], v[176:179], v[116:119]
  ds_read2_b32 v[148:149], v238 offset0:144 offset1:145
  ds_read2_b32 v[150:151], v238 offset0:146 offset1:147
  s_waitcnt lgkmcnt(8)
  v_mfma_f32_16x16x32_bf16 v[108:111], v[132:135], v[168:171], v[108:111]
  ds_read2_b32 v[144:145], v238 offset0:16 offset1:17
  ds_read2_b32 v[146:147], v238 offset0:18 offset1:19
  buffer_load_dwordx4 a[188:191], v2, s[52:55], s34 offen offset:3072 sc1
  v_mfma_f32_16x16x32_bf16 v[112:115], v[132:135], v[176:179], v[112:115]
  ds_read_b128 v[164:167], v241 offset:3136
  s_waitcnt lgkmcnt(10)
  v_mfma_f32_16x16x32_bf16 v[116:119], v[132:135], v[180:183], v[116:119]
  ds_read2_b32 v[140:141], v237 offset0:144 offset1:145
  ds_read2_b32 v[142:143], v237 offset0:146 offset1:147
  s_waitcnt lgkmcnt(10)
  v_mfma_f32_16x16x32_bf16 v[104:107], v[128:131], v[160:163], 0
  ds_read_b128 v[168:171], v241 offset:2624
  v_mfma_f32_16x16x32_bf16 v[108:111], v[128:131], v[172:175], v[108:111]
  ds_read2_b32 v[136:137], v237 offset0:16 offset1:17
  ds_read2_b32 v[138:139], v237 offset0:18 offset1:19
  ds_read_b128 v[160:163], v241 offset:3648
  v_mfma_f32_16x16x32_bf16 v[112:115], v[128:131], v[180:183], v[112:115]
  ds_read_b128 v[176:179], v241 offset:1600
  s_waitcnt lgkmcnt(14)
  v_mfma_f32_16x16x32_bf16 v[116:119], v[128:131], v[184:187], v[116:119]
  ds_read_b128 v[172:175], v241 offset:2112
  s_waitcnt lgkmcnt(2)
  v_mfma_f32_16x16x32_bf16 v[116:119], v[152:155], v[160:163], v[116:119]
  ds_read2_b32 v[132:133], v236 offset0:144 offset1:145
  ds_read2_b32 v[134:135], v236 offset0:146 offset1:147
  v_mfma_f32_16x16x32_bf16 v[112:115], v[148:151], v[160:163], v[112:115]
  ds_read_b128 v[180:183], v241 offset:1088
  s_add_u32 s34, s34, 4096
  buffer_load_dwordx4 a[192:195], v2, s[52:55], s34 offen offset:0 sc1
  v_mfma_f32_16x16x32_bf16 v[116:119], v[148:151], v[164:167], v[116:119]
  ds_read2_b32 v[128:129], v236 offset0:16 offset1:17
  ds_read2_b32 v[130:131], v236 offset0:18 offset1:19
  v_mfma_f32_16x16x32_bf16 v[112:115], v[144:147], v[164:167], v[112:115]
  ds_read_b128 v[184:187], v241 offset:576
  v_mfma_f32_16x16x32_bf16 v[116:119], v[144:147], v[168:171], v[116:119]
  v_mfma_f32_16x16x32_bf16 v[108:111], v[140:143], v[160:163], v[108:111]
  v_mfma_f32_16x16x32_bf16 v[112:115], v[140:143], v[168:171], v[112:115]
  buffer_load_dwordx4 a[196:199], v2, s[52:55], s34 offen offset:1024 sc1
  s_waitcnt lgkmcnt(6)
  v_mfma_f32_16x16x32_bf16 v[116:119], v[140:143], v[172:175], v[116:119]
  buffer_load_dwordx2 v[42:43], v244, s[52:55], s49 offen sc1
  v_mfma_f32_16x16x32_bf16 v[108:111], v[136:139], v[164:167], v[108:111]
  v_mfma_f32_16x16x32_bf16 v[112:115], v[136:139], v[172:175], v[112:115]
  v_mfma_f32_16x16x32_bf16 v[116:119], v[136:139], v[176:179], v[116:119]
  s_waitcnt lgkmcnt(4)
  v_mfma_f32_16x16x32_bf16 v[108:111], v[132:135], v[168:171], v[108:111]
  v_mfma_f32_16x16x32_bf16 v[112:115], v[132:135], v[176:179], v[112:115]
  s_waitcnt lgkmcnt(3)
  v_mfma_f32_16x16x32_bf16 v[116:119], v[132:135], v[180:183], v[116:119]
  s_waitcnt lgkmcnt(1)
  v_mfma_f32_16x16x32_bf16 v[104:107], v[128:131], v[160:163], v[104:107]
  v_mfma_f32_16x16x32_bf16 v[108:111], v[128:131], v[172:175], v[108:111]
  v_mfma_f32_16x16x32_bf16 v[112:115], v[128:131], v[180:183], v[112:115]
  s_waitcnt lgkmcnt(0)
  v_mfma_f32_16x16x32_bf16 v[116:119], v[128:131], v[184:187], v[116:119]
join_41:
  s_waitcnt vmcnt(0)
  v_xor_b32 v15, s8, v42
  v_xor_b32 v14, s8, v43
  v_or_b32 v15, v15, v14
  v_cmp_ne_u32 vcc, 0, v15
  s_cbranch_vccz ok_47
again_46:
  buffer_load_dwordx2 v[42:43], v244, s[52:55], s49 offen sc1
  s_sub_u32 s10, s10, 1
  s_cmp_gt_i32 s10, 0
  s_waitcnt vmcnt(0)
  v_xor_b32 v15, s8, v42
  v_xor_b32 v14, s8, v43
  v_or_b32 v15, v15, v14
  v_cmp_ne_u32 vcc, 0, v15
  s_cbranch_scc0 out_48
  s_cbranch_vccnz again_46
out_48:
ok_47:
  buffer_load_dwordx4 v[128:131], v2, s[52:55], s16 offen offset:0 sc1
  buffer_load_dwordx4 v[132:135], v2, s[52:55], s16 offen offset:1024 sc1
  buffer_load_dwordx4 v[136:139], v2, s[52:55], s16 offen offset:2048 sc1
  buffer_load_dwordx4 v[140:143], v2, s[52:55], s16 offen offset:3072 sc1
  s_add_u32 s16, s16, 4096
  buffer_load_dwordx4 v[144:147], v2, s[52:55], s16 offen offset:0 sc1
  buffer_load_dwordx4 v[148:151], v2, s[52:55], s16 offen offset:1024 sc1
  buffer_load_dwordx4 v[152:155], v2, s[52:55], s16 offen offset:2048 sc1
  buffer_load_dwordx4 v[156:159], v2, s[52:55], s16 offen offset:3072 sc1
  ds_write_b128 v252, v[104:107] offset:0
  ds_write_b128 v252, v[108:111] offset:1024
  ds_write_b128 v252, v[112:115] offset:2048
  ds_write_b128 v252, v[116:119] offset:3072
  s_waitcnt lgkmcnt(0)
  s_barrier
  ds_read_b128 v[208:211], v250 offset:0
  ds_read_b128 v[212:215], v250 offset:1024
  ds_read_b128 v[216:219], v250 offset:2048
  ds_read_b128 v[220:223], v250 offset:3072
  ds_read_b128 v[224:227], v251 offset:0
  ds_read_b128 v[228:231], v251 offset:4096
  ds_read_b128 v[232:235], v251 offset:8192
  ds_read_b128 v[236:239], v251 offset:12288
  s_waitcnt vmcnt(7)
  v_mfma_f32_16x16x32_bf16 v[48:51], a[0:3], v[128:131], 0
  s_add_u32 s16, s16, 4096
  buffer_load_dwordx4 v[160:163], v2, s[52:55], s16 offen offset:0 sc1
  s_waitcnt lgkmcnt(0)
  v_mfma_f32_16x16x32_bf16 v[52:55], a[4:7], v[128:131], 0
  v_add_f32 v208, v192, v208
  v_add_f32_e64 v209, v193, v209
  v_mfma_f32_16x16x32_bf16 v[56:59], a[8:11], v[128:131], 0
  v_add_f32 v210, v194, v210
  v_add_f32 v211, v195, v211
  v_mfma_f32_16x16x32_bf16 v[60:63], a[12:15], v[128:131], 0
  v_cvt_pk_bf16_f32 v208, v208, v209
  v_cvt_pk_bf16_f32 v209, v210, v211
  v_mfma_f32_16x16x32_bf16 v[64:67], a[16:19], v[128:131], 0
  buffer_store_dwordx2 v[208:209], v246, s[52:55], s50 offen offset:0 sc1
  s_waitcnt vmcnt(8)
  v_mfma_f32_16x16x32_bf16 v[48:51], a[20:23], v[132:135], v[48:51]
  buffer_load_dwordx4 v[164:167], v2, s[52:55], s16 offen offset:1024 sc1
  v_add_f32 v212, v196, v212
  v_mfma_f32_16x16x32_bf16 v[52:55], a[24:27], v[132:135], v[52:55]
  v_add_f32 v213, v197, v213
  v_add_f32 v214, v198, v214
  v_mfma_f32_16x16x32_bf16 v[56:59], a[28:31], v[132:135], v[56:59]
  v_add_f32_e64 v215, v199, v215
  v_cvt_pk_bf16_f32 v212, v212, v213
  v_mfma_f32_16x16x32_bf16 v[60:63], a[32:35], v[132:135], v[60:63]
  v_cvt_pk_bf16_f32 v213, v214, v215
  buffer_store_dwordx2 v[212:213], v246, s[52:55], s50 offen offset:512 sc1
  v_mfma_f32_16x16x32_bf16 v[64:67], a[36:39], v[132:135], v[64:67]
  v_add_f32 v216, v200, v216
  s_waitcnt vmcnt(9)
  v_mfma_f32_16x16x32_bf16 v[48:51], a[40:43], v[136:139], v[48:51]
  buffer_load_dwordx4 v[168:171], v2, s[52:55], s17 offen offset:0 sc1
  v_add_f32_e64 v217, v201, v217
  v_mfma_f32_16x16x32_bf16 v[52:55], a[44:47], v[136:139], v[52:55]
  v_add_f32 v218, v202, v218
  v_add_f32 v219, v203, v219
  v_mfma_f32_16x16x32_bf16 v[56:59], a[48:51], v[136:139], v[56:59]
  v_cvt_pk_bf16_f32 v216, v216, v217
  v_cvt_pk_bf16_f32 v217, v218, v219
  v_mfma_f32_16x16x32_bf16 v[60:63], a[52:55], v[136:139], v[60:63]
  buffer_store_dwordx2 v[216:217], v246, s[52:55], s50 offen offset:1024 sc1
  v_add_f32_e64 v220, v204, v220
  v_mfma_f32_16x16x32_bf16 v[64:67], a[56:59], v[136:139], v[64:67]
  v_add_f32 v221, v205, v221
  s_waitcnt vmcnt(10)
  v_mfma_f32_16x16x32_bf16 v[48:51], a[60:63], v[140:143], v[48:51]
  buffer_load_dwordx4 v[172:175], v2, s[52:55], s17 offen offset:1024 sc1
  v_add_f32_e64 v222, v206, v222
  v_mfma_f32_16x16x32_bf16 v[52:55], a[64:67], v[140:143], v[52:55]
  v_add_f32_e64 v223, v207, v223
  v_cvt_pk_bf16_f32 v220, v220, v221
  v_mfma_f32_16x16x32_bf16 v[56:59], a[68:71], v[140:143], v[56:59]
  v_cvt_pk_bf16_f32 v221, v222, v223
  buffer_store_dwordx2 v[220:221], v246, s[52:55], s50 offen offset:1536 sc1
  v_mfma_f32_16x16x32_bf16 v[60:63], a[72:75], v[140:143], v[60:63]
  v_dot2_f32_bf16 v224, v97, s45, v224
  v_dot2_f32_bf16 v225, v97, s25, v225
  v_mfma_f32_16x16x32_bf16 v[64:67], a[76:79], v[140:143], v[64:67]
  v_dot2_f32_bf16 v226, v96, s45, v226
  s_waitcnt vmcnt(11)
  v_mfma_f32_16x16x32_bf16 v[48:51], a[80:83], v[144:147], v[48:51]
  buffer_load_dwordx4 v[176:179], v2, s[52:55], s17 offen offset:2048 sc1
  v_dot2_f32_bf16 v227, v96, s25, v227
  v_mfma_f32_16x16x32_bf16 v[52:55], a[84:87], v[144:147], v[52:55]
  v_add_f32 v228, v228, v232
  v_add_f32_e64 v229, v229, v233
  v_mfma_f32_16x16x32_bf16 v[56:59], a[88:91], v[144:147], v[56:59]
  v_add_f32 v230, v230, v234
  v_add_f32 v231, v231, v235
  v_mfma_f32_16x16x32_bf16 v[60:63], a[92:95], v[144:147], v[60:63]
  v_add_f32 v224, v224, v236
  v_add_f32 v225, v225, v237
  v_mfma_f32_16x16x32_bf16 v[64:67], a[96:99], v[144:147], v[64:67]
  v_add_f32 v226, v226, v238
  s_waitcnt vmcnt(11)
  v_mfma_f32_16x16x32_bf16 v[48:51], a[100:103], v[148:151], v[48:51]
  buffer_load_dwordx4 v[180:183], v2, s[52:55], s17 offen offset:3072 sc1
  v_add_f32_e64 v227, v227, v239
  v_mfma_f32_16x16x32_bf16 v[52:55], a[104:107], v[148:151], v[52:55]
  v_add_f32 v224, v224, v228
  v_add_f32 v225, v225, v229
  v_mfma_f32_16x16x32_bf16 v[56:59], a[108:111], v[148:151], v[56:59]
  v_add_f32 v226, v226, v230
  v_add_f32 v227, v227, v231
  v_mfma_f32_16x16x32_bf16 v[60:63], a[112:115], v[148:151], v[60:63]
  v_cvt_pk_bf16_f32 v224, v224, v225
  v_cvt_pk_bf16_f32 v225, v226, v227
  v_mfma_f32_16x16x32_bf16 v[64:67], a[116:119], v[148:151], v[64:67]
  buffer_store_dwordx2 v[224:225], v246, s[52:55], s51 offen sc1
  s_waitcnt vmcnt(12)
  v_mfma_f32_16x16x32_bf16 v[48:51], a[120:123], v[152:155], v[48:51]
  s_add_u32 s17, s17, 4096
  buffer_load_dwordx4 v[184:187], v2, s[52:55], s17 offen offset:0 sc1
  s_barrier
  v_mfma_f32_16x16x32_bf16 v[52:55], a[124:127], v[152:155], v[52:55]
  v_accvgpr_read_b32 v102, a226
  v_accvgpr_read_b32 v103, a227
  v_mfma_f32_16x16x32_bf16 v[56:59], a[128:131], v[152:155], v[56:59]
  v_mul_f32_e64 v102, v102, v103
  v_accvgpr_read_b32 v98, a216
  v_mfma_f32_16x16x32_bf16 v[60:63], a[132:135], v[152:155], v[60:63]
  v_accvgpr_read_b32 v100, a230
  v_accvgpr_read_b32 v99, a217
  v_mfma_f32_16x16x32_bf16 v[64:67], a[136:139], v[152:155], v[64:67]
  v_accvgpr_read_b32 v101, a231
  v_lshlrev_b32 v108, 16, v98
  s_waitcnt vmcnt(12)
  v_mfma_f32_16x16x32_bf16 v[48:51], a[140:143], v[156:159], v[48:51]
  buffer_load_dwordx4 v[188:191], v2, s[52:55], s17 offen offset:1024 sc1
  v_and_b32 v109, 0xffff0000, v98
  v_mfma_f32_16x16x32_bf16 v[52:55], a[144:147], v[156:159], v[52:55]
  v_lshlrev_b32_e64 v110, 16, v99
  v_and_b32 v111, 0xffff0000, v99
  v_mfma_f32_16x16x32_bf16 v[56:59], a[148:151], v[156:159], v[56:59]
  v_lshlrev_b32_e64 v92, 16, v100
  v_and_b32 v93, 0xffff0000, v100
  v_mfma_f32_16x16x32_bf16 v[60:63], a[152:155], v[156:159], v[60:63]
  v_lshlrev_b32_e64 v94, 16, v101
  v_and_b32 v95, 0xffff0000, v101
  v_mfma_f32_16x16x32_bf16 v[64:67], a[156:159], v[156:159], v[64:67]
  v_fma_f32 v88, v108, v103, -v102
  s_waitcnt vmcnt(12)
  v_mfma_f32_16x16x32_bf16 v[48:51], a[160:163], v[160:163], v[48:51]
  buffer_load_dwordx4 v[128:131], v2, s[52:55], s17 offen offset:2048 sc1
  v_fma_f32 v89, v109, v103, -v102
  v_mfma_f32_16x16x32_bf16 v[52:55], a[164:167], v[160:163], v[52:55]
  v_fma_f32 v90, v110, v103, -v102
  v_fma_f32 v91, v111, v103, -v102
  v_mfma_f32_16x16x32_bf16 v[56:59], a[168:171], v[160:163], v[56:59]
  v_fmac_f32 v108, v88, v92
  v_fmac_f32_e64 v109, v89, v93
  v_mfma_f32_16x16x32_bf16 v[60:63], a[172:175], v[160:163], v[60:63]
  v_fmac_f32 v110, v90, v94
  v_fmac_f32 v111, v91, v95
  v_mfma_f32_16x16x32_bf16 v[64:67], a[176:179], v[160:163], v[64:67]
  v_accvgpr_read_b32 v98, a218
  s_waitcnt vmcnt(11)
  v_mfma_f32_16x16x32_bf16 v[48:51], a[180:183], v[164:167], v[48:51]
  buffer_load_dwordx4 v[132:135], v2, s[52:55], s17 offen offset:3072 sc1
  v_accvgpr_read_b32 v100, a232
  v_mfma_f32_16x16x32_bf16 v[52:55], a[184:187], v[164:167], v[52:55]
  v_accvgpr_read_b32 v99, a219
  v_accvgpr_read_b32 v101, a233
  v_mfma_f32_16x16x32_bf16 v[56:59], a[188:191], v[164:167], v[56:59]
  v_lshlrev_b32 v112, 16, v98
  v_and_b32 v113, 0xffff0000, v98
  v_mfma_f32_16x16x32_bf16 v[60:63], a[192:195], v[164:167], v[60:63]
  v_lshlrev_b32_e64 v114, 16, v99
  v_and_b32 v115, 0xffff0000, v99
  v_mfma_f32_16x16x32_bf16 v[64:67], a[196:199], v[164:167], v[64:67]
  v_lshlrev_b32 v92, 16, v100
  s_waitcnt vmcnt(10)
  v_mfma_f32_16x16x32_bf16 v[68:71], a[0:3], v[168:171], 0
  s_add_u32 s17, s17, 4096
  buffer_load_dwordx4 v[136:139], v2, s[52:55], s17 offen offset:0 sc1
  v_and_b32 v93, 0xffff0000, v100
  v_mfma_f32_16x16x32_bf16 v[72:75], a[4:7], v[168:171], 0
  v_lshlrev_b32_e64 v94, 16, v101
  v_and_b32 v95, 0xffff0000, v101
  v_mfma_f32_16x16x32_bf16 v[76:79], a[8:11], v[168:171], 0
  v_fma_f32 v88, v112, v103, -v102
  v_fma_f32 v89, v113, v103, -v102
  v_mfma_f32_16x16x32_bf16 v[80:83], a[12:15], v[168:171], 0
  v_fma_f32 v90, v114, v103, -v102
  v_fma_f32 v91, v115, v103, -v102
  v_mfma_f32_16x16x32_bf16 v[84:87], a[16:19], v[168:171], 0
  v_fmac_f32 v112, v88, v92
  s_waitcnt vmcnt(9)
  v_mfma_f32_16x16x32_bf16 v[68:71], a[20:23], v[172:175], v[68:71]
  ds_write_b128 v44, v[48:51] offset:0
  buffer_load_dwordx4 v[140:143], v2, s[52:55], s17 offen offset:1024 sc1
  v_fmac_f32_e64 v113, v89, v93
  v_mfma_f32_16x16x32_bf16 v[72:75], a[24:27], v[172:175], v[72:75]
  ds_write_b128 v44, v[52:55] offset:1024
  v_fmac_f32 v114, v90, v94
  v_fmac_f32 v115, v91, v95
  v_mfma_f32_16x16x32_bf16 v[76:79], a[28:31], v[172:175], v[76:79]
  ds_write_b128 v44, v[56:59] offset:2048
  v_accvgpr_read_b32 v98, a220
  v_accvgpr_read_b32 v100, a234
  v_mfma_f32_16x16x32_bf16 v[80:83], a[32:35], v[172:175], v[80:83]
  ds_write_b128 v44, v[60:63] offset:3072
  v_accvgpr_read_b32 v99, a221
  v_accvgpr_read_b32 v101, a235
  v_mfma_f32_16x16x32_bf16 v[84:87], a[36:39], v[172:175], v[84:87]
  ds_write_b128 v44, v[64:67] offset:4096
  v_lshlrev_b32 v116, 16, v98
  s_waitcnt vmcnt(8)
  v_mfma_f32_16x16x32_bf16 v[68:71], a[40:43], v[176:179], v[68:71]
  buffer_load_dwordx4 v[144:147], v2, s[52:55], s18 offen offset:0 sc1
  v_and_b32 v117, 0xffff0000, v98
  v_mfma_f32_16x16x32_bf16 v[72:75], a[44:47], v[176:179], v[72:75]
  v_lshlrev_b32_e64 v118, 16, v99
  v_and_b32 v119, 0xffff0000, v99
  v_mfma_f32_16x16x32_bf16 v[76:79], a[48:51], v[176:179], v[76:79]
  v_lshlrev_b32_e64 v92, 16, v100
  v_and_b32 v93, 0xffff0000, v100
  v_mfma_f32_16x16x32_bf16 v[80:83], a[52:55], v[176:179], v[80:83]
  v_lshlrev_b32_e64 v94, 16, v101
  v_and_b32 v95, 0xffff0000, v101
  v_mfma_f32_16x16x32_bf16 v[84:87], a[56:59], v[176:179], v[84:87]
  v_fma_f32 v88, v116, v103, -v102
  s_waitcnt vmcnt(8)
  v_mfma_f32_16x16x32_bf16 v[68:71], a[60:63], v[180:183], v[68:71]
  buffer_load_dwordx4 v[148:151], v2, s[52:55], s18 offen offset:1024 sc1
  v_fma_f32 v89, v117, v103, -v102
  v_mfma_f32_16x16x32_bf16 v[72:75], a[64:67], v[180:183], v[72:75]
  v_fma_f32 v90, v118, v103, -v102
  v_fma_f32 v91, v119, v103, -v102
  v_mfma_f32_16x16x32_bf16 v[76:79], a[68:71], v[180:183], v[76:79]
  v_fmac_f32 v116, v88, v92
  v_fmac_f32_e64 v117, v89, v93
  v_mfma_f32_16x16x32_bf16 v[80:83], a[72:75], v[180:183], v[80:83]
  v_fmac_f32 v118, v90, v94
  v_fmac_f32 v119, v91, v95
  v_mfma_f32_16x16x32_bf16 v[84:87], a[76:79], v[180:183], v[84:87]
  v_accvgpr_read_b32 v98, a222
  s_waitcnt vmcnt(7)
  v_mfma_f32_16x16x32_bf16 v[68:71], a[80:83], v[184:187], v[68:71]
  buffer_load_dwordx4 v[152:155], v2, s[52:55], s18 offen offset:2048 sc1
  v_accvgpr_read_b32 v100, a236
  v_mfma_f32_16x16x32_bf16 v[72:75], a[84:87], v[184:187], v[72:75]
  v_accvgpr_read_b32 v99, a223
  v_accvgpr_read_b32 v101, a237
  v_mfma_f32_16x16x32_bf16 v[76:79], a[88:91], v[184:187], v[76:79]
  v_lshlrev_b32 v120, 16, v98
  v_and_b32 v121, 0xffff0000, v98
  v_mfma_f32_16x16x32_bf16 v[80:83], a[92:95], v[184:187], v[80:83]
  v_lshlrev_b32_e64 v122, 16, v99
  v_and_b32 v123, 0xffff0000, v99
  v_mfma_f32_16x16x32_bf16 v[84:87], a[96:99], v[184:187], v[84:87]
  v_lshlrev_b32 v92, 16, v100
  s_waitcnt vmcnt(7)
  v_mfma_f32_16x16x32_bf16 v[68:71], a[100:103], v[188:191], v[68:71]
  buffer_load_dwordx4 v[156:159], v2, s[52:55], s18 offen offset:3072 sc1
  v_and_b32 v93, 0xffff0000, v100
  v_mfma_f32_16x16x32_bf16 v[72:75], a[104:107], v[188:191], v[72:75]
  v_lshlrev_b32_e64 v94, 16, v101
  v_and_b32 v95, 0xffff0000, v101
  v_mfma_f32_16x16x32_bf16 v[76:79], a[108:111], v[188:191], v[76:79]
  v_fma_f32 v88, v120, v103, -v102
  v_fma_f32 v89, v121, v103, -v102
  v_mfma_f32_16x16x32_bf16 v[80:83], a[112:115], v[188:191], v[80:83]
  v_fma_f32 v90, v122, v103, -v102
  v_fma_f32 v91, v123, v103, -v102
  v_mfma_f32_16x16x32_bf16 v[84:87], a[116:119], v[188:191], v[84:87]
  v_fmac_f32 v120, v88, v92
  s_waitcnt vmcnt(7)
  v_mfma_f32_16x16x32_bf16 v[68:71], a[120:123], v[128:131], v[68:71]
  s_add_u32 s18, s18, 4096
  buffer_load_dwordx4 v[160:163], v2, s[52:55], s18 offen offset:0 sc1
  v_fmac_f32_e64 v121, v89, v93
  v_mfma_f32_16x16x32_bf16 v[72:75], a[124:127], v[128:131], v[72:75]
  v_fmac_f32 v122, v90, v94
  v_fmac_f32 v123, v91, v95
  v_mfma_f32_16x16x32_bf16 v[76:79], a[128:131], v[128:131], v[76:79]
  v_accvgpr_read_b32 v98, a224
  v_accvgpr_read_b32 v100, a238
  v_mfma_f32_16x16x32_bf16 v[80:83], a[132:135], v[128:131], v[80:83]
  v_accvgpr_read_b32 v99, a225
  v_accvgpr_read_b32 v101, a239
  v_mfma_f32_16x16x32_bf16 v[84:87], a[136:139], v[128:131], v[84:87]
  v_lshlrev_b32 v124, 16, v98
  s_waitcnt vmcnt(7)
  v_mfma_f32_16x16x32_bf16 v[68:71], a[140:143], v[132:135], v[68:71]
  buffer_load_dwordx4 v[164:167], v2, s[52:55], s18 offen offset:1024 sc1
  v_and_b32 v125, 0xffff0000, v98
  v_mfma_f32_16x16x32_bf16 v[72:75], a[144:147], v[132:135], v[72:75]
  v_lshlrev_b32_e64 v126, 16, v99
  v_and_b32 v127, 0xffff0000, v99
  v_mfma_f32_16x16x32_bf16 v[76:79], a[148:151], v[132:135], v[76:79]
  v_lshlrev_b32_e64 v92, 16, v100
  v_and_b32 v93, 0xffff0000, v100
  v_mfma_f32_16x16x32_bf16 v[80:83], a[152:155], v[132:135], v[80:83]
  v_lshlrev_b32_e64 v94, 16, v101
  v_and_b32 v95, 0xffff0000, v101
  v_mfma_f32_16x16x32_bf16 v[84:87], a[156:159], v[132:135], v[84:87]
  v_fma_f32 v88, v124, v103, -v102
  s_waitcnt vmcnt(7)
  v_mfma_f32_16x16x32_bf16 v[68:71], a[160:163], v[136:139], v[68:71]
  buffer_load_dwordx4 v[168:171], v2, s[52:55], s18 offen offset:2048 sc1
  v_fma_f32 v89, v125, v103, -v102
  v_mfma_f32_16x16x32_bf16 v[72:75], a[164:167], v[136:139], v[72:75]
  v_fma_f32 v90, v126, v103, -v102
  v_fma_f32 v91, v127, v103, -v102
  v_mfma_f32_16x16x32_bf16 v[76:79], a[168:171], v[136:139], v[76:79]
  v_fmac_f32 v124, v88, v92
  v_fmac_f32_e64 v125, v89, v93
  v_mfma_f32_16x16x32_bf16 v[80:83], a[172:175], v[136:139], v[80:83]
  v_fmac_f32_e64 v126, v90, v94
  v_mfma_f32_16x16x32_bf16 v[84:87], a[176:179], v[136:139], v[84:87]
  v_fmac_f32 v127, v91, v95
  s_waitcnt vmcnt(7)
  v_mfma_f32_16x16x32_bf16 v[68:71], a[180:183], v[140:143], v[68:71]
  buffer_load_dwordx4 v[172:175], v2, s[52:55], s18 offen offset:3072 sc1
  v_mfma_f32_16x16x32_bf16 v[72:75], a[184:187], v[140:143], v[72:75]
  v_mfma_f32_16x16x32_bf16 v[76:79], a[188:191], v[140:143], v[76:79]
  v_mfma_f32_16x16x32_bf16 v[80:83], a[192:195], v[140:143], v[80:83]
  v_mfma_f32_16x16x32_bf16 v[84:87], a[196:199], v[140:143], v[84:87]
  s_waitcnt vmcnt(7)
  v_mfma_f32_16x16x32_bf16 v[48:51], a[0:3], v[144:147], 0
  s_add_u32 s18, s18, 4096
  buffer_load_dwordx4 v[176:179], v2, s[52:55], s18 offen offset:0 sc1
  v_mfma_f32_16x16x32_bf16 v[52:55], a[4:7], v[144:147], 0
  v_mfma_f32_16x16x32_bf16 v[56:59], a[8:11], v[144:147], 0
  v_mfma_f32_16x16x32_bf16 v[60:63], a[12:15], v[144:147], 0
  v_mfma_f32_16x16x32_bf16 v[64:67], a[16:19], v[144:147], 0
  s_waitcnt vmcnt(7)
  v_mfma_f32_16x16x32_bf16 v[48:51], a[20:23], v[148:151], v[48:51]
  ds_write_b128 v45, v[68:71] offset:0
  buffer_load_dwordx4 v[180:183], v2, s[52:55], s18 offen offset:1024 sc1
  v_mfma_f32_16x16x32_bf16 v[52:55], a[24:27], v[148:151], v[52:55]
  ds_write_b128 v45, v[72:75] offset:1024
  s_mul_i32 s15, s7, 10240
  v_mfma_f32_16x16x32_bf16 v[56:59], a[28:31], v[148:151], v[56:59]
  ds_write_b128 v45, v[76:79] offset:2048
  s_add_u32 s15, s15, 102400
  v_mfma_f32_16x16x32_bf16 v[60:63], a[32:35], v[148:151], v[60:63]
  ds_write_b128 v45, v[80:83] offset:3072
  v_add_u32_e64 v47, s15, v2
  v_mfma_f32_16x16x32_bf16 v[64:67], a[36:39], v[148:151], v[64:67]
  ds_write_b128 v45, v[84:87] offset:4096
  s_waitcnt vmcnt(7)
  v_mfma_f32_16x16x32_bf16 v[48:51], a[40:43], v[152:155], v[48:51]
  buffer_load_dwordx4 v[184:187], v2, s[52:55], s19 offen offset:0 sc1
  s_waitcnt lgkmcnt(0)
  s_barrier
  v_mfma_f32_16x16x32_bf16 v[52:55], a[44:47], v[152:155], v[52:55]
  ds_read_b128 v[192:195], v47 offset:0
  ds_read_b128 v[196:199], v47 offset:1024
  v_mfma_f32_16x16x32_bf16 v[56:59], a[48:51], v[152:155], v[56:59]
  ds_read_b128 v[200:203], v47 offset:2048
  ds_read_b128 v[204:207], v47 offset:3072
  v_mfma_f32_16x16x32_bf16 v[60:63], a[52:55], v[152:155], v[60:63]
  ds_read_b128 v[208:211], v47 offset:4096
  v_mfma_f32_16x16x32_bf16 v[64:67], a[56:59], v[152:155], v[64:67]
  ds_read_b128 v[212:215], v47 offset:5120
  s_waitcnt vmcnt(7)
  v_mfma_f32_16x16x32_bf16 v[48:51], a[60:63], v[156:159], v[48:51]
  buffer_load_dwordx4 v[188:191], v2, s[52:55], s19 offen offset:1024 sc1
  ds_read_b128 v[216:219], v47 offset:6144
  v_mfma_f32_16x16x32_bf16 v[52:55], a[64:67], v[156:159], v[52:55]
  ds_read_b128 v[220:223], v47 offset:7168
  ds_read_b128 v[224:227], v47 offset:8192
  v_mfma_f32_16x16x32_bf16 v[56:59], a[68:71], v[156:159], v[56:59]
  ds_read_b128 v[228:231], v47 offset:9216
  s_waitcnt lgkmcnt(5)
  v_mfma_f32_16x16x32_bf16 v[60:63], a[72:75], v[156:159], v[60:63]
  v_add_f32 v108, v108, v192
  v_mfma_f32_16x16x32_bf16 v[64:67], a[76:79], v[156:159], v[64:67]
  v_add_f32 v109, v109, v193
  s_waitcnt vmcnt(7)
  v_mfma_f32_16x16x32_bf16 v[48:51], a[80:83], v[160:163], v[48:51]
  buffer_load_dwordx4 v[128:131], v2, s[52:55], s19 offen offset:2048 sc1
  v_add_f32_e64 v110, v110, v194
  v_mfma_f32_16x16x32_bf16 v[52:55], a[84:87], v[160:163], v[52:55]
  v_add_f32 v111, v111, v195
  v_add_f32 v112, v112, v196
  v_mfma_f32_16x16x32_bf16 v[56:59], a[88:91], v[160:163], v[56:59]
  v_add_f32 v113, v113, v197
  v_add_f32 v114, v114, v198
  v_mfma_f32_16x16x32_bf16 v[60:63], a[92:95], v[160:163], v[60:63]
  v_add_f32_e64 v115, v115, v199
  v_mfma_f32_16x16x32_bf16 v[64:67], a[96:99], v[160:163], v[64:67]
  v_add_f32 v116, v116, v200
  s_waitcnt vmcnt(7)
  v_mfma_f32_16x16x32_bf16 v[48:51], a[100:103], v[164:167], v[48:51]
  buffer_load_dwordx4 v[132:135], v2, s[52:55], s19 offen offset:3072 sc1
  v_add_f32_e64 v117, v117, v201
  v_mfma_f32_16x16x32_bf16 v[52:55], a[104:107], v[164:167], v[52:55]
  v_add_f32 v118, v118, v202
  v_add_f32 v119, v119, v203
  v_mfma_f32_16x16x32_bf16 v[56:59], a[108:111], v[164:167], v[56:59]
  v_add_f32 v120, v120, v204
  v_add_f32 v121, v121, v205
  v_mfma_f32_16x16x32_bf16 v[60:63], a[112:115], v[164:167], v[60:63]
  v_add_f32_e64 v122, v122, v206
  v_mfma_f32_16x16x32_bf16 v[64:67], a[116:119], v[164:167], v[64:67]
  v_add_f32 v123, v123, v207
  s_waitcnt vmcnt(7)
  v_mfma_f32_16x16x32_bf16 v[48:51], a[120:123], v[168:171], v[48:51]
  s_add_u32 s19, s19, 4096
  buffer_load_dwordx4 v[136:139], v2, s[52:55], s19 offen offset:0 sc1
  v_add_f32_e64 v124, v124, v208
  v_mfma_f32_16x16x32_bf16 v[52:55], a[124:127], v[168:171], v[52:55]
  v_add_f32 v125, v125, v209
  v_add_f32 v126, v126, v210
  v_mfma_f32_16x16x32_bf16 v[56:59], a[128:131], v[168:171], v[56:59]
  v_add_f32 v127, v127, v211
  s_waitcnt lgkmcnt(0)
  v_mfma_f32_16x16x32_bf16 v[60:63], a[132:135], v[168:171], v[60:63]
  v_add_f32_e64 v108, v108, v212
  v_mfma_f32_16x16x32_bf16 v[64:67], a[136:139], v[168:171], v[64:67]
  v_add_f32 v109, v109, v213
  s_waitcnt vmcnt(7)
  v_mfma_f32_16x16x32_bf16 v[48:51], a[140:143], v[172:175], v[48:51]
  buffer_load_dwordx4 v[140:143], v2, s[52:55], s19 offen offset:1024 sc1
  s_mul_i32 s93, s6, 327680
  s_lshl_b32 s12, s5, 7
  s_add_u32 s93, s93, s12
  v_mfma_f32_16x16x32_bf16 v[52:55], a[144:147], v[172:175], v[52:55]
  s_lshr_b32 s12, s7, 1
  s_mul_i32 s94, s12, 5120
  s_add_u32 s94, s94, 143360
  s_lshl_b32 s12, s12, 6
  v_mfma_f32_16x16x32_bf16 v[56:59], a[148:151], v[172:175], v[56:59]
  s_add_u32 s93, s93, s12
  s_add_u32 s93, s93, 19922944
  s_mov_b32 s92, s93
  v_add_f32_e64 v110, v110, v214
  v_mfma_f32_16x16x32_bf16 v[60:63], a[152:155], v[172:175], v[60:63]
  v_add_f32 v111, v111, v215
  v_add_f32 v112, v112, v216
  v_add_f32_e64 v113, v113, v217
  v_mfma_f32_16x16x32_bf16 v[64:67], a[156:159], v[172:175], v[64:67]
  v_add_f32 v114, v114, v218
  v_add_f32 v115, v115, v219
  v_add_f32 v116, v116, v220
  s_waitcnt vmcnt(7)
  v_mfma_f32_16x16x32_bf16 v[48:51], a[160:163], v[176:179], v[48:51]
  buffer_load_dwordx4 v[144:147], v2, s[52:55], s19 offen offset:2048 sc1
  s_and_b32 s12, s7, 1
  s_mul_i32 s13, s12, 196608
  s_add_u32 s93, s93, s13
  v_mfma_f32_16x16x32_bf16 v[52:55], a[164:167], v[176:179], v[52:55]
  s_mul_i32 s13, s12, 3072
  s_add_u32 s95, s94, s13
  s_lshl_b32 s12, s12, 3
  s_add_u32 s94, s94, s12
  v_mfma_f32_16x16x32_bf16 v[56:59], a[168:171], v[176:179], v[56:59]
  v_lshrrev_b32 v252, 2, v1
  v_lshlrev_b32 v252, 12, v252
  v_and_b32 v12, 3, v1
  v_lshl_add_u32 v252, v12, 4, v252
  v_mfma_f32_16x16x32_bf16 v[60:63], a[172:175], v[176:179], v[60:63]
  v_add_f32 v117, v117, v221
  v_add_f32 v118, v118, v222
  v_add_f32 v119, v119, v223
  v_add_f32 v120, v120, v224
  v_mfma_f32_16x16x32_bf16 v[64:67], a[176:179], v[176:179], v[64:67]
  v_add_f32 v121, v121, v225
  v_add_f32 v122, v122, v226
  v_add_f32 v123, v123, v227
  s_waitcnt vmcnt(7)
  v_mfma_f32_16x16x32_bf16 v[48:51], a[180:183], v[180:183], v[48:51]
  buffer_load_dwordx4 v[148:151], v2, s[52:55], s19 offen offset:3072 sc1
  v_mfma_f32_16x16x32_bf16 v[52:55], a[184:187], v[180:183], v[52:55]
  v_add_f32_e64 v124, v124, v228
  v_mfma_f32_16x16x32_bf16 v[56:59], a[188:191], v[180:183], v[56:59]
  v_add_f32_e64 v125, v125, v229
  v_mfma_f32_16x16x32_bf16 v[60:63], a[192:195], v[180:183], v[60:63]
  v_add_f32_e64 v126, v126, v230
  v_mfma_f32_16x16x32_bf16 v[64:67], a[196:199], v[180:183], v[64:67]
  v_add_f32 v127, v127, v231
  s_waitcnt vmcnt(7)
  v_mfma_f32_16x16x32_bf16 v[68:71], a[0:3], v[184:187], v[108:111]
  s_add_u32 s19, s19, 4096
  buffer_load_dwordx4 v[152:155], v2, s[52:55], s19 offen offset:0 sc1
  v_mfma_f32_16x16x32_bf16 v[72:75], a[4:7], v[184:187], v[112:115]
  v_mfma_f32_16x16x32_bf16 v[76:79], a[8:11], v[184:187], v[116:119]
  v_mfma_f32_16x16x32_bf16 v[80:83], a[12:15], v[184:187], v[120:123]
  v_mfma_f32_16x16x32_bf16 v[84:87], a[16:19], v[184:187], v[124:127]
  s_waitcnt vmcnt(7)
  v_mfma_f32_16x16x32_bf16 v[68:71], a[20:23], v[188:191], v[68:71]
  ds_write_b128 v46, v[48:51] offset:0
  buffer_load_dwordx4 v[156:159], v2, s[52:55], s19 offen offset:1024 sc1
  v_mfma_f32_16x16x32_bf16 v[72:75], a[24:27], v[188:191], v[72:75]
  ds_write_b128 v46, v[52:55] offset:1024
  v_mfma_f32_16x16x32_bf16 v[76:79], a[28:31], v[188:191], v[76:79]
  ds_write_b128 v46, v[56:59] offset:2048
  v_mfma_f32_16x16x32_bf16 v[80:83], a[32:35], v[188:191], v[80:83]
  ds_write_b128 v46, v[60:63] offset:3072
  v_mfma_f32_16x16x32_bf16 v[84:87], a[36:39], v[188:191], v[84:87]
  ds_write_b128 v46, v[64:67] offset:4096
  s_waitcnt vmcnt(7)
  v_mfma_f32_16x16x32_bf16 v[68:71], a[40:43], v[128:131], v[68:71]
  s_add_u32 m0, s95, 0
  s_nop 0
  buffer_load_dwordx4 v252, s[52:55], s93 offen sc1 lds
  s_add_u32 s93, s93, 65536
  v_mfma_f32_16x16x32_bf16 v[72:75], a[44:47], v[128:131], v[72:75]
  s_add_u32 m0, s95, 1024
  s_nop 0
  buffer_load_dwordx4 v252, s[52:55], s93 offen sc1 lds
  s_add_u32 s93, s93, 65536
  v_mfma_f32_16x16x32_bf16 v[76:79], a[48:51], v[128:131], v[76:79]
  s_add_u32 m0, s95, 2048
  s_bitcmp1_b32 s7, 0
  s_cselect_b32 s93, 1879048192, s93
  s_cselect_b32 m0, 163840, m0
  s_nop 0
  buffer_load_dwordx4 v252, s[52:55], s93 offen sc1 lds
  s_add_u32 s93, s93, 65536
  v_mfma_f32_16x16x32_bf16 v[80:83], a[52:55], v[128:131], v[80:83]
  v_mfma_f32_16x16x32_bf16 v[84:87], a[56:59], v[128:131], v[84:87]
  s_waitcnt vmcnt(9)
  v_mfma_f32_16x16x32_bf16 v[68:71], a[60:63], v[132:135], v[68:71]
  v_add_u32_e64 v253, s94, v2
  v_mfma_f32_16x16x32_bf16 v[72:75], a[64:67], v[132:135], v[72:75]
  s_mul_i32 s15, s7, 5120
  v_mfma_f32_16x16x32_bf16 v[76:79], a[68:71], v[132:135], v[76:79]
  v_add_u32_e64 v47, s15, v2
  v_mfma_f32_16x16x32_bf16 v[80:83], a[72:75], v[132:135], v[80:83]
  v_mfma_f32_16x16x32_bf16 v[84:87], a[76:79], v[132:135], v[84:87]
  s_waitcnt vmcnt(8)
  v_mfma_f32_16x16x32_bf16 v[68:71], a[80:83], v[136:139], v[68:71]
  s_waitcnt lgkmcnt(0)
  s_barrier
  ds_read_b128 v[192:195], v47 offset:0
  v_mfma_f32_16x16x32_bf16 v[72:75], a[84:87], v[136:139], v[72:75]
  ds_read_b128 v[196:199], v47 offset:1024
  v_mfma_f32_16x16x32_bf16 v[76:79], a[88:91], v[136:139], v[76:79]
  ds_read_b128 v[200:203], v47 offset:2048
  v_mfma_f32_16x16x32_bf16 v[80:83], a[92:95], v[136:139], v[80:83]
  ds_read_b128 v[204:207], v47 offset:3072
  v_mfma_f32_16x16x32_bf16 v[84:87], a[96:99], v[136:139], v[84:87]
  ds_read_b128 v[208:211], v47 offset:4096
  s_waitcnt vmcnt(7)
  v_mfma_f32_16x16x32_bf16 v[68:71], a[100:103], v[140:143], v[68:71]
  v_mfma_f32_16x16x32_bf16 v[72:75], a[104:107], v[140:143], v[72:75]
  v_mfma_f32_16x16x32_bf16 v[76:79], a[108:111], v[140:143], v[76:79]
  v_mfma_f32_16x16x32_bf16 v[80:83], a[112:115], v[140:143], v[80:83]
  v_mfma_f32_16x16x32_bf16 v[84:87], a[116:119], v[140:143], v[84:87]
  s_waitcnt vmcnt(6)
  v_mfma_f32_16x16x32_bf16 v[68:71], a[120:123], v[144:147], v[68:71]
  v_mfma_f32_16x16x32_bf16 v[72:75], a[124:127], v[144:147], v[72:75]
  v_mfma_f32_16x16x32_bf16 v[76:79], a[128:131], v[144:147], v[76:79]
  v_mfma_f32_16x16x32_bf16 v[80:83], a[132:135], v[144:147], v[80:83]
  v_mfma_f32_16x16x32_bf16 v[84:87], a[136:139], v[144:147], v[84:87]
  s_waitcnt vmcnt(5)
  v_mfma_f32_16x16x32_bf16 v[68:71], a[140:143], v[148:151], v[68:71]
  v_mfma_f32_16x16x32_bf16 v[72:75], a[144:147], v[148:151], v[72:75]
  v_mfma_f32_16x16x32_bf16 v[76:79], a[148:151], v[148:151], v[76:79]
  v_mfma_f32_16x16x32_bf16 v[80:83], a[152:155], v[148:151], v[80:83]
  v_mfma_f32_16x16x32_bf16 v[84:87], a[156:159], v[148:151], v[84:87]
  s_waitcnt vmcnt(4)
  v_mfma_f32_16x16x32_bf16 v[68:71], a[160:163], v[152:155], v[68:71]
  v_mfma_f32_16x16x32_bf16 v[72:75], a[164:167], v[152:155], v[72:75]
  v_mfma_f32_16x16x32_bf16 v[76:79], a[168:171], v[152:155], v[76:79]
  v_mfma_f32_16x16x32_bf16 v[80:83], a[172:175], v[152:155], v[80:83]
  v_mfma_f32_16x16x32_bf16 v[84:87], a[176:179], v[152:155], v[84:87]
  s_waitcnt vmcnt(3)
  v_mfma_f32_16x16x32_bf16 v[68:71], a[180:183], v[156:159], v[68:71]
  v_mfma_f32_16x16x32_bf16 v[72:75], a[184:187], v[156:159], v[72:75]
  v_mfma_f32_16x16x32_bf16 v[76:79], a[188:191], v[156:159], v[76:79]
  v_mfma_f32_16x16x32_bf16 v[80:83], a[192:195], v[156:159], v[80:83]
  v_mfma_f32_16x16x32_bf16 v[84:87], a[196:199], v[156:159], v[84:87]
  s_lshl_b32 s12, s5, 15
  s_lshl_b32 s13, s7, 10
  s_add_u32 s12, s12, s13
  s_add_u32 s12, s12, 1310720
  s_lshl_b32 s13, s6, 12
  s_add_u32 s13, s13, s12
  s_waitcnt lgkmcnt(0)
  s_waitcnt vmcnt(0)
  s_barrier
  ds_read_b64_tr_b16 v[232:233], v253 offset:0
  ds_read_b64_tr_b16 v[234:235], v253 offset:1024
  ds_read_b64_tr_b16 v[236:237], v253 offset:2048
  ds_read_b64_tr_b16 v[238:239], v253 offset:3072
  ds_read_b64_tr_b16 v[240:241], v253 offset:4096
  v_accvgpr_read_b32 v244, a243
  v_accvgpr_read_b32 v245, a244
  v_pk_add_f32 v[68:69], v[68:69], v[192:193]
  v_pk_add_f32 v[70:71], v[70:71], v[194:195]
  v_pk_add_f32 v[72:73], v[72:73], v[196:197]
  v_pk_add_f32 v[74:75], v[74:75], v[198:199]
  v_pk_add_f32 v[76:77], v[76:77], v[200:201]
  v_pk_add_f32 v[78:79], v[78:79], v[202:203]
  v_pk_add_f32 v[80:81], v[80:81], v[204:205]
  v_pk_add_f32 v[82:83], v[82:83], v[206:207]
  v_pk_add_f32 v[84:85], v[84:85], v[208:209]
  v_pk_add_f32 v[86:87], v[86:87], v[210:211]
  v_pk_add_f32 v[212:213], v[68:69], v[70:71]
  v_pk_mul_f32 v[214:215], v[68:69], v[68:69]
  v_pk_fma_f32 v[214:215], v[70:71], v[70:71], v[214:215]
  v_pk_add_f32 v[212:213], v[212:213], v[72:73]
  v_pk_fma_f32 v[214:215], v[72:73], v[72:73], v[214:215]
  v_pk_add_f32 v[212:213], v[212:213], v[74:75]
  v_pk_fma_f32 v[214:215], v[74:75], v[74:75], v[214:215]
  v_pk_add_f32 v[212:213], v[212:213], v[76:77]
  v_pk_fma_f32 v[214:215], v[76:77], v[76:77], v[214:215]
  v_pk_add_f32 v[212:213], v[212:213], v[78:79]
  v_pk_fma_f32 v[214:215], v[78:79], v[78:79], v[214:215]
  v_pk_add_f32 v[212:213], v[212:213], v[80:81]
  v_pk_fma_f32 v[214:215], v[80:81], v[80:81], v[214:215]
  v_pk_add_f32 v[212:213], v[212:213], v[82:83]
  v_pk_fma_f32 v[214:215], v[82:83], v[82:83], v[214:215]
  v_pk_add_f32 v[212:213], v[212:213], v[84:85]
  v_pk_fma_f32 v[214:215], v[84:85], v[84:85], v[214:215]
  v_pk_add_f32 v[212:213], v[212:213], v[86:87]
  v_pk_fma_f32 v[214:215], v[86:87], v[86:87], v[214:215]
  s_waitcnt lgkmcnt(0)
  v_pk_max_u16 v15, v232, v233
  v_pk_max_u16 v15, v15, v234
  v_pk_max_u16 v15, v15, v235
  v_pk_max_u16 v15, v15, v236
  v_pk_max_u16 v15, v15, v237
  v_pk_max_u16 v15, v15, v238
  v_pk_max_u16 v15, v15, v239
  v_pk_max_u16 v15, v15, v240
  v_pk_max_u16 v15, v15, v241
  v_lshlrev_b32 v14, 16, v15
  v_max_u32_e64 v15, v15, v14
  v_cmp_le_u32 vcc, 0xffff0000, v15
  s_cbranch_vccnz again_49
ok_50:
  v_lshlrev_b32 v88, 16, v232
  v_and_b32 v89, 0xffff0000, v232
  v_lshlrev_b32_e64 v90, 16, v233
  v_and_b32 v91, 0xffff0000, v233
  s_add_u32 m0, s75, 0
  s_add_u32 s14, s74, 0
  buffer_load_dwordx4 v244, s[56:59], s14 offen lds
  buffer_load_dwordx4 v245, s[56:59], s14 offen offset:2048 lds
  v_pk_mul_f32 v[160:161], v[68:69], v[88:89]
  v_pk_mul_f32 v[226:227], v[88:89], v[88:89]
  v_pk_mul_f32 v[218:219], v[160:161], v[68:69]
  v_pk_mul_f32 v[220:221], v[160:161], v[160:161]
  v_pk_mul_f32 v[222:223], v[160:161], v[88:89]
  v_pk_mul_f32 v[162:163], v[70:71], v[90:91]
  v_pk_add_f32 v[224:225], v[88:89], v[90:91]
  v_pk_fma_f32 v[226:227], v[90:91], v[90:91], v[226:227]
  v_pk_add_f32 v[216:217], v[160:161], v[162:163]
  v_pk_fma_f32 v[218:219], v[162:163], v[70:71], v[218:219]
  v_pk_fma_f32 v[220:221], v[162:163], v[162:163], v[220:221]
  v_pk_fma_f32 v[222:223], v[162:163], v[90:91], v[222:223]
  v_lshlrev_b32_e64 v92, 16, v234
  v_and_b32 v93, 0xffff0000, v234
  v_lshlrev_b32_e64 v94, 16, v235
  v_and_b32 v95, 0xffff0000, v235
  v_pk_mul_f32 v[164:165], v[72:73], v[92:93]
  v_pk_add_f32 v[224:225], v[224:225], v[92:93]
  v_pk_fma_f32 v[226:227], v[92:93], v[92:93], v[226:227]
  v_pk_add_f32 v[216:217], v[216:217], v[164:165]
  v_pk_fma_f32 v[218:219], v[164:165], v[72:73], v[218:219]
  v_pk_fma_f32 v[220:221], v[164:165], v[164:165], v[220:221]
  v_pk_fma_f32 v[222:223], v[164:165], v[92:93], v[222:223]
  v_pk_mul_f32 v[166:167], v[74:75], v[94:95]
  v_pk_add_f32 v[224:225], v[224:225], v[94:95]
  v_pk_fma_f32 v[226:227], v[94:95], v[94:95], v[226:227]
  v_pk_add_f32 v[216:217], v[216:217], v[166:167]
  v_pk_fma_f32 v[218:219], v[166:167], v[74:75], v[218:219]
  v_pk_fma_f32 v[220:221], v[166:167], v[166:167], v[220:221]
  v_pk_fma_f32 v[222:223], v[166:167], v[94:95], v[222:223]
  v_lshlrev_b32_e64 v96, 16, v236
  v_and_b32 v97, 0xffff0000, v236
  v_lshlrev_b32_e64 v98, 16, v237
  v_and_b32 v99, 0xffff0000, v237
  s_add_u32 m0, s75, 4096
  s_add_u32 s14, s74, 20480
  buffer_load_dwordx4 v244, s[56:59], s14 offen lds
  buffer_load_dwordx4 v245, s[56:59], s14 offen offset:2048 lds
  v_pk_mul_f32 v[168:169], v[76:77], v[96:97]
  v_pk_add_f32 v[224:225], v[224:225], v[96:97]
  v_pk_fma_f32 v[226:227], v[96:97], v[96:97], v[226:227]
  v_pk_add_f32 v[216:217], v[216:217], v[168:169]
  v_pk_fma_f32 v[218:219], v[168:169], v[76:77], v[218:219]
  v_pk_fma_f32 v[220:221], v[168:169], v[168:169], v[220:221]
  v_pk_fma_f32 v[222:223], v[168:169], v[96:97], v[222:223]
  v_pk_mul_f32 v[170:171], v[78:79], v[98:99]
  v_pk_add_f32 v[224:225], v[224:225], v[98:99]
  v_pk_fma_f32 v[226:227], v[98:99], v[98:99], v[226:227]
  v_pk_add_f32 v[216:217], v[216:217], v[170:171]
  v_pk_fma_f32 v[218:219], v[170:171], v[78:79], v[218:219]
  v_pk_fma_f32 v[220:221], v[170:171], v[170:171], v[220:221]
  v_pk_fma_f32 v[222:223], v[170:171], v[98:99], v[222:223]
  v_lshlrev_b32_e64 v100, 16, v238
  v_and_b32 v101, 0xffff0000, v238
  v_lshlrev_b32_e64 v102, 16, v239
  v_and_b32 v103, 0xffff0000, v239
  v_pk_mul_f32 v[172:173], v[80:81], v[100:101]
  v_pk_add_f32 v[224:225], v[224:225], v[100:101]
  v_pk_fma_f32 v[226:227], v[100:101], v[100:101], v[226:227]
  v_pk_add_f32 v[216:217], v[216:217], v[172:173]
  v_pk_fma_f32 v[218:219], v[172:173], v[80:81], v[218:219]
  v_pk_fma_f32 v[220:221], v[172:173], v[172:173], v[220:221]
  v_pk_fma_f32 v[222:223], v[172:173], v[100:101], v[222:223]
  v_pk_mul_f32 v[174:175], v[82:83], v[102:103]
  v_pk_add_f32 v[224:225], v[224:225], v[102:103]
  v_pk_fma_f32 v[226:227], v[102:103], v[102:103], v[226:227]
  v_pk_add_f32 v[216:217], v[216:217], v[174:175]
  v_pk_fma_f32 v[218:219], v[174:175], v[82:83], v[218:219]
  v_pk_fma_f32 v[220:221], v[174:175], v[174:175], v[220:221]
  v_pk_fma_f32 v[222:223], v[174:175], v[102:103], v[222:223]
  v_lshlrev_b32_e64 v104, 16, v240
  v_and_b32 v105, 0xffff0000, v240
  v_lshlrev_b32_e64 v106, 16, v241
  v_and_b32 v107, 0xffff0000, v241
  s_add_u32 m0, s75, 8192
  s_add_u32 s14, s74, 40960
  buffer_load_dwordx4 v244, s[56:59], s14 offen lds
  v_pk_mul_f32 v[176:177], v[84:85], v[104:105]
  v_pk_add_f32 v[224:225], v[224:225], v[104:105]
  v_pk_fma_f32 v[226:227], v[104:105], v[104:105], v[226:227]
  v_pk_add_f32 v[216:217], v[216:217], v[176:177]
  v_pk_fma_f32 v[218:219], v[176:177], v[84:85], v[218:219]
  v_pk_fma_f32 v[220:221], v[176:177], v[176:177], v[220:221]
  v_pk_fma_f32 v[222:223], v[176:177], v[104:105], v[222:223]
  v_pk_mul_f32 v[178:179], v[86:87], v[106:107]
  v_pk_add_f32 v[224:225], v[224:225], v[106:107]
  v_pk_fma_f32 v[226:227], v[106:107], v[106:107], v[226:227]
  v_pk_add_f32 v[216:217], v[216:217], v[178:179]
  v_pk_fma_f32 v[218:219], v[178:179], v[86:87], v[218:219]
  v_pk_fma_f32 v[220:221], v[178:179], v[178:179], v[220:221]
  v_pk_fma_f32 v[222:223], v[178:179], v[106:107], v[222:223]
  v_add_f32 v212, v212, v213
  v_add_f32 v214, v214, v215
  v_add_f32 v216, v216, v217
  v_add_f32 v218, v218, v219
  v_add_f32 v220, v220, v221
  v_add_f32 v222, v222, v223
  v_add_f32 v224, v224, v225
  v_add_f32 v226, v226, v227
  v_permlane16_swap_b32 v212, v220
  v_permlane16_swap_b32 v214, v222
  v_permlane16_swap_b32 v216, v224
  v_permlane16_swap_b32 v218, v226
  v_add_f32 v228, v212, v220
  v_add_f32 v229, v214, v222
  v_add_f32 v230, v216, v224
  v_add_f32 v231, v218, v226
  v_mov_b32 v212, v228
  v_mov_b32 v213, v229
  v_mov_b32 v214, v230
  v_mov_b32 v215, v231
  v_permlane32_swap_b32 v228, v212
  v_permlane32_swap_b32 v229, v213
  v_permlane32_swap_b32 v230, v214
  v_permlane32_swap_b32 v231, v215
  s_movk_i32 s14, 0xff
  v_add_f32 v228, v228, v212
  v_add_f32 v229, v229, v213
  v_add_f32 v230, v230, v214
  v_add_f32 v231, v231, v215
  s_lshr_b32 s15, s8, 0
  v_mov_b32_e64 v212, s15
  v_bfi_b32 v228, s14, v212, v228
  s_lshr_b32 s15, s8, 8
  v_mov_b32 v213, s15
  v_bfi_b32 v229, s14, v213, v229
  s_lshr_b32 s15, s8, 16
  v_mov_b32 v214, s15
  v_bfi_b32 v230, s14, v214, v230
  s_lshr_b32 s15, s8, 24
  v_mov_b32 v215, s15
  v_bfi_b32 v231, s14, v215, v231
  s_mov_b32 exec_hi, 0
  s_cmp_eq_u32 s9, 0
  s_cbranch_scc1 slow_51
  buffer_store_dwordx4 v[228:231], v2, s[52:55], s13 offen
back_52:
  s_mov_b32 exec_hi, -1
  v_accvgpr_write_b32 a200, v232
  v_accvgpr_write_b32 a201, v233
  v_accvgpr_write_b32 a202, v234
  v_accvgpr_write_b32 a203, v235
  v_accvgpr_write_b32 a204, v236
  v_accvgpr_write_b32 a205, v237
  v_accvgpr_write_b32 a206, v238
  v_accvgpr_write_b32 a207, v239
  v_accvgpr_write_b32 a208, v240
  v_accvgpr_write_b32 a209, v241
  v_lshrrev_b32_e64 v11, 2, v3
  v_mul_u32_u24 v11, 5120, v11
  v_and_b32_e64 v12, 3, v3
  v_lshl_add_u32 v11, v12, 4, v11
  v_lshrrev_b32_e64 v12, 1, v4
  v_lshl_add_u32 v11, v12, 6, v11
  v_and_b32_e64 v12, 1, v4
  v_lshl_add_u32 v47, v12, 3, v11
  s_lshl_b32 s88, s5, 2
  s_add_u32 s88, s88, s7
  s_mul_i32 s88, s88, 20480
  s_mul_i32 s14, s6, 640
  s_add_u32 s88, s88, s14
  s_add_u32 s88, s88, 4194304
  v_accvgpr_read_b32 v190, a230
  v_accvgpr_read_b32 v191, a231
  v_accvgpr_read_b32 v192, a232
  v_accvgpr_read_b32 v193, a233
  v_accvgpr_read_b32 v194, a234
  v_accvgpr_read_b32 v195, a235
  v_accvgpr_read_b32 v196, a236
  v_accvgpr_read_b32 v197, a237
  v_accvgpr_read_b32 v198, a238
  v_accvgpr_read_b32 v199, a239
  v_lshlrev_b32 v108, 16, v190
  v_and_b32 v109, 0xffff0000, v190
  v_lshlrev_b32_e64 v110, 16, v191
  v_and_b32 v111, 0xffff0000, v191
  v_lshlrev_b32_e64 v112, 16, v192
  v_and_b32 v113, 0xffff0000, v192
  v_lshlrev_b32_e64 v114, 16, v193
  v_and_b32 v115, 0xffff0000, v193
  v_lshlrev_b32_e64 v116, 16, v194
  v_and_b32 v117, 0xffff0000, v194
  v_lshlrev_b32_e64 v118, 16, v195
  v_and_b32 v119, 0xffff0000, v195
  v_lshlrev_b32_e64 v120, 16, v196
  v_and_b32 v121, 0xffff0000, v196
  v_lshlrev_b32_e64 v122, 16, v197
  v_and_b32 v123, 0xffff0000, v197
  v_lshlrev_b32_e64 v124, 16, v198
  v_and_b32 v125, 0xffff0000, v198
  v_lshlrev_b32_e64 v126, 16, v199
  v_and_b32 v127, 0xffff0000, v199
  s_lshl_b32 s87, s3, 8
  s_lshr_b32 s13, s7, 1
  s_lshl_b32 s13, s13, 7
  s_add_u32 s87, s87, s13
  s_and_b32 s13, s7, 1
  s_lshl_b32 s13, s13, 3
  s_add_u32 s87, s87, s13
  s_add_u32 s87, s87, 8192
  v_and_b32 v46, 7, v1
  v_lshlrev_b32_e64 v46, 4, v46
  s_add_u32 s34, s76, 4194304
  s_add_u32 s35, s34, 20480
  s_lshl_b32 s44, s5, 5
  s_lshl_b32 s13, s6, 2
  s_add_u32 s44, s44, s13
  s_add_u32 s44, s44, s7
  v_and_b32 v11, 31, v1
  v_lshlrev_b32 v11, 4, v11
  v_lshrrev_b32_e64 v12, 5, v1
  v_lshl_add_u32 v11, v12, 14, v11
  s_mov_b32 s14, 0x0c0c0400
  s_mov_b32 s15, 0x04000c0c
  s_add_u32 s89, s12, 4096
  s_add_u32 s90, s12, 8192
  s_add_u32 s91, s12, 12288
stpoll_53:
  buffer_load_dwordx4 v[128:131], v11, s[52:55], s12 offen sc1
  buffer_load_dwordx4 v[132:135], v11, s[52:55], s89 offen sc1
  buffer_load_dwordx4 v[136:139], v11, s[52:55], s90 offen sc1
  buffer_load_dwordx4 v[140:143], v11, s[52:55], s91 offen sc1
  s_waitcnt vmcnt(0)
  v_perm_b32 v212, v129, v128, s14
  v_perm_b32 v213, v131, v130, s15
  v_perm_b32 v214, v133, v132, s14
  v_perm_b32 v215, v135, v134, s15
  v_perm_b32 v216, v137, v136, s14
  v_perm_b32 v217, v139, v138, s15
  v_perm_b32 v218, v141, v140, s14
  v_perm_b32 v219, v143, v142, s15
  v_or_b32 v212, v212, v213
  v_or_b32 v214, v214, v215
  v_or_b32 v216, v216, v217
  v_or_b32_e64 v218, v218, v219
  v_min3_u32 v13, v212, v214, s8
  v_max3_u32 v14, v212, v214, s8
  v_min3_u32 v13, v13, v216, v218
  v_max3_u32 v14, v14, v216, v218
  v_cmp_ne_u32 vcc, v13, v14
  s_sub_u32 s10, s10, 1
  s_cmp_gt_i32 s10, 0
  s_cbranch_scc0 giveup_55
  s_cbranch_vccnz stpoll_53
giveup_55:
  v_pk_add_f32 v[128:129], v[128:129], v[132:133]
  v_pk_add_f32 v[136:137], v[136:137], v[140:141]
  v_pk_add_f32 v[130:131], v[130:131], v[134:135]
  v_pk_add_f32 v[138:139], v[138:139], v[142:143]
  v_pk_add_f32 v[128:129], v[128:129], v[136:137]
  v_pk_add_f32 v[130:131], v[130:131], v[138:139]
  v_mov_b32 v132, v128
  v_mov_b32 v133, v129
  v_mov_b32 v134, v130
  v_mov_b32 v135, v131
  v_permlane32_swap_b32 v128, v132
  v_permlane32_swap_b32 v129, v133
  v_permlane32_swap_b32 v130, v134
  v_permlane32_swap_b32 v131, v135
  v_add_f32 v212, v128, v132
  v_add_f32 v213, v129, v133
  v_add_f32 v214, v130, v134
  v_add_f32 v215, v131, v135
  v_mov_b32 v216, v212
  v_mov_b32 v217, v213
  v_mov_b32 v218, v214
  v_mov_b32 v219, v215
  v_permlane16_swap_b32 v212, v216
  v_permlane16_swap_b32 v213, v217
  v_permlane16_swap_b32 v214, v218
  v_permlane16_swap_b32 v215, v219
  v_mul_f32 v200, 0x3acccccd, v212
  v_mul_f32 v204, 0x3acccccd, v213
  v_fma_f32 v204, -v200, v200, v204
  v_max_f32 v204, 0, v204
  v_add_f32 v204, 0x3727c5ac, v204
  v_rsq_f32 v202, v204
  s_nop 0
  v_mul_f32_e64 v203, v200, v202
  v_fma_f32 v204, v202, v214, v212
  v_fma_f32 v204, -v203, v218, v204
  v_mul_f32_e64 v205, v202, v216
  v_fma_f32 v205, 2.0, v215, v205
  v_fma_f32 v205, v202, v205, v213
  v_fma_f32 v214, v202, v217, v214
  v_mul_f32_e64 v219, v203, v219
  v_fma_f32 v214, -2.0, v214, v219
  v_fma_f32 v205, v203, v214, v205
  v_mul_f32 v204, 0x3acccccd, v204
  v_mul_f32 v205, 0x3acccccd, v205
  v_fma_f32 v205, -v204, v204, v205
  v_max_f32_e64 v205, 0, v205
  v_add_f32 v205, 0x3727c5ac, v205
  v_rsq_f32 v206, v205
  s_nop 0
  v_mul_f32_e64 v207, v204, v206
  v_pk_fma_f32 v[160:161], v[68:69], v[202:203], v[202:203] op_sel:[0,0,1] op_sel_hi:[1,0,1] neg_lo:[0,0,1] neg_hi:[0,0,1]
  v_pk_fma_f32 v[162:163], v[70:71], v[202:203], v[202:203] op_sel:[0,0,1] op_sel_hi:[1,0,1] neg_lo:[0,0,1] neg_hi:[0,0,1]
  v_pk_fma_f32 v[164:165], v[72:73], v[202:203], v[202:203] op_sel:[0,0,1] op_sel_hi:[1,0,1] neg_lo:[0,0,1] neg_hi:[0,0,1]
  v_pk_fma_f32 v[166:167], v[74:75], v[202:203], v[202:203] op_sel:[0,0,1] op_sel_hi:[1,0,1] neg_lo:[0,0,1] neg_hi:[0,0,1]
  v_pk_fma_f32 v[168:169], v[76:77], v[202:203], v[202:203] op_sel:[0,0,1] op_sel_hi:[1,0,1] neg_lo:[0,0,1] neg_hi:[0,0,1]
  v_pk_fma_f32 v[170:171], v[78:79], v[202:203], v[202:203] op_sel:[0,0,1] op_sel_hi:[1,0,1] neg_lo:[0,0,1] neg_hi:[0,0,1]
  v_pk_fma_f32 v[172:173], v[80:81], v[202:203], v[202:203] op_sel:[0,0,1] op_sel_hi:[1,0,1] neg_lo:[0,0,1] neg_hi:[0,0,1]
  v_pk_fma_f32 v[174:175], v[82:83], v[202:203], v[202:203] op_sel:[0,0,1] op_sel_hi:[1,0,1] neg_lo:[0,0,1] neg_hi:[0,0,1]
  v_pk_fma_f32 v[176:177], v[84:85], v[202:203], v[202:203] op_sel:[0,0,1] op_sel_hi:[1,0,1] neg_lo:[0,0,1] neg_hi:[0,0,1]
  v_pk_fma_f32 v[178:179], v[86:87], v[202:203], v[202:203] op_sel:[0,0,1] op_sel_hi:[1,0,1] neg_lo:[0,0,1] neg_hi:[0,0,1]
  v_pk_fma_f32 v[68:69], v[160:161], v[88:89], v[68:69]
  v_pk_fma_f32 v[70:71], v[162:163], v[90:91], v[70:71]
  v_pk_fma_f32 v[72:73], v[164:165], v[92:93], v[72:73]
  v_pk_fma_f32 v[74:75], v[166:167], v[94:95], v[74:75]
  v_pk_fma_f32 v[76:77], v[168:169], v[96:97], v[76:77]
  v_pk_fma_f32 v[78:79], v[170:171], v[98:99], v[78:79]
  v_pk_fma_f32 v[80:81], v[172:173], v[100:101], v[80:81]
  v_pk_fma_f32 v[82:83], v[174:175], v[102:103], v[82:83]
  v_pk_fma_f32 v[84:85], v[176:177], v[104:105], v[84:85]
  v_pk_fma_f32 v[86:87], v[178:179], v[106:107], v[86:87]
  v_pk_fma_f32 v[160:161], v[68:69], v[206:207], v[206:207] op_sel:[0,0,1] op_sel_hi:[1,0,1] neg_lo:[0,0,1] neg_hi:[0,0,1]
  v_pk_fma_f32 v[162:163], v[70:71], v[206:207], v[206:207] op_sel:[0,0,1] op_sel_hi:[1,0,1] neg_lo:[0,0,1] neg_hi:[0,0,1]
  v_pk_fma_f32 v[164:165], v[72:73], v[206:207], v[206:207] op_sel:[0,0,1] op_sel_hi:[1,0,1] neg_lo:[0,0,1] neg_hi:[0,0,1]
  v_pk_fma_f32 v[166:167], v[74:75], v[206:207], v[206:207] op_sel:[0,0,1] op_sel_hi:[1,0,1] neg_lo:[0,0,1] neg_hi:[0,0,1]
  v_pk_fma_f32 v[168:169], v[76:77], v[206:207], v[206:207] op_sel:[0,0,1] op_sel_hi:[1,0,1] neg_lo:[0,0,1] neg_hi:[0,0,1]
  v_pk_fma_f32 v[170:171], v[78:79], v[206:207], v[206:207] op_sel:[0,0,1] op_sel_hi:[1,0,1] neg_lo:[0,0,1] neg_hi:[0,0,1]
  v_pk_fma_f32 v[172:173], v[80:81], v[206:207], v[206:207] op_sel:[0,0,1] op_sel_hi:[1,0,1] neg_lo:[0,0,1] neg_hi:[0,0,1]
  v_pk_fma_f32 v[174:175], v[82:83], v[206:207], v[206:207] op_sel:[0,0,1] op_sel_hi:[1,0,1] neg_lo:[0,0,1] neg_hi:[0,0,1]
  v_pk_fma_f32 v[176:177], v[84:85], v[206:207], v[206:207] op_sel:[0,0,1] op_sel_hi:[1,0,1] neg_lo:[0,0,1] neg_hi:[0,0,1]
  v_pk_fma_f32 v[178:179], v[86:87], v[206:207], v[206:207] op_sel:[0,0,1] op_sel_hi:[1,0,1] neg_lo:[0,0,1] neg_hi:[0,0,1]
  v_cvt_pk_bf16_f32 v180, v160, v161
  v_cvt_pk_bf16_f32 v181, v162, v163
  v_cvt_pk_bf16_f32 v182, v164, v165
  v_cvt_pk_bf16_f32 v183, v166, v167
  v_cvt_pk_bf16_f32 v184, v168, v169
  v_cvt_pk_bf16_f32 v185, v170, v171
  v_cvt_pk_bf16_f32 v186, v172, v173
  v_cvt_pk_bf16_f32 v187, v174, v175
  v_cvt_pk_bf16_f32 v188, v176, v177
  v_cvt_pk_bf16_f32 v189, v178, v179
  s_cmp_eq_u32 s9, 0
  s_cbranch_scc1 slow_56
  buffer_store_dwordx2 v[180:181], v47, s[52:55], s88 offen offset:0
  buffer_store_dwordx2 v[182:183], v47, s[52:55], s88 offen offset:128
  buffer_store_dwordx2 v[184:185], v47, s[52:55], s88 offen offset:256
  buffer_store_dwordx2 v[186:187], v47, s[52:55], s88 offen offset:384
  buffer_store_dwordx2 v[188:189], v47, s[52:55], s88 offen offset:512
back_57:
  v_pk_fma_f32 v[68:69], v[160:161], v[108:109], v[68:69]
  v_pk_fma_f32 v[70:71], v[162:163], v[110:111], v[70:71]
  v_pk_fma_f32 v[72:73], v[164:165], v[112:113], v[72:73]
  v_pk_fma_f32 v[74:75], v[166:167], v[114:115], v[74:75]
  v_pk_fma_f32 v[76:77], v[168:169], v[116:117], v[76:77]
  v_pk_fma_f32 v[78:79], v[170:171], v[118:119], v[78:79]
  v_pk_fma_f32 v[80:81], v[172:173], v[120:121], v[80:81]
  v_pk_fma_f32 v[82:83], v[174:175], v[122:123], v[82:83]
  v_pk_fma_f32 v[84:85], v[176:177], v[124:125], v[84:85]
  v_pk_fma_f32 v[86:87], v[178:179], v[126:127], v[86:87]
  v_accvgpr_write_b32 a210, v68
  v_accvgpr_write_b32 a211, v69
  v_accvgpr_write_b32 a212, v70
  v_accvgpr_write_b32 a213, v71
  v_accvgpr_write_b32 a214, v72
  v_accvgpr_write_b32 a215, v73
  v_accvgpr_write_b32 a216, v74
  v_accvgpr_write_b32 a217, v75
  v_accvgpr_write_b32 a218, v76
  v_accvgpr_write_b32 a219, v77
  v_accvgpr_write_b32 a220, v78
  v_accvgpr_write_b32 a221, v79
  v_accvgpr_write_b32 a222, v80
  v_accvgpr_write_b32 a223, v81
  v_accvgpr_write_b32 a224, v82
  v_accvgpr_write_b32 a225, v83
  v_accvgpr_write_b32 a226, v84
  v_accvgpr_write_b32 a227, v85
  v_accvgpr_write_b32 a228, v86
  v_accvgpr_write_b32 a229, v87
  s_add_u32 s13, s84, 8192
  s_waitcnt vmcnt(0)
  v_mov_b32 v15, s8
  s_mov_b64 exec, 1
  s_cmp_eq_u32 s9, 0
  s_cbranch_scc1 slow_58
  buffer_store_dword v15, off, s[52:55], s13
back_59:
  s_mov_b64 exec, -1
  s_cmp_lg_u32 s44, 992
  s_cbranch_scc1 skip_60
  v_mov_b32 v15, s8
  s_mov_b64 exec, 1
  buffer_store_dword v15, off, s[52:55], 0 sc1
  s_mov_b64 exec, -1
skip_60:
again_61:
  buffer_load_dwordx2 v[42:43], v46, s[52:55], s87 offen sc1
  s_sub_u32 s10, s10, 1
  s_cmp_gt_i32 s10, 0
  s_waitcnt vmcnt(0)
  v_xor_b32 v15, s8, v42
  v_xor_b32 v14, s8, v43
  v_or_b32 v15, v15, v14
  v_cmp_ne_u32 vcc, 0, v15
  s_cbranch_scc0 out_63
  s_cbranch_vccnz again_61
out_63:
ok_62:
  buffer_load_dwordx4 v[128:131], v0, s[52:55], s34 offen offset:1024 sc1
  buffer_load_dwordx4 v[132:135], v0, s[52:55], s35 offen offset:1024 sc1
  buffer_load_dwordx4 v[136:139], v0, s[52:55], s34 offen offset:1280 sc1
  buffer_load_dwordx4 v[140:143], v0, s[52:55], s35 offen offset:1280 sc1
  buffer_load_dwordx4 v[144:147], v0, s[52:55], s34 offen offset:1536 sc1
  buffer_load_dwordx4 v[148:151], v0, s[52:55], s35 offen offset:1536 sc1
  buffer_load_dwordx4 v[152:155], v0, s[52:55], s34 offen offset:1792 sc1
  buffer_load_dwordx4 v[156:159], v0, s[52:55], s35 offen offset:1792 sc1
  ds_read_b128 v[88:91], v5 offset:20480
  ds_read_b128 v[92:95], v5 offset:22528
  ds_read_b128 v[96:99], v5 offset:24576
  ds_read_b128 v[100:103], v5 offset:26624
  ds_read_b128 v[104:107], v5 offset:28672
  s_waitcnt vmcnt(6)
  s_waitcnt lgkmcnt(4)
  v_mfma_f32_16x16x32_bf16 v[48:51], v[128:131], v[88:91], 0
  ds_read_b128 v[108:111], v6 offset:20480
  v_mfma_f32_16x16x32_bf16 v[52:55], v[132:135], v[88:91], 0
  buffer_load_dwordx4 v[160:163], v0, s[52:55], s34 offen offset:2048 sc1
  s_waitcnt lgkmcnt(4)
  v_mfma_f32_16x16x32_bf16 v[56:59], v[128:131], v[92:95], 0
  ds_read_b128 v[112:115], v6 offset:22528
  v_mfma_f32_16x16x32_bf16 v[60:63], v[132:135], v[92:95], 0
  buffer_load_dwordx4 v[164:167], v0, s[52:55], s35 offen offset:2048 sc1
  s_waitcnt lgkmcnt(4)
  v_mfma_f32_16x16x32_bf16 v[64:67], v[128:131], v[96:99], 0
  ds_read_b128 v[116:119], v6 offset:24576
  v_mfma_f32_16x16x32_bf16 v[68:71], v[132:135], v[96:99], 0
  s_waitcnt lgkmcnt(4)
  v_mfma_f32_16x16x32_bf16 v[72:75], v[128:131], v[100:103], 0
  ds_read_b128 v[120:123], v6 offset:26624
  v_mfma_f32_16x16x32_bf16 v[76:79], v[132:135], v[100:103], 0
  s_waitcnt lgkmcnt(4)
  v_mfma_f32_16x16x32_bf16 v[80:83], v[128:131], v[104:107], 0
  ds_read_b128 v[124:127], v6 offset:28672
  v_mfma_f32_16x16x32_bf16 v[84:87], v[132:135], v[104:107], 0
  s_waitcnt vmcnt(6)
  s_waitcnt lgkmcnt(2)
  v_mfma_f32_16x16x32_bf16 v[48:51], v[136:139], v[108:111], v[48:51]
  ds_read_b128 v[88:91], v5 offset:30720
  v_mfma_f32_16x16x32_bf16 v[52:55], v[140:143], v[108:111], v[52:55]
  buffer_load_dwordx4 v[168:171], v0, s[52:55], s34 offen offset:2304 sc1
  v_mfma_f32_16x16x32_bf16 v[56:59], v[136:139], v[112:115], v[56:59]
  ds_read_b128 v[92:95], v5 offset:32768
  v_mfma_f32_16x16x32_bf16 v[60:63], v[140:143], v[112:115], v[60:63]
  buffer_load_dwordx4 v[172:175], v0, s[52:55], s35 offen offset:2304 sc1
  v_mfma_f32_16x16x32_bf16 v[64:67], v[136:139], v[116:119], v[64:67]
  ds_read_b128 v[96:99], v5 offset:34816
  v_mfma_f32_16x16x32_bf16 v[68:71], v[140:143], v[116:119], v[68:71]
  s_waitcnt lgkmcnt(3)
  v_mfma_f32_16x16x32_bf16 v[72:75], v[136:139], v[120:123], v[72:75]
  ds_read_b128 v[100:103], v5 offset:36864
  v_mfma_f32_16x16x32_bf16 v[76:79], v[140:143], v[120:123], v[76:79]
  v_mfma_f32_16x16x32_bf16 v[80:83], v[136:139], v[124:127], v[80:83]
  ds_read_b128 v[104:107], v5 offset:38912
  v_mfma_f32_16x16x32_bf16 v[84:87], v[140:143], v[124:127], v[84:87]
  s_waitcnt vmcnt(6)
  s_waitcnt lgkmcnt(2)
  v_mfma_f32_16x16x32_bf16 v[48:51], v[144:147], v[88:91], v[48:51]
  ds_read_b128 v[108:111], v6 offset:30720
  v_mfma_f32_16x16x32_bf16 v[52:55], v[148:151], v[88:91], v[52:55]
  buffer_load_dwordx4 v[176:179], v0, s[52:55], s34 offen offset:2560 sc1
  v_mfma_f32_16x16x32_bf16 v[56:59], v[144:147], v[92:95], v[56:59]
  ds_read_b128 v[112:115], v6 offset:32768
  v_mfma_f32_16x16x32_bf16 v[60:63], v[148:151], v[92:95], v[60:63]
  buffer_load_dwordx4 v[180:183], v0, s[52:55], s35 offen offset:2560 sc1
  v_mfma_f32_16x16x32_bf16 v[64:67], v[144:147], v[96:99], v[64:67]
  ds_read_b128 v[116:119], v6 offset:34816
  v_mfma_f32_16x16x32_bf16 v[68:71], v[148:151], v[96:99], v[68:71]
  s_waitcnt lgkmcnt(3)
  v_mfma_f32_16x16x32_bf16 v[72:75], v[144:147], v[100:103], v[72:75]
  ds_read_b128 v[120:123], v6 offset:36864
  v_mfma_f32_16x16x32_bf16 v[76:79], v[148:151], v[100:103], v[76:79]
  v_mfma_f32_16x16x32_bf16 v[80:83], v[144:147], v[104:107], v[80:83]
  ds_read_b128 v[124:127], v6 offset:38912
  v_mfma_f32_16x16x32_bf16 v[84:87], v[148:151], v[104:107], v[84:87]
  s_waitcnt vmcnt(6)
  s_waitcnt lgkmcnt(2)
  v_mfma_f32_16x16x32_bf16 v[48:51], v[152:155], v[108:111], v[48:51]
  ds_read_b128 v[88:91], v5 offset:40960
  v_mfma_f32_16x16x32_bf16 v[52:55], v[156:159], v[108:111], v[52:55]
  buffer_load_dwordx4 v[184:187], v0, s[52:55], s34 offen offset:2816 sc1
  v_mfma_f32_16x16x32_bf16 v[56:59], v[152:155], v[112:115], v[56:59]
  ds_read_b128 v[92:95], v5 offset:43008
  v_mfma_f32_16x16x32_bf16 v[60:63], v[156:159], v[112:115], v[60:63]
  buffer_load_dwordx4 v[188:191], v0, s[52:55], s35 offen offset:2816 sc1
  v_mfma_f32_16x16x32_bf16 v[64:67], v[152:155], v[116:119], v[64:67]
  ds_read_b128 v[96:99], v5 offset:45056
  v_mfma_f32_16x16x32_bf16 v[68:71], v[156:159], v[116:119], v[68:71]
  s_waitcnt lgkmcnt(3)
  v_mfma_f32_16x16x32_bf16 v[72:75], v[152:155], v[120:123], v[72:75]
  ds_read_b128 v[100:103], v5 offset:47104
  v_mfma_f32_16x16x32_bf16 v[76:79], v[156:159], v[120:123], v[76:79]
  v_mfma_f32_16x16x32_bf16 v[80:83], v[152:155], v[124:127], v[80:83]
  ds_read_b128 v[104:107], v5 offset:49152
  v_mfma_f32_16x16x32_bf16 v[84:87], v[156:159], v[124:127], v[84:87]
  s_waitcnt vmcnt(6)
  s_waitcnt lgkmcnt(2)
  v_mfma_f32_16x16x32_bf16 v[48:51], v[160:163], v[88:91], v[48:51]
  ds_read_b128 v[108:111], v6 offset:40960
  v_mfma_f32_16x16x32_bf16 v[52:55], v[164:167], v[88:91], v[52:55]
  buffer_load_dwordx4 v[128:131], v0, s[52:55], s34 offen offset:3072 sc1
  v_mfma_f32_16x16x32_bf16 v[56:59], v[160:163], v[92:95], v[56:59]
  ds_read_b128 v[112:115], v6 offset:43008
  v_mfma_f32_16x16x32_bf16 v[60:63], v[164:167], v[92:95], v[60:63]
  buffer_load_dwordx4 v[132:135], v0, s[52:55], s35 offen offset:3072 sc1
  v_mfma_f32_16x16x32_bf16 v[64:67], v[160:163], v[96:99], v[64:67]
  ds_read_b128 v[116:119], v6 offset:45056
  v_mfma_f32_16x16x32_bf16 v[68:71], v[164:167], v[96:99], v[68:71]
  s_waitcnt lgkmcnt(3)
  v_mfma_f32_16x16x32_bf16 v[72:75], v[160:163], v[100:103], v[72:75]
  ds_read_b128 v[120:123], v6 offset:47104
  v_mfma_f32_16x16x32_bf16 v[76:79], v[164:167], v[100:103], v[76:79]
  v_mfma_f32_16x16x32_bf16 v[80:83], v[160:163], v[104:107], v[80:83]
  ds_read_b128 v[124:127], v6 offset:49152
  v_mfma_f32_16x16x32_bf16 v[84:87], v[164:167], v[104:107], v[84:87]
  s_waitcnt vmcnt(6)
  s_waitcnt lgkmcnt(2)
  v_mfma_f32_16x16x32_bf16 v[48:51], v[168:171], v[108:111], v[48:51]
  ds_read_b128 v[88:91], v7 offset:0
  v_mfma_f32_16x16x32_bf16 v[52:55], v[172:175], v[108:111], v[52:55]
  buffer_load_dwordx4 v[136:139], v0, s[52:55], s34 offen offset:3328 sc1
  v_mfma_f32_16x16x32_bf16 v[56:59], v[168:171], v[112:115], v[56:59]
  ds_read_b128 v[92:95], v7 offset:2048
  v_mfma_f32_16x16x32_bf16 v[60:63], v[172:175], v[112:115], v[60:63]
  buffer_load_dwordx4 v[140:143], v0, s[52:55], s35 offen offset:3328 sc1
  v_mfma_f32_16x16x32_bf16 v[64:67], v[168:171], v[116:119], v[64:67]
  ds_read_b128 v[96:99], v7 offset:4096
  v_mfma_f32_16x16x32_bf16 v[68:71], v[172:175], v[116:119], v[68:71]
  s_waitcnt lgkmcnt(3)
  v_mfma_f32_16x16x32_bf16 v[72:75], v[168:171], v[120:123], v[72:75]
  ds_read_b128 v[100:103], v7 offset:6144
  v_mfma_f32_16x16x32_bf16 v[76:79], v[172:175], v[120:123], v[76:79]
  v_mfma_f32_16x16x32_bf16 v[80:83], v[168:171], v[124:127], v[80:83]
  ds_read_b128 v[104:107], v7 offset:8192
  v_mfma_f32_16x16x32_bf16 v[84:87], v[172:175], v[124:127], v[84:87]
  s_waitcnt vmcnt(6)
  s_waitcnt lgkmcnt(2)
  v_mfma_f32_16x16x32_bf16 v[48:51], v[176:179], v[88:91], v[48:51]
  ds_read_b128 v[108:111], v8 offset:0
  v_mfma_f32_16x16x32_bf16 v[52:55], v[180:183], v[88:91], v[52:55]
  buffer_load_dwordx4 v[144:147], v0, s[52:55], s34 offen offset:3584 sc1
  v_mfma_f32_16x16x32_bf16 v[56:59], v[176:179], v[92:95], v[56:59]
  ds_read_b128 v[112:115], v8 offset:2048
  v_mfma_f32_16x16x32_bf16 v[60:63], v[180:183], v[92:95], v[60:63]
  buffer_load_dwordx4 v[148:151], v0, s[52:55], s35 offen offset:3584 sc1
  v_mfma_f32_16x16x32_bf16 v[64:67], v[176:179], v[96:99], v[64:67]
  ds_read_b128 v[116:119], v8 offset:4096
  v_mfma_f32_16x16x32_bf16 v[68:71], v[180:183], v[96:99], v[68:71]
  s_waitcnt lgkmcnt(3)
  v_mfma_f32_16x16x32_bf16 v[72:75], v[176:179], v[100:103], v[72:75]
  ds_read_b128 v[120:123], v8 offset:6144
  v_mfma_f32_16x16x32_bf16 v[76:79], v[180:183], v[100:103], v[76:79]
  v_mfma_f32_16x16x32_bf16 v[80:83], v[176:179], v[104:107], v[80:83]
  ds_read_b128 v[124:127], v8 offset:8192
  v_mfma_f32_16x16x32_bf16 v[84:87], v[180:183], v[104:107], v[84:87]
  s_waitcnt vmcnt(6)
  s_waitcnt lgkmcnt(2)
  v_mfma_f32_16x16x32_bf16 v[48:51], v[184:187], v[108:111], v[48:51]
  ds_read_b128 v[88:91], v7 offset:10240
  v_mfma_f32_16x16x32_bf16 v[52:55], v[188:191], v[108:111], v[52:55]
  buffer_load_dwordx4 v[152:155], v0, s[52:55], s34 offen offset:3840 sc1
  v_mfma_f32_16x16x32_bf16 v[56:59], v[184:187], v[112:115], v[56:59]
  ds_read_b128 v[92:95], v7 offset:12288
  v_mfma_f32_16x16x32_bf16 v[60:63], v[188:191], v[112:115], v[60:63]
  buffer_load_dwordx4 v[156:159], v0, s[52:55], s35 offen offset:3840 sc1
  v_mfma_f32_16x16x32_bf16 v[64:67], v[184:187], v[116:119], v[64:67]
  ds_read_b128 v[96:99], v7 offset:14336
  v_mfma_f32_16x16x32_bf16 v[68:71], v[188:191], v[116:119], v[68:71]
  s_waitcnt lgkmcnt(3)
  v_mfma_f32_16x16x32_bf16 v[72:75], v[184:187], v[120:123], v[72:75]
  ds_read_b128 v[100:103], v7 offset:16384
  v_mfma_f32_16x16x32_bf16 v[76:79], v[188:191], v[120:123], v[76:79]
  v_mfma_f32_16x16x32_bf16 v[80:83], v[184:187], v[124:127], v[80:83]
  ds_read_b128 v[104:107], v7 offset:18432
  v_mfma_f32_16x16x32_bf16 v[84:87], v[188:191], v[124:127], v[84:87]
  s_waitcnt vmcnt(6)
  s_waitcnt lgkmcnt(2)
  v_mfma_f32_16x16x32_bf16 v[48:51], v[128:131], v[88:91], v[48:51]
  ds_read_b128 v[108:111], v8 offset:10240
  v_mfma_f32_16x16x32_bf16 v[52:55], v[132:135], v[88:91], v[52:55]
  s_add_u32 s34, s34, 4096
  buffer_load_dwordx4 v[160:163], v0, s[52:55], s34 offen offset:0 sc1
  v_mfma_f32_16x16x32_bf16 v[56:59], v[128:131], v[92:95], v[56:59]
  ds_read_b128 v[112:115], v8 offset:12288
  v_mfma_f32_16x16x32_bf16 v[60:63], v[132:135], v[92:95], v[60:63]
  s_add_u32 s35, s35, 4096
  buffer_load_dwordx4 v[164:167], v0, s[52:55], s35 offen offset:0 sc1
  v_mfma_f32_16x16x32_bf16 v[64:67], v[128:131], v[96:99], v[64:67]
  ds_read_b128 v[116:119], v8 offset:14336
  v_mfma_f32_16x16x32_bf16 v[68:71], v[132:135], v[96:99], v[68:71]
  s_waitcnt lgkmcnt(3)
  v_mfma_f32_16x16x32_bf16 v[72:75], v[128:131], v[100:103], v[72:75]
  ds_read_b128 v[120:123], v8 offset:16384
  v_mfma_f32_16x16x32_bf16 v[76:79], v[132:135], v[100:103], v[76:79]
  v_mfma_f32_16x16x32_bf16 v[80:83], v[128:131], v[104:107], v[80:83]
  ds_read_b128 v[124:127], v8 offset:18432
  v_mfma_f32_16x16x32_bf16 v[84:87], v[132:135], v[104:107], v[84:87]
  s_waitcnt vmcnt(6)
  s_waitcnt lgkmcnt(2)
  v_mfma_f32_16x16x32_bf16 v[48:51], v[136:139], v[108:111], v[48:51]
  ds_read_b128 v[88:91], v7 offset:20480
  v_mfma_f32_16x16x32_bf16 v[52:55], v[140:143], v[108:111], v[52:55]
  buffer_load_dwordx4 v[168:171], v0, s[52:55], s34 offen offset:256 sc1
  v_mfma_f32_16x16x32_bf16 v[56:59], v[136:139], v[112:115], v[56:59]
  ds_read_b128 v[92:95], v7 offset:22528
  v_mfma_f32_16x16x32_bf16 v[60:63], v[140:143], v[112:115], v[60:63]
  buffer_load_dwordx4 v[172:175], v0, s[52:55], s35 offen offset:256 sc1
  v_mfma_f32_16x16x32_bf16 v[64:67], v[136:139], v[116:119], v[64:67]
  ds_read_b128 v[96:99], v7 offset:24576
  v_mfma_f32_16x16x32_bf16 v[68:71], v[140:143], v[116:119], v[68:71]
  s_waitcnt lgkmcnt(3)
  v_mfma_f32_16x16x32_bf16 v[72:75], v[136:139], v[120:123], v[72:75]
  ds_read_b128 v[100:103], v7 offset:26624
  v_mfma_f32_16x16x32_bf16 v[76:79], v[140:143], v[120:123], v[76:79]
  v_mfma_f32_16x16x32_bf16 v[80:83], v[136:139], v[124:127], v[80:83]
  ds_read_b128 v[104:107], v7 offset:28672
  v_mfma_f32_16x16x32_bf16 v[84:87], v[140:143], v[124:127], v[84:87]
  s_waitcnt vmcnt(6)
  s_waitcnt lgkmcnt(2)
  v_mfma_f32_16x16x32_bf16 v[48:51], v[144:147], v[88:91], v[48:51]
  ds_read_b128 v[108:111], v8 offset:20480
  v_mfma_f32_16x16x32_bf16 v[52:55], v[148:151], v[88:91], v[52:55]
  buffer_load_dwordx4 v[176:179], v0, s[52:55], s34 offen offset:512 sc1
  v_mfma_f32_16x16x32_bf16 v[56:59], v[144:147], v[92:95], v[56:59]
  ds_read_b128 v[112:115], v8 offset:22528
  v_mfma_f32_16x16x32_bf16 v[60:63], v[148:151], v[92:95], v[60:63]
  buffer_load_dwordx4 v[180:183], v0, s[52:55], s35 offen offset:512 sc1
  v_mfma_f32_16x16x32_bf16 v[64:67], v[144:147], v[96:99], v[64:67]
  ds_read_b128 v[116:119], v8 offset:24576
  v_mfma_f32_16x16x32_bf16 v[68:71], v[148:151], v[96:99], v[68:71]
  s_waitcnt lgkmcnt(3)
  v_mfma_f32_16x16x32_bf16 v[72:75], v[144:147], v[100:103], v[72:75]
  ds_read_b128 v[120:123], v8 offset:26624
  v_mfma_f32_16x16x32_bf16 v[76:79], v[148:151], v[100:103], v[76:79]
  v_mfma_f32_16x16x32_bf16 v[80:83], v[144:147], v[104:107], v[80:83]
  ds_read_b128 v[124:127], v8 offset:28672
  v_mfma_f32_16x16x32_bf16 v[84:87], v[148:151], v[104:107], v[84:87]
  s_waitcnt vmcnt(6)
  s_waitcnt lgkmcnt(2)
  v_mfma_f32_16x16x32_bf16 v[48:51], v[152:155], v[108:111], v[48:51]
  ds_read_b128 v[88:91], v7 offset:30720
  v_mfma_f32_16x16x32_bf16 v[52:55], v[156:159], v[108:111], v[52:55]
  buffer_load_dwordx4 v[184:187], v0, s[52:55], s34 offen offset:768 sc1
  v_mfma_f32_16x16x32_bf16 v[56:59], v[152:155], v[112:115], v[56:59]
  ds_read_b128 v[92:95], v7 offset:32768
  v_mfma_f32_16x16x32_bf16 v[60:63], v[156:159], v[112:115], v[60:63]
  buffer_load_dwordx4 v[188:191], v0, s[52:55], s35 offen offset:768 sc1
  v_mfma_f32_16x16x32_bf16 v[64:67], v[152:155], v[116:119], v[64:67]
  ds_read_b128 v[96:99], v7 offset:34816
  v_mfma_f32_16x16x32_bf16 v[68:71], v[156:159], v[116:119], v[68:71]
  s_waitcnt lgkmcnt(3)
  v_mfma_f32_16x16x32_bf16 v[72:75], v[152:155], v[120:123], v[72:75]
  ds_read_b128 v[100:103], v7 offset:36864
  v_mfma_f32_16x16x32_bf16 v[76:79], v[156:159], v[120:123], v[76:79]
  v_mfma_f32_16x16x32_bf16 v[80:83], v[152:155], v[124:127], v[80:83]
  ds_read_b128 v[104:107], v7 offset:38912
  v_mfma_f32_16x16x32_bf16 v[84:87], v[156:159], v[124:127], v[84:87]
  s_waitcnt vmcnt(6)
  s_waitcnt lgkmcnt(2)
  v_mfma_f32_16x16x32_bf16 v[48:51], v[160:163], v[88:91], v[48:51]
  ds_read_b128 v[108:111], v8 offset:30720
  v_mfma_f32_16x16x32_bf16 v[52:55], v[164:167], v[88:91], v[52:55]
  s_sub_u32 s34, s34, 4096
  buffer_load_dwordx4 v[128:131], v0, s[52:55], s34 offen offset:0 sc1
  v_mfma_f32_16x16x32_bf16 v[56:59], v[160:163], v[92:95], v[56:59]
  ds_read_b128 v[112:115], v8 offset:32768
  v_mfma_f32_16x16x32_bf16 v[60:63], v[164:167], v[92:95], v[60:63]
  s_sub_u32 s35, s35, 4096
  buffer_load_dwordx4 v[132:135], v0, s[52:55], s35 offen offset:0 sc1
  v_mfma_f32_16x16x32_bf16 v[64:67], v[160:163], v[96:99], v[64:67]
  ds_read_b128 v[116:119], v8 offset:34816
  v_mfma_f32_16x16x32_bf16 v[68:71], v[164:167], v[96:99], v[68:71]
  s_waitcnt lgkmcnt(3)
  v_mfma_f32_16x16x32_bf16 v[72:75], v[160:163], v[100:103], v[72:75]
  ds_read_b128 v[120:123], v8 offset:36864
  v_mfma_f32_16x16x32_bf16 v[76:79], v[164:167], v[100:103], v[76:79]
  v_mfma_f32_16x16x32_bf16 v[80:83], v[160:163], v[104:107], v[80:83]
  ds_read_b128 v[124:127], v8 offset:38912
  v_mfma_f32_16x16x32_bf16 v[84:87], v[164:167], v[104:107], v[84:87]
  s_waitcnt vmcnt(6)
  s_waitcnt lgkmcnt(2)
  v_mfma_f32_16x16x32_bf16 v[48:51], v[168:171], v[108:111], v[48:51]
  ds_read_b128 v[88:91], v7 offset:40960
  v_mfma_f32_16x16x32_bf16 v[52:55], v[172:175], v[108:111], v[52:55]
  buffer_load_dwordx4 v[136:139], v0, s[52:55], s34 offen offset:256 sc1
  v_mfma_f32_16x16x32_bf16 v[56:59], v[168:171], v[112:115], v[56:59]
  ds_read_b128 v[92:95], v7 offset:43008
  v_mfma_f32_16x16x32_bf16 v[60:63], v[172:175], v[112:115], v[60:63]
  buffer_load_dwordx4 v[140:143], v0, s[52:55], s35 offen offset:256 sc1
  v_mfma_f32_16x16x32_bf16 v[64:67], v[168:171], v[116:119], v[64:67]
  ds_read_b128 v[96:99], v7 offset:45056
  v_mfma_f32_16x16x32_bf16 v[68:71], v[172:175], v[116:119], v[68:71]
  s_waitcnt lgkmcnt(3)
  v_mfma_f32_16x16x32_bf16 v[72:75], v[168:171], v[120:123], v[72:75]
  ds_read_b128 v[100:103], v7 offset:47104
  v_mfma_f32_16x16x32_bf16 v[76:79], v[172:175], v[120:123], v[76:79]
  v_mfma_f32_16x16x32_bf16 v[80:83], v[168:171], v[124:127], v[80:83]
  ds_read_b128 v[104:107], v7 offset:49152
  v_mfma_f32_16x16x32_bf16 v[84:87], v[172:175], v[124:127], v[84:87]
  s_waitcnt vmcnt(6)
  s_waitcnt lgkmcnt(2)
  v_mfma_f32_16x16x32_bf16 v[48:51], v[176:179], v[88:91], v[48:51]
  ds_read_b128 v[108:111], v8 offset:40960
  v_mfma_f32_16x16x32_bf16 v[52:55], v[180:183], v[88:91], v[52:55]
  buffer_load_dwordx4 v[144:147], v0, s[52:55], s34 offen offset:512 sc1
  v_mfma_f32_16x16x32_bf16 v[56:59], v[176:179], v[92:95], v[56:59]
  ds_read_b128 v[112:115], v8 offset:43008
  v_mfma_f32_16x16x32_bf16 v[60:63], v[180:183], v[92:95], v[60:63]
  buffer_load_dwordx4 v[148:151], v0, s[52:55], s35 offen offset:512 sc1
  v_mfma_f32_16x16x32_bf16 v[64:67], v[176:179], v[96:99], v[64:67]
  ds_read_b128 v[116:119], v8 offset:45056
  v_mfma_f32_16x16x32_bf16 v[68:71], v[180:183], v[96:99], v[68:71]
  s_waitcnt lgkmcnt(3)
  v_mfma_f32_16x16x32_bf16 v[72:75], v[176:179], v[100:103], v[72:75]
  ds_read_b128 v[120:123], v8 offset:47104
  v_mfma_f32_16x16x32_bf16 v[76:79], v[180:183], v[100:103], v[76:79]
  v_mfma_f32_16x16x32_bf16 v[80:83], v[176:179], v[104:107], v[80:83]
  ds_read_b128 v[124:127], v8 offset:49152
  v_mfma_f32_16x16x32_bf16 v[84:87], v[180:183], v[104:107], v[84:87]
  s_waitcnt vmcnt(6)
  s_barrier
  s_waitcnt lgkmcnt(2)
  v_mfma_f32_16x16x32_bf16 v[48:51], v[184:187], v[108:111], v[48:51]
  ds_read_b128 v[88:91], v5 offset:0
  v_mfma_f32_16x16x32_bf16 v[52:55], v[188:191], v[108:111], v[52:55]
  buffer_load_dwordx4 v[152:155], v0, s[52:55], s34 offen offset:768 sc1
  v_mfma_f32_16x16x32_bf16 v[56:59], v[184:187], v[112:115], v[56:59]
  ds_read_b128 v[92:95], v5 offset:2048
  v_mfma_f32_16x16x32_bf16 v[60:63], v[188:191], v[112:115], v[60:63]
  buffer_load_dwordx4 v[156:159], v0, s[52:55], s35 offen offset:768 sc1
  v_mfma_f32_16x16x32_bf16 v[64:67], v[184:187], v[116:119], v[64:67]
  ds_read_b128 v[96:99], v5 offset:4096
  v_mfma_f32_16x16x32_bf16 v[68:71], v[188:191], v[116:119], v[68:71]
  s_waitcnt lgkmcnt(3)
  v_mfma_f32_16x16x32_bf16 v[72:75], v[184:187], v[120:123], v[72:75]
  ds_read_b128 v[100:103], v5 offset:6144
  v_mfma_f32_16x16x32_bf16 v[76:79], v[188:191], v[120:123], v[76:79]
  v_mfma_f32_16x16x32_bf16 v[80:83], v[184:187], v[124:127], v[80:83]
  ds_read_b128 v[104:107], v5 offset:8192
  v_mfma_f32_16x16x32_bf16 v[84:87], v[188:191], v[124:127], v[84:87]
  s_waitcnt vmcnt(6)
  s_waitcnt lgkmcnt(2)
  v_mfma_f32_16x16x32_bf16 v[48:51], v[128:131], v[88:91], v[48:51]
  ds_read_b128 v[108:111], v6 offset:0
  v_mfma_f32_16x16x32_bf16 v[52:55], v[132:135], v[88:91], v[52:55]
  v_mfma_f32_16x16x32_bf16 v[56:59], v[128:131], v[92:95], v[56:59]
  ds_read_b128 v[112:115], v6 offset:2048
  v_mfma_f32_16x16x32_bf16 v[60:63], v[132:135], v[92:95], v[60:63]
  v_mfma_f32_16x16x32_bf16 v[64:67], v[128:131], v[96:99], v[64:67]
  ds_read_b128 v[116:119], v6 offset:4096
  v_mfma_f32_16x16x32_bf16 v[68:71], v[132:135], v[96:99], v[68:71]
  s_waitcnt lgkmcnt(3)
  v_mfma_f32_16x16x32_bf16 v[72:75], v[128:131], v[100:103], v[72:75]
  ds_read_b128 v[120:123], v6 offset:6144
  v_mfma_f32_16x16x32_bf16 v[76:79], v[132:135], v[100:103], v[76:79]
  v_mfma_f32_16x16x32_bf16 v[80:83], v[128:131], v[104:107], v[80:83]
  ds_read_b128 v[124:127], v6 offset:8192
  v_mfma_f32_16x16x32_bf16 v[84:87], v[132:135], v[104:107], v[84:87]
  s_waitcnt vmcnt(4)
  s_waitcnt lgkmcnt(2)
  v_mfma_f32_16x16x32_bf16 v[48:51], v[136:139], v[108:111], v[48:51]
  ds_read_b128 v[88:91], v5 offset:10240
  v_mfma_f32_16x16x32_bf16 v[52:55], v[140:143], v[108:111], v[52:55]
  v_mfma_f32_16x16x32_bf16 v[56:59], v[136:139], v[112:115], v[56:59]
  ds_read_b128 v[92:95], v5 offset:12288
  v_mfma_f32_16x16x32_bf16 v[60:63], v[140:143], v[112:115], v[60:63]
  v_mfma_f32_16x16x32_bf16 v[64:67], v[136:139], v[116:119], v[64:67]
  ds_read_b128 v[96:99], v5 offset:14336
  v_mfma_f32_16x16x32_bf16 v[68:71], v[140:143], v[116:119], v[68:71]
  s_waitcnt lgkmcnt(3)
  v_mfma_f32_16x16x32_bf16 v[72:75], v[136:139], v[120:123], v[72:75]
  ds_read_b128 v[100:103], v5 offset:16384
  v_mfma_f32_16x16x32_bf16 v[76:79], v[140:143], v[120:123], v[76:79]
  v_mfma_f32_16x16x32_bf16 v[80:83], v[136:139], v[124:127], v[80:83]
  ds_read_b128 v[104:107], v5 offset:18432
  v_mfma_f32_16x16x32_bf16 v[84:87], v[140:143], v[124:127], v[84:87]
  s_waitcnt vmcnt(2)
  s_waitcnt lgkmcnt(2)
  v_mfma_f32_16x16x32_bf16 v[48:51], v[144:147], v[88:91], v[48:51]
  ds_read_b128 v[108:111], v6 offset:10240
  v_mfma_f32_16x16x32_bf16 v[52:55], v[148:151], v[88:91], v[52:55]
  v_mfma_f32_16x16x32_bf16 v[56:59], v[144:147], v[92:95], v[56:59]
  ds_read_b128 v[112:115], v6 offset:12288
  v_mfma_f32_16x16x32_bf16 v[60:63], v[148:151], v[92:95], v[60:63]
  v_mfma_f32_16x16x32_bf16 v[64:67], v[144:147], v[96:99], v[64:67]
  ds_read_b128 v[116:119], v6 offset:14336
  v_mfma_f32_16x16x32_bf16 v[68:71], v[148:151], v[96:99], v[68:71]
  s_waitcnt lgkmcnt(3)
  v_mfma_f32_16x16x32_bf16 v[72:75], v[144:147], v[100:103], v[72:75]
  ds_read_b128 v[120:123], v6 offset:16384
  v_mfma_f32_16x16x32_bf16 v[76:79], v[148:151], v[100:103], v[76:79]
  v_mfma_f32_16x16x32_bf16 v[80:83], v[144:147], v[104:107], v[80:83]
  ds_read_b128 v[124:127], v6 offset:18432
  v_mfma_f32_16x16x32_bf16 v[84:87], v[148:151], v[104:107], v[84:87]
  s_waitcnt vmcnt(0)
  s_waitcnt lgkmcnt(2)
  v_mfma_f32_16x16x32_bf16 v[48:51], v[152:155], v[108:111], v[48:51]
  v_mfma_f32_16x16x32_bf16 v[52:55], v[156:159], v[108:111], v[52:55]
  v_mfma_f32_16x16x32_bf16 v[56:59], v[152:155], v[112:115], v[56:59]
  v_mfma_f32_16x16x32_bf16 v[60:63], v[156:159], v[112:115], v[60:63]
  v_mfma_f32_16x16x32_bf16 v[64:67], v[152:155], v[116:119], v[64:67]
  v_mfma_f32_16x16x32_bf16 v[68:71], v[156:159], v[116:119], v[68:71]
  s_waitcnt lgkmcnt(0)
  v_mfma_f32_16x16x32_bf16 v[72:75], v[152:155], v[120:123], v[72:75]
  v_mfma_f32_16x16x32_bf16 v[76:79], v[156:159], v[120:123], v[76:79]
  v_mfma_f32_16x16x32_bf16 v[80:83], v[152:155], v[124:127], v[80:83]
  v_mfma_f32_16x16x32_bf16 v[84:87], v[156:159], v[124:127], v[84:87]
  v_fmac_f32 v49, v16, v48
  v_fmac_f32 v57, v17, v56
  v_fmac_f32 v65, v18, v64
  s_nop 1
  v_fmac_f32 v73, v19, v72
  s_nop 0
  v_fmac_f32 v81, v20, v80
  v_fmac_f32_dpp v49, v48, v21 quad_perm:[1,0,3,2] row_mask:0xf bank_mask:0xf
  v_fmac_f32_dpp v57, v56, v22 quad_perm:[1,0,3,2] row_mask:0xf bank_mask:0xf
  v_fmac_f32_dpp v65, v64, v23 quad_perm:[1,0,3,2] row_mask:0xf bank_mask:0xf
  v_fmac_f32_dpp v73, v72, v24 quad_perm:[1,0,3,2] row_mask:0xf bank_mask:0xf
  v_fmac_f32_dpp v81, v80, v25 quad_perm:[1,0,3,2] row_mask:0xf bank_mask:0xf
  v_fmac_f32 v50, v16, v49
  v_fmac_f32 v58, v17, v57
  v_fmac_f32 v66, v18, v65
  v_fmac_f32 v74, v19, v73
  v_fmac_f32_e64 v82, v20, v81
  v_fmac_f32_dpp v50, v49, v21 quad_perm:[1,0,3,2] row_mask:0xf bank_mask:0xf
  v_fmac_f32_dpp v58, v57, v22 quad_perm:[1,0,3,2] row_mask:0xf bank_mask:0xf
  v_fmac_f32_dpp v66, v65, v23 quad_perm:[1,0,3,2] row_mask:0xf bank_mask:0xf
  v_fmac_f32_dpp v74, v73, v24 quad_perm:[1,0,3,2] row_mask:0xf bank_mask:0xf
  v_fmac_f32_dpp v82, v81, v25 quad_perm:[1,0,3,2] row_mask:0xf bank_mask:0xf
  v_fmac_f32 v51, v16, v50
  v_fmac_f32 v59, v17, v58
  v_fmac_f32 v67, v18, v66
  v_fmac_f32 v75, v19, v74
  v_fmac_f32_e64 v83, v20, v82
  v_fmac_f32_dpp v51, v50, v21 quad_perm:[1,0,3,2] row_mask:0xf bank_mask:0xf
  v_fmac_f32_dpp v59, v58, v22 quad_perm:[1,0,3,2] row_mask:0xf bank_mask:0xf
  v_fmac_f32_dpp v67, v66, v23 quad_perm:[1,0,3,2] row_mask:0xf bank_mask:0xf
  v_fmac_f32_dpp v75, v74, v24 quad_perm:[1,0,3,2] row_mask:0xf bank_mask:0xf
  v_fmac_f32_dpp v83, v82, v25 quad_perm:[1,0,3,2] row_mask:0xf bank_mask:0xf
  v_fmac_f32 v52, v16, v51
  v_fmac_f32 v60, v17, v59
  v_fmac_f32 v68, v18, v67
  v_fmac_f32 v76, v19, v75
  v_fmac_f32_e64 v84, v20, v83
  v_fmac_f32_dpp v52, v51, v21 quad_perm:[1,0,3,2] row_mask:0xf bank_mask:0xf
  v_fmac_f32_dpp v60, v59, v22 quad_perm:[1,0,3,2] row_mask:0xf bank_mask:0xf
  v_fmac_f32_dpp v68, v67, v23 quad_perm:[1,0,3,2] row_mask:0xf bank_mask:0xf
  v_fmac_f32_dpp v76, v75, v24 quad_perm:[1,0,3,2] row_mask:0xf bank_mask:0xf
  v_fmac_f32_dpp v84, v83, v25 quad_perm:[1,0,3,2] row_mask:0xf bank_mask:0xf
  v_fmac_f32 v53, v16, v52
  v_fmac_f32 v61, v17, v60
  v_fmac_f32 v69, v18, v68
  v_fmac_f32 v77, v19, v76
  v_fmac_f32_e64 v85, v20, v84
  v_fmac_f32_dpp v53, v52, v21 quad_perm:[1,0,3,2] row_mask:0xf bank_mask:0xf
  v_fmac_f32_dpp v61, v60, v22 quad_perm:[1,0,3,2] row_mask:0xf bank_mask:0xf
  v_fmac_f32_dpp v69, v68, v23 quad_perm:[1,0,3,2] row_mask:0xf bank_mask:0xf
  v_fmac_f32_dpp v77, v76, v24 quad_perm:[1,0,3,2] row_mask:0xf bank_mask:0xf
  v_fmac_f32_dpp v85, v84, v25 quad_perm:[1,0,3,2] row_mask:0xf bank_mask:0xf
  v_fmac_f32 v54, v16, v53
  v_fmac_f32 v62, v17, v61
  v_fmac_f32 v70, v18, v69
  v_fmac_f32 v78, v19, v77
  v_fmac_f32_e64 v86, v20, v85
  v_fmac_f32_dpp v54, v53, v21 quad_perm:[1,0,3,2] row_mask:0xf bank_mask:0xf
  v_fmac_f32_dpp v62, v61, v22 quad_perm:[1,0,3,2] row_mask:0xf bank_mask:0xf
  v_fmac_f32_dpp v70, v69, v23 quad_perm:[1,0,3,2] row_mask:0xf bank_mask:0xf
  v_fmac_f32_dpp v78, v77, v24 quad_perm:[1,0,3,2] row_mask:0xf bank_mask:0xf
  v_fmac_f32_dpp v86, v85, v25 quad_perm:[1,0,3,2] row_mask:0xf bank_mask:0xf
  v_fmac_f32 v55, v16, v54
  v_fmac_f32 v63, v17, v62
  v_fmac_f32 v71, v18, v70
  v_fmac_f32 v79, v19, v78
  v_fmac_f32_e64 v87, v20, v86
  v_fmac_f32_dpp v55, v54, v21 quad_perm:[1,0,3,2] row_mask:0xf bank_mask:0xf
  v_fmac_f32_dpp v63, v62, v22 quad_perm:[1,0,3,2] row_mask:0xf bank_mask:0xf
  v_fmac_f32_dpp v71, v70, v23 quad_perm:[1,0,3,2] row_mask:0xf bank_mask:0xf
  v_fmac_f32_dpp v79, v78, v24 quad_perm:[1,0,3,2] row_mask:0xf bank_mask:0xf
  v_fmac_f32_dpp v87, v86, v25 quad_perm:[1,0,3,2] row_mask:0xf bank_mask:0xf
  v_add_u32 v11, 152320, v9
  v_min_u32 v12, 39, v1
  v_lshlrev_b32 v44, 3, v12
  v_add_u32 v44, 158400, v44
  v_mov_b32 v42, 0
  v_mov_b32 v43, 0
  ds_write_b32 v11, v55 offset:0
  ds_write_b32 v11, v63 offset:1152
  ds_write_b32 v11, v71 offset:2304
  ds_write_b32 v11, v79 offset:3456
  ds_write_b32 v11, v87 offset:4608
  ds_write_b64 v44, v[42:43]
  v_mul_u32_u24 v46, 144, v12
  v_add_u32 v46, 152320, v46
  s_waitcnt lgkmcnt(0)
  s_barrier
  ds_read_b128 v[88:91], v46 offset:0
  ds_read_b128 v[92:95], v46 offset:16
  ds_read_b128 v[96:99], v46 offset:32
  ds_read_b128 v[100:103], v46 offset:48
  ds_read_b128 v[104:107], v46 offset:64
  ds_read_b128 v[108:111], v46 offset:80
  ds_read_b128 v[112:115], v46 offset:96
  ds_read_b128 v[116:119], v46 offset:112
  s_waitcnt lgkmcnt(7)
  v_pk_fma_f32 v[90:91], v[88:89], v[36:37], v[90:91] op_sel:[1,1,0] op_sel_hi:[0,1,1] neg_lo:[0,1,0]
  v_pk_fma_f32 v[90:91], v[88:89], v[36:37], v[90:91] op_sel:[0,0,0] op_sel_hi:[1,0,1]
  s_waitcnt lgkmcnt(6)
  v_pk_fma_f32 v[92:93], v[90:91], v[36:37], v[92:93] op_sel:[1,1,0] op_sel_hi:[0,1,1] neg_lo:[0,1,0]
  v_pk_fma_f32 v[92:93], v[90:91], v[36:37], v[92:93] op_sel:[0,0,0] op_sel_hi:[1,0,1]
  v_pk_fma_f32 v[94:95], v[92:93], v[36:37], v[94:95] op_sel:[1,1,0] op_sel_hi:[0,1,1] neg_lo:[0,1,0]
  v_pk_fma_f32 v[94:95], v[92:93], v[36:37], v[94:95] op_sel:[0,0,0] op_sel_hi:[1,0,1]
  s_waitcnt lgkmcnt(5)
  v_pk_fma_f32 v[96:97], v[94:95], v[36:37], v[96:97] op_sel:[1,1,0] op_sel_hi:[0,1,1] neg_lo:[0,1,0]
  v_pk_fma_f32 v[96:97], v[94:95], v[36:37], v[96:97] op_sel:[0,0,0] op_sel_hi:[1,0,1]
  v_pk_fma_f32 v[98:99], v[96:97], v[36:37], v[98:99] op_sel:[1,1,0] op_sel_hi:[0,1,1] neg_lo:[0,1,0]
  v_pk_fma_f32 v[98:99], v[96:97], v[36:37], v[98:99] op_sel:[0,0,0] op_sel_hi:[1,0,1]
  s_waitcnt lgkmcnt(4)
  v_pk_fma_f32 v[100:101], v[98:99], v[36:37], v[100:101] op_sel:[1,1,0] op_sel_hi:[0,1,1] neg_lo:[0,1,0]
  v_pk_fma_f32 v[100:101], v[98:99], v[36:37], v[100:101] op_sel:[0,0,0] op_sel_hi:[1,0,1]
  v_pk_fma_f32 v[102:103], v[100:101], v[36:37], v[102:103] op_sel:[1,1,0] op_sel_hi:[0,1,1] neg_lo:[0,1,0]
  v_pk_fma_f32 v[102:103], v[100:101], v[36:37], v[102:103] op_sel:[0,0,0] op_sel_hi:[1,0,1]
  s_waitcnt lgkmcnt(3)
  v_pk_fma_f32 v[104:105], v[102:103], v[36:37], v[104:105] op_sel:[1,1,0] op_sel_hi:[0,1,1] neg_lo:[0,1,0]
  v_pk_fma_f32 v[104:105], v[102:103], v[36:37], v[104:105] op_sel:[0,0,0] op_sel_hi:[1,0,1]
  v_pk_fma_f32 v[106:107], v[104:105], v[36:37], v[106:107] op_sel:[1,1,0] op_sel_hi:[0,1,1] neg_lo:[0,1,0]
  v_pk_fma_f32 v[106:107], v[104:105], v[36:37], v[106:107] op_sel:[0,0,0] op_sel_hi:[1,0,1]
  s_waitcnt lgkmcnt(2)
  v_pk_fma_f32 v[108:109], v[106:107], v[36:37], v[108:109] op_sel:[1,1,0] op_sel_hi:[0,1,1] neg_lo:[0,1,0]
  v_pk_fma_f32 v[108:109], v[106:107], v[36:37], v[108:109] op_sel:[0,0,0] op_sel_hi:[1,0,1]
  v_pk_fma_f32 v[110:111], v[108:109], v[36:37], v[110:111] op_sel:[1,1,0] op_sel_hi:[0,1,1] neg_lo:[0,1,0]
  v_pk_fma_f32 v[110:111], v[108:109], v[36:37], v[110:111] op_sel:[0,0,0] op_sel_hi:[1,0,1]
  s_waitcnt lgkmcnt(1)
  v_pk_fma_f32 v[112:113], v[110:111], v[36:37], v[112:113] op_sel:[1,1,0] op_sel_hi:[0,1,1] neg_lo:[0,1,0]
  v_pk_fma_f32 v[112:113], v[110:111], v[36:37], v[112:113] op_sel:[0,0,0] op_sel_hi:[1,0,1]
  v_pk_fma_f32 v[114:115], v[112:113], v[36:37], v[114:115] op_sel:[1,1,0] op_sel_hi:[0,1,1] neg_lo:[0,1,0]
  v_pk_fma_f32 v[114:115], v[112:113], v[36:37], v[114:115] op_sel:[0,0,0] op_sel_hi:[1,0,1]
  s_waitcnt lgkmcnt(0)
  v_pk_fma_f32 v[116:117], v[114:115], v[36:37], v[116:117] op_sel:[1,1,0] op_sel_hi:[0,1,1] neg_lo:[0,1,0]
  v_pk_fma_f32 v[116:117], v[114:115], v[36:37], v[116:117] op_sel:[0,0,0] op_sel_hi:[1,0,1]
  v_pk_fma_f32 v[118:119], v[116:117], v[36:37], v[118:119] op_sel:[1,1,0] op_sel_hi:[0,1,1] neg_lo:[0,1,0]
  v_pk_fma_f32 v[118:119], v[116:117], v[36:37], v[118:119] op_sel:[0,0,0] op_sel_hi:[1,0,1]
  v_mov_b32 v120, s8
  v_mov_b32 v121, s8
  s_add_u32 s12, s83, 337920
  s_mov_b64 exec, s[96:97]
  buffer_store_dwordx4 v[118:121], v2, s[52:55], s12 offen sc1
  s_mov_b64 exec, -1
  v_subrev_u32 v46, 8576, v46
  ds_write_b64 v46, v[42:43] offset:8
  ds_write_b128 v46, v[88:91] offset:16
  ds_write_b128 v46, v[92:95] offset:32
  ds_write_b128 v46, v[96:99] offset:48
  ds_write_b128 v46, v[100:103] offset:64
  ds_write_b128 v46, v[104:107] offset:80
  ds_write_b128 v46, v[108:111] offset:96
  ds_write_b128 v46, v[112:115] offset:112
  ds_write_b128 v46, v[116:119] offset:128
  v_add_u32 v46, 143752, v9
  ds_read_b32 v244, v46 offset:0
  ds_read_b32 v246, v46 offset:1152
  ds_read_b32 v248, v46 offset:2304
  ds_read_b32 v250, v46 offset:3456
  ds_read_b32 v252, v46 offset:4608
  v_and_b32 v43, 1, v3
  v_cvt_f32_u32 v43, v43
  v_fma_f32 v43, 2.0, v43, -1.0
  s_waitcnt lgkmcnt(0)
  s_nop 0
  v_mul_f32_dpp v245, v244, v43 quad_perm:[1,0,3,2] row_mask:0xf bank_mask:0xf
  v_mul_f32_dpp v247, v246, v43 quad_perm:[1,0,3,2] row_mask:0xf bank_mask:0xf
  v_mul_f32_dpp v249, v248, v43 quad_perm:[1,0,3,2] row_mask:0xf bank_mask:0xf
  v_mul_f32_dpp v251, v250, v43 quad_perm:[1,0,3,2] row_mask:0xf bank_mask:0xf
  v_mul_f32_dpp v253, v252, v43 quad_perm:[1,0,3,2] row_mask:0xf bank_mask:0xf
  s_and_b32 vcc_lo, s1, 7
  s_lshl_b32 vcc_lo, vcc_lo, 2
  s_add_u32 vcc_lo, vcc_lo, s7
  s_lshl_b32 vcc_lo, vcc_lo, 11
  v_lshl_add_u32 v15, v3, 7, vcc_lo
  v_min_u32 v15, L_codeend-L_pc-4, v15
  s_mov_b64 exec, 0xffff
  global_load_dword a250, v15, s[98:99]
  s_mov_b64 exec, -1
  s_lshl_b32 s90, s7, 2
  s_sub_u32 s90, 12, s90
  s_mul_i32 s90, s90, 640
  s_add_u32 s90, s90, s83
  s_add_u32 s90, s90, 327680
  v_min_u32 v42, 39, v1
  v_lshlrev_b32 v42, 4, v42
  buffer_load_dwordx3 v[88:90], v42, s[52:55], s90 offen offset:0 sc1
  buffer_load_dwordx3 v[92:94], v42, s[52:55], s90 offen offset:640 sc1
  buffer_load_dwordx3 v[96:98], v42, s[52:55], s90 offen offset:1280 sc1
  buffer_load_dwordx3 v[100:102], v42, s[52:55], s90 offen offset:1920 sc1
  v_lshrrev_b32_e64 v11, 1, v3
  v_mul_u32_u24 v12, 80, v11
  v_add_u32 v12, 160640, v12
  v_lshlrev_b32_e64 v11, 3, v11
  v_add_u32 v11, 158400, v11
  ds_read_b128 v[128:131], v12 offset:0
  ds_read_b128 v[132:135], v12 offset:16
  ds_read_b128 v[136:139], v12 offset:32
  ds_read_b128 v[140:143], v12 offset:48
  ds_read_b128 v[144:147], v12 offset:640
  ds_read_b128 v[148:151], v12 offset:656
  ds_read_b128 v[152:155], v12 offset:672
  ds_read_b128 v[156:159], v12 offset:688
  ds_read_b128 v[160:163], v12 offset:1280
  ds_read_b128 v[164:167], v12 offset:1296
  ds_read_b128 v[168:171], v12 offset:1312
  ds_read_b128 v[172:175], v12 offset:1328
  ds_read_b128 v[176:179], v12 offset:1920
  ds_read_b128 v[180:183], v12 offset:1936
  ds_read_b128 v[184:187], v12 offset:1952
  ds_read_b128 v[188:191], v12 offset:1968
  ds_read_b128 v[104:107], v12 offset:2560
  ds_read_b128 v[108:111], v12 offset:2576
  ds_read_b128 v[112:115], v12 offset:2592
  ds_read_b128 v[116:119], v12 offset:2608
  v_accvgpr_read_b32 v254, a240
  v_accvgpr_read_b32 v255, a241
  v_accvgpr_read_b32 v47, a242
  s_waitcnt vmcnt(0)
  v_min3_u32 v14, v90, v94, s8
  v_max3_u32 v15, v90, v94, s8
  v_min3_u32 v14, v14, v98, v102
  v_max3_u32 v15, v15, v98, v102
  v_cmp_ne_u32 vcc, v14, v15
  s_cbranch_vccz ok_65
again_64:
  buffer_load_dwordx3 v[88:90], v42, s[52:55], s90 offen offset:0 sc1
  buffer_load_dwordx3 v[92:94], v42, s[52:55], s90 offen offset:640 sc1
  buffer_load_dwordx3 v[96:98], v42, s[52:55], s90 offen offset:1280 sc1
  buffer_load_dwordx3 v[100:102], v42, s[52:55], s90 offen offset:1920 sc1
  s_sub_u32 s10, s10, 1
  s_cmp_gt_i32 s10, 0
  s_waitcnt vmcnt(0)
  v_min3_u32 v14, v90, v94, s8
  v_max3_u32 v15, v90, v94, s8
  v_min3_u32 v14, v14, v98, v102
  v_max3_u32 v15, v15, v98, v102
  v_cmp_ne_u32 vcc, v14, v15
  s_cbranch_scc0 out_66
  s_cbranch_vccnz again_64
out_66:
ok_65:
  v_pk_fma_f32 v[92:93], v[88:89], v[38:39], v[92:93] op_sel:[1,1,0] op_sel_hi:[0,1,1] neg_lo:[0,1,0]
  v_pk_fma_f32 v[92:93], v[88:89], v[38:39], v[92:93] op_sel:[0,0,0] op_sel_hi:[1,0,1]
  v_pk_fma_f32 v[96:97], v[92:93], v[38:39], v[96:97] op_sel:[1,1,0] op_sel_hi:[0,1,1] neg_lo:[0,1,0]
  v_pk_fma_f32 v[96:97], v[92:93], v[38:39], v[96:97] op_sel:[0,0,0] op_sel_hi:[1,0,1]
  v_pk_fma_f32 v[100:101], v[96:97], v[38:39], v[100:101] op_sel:[1,1,0] op_sel_hi:[0,1,1] neg_lo:[0,1,0]
  v_pk_fma_f32 v[100:101], v[96:97], v[38:39], v[100:101] op_sel:[0,0,0] op_sel_hi:[1,0,1]
  v_pk_mul_f32 v[88:89], v[100:101], v[40:41] op_sel:[1,1] op_sel_hi:[0,1] neg_lo:[0,1]
  v_pk_fma_f32 v[88:89], v[100:101], v[40:41], v[88:89] op_sel:[0,0,0] op_sel_hi:[1,0,1]
  s_mov_b32 exec_hi, 0xff
  ds_add_f32 v44, v88
  ds_add_f32 v44, v89 offset:4
  s_mov_b32 exec_hi, -1
  s_waitcnt lgkmcnt(0)
  s_barrier
  ds_read_b64 v[88:89], v11 offset:0
  ds_read_b64 v[90:91], v11 offset:64
  ds_read_b64 v[92:93], v11 offset:128
  ds_read_b64 v[94:95], v11 offset:192
  ds_read_b64 v[96:97], v11 offset:256
  s_waitcnt lgkmcnt(4)
  v_pk_fma_f32 v[244:245], v[26:27], v[88:89], v[244:245] op_sel:[0,0,0] op_sel_hi:[1,0,1]
  v_pk_fma_f32 v[244:245], v[26:27], v[88:89], v[244:245] op_sel:[1,1,0] op_sel_hi:[0,1,1] neg_hi:[1,0,0]
  s_waitcnt lgkmcnt(3)
  v_pk_fma_f32 v[246:247], v[28:29], v[90:91], v[246:247] op_sel:[0,0,0] op_sel_hi:[1,0,1]
  v_pk_fma_f32 v[246:247], v[28:29], v[90:91], v[246:247] op_sel:[1,1,0] op_sel_hi:[0,1,1] neg_hi:[1,0,0]
  v_pk_fma_f32 v[48:49], v[128:129], v[244:245], v[48:49] op_sel:[0,0,0] op_sel_hi:[1,0,1]
  v_pk_fma_f32 v[50:51], v[130:131], v[244:245], v[50:51] op_sel:[0,0,0] op_sel_hi:[1,0,1]
  v_pk_fma_f32 v[52:53], v[132:133], v[244:245], v[52:53] op_sel:[0,0,0] op_sel_hi:[1,0,1]
  v_pk_fma_f32 v[54:55], v[134:135], v[244:245], v[54:55] op_sel:[0,0,0] op_sel_hi:[1,0,1]
  v_pk_fma_f32 v[48:49], v[136:137], v[244:245], v[48:49] op_sel:[0,1,0] op_sel_hi:[1,1,1]
  v_pk_fma_f32 v[50:51], v[138:139], v[244:245], v[50:51] op_sel:[0,1,0] op_sel_hi:[1,1,1]
  v_pk_fma_f32 v[52:53], v[140:141], v[244:245], v[52:53] op_sel:[0,1,0] op_sel_hi:[1,1,1]
  v_pk_fma_f32 v[54:55], v[142:143], v[244:245], v[54:55] op_sel:[0,1,0] op_sel_hi:[1,1,1]
  v_cvt_pk_bf16_f32 v98, v48, v49
  v_cvt_pk_bf16_f32 v99, v50, v51
  v_cvt_pk_bf16_f32 v100, v52, v53
  v_cvt_pk_bf16_f32 v101, v54, v55
  ds_write_b128 v254, v[98:101]
  ds_read_b64_tr_b16 v[52:53], v255
  ds_read_b64_tr_b16 v[54:55], v255 offset:640
  s_waitcnt lgkmcnt(5)
  v_pk_fma_f32 v[248:249], v[30:31], v[92:93], v[248:249] op_sel:[0,0,0] op_sel_hi:[1,0,1]
  v_pk_fma_f32 v[248:249], v[30:31], v[92:93], v[248:249] op_sel:[1,1,0] op_sel_hi:[0,1,1] neg_hi:[1,0,0]
  v_pk_fma_f32 v[56:57], v[144:145], v[246:247], v[56:57] op_sel:[0,0,0] op_sel_hi:[1,0,1]
  v_pk_fma_f32 v[58:59], v[146:147], v[246:247], v[58:59] op_sel:[0,0,0] op_sel_hi:[1,0,1]
  v_pk_fma_f32 v[60:61], v[148:149], v[246:247], v[60:61] op_sel:[0,0,0] op_sel_hi:[1,0,1]
  v_pk_fma_f32 v[62:63], v[150:151], v[246:247], v[62:63] op_sel:[0,0,0] op_sel_hi:[1,0,1]
  v_pk_fma_f32 v[56:57], v[152:153], v[246:247], v[56:57] op_sel:[0,1,0] op_sel_hi:[1,1,1]
  v_pk_fma_f32 v[58:59], v[154:155], v[246:247], v[58:59] op_sel:[0,1,0] op_sel_hi:[1,1,1]
  v_pk_fma_f32 v[60:61], v[156:157], v[246:247], v[60:61] op_sel:[0,1,0] op_sel_hi:[1,1,1]
  v_pk_fma_f32 v[62:63], v[158:159], v[246:247], v[62:63] op_sel:[0,1,0] op_sel_hi:[1,1,1]
  v_cvt_pk_bf16_f32 v120, v56, v57
  v_cvt_pk_bf16_f32 v121, v58, v59
  v_cvt_pk_bf16_f32 v122, v60, v61
  v_cvt_pk_bf16_f32 v123, v62, v63
  ds_write_b128 v254, v[120:123]
  ds_read_b64_tr_b16 v[60:61], v255
  ds_read_b64_tr_b16 v[62:63], v255 offset:640
  s_waitcnt lgkmcnt(7)
  v_pk_fma_f32 v[250:251], v[32:33], v[94:95], v[250:251] op_sel:[0,0,0] op_sel_hi:[1,0,1]
  v_pk_fma_f32 v[250:251], v[32:33], v[94:95], v[250:251] op_sel:[1,1,0] op_sel_hi:[0,1,1] neg_hi:[1,0,0]
  v_pk_fma_f32 v[64:65], v[160:161], v[248:249], v[64:65] op_sel:[0,0,0] op_sel_hi:[1,0,1]
  v_pk_fma_f32 v[66:67], v[162:163], v[248:249], v[66:67] op_sel:[0,0,0] op_sel_hi:[1,0,1]
  v_pk_fma_f32 v[68:69], v[164:165], v[248:249], v[68:69] op_sel:[0,0,0] op_sel_hi:[1,0,1]
  v_pk_fma_f32 v[70:71], v[166:167], v[248:249], v[70:71] op_sel:[0,0,0] op_sel_hi:[1,0,1]
  v_pk_fma_f32 v[64:65], v[168:169], v[248:249], v[64:65] op_sel:[0,1,0] op_sel_hi:[1,1,1]
  v_pk_fma_f32 v[66:67], v[170:171], v[248:249], v[66:67] op_sel:[0,1,0] op_sel_hi:[1,1,1]
  v_pk_fma_f32 v[68:69], v[172:173], v[248:249], v[68:69] op_sel:[0,1,0] op_sel_hi:[1,1,1]
  v_pk_fma_f32 v[70:71], v[174:175], v[248:249], v[70:71] op_sel:[0,1,0] op_sel_hi:[1,1,1]
  v_cvt_pk_bf16_f32 v98, v64, v65
  v_cvt_pk_bf16_f32 v99, v66, v67
  v_cvt_pk_bf16_f32 v100, v68, v69
  v_cvt_pk_bf16_f32 v101, v70, v71
  ds_write_b128 v254, v[98:101]
  ds_read_b64_tr_b16 v[68:69], v255
  ds_read_b64_tr_b16 v[70:71], v255 offset:640
  s_waitcnt lgkmcnt(9)
  v_pk_fma_f32 v[252:253], v[34:35], v[96:97], v[252:253] op_sel:[0,0,0] op_sel_hi:[1,0,1]
  v_pk_fma_f32 v[252:253], v[34:35], v[96:97], v[252:253] op_sel:[1,1,0] op_sel_hi:[0,1,1] neg_hi:[1,0,0]
  s_add_u32 s13, s78, 10485760
  s_waitcnt lgkmcnt(6)
  s_cmp_eq_u32 s9, 0
  s_cbranch_scc1 slow_67
  buffer_store_dwordx4 v[52:55], v47, s[52:55], s13 offen
back_68:
  v_pk_fma_f32 v[72:73], v[176:177], v[250:251], v[72:73] op_sel:[0,0,0] op_sel_hi:[1,0,1]
  v_pk_fma_f32 v[74:75], v[178:179], v[250:251], v[74:75] op_sel:[0,0,0] op_sel_hi:[1,0,1]
  v_pk_fma_f32 v[76:77], v[180:181], v[250:251], v[76:77] op_sel:[0,0,0] op_sel_hi:[1,0,1]
  v_pk_fma_f32 v[78:79], v[182:183], v[250:251], v[78:79] op_sel:[0,0,0] op_sel_hi:[1,0,1]
  v_pk_fma_f32 v[72:73], v[184:185], v[250:251], v[72:73] op_sel:[0,1,0] op_sel_hi:[1,1,1]
  v_pk_fma_f32 v[74:75], v[186:187], v[250:251], v[74:75] op_sel:[0,1,0] op_sel_hi:[1,1,1]
  v_pk_fma_f32 v[76:77], v[188:189], v[250:251], v[76:77] op_sel:[0,1,0] op_sel_hi:[1,1,1]
  v_pk_fma_f32 v[78:79], v[190:191], v[250:251], v[78:79] op_sel:[0,1,0] op_sel_hi:[1,1,1]
  v_cvt_pk_bf16_f32 v120, v72, v73
  v_cvt_pk_bf16_f32 v121, v74, v75
  v_cvt_pk_bf16_f32 v122, v76, v77
  v_cvt_pk_bf16_f32 v123, v78, v79
  ds_write_b128 v254, v[120:123]
  ds_read_b64_tr_b16 v[76:77], v255
  ds_read_b64_tr_b16 v[78:79], v255 offset:640
  s_add_u32 s13, s79, 10485760
  s_waitcnt lgkmcnt(6)
  s_cmp_eq_u32 s9, 0
  s_cbranch_scc1 slow_69
  buffer_store_dwordx4 v[60:63], v47, s[52:55], s13 offen
back_70:
  v_pk_fma_f32 v[80:81], v[104:105], v[252:253], v[80:81] op_sel:[0,0,0] op_sel_hi:[1,0,1]
  v_pk_fma_f32 v[82:83], v[106:107], v[252:253], v[82:83] op_sel:[0,0,0] op_sel_hi:[1,0,1]
  v_pk_fma_f32 v[84:85], v[108:109], v[252:253], v[84:85] op_sel:[0,0,0] op_sel_hi:[1,0,1]
  v_pk_fma_f32 v[86:87], v[110:111], v[252:253], v[86:87] op_sel:[0,0,0] op_sel_hi:[1,0,1]
  v_pk_fma_f32 v[80:81], v[112:113], v[252:253], v[80:81] op_sel:[0,1,0] op_sel_hi:[1,1,1]
  v_pk_fma_f32 v[82:83], v[114:115], v[252:253], v[82:83] op_sel:[0,1,0] op_sel_hi:[1,1,1]
  v_pk_fma_f32 v[84:85], v[116:117], v[252:253], v[84:85] op_sel:[0,1,0] op_sel_hi:[1,1,1]
  v_pk_fma_f32 v[86:87], v[118:119], v[252:253], v[86:87] op_sel:[0,1,0] op_sel_hi:[1,1,1]
  v_cvt_pk_bf16_f32 v98, v80, v81
  v_cvt_pk_bf16_f32 v99, v82, v83
  v_cvt_pk_bf16_f32 v100, v84, v85
  v_cvt_pk_bf16_f32 v101, v86, v87
  ds_write_b128 v254, v[98:101]
  ds_read_b64_tr_b16 v[84:85], v255
  ds_read_b64_tr_b16 v[86:87], v255 offset:640
  s_add_u32 s13, s80, 10485760
  s_waitcnt lgkmcnt(6)
  s_cmp_eq_u32 s9, 0
  s_cbranch_scc1 slow_71
  buffer_store_dwordx4 v[68:71], v47, s[52:55], s13 offen
back_72:
  s_add_u32 s13, s81, 10485760
  s_waitcnt lgkmcnt(3)
  s_cmp_eq_u32 s9, 0
  s_cbranch_scc1 slow_73
  buffer_store_dwordx4 v[76:79], v47, s[52:55], s13 offen
back_74:
  s_add_u32 s13, s82, 10485760
  s_waitcnt lgkmcnt(0)
  s_cmp_eq_u32 s9, 0
  s_cbranch_scc1 slow_75
  buffer_store_dwordx4 v[84:87], v47, s[52:55], s13 offen
back_76:
  s_mul_i32 s13, s5, 163840
  s_mul_i32 s14, s7, 10240
  s_add_u32 s13, s13, s14
  s_add_u32 s13, s13, 10485760
  s_add_u32 s14, s7, 1
  s_and_b32 s14, s14, 3
  s_mul_i32 s15, s14, 40960
  s_add_u32 s16, s15, s13
  s_mul_i32 s15, s14, 10240
  s_add_u32 s15, s15, 102400
  v_add_u32 v44, s15, v2
  s_add_u32 s14, s7, 2
  s_and_b32 s14, s14, 3
  s_mul_i32 s15, s14, 40960
  s_add_u32 s17, s15, s13
  s_mul_i32 s15, s14, 10240
  s_add_u32 s15, s15, 107520
  v_add_u32 v45, s15, v2
  s_add_u32 s14, s7, 3
  s_and_b32 s14, s14, 3
  s_mul_i32 s15, s14, 40960
  s_add_u32 s18, s15, s13
  s_mul_i32 s15, s14, 5120
  v_add_u32 v46, s15, v2
  s_add_u32 s14, s7, 4
  s_and_b32 s14, s14, 3
  s_mul_i32 s15, s14, 40960
  s_add_u32 s19, s15, s13
  s_lshl_b32 s49, s3, 8
  s_lshl_b32 s13, s7, 6
  s_add_u32 s49, s49, s13
  s_and_b32 s13, s5, 1
  s_lshl_b32 s13, s13, 3
  s_add_u32 s49, s49, s13
  s_add_u32 s49, s49, 16384
  v_and_b32 v244, 3, v1
  v_lshlrev_b32 v244, 4, v244
  s_waitcnt vmcnt(0)
  s_add_u32 s14, s84, 16384
  v_mov_b32 v15, s8
  s_mov_b64 exec, 1
  s_cmp_eq_u32 s9, 0
  s_cbranch_scc1 slow_77
  buffer_store_dword v15, off, s[52:55], s14
back_78:
  s_mov_b64 exec, -1
  v_accvgpr_read_b32 v108, a210
  v_accvgpr_read_b32 v109, a211
  v_accvgpr_read_b32 v110, a212
  v_accvgpr_read_b32 v111, a213
  v_accvgpr_read_b32 v112, a214
  v_accvgpr_read_b32 v113, a215
  v_accvgpr_read_b32 v114, a216
  v_accvgpr_read_b32 v115, a217
  v_accvgpr_read_b32 v116, a218
  v_accvgpr_read_b32 v117, a219
  v_accvgpr_read_b32 v118, a220
  v_accvgpr_read_b32 v119, a221
  v_accvgpr_read_b32 v120, a222
  v_accvgpr_read_b32 v121, a223
  v_accvgpr_read_b32 v122, a224
  v_accvgpr_read_b32 v123, a225
  v_accvgpr_read_b32 v124, a226
  v_accvgpr_read_b32 v125, a227
  v_accvgpr_read_b32 v126, a228
  v_accvgpr_read_b32 v127, a229
  v_accvgpr_read_b32 v232, a200
  v_accvgpr_read_b32 v233, a201
  v_accvgpr_read_b32 v234, a202
  v_accvgpr_read_b32 v235, a203
  v_accvgpr_read_b32 v236, a204
  v_accvgpr_read_b32 v237, a205
  v_accvgpr_read_b32 v238, a206
  v_accvgpr_read_b32 v239, a207
  v_accvgpr_read_b32 v240, a208
  v_accvgpr_read_b32 v241, a209
  v_lshlrev_b32_e64 v88, 16, v232
  v_and_b32 v89, 0xffff0000, v232
  v_lshlrev_b32_e64 v90, 16, v233
  v_and_b32 v91, 0xffff0000, v233
  v_lshlrev_b32_e64 v92, 16, v234
  v_and_b32 v93, 0xffff0000, v234
  v_lshlrev_b32_e64 v94, 16, v235
  v_and_b32 v95, 0xffff0000, v235
  v_lshlrev_b32_e64 v96, 16, v236
  v_and_b32 v97, 0xffff0000, v236
  v_lshlrev_b32_e64 v98, 16, v237
  v_and_b32 v99, 0xffff0000, v237
  v_lshlrev_b32_e64 v100, 16, v238
  v_and_b32 v101, 0xffff0000, v238
  v_lshlrev_b32_e64 v102, 16, v239
  v_and_b32 v103, 0xffff0000, v239
  v_lshlrev_b32_e64 v104, 16, v240
  v_and_b32 v105, 0xffff0000, v240
  v_lshlrev_b32_e64 v106, 16, v241
  v_and_b32 v107, 0xffff0000, v241
again_79:
  buffer_load_dwordx2 v[42:43], v244, s[52:55], s49 offen sc1
  s_sub_u32 s10, s10, 1
  s_cmp_gt_i32 s10, 0
  s_waitcnt vmcnt(0)
  v_xor_b32 v15, s8, v42
  v_xor_b32 v14, s8, v43
  v_or_b32 v15, v15, v14
  v_cmp_ne_u32 vcc, 0, v15
  s_cbranch_scc0 out_81
  s_cbranch_vccnz again_79
out_81:
ok_80:
  buffer_load_dwordx4 v[128:131], v2, s[52:55], s16 offen offset:0 sc1
  buffer_load_dwordx4 v[132:135], v2, s[52:55], s16 offen offset:1024 sc1
  buffer_load_dwordx4 v[136:139], v2, s[52:55], s16 offen offset:2048 sc1
  buffer_load_dwordx4 v[140:143], v2, s[52:55], s16 offen offset:3072 sc1
  s_add_u32 s16, s16, 4096
  buffer_load_dwordx4 v[144:147], v2, s[52:55], s16 offen offset:0 sc1
  buffer_load_dwordx4 v[148:151], v2, s[52:55], s16 offen offset:1024 sc1
  buffer_load_dwordx4 v[152:155], v2, s[52:55], s16 offen offset:2048 sc1
  buffer_load_dwordx4 v[156:159], v2, s[52:55], s16 offen offset:3072 sc1
  s_waitcnt vmcnt(7)
  v_mfma_f32_16x16x32_bf16 v[48:51], a[0:3], v[128:131], 0
  s_add_u32 s16, s16, 4096
  buffer_load_dwordx4 v[160:163], v2, s[52:55], s16 offen offset:0 sc1
  v_mfma_f32_16x16x32_bf16 v[52:55], a[4:7], v[128:131], 0
  v_mfma_f32_16x16x32_bf16 v[56:59], a[8:11], v[128:131], 0
  v_mfma_f32_16x16x32_bf16 v[60:63], a[12:15], v[128:131], 0
  v_mfma_f32_16x16x32_bf16 v[64:67], a[16:19], v[128:131], 0
  s_waitcnt vmcnt(7)
  v_mfma_f32_16x16x32_bf16 v[48:51], a[20:23], v[132:135], v[48:51]
  buffer_load_dwordx4 v[164:167], v2, s[52:55], s16 offen offset:1024 sc1
  v_mfma_f32_16x16x32_bf16 v[52:55], a[24:27], v[132:135], v[52:55]
  v_mfma_f32_16x16x32_bf16 v[56:59], a[28:31], v[132:135], v[56:59]
  v_mfma_f32_16x16x32_bf16 v[60:63], a[32:35], v[132:135], v[60:63]
  v_mfma_f32_16x16x32_bf16 v[64:67], a[36:39], v[132:135], v[64:67]
  s_waitcnt vmcnt(7)
  v_mfma_f32_16x16x32_bf16 v[48:51], a[40:43], v[136:139], v[48:51]
  buffer_load_dwordx4 v[168:171], v2, s[52:55], s17 offen offset:0 sc1
  v_mfma_f32_16x16x32_bf16 v[52:55], a[44:47], v[136:139], v[52:55]
  v_mfma_f32_16x16x32_bf16 v[56:59], a[48:51], v[136:139], v[56:59]
  v_mfma_f32_16x16x32_bf16 v[60:63], a[52:55], v[136:139], v[60:63]
  v_mfma_f32_16x16x32_bf16 v[64:67], a[56:59], v[136:139], v[64:67]
  s_waitcnt vmcnt(7)
  v_mfma_f32_16x16x32_bf16 v[48:51], a[60:63], v[140:143], v[48:51]
  buffer_load_dwordx4 v[172:175], v2, s[52:55], s17 offen offset:1024 sc1
  v_mfma_f32_16x16x32_bf16 v[52:55], a[64:67], v[140:143], v[52:55]
  v_mfma_f32_16x16x32_bf16 v[56:59], a[68:71], v[140:143], v[56:59]
  v_mfma_f32_16x16x32_bf16 v[60:63], a[72:75], v[140:143], v[60:63]
  v_mfma_f32_16x16x32_bf16 v[64:67], a[76:79], v[140:143], v[64:67]
  s_waitcnt vmcnt(7)
  v_mfma_f32_16x16x32_bf16 v[48:51], a[80:83], v[144:147], v[48:51]
  buffer_load_dwordx4 v[176:179], v2, s[52:55], s17 offen offset:2048 sc1
  v_mfma_f32_16x16x32_bf16 v[52:55], a[84:87], v[144:147], v[52:55]
  v_mfma_f32_16x16x32_bf16 v[56:59], a[88:91], v[144:147], v[56:59]
  v_mfma_f32_16x16x32_bf16 v[60:63], a[92:95], v[144:147], v[60:63]
  v_mfma_f32_16x16x32_bf16 v[64:67], a[96:99], v[144:147], v[64:67]
  s_waitcnt vmcnt(7)
  v_mfma_f32_16x16x32_bf16 v[48:51], a[100:103], v[148:151], v[48:51]
  buffer_load_dwordx4 v[180:183], v2, s[52:55], s17 offen offset:3072 sc1
  v_mfma_f32_16x16x32_bf16 v[52:55], a[104:107], v[148:151], v[52:55]
  v_mfma_f32_16x16x32_bf16 v[56:59], a[108:111], v[148:151], v[56:59]
  v_mfma_f32_16x16x32_bf16 v[60:63], a[112:115], v[148:151], v[60:63]
  v_mfma_f32_16x16x32_bf16 v[64:67], a[116:119], v[148:151], v[64:67]
  s_waitcnt vmcnt(7)
  v_mfma_f32_16x16x32_bf16 v[48:51], a[120:123], v[152:155], v[48:51]
  s_add_u32 s17, s17, 4096
  buffer_load_dwordx4 v[184:187], v2, s[52:55], s17 offen offset:0 sc1
  v_mfma_f32_16x16x32_bf16 v[52:55], a[124:127], v[152:155], v[52:55]
  v_mfma_f32_16x16x32_bf16 v[56:59], a[128:131], v[152:155], v[56:59]
  v_mfma_f32_16x16x32_bf16 v[60:63], a[132:135], v[152:155], v[60:63]
  v_mfma_f32_16x16x32_bf16 v[64:67], a[136:139], v[152:155], v[64:67]
  s_waitcnt vmcnt(7)
  v_mfma_f32_16x16x32_bf16 v[48:51], a[140:143], v[156:159], v[48:51]
  buffer_load_dwordx4 v[188:191], v2, s[52:55], s17 offen offset:1024 sc1
  v_mfma_f32_16x16x32_bf16 v[52:55], a[144:147], v[156:159], v[52:55]
  v_mfma_f32_16x16x32_bf16 v[56:59], a[148:151], v[156:159], v[56:59]
  v_mfma_f32_16x16x32_bf16 v[60:63], a[152:155], v[156:159], v[60:63]
  v_mfma_f32_16x16x32_bf16 v[64:67], a[156:159], v[156:159], v[64:67]
  s_waitcnt vmcnt(7)
  v_mfma_f32_16x16x32_bf16 v[48:51], a[160:163], v[160:163], v[48:51]
  buffer_load_dwordx4 v[128:131], v2, s[52:55], s17 offen offset:2048 sc1
  v_mfma_f32_16x16x32_bf16 v[52:55], a[164:167], v[160:163], v[52:55]
  v_mfma_f32_16x16x32_bf16 v[56:59], a[168:171], v[160:163], v[56:59]
  v_mfma_f32_16x16x32_bf16 v[60:63], a[172:175], v[160:163], v[60:63]
  v_mfma_f32_16x16x32_bf16 v[64:67], a[176:179], v[160:163], v[64:67]
  s_waitcnt vmcnt(7)
  v_mfma_f32_16x16x32_bf16 v[48:51], a[180:183], v[164:167], v[48:51]
  buffer_load_dwordx4 v[132:135], v2, s[52:55], s17 offen offset:3072 sc1
  v_mfma_f32_16x16x32_bf16 v[52:55], a[184:187], v[164:167], v[52:55]
  v_mfma_f32_16x16x32_bf16 v[56:59], a[188:191], v[164:167], v[56:59]
  v_mfma_f32_16x16x32_bf16 v[60:63], a[192:195], v[164:167], v[60:63]
  v_mfma_f32_16x16x32_bf16 v[64:67], a[196:199], v[164:167], v[64:67]
  s_waitcnt vmcnt(7)
  v_mfma_f32_16x16x32_bf16 v[68:71], a[0:3], v[168:171], 0
  s_add_u32 s17, s17, 4096
  buffer_load_dwordx4 v[136:139], v2, s[52:55], s17 offen offset:0 sc1
  v_mfma_f32_16x16x32_bf16 v[72:75], a[4:7], v[168:171], 0
  v_mfma_f32_16x16x32_bf16 v[76:79], a[8:11], v[168:171], 0
  v_mfma_f32_16x16x32_bf16 v[80:83], a[12:15], v[168:171], 0
  v_mfma_f32_16x16x32_bf16 v[84:87], a[16:19], v[168:171], 0
  s_waitcnt vmcnt(7)
  v_mfma_f32_16x16x32_bf16 v[68:71], a[20:23], v[172:175], v[68:71]
  ds_write_b128 v44, v[48:51] offset:0
  buffer_load_dwordx4 v[140:143], v2, s[52:55], s17 offen offset:1024 sc1
  v_mfma_f32_16x16x32_bf16 v[72:75], a[24:27], v[172:175], v[72:75]
  ds_write_b128 v44, v[52:55] offset:1024
  v_mfma_f32_16x16x32_bf16 v[76:79], a[28:31], v[172:175], v[76:79]
  ds_write_b128 v44, v[56:59] offset:2048
  v_mfma_f32_16x16x32_bf16 v[80:83], a[32:35], v[172:175], v[80:83]
  ds_write_b128 v44, v[60:63] offset:3072
  v_mfma_f32_16x16x32_bf16 v[84:87], a[36:39], v[172:175], v[84:87]
  ds_write_b128 v44, v[64:67] offset:4096
  s_waitcnt vmcnt(7)
  v_mfma_f32_16x16x32_bf16 v[68:71], a[40:43], v[176:179], v[68:71]
  buffer_load_dwordx4 v[144:147], v2, s[52:55], s18 offen offset:0 sc1
  v_mfma_f32_16x16x32_bf16 v[72:75], a[44:47], v[176:179], v[72:75]
  v_mfma_f32_16x16x32_bf16 v[76:79], a[48:51], v[176:179], v[76:79]
  v_mfma_f32_16x16x32_bf16 v[80:83], a[52:55], v[176:179], v[80:83]
  v_mfma_f32_16x16x32_bf16 v[84:87], a[56:59], v[176:179], v[84:87]
  s_waitcnt vmcnt(7)
  v_mfma_f32_16x16x32_bf16 v[68:71], a[60:63], v[180:183], v[68:71]
  buffer_load_dwordx4 v[148:151], v2, s[52:55], s18 offen offset:1024 sc1
  v_mfma_f32_16x16x32_bf16 v[72:75], a[64:67], v[180:183], v[72:75]
  v_mfma_f32_16x16x32_bf16 v[76:79], a[68:71], v[180:183], v[76:79]
  v_mfma_f32_16x16x32_bf16 v[80:83], a[72:75], v[180:183], v[80:83]
  v_mfma_f32_16x16x32_bf16 v[84:87], a[76:79], v[180:183], v[84:87]
  s_waitcnt vmcnt(7)
  v_mfma_f32_16x16x32_bf16 v[68:71], a[80:83], v[184:187], v[68:71]
  buffer_load_dwordx4 v[152:155], v2, s[52:55], s18 offen offset:2048 sc1
  v_mfma_f32_16x16x32_bf16 v[72:75], a[84:87], v[184:187], v[72:75]
  v_mfma_f32_16x16x32_bf16 v[76:79], a[88:91], v[184:187], v[76:79]
  v_mfma_f32_16x16x32_bf16 v[80:83], a[92:95], v[184:187], v[80:83]
  v_mfma_f32_16x16x32_bf16 v[84:87], a[96:99], v[184:187], v[84:87]
  s_waitcnt vmcnt(7)
  v_mfma_f32_16x16x32_bf16 v[68:71], a[100:103], v[188:191], v[68:71]
  buffer_load_dwordx4 v[156:159], v2, s[52:55], s18 offen offset:3072 sc1
  v_mfma_f32_16x16x32_bf16 v[72:75], a[104:107], v[188:191], v[72:75]
  v_mfma_f32_16x16x32_bf16 v[76:79], a[108:111], v[188:191], v[76:79]
  v_mfma_f32_16x16x32_bf16 v[80:83], a[112:115], v[188:191], v[80:83]
  v_mfma_f32_16x16x32_bf16 v[84:87], a[116:119], v[188:191], v[84:87]
  s_waitcnt vmcnt(7)
  v_mfma_f32_16x16x32_bf16 v[68:71], a[120:123], v[128:131], v[68:71]
  s_add_u32 s18, s18, 4096
  buffer_load_dwordx4 v[160:163], v2, s[52:55], s18 offen offset:0 sc1
  v_mfma_f32_16x16x32_bf16 v[72:75], a[124:127], v[128:131], v[72:75]
  v_mfma_f32_16x16x32_bf16 v[76:79], a[128:131], v[128:131], v[76:79]
  v_mfma_f32_16x16x32_bf16 v[80:83], a[132:135], v[128:131], v[80:83]
  v_mfma_f32_16x16x32_bf16 v[84:87], a[136:139], v[128:131], v[84:87]
  s_waitcnt vmcnt(7)
  v_mfma_f32_16x16x32_bf16 v[68:71], a[140:143], v[132:135], v[68:71]
  buffer_load_dwordx4 v[164:167], v2, s[52:55], s18 offen offset:1024 sc1
  v_mfma_f32_16x16x32_bf16 v[72:75], a[144:147], v[132:135], v[72:75]
  v_mfma_f32_16x16x32_bf16 v[76:79], a[148:151], v[132:135], v[76:79]
  v_mfma_f32_16x16x32_bf16 v[80:83], a[152:155], v[132:135], v[80:83]
  v_mfma_f32_16x16x32_bf16 v[84:87], a[156:159], v[132:135], v[84:87]
  s_waitcnt vmcnt(7)
  v_mfma_f32_16x16x32_bf16 v[68:71], a[160:163], v[136:139], v[68:71]
  buffer_load_dwordx4 v[168:171], v2, s[52:55], s18 offen offset:2048 sc1
  v_mfma_f32_16x16x32_bf16 v[72:75], a[164:167], v[136:139], v[72:75]
  v_mfma_f32_16x16x32_bf16 v[76:79], a[168:171], v[136:139], v[76:79]
  v_mfma_f32_16x16x32_bf16 v[80:83], a[172:175], v[136:139], v[80:83]
  v_mfma_f32_16x16x32_bf16 v[84:87], a[176:179], v[136:139], v[84:87]
  s_waitcnt vmcnt(7)
  v_mfma_f32_16x16x32_bf16 v[68:71], a[180:183], v[140:143], v[68:71]
  buffer_load_dwordx4 v[172:175], v2, s[52:55], s18 offen offset:3072 sc1
  v_mfma_f32_16x16x32_bf16 v[72:75], a[184:187], v[140:143], v[72:75]
  v_mfma_f32_16x16x32_bf16 v[76:79], a[188:191], v[140:143], v[76:79]
  v_mfma_f32_16x16x32_bf16 v[80:83], a[192:195], v[140:143], v[80:83]
  v_mfma_f32_16x16x32_bf16 v[84:87], a[196:199], v[140:143], v[84:87]
  s_waitcnt vmcnt(7)
  v_mfma_f32_16x16x32_bf16 v[48:51], a[0:3], v[144:147], 0
  s_add_u32 s18, s18, 4096
  buffer_load_dwordx4 v[176:179], v2, s[52:55], s18 offen offset:0 sc1
  v_mfma_f32_16x16x32_bf16 v[52:55], a[4:7], v[144:147], 0
  v_mfma_f32_16x16x32_bf16 v[56:59], a[8:11], v[144:147], 0
  v_mfma_f32_16x16x32_bf16 v[60:63], a[12:15], v[144:147], 0
  v_mfma_f32_16x16x32_bf16 v[64:67], a[16:19], v[144:147], 0
  s_waitcnt vmcnt(7)
  v_mfma_f32_16x16x32_bf16 v[48:51], a[20:23], v[148:151], v[48:51]
  ds_write_b128 v45, v[68:71] offset:0
  buffer_load_dwordx4 v[180:183], v2, s[52:55], s18 offen offset:1024 sc1
  v_mfma_f32_16x16x32_bf16 v[52:55], a[24:27], v[148:151], v[52:55]
  ds_write_b128 v45, v[72:75] offset:1024
  s_mul_i32 s15, s7, 10240
  v_mfma_f32_16x16x32_bf16 v[56:59], a[28:31], v[148:151], v[56:59]
  ds_write_b128 v45, v[76:79] offset:2048
  s_add_u32 s15, s15, 102400
  v_mfma_f32_16x16x32_bf16 v[60:63], a[32:35], v[148:151], v[60:63]
  ds_write_b128 v45, v[80:83] offset:3072
  v_add_u32 v47, s15, v2
  v_mfma_f32_16x16x32_bf16 v[64:67], a[36:39], v[148:151], v[64:67]
  ds_write_b128 v45, v[84:87] offset:4096
  s_waitcnt vmcnt(7)
  v_mfma_f32_16x16x32_bf16 v[48:51], a[40:43], v[152:155], v[48:51]
  buffer_load_dwordx4 v[184:187], v2, s[52:55], s19 offen offset:0 sc1
  s_waitcnt lgkmcnt(0)
  s_barrier
  v_mfma_f32_16x16x32_bf16 v[52:55], a[44:47], v[152:155], v[52:55]
  ds_read_b128 v[192:195], v47 offset:0
  ds_read_b128 v[196:199], v47 offset:1024
  v_mfma_f32_16x16x32_bf16 v[56:59], a[48:51], v[152:155], v[56:59]
  ds_read_b128 v[200:203], v47 offset:2048
  ds_read_b128 v[204:207], v47 offset:3072
  v_mfma_f32_16x16x32_bf16 v[60:63], a[52:55], v[152:155], v[60:63]
  ds_read_b128 v[208:211], v47 offset:4096
  v_mfma_f32_16x16x32_bf16 v[64:67], a[56:59], v[152:155], v[64:67]
  ds_read_b128 v[212:215], v47 offset:5120
  s_waitcnt vmcnt(7)
  v_mfma_f32_16x16x32_bf16 v[48:51], a[60:63], v[156:159], v[48:51]
  buffer_load_dwordx4 v[188:191], v2, s[52:55], s19 offen offset:1024 sc1
  ds_read_b128 v[216:219], v47 offset:6144
  v_mfma_f32_16x16x32_bf16 v[52:55], a[64:67], v[156:159], v[52:55]
  ds_read_b128 v[220:223], v47 offset:7168
  ds_read_b128 v[224:227], v47 offset:8192
  v_mfma_f32_16x16x32_bf16 v[56:59], a[68:71], v[156:159], v[56:59]
  ds_read_b128 v[228:231], v47 offset:9216
  s_waitcnt lgkmcnt(5)
  v_mfma_f32_16x16x32_bf16 v[60:63], a[72:75], v[156:159], v[60:63]
  v_add_f32 v108, v108, v192
  v_mfma_f32_16x16x32_bf16 v[64:67], a[76:79], v[156:159], v[64:67]
  v_add_f32 v109, v109, v193
  s_waitcnt vmcnt(7)
  v_mfma_f32_16x16x32_bf16 v[48:51], a[80:83], v[160:163], v[48:51]
  buffer_load_dwordx4 v[128:131], v2, s[52:55], s19 offen offset:2048 sc1
  v_add_f32_e64 v110, v110, v194
  v_mfma_f32_16x16x32_bf16 v[52:55], a[84:87], v[160:163], v[52:55]
  v_add_f32 v111, v111, v195
  v_add_f32 v112, v112, v196
  v_mfma_f32_16x16x32_bf16 v[56:59], a[88:91], v[160:163], v[56:59]
  v_add_f32 v113, v113, v197
  v_add_f32 v114, v114, v198
  v_mfma_f32_16x16x32_bf16 v[60:63], a[92:95], v[160:163], v[60:63]
  v_add_f32_e64 v115, v115, v199
  v_mfma_f32_16x16x32_bf16 v[64:67], a[96:99], v[160:163], v[64:67]
  v_add_f32 v116, v116, v200
  s_waitcnt vmcnt(7)
  v_mfma_f32_16x16x32_bf16 v[48:51], a[100:103], v[164:167], v[48:51]
  buffer_load_dwordx4 v[132:135], v2, s[52:55], s19 offen offset:3072 sc1
  v_add_f32_e64 v117, v117, v201
  v_mfma_f32_16x16x32_bf16 v[52:55], a[104:107], v[164:167], v[52:55]
  v_add_f32 v118, v118, v202
  v_add_f32 v119, v119, v203
  v_mfma_f32_16x16x32_bf16 v[56:59], a[108:111], v[164:167], v[56:59]
  v_add_f32 v120, v120, v204
  v_add_f32 v121, v121, v205
  v_mfma_f32_16x16x32_bf16 v[60:63], a[112:115], v[164:167], v[60:63]
  v_add_f32_e64 v122, v122, v206
  v_mfma_f32_16x16x32_bf16 v[64:67], a[116:119], v[164:167], v[64:67]
  v_add_f32 v123, v123, v207
  s_waitcnt vmcnt(7)
  v_mfma_f32_16x16x32_bf16 v[48:51], a[120:123], v[168:171], v[48:51]
  s_add_u32 s19, s19, 4096
  buffer_load_dwordx4 v[136:139], v2, s[52:55], s19 offen offset:0 sc1
  v_add_f32_e64 v124, v124, v208
  v_mfma_f32_16x16x32_bf16 v[52:55], a[124:127], v[168:171], v[52:55]
  v_add_f32 v125, v125, v209
  v_add_f32 v126, v126, v210
  v_mfma_f32_16x16x32_bf16 v[56:59], a[128:131], v[168:171], v[56:59]
  v_add_f32 v127, v127, v211
  s_waitcnt lgkmcnt(0)
  v_mfma_f32_16x16x32_bf16 v[60:63], a[132:135], v[168:171], v[60:63]
  v_add_f32_e64 v108, v108, v212
  v_mfma_f32_16x16x32_bf16 v[64:67], a[136:139], v[168:171], v[64:67]
  v_add_f32 v109, v109, v213
  s_waitcnt vmcnt(7)
  v_mfma_f32_16x16x32_bf16 v[48:51], a[140:143], v[172:175], v[48:51]
  buffer_load_dwordx4 v[140:143], v2, s[52:55], s19 offen offset:1024 sc1
  v_add_f32_e64 v110, v110, v214
  v_mfma_f32_16x16x32_bf16 v[52:55], a[144:147], v[172:175], v[52:55]
  v_add_f32 v111, v111, v215
  v_add_f32 v112, v112, v216
  v_mfma_f32_16x16x32_bf16 v[56:59], a[148:151], v[172:175], v[56:59]
  v_add_f32 v113, v113, v217
  v_add_f32 v114, v114, v218
  v_mfma_f32_16x16x32_bf16 v[60:63], a[152:155], v[172:175], v[60:63]
  v_add_f32_e64 v115, v115, v219
  v_mfma_f32_16x16x32_bf16 v[64:67], a[156:159], v[172:175], v[64:67]
  v_add_f32 v116, v116, v220
  s_waitcnt vmcnt(7)
  v_mfma_f32_16x16x32_bf16 v[48:51], a[160:163], v[176:179], v[48:51]
  buffer_load_dwordx4 v[144:147], v2, s[52:55], s19 offen offset:2048 sc1
  v_add_f32_e64 v117, v117, v221
  v_mfma_f32_16x16x32_bf16 v[52:55], a[164:167], v[176:179], v[52:55]
  v_add_f32 v118, v118, v222
  v_add_f32 v119, v119, v223
  v_mfma_f32_16x16x32_bf16 v[56:59], a[168:171], v[176:179], v[56:59]
  v_add_f32 v120, v120, v224
  v_add_f32 v121, v121, v225
  v_mfma_f32_16x16x32_bf16 v[60:63], a[172:175], v[176:179], v[60:63]
  v_add_f32_e64 v122, v122, v226
  v_mfma_f32_16x16x32_bf16 v[64:67], a[176:179], v[176:179], v[64:67]
  v_add_f32 v123, v123, v227
  s_waitcnt vmcnt(7)
  v_mfma_f32_16x16x32_bf16 v[48:51], a[180:183], v[180:183], v[48:51]
  buffer_load_dwordx4 v[148:151], v2, s[52:55], s19 offen offset:3072 sc1
  v_mfma_f32_16x16x32_bf16 v[52:55], a[184:187], v[180:183], v[52:55]
  v_add_f32_e64 v124, v124, v228
  v_mfma_f32_16x16x32_bf16 v[56:59], a[188:191], v[180:183], v[56:59]
  v_add_f32_e64 v125, v125, v229
  v_mfma_f32_16x16x32_bf16 v[60:63], a[192:195], v[180:183], v[60:63]
  v_add_f32_e64 v126, v126, v230
  v_mfma_f32_16x16x32_bf16 v[64:67], a[196:199], v[180:183], v[64:67]
  v_add_f32 v127, v127, v231
  s_waitcnt vmcnt(7)
  v_mfma_f32_16x16x32_bf16 v[68:71], a[0:3], v[184:187], v[108:111]
  s_add_u32 s19, s19, 4096
  buffer_load_dwordx4 v[152:155], v2, s[52:55], s19 offen offset:0 sc1
  v_mfma_f32_16x16x32_bf16 v[72:75], a[4:7], v[184:187], v[112:115]
  v_mfma_f32_16x16x32_bf16 v[76:79], a[8:11], v[184:187], v[116:119]
  v_mfma_f32_16x16x32_bf16 v[80:83], a[12:15], v[184:187], v[120:123]
  v_mfma_f32_16x16x32_bf16 v[84:87], a[16:19], v[184:187], v[124:127]
  s_waitcnt vmcnt(7)
  v_mfma_f32_16x16x32_bf16 v[68:71], a[20:23], v[188:191], v[68:71]
  ds_write_b128 v46, v[48:51] offset:0
  buffer_load_dwordx4 v[156:159], v2, s[52:55], s19 offen offset:1024 sc1
  v_mfma_f32_16x16x32_bf16 v[72:75], a[24:27], v[188:191], v[72:75]
  ds_write_b128 v46, v[52:55] offset:1024
  v_mfma_f32_16x16x32_bf16 v[76:79], a[28:31], v[188:191], v[76:79]
  ds_write_b128 v46, v[56:59] offset:2048
  v_mfma_f32_16x16x32_bf16 v[80:83], a[32:35], v[188:191], v[80:83]
  ds_write_b128 v46, v[60:63] offset:3072
  v_mfma_f32_16x16x32_bf16 v[84:87], a[36:39], v[188:191], v[84:87]
  ds_write_b128 v46, v[64:67] offset:4096
  s_waitcnt vmcnt(7)
  v_mfma_f32_16x16x32_bf16 v[68:71], a[40:43], v[128:131], v[68:71]
  v_mfma_f32_16x16x32_bf16 v[72:75], a[44:47], v[128:131], v[72:75]
  v_mfma_f32_16x16x32_bf16 v[76:79], a[48:51], v[128:131], v[76:79]
  v_mfma_f32_16x16x32_bf16 v[80:83], a[52:55], v[128:131], v[80:83]
  v_mfma_f32_16x16x32_bf16 v[84:87], a[56:59], v[128:131], v[84:87]
  s_waitcnt vmcnt(6)
  v_mfma_f32_16x16x32_bf16 v[68:71], a[60:63], v[132:135], v[68:71]
  s_lshl_b32 vcc_lo, s1, 2
  s_add_u32 vcc_lo, vcc_lo, s7
  s_cmp_lg_u32 vcc_lo, 3
  s_cbranch_scc1 skip_82
  buffer_wbl2 sc1
skip_82:
  v_mfma_f32_16x16x32_bf16 v[72:75], a[64:67], v[132:135], v[72:75]
  s_mul_i32 s15, s7, 5120
  v_mfma_f32_16x16x32_bf16 v[76:79], a[68:71], v[132:135], v[76:79]
  v_add_u32 v47, s15, v2
  v_mfma_f32_16x16x32_bf16 v[80:83], a[72:75], v[132:135], v[80:83]
  v_mfma_f32_16x16x32_bf16 v[84:87], a[76:79], v[132:135], v[84:87]
  s_waitcnt vmcnt(5)
  v_mfma_f32_16x16x32_bf16 v[68:71], a[80:83], v[136:139], v[68:71]
  s_waitcnt lgkmcnt(0)
  s_barrier
  ds_read_b128 v[192:195], v47 offset:0
  v_mfma_f32_16x16x32_bf16 v[72:75], a[84:87], v[136:139], v[72:75]
  ds_read_b128 v[196:199], v47 offset:1024
  v_mfma_f32_16x16x32_bf16 v[76:79], a[88:91], v[136:139], v[76:79]
  ds_read_b128 v[200:203], v47 offset:2048
  v_mfma_f32_16x16x32_bf16 v[80:83], a[92:95], v[136:139], v[80:83]
  ds_read_b128 v[204:207], v47 offset:3072
  v_mfma_f32_16x16x32_bf16 v[84:87], a[96:99], v[136:139], v[84:87]
  ds_read_b128 v[208:211], v47 offset:4096
  s_waitcnt vmcnt(4)
  v_mfma_f32_16x16x32_bf16 v[68:71], a[100:103], v[140:143], v[68:71]
  v_mfma_f32_16x16x32_bf16 v[72:75], a[104:107], v[140:143], v[72:75]
  v_mfma_f32_16x16x32_bf16 v[76:79], a[108:111], v[140:143], v[76:79]
  v_mfma_f32_16x16x32_bf16 v[80:83], a[112:115], v[140:143], v[80:83]
  v_mfma_f32_16x16x32_bf16 v[84:87], a[116:119], v[140:143], v[84:87]
  s_waitcnt vmcnt(3)
  v_mfma_f32_16x16x32_bf16 v[68:71], a[120:123], v[144:147], v[68:71]
  v_mfma_f32_16x16x32_bf16 v[72:75], a[124:127], v[144:147], v[72:75]
  v_mfma_f32_16x16x32_bf16 v[76:79], a[128:131], v[144:147], v[76:79]
  v_mfma_f32_16x16x32_bf16 v[80:83], a[132:135], v[144:147], v[80:83]
  v_mfma_f32_16x16x32_bf16 v[84:87], a[136:139], v[144:147], v[84:87]
  s_waitcnt vmcnt(2)
  v_mfma_f32_16x16x32_bf16 v[68:71], a[140:143], v[148:151], v[68:71]
  v_mfma_f32_16x16x32_bf16 v[72:75], a[144:147], v[148:151], v[72:75]
  v_mfma_f32_16x16x32_bf16 v[76:79], a[148:151], v[148:151], v[76:79]
  v_mfma_f32_16x16x32_bf16 v[80:83], a[152:155], v[148:151], v[80:83]
  v_mfma_f32_16x16x32_bf16 v[84:87], a[156:159], v[148:151], v[84:87]
  s_waitcnt vmcnt(1)
  v_mfma_f32_16x16x32_bf16 v[68:71], a[160:163], v[152:155], v[68:71]
  v_mfma_f32_16x16x32_bf16 v[72:75], a[164:167], v[152:155], v[72:75]
  v_mfma_f32_16x16x32_bf16 v[76:79], a[168:171], v[152:155], v[76:79]
  v_mfma_f32_16x16x32_bf16 v[80:83], a[172:175], v[152:155], v[80:83]
  v_mfma_f32_16x16x32_bf16 v[84:87], a[176:179], v[152:155], v[84:87]
  s_waitcnt vmcnt(0)
  v_mfma_f32_16x16x32_bf16 v[68:71], a[180:183], v[156:159], v[68:71]
  v_mfma_f32_16x16x32_bf16 v[72:75], a[184:187], v[156:159], v[72:75]
  v_mfma_f32_16x16x32_bf16 v[76:79], a[188:191], v[156:159], v[76:79]
  v_mfma_f32_16x16x32_bf16 v[80:83], a[192:195], v[156:159], v[80:83]
  v_mfma_f32_16x16x32_bf16 v[84:87], a[196:199], v[156:159], v[84:87]
  s_lshl_b32 s12, s5, 15
  s_lshl_b32 s13, s7, 10
  s_add_u32 s12, s12, s13
  s_add_u32 s12, s12, 2359296
  s_lshl_b32 s13, s6, 12
  s_add_u32 s13, s13, s12
  s_waitcnt lgkmcnt(0)
  v_pk_add_f32 v[68:69], v[68:69], v[192:193]
  v_pk_add_f32 v[70:71], v[70:71], v[194:195]
  v_pk_add_f32 v[72:73], v[72:73], v[196:197]
  v_pk_add_f32 v[74:75], v[74:75], v[198:199]
  v_pk_add_f32 v[76:77], v[76:77], v[200:201]
  v_pk_add_f32 v[78:79], v[78:79], v[202:203]
  v_pk_add_f32 v[80:81], v[80:81], v[204:205]
  v_pk_add_f32 v[82:83], v[82:83], v[206:207]
  v_pk_add_f32 v[84:85], v[84:85], v[208:209]
  v_pk_add_f32 v[86:87], v[86:87], v[210:211]
  v_pk_add_f32 v[212:213], v[68:69], v[70:71]
  v_pk_mul_f32 v[214:215], v[68:69], v[68:69]
  v_pk_fma_f32 v[214:215], v[70:71], v[70:71], v[214:215]
  v_pk_add_f32 v[212:213], v[212:213], v[72:73]
  v_pk_fma_f32 v[214:215], v[72:73], v[72:73], v[214:215]
  v_pk_add_f32 v[212:213], v[212:213], v[74:75]
  v_pk_fma_f32 v[214:215], v[74:75], v[74:75], v[214:215]
  v_pk_add_f32 v[212:213], v[212:213], v[76:77]
  v_pk_fma_f32 v[214:215], v[76:77], v[76:77], v[214:215]
  v_pk_add_f32 v[212:213], v[212:213], v[78:79]
  v_pk_fma_f32 v[214:215], v[78:79], v[78:79], v[214:215]
  v_pk_add_f32 v[212:213], v[212:213], v[80:81]
  v_pk_fma_f32 v[214:215], v[80:81], v[80:81], v[214:215]
  v_pk_add_f32 v[212:213], v[212:213], v[82:83]
  v_pk_fma_f32 v[214:215], v[82:83], v[82:83], v[214:215]
  v_pk_add_f32 v[212:213], v[212:213], v[84:85]
  v_pk_fma_f32 v[214:215], v[84:85], v[84:85], v[214:215]
  v_pk_add_f32 v[212:213], v[212:213], v[86:87]
  v_pk_fma_f32 v[214:215], v[86:87], v[86:87], v[214:215]
  v_add_f32 v228, v212, v213
  v_add_f32 v229, v214, v215
  v_mov_b32 v230, s8
  v_mov_b32 v231, s8
  v_mov_b32 v212, v228
  v_mov_b32 v213, v229
  s_nop 0
  v_permlane32_swap_b32 v228, v212
  v_permlane32_swap_b32 v229, v213
  v_add_f32 v228, v228, v212
  v_add_f32 v229, v229, v213
  v_mov_b32 v212, v228
  v_mov_b32 v213, v229
  s_nop 0
  v_permlane16_swap_b32 v228, v212
  v_permlane16_swap_b32 v229, v213
  v_add_f32 v228, v228, v212
  v_add_f32 v229, v229, v213
  s_mov_b64 exec, 0xffff
  s_cmp_eq_u32 s9, 0
  s_cbranch_scc1 slow_83
  buffer_store_dwordx4 v[228:231], v2, s[52:55], s13 offen
back_84:
  s_mov_b64 exec, -1
  s_mul_i32 s14, s7, 10240
  s_add_u32 s14, s14, 102400
  v_lshrrev_b32 v12, 1, v3
  v_xor_b32 v12, v12, v4
  v_and_b32 v12, 3, v12
  v_lshlrev_b32_e64 v12, 4, v12
  v_lshl_add_u32 v12, v3, 6, v12
  v_add_u32_e64 v44, s14, v12
  ds_write_b128 v44, v[68:71] offset:0
  ds_write_b128 v44, v[88:91] offset:5120
  ds_write_b128 v44, v[72:75] offset:1024
  ds_write_b128 v44, v[92:95] offset:6144
  ds_write_b128 v44, v[76:79] offset:2048
  ds_write_b128 v44, v[96:99] offset:7168
  ds_write_b128 v44, v[80:83] offset:3072
  ds_write_b128 v44, v[100:103] offset:8192
  ds_write_b128 v44, v[84:87] offset:4096
  ds_write_b128 v44, v[104:107] offset:9216
  v_lshrrev_b32 v12, 3, v1
  v_xor_b32 v12, v12, v1
  v_and_b32 v12, 3, v12
  v_lshlrev_b32 v12, 4, v12
  v_lshrrev_b32_e64 v13, 2, v1
  v_lshl_add_u32 v12, v13, 6, v12
  v_add_u32_e64 v45, s14, v12
  ds_read_b128 v[160:163], v45 offset:0
  ds_read_b128 v[180:183], v45 offset:5120
  ds_read_b128 v[164:167], v45 offset:1024
  ds_read_b128 v[184:187], v45 offset:6144
  ds_read_b128 v[168:171], v45 offset:2048
  ds_read_b128 v[188:191], v45 offset:7168
  ds_read_b128 v[172:175], v45 offset:3072
  ds_read_b128 v[192:195], v45 offset:8192
  ds_read_b128 v[176:179], v45 offset:4096
  ds_read_b128 v[196:199], v45 offset:9216
  v_and_b32 v14, 3, v1
  v_lshlrev_b32 v11, 13, v14
  v_lshl_add_u32 v11, v13, 4, v11
  s_add_u32 s13, s12, 4096
  v_lshrrev_b32_e64 v12, 2, v13
  v_lshl_add_u32 v12, v12, 2, v13
  v_mul_u32_u24 v12, 2560, v12
  v_lshl_add_u32 v46, v14, 4, v12
  s_lshl_b32 s15, s5, 6
  s_lshr_b32 s88, s7, 1
  s_lshl_b32 s88, s88, 5
  s_add_u32 s15, s15, s88
  s_and_b32 s88, s7, 1
  s_lshl_b32 s88, s88, 2
  s_add_u32 s15, s15, s88
  s_mul_i32 s15, s15, 2560
  s_mul_i32 s88, s6, 320
  s_add_u32 s15, s15, s88
  s_mov_b32 s60, s46
  s_and_b32 s61, s47, 0xffff
  s_mov_b32 s62, 5242880
  s_mov_b32 s63, 0x20000
again_85:
  buffer_load_dwordx3 v[128:130], v11, s[52:55], s12 offen sc1
  buffer_load_dwordx3 v[132:134], v11, s[52:55], s13 offen sc1
  s_sub_u32 s10, s10, 1
  s_cmp_gt_i32 s10, 0
  s_waitcnt vmcnt(0)
  v_xor_b32 v15, s8, v130
  v_xor_b32 v14, s8, v134
  v_or_b32 v15, v15, v14
  v_cmp_ne_u32 vcc, 0, v15
  s_cbranch_scc0 out_87
  s_cbranch_vccnz again_85
out_87:
ok_86:
  s_waitcnt lgkmcnt(0)
  v_pk_add_f32 v[128:129], v[128:129], v[132:133]
  s_nop 1
  v_add_f32_dpp v128, v128, v128 quad_perm:[1,0,3,2] row_mask:0xf bank_mask:0xf
  v_add_f32_dpp v129, v129, v129 quad_perm:[1,0,3,2] row_mask:0xf bank_mask:0xf
  s_nop 0
  v_add_f32_dpp v128, v128, v128 quad_perm:[2,3,0,1] row_mask:0xf bank_mask:0xf
  v_add_f32_dpp v129, v129, v129 quad_perm:[2,3,0,1] row_mask:0xf bank_mask:0xf
  v_mul_f32 v128, 0x3acccccd, v128
  v_mul_f32 v202, 0x3acccccd, v129
  v_fma_f32 v202, -v128, v128, v202
  v_max_f32 v202, 0, v202
  v_add_f32 v202, 0x3727c5ac, v202
  v_rsq_f32 v200, v202
  s_nop 0
  v_mul_f32_e64 v201, v128, v200
  v_pk_fma_f32 v[132:133], v[160:161], v[200:201], v[200:201] op_sel:[0,0,1] op_sel_hi:[1,0,1] neg_lo:[0,0,1] neg_hi:[0,0,1]
  v_pk_fma_f32 v[134:135], v[162:163], v[200:201], v[200:201] op_sel:[0,0,1] op_sel_hi:[1,0,1] neg_lo:[0,0,1] neg_hi:[0,0,1]
  v_pk_fma_f32 v[160:161], v[132:133], v[180:181], v[160:161]
  v_pk_fma_f32 v[162:163], v[134:135], v[182:183], v[162:163]
  buffer_store_dwordx4 v[160:163], v46, s[60:63], s15 offen offset:0 sc1
  v_pk_fma_f32 v[136:137], v[164:165], v[200:201], v[200:201] op_sel:[0,0,1] op_sel_hi:[1,0,1] neg_lo:[0,0,1] neg_hi:[0,0,1]
  v_pk_fma_f32 v[138:139], v[166:167], v[200:201], v[200:201] op_sel:[0,0,1] op_sel_hi:[1,0,1] neg_lo:[0,0,1] neg_hi:[0,0,1]
  v_pk_fma_f32 v[164:165], v[136:137], v[184:185], v[164:165]
  v_pk_fma_f32 v[166:167], v[138:139], v[186:187], v[166:167]
  buffer_store_dwordx4 v[164:167], v46, s[60:63], s15 offen offset:64 sc1
  v_pk_fma_f32 v[132:133], v[168:169], v[200:201], v[200:201] op_sel:[0,0,1] op_sel_hi:[1,0,1] neg_lo:[0,0,1] neg_hi:[0,0,1]
  v_pk_fma_f32 v[134:135], v[170:171], v[200:201], v[200:201] op_sel:[0,0,1] op_sel_hi:[1,0,1] neg_lo:[0,0,1] neg_hi:[0,0,1]
  v_pk_fma_f32 v[168:169], v[132:133], v[188:189], v[168:169]
  v_pk_fma_f32 v[170:171], v[134:135], v[190:191], v[170:171]
  buffer_store_dwordx4 v[168:171], v46, s[60:63], s15 offen offset:128 sc1
  v_pk_fma_f32 v[136:137], v[172:173], v[200:201], v[200:201] op_sel:[0,0,1] op_sel_hi:[1,0,1] neg_lo:[0,0,1] neg_hi:[0,0,1]
  v_pk_fma_f32 v[138:139], v[174:175], v[200:201], v[200:201] op_sel:[0,0,1] op_sel_hi:[1,0,1] neg_lo:[0,0,1] neg_hi:[0,0,1]
  v_pk_fma_f32 v[172:173], v[136:137], v[192:193], v[172:173]
  v_pk_fma_f32 v[174:175], v[138:139], v[194:195], v[174:175]
  buffer_store_dwordx4 v[172:175], v46, s[60:63], s15 offen offset:192 sc1
  v_pk_fma_f32 v[132:133], v[176:177], v[200:201], v[200:201] op_sel:[0,0,1] op_sel_hi:[1,0,1] neg_lo:[0,0,1] neg_hi:[0,0,1]
  v_pk_fma_f32 v[134:135], v[178:179], v[200:201], v[200:201] op_sel:[0,0,1] op_sel_hi:[1,0,1] neg_lo:[0,0,1] neg_hi:[0,0,1]
  v_pk_fma_f32 v[176:177], v[132:133], v[196:197], v[176:177]
  v_pk_fma_f32 v[178:179], v[134:135], v[198:199], v[178:179]
  buffer_store_dwordx4 v[176:179], v46, s[60:63], s15 offen offset:256 sc1
L_end:
  s_endpgm
again_10:
  s_sub_u32 s10, s10, 1
  s_cmp_gt_i32 s10, 0
  s_cbranch_scc0 ok_11
  buffer_load_dword v184, v185, s[52:55], s89 offen sc1
  s_waitcnt vmcnt(0)
  v_xor_b32 v15, s8, v184
  v_cmp_lt_u32 vcc, 15, v15
  s_cbranch_vccz ok_11
  s_and_b32 s13, s10, 3
  s_cbranch_scc1 again_10
  buffer_load_dword v184, v185, s[52:55], s89 offen offset:128 sc1
  s_waitcnt vmcnt(0)
  v_xor_b32 v15, s8, v184
  v_cmp_lt_u32 vcc, 15, v15
  s_cbranch_vccnz again_10
  s_branch ok_11
slow_12:
  buffer_store_dwordx4 v[232:235], v171, s[52:55], s87 offen sc1
  s_add_u32 s87, s87, 4096
  buffer_store_dwordx4 v[236:239], v171, s[52:55], s87 offen sc1
  s_add_u32 s87, s87, 4096
  buffer_store_dwordx4 v[88:91], v171, s[52:55], s87 offen sc1
  s_add_u32 s87, s87, 4096
  buffer_store_dwordx4 v[92:95], v171, s[52:55], s87 offen sc1
  s_nop 1
  s_branch back_13
again_14:
  s_sub_u32 s10, s10, 1
  s_cmp_gt_i32 s10, 0
  s_cbranch_scc0 ok_15
  buffer_load_dword v184, v185, s[52:55], s89 offen sc1
  s_waitcnt vmcnt(0)
  v_xor_b32 v15, s8, v184
  v_cmp_lt_u32 vcc, 15, v15
  s_cbranch_vccz ok_15
  s_and_b32 s13, s10, 3
  s_cbranch_scc1 again_14
  buffer_load_dword v184, v185, s[52:55], s89 offen offset:128 sc1
  s_waitcnt vmcnt(0)
  v_xor_b32 v15, s8, v184
  v_cmp_lt_u32 vcc, 15, v15
  s_cbranch_vccnz again_14
  s_branch ok_15
slow_16:
  buffer_store_dword v15, off, s[52:55], s12 sc1
  s_nop 1
  s_branch back_17
again_18:
  s_sub_u32 s10, s10, 1
  s_cmp_gt_i32 s10, 0
  s_cbranch_scc0 ok_19
  buffer_load_dwordx4 v[188:191], v187, s[52:55], s87 offen sc1
  s_waitcnt vmcnt(0)
  v_min3_u32 v15, v188, v189, s8
  v_max3_u32 v14, v188, v189, s8
  v_min3_u32 v15, v15, v190, v191
  v_max3_u32 v14, v14, v190, v191
  v_cmp_ne_u32 vcc, v15, v14
  s_cbranch_vccnz again_18
  s_branch ok_19
again_20:
  s_sub_u32 s10, s10, 1
  s_cmp_gt_i32 s10, 0
  s_cbranch_scc0 ok_21
  buffer_load_dwordx4 v[188:191], v187, s[52:55], s88 offen sc1
  s_waitcnt vmcnt(0)
  v_min3_u32 v15, v188, v189, s8
  v_max3_u32 v14, v188, v189, s8
  v_min3_u32 v15, v15, v190, v191
  v_max3_u32 v14, v14, v190, v191
  v_cmp_ne_u32 vcc, v15, v14
  s_cbranch_vccnz again_20
  s_branch ok_21
again_22:
  s_sub_u32 s10, s10, 1
  s_cmp_gt_i32 s10, 0
  s_cbranch_scc0 ok_23
  buffer_load_dwordx3 v[152:154], v160, s[52:55], s93 offen sc1
  buffer_load_dwordx2 v[156:157], v161, s[52:55], s94 offen sc1
  buffer_load_dwordx2 v[158:159], v162, s[52:55], s94 offen offset:512 sc1
  s_waitcnt vmcnt(0)
  v_min3_u32 v15, v154, v154, s8
  v_max3_u32 v14, v154, v154, s8
  v_min3_u32 v15, v15, v157, v159
  v_max3_u32 v14, v14, v157, v159
  v_cmp_ne_u32 vcc, v15, v14
  s_cbranch_vccnz again_22
  s_branch ok_23
slow_28:
  buffer_store_dwordx4 v[52:55], v47, s[52:55], s13 offen sc1
  s_nop 1
  s_branch back_29
slow_30:
  buffer_store_dwordx4 v[60:63], v47, s[52:55], s13 offen sc1
  s_nop 1
  s_branch back_31
slow_32:
  buffer_store_dwordx4 v[68:71], v47, s[52:55], s13 offen sc1
  s_nop 1
  s_branch back_33
slow_34:
  buffer_store_dwordx4 v[76:79], v47, s[52:55], s13 offen sc1
  s_nop 1
  s_branch back_35
slow_36:
  buffer_store_dwordx4 v[84:87], v47, s[52:55], s13 offen sc1
  s_nop 1
  s_branch back_37
slow_42:
  buffer_store_dword v15, off, s[52:55], s14 sc1
  s_nop 1
  s_branch back_43
slow_44:
  buffer_store_dword v15, off, s[52:55], s14 sc1
  s_nop 1
  s_branch back_45
again_49:
  s_sub_u32 s10, s10, 1
  s_cmp_gt_i32 s10, 0
  s_cbranch_scc0 ok_50
  s_mul_i32 s95, s7, 10240
  s_add_u32 s95, s95, 107520
  s_and_b32 s93, s7, 1
  s_lshl_b32 s93, s93, 3
  s_add_u32 s93, s93, s95
  v_add_u32 v253, s93, v2
  s_add_u32 m0, s95, 0
  s_add_u32 s93, s92, 0
  buffer_load_dwordx4 v252, s[52:55], s93 offen sc1 lds
  s_add_u32 m0, s95, 1024
  s_add_u32 s93, s92, 65536
  buffer_load_dwordx4 v252, s[52:55], s93 offen sc1 lds
  s_add_u32 m0, s95, 2048
  s_add_u32 s93, s92, 131072
  buffer_load_dwordx4 v252, s[52:55], s93 offen sc1 lds
  s_add_u32 m0, s95, 3072
  s_add_u32 s93, s92, 196608
  buffer_load_dwordx4 v252, s[52:55], s93 offen sc1 lds
  s_add_u32 m0, s95, 4096
  s_add_u32 s93, s92, 262144
  buffer_load_dwordx4 v252, s[52:55], s93 offen sc1 lds
  s_waitcnt vmcnt(0)
  ds_read_b64_tr_b16 v[232:233], v253 offset:0
  ds_read_b64_tr_b16 v[234:235], v253 offset:1024
  ds_read_b64_tr_b16 v[236:237], v253 offset:2048
  ds_read_b64_tr_b16 v[238:239], v253 offset:3072
  ds_read_b64_tr_b16 v[240:241], v253 offset:4096
  s_waitcnt lgkmcnt(0)
  v_pk_max_u16 v15, v232, v233
  v_pk_max_u16 v15, v15, v234
  v_pk_max_u16 v15, v15, v235
  v_pk_max_u16 v15, v15, v236
  v_pk_max_u16 v15, v15, v237
  v_pk_max_u16 v15, v15, v238
  v_pk_max_u16 v15, v15, v239
  v_pk_max_u16 v15, v15, v240
  v_pk_max_u16 v15, v15, v241
  v_lshlrev_b32 v14, 16, v15
  v_max_u32_e64 v15, v15, v14
  v_cmp_le_u32 vcc, 0xffff0000, v15
  s_cbranch_vccnz again_49
  s_branch ok_50
slow_51:
  buffer_store_dwordx4 v[228:231], v2, s[52:55], s13 offen sc1
  s_nop 1
  s_branch back_52
slow_56:
  buffer_store_dwordx2 v[180:181], v47, s[52:55], s88 offen offset:0 sc1
  buffer_store_dwordx2 v[182:183], v47, s[52:55], s88 offen offset:128 sc1
  buffer_store_dwordx2 v[184:185], v47, s[52:55], s88 offen offset:256 sc1
  buffer_store_dwordx2 v[186:187], v47, s[52:55], s88 offen offset:384 sc1
  buffer_store_dwordx2 v[188:189], v47, s[52:55], s88 offen offset:512 sc1
  s_nop 1
  s_branch back_57
slow_58:
  buffer_store_dword v15, off, s[52:55], s13 sc1
  s_nop 1
  s_branch back_59
slow_67:
  buffer_store_dwordx4 v[52:55], v47, s[52:55], s13 offen sc1
  s_nop 1
  s_branch back_68
slow_69:
  buffer_store_dwordx4 v[60:63], v47, s[52:55], s13 offen sc1
  s_nop 1
  s_branch back_70
slow_71:
  buffer_store_dwordx4 v[68:71], v47, s[52:55], s13 offen sc1
  s_nop 1
  s_branch back_72
slow_73:
  buffer_store_dwordx4 v[76:79], v47, s[52:55], s13 offen sc1
  s_nop 1
  s_branch back_74
slow_75:
  buffer_store_dwordx4 v[84:87], v47, s[52:55], s13 offen sc1
  s_nop 1
  s_branch back_76
slow_77:
  buffer_store_dword v15, off, s[52:55], s14 sc1
  s_nop 1
  s_branch back_78
slow_83:
  buffer_store_dwordx4 v[228:231], v2, s[52:55], s13 offen sc1
  s_nop 1
  s_branch back_84
  s_endpgm
L_codeend:
.section .rodata,"a"
.p2align 6
.amdhsa_kernel interleave_layers__ssm_conv_s5__ssm_conv_h3__prompt_kernel
  .amdhsa_next_free_vgpr 512
  .amdhsa_next_free_sgpr 102
  .amdhsa_accum_offset 256
  .amdhsa_group_segment_fixed_size 0
  .amdhsa_kernarg_size 144
  .amdhsa_user_sgpr_count 2
  .amdhsa_user_sgpr_kernarg_segment_ptr 1
  .amdhsa_system_sgpr_workgroup_id_x 1
.end_amdhsa_kernel
```

```asm
; @launch grid=(256,1,1) block=(256,1,1) lds=163840
.amdgcn_target "amdgcn-amd-amdhsa--gfx950"
.text
.globl interleave_layers__ssm_conv_s5__ssm_conv_h3__prompt_kernel
.p2align 8
.type interleave_layers__ssm_conv_s5__ssm_conv_h3__prompt_kernel,@function
interleave_layers__ssm_conv_s5__ssm_conv_h3__prompt_kernel:
  s_cmp_ge_u32 s2, 256
  s_cbranch_scc1 L_end
  s_load_dwordx16 s[16:31], s[0:1], 0
  s_load_dwordx16 s[32:47], s[0:1], 64
  s_load_dwordx4 s[48:51], s[0:1], 128
  v_and_b32 v1, 63, v0
  v_lshrrev_b32 v11, 6, v0
  v_lshlrev_b32 v2, 4, v1
  v_readfirstlane_b32 s7, v11
  v_and_b32 v3, 15, v1
  v_lshrrev_b32 v4, 4, v1
  s_and_b32 s12, s2, 7
  s_lshr_b32 s13, s2, 3
  s_getpc_b64 s[98:99]
L_pc:
  s_and_b32 s4, s13, 15
  s_lshr_b32 s14, s13, 4
  s_lshl_b32 s3, s12, 1
  s_add_u32 s3, s3, s14
  s_mov_b32 s0, s12
  s_mov_b32 s1, s13
  s_and_b32 vcc_lo, s1, 7
  s_lshl_b32 vcc_lo, vcc_lo, 2
  s_add_u32 vcc_lo, vcc_lo, s7
  s_lshl_b32 vcc_lo, vcc_lo, 11
  v_lshl_add_u32 v15, v3, 7, vcc_lo
  v_min_u32 v15, L_codeend-L_pc-4, v15
  s_mov_b64 exec, 0xffff
  global_load_dword a250, v15, s[98:99]
  s_mov_b64 exec, -1
  v_lshrrev_b32 v11, 3, v1
  v_and_b32_e64 v13, 7, v1
  v_mul_u32_u24 v150, 1280, v11
  v_lshl_add_u32 v150, v13, 4, v150
  s_mul_i32 s12, s1, 81920
  s_lshl_b32 s13, s0, 7
  s_add_u32 s12, s12, s13
  v_add_u32 v169, s12, v150
  s_lshl_b32 s95, s0, 5
  s_add_u32 s95, s95, s1
  s_mul_i32 s12, s95, 10240
  s_add_u32 s12, s12, 1024
  v_add_u32 v170, s12, v150
  s_waitcnt lgkmcnt(0)
  s_load_dword s8, s[50:51], 0
  s_cmp_eq_u32 s7, 1
  s_cbranch_scc1 w1_3
  s_cmp_eq_u32 s7, 2
  s_cbranch_scc1 w2_4
  s_cmp_eq_u32 s7, 3
  s_cbranch_scc1 w3_5
w0_2:
  s_mov_b32 s60, s36
  s_and_b32 s61, s37, 0xffff
  s_mov_b32 s62, 2621440
  s_mov_b32 s63, 0x20000
  s_mov_b32 m0, 119840
  s_nop 0
  buffer_load_dwordx4 v169, s[60:63], 0 offen lds
  s_mov_b32 m0, 120896
  s_mov_b32 s12, 10240
  buffer_load_dwordx4 v169, s[60:63], s12 offen lds
  s_mov_b32 m0, 121952
  s_mov_b32 s12, 20480
  buffer_load_dwordx4 v169, s[60:63], s12 offen lds
  s_mov_b32 m0, 123008
  s_mov_b32 s12, 30720
  buffer_load_dwordx4 v169, s[60:63], s12 offen lds
  s_mov_b32 m0, 124064
  s_mov_b32 s12, 40960
  buffer_load_dwordx4 v169, s[60:63], s12 offen lds
  s_mov_b32 m0, 125120
  s_mov_b32 s12, 51200
  buffer_load_dwordx4 v169, s[60:63], s12 offen lds
  s_mov_b32 m0, 126176
  s_mov_b32 s12, 61440
  buffer_load_dwordx4 v169, s[60:63], s12 offen lds
  v_subrev_u32 v11, 10240, v169
  s_mov_b32 exec_lo, 0
  s_mov_b32 exec_hi, 0xffffff00
  s_mov_b32 m0, 118784
  s_nop 0
  buffer_load_dwordx4 v11, s[60:63], 0 offen lds
  s_mov_b64 exec, -1
  s_branch join_1
w1_3:
  v_min_u32 v11, 39, v1
  s_mul_i32 s12, s4, 80
  v_lshl_add_u32 v14, v11, 1, s12
  global_load_ushort v229, v14, s[18:19]
  global_load_ushort v230, v14, s[20:21]
  global_load_ushort v231, v14, s[30:31]
  s_mov_b32 s64, s38
  s_and_b32 s65, s39, 0xffff
  s_mov_b32 s66, 2621440
  s_mov_b32 s67, 0x20000
  s_mov_b32 m0, 132512
  s_nop 0
  buffer_load_dwordx4 v169, s[64:67], 0 offen lds
  s_mov_b32 m0, 133568
  s_mov_b32 s12, 10240
  buffer_load_dwordx4 v169, s[64:67], s12 offen lds
  s_mov_b32 m0, 134624
  s_mov_b32 s12, 20480
  buffer_load_dwordx4 v169, s[64:67], s12 offen lds
  s_mov_b32 m0, 135680
  s_mov_b32 s12, 30720
  buffer_load_dwordx4 v169, s[64:67], s12 offen lds
  s_mov_b32 m0, 136736
  s_mov_b32 s12, 40960
  buffer_load_dwordx4 v169, s[64:67], s12 offen lds
  s_mov_b32 m0, 137792
  s_mov_b32 s12, 51200
  buffer_load_dwordx4 v169, s[64:67], s12 offen lds
  s_mov_b32 m0, 138848
  s_mov_b32 s12, 61440
  buffer_load_dwordx4 v169, s[64:67], s12 offen lds
  s_mov_b32 m0, 139904
  s_mov_b32 s12, 71680
  buffer_load_dwordx4 v169, s[64:67], s12 offen lds
  s_branch join_1
w2_4:
  s_mov_b32 s60, s36
  s_and_b32 s61, s37, 0xffff
  s_mov_b32 s62, 2621440
  s_mov_b32 s63, 0x20000
  s_mov_b32 s64, s38
  s_and_b32 s65, s39, 0xffff
  s_mov_b32 s66, 2621440
  s_mov_b32 s67, 0x20000
  s_mov_b32 m0, 127232
  s_mov_b32 s12, 71680
  buffer_load_dwordx4 v169, s[60:63], s12 offen lds
  s_mov_b32 m0, 129344
  s_nop 0
  buffer_load_dwordx4 v170, s[60:63], 0 offen lds
  s_mov_b32 m0, 142016
  s_nop 0
  buffer_load_dwordx4 v170, s[64:67], 0 offen lds
  s_mov_b32 m0, 131456
  s_mov_b32 s12, 128
  buffer_load_dwordx4 v170, s[60:63], s12 offen lds
  s_mov_b32 m0, 144128
  s_mov_b32 s12, 128
  buffer_load_dwordx4 v170, s[64:67], s12 offen lds
  v_subrev_u32 v11, 10240, v170
  s_mov_b32 exec_lo, 0
  s_mov_b32 exec_hi, 0xffffff00
  s_mov_b32 m0, 128288
  s_nop 0
  buffer_load_dwordx4 v11, s[60:63], 0 offen lds
  s_mov_b64 exec, -1
  v_subrev_u32 v11, 10240, v170
  s_mov_b32 exec_lo, 0
  s_mov_b32 exec_hi, 0xffffff00
  s_mov_b32 m0, 130400
  s_mov_b32 s12, 128
  buffer_load_dwordx4 v11, s[60:63], s12 offen lds
  s_mov_b64 exec, -1
  s_mov_b32 s64, s40
  s_and_b32 s65, s41, 0xffff
  s_mov_b32 s66, 5120
  s_mov_b32 s67, 0x20000
  s_mov_b32 m0, 143072
  s_movk_i32 s12, 4096
  buffer_load_dwordx4 v2, s[64:67], s12 offen lds
  s_mov_b32 m0, 140960
  s_lshl_b32 s12, s0, 9
  s_mov_b32 exec_hi, 0
  buffer_load_dwordx4 v2, s[64:67], s12 offen lds
  s_mov_b32 exec_hi, -1
  s_branch join_1
w3_5:
  s_mov_b32 s68, s16
  s_and_b32 s69, s17, 0xffff
  s_mov_b32 s70, 2621440
  s_mov_b32 s71, 0x20000
  s_lshl_b32 s12, s3, 4
  s_add_u32 s12, s12, s4
  s_mul_i32 s12, s12, 10240
  buffer_load_dwordx4 v[48:51], v150, s[68:71], s12 offen offset:0
  buffer_load_dwordx4 v[52:55], v150, s[68:71], s12 offen offset:128
  buffer_load_dwordx4 v[56:59], v150, s[68:71], s12 offen offset:256
  buffer_load_dwordx4 v[60:63], v150, s[68:71], s12 offen offset:384
  buffer_load_dwordx4 v[64:67], v150, s[68:71], s12 offen offset:512
  buffer_load_dwordx4 v[68:71], v150, s[68:71], s12 offen offset:640
  buffer_load_dwordx4 v[72:75], v150, s[68:71], s12 offen offset:768
  buffer_load_dwordx4 v[76:79], v150, s[68:71], s12 offen offset:896
  buffer_load_dwordx4 v[80:83], v150, s[68:71], s12 offen offset:1024
  buffer_load_dwordx4 v[84:87], v150, s[68:71], s12 offen offset:1152
join_1:
  s_lshl_b32 s86, s95, 1
  s_lshl_b32 s12, s86, 1
  s_load_dword s72, s[44:45], s12
  s_and_b32 s12, s95, 0xfffffffc
  s_add_u32 s12, s12, 1024
  s_load_dword s73, s[44:45], s12
  s_getreg_b32 s11, hwreg(HW_REG_XCC_ID, 0, 4)
  s_mov_b32 s10, 262144
  s_mov_b32 s2, 0x3f803f80
  v_lshrrev_b32 v11, 3, v1
  v_and_b32 v12, 6, v11
  v_and_b32 v13, 7, v1
  s_movk_i32 s15, 0x78
  v_bfe_u32 v14, s15, v12, 2
  v_xor_b32 v14, v14, v13
  v_mul_u32_u24 v146, 1280, v11
  v_lshl_add_u32 v148, v14, 4, v146
  s_and_b32 s12, s7, 1
  s_lshl_b32 s13, s12, 6
  v_xor_b32_e64 v148, s13, v148
  v_add_u32 v149, 8192, v148
  v_xor_b32 v12, v12, v13
  v_and_b32 v11, 4, v11
  v_mul_u32_u24 v11, 1280, v11
  v_lshl_add_u32 v11, v12, 4, v11
  v_add_u32_e64 v146, v11, v146
  v_add_u32 v147, 19456, v146
  s_lshr_b32 s13, s7, 1
  s_mul_i32 s75, s13, 10240
  s_lshl_b32 s12, s12, 10
  s_add_u32 s75, s75, s12
  s_mul_i32 s74, s4, 51200
  s_lshl_b32 s13, s13, 7
  s_add_u32 s74, s74, s13
  s_lshl_b32 s76, s3, 2
  s_add_u32 s76, s76, s7
  s_mul_i32 s76, s76, 40960
  s_lshl_b32 s77, s7, 11
  s_add_u32 s77, s77, 102400
  s_bitcmp1_b32 s7, 0
  s_cselect_b32 s56, s24, s22
  s_cselect_b32 s57, s25, s23
  s_and_b32 s57, s57, 0xffff
  s_mov_b32 s58, 819200
  s_mov_b32 s59, 0x20000
  s_bitcmp1_b32 s3, 3
  s_cselect_b32 s60, s24, s22
  s_cselect_b32 s61, s25, s23
  s_and_b32 s61, s61, 0xffff
  s_mov_b32 s62, 819200
  s_mov_b32 s63, 0x20000
  s_mov_b32 s68, s16
  s_and_b32 s69, s17, 0xffff
  s_mov_b32 s70, 2621440
  s_mov_b32 s71, 0x20000
  s_mov_b32 s52, s50
  s_and_b32 s53, s51, 0xffff
  s_mov_b32 s54, 41943040
  s_mov_b32 s55, 0x20000
  s_lshr_b32 s14, s4, 3
  s_lshl_b32 s5, s3, 1
  s_add_u32 s5, s5, s14
  s_and_b32 s6, s4, 7
  s_lshl_b32 s84, s3, 8
  s_lshl_b32 s13, s4, 4
  s_add_u32 s84, s84, s13
  s_lshl_b32 s13, s7, 2
  s_add_u32 s84, s84, s13
  s_lshl_b32 s85, s0, 9
  s_add_u32 s85, s85, s13
  s_lshl_b32 s13, s1, 4
  s_add_u32 s85, s85, s13
  s_lshl_b32 s83, s4, 5
  s_add_u32 s83, s83, s3
  s_mul_i32 s83, s83, 640
  s_add_u32 s83, s83, 327680
  s_cmp_eq_u32 s7, 0
  s_cselect_b32 s96, -1, 0
  s_cselect_b32 s97, 0xff, 0
  s_lshl_b32 s12, s76, 1
  s_mul_i32 s13, s4, 5
  s_add_u32 s14, s13, 0
  s_lshr_b32 s15, s14, 2
  s_lshl_b32 s15, s15, 11
  s_and_b32 s14, s14, 3
  s_lshl_b32 s14, s14, 8
  s_add_u32 s14, s14, s15
  s_add_u32 s78, s14, s12
  s_add_u32 s14, s13, 1
  s_lshr_b32 s15, s14, 2
  s_lshl_b32 s15, s15, 11
  s_and_b32 s14, s14, 3
  s_lshl_b32 s14, s14, 8
  s_add_u32 s14, s14, s15
  s_add_u32 s79, s14, s12
  s_add_u32 s14, s13, 2
  s_lshr_b32 s15, s14, 2
  s_lshl_b32 s15, s15, 11
  s_and_b32 s14, s14, 3
  s_lshl_b32 s14, s14, 8
  s_add_u32 s14, s14, s15
  s_add_u32 s80, s14, s12
  s_add_u32 s14, s13, 3
  s_lshr_b32 s15, s14, 2
  s_lshl_b32 s15, s15, 11
  s_and_b32 s14, s14, 3
  s_lshl_b32 s14, s14, 8
  s_add_u32 s14, s14, s15
  s_add_u32 s81, s14, s12
  s_add_u32 s14, s13, 4
  s_lshr_b32 s15, s14, 2
  s_lshl_b32 s15, s15, 11
  s_and_b32 s14, s14, 3
  s_lshl_b32 s14, s14, 8
  s_add_u32 s14, s14, s15
  s_add_u32 s82, s14, s12
  s_mul_i32 s12, s7, 1280
  s_add_u32 s12, s12, 13824
  v_mul_u32_u24 v11, 80, v3
  v_lshl_add_u32 v11, v4, 4, v11
  v_add_u32_e64 v42, s12, v11
  v_bfe_u32 v12, v1, 2, 2
  v_mul_u32_u24 v12, 160, v12
  v_and_b32_e64 v13, 3, v1
  v_lshl_add_u32 v12, v13, 4, v12
  v_lshrrev_b32_e64 v13, 1, v4
  v_mul_u32_u24 v14, 80, v13
  v_lshlrev_b32_e64 v13, 10, v13
  v_add3_u32 v12, v12, v14, s12
  v_and_b32_e64 v14, 1, v4
  v_lshl_add_u32 v43, v14, 3, v12
  v_mul_u32_u24 v14, 40960, v14
  v_lshl_add_u32 v13, v3, 4, v13
  v_add_u32_e64 v44, v13, v14
  v_accvgpr_write_b32 a240, v42
  v_accvgpr_write_b32 a241, v43
  v_accvgpr_write_b32 a242, v44
  v_accvgpr_write_b32 a243, v148
  v_accvgpr_write_b32 a244, v149
  v_lshrrev_b32_e64 v11, 2, v3
  v_mul_u32_u24 v11, 5120, v11
  v_and_b32_e64 v12, 3, v3
  v_lshl_add_u32 v11, v12, 4, v11
  v_lshl_add_u32 v0, v4, 6, v11
  s_waitcnt lgkmcnt(0)
  s_lshr_b32 s8, s8, 4
  s_mul_i32 s8, s8, 0x19660d
  s_add_u32 s8, s8, 0x3c6ef35f
  s_lshl_b32 s8, s8, 4
  s_lshl_b32 s93, s3, 11
  s_lshl_b32 s12, s7, 9
  s_add_u32 s93, s93, s12
  s_add_u32 s93, s93, 262144
  v_and_b32 v160, 7, v3
  v_lshlrev_b32 v160, 4, v160
  v_lshl_add_u32 v160, v4, 7, v160
  s_mul_i32 s94, s4, 640
  s_add_u32 s94, s94, 303104
  v_lshlrev_b32 v161, 3, v1
  v_lshlrev_b32 v162, 3, v3
  v_and_b32 v187, 31, v1
  v_lshlrev_b32 v187, 4, v187
  s_lshl_b32 s88, s6, 9
  s_add_u32 s88, s88, 20480
  v_and_b32 v185, 31, v1
  v_lshlrev_b32 v185, 2, v185
  s_lshl_b32 s89, s0, 8
  s_add_u32 s89, s89, 294912
  v_add_u32 v11, 1, v3
  v_and_b32 v12, 1, v11
  v_mul_u32_u24 v12, 4160, v12
  v_lshrrev_b32_e64 v11, 1, v11
  v_lshl_add_u32 v12, v11, 2, v12
  v_lshl_add_u32 v12, v4, 4, v12
  v_sub_u32 v11, 15, v3
  v_lshlrev_b32 v11, 5, v11
  v_lshl_add_u32 v11, v4, 4, v11
  s_lshr_b32 s12, s7, 1
  s_and_b32 s13, s7, 1
  s_lshl_b32 s13, s13, 8
  s_mul_i32 s91, s12, 8320
  s_add_u32 s91, s91, s13
  s_add_u32 s91, s91, 102400
  v_add_u32_e64 v232, s91, v12
  s_mul_i32 s91, s12, 4608
  s_add_u32 s91, s91, s13
  v_add_u32 v240, s91, v11
  s_lshl_b32 s13, s7, 7
  s_add_u32 s91, s13, 119040
  v_add_u32 v236, s91, v12
  s_add_u32 s91, s13, 9216
  v_add_u32_e64 v241, s91, v11
  s_mul_i32 s13, s5, 163840
  s_mul_i32 s14, s7, 10240
  s_add_u32 s13, s13, s14
  s_add_u32 s13, s13, 10485760
  s_add_u32 s14, s7, 1
  s_and_b32 s14, s14, 3
  s_mul_i32 s15, s14, 40960
  s_add_u32 s16, s15, s13
  s_mul_i32 s15, s14, 10240
  s_add_u32 s15, s15, 102400
  v_add_u32 v44, s15, v2
  s_add_u32 s14, s7, 2
  s_and_b32 s14, s14, 3
  s_mul_i32 s15, s14, 40960
  s_add_u32 s17, s15, s13
  s_mul_i32 s15, s14, 10240
  s_add_u32 s15, s15, 107520
  v_add_u32 v45, s15, v2
  s_add_u32 s14, s7, 3
  s_and_b32 s14, s14, 3
  s_mul_i32 s15, s14, 40960
  s_add_u32 s18, s15, s13
  s_mul_i32 s15, s14, 5120
  v_add_u32 v46, s15, v2
  s_add_u32 s14, s7, 4
  s_and_b32 s14, s14, 3
  s_mul_i32 s15, s14, 40960
  s_add_u32 s19, s15, s13
  s_lshl_b32 s49, s3, 8
  s_lshl_b32 s13, s7, 6
  s_add_u32 s49, s49, s13
  s_and_b32 s13, s5, 1
  s_lshl_b32 s13, s13, 3
  s_add_u32 s49, s49, s13
  s_add_u32 s49, s49, 12288
  v_and_b32 v244, 3, v1
  v_lshlrev_b32 v244, 4, v244
  s_lshr_b32 s24, s95, 1
  s_add_u32 s24, s24, 512
  s_lshr_b32 s13, s7, 1
  s_add_u32 s12, s86, s13
  s_bitcmp1_b32 s12, 0
  s_cselect_b32 s92, 16, 0
  s_lshr_b32 s72, s72, s92
  s_and_b32 s30, s72, 0xffff
  s_lshl_b32 s31, s72, 16
  s_bitcmp1_b32 s24, 0
  s_cselect_b32 s92, 16, 0
  s_lshr_b32 s73, s73, s92
  s_and_b32 s25, s73, 0xffff
  s_lshl_b32 s45, s73, 16
  s_lshl_b32 s50, s12, 12
  s_and_b32 s12, s7, 1
  s_lshl_b32 s12, s12, 11
  s_add_u32 s50, s50, s12
  s_add_u32 s50, s50, 19922944
  s_mul_i32 s13, s13, 4608
  s_sub_u32 s13, s13, s12
  s_add_u32 s13, s13, 2552
  v_lshlrev_b32_e64 v246, 5, v3
  v_lshl_add_u32 v246, v4, 3, v246
  v_sub_u32 v247, s13, v246
  s_bitcmp1_b32 s1, 0
  s_movk_i32 s12, 0x7421
  s_cselect_b32 s12, 0x6530, s12
  s_lshl_b32 s13, s7, 2
  s_lshr_b32 s12, s12, s13
  s_and_b32 s12, s12, 7
  s_lshl_b32 s12, s12, 9
  s_lshl_b32 s51, s24, 12
  s_add_u32 s51, s51, s12
  s_add_u32 s51, s51, 19922944
  s_sub_u32 s12, 13304, s12
  v_sub_u32 v248, s12, v246
  s_lshl_b32 s12, s7, 12
  s_add_u32 s13, s12, 102400
  v_add_u32 v252, s13, v2
  s_add_u32 s13, s12, 127360
  v_add_u32_e64 v249, s13, v2
  s_xor_b32 s13, s12, 4096
  s_add_u32 s13, s13, 127360
  v_add_u32 v250, s13, v2
  s_lshl_b32 s13, s7, 10
  s_add_u32 s13, s13, 102400
  v_add_u32_e64 v251, s13, v2
  v_accvgpr_write_b32 a200, v232
  v_accvgpr_write_b32 a201, v236
  v_accvgpr_write_b32 a202, v240
  v_accvgpr_write_b32 a203, v241
  v_accvgpr_write_b32 a204, v246
  v_accvgpr_write_b32 a205, v247
  v_accvgpr_write_b32 a206, v248
  v_accvgpr_write_b32 a207, v249
  v_accvgpr_write_b32 a208, v250
  v_accvgpr_write_b32 a209, v251
  v_accvgpr_write_b32 a210, v252
  v_accvgpr_write_b32 a211, v44
  v_accvgpr_write_b32 a212, v45
  v_accvgpr_write_b32 a213, v46
  v_accvgpr_write_b32 a214, v244
  s_lshl_b32 s12, s5, 6
  s_lshr_b32 s13, s7, 1
  s_lshl_b32 s13, s13, 5
  s_add_u32 s12, s12, s13
  s_and_b32 s13, s7, 1
  s_lshl_b32 s13, s13, 2
  s_add_u32 s12, s12, s13
  s_mul_i32 s20, s12, 1280
  s_mul_i32 s13, s6, 160
  s_add_u32 s20, s20, s13
  s_lshl_b32 s48, s7, 12
  s_add_u32 s48, s48, 127360
  v_add_u32 v11, 0, v1
  v_mul_u32_u24 v12, 205, v11
  v_lshrrev_b32 v12, 11, v12
  v_lshrrev_b32 v13, 2, v12
  v_mul_u32_u24 v12, 1120, v12
  v_mul_u32_u24 v13, 5120, v13
  v_lshlrev_b32_e64 v11, 4, v11
  v_add3_u32 v224, v11, v12, v13
  v_add_u32_e64 v11, 64, v1
  v_mul_u32_u24 v12, 205, v11
  v_lshrrev_b32 v12, 11, v12
  v_lshrrev_b32 v13, 2, v12
  v_mul_u32_u24 v12, 1120, v12
  v_mul_u32_u24 v13, 5120, v13
  v_lshlrev_b32_e64 v11, 4, v11
  v_add3_u32 v225, v11, v12, v13
  v_add_u32 v11, 128, v1
  v_mul_u32_u24 v12, 205, v11
  v_lshrrev_b32 v12, 11, v12
  v_lshrrev_b32 v13, 2, v12
  v_mul_u32_u24 v12, 1120, v12
  v_mul_u32_u24 v13, 5120, v13
  v_lshlrev_b32_e64 v11, 4, v11
  v_add3_u32 v226, v11, v12, v13
  s_and_b32 s12, s5, 1
  s_lshl_b32 s12, s12, 2
  s_add_u32 s12, s12, s7
  s_lshr_b32 s13, s12, 1
  s_lshl_b32 s13, s13, 8
  s_and_b32 s12, s12, 1
  s_lshl_b32 s12, s12, 5
  s_add_u32 s12, s12, s13
  s_add_u32 s12, s12, 158720
  v_lshrrev_b32 v12, 2, v3
  v_lshlrev_b32 v12, 6, v12
  v_and_b32_e64 v13, 3, v3
  v_lshl_add_u32 v12, v13, 3, v12
  v_add_u32 v227, s12, v12
  v_and_b32 v13, 7, v3
  v_lshlrev_b32_e64 v13, 3, v13
  v_lshl_add_u32 v13, v4, 6, v13
  s_lshl_b32 s12, s7, 8
  s_add_u32 s12, s12, 158720
  v_add_u32 v228, s12, v13
  v_lshl_add_u32 v243, v4, 3, s48
  v_mul_u32_u24 v242, 160, v3
  v_lshl_add_u32 v242, v4, 3, v242
  v_add_u32 v242, s48, v242
  v_and_b32 v11, 1, v3
  v_lshrrev_b32 v12, 1, v3
  v_and_b32 v13, 6, v12
  s_movk_i32 s15, 0x78
  v_bfe_u32 v13, s15, v13, 2
  v_xor_b32 v13, v13, v4
  v_lshl_add_u32 v13, v11, 2, v13
  v_lshlrev_b32_e64 v13, 4, v13
  v_lshl_add_u32 v13, v12, 7, v13
  v_lshl_add_u32 v5, v11, 10, v13
  v_xor_b32_e64 v6, 64, v5
  v_add_u32 v7, 51200, v5
  v_add_u32 v8, 51200, v6
  v_mul_u32_u24 v9, 144, v12
  v_lshl_add_u32 v9, v11, 2, v9
  v_lshl_add_u32 v9, v4, 3, v9
  s_lshl_b32 s12, s7, 5
  v_add_u32 v9, s12, v9
  v_and_b32 v11, 6, v3
  v_xor_b32 v11, v11, v4
  v_lshlrev_b32_e64 v11, 4, v11
  v_lshl_add_u32 v11, v3, 7, v11
  v_add_u32 v144, s77, v11
  v_xor_b32 v145, 64, v144
  v_lshrrev_b32 v11, 3, v1
  v_and_b32 v12, 7, v1
  v_mul_u32_u24 v13, 1056, v12
  v_lshl_add_u32 v13, v11, 3, v13
  s_lshl_b32 s12, s7, 6
  s_add_u32 s12, s12, 118784
  v_add_u32 v172, s12, v13
  s_lshl_b32 s12, s7, 8
  s_add_u32 s12, s12, 140960
  v_lshl_add_u32 v173, v11, 5, s12
  v_sub_u32 v13, 7, v12
  v_lshlrev_b32_e64 v13, 4, v13
  v_lshl_add_u32 v171, v11, 14, v13
  s_mul_i32 s12, s0, 80
  s_lshl_b32 s13, s7, 5
  s_add_u32 s12, s12, s13
  s_lshl_b32 s12, s12, 12
  s_lshl_b32 s13, s1, 7
  s_sub_u32 s12, s12, s13
  s_add_u32 s87, s12, 4198272
  s_add_u32 s41, s85, 28672
  s_movk_i32 s36, 4096
  s_cmp_lg_u32 s7, 2
  s_cbranch_scc1 skip_6
  v_bfe_u32 v13, v1, 4, 1
  v_mul_u32_u24 v13, 2112, v13
  v_and_b32_e64 v14, 15, v1
  v_lshl_add_u32 v13, v14, 3, v13
  v_add_u32 v172, 128288, v13
  v_and_b32 v13, 31, v1
  v_lshlrev_b32 v13, 5, v13
  v_add_u32 v173, 143072, v13
  v_cmp_gt_u32_e64 vcc, 32, v1
  v_mov_b32 v14, 1879048192
  s_lshl_b32 s87, s95, 11
  s_add_u32 s87, s87, 26214400
  v_cndmask_b32 v171, v14, v2, vcc
  s_lshl_b32 s41, s95, 2
  s_add_u32 s41, s41, 32768
  s_movk_i32 s36, 512
skip_6:
  s_lshl_b32 s12, s86, 12
  s_lshl_b32 s13, s7, 10
  s_add_u32 s90, s12, s13
  s_add_u32 s91, s90, 4096
  s_lshl_b32 s92, s24, 12
  s_add_u32 s92, s92, s13
  s_add_u32 s13, s13, 102432
  v_add_u32 v186, s13, v2
  v_lshrrev_b32_e64 v11, 1, v1
  v_mul_u32_u24 v11, 4160, v11
  v_and_b32_e64 v12, 1, v1
  v_lshl_add_u32 v11, v12, 4, v11
  v_add_u32 v163, 102400, v11
  s_add_u32 m0, s75, 0
  s_add_u32 s14, s74, 0
  buffer_load_dwordx4 v148, s[56:59], s14 offen lds
  buffer_load_dwordx4 v149, s[56:59], s14 offen offset:2048 lds
  s_add_u32 m0, s75, 4096
  s_add_u32 s14, s74, 20480
  buffer_load_dwordx4 v148, s[56:59], s14 offen lds
  buffer_load_dwordx4 v149, s[56:59], s14 offen offset:2048 lds
  s_add_u32 m0, s75, 8192
  s_add_u32 s14, s74, 40960
  buffer_load_dwordx4 v148, s[56:59], s14 offen lds
  s_add_u32 m0, s77, 0
  s_add_u32 s15, s76, 0
  buffer_load_dwordx4 v146, s[68:71], s15 offen lds
  buffer_load_dwordx4 v147, s[68:71], s15 offen offset:1024 lds
  s_add_u32 m0, s77, 8192
  s_add_u32 s15, s76, 5120
  buffer_load_dwordx4 v146, s[68:71], s15 offen lds
  buffer_load_dwordx4 v147, s[68:71], s15 offen offset:1024 lds
  s_cmp_eq_u32 s7, 1
  s_cbranch_scc1 w1_8
  s_cmp_eq_u32 s7, 2
  s_cbranch_scc1 w2_9
  s_cmp_eq_u32 s7, 3
  s_cbranch_scc1 w3_10
  s_branch join_7
w1_8:
  s_waitcnt vmcnt(17)
  v_lshlrev_b32 v229, 16, v229
  v_lshlrev_b32 v230, 16, v230
  v_lshlrev_b32_e64 v231, 16, v231
  v_mul_f32 v231, 0x3fb8aa3b, v231
  v_exp_f32 v231, v231
  v_min_u32 v200, 39, v1
  v_mul_u32_u24 v198, 80, v200
  v_mul_u32_u24 v199, 176, v200
  v_cvt_pk_bf16_f32 v231, v231, v231
  v_and_b32 v231, 0xffff0000, v231
  v_mul_f32 v192, v231, v229
  v_mul_f32 v193, v231, v230
  v_mul_f32 v192, 0x3fb8aa3b, v192
  v_mul_f32 v193, 0x3e22f983, v193
  v_mul_f32 v194, 1.0, v192
  v_mul_f32 v195, 1.0, v193
  v_exp_f32 v194, v194
  v_fract_f32 v195, v195
  v_sin_f32 v196, v195
  v_cos_f32 v197, v195
  v_mul_f32 v203, v194, v196
  v_mul_f32_e64 v202, v194, v197
  v_mul_f32 v194, 0x41000000, v192
  v_mul_f32 v195, 0x41000000, v193
  v_exp_f32 v194, v194
  v_fract_f32 v195, v195
  v_sin_f32 v196, v195
  v_cos_f32 v197, v195
  v_mul_f32 v51, v194, v196
  v_mul_f32 v50, v194, v197
  v_mul_f32 v194, v229, v229
  v_fmac_f32 v194, v230, v230
  v_rcp_f32 v194, v194
  v_add_f32 v195, -1.0, v202
  v_add_f32 v194, v194, v194
  v_mul_f32 v196, v195, v229
  v_fmac_f32 v196, v203, v230
  v_mul_f32 v197, v203, v229
  v_fma_f32 v197, -v195, v230, v197
  v_mul_f32 v196, v194, v196
  v_mul_f32 v197, v194, v197
  v_and_b32 v194, 1, v200
  v_lshrrev_b32 v200, 1, v200
  v_lshlrev_b32_e64 v200, 4, v200
  v_lshl_add_u32 v200, v194, 2, v200
  v_add_u32 v200, 159744, v200
  v_add_u32 v198, 160640, v198
  v_add_u32 v199, 145184, v199
  ds_write2_b32 v200, v196, v197 offset0:0 offset1:2
  v_mov_b32 v48, 1.0
  v_mov_b32 v49, 0
  v_mov_b32 v84, 1.0
  v_mov_b32 v85, 0
  v_pk_mul_f32 v[52:53], v[50:51], v[50:51] op_sel:[1,1] op_sel_hi:[0,1] neg_lo:[0,1]
  v_pk_mul_f32 v[204:205], v[202:203], v[202:203] op_sel:[1,1] op_sel_hi:[0,1] neg_lo:[0,1]
  v_pk_fma_f32 v[52:53], v[50:51], v[50:51], v[52:53] op_sel:[0,0,0] op_sel_hi:[1,0,1]
  v_pk_fma_f32 v[204:205], v[202:203], v[202:203], v[204:205] op_sel:[0,0,0] op_sel_hi:[1,0,1]
  v_pk_mul_f32 v[54:55], v[52:53], v[50:51] op_sel:[1,1] op_sel_hi:[0,1] neg_lo:[0,1]
  v_pk_mul_f32 v[206:207], v[204:205], v[202:203] op_sel:[1,1] op_sel_hi:[0,1] neg_lo:[0,1]
  v_pk_fma_f32 v[54:55], v[52:53], v[50:51], v[54:55] op_sel:[0,0,0] op_sel_hi:[1,0,1]
  v_pk_fma_f32 v[206:207], v[204:205], v[202:203], v[206:207] op_sel:[0,0,0] op_sel_hi:[1,0,1]
  ds_write_b128 v199, v[48:51] offset:0
  v_pk_mul_f32 v[56:57], v[54:55], v[50:51] op_sel:[1,1] op_sel_hi:[0,1] neg_lo:[0,1]
  v_pk_mul_f32 v[208:209], v[206:207], v[202:203] op_sel:[1,1] op_sel_hi:[0,1] neg_lo:[0,1]
  v_pk_fma_f32 v[56:57], v[54:55], v[50:51], v[56:57] op_sel:[0,0,0] op_sel_hi:[1,0,1]
  v_pk_fma_f32 v[208:209], v[206:207], v[202:203], v[208:209] op_sel:[0,0,0] op_sel_hi:[1,0,1]
  v_pk_mul_f32 v[58:59], v[56:57], v[50:51] op_sel:[1,1] op_sel_hi:[0,1] neg_lo:[0,1]
  v_pk_mul_f32 v[210:211], v[208:209], v[202:203] op_sel:[1,1] op_sel_hi:[0,1] neg_lo:[0,1]
  v_pk_fma_f32 v[58:59], v[56:57], v[50:51], v[58:59] op_sel:[0,0,0] op_sel_hi:[1,0,1]
  v_pk_fma_f32 v[210:211], v[208:209], v[202:203], v[210:211] op_sel:[0,0,0] op_sel_hi:[1,0,1]
  ds_write_b128 v199, v[52:55] offset:16
  v_pk_mul_f32 v[60:61], v[58:59], v[50:51] op_sel:[1,1] op_sel_hi:[0,1] neg_lo:[0,1]
  v_pk_mul_f32 v[212:213], v[210:211], v[202:203] op_sel:[1,1] op_sel_hi:[0,1] neg_lo:[0,1]
  v_pk_fma_f32 v[60:61], v[58:59], v[50:51], v[60:61] op_sel:[0,0,0] op_sel_hi:[1,0,1]
  v_pk_fma_f32 v[212:213], v[210:211], v[202:203], v[212:213] op_sel:[0,0,0] op_sel_hi:[1,0,1]
  v_pk_mul_f32 v[62:63], v[60:61], v[50:51] op_sel:[1,1] op_sel_hi:[0,1] neg_lo:[0,1]
  v_pk_mul_f32 v[214:215], v[212:213], v[202:203] op_sel:[1,1] op_sel_hi:[0,1] neg_lo:[0,1]
  v_pk_fma_f32 v[62:63], v[60:61], v[50:51], v[62:63] op_sel:[0,0,0] op_sel_hi:[1,0,1]
  v_pk_fma_f32 v[214:215], v[212:213], v[202:203], v[214:215] op_sel:[0,0,0] op_sel_hi:[1,0,1]
  ds_write_b128 v199, v[56:59] offset:32
  v_pk_mul_f32 v[64:65], v[62:63], v[50:51] op_sel:[1,1] op_sel_hi:[0,1] neg_lo:[0,1]
  v_pk_fma_f32 v[64:65], v[62:63], v[50:51], v[64:65] op_sel:[0,0,0] op_sel_hi:[1,0,1]
  ds_write2_b32 v198, v202, v203 offset0:0 offset1:8
  v_pk_mul_f32 v[66:67], v[64:65], v[50:51] op_sel:[1,1] op_sel_hi:[0,1] neg_lo:[0,1]
  v_pk_fma_f32 v[66:67], v[64:65], v[50:51], v[66:67] op_sel:[0,0,0] op_sel_hi:[1,0,1]
  ds_write2_b32 v198, v204, v205 offset0:1 offset1:9
  ds_write_b128 v199, v[60:63] offset:48
  v_pk_mul_f32 v[68:69], v[66:67], v[50:51] op_sel:[1,1] op_sel_hi:[0,1] neg_lo:[0,1]
  v_pk_fma_f32 v[68:69], v[66:67], v[50:51], v[68:69] op_sel:[0,0,0] op_sel_hi:[1,0,1]
  ds_write2_b32 v198, v206, v207 offset0:2 offset1:10
  v_pk_mul_f32 v[70:71], v[68:69], v[50:51] op_sel:[1,1] op_sel_hi:[0,1] neg_lo:[0,1]
  v_pk_fma_f32 v[70:71], v[68:69], v[50:51], v[70:71] op_sel:[0,0,0] op_sel_hi:[1,0,1]
  ds_write2_b32 v198, v208, v209 offset0:3 offset1:11
  ds_write_b128 v199, v[64:67] offset:64
  v_pk_mul_f32 v[72:73], v[70:71], v[50:51] op_sel:[1,1] op_sel_hi:[0,1] neg_lo:[0,1]
  v_pk_fma_f32 v[72:73], v[70:71], v[50:51], v[72:73] op_sel:[0,0,0] op_sel_hi:[1,0,1]
  ds_write2_b32 v198, v210, v211 offset0:4 offset1:12
  v_pk_mul_f32 v[74:75], v[72:73], v[50:51] op_sel:[1,1] op_sel_hi:[0,1] neg_lo:[0,1]
  v_pk_fma_f32 v[74:75], v[72:73], v[50:51], v[74:75] op_sel:[0,0,0] op_sel_hi:[1,0,1]
  ds_write2_b32 v198, v212, v213 offset0:5 offset1:13
  ds_write_b128 v199, v[68:71] offset:80
  v_pk_mul_f32 v[76:77], v[74:75], v[50:51] op_sel:[1,1] op_sel_hi:[0,1] neg_lo:[0,1]
  v_pk_fma_f32 v[76:77], v[74:75], v[50:51], v[76:77] op_sel:[0,0,0] op_sel_hi:[1,0,1]
  ds_write2_b32 v198, v214, v215 offset0:6 offset1:14
  v_pk_mul_f32 v[78:79], v[76:77], v[50:51] op_sel:[1,1] op_sel_hi:[0,1] neg_lo:[0,1]
  v_pk_fma_f32 v[78:79], v[76:77], v[50:51], v[78:79] op_sel:[0,0,0] op_sel_hi:[1,0,1]
  ds_write_b128 v199, v[72:75] offset:96
  v_pk_mul_f32 v[80:81], v[78:79], v[50:51] op_sel:[1,1] op_sel_hi:[0,1] neg_lo:[0,1]
  v_pk_fma_f32 v[80:81], v[78:79], v[50:51], v[80:81] op_sel:[0,0,0] op_sel_hi:[1,0,1]
  ds_write2_b32 v198, v50, v51 offset0:7 offset1:15
  ds_write_b128 v199, v[76:79] offset:112
  v_pk_mul_f32 v[194:195], v[80:81], v[80:81] op_sel:[1,1] op_sel_hi:[0,1] neg_lo:[0,1]
  v_pk_fma_f32 v[194:195], v[80:81], v[80:81], v[194:195] op_sel:[0,0,0] op_sel_hi:[1,0,1]
  v_pk_mul_f32 v[86:87], v[194:195], v[194:195] op_sel:[1,1] op_sel_hi:[0,1] neg_lo:[0,1]
  v_pk_fma_f32 v[86:87], v[194:195], v[194:195], v[86:87] op_sel:[0,0,0] op_sel_hi:[1,0,1]
  v_pk_mul_f32 v[88:89], v[86:87], v[86:87] op_sel:[1,1] op_sel_hi:[0,1] neg_lo:[0,1]
  v_pk_fma_f32 v[88:89], v[86:87], v[86:87], v[88:89] op_sel:[0,0,0] op_sel_hi:[1,0,1]
  v_pk_mul_f32 v[90:91], v[88:89], v[86:87] op_sel:[1,1] op_sel_hi:[0,1] neg_lo:[0,1]
  v_pk_fma_f32 v[90:91], v[88:89], v[86:87], v[90:91] op_sel:[0,0,0] op_sel_hi:[1,0,1]
  ds_write_b64 v199, v[80:81] offset:128
  ds_write_b128 v199, v[84:87] offset:144
  ds_write_b128 v199, v[88:91] offset:160
  s_branch join_7
w2_9:
  v_lshrrev_b32 v12, 1, v1
  v_and_b32 v11, 1, v1
  v_lshlrev_b32 v11, 7, v11
  v_lshl_add_u32 v11, v12, 12, v11
  s_lshl_b32 s12, s3, 8
  s_add_u32 s12, s12, 8192
  v_add_u32 v11, s12, v11
  s_lshl_b32 s12, s0, 9
  s_add_u32 s12, s12, 27904
  v_lshl_add_u32 v12, v1, 7, s12
  v_cmp_lt_u32 vcc, 5, v1
  s_lshl_b32 s12, s0, 8
  s_add_u32 s12, s12, 294912
  v_cndmask_b32 v11, v11, v12, vcc
  v_mov_b32 v12, s12
  v_cmp_lt_u32 vcc, 9, v1
  v_mov_b32 v88, 0
  s_nop 0
  v_cndmask_b32 v11, v11, v12, vcc
  buffer_load_dword a250, v11, s[52:55], 0 offen
  s_lshl_b32 s12, s0, 8
  s_lshl_b32 s13, s1, 2
  s_add_u32 s12, s12, s13
  s_add_u32 s12, s12, 294912
  s_or_b32 s13, s8, s11
  v_mov_b32 v15, s13
  s_mov_b64 exec, 1
  buffer_store_dword v15, off, s[52:55], s12
  s_mov_b64 exec, -1
  s_lshl_b32 s12, s0, 8
  s_lshl_b32 s13, s1, 2
  s_add_u32 s12, s12, s13
  s_add_u32 s12, s12, 294912
  s_or_b32 s13, s8, s11
  v_mov_b32 v15, s13
  s_mov_b64 exec, 1
  buffer_store_dword v15, off, s[52:55], s12 offset:128 sc1
  s_mov_b64 exec, -1
  v_mov_b32 v89, 0
  v_mov_b32 v90, s8
  v_mov_b32 v91, s8
  s_add_u32 s12, s83, 327680
  s_mov_b32 exec_hi, 0xff
  buffer_store_dwordx4 v[88:91], v2, s[52:55], s83 offen sc1
  buffer_store_dwordx4 v[88:91], v2, s[52:55], s12 offen sc1
  s_mov_b32 exec_hi, -1
  s_branch join_7
w3_10:
  s_waitcnt vmcnt(9)
  v_dot2_f32_bf16 v88, v48, s2, 0
  v_dot2_f32_bf16 v90, v48, v48, 0
  v_dot2_f32_bf16 v88, v49, s2, v88
  v_dot2_f32_bf16 v90, v49, v49, v90
  v_dot2_f32_bf16 v88, v50, s2, v88
  v_dot2_f32_bf16 v90, v50, v50, v90
  v_dot2_f32_bf16 v88, v51, s2, v88
  v_dot2_f32_bf16 v90, v51, v51, v90
  v_dot2_f32_bf16 v88, v52, s2, v88
  v_dot2_f32_bf16 v90, v52, v52, v90
  v_dot2_f32_bf16 v88, v53, s2, v88
  v_dot2_f32_bf16 v90, v53, v53, v90
  v_dot2_f32_bf16 v88, v54, s2, v88
  v_dot2_f32_bf16 v90, v54, v54, v90
  v_dot2_f32_bf16 v88, v55, s2, v88
  v_dot2_f32_bf16 v90, v55, v55, v90
  v_dot2_f32_bf16 v88, v56, s2, v88
  v_dot2_f32_bf16 v90, v56, v56, v90
  v_dot2_f32_bf16 v88, v57, s2, v88
  v_dot2_f32_bf16 v90, v57, v57, v90
  v_dot2_f32_bf16 v88, v58, s2, v88
  v_dot2_f32_bf16 v90, v58, v58, v90
  v_dot2_f32_bf16 v88, v59, s2, v88
  v_dot2_f32_bf16 v90, v59, v59, v90
  v_dot2_f32_bf16 v88, v60, s2, v88
  v_dot2_f32_bf16 v90, v60, v60, v90
  v_dot2_f32_bf16 v88, v61, s2, v88
  v_dot2_f32_bf16 v90, v61, v61, v90
  v_dot2_f32_bf16 v88, v62, s2, v88
  v_dot2_f32_bf16 v90, v62, v62, v90
  v_dot2_f32_bf16 v88, v63, s2, v88
  v_dot2_f32_bf16 v90, v63, v63, v90
  v_dot2_f32_bf16 v88, v64, s2, v88
  v_dot2_f32_bf16 v90, v64, v64, v90
  v_dot2_f32_bf16 v88, v65, s2, v88
  v_dot2_f32_bf16 v90, v65, v65, v90
  v_dot2_f32_bf16 v88, v66, s2, v88
  v_dot2_f32_bf16 v90, v66, v66, v90
  v_dot2_f32_bf16 v88, v67, s2, v88
  v_dot2_f32_bf16 v90, v67, v67, v90
  v_dot2_f32_bf16 v88, v68, s2, v88
  v_dot2_f32_bf16 v90, v68, v68, v90
  v_dot2_f32_bf16 v88, v69, s2, v88
  v_dot2_f32_bf16 v90, v69, v69, v90
  v_dot2_f32_bf16 v88, v70, s2, v88
  v_dot2_f32_bf16 v90, v70, v70, v90
  v_dot2_f32_bf16 v88, v71, s2, v88
  v_dot2_f32_bf16 v90, v71, v71, v90
  v_dot2_f32_bf16 v88, v72, s2, v88
  v_dot2_f32_bf16 v90, v72, v72, v90
  v_dot2_f32_bf16 v88, v73, s2, v88
  v_dot2_f32_bf16 v90, v73, v73, v90
  v_dot2_f32_bf16 v88, v74, s2, v88
  v_dot2_f32_bf16 v90, v74, v74, v90
  v_dot2_f32_bf16 v88, v75, s2, v88
  v_dot2_f32_bf16 v90, v75, v75, v90
  v_dot2_f32_bf16 v88, v76, s2, v88
  v_dot2_f32_bf16 v90, v76, v76, v90
  v_dot2_f32_bf16 v88, v77, s2, v88
  v_dot2_f32_bf16 v90, v77, v77, v90
  v_dot2_f32_bf16 v88, v78, s2, v88
  v_dot2_f32_bf16 v90, v78, v78, v90
  v_dot2_f32_bf16 v88, v79, s2, v88
  v_dot2_f32_bf16 v90, v79, v79, v90
  v_dot2_f32_bf16 v88, v80, s2, v88
  v_dot2_f32_bf16 v90, v80, v80, v90
  v_dot2_f32_bf16 v88, v81, s2, v88
  v_dot2_f32_bf16 v90, v81, v81, v90
  v_dot2_f32_bf16 v88, v82, s2, v88
  v_dot2_f32_bf16 v90, v82, v82, v90
  v_dot2_f32_bf16 v88, v83, s2, v88
  v_dot2_f32_bf16 v90, v83, v83, v90
  v_dot2_f32_bf16 v88, v84, s2, v88
  v_dot2_f32_bf16 v90, v84, v84, v90
  v_dot2_f32_bf16 v88, v85, s2, v88
  v_dot2_f32_bf16 v90, v85, v85, v90
  v_dot2_f32_bf16 v88, v86, s2, v88
  v_dot2_f32_bf16 v90, v86, v86, v90
  v_dot2_f32_bf16 v88, v87, s2, v88
  v_dot2_f32_bf16 v90, v87, v87, v90
  s_nop 1
  v_add_f32_dpp v88, v88, v88 quad_perm:[1,0,3,2] row_mask:0xf bank_mask:0xf
  v_add_f32_dpp v90, v90, v90 quad_perm:[1,0,3,2] row_mask:0xf bank_mask:0xf
  s_nop 0
  v_add_f32_dpp v88, v88, v88 quad_perm:[2,3,0,1] row_mask:0xf bank_mask:0xf
  v_add_f32_dpp v90, v90, v90 quad_perm:[2,3,0,1] row_mask:0xf bank_mask:0xf
  s_nop 0
  v_add_f32_dpp v88, v88, v88 row_half_mirror row_mask:0xf bank_mask:0xf
  v_add_f32_dpp v90, v90, v90 row_half_mirror row_mask:0xf bank_mask:0xf
  v_mul_f32 v88, 0x3acccccd, v88
  v_mul_f32 v90, 0x3acccccd, v90
  v_fma_f32 v90, -v88, v88, v90
  v_max_f32_e64 v90, 0, v90
  v_cvt_pk_bf16_f32 v88, v88, v88
  v_and_b32 v88, 0xffff0000, v88
  v_cvt_pk_bf16_f32 v90, v90, v90
  v_and_b32 v90, 0xffff0000, v90
  v_add_f32 v90, 0x3727c5ac, v90
  v_cvt_pk_bf16_f32 v90, v90, v90
  v_and_b32 v90, 0xffff0000, v90
  v_sqrt_f32 v90, v90
  s_nop 0
  v_cvt_pk_bf16_f32 v90, v90, v90
  v_and_b32 v90, 0xffff0000, v90
  v_rcp_f32 v89, v90
  v_mov_b32 v90, s8
  v_mov_b32 v91, s8
  v_lshlrev_b32 v11, 1, v1
  s_lshl_b32 s12, s3, 4
  s_add_u32 s12, s12, s4
  s_lshl_b32 s12, s12, 7
  s_add_u32 s12, s12, 262144
  s_mov_b32 exec_lo, 0x01010101
  s_mov_b32 exec_hi, 0x01010101
  buffer_store_dwordx4 v[88:91], v11, s[52:55], s12 offen sc1
  s_mov_b64 exec, -1
join_7:
  v_mul_u32_u24 v11, 171, v1
  v_lshrrev_b32 v11, 11, v11
  v_mul_u32_u24 v12, 12, v11
  v_sub_u32 v12, v1, v12
  s_mul_i32 s12, s4, 5
  v_min_u32 v13, 4, v11
  v_add_u32 v13, s12, v13
  s_mul_i32 s13, s7, 12
  v_add_u32 v12, s13, v12
  v_cmp_gt_u32_e64 vcc, 40, v12
  v_cmp_gt_u32 s[14:15], 5, v11
  s_lshr_b32 s13, s1, 4
  s_mul_i32 s13, s13, 40
  v_min_u32 v12, 39, v12
  s_and_b64 vcc, vcc, s[14:15]
  v_add_u32_e64 v12, s13, v12
  s_mul_i32 s14, s0, 102400
  v_mul_u32_u24 v14, 1280, v12
  v_lshl_add_u32 v14, v13, 4, v14
  v_add_u32_e64 v14, s14, v14
  global_load_dwordx4 v[176:179], v14, s[26:27]
  global_load_dwordx4 v[180:183], v14, s[28:29]
  v_lshrrev_b32_e64 v14, 2, v13
  v_mul_u32_u24 v14, 10240, v14
  v_and_b32_e64 v13, 3, v13
  v_lshl_add_u32 v14, v13, 8, v14
  v_lshrrev_b32_e64 v13, 4, v12
  v_lshl_add_u32 v14, v13, 10, v14
  v_and_b32_e64 v12, 15, v12
  v_lshl_add_u32 v14, v12, 4, v14
  v_mov_b32 v13, 1879048192
  v_cndmask_b32 v174, v13, v14, vcc
  v_min_u32 v11, 4, v11
  v_lshlrev_b32_e64 v11, 6, v11
  v_add_u32 v175, 159744, v11
  s_waitcnt vmcnt(11)
  s_waitcnt lgkmcnt(0)
  s_barrier
  buffer_load_dword v184, v185, s[52:55], s89 offen sc1
  v_lshrrev_b32 v11, 1, v3
  v_mul_u32_u24 v12, 176, v11
  v_mul_u32_u24 v11, 80, v11
  v_and_b32_e64 v13, 1, v3
  v_lshl_add_u32 v12, v13, 2, v12
  v_lshl_add_u32 v12, v4, 3, v12
  s_lshl_b32 s12, s7, 5
  s_add_u32 s12, s12, 145184
  v_add_u32 v12, s12, v12
  v_add_u32 v11, 160640, v11
  v_cvt_f32_u32 v151, v13
  v_min_u32 v13, 39, v1
  v_mul_u32_u24 v13, 176, v13
  v_fma_f32 v151, 2.0, v151, -1.0
  v_add_u32 v13, 145184, v13
  s_lshl_b32 s12, s7, 3
  ds_read_b32 v16, v11 offset:0
  ds_read_b32 v21, v11 offset:32
  ds_read_b32 v26, v12 offset:0
  ds_read_b32 v17, v11 offset:640
  ds_read_b32 v22, v11 offset:672
  ds_read_b32 v28, v12 offset:1408
  ds_read_b32 v18, v11 offset:1280
  ds_read_b32 v23, v11 offset:1312
  ds_read_b32 v30, v12 offset:2816
  ds_read_b32 v19, v11 offset:1920
  ds_read_b32 v24, v11 offset:1952
  ds_read_b32 v32, v12 offset:4224
  ds_read_b32 v20, v11 offset:2560
  ds_read_b32 v25, v11 offset:2592
  ds_read_b32 v34, v12 offset:5632
  ds_read_b64 v[36:37], v13 offset:8
  ds_read_b64 v[38:39], v13 offset:128
  v_add_u32 v13, s12, v13
  ds_read_b64 v[40:41], v13 offset:144
  s_cmp_eq_u32 s7, 3
  s_cbranch_scc1 w3_11
  ds_read_b128 v[88:91], v173
  ds_read_b128 v[92:95], v173 offset:16
  ds_read_b64 v[48:49], v172 offset:640
  ds_read_b64 v[50:51], v172 offset:768
  ds_read_b64 v[52:53], v172 offset:896
  ds_read_b64 v[54:55], v172 offset:1056
  ds_read_b64 v[56:57], v172 offset:1184
  ds_read_b64 v[58:59], v172 offset:1312
  ds_read_b64 v[60:61], v172 offset:1440
  ds_read_b64 v[62:63], v172 offset:1568
  ds_read_b64 v[64:65], v172 offset:1696
  ds_read_b64 v[66:67], v172 offset:1824
  ds_read_b64 v[68:69], v172 offset:1952
  ds_read_b64 v[70:71], v172 offset:13728
  ds_read_b64 v[72:73], v172 offset:13856
  ds_read_b64 v[74:75], v172 offset:13984
  ds_read_b64 v[76:77], v172 offset:14112
  ds_read_b64 v[78:79], v172 offset:14240
  ds_read_b64 v[80:81], v172 offset:14368
  ds_read_b64 v[82:83], v172 offset:14496
  ds_read_b64 v[84:85], v172 offset:14624
  s_waitcnt lgkmcnt(15)
  v_lshlrev_b32 v96, 16, v88
  v_and_b32 v100, 0xffff0000, v88
  v_lshlrev_b32_e64 v104, 16, v89
  v_and_b32 v108, 0xffff0000, v89
  v_lshlrev_b32_e64 v97, 16, v90
  v_and_b32 v101, 0xffff0000, v90
  v_lshlrev_b32_e64 v105, 16, v91
  v_and_b32 v109, 0xffff0000, v91
  v_lshlrev_b32_e64 v98, 16, v92
  v_and_b32 v102, 0xffff0000, v92
  v_lshlrev_b32_e64 v106, 16, v93
  v_and_b32 v110, 0xffff0000, v93
  v_lshlrev_b32_e64 v99, 16, v94
  v_and_b32 v103, 0xffff0000, v94
  v_lshlrev_b32_e64 v107, 16, v95
  v_and_b32 v111, 0xffff0000, v95
  s_waitcnt lgkmcnt(8)
  v_lshlrev_b32 v216, 16, v48
  v_and_b32 v217, 0xffff0000, v48
  v_pk_mul_f32 v[112:113], v[216:217], v[108:109]
  v_lshlrev_b32_e64 v218, 16, v50
  v_and_b32 v219, 0xffff0000, v50
  v_pk_mul_f32 v[114:115], v[218:219], v[108:109]
  v_lshlrev_b32_e64 v216, 16, v52
  v_and_b32 v217, 0xffff0000, v52
  v_pk_fma_f32 v[112:113], v[218:219], v[104:105], v[112:113]
  v_pk_mul_f32 v[116:117], v[216:217], v[108:109]
  v_lshlrev_b32_e64 v218, 16, v54
  v_and_b32 v219, 0xffff0000, v54
  v_pk_fma_f32 v[114:115], v[216:217], v[104:105], v[114:115]
  v_pk_fma_f32 v[112:113], v[216:217], v[100:101], v[112:113]
  v_pk_mul_f32 v[118:119], v[218:219], v[108:109]
  v_lshlrev_b32_e64 v216, 16, v56
  v_and_b32 v217, 0xffff0000, v56
  v_pk_fma_f32 v[116:117], v[218:219], v[104:105], v[116:117]
  v_pk_fma_f32 v[114:115], v[218:219], v[100:101], v[114:115]
  v_pk_fma_f32 v[112:113], v[218:219], v[96:97], v[112:113]
  v_pk_mul_f32 v[120:121], v[216:217], v[108:109]
  v_lshlrev_b32_e64 v218, 16, v58
  v_and_b32 v219, 0xffff0000, v58
  v_pk_fma_f32 v[118:119], v[216:217], v[104:105], v[118:119]
  v_pk_fma_f32 v[116:117], v[216:217], v[100:101], v[116:117]
  v_pk_fma_f32 v[114:115], v[216:217], v[96:97], v[114:115]
  v_pk_mul_f32 v[122:123], v[218:219], v[108:109]
  v_lshlrev_b32_e64 v216, 16, v60
  v_and_b32 v217, 0xffff0000, v60
  v_pk_fma_f32 v[120:121], v[218:219], v[104:105], v[120:121]
  v_pk_fma_f32 v[118:119], v[218:219], v[100:101], v[118:119]
  v_pk_fma_f32 v[116:117], v[218:219], v[96:97], v[116:117]
  v_pk_mul_f32 v[124:125], v[216:217], v[108:109]
  v_lshlrev_b32_e64 v218, 16, v62
  v_and_b32 v219, 0xffff0000, v62
  v_pk_fma_f32 v[122:123], v[216:217], v[104:105], v[122:123]
  v_pk_fma_f32 v[120:121], v[216:217], v[100:101], v[120:121]
  v_pk_fma_f32 v[118:119], v[216:217], v[96:97], v[118:119]
  v_pk_mul_f32 v[126:127], v[218:219], v[108:109]
  v_lshlrev_b32_e64 v216, 16, v64
  v_and_b32 v217, 0xffff0000, v64
  v_pk_fma_f32 v[124:125], v[218:219], v[104:105], v[124:125]
  v_pk_fma_f32 v[122:123], v[218:219], v[100:101], v[122:123]
  v_pk_fma_f32 v[120:121], v[218:219], v[96:97], v[120:121]
  v_pk_fma_f32 v[126:127], v[216:217], v[104:105], v[126:127]
  v_lshlrev_b32_e64 v218, 16, v66
  v_and_b32 v219, 0xffff0000, v66
  v_pk_fma_f32 v[124:125], v[216:217], v[100:101], v[124:125]
  v_pk_fma_f32 v[122:123], v[216:217], v[96:97], v[122:123]
  v_pk_fma_f32 v[126:127], v[218:219], v[100:101], v[126:127]
  v_lshlrev_b32_e64 v216, 16, v68
  v_and_b32 v217, 0xffff0000, v68
  v_pk_fma_f32 v[124:125], v[218:219], v[96:97], v[124:125]
  v_pk_fma_f32 v[126:127], v[216:217], v[96:97], v[126:127]
  s_waitcnt lgkmcnt(0)
  v_lshlrev_b32 v220, 16, v70
  v_and_b32 v221, 0xffff0000, v70
  v_lshlrev_b32_e64 v222, 16, v72
  v_and_b32 v223, 0xffff0000, v72
  v_pk_mul_f32 v[112:113], v[112:113], v[220:221]
  v_lshlrev_b32_e64 v220, 16, v74
  v_and_b32 v221, 0xffff0000, v74
  v_pk_mul_f32 v[114:115], v[114:115], v[222:223]
  v_lshlrev_b32_e64 v222, 16, v76
  v_and_b32 v223, 0xffff0000, v76
  v_pk_mul_f32 v[116:117], v[116:117], v[220:221]
  v_lshlrev_b32_e64 v220, 16, v78
  v_and_b32 v221, 0xffff0000, v78
  v_pk_mul_f32 v[118:119], v[118:119], v[222:223]
  v_lshlrev_b32_e64 v222, 16, v80
  v_and_b32 v223, 0xffff0000, v80
  v_pk_mul_f32 v[120:121], v[120:121], v[220:221]
  v_lshlrev_b32_e64 v220, 16, v82
  v_and_b32 v221, 0xffff0000, v82
  v_pk_mul_f32 v[122:123], v[122:123], v[222:223]
  v_lshlrev_b32_e64 v222, 16, v84
  v_and_b32 v223, 0xffff0000, v84
  v_pk_mul_f32 v[124:125], v[124:125], v[220:221]
  v_pk_mul_f32 v[126:127], v[126:127], v[222:223]
  v_cvt_pk_bf16_f32 v232, v126, v124
  v_cvt_pk_bf16_f32 v233, v122, v120
  v_cvt_pk_bf16_f32 v234, v118, v116
  v_cvt_pk_bf16_f32 v235, v114, v112
  v_cvt_pk_bf16_f32 v236, v127, v125
  v_cvt_pk_bf16_f32 v237, v123, v121
  v_cvt_pk_bf16_f32 v238, v119, v117
  v_cvt_pk_bf16_f32 v239, v115, v113
  v_lshlrev_b32_e64 v216, 16, v49
  v_and_b32 v217, 0xffff0000, v49
  v_pk_mul_f32 v[112:113], v[216:217], v[110:111]
  v_lshlrev_b32_e64 v218, 16, v51
  v_and_b32 v219, 0xffff0000, v51
  v_pk_mul_f32 v[114:115], v[218:219], v[110:111]
  v_lshlrev_b32_e64 v216, 16, v53
  v_and_b32 v217, 0xffff0000, v53
  v_pk_fma_f32 v[112:113], v[218:219], v[106:107], v[112:113]
  v_pk_mul_f32 v[116:117], v[216:217], v[110:111]
  v_lshlrev_b32_e64 v218, 16, v55
  v_and_b32 v219, 0xffff0000, v55
  v_pk_fma_f32 v[114:115], v[216:217], v[106:107], v[114:115]
  v_pk_fma_f32 v[112:113], v[216:217], v[102:103], v[112:113]
  v_pk_mul_f32 v[118:119], v[218:219], v[110:111]
  v_lshlrev_b32_e64 v216, 16, v57
  v_and_b32 v217, 0xffff0000, v57
  v_pk_fma_f32 v[116:117], v[218:219], v[106:107], v[116:117]
  v_pk_fma_f32 v[114:115], v[218:219], v[102:103], v[114:115]
  v_pk_fma_f32 v[112:113], v[218:219], v[98:99], v[112:113]
  v_pk_mul_f32 v[120:121], v[216:217], v[110:111]
  v_lshlrev_b32_e64 v218, 16, v59
  v_and_b32 v219, 0xffff0000, v59
  v_pk_fma_f32 v[118:119], v[216:217], v[106:107], v[118:119]
  v_pk_fma_f32 v[116:117], v[216:217], v[102:103], v[116:117]
  v_pk_fma_f32 v[114:115], v[216:217], v[98:99], v[114:115]
  v_pk_mul_f32 v[122:123], v[218:219], v[110:111]
  v_lshlrev_b32_e64 v216, 16, v61
  v_and_b32 v217, 0xffff0000, v61
  v_pk_fma_f32 v[120:121], v[218:219], v[106:107], v[120:121]
  v_pk_fma_f32 v[118:119], v[218:219], v[102:103], v[118:119]
  v_pk_fma_f32 v[116:117], v[218:219], v[98:99], v[116:117]
  v_pk_mul_f32 v[124:125], v[216:217], v[110:111]
  v_lshlrev_b32_e64 v218, 16, v63
  v_and_b32 v219, 0xffff0000, v63
  v_pk_fma_f32 v[122:123], v[216:217], v[106:107], v[122:123]
  v_pk_fma_f32 v[120:121], v[216:217], v[102:103], v[120:121]
  v_pk_fma_f32 v[118:119], v[216:217], v[98:99], v[118:119]
  v_pk_mul_f32 v[126:127], v[218:219], v[110:111]
  v_lshlrev_b32_e64 v216, 16, v65
  v_and_b32 v217, 0xffff0000, v65
  v_pk_fma_f32 v[124:125], v[218:219], v[106:107], v[124:125]
  v_pk_fma_f32 v[122:123], v[218:219], v[102:103], v[122:123]
  v_pk_fma_f32 v[120:121], v[218:219], v[98:99], v[120:121]
  v_pk_fma_f32 v[126:127], v[216:217], v[106:107], v[126:127]
  v_lshlrev_b32_e64 v218, 16, v67
  v_and_b32 v219, 0xffff0000, v67
  v_pk_fma_f32 v[124:125], v[216:217], v[102:103], v[124:125]
  v_pk_fma_f32 v[122:123], v[216:217], v[98:99], v[122:123]
  v_pk_fma_f32 v[126:127], v[218:219], v[102:103], v[126:127]
  v_lshlrev_b32_e64 v216, 16, v69
  v_and_b32 v217, 0xffff0000, v69
  v_pk_fma_f32 v[124:125], v[218:219], v[98:99], v[124:125]
  v_pk_fma_f32 v[126:127], v[216:217], v[98:99], v[126:127]
  v_lshlrev_b32_e64 v220, 16, v71
  v_and_b32 v221, 0xffff0000, v71
  v_lshlrev_b32_e64 v222, 16, v73
  v_and_b32 v223, 0xffff0000, v73
  v_pk_mul_f32 v[112:113], v[112:113], v[220:221]
  v_lshlrev_b32_e64 v220, 16, v75
  v_and_b32 v221, 0xffff0000, v75
  v_pk_mul_f32 v[114:115], v[114:115], v[222:223]
  v_lshlrev_b32_e64 v222, 16, v77
  v_and_b32 v223, 0xffff0000, v77
  v_pk_mul_f32 v[116:117], v[116:117], v[220:221]
  v_lshlrev_b32_e64 v220, 16, v79
  v_and_b32 v221, 0xffff0000, v79
  v_pk_mul_f32 v[118:119], v[118:119], v[222:223]
  v_lshlrev_b32_e64 v222, 16, v81
  v_and_b32 v223, 0xffff0000, v81
  v_pk_mul_f32 v[120:121], v[120:121], v[220:221]
  v_lshlrev_b32_e64 v220, 16, v83
  v_and_b32 v221, 0xffff0000, v83
  v_pk_mul_f32 v[122:123], v[122:123], v[222:223]
  v_lshlrev_b32_e64 v222, 16, v85
  v_and_b32 v223, 0xffff0000, v85
  v_pk_mul_f32 v[124:125], v[124:125], v[220:221]
  v_pk_mul_f32 v[126:127], v[126:127], v[222:223]
  v_cvt_pk_bf16_f32 v88, v126, v124
  v_cvt_pk_bf16_f32 v89, v122, v120
  v_cvt_pk_bf16_f32 v90, v118, v116
  v_cvt_pk_bf16_f32 v91, v114, v112
  v_cvt_pk_bf16_f32 v92, v127, v125
  v_cvt_pk_bf16_f32 v93, v123, v121
  v_cvt_pk_bf16_f32 v94, v119, v117
  v_cvt_pk_bf16_f32 v95, v115, v113
  s_waitcnt vmcnt(0)
  v_xor_b32 v15, s8, v184
  v_cmp_lt_u32 vcc, 15, v15
  s_cbranch_vccnz again_13
ok_14:
  s_or_b32 s13, s8, s11
  v_cmp_ne_u32 vcc, s13, v184
  s_cmp_eq_u64 vcc, 0
  s_cselect_b32 s9, 1, 0
  s_cmp_eq_u32 s7, 2
  s_cselect_b32 s40, 0, s9
  buffer_store_dwordx4 v[232:235], v171, s[52:55], s87 offen sc1
  s_add_u32 s87, s87, s36
  buffer_store_dwordx4 v[236:239], v171, s[52:55], s87 offen sc1
  s_add_u32 s87, s87, s36
  buffer_store_dwordx4 v[88:91], v171, s[52:55], s87 offen sc1
  s_add_u32 s87, s87, s36
  buffer_store_dwordx4 v[92:95], v171, s[52:55], s87 offen sc1
  s_branch join_12
w3_11:
  s_lshl_b32 s12, s4, 3
  s_and_b32 s13, s3, 7
  s_add_u32 s12, s12, s13
  s_mul_i32 s12, s12, 6400
  s_mov_b32 exec_hi, 0xff
  buffer_load_dwordx4 v[48:51], v150, s[60:63], s12 offen offset:0
  buffer_load_dwordx4 v[52:55], v150, s[60:63], s12 offen offset:128
  buffer_load_dwordx4 v[56:59], v150, s[60:63], s12 offen offset:256
  buffer_load_dwordx4 v[60:63], v150, s[60:63], s12 offen offset:384
  buffer_load_dwordx4 v[64:67], v150, s[60:63], s12 offen offset:512
  buffer_load_dwordx4 v[68:71], v150, s[60:63], s12 offen offset:640
  buffer_load_dwordx4 v[72:75], v150, s[60:63], s12 offen offset:768
  buffer_load_dwordx4 v[76:79], v150, s[60:63], s12 offen offset:896
  buffer_load_dwordx4 v[80:83], v150, s[60:63], s12 offen offset:1024
  buffer_load_dwordx4 v[84:87], v150, s[60:63], s12 offen offset:1152
  s_mov_b32 exec_hi, -1
  s_mov_b32 s64, s22
  s_and_b32 s65, s23, 0xffff
  s_mov_b32 s66, 819200
  s_mov_b32 s67, 0x20000
  v_xor_b32 v11, 64, v148
  v_xor_b32_e64 v12, 64, v149
  s_mul_i32 s15, s4, 51200
  s_add_u32 s14, s15, 256
  s_mov_b32 m0, 20480
  s_nop 0
  buffer_load_dwordx4 v11, s[64:67], s14 offen lds
  buffer_load_dwordx4 v12, s[64:67], s14 offen offset:2048 lds
  s_mov_b32 m0, 21504
  s_nop 0
  buffer_load_dwordx4 v148, s[56:59], s14 offen lds
  buffer_load_dwordx4 v149, s[56:59], s14 offen offset:2048 lds
  s_add_u32 s14, s15, 20736
  s_mov_b32 m0, 24576
  s_nop 0
  buffer_load_dwordx4 v11, s[64:67], s14 offen lds
  buffer_load_dwordx4 v12, s[64:67], s14 offen offset:2048 lds
  s_mov_b32 m0, 25600
  s_nop 0
  buffer_load_dwordx4 v148, s[56:59], s14 offen lds
  buffer_load_dwordx4 v149, s[56:59], s14 offen offset:2048 lds
  s_add_u32 s14, s15, 41216
  s_mov_b32 m0, 28672
  s_nop 0
  buffer_load_dwordx4 v11, s[64:67], s14 offen lds
  s_mov_b32 m0, 29696
  s_nop 0
  buffer_load_dwordx4 v148, s[56:59], s14 offen lds
  s_add_u32 s14, s15, 384
  s_mov_b32 m0, 30720
  s_nop 0
  buffer_load_dwordx4 v11, s[64:67], s14 offen lds
  buffer_load_dwordx4 v12, s[64:67], s14 offen offset:2048 lds
  s_mov_b32 m0, 31744
  s_nop 0
  buffer_load_dwordx4 v148, s[56:59], s14 offen lds
  buffer_load_dwordx4 v149, s[56:59], s14 offen offset:2048 lds
  s_add_u32 s14, s15, 20864
  s_mov_b32 m0, 34816
  s_nop 0
  buffer_load_dwordx4 v11, s[64:67], s14 offen lds
  buffer_load_dwordx4 v12, s[64:67], s14 offen offset:2048 lds
  s_mov_b32 m0, 35840
  s_nop 0
  buffer_load_dwordx4 v148, s[56:59], s14 offen lds
  buffer_load_dwordx4 v149, s[56:59], s14 offen offset:2048 lds
  s_add_u32 s14, s15, 41344
  s_mov_b32 m0, 38912
  s_nop 0
  buffer_load_dwordx4 v11, s[64:67], s14 offen lds
  s_mov_b32 m0, 39936
  s_nop 0
  buffer_load_dwordx4 v148, s[56:59], s14 offen lds
  s_waitcnt vmcnt(30)
  v_xor_b32 v15, s8, v184
  v_cmp_lt_u32 vcc, 15, v15
  s_cbranch_vccnz again_15
ok_16:
  s_or_b32 s13, s8, s11
  v_cmp_ne_u32 vcc, s13, v184
  s_cmp_eq_u64 vcc, 0
  s_cselect_b32 s9, 1, 0
  s_cmp_eq_u32 s7, 2
  s_cselect_b32 s40, 0, s9
  s_waitcnt vmcnt(20)
  v_dot2_f32_bf16 v88, v48, s2, 0
  v_dot2_f32_bf16 v89, v49, s2, 0
  v_dot2_f32_bf16 v88, v50, s2, v88
  v_dot2_f32_bf16 v89, v51, s2, v89
  v_dot2_f32_bf16 v88, v52, s2, v88
  v_dot2_f32_bf16 v89, v53, s2, v89
  v_dot2_f32_bf16 v88, v54, s2, v88
  v_dot2_f32_bf16 v89, v55, s2, v89
  v_dot2_f32_bf16 v88, v56, s2, v88
  v_dot2_f32_bf16 v89, v57, s2, v89
  v_dot2_f32_bf16 v88, v58, s2, v88
  v_dot2_f32_bf16 v89, v59, s2, v89
  v_dot2_f32_bf16 v88, v60, s2, v88
  v_dot2_f32_bf16 v89, v61, s2, v89
  v_dot2_f32_bf16 v88, v62, s2, v88
  v_dot2_f32_bf16 v89, v63, s2, v89
  v_dot2_f32_bf16 v88, v64, s2, v88
  v_dot2_f32_bf16 v89, v65, s2, v89
  v_dot2_f32_bf16 v88, v66, s2, v88
  v_dot2_f32_bf16 v89, v67, s2, v89
  v_dot2_f32_bf16 v88, v68, s2, v88
  v_dot2_f32_bf16 v89, v69, s2, v89
  v_dot2_f32_bf16 v88, v70, s2, v88
  v_dot2_f32_bf16 v89, v71, s2, v89
  v_dot2_f32_bf16 v88, v72, s2, v88
  v_dot2_f32_bf16 v89, v73, s2, v89
  v_dot2_f32_bf16 v88, v74, s2, v88
  v_dot2_f32_bf16 v89, v75, s2, v89
  v_dot2_f32_bf16 v88, v76, s2, v88
  v_dot2_f32_bf16 v89, v77, s2, v89
  v_dot2_f32_bf16 v88, v78, s2, v88
  v_dot2_f32_bf16 v89, v79, s2, v89
  v_dot2_f32_bf16 v88, v80, s2, v88
  v_dot2_f32_bf16 v89, v81, s2, v89
  v_dot2_f32_bf16 v88, v82, s2, v88
  v_dot2_f32_bf16 v89, v83, s2, v89
  v_dot2_f32_bf16 v88, v84, s2, v88
  v_dot2_f32_bf16 v89, v85, s2, v89
  v_dot2_f32_bf16 v88, v86, s2, v88
  v_dot2_f32_bf16 v89, v87, s2, v89
  s_nop 2
  v_add_f32 v88, v88, v89
  s_nop 1
  v_add_f32_dpp v88, v88, v88 quad_perm:[1,0,3,2] row_mask:0xf bank_mask:0xf
  s_nop 1
  v_add_f32_dpp v88, v88, v88 quad_perm:[2,3,0,1] row_mask:0xf bank_mask:0xf
  s_nop 1
  v_add_f32_dpp v88, v88, v88 row_half_mirror row_mask:0xf bank_mask:0xf
  v_mov_b32 v89, s8
  v_lshlrev_b32 v11, 1, v1
  s_lshl_b32 s12, s4, 3
  s_and_b32 s13, s3, 7
  s_add_u32 s12, s12, s13
  s_mul_i32 s12, s12, 80
  s_and_b32 s13, s3, 8
  s_add_u32 s12, s12, s13
  s_add_u32 s12, s12, 303104
  s_mov_b32 exec_lo, 0x01010101
  s_mov_b32 exec_hi, 1
  buffer_store_dwordx2 v[88:89], v11, s[52:55], s12 offen sc1
  s_mov_b64 exec, -1
join_12:
  s_waitcnt lgkmcnt(0)
  v_mul_f32_e64 v21, v151, v21
  v_mul_f32_dpp v27, v26, v151 quad_perm:[1,0,3,2] row_mask:0xf bank_mask:0xf
  v_mul_f32_e64 v22, v151, v22
  v_mul_f32_dpp v29, v28, v151 quad_perm:[1,0,3,2] row_mask:0xf bank_mask:0xf
  v_mul_f32_e64 v23, v151, v23
  v_mul_f32_dpp v31, v30, v151 quad_perm:[1,0,3,2] row_mask:0xf bank_mask:0xf
  v_mul_f32_e64 v24, v151, v24
  v_mul_f32_dpp v33, v32, v151 quad_perm:[1,0,3,2] row_mask:0xf bank_mask:0xf
  v_mul_f32_e64 v25, v151, v25
  v_mul_f32_dpp v35, v34, v151 quad_perm:[1,0,3,2] row_mask:0xf bank_mask:0xf
  s_waitcnt vmcnt(7)
  s_barrier
  ds_read_b128 v[128:131], v144 offset:0
  ds_read_b128 v[132:135], v144 offset:8192
  ds_read_b128 v[88:91], v5 offset:0
  ds_read_b128 v[92:95], v5 offset:2048
  ds_read_b128 v[96:99], v5 offset:4096
  ds_read_b128 v[100:103], v5 offset:6144
  ds_read_b128 v[104:107], v5 offset:8192
  s_add_u32 m0, s77, 16384
  s_add_u32 s15, s76, 128
  buffer_load_dwordx4 v146, s[68:71], s15 offen lds
  buffer_load_dwordx4 v147, s[68:71], s15 offen offset:1024 lds
  s_add_u32 m0, s77, 24576
  s_add_u32 s15, s76, 5248
  buffer_load_dwordx4 v146, s[68:71], s15 offen lds
  buffer_load_dwordx4 v147, s[68:71], s15 offen offset:1024 lds
  s_waitcnt lgkmcnt(4)
  v_mfma_f32_16x16x32_bf16 v[48:51], v[128:131], v[88:91], 0
  ds_read_b128 v[136:139], v145 offset:0
  ds_read_b128 v[140:143], v145 offset:8192
  ds_read_b128 v[108:111], v6 offset:0
  s_add_u32 m0, s77, 32768
  s_add_u32 s15, s76, 256
  buffer_load_dwordx4 v146, s[68:71], s15 offen lds
  buffer_load_dwordx4 v147, s[68:71], s15 offen offset:1024 lds
  v_mfma_f32_16x16x32_bf16 v[52:55], v[132:135], v[88:91], 0
  s_add_u32 m0, s77, 40960
  s_add_u32 s15, s76, 5376
  buffer_load_dwordx4 v146, s[68:71], s15 offen lds
  buffer_load_dwordx4 v147, s[68:71], s15 offen offset:1024 lds
  s_waitcnt lgkmcnt(6)
  v_mfma_f32_16x16x32_bf16 v[56:59], v[128:131], v[92:95], 0
  ds_read_b128 v[112:115], v6 offset:2048
  s_add_u32 m0, s75, 40960
  s_add_u32 s14, s74, 512
  buffer_load_dwordx4 v148, s[56:59], s14 offen lds
  buffer_load_dwordx4 v149, s[56:59], s14 offen offset:2048 lds
  v_mfma_f32_16x16x32_bf16 v[60:63], v[132:135], v[92:95], 0
  s_add_u32 m0, s75, 45056
  s_add_u32 s14, s74, 20992
  buffer_load_dwordx4 v148, s[56:59], s14 offen lds
  buffer_load_dwordx4 v149, s[56:59], s14 offen offset:2048 lds
  s_waitcnt lgkmcnt(6)
  v_mfma_f32_16x16x32_bf16 v[64:67], v[128:131], v[96:99], 0
  ds_read_b128 v[116:119], v6 offset:4096
  v_mfma_f32_16x16x32_bf16 v[68:71], v[132:135], v[96:99], 0
  s_waitcnt lgkmcnt(6)
  v_mfma_f32_16x16x32_bf16 v[72:75], v[128:131], v[100:103], 0
  ds_read_b128 v[120:123], v6 offset:6144
  v_mfma_f32_16x16x32_bf16 v[76:79], v[132:135], v[100:103], 0
  s_waitcnt lgkmcnt(6)
  v_mfma_f32_16x16x32_bf16 v[80:83], v[128:131], v[104:107], 0
  ds_read_b128 v[124:127], v6 offset:8192
  v_mfma_f32_16x16x32_bf16 v[84:87], v[132:135], v[104:107], 0
  s_waitcnt vmcnt(8)
  s_waitcnt lgkmcnt(2)
  v_mfma_f32_16x16x32_bf16 v[48:51], v[136:139], v[108:111], v[48:51]
  ds_read_b128 v[128:131], v144 offset:16384
  ds_read_b128 v[132:135], v144 offset:24576
  ds_read_b128 v[88:91], v5 offset:10240
  ds_read_b128 v[192:195], v175 offset:0
  ds_read_b128 v[196:199], v175 offset:16
  v_mfma_f32_16x16x32_bf16 v[52:55], v[140:143], v[108:111], v[52:55]
  ds_read_b128 v[200:203], v175 offset:32
  ds_read_b128 v[204:207], v175 offset:48
  v_mfma_f32_16x16x32_bf16 v[56:59], v[136:139], v[112:115], v[56:59]
  ds_read_b128 v[92:95], v5 offset:12288
  s_waitcnt lgkmcnt(1)
  v_lshlrev_b32_e64 v152, 16, v176
  v_mfma_f32_16x16x32_bf16 v[60:63], v[140:143], v[112:115], v[60:63]
  v_and_b32 v153, 0xffff0000, v176
  v_lshlrev_b32_e64 v154, 16, v180
  v_mfma_f32_16x16x32_bf16 v[64:67], v[136:139], v[116:119], v[64:67]
  ds_read_b128 v[96:99], v5 offset:14336
  v_and_b32 v155, 0xffff0000, v180
  v_pk_mul_f32 v[156:157], v[152:153], v[192:193]
  v_mfma_f32_16x16x32_bf16 v[68:71], v[140:143], v[116:119], v[68:71]
  v_pk_mul_f32 v[158:159], v[152:153], v[194:195] neg_lo:[0,1] neg_hi:[0,1]
  v_pk_fma_f32 v[156:157], v[154:155], v[194:195], v[156:157] neg_lo:[0,1,0] neg_hi:[0,1,0]
  v_mfma_f32_16x16x32_bf16 v[72:75], v[136:139], v[120:123], v[72:75]
  ds_read_b128 v[100:103], v5 offset:16384
  v_pk_fma_f32 v[158:159], v[154:155], v[192:193], v[158:159] neg_lo:[0,1,0] neg_hi:[0,1,0]
  v_cvt_pk_bf16_f32 v176, v156, v157
  v_mfma_f32_16x16x32_bf16 v[76:79], v[140:143], v[120:123], v[76:79]
  s_add_u32 m0, s77, 49152
  s_add_u32 s15, s76, 384
  buffer_load_dwordx4 v146, s[68:71], s15 offen lds
  buffer_load_dwordx4 v147, s[68:71], s15 offen offset:1024 lds
  s_add_u32 m0, s77, 0
  s_add_u32 s15, s76, 5504
  buffer_load_dwordx4 v146, s[68:71], s15 offen lds
  buffer_load_dwordx4 v147, s[68:71], s15 offen offset:1024 lds
  v_mfma_f32_16x16x32_bf16 v[80:83], v[136:139], v[124:127], v[80:83]
  ds_read_b128 v[104:107], v5 offset:18432
  s_add_u32 m0, s75, 49152
  s_add_u32 s14, s74, 41472
  buffer_load_dwordx4 v148, s[56:59], s14 offen lds
  s_add_u32 m0, s75, 61440
  s_add_u32 s14, s74, 768
  buffer_load_dwordx4 v148, s[56:59], s14 offen lds
  buffer_load_dwordx4 v149, s[56:59], s14 offen offset:2048 lds
  v_mfma_f32_16x16x32_bf16 v[84:87], v[140:143], v[124:127], v[84:87]
  s_add_u32 m0, s75, 65536
  s_add_u32 s14, s74, 21248
  buffer_load_dwordx4 v148, s[56:59], s14 offen lds
  buffer_load_dwordx4 v149, s[56:59], s14 offen offset:2048 lds
  s_waitcnt lgkmcnt(2)
  v_mfma_f32_16x16x32_bf16 v[48:51], v[128:131], v[88:91], v[48:51]
  ds_read_b128 v[136:139], v145 offset:16384
  ds_read_b128 v[140:143], v145 offset:24576
  ds_read_b128 v[108:111], v6 offset:10240
  v_cvt_pk_bf16_f32 v180, v158, v159
  v_lshlrev_b32_e64 v152, 16, v177
  v_mfma_f32_16x16x32_bf16 v[52:55], v[132:135], v[88:91], v[52:55]
  v_and_b32 v153, 0xffff0000, v177
  v_lshlrev_b32_e64 v154, 16, v181
  v_mfma_f32_16x16x32_bf16 v[56:59], v[128:131], v[92:95], v[56:59]
  ds_read_b128 v[112:115], v6 offset:12288
  v_and_b32 v155, 0xffff0000, v181
  v_pk_mul_f32 v[156:157], v[152:153], v[196:197]
  v_mfma_f32_16x16x32_bf16 v[60:63], v[132:135], v[92:95], v[60:63]
  v_pk_mul_f32 v[158:159], v[152:153], v[198:199] neg_lo:[0,1] neg_hi:[0,1]
  v_pk_fma_f32 v[156:157], v[154:155], v[198:199], v[156:157] neg_lo:[0,1,0] neg_hi:[0,1,0]
  v_mfma_f32_16x16x32_bf16 v[64:67], v[128:131], v[96:99], v[64:67]
  ds_read_b128 v[116:119], v6 offset:14336
  v_pk_fma_f32 v[158:159], v[154:155], v[196:197], v[158:159] neg_lo:[0,1,0] neg_hi:[0,1,0]
  v_cvt_pk_bf16_f32 v177, v156, v157
  v_mfma_f32_16x16x32_bf16 v[68:71], v[132:135], v[96:99], v[68:71]
  v_cvt_pk_bf16_f32 v181, v158, v159
  v_lshlrev_b32 v152, 16, v178
  s_waitcnt lgkmcnt(5)
  v_mfma_f32_16x16x32_bf16 v[72:75], v[128:131], v[100:103], v[72:75]
  ds_read_b128 v[120:123], v6 offset:16384
  v_and_b32 v153, 0xffff0000, v178
  v_mfma_f32_16x16x32_bf16 v[76:79], v[132:135], v[100:103], v[76:79]
  v_lshlrev_b32_e64 v154, 16, v182
  v_mfma_f32_16x16x32_bf16 v[80:83], v[128:131], v[104:107], v[80:83]
  ds_read_b128 v[124:127], v6 offset:18432
  s_add_u32 m0, s77, 8192
  s_add_u32 s15, s76, 512
  buffer_load_dwordx4 v146, s[68:71], s15 offen lds
  buffer_load_dwordx4 v147, s[68:71], s15 offen offset:1024 lds
  v_mfma_f32_16x16x32_bf16 v[84:87], v[132:135], v[104:107], v[84:87]
  s_add_u32 m0, s75, 69632
  s_add_u32 s14, s74, 41728
  buffer_load_dwordx4 v148, s[56:59], s14 offen lds
  s_waitcnt vmcnt(16)
  s_barrier
  s_waitcnt lgkmcnt(2)
  v_mfma_f32_16x16x32_bf16 v[48:51], v[136:139], v[108:111], v[48:51]
  ds_read_b128 v[128:131], v144 offset:32768
  ds_read_b128 v[132:135], v144 offset:40960
  ds_read_b128 v[88:91], v5 offset:20480
  v_and_b32 v155, 0xffff0000, v182
  v_pk_mul_f32 v[156:157], v[152:153], v[200:201]
  v_mfma_f32_16x16x32_bf16 v[52:55], v[140:143], v[108:111], v[52:55]
  v_pk_mul_f32 v[158:159], v[152:153], v[202:203] neg_lo:[0,1] neg_hi:[0,1]
  v_pk_fma_f32 v[156:157], v[154:155], v[202:203], v[156:157] neg_lo:[0,1,0] neg_hi:[0,1,0]
  v_mfma_f32_16x16x32_bf16 v[56:59], v[136:139], v[112:115], v[56:59]
  ds_read_b128 v[92:95], v5 offset:22528
  v_pk_fma_f32 v[158:159], v[154:155], v[200:201], v[158:159] neg_lo:[0,1,0] neg_hi:[0,1,0]
  v_cvt_pk_bf16_f32 v178, v156, v157
  v_mfma_f32_16x16x32_bf16 v[60:63], v[140:143], v[112:115], v[60:63]
  v_cvt_pk_bf16_f32 v182, v158, v159
  v_lshlrev_b32 v152, 16, v179
  v_mfma_f32_16x16x32_bf16 v[64:67], v[136:139], v[116:119], v[64:67]
  ds_read_b128 v[96:99], v5 offset:24576
  v_and_b32 v153, 0xffff0000, v179
  v_lshlrev_b32_e64 v154, 16, v183
  v_mfma_f32_16x16x32_bf16 v[68:71], v[140:143], v[116:119], v[68:71]
  v_and_b32 v155, 0xffff0000, v183
  v_pk_mul_f32 v[156:157], v[152:153], v[204:205]
  s_waitcnt lgkmcnt(5)
  v_mfma_f32_16x16x32_bf16 v[72:75], v[136:139], v[120:123], v[72:75]
  ds_read_b128 v[100:103], v5 offset:26624
  v_pk_mul_f32 v[158:159], v[152:153], v[206:207] neg_lo:[0,1] neg_hi:[0,1]
  v_pk_fma_f32 v[156:157], v[154:155], v[206:207], v[156:157] neg_lo:[0,1,0] neg_hi:[0,1,0]
  v_mfma_f32_16x16x32_bf16 v[76:79], v[140:143], v[120:123], v[76:79]
  s_add_u32 m0, s77, 16384
  s_add_u32 s15, s76, 5632
  buffer_load_dwordx4 v146, s[68:71], s15 offen lds
  buffer_load_dwordx4 v147, s[68:71], s15 offen offset:1024 lds
  v_mfma_f32_16x16x32_bf16 v[80:83], v[136:139], v[124:127], v[80:83]
  ds_read_b128 v[104:107], v5 offset:28672
  s_add_u32 m0, s75, 81920
  s_add_u32 s14, s74, 1024
  buffer_load_dwordx4 v148, s[56:59], s14 offen lds
  buffer_load_dwordx4 v149, s[56:59], s14 offen offset:2048 lds
  v_mfma_f32_16x16x32_bf16 v[84:87], v[140:143], v[124:127], v[84:87]
  s_add_u32 m0, s75, 86016
  s_add_u32 s14, s74, 21504
  buffer_load_dwordx4 v148, s[56:59], s14 offen lds
  buffer_load_dwordx4 v149, s[56:59], s14 offen offset:2048 lds
  s_waitcnt lgkmcnt(2)
  v_mfma_f32_16x16x32_bf16 v[48:51], v[128:131], v[88:91], v[48:51]
  ds_read_b128 v[136:139], v145 offset:32768
  ds_read_b128 v[140:143], v145 offset:40960
  ds_read_b128 v[108:111], v6 offset:20480
  v_pk_fma_f32 v[158:159], v[154:155], v[204:205], v[158:159] neg_lo:[0,1,0] neg_hi:[0,1,0]
  v_mfma_f32_16x16x32_bf16 v[52:55], v[132:135], v[88:91], v[52:55]
  v_cvt_pk_bf16_f32 v179, v156, v157
  v_mfma_f32_16x16x32_bf16 v[56:59], v[128:131], v[92:95], v[56:59]
  ds_read_b128 v[112:115], v6 offset:22528
  v_cvt_pk_bf16_f32 v183, v158, v159
  v_mfma_f32_16x16x32_bf16 v[60:63], v[132:135], v[92:95], v[60:63]
  s_mul_i32 s12, s0, 204800
  s_add_u32 s12, s12, 23068672
  s_add_u32 s13, s12, 5120
  buffer_store_dwordx4 v[176:179], v174, s[52:55], s12 offen sc1
  buffer_store_dwordx4 v[180:183], v174, s[52:55], s13 offen sc1
  v_mfma_f32_16x16x32_bf16 v[64:67], v[128:131], v[96:99], v[64:67]
  ds_read_b128 v[116:119], v6 offset:24576
  s_add_u32 m0, s77, 24576
  s_add_u32 s15, s76, 640
  buffer_load_dwordx4 v146, s[68:71], s15 offen lds
  buffer_load_dwordx4 v147, s[68:71], s15 offen offset:1024 lds
  v_mfma_f32_16x16x32_bf16 v[68:71], v[132:135], v[96:99], v[68:71]
  s_add_u32 m0, s75, 90112
  s_add_u32 s14, s74, 41984
  buffer_load_dwordx4 v148, s[56:59], s14 offen lds
  s_waitcnt lgkmcnt(5)
  v_mfma_f32_16x16x32_bf16 v[72:75], v[128:131], v[100:103], v[72:75]
  ds_read_b128 v[120:123], v6 offset:26624
  v_mfma_f32_16x16x32_bf16 v[76:79], v[132:135], v[100:103], v[76:79]
  v_mfma_f32_16x16x32_bf16 v[80:83], v[128:131], v[104:107], v[80:83]
  ds_read_b128 v[124:127], v6 offset:28672
  v_mfma_f32_16x16x32_bf16 v[84:87], v[132:135], v[104:107], v[84:87]
  s_waitcnt vmcnt(19)
  s_waitcnt lgkmcnt(2)
  v_mfma_f32_16x16x32_bf16 v[48:51], v[136:139], v[108:111], v[48:51]
  ds_read_b128 v[128:131], v144 offset:49152
  ds_read_b128 v[132:135], v144 offset:0
  ds_read_b128 v[88:91], v5 offset:30720
  s_add_u32 m0, s77, 32768
  s_add_u32 s15, s76, 5760
  buffer_load_dwordx4 v146, s[68:71], s15 offen lds
  buffer_load_dwordx4 v147, s[68:71], s15 offen offset:1024 lds
  v_mfma_f32_16x16x32_bf16 v[52:55], v[140:143], v[108:111], v[52:55]
  v_mov_b32 v15, s8
  s_mov_b64 exec, 1
  s_cmp_eq_u32 s40, 0
  s_cbranch_scc1 slow_17
  buffer_store_dword v15, off, s[52:55], s41
back_18:
  s_mov_b64 exec, -1
  v_mfma_f32_16x16x32_bf16 v[56:59], v[136:139], v[112:115], v[56:59]
  ds_read_b128 v[92:95], v5 offset:32768
  v_mfma_f32_16x16x32_bf16 v[60:63], v[140:143], v[112:115], v[60:63]
  v_mfma_f32_16x16x32_bf16 v[64:67], v[136:139], v[116:119], v[64:67]
  ds_read_b128 v[96:99], v5 offset:34816
  v_mfma_f32_16x16x32_bf16 v[68:71], v[140:143], v[116:119], v[68:71]
  s_waitcnt lgkmcnt(5)
  v_mfma_f32_16x16x32_bf16 v[72:75], v[136:139], v[120:123], v[72:75]
  ds_read_b128 v[100:103], v5 offset:36864
  v_mfma_f32_16x16x32_bf16 v[76:79], v[140:143], v[120:123], v[76:79]
  v_mfma_f32_16x16x32_bf16 v[80:83], v[136:139], v[124:127], v[80:83]
  ds_read_b128 v[104:107], v5 offset:38912
  v_mfma_f32_16x16x32_bf16 v[84:87], v[140:143], v[124:127], v[84:87]
  s_waitcnt lgkmcnt(2)
  v_mfma_f32_16x16x32_bf16 v[48:51], v[128:131], v[88:91], v[48:51]
  ds_read_b128 v[136:139], v145 offset:49152
  ds_read_b128 v[140:143], v145 offset:0
  ds_read_b128 v[108:111], v6 offset:30720
  s_add_u32 m0, s77, 40960
  s_add_u32 s15, s76, 768
  buffer_load_dwordx4 v146, s[68:71], s15 offen lds
  buffer_load_dwordx4 v147, s[68:71], s15 offen offset:1024 lds
  v_mfma_f32_16x16x32_bf16 v[52:55], v[132:135], v[88:91], v[52:55]
  v_mfma_f32_16x16x32_bf16 v[56:59], v[128:131], v[92:95], v[56:59]
  ds_read_b128 v[112:115], v6 offset:32768
  v_mfma_f32_16x16x32_bf16 v[60:63], v[132:135], v[92:95], v[60:63]
  v_mfma_f32_16x16x32_bf16 v[64:67], v[128:131], v[96:99], v[64:67]
  ds_read_b128 v[116:119], v6 offset:34816
  v_mfma_f32_16x16x32_bf16 v[68:71], v[132:135], v[96:99], v[68:71]
  s_waitcnt lgkmcnt(5)
  v_mfma_f32_16x16x32_bf16 v[72:75], v[128:131], v[100:103], v[72:75]
  ds_read_b128 v[120:123], v6 offset:36864
  v_mfma_f32_16x16x32_bf16 v[76:79], v[132:135], v[100:103], v[76:79]
  v_mfma_f32_16x16x32_bf16 v[80:83], v[128:131], v[104:107], v[80:83]
  ds_read_b128 v[124:127], v6 offset:38912
  v_mfma_f32_16x16x32_bf16 v[84:87], v[132:135], v[104:107], v[84:87]
  s_waitcnt vmcnt(14)
  s_barrier
  s_waitcnt lgkmcnt(2)
  v_mfma_f32_16x16x32_bf16 v[48:51], v[136:139], v[108:111], v[48:51]
  ds_read_b128 v[128:131], v144 offset:8192
  ds_read_b128 v[132:135], v144 offset:16384
  ds_read_b128 v[88:91], v5 offset:40960
  s_add_u32 m0, s77, 49152
  s_add_u32 s15, s76, 5888
  buffer_load_dwordx4 v146, s[68:71], s15 offen lds
  buffer_load_dwordx4 v147, s[68:71], s15 offen offset:1024 lds
  v_mfma_f32_16x16x32_bf16 v[52:55], v[140:143], v[108:111], v[52:55]
  v_mfma_f32_16x16x32_bf16 v[56:59], v[136:139], v[112:115], v[56:59]
  ds_read_b128 v[92:95], v5 offset:43008
  v_mfma_f32_16x16x32_bf16 v[60:63], v[140:143], v[112:115], v[60:63]
  v_mfma_f32_16x16x32_bf16 v[64:67], v[136:139], v[116:119], v[64:67]
  ds_read_b128 v[96:99], v5 offset:45056
  v_mfma_f32_16x16x32_bf16 v[68:71], v[140:143], v[116:119], v[68:71]
  s_waitcnt lgkmcnt(5)
  v_mfma_f32_16x16x32_bf16 v[72:75], v[136:139], v[120:123], v[72:75]
  ds_read_b128 v[100:103], v5 offset:47104
  v_mfma_f32_16x16x32_bf16 v[76:79], v[140:143], v[120:123], v[76:79]
  v_mfma_f32_16x16x32_bf16 v[80:83], v[136:139], v[124:127], v[80:83]
  ds_read_b128 v[104:107], v5 offset:49152
  v_mfma_f32_16x16x32_bf16 v[84:87], v[140:143], v[124:127], v[84:87]
  s_waitcnt lgkmcnt(2)
  v_mfma_f32_16x16x32_bf16 v[48:51], v[128:131], v[88:91], v[48:51]
  ds_read_b128 v[136:139], v145 offset:8192
  ds_read_b128 v[140:143], v145 offset:16384
  ds_read_b128 v[108:111], v6 offset:40960
  s_mov_b32 s64, s42
  s_and_b32 s65, s43, 0xffff
  s_mov_b32 s66, 2621440
  s_mov_b32 s67, 0x20000
  buffer_load_dwordx4 v[192:195], v2, s[64:67], s90 offen
  v_mfma_f32_16x16x32_bf16 v[52:55], v[132:135], v[88:91], v[52:55]
  buffer_load_dwordx4 v[204:207], v2, s[64:67], s90 offen offset:4
  s_add_u32 m0, s77, 0
  s_add_u32 s15, s76, 896
  buffer_load_dwordx4 v146, s[68:71], s15 offen lds
  buffer_load_dwordx4 v147, s[68:71], s15 offen offset:1024 lds
  v_mfma_f32_16x16x32_bf16 v[56:59], v[128:131], v[92:95], v[56:59]
  ds_read_b128 v[112:115], v6 offset:43008
  v_lshrrev_b32_e64 v11, 5, v1
  v_mul_u32_u24 v11, 4096, v11
  v_mfma_f32_16x16x32_bf16 v[60:63], v[132:135], v[92:95], v[60:63]
  v_add_u32_e64 v11, v11, v2
  v_mfma_f32_16x16x32_bf16 v[64:67], v[128:131], v[96:99], v[64:67]
  ds_read_b128 v[116:119], v6 offset:45056
  v_mov_b32_e64 v216, 0
  v_mfma_f32_16x16x32_bf16 v[68:71], v[132:135], v[96:99], v[68:71]
  v_mov_b32 v217, 0
  s_waitcnt lgkmcnt(5)
  v_mfma_f32_16x16x32_bf16 v[72:75], v[128:131], v[100:103], v[72:75]
  ds_read_b128 v[120:123], v6 offset:47104
  v_mov_b32_e64 v218, 0
  v_mfma_f32_16x16x32_bf16 v[76:79], v[132:135], v[100:103], v[76:79]
  v_mov_b32_e64 v219, 0
  v_mfma_f32_16x16x32_bf16 v[80:83], v[128:131], v[104:107], v[80:83]
  ds_read_b128 v[124:127], v6 offset:49152
  ds_write_b128 v11, v[216:219] offset:4096
  v_mfma_f32_16x16x32_bf16 v[84:87], v[132:135], v[104:107], v[84:87]
  ds_write_b128 v11, v[216:219] offset:8704
  s_waitcnt vmcnt(9)
  s_waitcnt lgkmcnt(4)
  v_mfma_f32_16x16x32_bf16 v[48:51], v[136:139], v[108:111], v[48:51]
  ds_read_b128 v[128:131], v144 offset:24576
  ds_read_b128 v[132:135], v144 offset:32768
  ds_read_b128 v[88:91], v7 offset:0
  buffer_load_dwordx4 v[196:199], v2, s[64:67], s91 offen
  v_mfma_f32_16x16x32_bf16 v[52:55], v[140:143], v[108:111], v[52:55]
  buffer_load_dwordx4 v[208:211], v2, s[64:67], s91 offen offset:4
  v_mfma_f32_16x16x32_bf16 v[56:59], v[136:139], v[112:115], v[56:59]
  ds_read_b128 v[92:95], v7 offset:2048
  buffer_load_dwordx4 v[200:203], v2, s[64:67], s92 offen
  v_mfma_f32_16x16x32_bf16 v[60:63], v[140:143], v[112:115], v[60:63]
  s_add_u32 m0, s77, 8192
  s_add_u32 s15, s76, 6016
  buffer_load_dwordx4 v146, s[68:71], s15 offen lds
  buffer_load_dwordx4 v147, s[68:71], s15 offen offset:1024 lds
  v_mfma_f32_16x16x32_bf16 v[64:67], v[136:139], v[116:119], v[64:67]
  ds_read_b128 v[96:99], v7 offset:4096
  s_add_u32 s12, s85, 20480
  v_mov_b32 v15, s8
  s_mov_b64 exec, 1
  buffer_store_dword v15, off, s[52:55], s12 sc1
  s_mov_b64 exec, -1
  v_mfma_f32_16x16x32_bf16 v[68:71], v[140:143], v[116:119], v[68:71]
  s_waitcnt lgkmcnt(7)
  v_mfma_f32_16x16x32_bf16 v[72:75], v[136:139], v[120:123], v[72:75]
  ds_read_b128 v[100:103], v7 offset:6144
  v_mfma_f32_16x16x32_bf16 v[76:79], v[140:143], v[120:123], v[76:79]
  v_mfma_f32_16x16x32_bf16 v[80:83], v[136:139], v[124:127], v[80:83]
  ds_read_b128 v[104:107], v7 offset:8192
  v_mfma_f32_16x16x32_bf16 v[84:87], v[140:143], v[124:127], v[84:87]
  s_waitcnt lgkmcnt(2)
  v_mfma_f32_16x16x32_bf16 v[48:51], v[128:131], v[88:91], v[48:51]
  ds_read_b128 v[136:139], v145 offset:24576
  ds_read_b128 v[140:143], v145 offset:32768
  ds_read_b128 v[108:111], v8 offset:0
  buffer_load_dwordx4 v[212:215], v2, s[64:67], s92 offen offset:4
  v_mfma_f32_16x16x32_bf16 v[52:55], v[132:135], v[88:91], v[52:55]
  s_add_u32 m0, s77, 16384
  s_add_u32 s15, s76, 1024
  buffer_load_dwordx4 v146, s[68:71], s15 offen lds
  buffer_load_dwordx4 v147, s[68:71], s15 offen offset:1024 lds
  v_mfma_f32_16x16x32_bf16 v[56:59], v[128:131], v[92:95], v[56:59]
  ds_read_b128 v[112:115], v8 offset:2048
  s_and_b32 s87, s85, 0xe00
  s_add_u32 s87, s87, 28672
  buffer_load_dwordx2 v[188:189], v187, s[52:55], s87 offen sc1
  v_mfma_f32_16x16x32_bf16 v[60:63], v[132:135], v[92:95], v[60:63]
  v_mfma_f32_16x16x32_bf16 v[64:67], v[128:131], v[96:99], v[64:67]
  ds_read_b128 v[116:119], v8 offset:4096
  v_mfma_f32_16x16x32_bf16 v[68:71], v[132:135], v[96:99], v[68:71]
  s_waitcnt lgkmcnt(5)
  v_mfma_f32_16x16x32_bf16 v[72:75], v[128:131], v[100:103], v[72:75]
  ds_read_b128 v[120:123], v8 offset:6144
  v_mfma_f32_16x16x32_bf16 v[76:79], v[132:135], v[100:103], v[76:79]
  v_mfma_f32_16x16x32_bf16 v[80:83], v[128:131], v[104:107], v[80:83]
  ds_read_b128 v[124:127], v8 offset:8192
  v_mfma_f32_16x16x32_bf16 v[84:87], v[132:135], v[104:107], v[84:87]
  s_waitcnt vmcnt(14)
  s_barrier
  s_waitcnt lgkmcnt(2)
  v_mfma_f32_16x16x32_bf16 v[48:51], v[136:139], v[108:111], v[48:51]
  ds_read_b128 v[128:131], v144 offset:40960
  ds_read_b128 v[132:135], v144 offset:49152
  ds_read_b128 v[88:91], v7 offset:10240
  s_add_u32 m0, s77, 24576
  s_add_u32 s15, s76, 6144
  buffer_load_dwordx4 v146, s[68:71], s15 offen lds
  buffer_load_dwordx4 v147, s[68:71], s15 offen offset:1024 lds
  v_mfma_f32_16x16x32_bf16 v[52:55], v[140:143], v[108:111], v[52:55]
  v_mfma_f32_16x16x32_bf16 v[56:59], v[136:139], v[112:115], v[56:59]
  ds_read_b128 v[92:95], v7 offset:12288
  v_mfma_f32_16x16x32_bf16 v[60:63], v[140:143], v[112:115], v[60:63]
  v_mfma_f32_16x16x32_bf16 v[64:67], v[136:139], v[116:119], v[64:67]
  ds_read_b128 v[96:99], v7 offset:14336
  v_mfma_f32_16x16x32_bf16 v[68:71], v[140:143], v[116:119], v[68:71]
  s_waitcnt lgkmcnt(5)
  v_mfma_f32_16x16x32_bf16 v[72:75], v[136:139], v[120:123], v[72:75]
  ds_read_b128 v[100:103], v7 offset:16384
  v_mfma_f32_16x16x32_bf16 v[76:79], v[140:143], v[120:123], v[76:79]
  v_mfma_f32_16x16x32_bf16 v[80:83], v[136:139], v[124:127], v[80:83]
  ds_read_b128 v[104:107], v7 offset:18432
  v_mfma_f32_16x16x32_bf16 v[84:87], v[140:143], v[124:127], v[84:87]
  s_waitcnt lgkmcnt(2)
  v_mfma_f32_16x16x32_bf16 v[48:51], v[128:131], v[88:91], v[48:51]
  ds_read_b128 v[136:139], v145 offset:40960
  ds_read_b128 v[140:143], v145 offset:49152
  ds_read_b128 v[108:111], v8 offset:10240
  s_add_u32 m0, s77, 32768
  s_add_u32 s15, s76, 1152
  buffer_load_dwordx4 v146, s[68:71], s15 offen lds
  buffer_load_dwordx4 v147, s[68:71], s15 offen offset:1024 lds
  v_mfma_f32_16x16x32_bf16 v[52:55], v[132:135], v[88:91], v[52:55]
  s_waitcnt vmcnt(4)
  v_xor_b32 v15, s8, v188
  v_xor_b32 v14, s8, v189
  v_or_b32 v15, v15, v14
  v_cmp_ne_u32 vcc, 0, v15
  s_cbranch_vccnz again_19
ok_20:
  s_lshl_b32 s12, s0, 16
  s_add_u32 s12, s12, s90
  s_add_u32 s12, s12, 4194304
  s_lshl_b32 m0, s7, 10
  s_nop 0
  buffer_load_dwordx4 v2, s[52:55], s12 offen sc1 lds
  s_lshl_b32 s12, s0, 16
  s_add_u32 s12, s12, s91
  s_add_u32 s12, s12, 4194304
  s_lshl_b32 m0, s7, 10
  s_add_u32 m0, m0, 4608
  s_nop 0
  buffer_load_dwordx4 v2, s[52:55], s12 offen sc1 lds
  v_mfma_f32_16x16x32_bf16 v[56:59], v[128:131], v[92:95], v[56:59]
  ds_read_b128 v[112:115], v8 offset:12288
  v_mfma_f32_16x16x32_bf16 v[60:63], v[132:135], v[92:95], v[60:63]
  v_mfma_f32_16x16x32_bf16 v[64:67], v[128:131], v[96:99], v[64:67]
  ds_read_b128 v[116:119], v8 offset:14336
  v_mfma_f32_16x16x32_bf16 v[68:71], v[132:135], v[96:99], v[68:71]
  s_waitcnt lgkmcnt(5)
  v_mfma_f32_16x16x32_bf16 v[72:75], v[128:131], v[100:103], v[72:75]
  ds_read_b128 v[120:123], v8 offset:16384
  v_mfma_f32_16x16x32_bf16 v[76:79], v[132:135], v[100:103], v[76:79]
  v_mfma_f32_16x16x32_bf16 v[80:83], v[128:131], v[104:107], v[80:83]
  ds_read_b128 v[124:127], v8 offset:18432
  v_mfma_f32_16x16x32_bf16 v[84:87], v[132:135], v[104:107], v[84:87]
  s_waitcnt lgkmcnt(2)
  v_mfma_f32_16x16x32_bf16 v[48:51], v[136:139], v[108:111], v[48:51]
  ds_read_b128 v[128:131], v144 offset:0
  ds_read_b128 v[132:135], v144 offset:8192
  ds_read_b128 v[88:91], v7 offset:20480
  s_add_u32 m0, s77, 40960
  s_add_u32 s15, s76, 6272
  buffer_load_dwordx4 v146, s[68:71], s15 offen lds
  buffer_load_dwordx4 v147, s[68:71], s15 offen offset:1024 lds
  v_mfma_f32_16x16x32_bf16 v[52:55], v[140:143], v[108:111], v[52:55]
  buffer_load_dwordx3 v[152:154], v160, s[52:55], s93 offen sc1
  v_mfma_f32_16x16x32_bf16 v[56:59], v[136:139], v[112:115], v[56:59]
  ds_read_b128 v[92:95], v7 offset:22528
  buffer_load_dwordx2 v[156:157], v161, s[52:55], s94 offen sc1
  v_mfma_f32_16x16x32_bf16 v[60:63], v[140:143], v[112:115], v[60:63]
  buffer_load_dwordx2 v[158:159], v162, s[52:55], s94 offen offset:512 sc1
  v_mfma_f32_16x16x32_bf16 v[64:67], v[136:139], v[116:119], v[64:67]
  ds_read_b128 v[96:99], v7 offset:24576
  s_mov_b32 s36, 32768
  buffer_load_dwordx4 v[220:223], v2, s[52:55], s36 offen sc1
  v_mfma_f32_16x16x32_bf16 v[68:71], v[140:143], v[116:119], v[68:71]
  s_waitcnt lgkmcnt(5)
  v_mfma_f32_16x16x32_bf16 v[72:75], v[136:139], v[120:123], v[72:75]
  ds_read_b128 v[100:103], v7 offset:26624
  v_mfma_f32_16x16x32_bf16 v[76:79], v[140:143], v[120:123], v[76:79]
  v_mfma_f32_16x16x32_bf16 v[80:83], v[136:139], v[124:127], v[80:83]
  ds_read_b128 v[104:107], v7 offset:28672
  v_mfma_f32_16x16x32_bf16 v[84:87], v[140:143], v[124:127], v[84:87]
  s_waitcnt lgkmcnt(2)
  v_mfma_f32_16x16x32_bf16 v[48:51], v[128:131], v[88:91], v[48:51]
  ds_read_b128 v[136:139], v145 offset:0
  ds_read_b128 v[140:143], v145 offset:8192
  ds_read_b128 v[108:111], v8 offset:20480
  buffer_load_dwordx4 v[188:191], v187, s[52:55], s88 offen sc1
  v_mfma_f32_16x16x32_bf16 v[52:55], v[132:135], v[88:91], v[52:55]
  v_mfma_f32_16x16x32_bf16 v[56:59], v[128:131], v[92:95], v[56:59]
  ds_read_b128 v[112:115], v8 offset:22528
  v_mfma_f32_16x16x32_bf16 v[60:63], v[132:135], v[92:95], v[60:63]
  v_mfma_f32_16x16x32_bf16 v[64:67], v[128:131], v[96:99], v[64:67]
  ds_read_b128 v[116:119], v8 offset:24576
  v_mfma_f32_16x16x32_bf16 v[68:71], v[132:135], v[96:99], v[68:71]
  s_waitcnt lgkmcnt(5)
  v_mfma_f32_16x16x32_bf16 v[72:75], v[128:131], v[100:103], v[72:75]
  ds_read_b128 v[120:123], v8 offset:26624
  v_mfma_f32_16x16x32_bf16 v[76:79], v[132:135], v[100:103], v[76:79]
  v_mfma_f32_16x16x32_bf16 v[80:83], v[128:131], v[104:107], v[80:83]
  ds_read_b128 v[124:127], v8 offset:28672
  v_mfma_f32_16x16x32_bf16 v[84:87], v[132:135], v[104:107], v[84:87]
  s_waitcnt vmcnt(11)
  s_barrier
  s_waitcnt lgkmcnt(2)
  v_mfma_f32_16x16x32_bf16 v[48:51], v[136:139], v[108:111], v[48:51]
  ds_read_b128 v[128:131], v144 offset:16384
  ds_read_b128 v[132:135], v144 offset:24576
  ds_read_b128 v[88:91], v7 offset:30720
  v_mfma_f32_16x16x32_bf16 v[52:55], v[140:143], v[108:111], v[52:55]
  v_mfma_f32_16x16x32_bf16 v[56:59], v[136:139], v[112:115], v[56:59]
  ds_read_b128 v[92:95], v7 offset:32768
  v_mfma_f32_16x16x32_bf16 v[60:63], v[140:143], v[112:115], v[60:63]
  v_mfma_f32_16x16x32_bf16 v[64:67], v[136:139], v[116:119], v[64:67]
  ds_read_b128 v[96:99], v7 offset:34816
  v_mfma_f32_16x16x32_bf16 v[68:71], v[140:143], v[116:119], v[68:71]
  s_waitcnt lgkmcnt(5)
  v_mfma_f32_16x16x32_bf16 v[72:75], v[136:139], v[120:123], v[72:75]
  ds_read_b128 v[100:103], v7 offset:36864
  v_mfma_f32_16x16x32_bf16 v[76:79], v[140:143], v[120:123], v[76:79]
  v_mfma_f32_16x16x32_bf16 v[80:83], v[136:139], v[124:127], v[80:83]
  ds_read_b128 v[104:107], v7 offset:38912
  v_mfma_f32_16x16x32_bf16 v[84:87], v[140:143], v[124:127], v[84:87]
  s_waitcnt lgkmcnt(2)
  v_mfma_f32_16x16x32_bf16 v[48:51], v[128:131], v[88:91], v[48:51]
  ds_read_b128 v[136:139], v145 offset:16384
  ds_read_b128 v[140:143], v145 offset:24576
  ds_read_b128 v[108:111], v8 offset:30720
  v_mfma_f32_16x16x32_bf16 v[52:55], v[132:135], v[88:91], v[52:55]
  v_mfma_f32_16x16x32_bf16 v[56:59], v[128:131], v[92:95], v[56:59]
  ds_read_b128 v[112:115], v8 offset:32768
  v_mfma_f32_16x16x32_bf16 v[60:63], v[132:135], v[92:95], v[60:63]
  v_mfma_f32_16x16x32_bf16 v[64:67], v[128:131], v[96:99], v[64:67]
  ds_read_b128 v[116:119], v8 offset:34816
  v_mfma_f32_16x16x32_bf16 v[68:71], v[132:135], v[96:99], v[68:71]
  s_waitcnt lgkmcnt(5)
  v_mfma_f32_16x16x32_bf16 v[72:75], v[128:131], v[100:103], v[72:75]
  ds_read_b128 v[120:123], v8 offset:36864
  v_mfma_f32_16x16x32_bf16 v[76:79], v[132:135], v[100:103], v[76:79]
  v_mfma_f32_16x16x32_bf16 v[80:83], v[128:131], v[104:107], v[80:83]
  ds_read_b128 v[124:127], v8 offset:38912
  v_mfma_f32_16x16x32_bf16 v[84:87], v[132:135], v[104:107], v[84:87]
  s_waitcnt vmcnt(5)
  s_waitcnt lgkmcnt(2)
  v_mfma_f32_16x16x32_bf16 v[48:51], v[136:139], v[108:111], v[48:51]
  ds_read_b128 v[128:131], v144 offset:32768
  ds_read_b128 v[132:135], v144 offset:40960
  ds_read_b128 v[88:91], v7 offset:40960
  s_waitcnt vmcnt(1)
  v_min3_u32 v15, v220, v221, s8
  v_max3_u32 v14, v220, v221, s8
  v_min3_u32 v15, v15, v222, v223
  v_max3_u32 v14, v14, v222, v223
  v_cmp_ne_u32 vcc, v15, v14
  s_cbranch_vccnz again_21
ok_22:
  s_lshl_b32 s13, s7, 6
  s_sub_u32 s12, 255, s13
  v_sub_u32 v11, s12, v1
  v_lshlrev_b32 v11, 11, v11
  s_and_b32 s12, s24, 3
  s_lshl_b32 s12, s12, 9
  s_bfe_u32 s14, s24, 0x50002
  s_lshl_b32 s14, s14, 4
  s_add_u32 s12, s12, s14
  s_add_u32 s12, s12, 26214400
  s_lshl_b32 s13, s13, 4
  s_add_u32 m0, s13, 9216
  s_nop 0
  buffer_load_dwordx4 v11, s[52:55], s12 offen sc1 lds
  v_mfma_f32_16x16x32_bf16 v[52:55], v[140:143], v[108:111], v[52:55]
  s_waitcnt vmcnt(1)
  v_min3_u32 v15, v188, v189, s8
  v_max3_u32 v14, v188, v189, s8
  v_min3_u32 v15, v15, v190, v191
  v_max3_u32 v14, v14, v190, v191
  v_cmp_ne_u32 vcc, v15, v14
  s_cbranch_vccnz again_23
ok_24:
  s_mul_i32 s34, s6, 200
  s_mul_i32 s12, s7, 50
  s_add_u32 s34, s34, s12
  s_lshl_b32 s34, s34, 10
  s_add_u32 s34, s34, 23068672
  v_mfma_f32_16x16x32_bf16 v[56:59], v[136:139], v[112:115], v[56:59]
  ds_read_b128 v[92:95], v7 offset:43008
  buffer_load_dwordx4 a[0:3], v2, s[52:55], s34 offen offset:0 sc1
  v_mfma_f32_16x16x32_bf16 v[60:63], v[140:143], v[112:115], v[60:63]
  buffer_load_dwordx4 a[4:7], v2, s[52:55], s34 offen offset:1024 sc1
  v_mfma_f32_16x16x32_bf16 v[64:67], v[136:139], v[116:119], v[64:67]
  ds_read_b128 v[96:99], v7 offset:45056
  buffer_load_dwordx4 a[8:11], v2, s[52:55], s34 offen offset:2048 sc1
  v_mfma_f32_16x16x32_bf16 v[68:71], v[140:143], v[116:119], v[68:71]
  s_waitcnt lgkmcnt(5)
  v_mfma_f32_16x16x32_bf16 v[72:75], v[136:139], v[120:123], v[72:75]
  ds_read_b128 v[100:103], v7 offset:47104
  v_mfma_f32_16x16x32_bf16 v[76:79], v[140:143], v[120:123], v[76:79]
  v_mfma_f32_16x16x32_bf16 v[80:83], v[136:139], v[124:127], v[80:83]
  ds_read_b128 v[104:107], v7 offset:49152
  v_mfma_f32_16x16x32_bf16 v[84:87], v[140:143], v[124:127], v[84:87]
  s_waitcnt lgkmcnt(2)
  v_mfma_f32_16x16x32_bf16 v[48:51], v[128:131], v[88:91], v[48:51]
  ds_read_b128 v[136:139], v145 offset:32768
  ds_read_b128 v[140:143], v145 offset:40960
  ds_read_b128 v[108:111], v8 offset:40960
  v_min3_u32 v15, v154, v154, s8
  v_max3_u32 v14, v154, v154, s8
  v_min3_u32 v15, v15, v157, v159
  v_max3_u32 v14, v14, v157, v159
  v_cmp_ne_u32 vcc, v15, v14
  s_cbranch_vccnz again_25
ok_26:
  v_mfma_f32_16x16x32_bf16 v[52:55], v[132:135], v[88:91], v[52:55]
  buffer_load_dwordx4 a[12:15], v2, s[52:55], s34 offen offset:3072 sc1
  v_mfma_f32_16x16x32_bf16 v[56:59], v[128:131], v[92:95], v[56:59]
  ds_read_b128 v[112:115], v8 offset:43008
  s_add_u32 s34, s34, 4096
  buffer_load_dwordx4 a[16:19], v2, s[52:55], s34 offen offset:0 sc1
  v_mfma_f32_16x16x32_bf16 v[60:63], v[132:135], v[92:95], v[60:63]
  buffer_load_dwordx4 a[20:23], v2, s[52:55], s34 offen offset:1024 sc1
  v_mfma_f32_16x16x32_bf16 v[64:67], v[128:131], v[96:99], v[64:67]
  ds_read_b128 v[116:119], v8 offset:45056
  v_mfma_f32_16x16x32_bf16 v[68:71], v[132:135], v[96:99], v[68:71]
  s_waitcnt lgkmcnt(5)
  v_mfma_f32_16x16x32_bf16 v[72:75], v[128:131], v[100:103], v[72:75]
  ds_read_b128 v[120:123], v8 offset:47104
  v_mfma_f32_16x16x32_bf16 v[76:79], v[132:135], v[100:103], v[76:79]
  v_mfma_f32_16x16x32_bf16 v[80:83], v[128:131], v[104:107], v[80:83]
  ds_read_b128 v[124:127], v8 offset:49152
  v_mfma_f32_16x16x32_bf16 v[84:87], v[132:135], v[104:107], v[84:87]
  s_waitcnt lgkmcnt(2)
  s_barrier
  v_mfma_f32_16x16x32_bf16 v[48:51], v[136:139], v[108:111], v[48:51]
  buffer_load_dwordx4 a[24:27], v2, s[52:55], s34 offen offset:2048 sc1
  buffer_load_dwordx4 a[28:31], v2, s[52:55], s34 offen offset:3072 sc1
  v_mov_b32 v246, v156
  v_mfma_f32_16x16x32_bf16 v[52:55], v[140:143], v[108:111], v[52:55]
  v_mov_b32 v247, v156
  v_mov_b32 v250, v158
  s_nop 0
  v_permlane16_swap_b32 v246, v247
  v_mfma_f32_16x16x32_bf16 v[56:59], v[136:139], v[112:115], v[56:59]
  v_mov_b32 v248, v246
  v_mov_b32 v249, v247
  s_nop 0
  v_permlane32_swap_b32 v246, v248
  v_mfma_f32_16x16x32_bf16 v[60:63], v[140:143], v[112:115], v[60:63]
  v_permlane32_swap_b32 v247, v249
  v_mov_b32_dpp v88, v152 row_newbcast:0 row_mask:0xf bank_mask:0xf
  v_mov_b32_dpp v96, v153 row_newbcast:0 row_mask:0xf bank_mask:0xf
  v_mfma_f32_16x16x32_bf16 v[64:67], v[136:139], v[116:119], v[64:67]
  v_mov_b32_dpp v89, v152 row_newbcast:1 row_mask:0xf bank_mask:0xf
  v_mov_b32_dpp v97, v153 row_newbcast:1 row_mask:0xf bank_mask:0xf
  v_mov_b32_dpp v90, v152 row_newbcast:2 row_mask:0xf bank_mask:0xf
  v_mfma_f32_16x16x32_bf16 v[68:71], v[140:143], v[116:119], v[68:71]
  v_mov_b32_dpp v98, v153 row_newbcast:2 row_mask:0xf bank_mask:0xf
  v_mov_b32_dpp v91, v152 row_newbcast:3 row_mask:0xf bank_mask:0xf
  v_mov_b32_dpp v99, v153 row_newbcast:3 row_mask:0xf bank_mask:0xf
  s_waitcnt lgkmcnt(0)
  v_mfma_f32_16x16x32_bf16 v[72:75], v[136:139], v[120:123], v[72:75]
  v_mov_b32_dpp v92, v152 row_newbcast:4 row_mask:0xf bank_mask:0xf
  v_mov_b32_dpp v100, v153 row_newbcast:4 row_mask:0xf bank_mask:0xf
  v_mfma_f32_16x16x32_bf16 v[76:79], v[140:143], v[120:123], v[76:79]
  v_mov_b32_dpp v93, v152 row_newbcast:5 row_mask:0xf bank_mask:0xf
  v_mov_b32_dpp v101, v153 row_newbcast:5 row_mask:0xf bank_mask:0xf
  v_mfma_f32_16x16x32_bf16 v[80:83], v[136:139], v[124:127], v[80:83]
  v_mov_b32_dpp v94, v152 row_newbcast:6 row_mask:0xf bank_mask:0xf
  v_mov_b32_dpp v102, v153 row_newbcast:6 row_mask:0xf bank_mask:0xf
  v_mfma_f32_16x16x32_bf16 v[84:87], v[140:143], v[124:127], v[84:87]
  v_mov_b32_dpp v95, v152 row_newbcast:7 row_mask:0xf bank_mask:0xf
  v_mov_b32_dpp v103, v153 row_newbcast:7 row_mask:0xf bank_mask:0xf
  v_pk_fma_f32 v[48:49], v[88:89], v[246:247], v[48:49] op_sel_hi:[1,0,1] neg_lo:[1,0,0] neg_hi:[1,0,0]
  v_pk_fma_f32 v[50:51], v[90:91], v[246:247], v[50:51] op_sel_hi:[1,0,1] neg_lo:[1,0,0] neg_hi:[1,0,0]
  v_pk_fma_f32 v[52:53], v[92:93], v[246:247], v[52:53] op_sel_hi:[1,0,1] neg_lo:[1,0,0] neg_hi:[1,0,0]
  v_pk_fma_f32 v[54:55], v[94:95], v[246:247], v[54:55] op_sel_hi:[1,0,1] neg_lo:[1,0,0] neg_hi:[1,0,0]
  v_pk_fma_f32 v[56:57], v[88:89], v[246:247], v[56:57] op_sel:[0,1,0] op_sel_hi:[1,1,1] neg_lo:[1,0,0] neg_hi:[1,0,0]
  v_pk_fma_f32 v[58:59], v[90:91], v[246:247], v[58:59] op_sel:[0,1,0] op_sel_hi:[1,1,1] neg_lo:[1,0,0] neg_hi:[1,0,0]
  v_pk_fma_f32 v[60:61], v[92:93], v[246:247], v[60:61] op_sel:[0,1,0] op_sel_hi:[1,1,1] neg_lo:[1,0,0] neg_hi:[1,0,0]
  v_pk_fma_f32 v[62:63], v[94:95], v[246:247], v[62:63] op_sel:[0,1,0] op_sel_hi:[1,1,1] neg_lo:[1,0,0] neg_hi:[1,0,0]
  v_pk_fma_f32 v[64:65], v[88:89], v[248:249], v[64:65] op_sel_hi:[1,0,1] neg_lo:[1,0,0] neg_hi:[1,0,0]
  v_pk_fma_f32 v[66:67], v[90:91], v[248:249], v[66:67] op_sel_hi:[1,0,1] neg_lo:[1,0,0] neg_hi:[1,0,0]
  v_pk_fma_f32 v[68:69], v[92:93], v[248:249], v[68:69] op_sel_hi:[1,0,1] neg_lo:[1,0,0] neg_hi:[1,0,0]
  v_pk_fma_f32 v[70:71], v[94:95], v[248:249], v[70:71] op_sel_hi:[1,0,1] neg_lo:[1,0,0] neg_hi:[1,0,0]
  v_pk_fma_f32 v[72:73], v[88:89], v[248:249], v[72:73] op_sel:[0,1,0] op_sel_hi:[1,1,1] neg_lo:[1,0,0] neg_hi:[1,0,0]
  v_pk_fma_f32 v[74:75], v[90:91], v[248:249], v[74:75] op_sel:[0,1,0] op_sel_hi:[1,1,1] neg_lo:[1,0,0] neg_hi:[1,0,0]
  v_pk_fma_f32 v[76:77], v[92:93], v[248:249], v[76:77] op_sel:[0,1,0] op_sel_hi:[1,1,1] neg_lo:[1,0,0] neg_hi:[1,0,0]
  v_pk_fma_f32 v[78:79], v[94:95], v[248:249], v[78:79] op_sel:[0,1,0] op_sel_hi:[1,1,1] neg_lo:[1,0,0] neg_hi:[1,0,0]
  v_pk_fma_f32 v[80:81], v[88:89], v[250:251], v[80:81] op_sel_hi:[1,0,1] neg_lo:[1,0,0] neg_hi:[1,0,0]
  v_pk_fma_f32 v[82:83], v[90:91], v[250:251], v[82:83] op_sel_hi:[1,0,1] neg_lo:[1,0,0] neg_hi:[1,0,0]
  v_pk_fma_f32 v[84:85], v[92:93], v[250:251], v[84:85] op_sel_hi:[1,0,1] neg_lo:[1,0,0] neg_hi:[1,0,0]
  v_pk_fma_f32 v[86:87], v[94:95], v[250:251], v[86:87] op_sel_hi:[1,0,1] neg_lo:[1,0,0] neg_hi:[1,0,0]
  v_pk_mul_f32 v[48:49], v[48:49], v[96:97]
  v_pk_mul_f32 v[50:51], v[50:51], v[98:99]
  v_pk_mul_f32 v[52:53], v[52:53], v[100:101]
  v_pk_mul_f32 v[54:55], v[54:55], v[102:103]
  v_pk_mul_f32 v[56:57], v[56:57], v[96:97]
  v_pk_mul_f32 v[58:59], v[58:59], v[98:99]
  v_pk_mul_f32 v[60:61], v[60:61], v[100:101]
  v_pk_mul_f32 v[62:63], v[62:63], v[102:103]
  v_pk_mul_f32 v[64:65], v[64:65], v[96:97]
  v_pk_mul_f32 v[66:67], v[66:67], v[98:99]
  v_pk_mul_f32 v[68:69], v[68:69], v[100:101]
  v_pk_mul_f32 v[70:71], v[70:71], v[102:103]
  v_pk_mul_f32 v[72:73], v[72:73], v[96:97]
  v_pk_mul_f32 v[74:75], v[74:75], v[98:99]
  v_pk_mul_f32 v[76:77], v[76:77], v[100:101]
  v_pk_mul_f32 v[78:79], v[78:79], v[102:103]
  v_pk_mul_f32 v[80:81], v[80:81], v[96:97]
  v_pk_mul_f32 v[82:83], v[82:83], v[98:99]
  v_pk_mul_f32 v[84:85], v[84:85], v[100:101]
  v_pk_mul_f32 v[86:87], v[86:87], v[102:103]
  ds_write_b128 v186, v[192:195] offset:0
  s_add_u32 s34, s34, 4096
  buffer_load_dwordx4 a[32:35], v2, s[52:55], s34 offen offset:0 sc1
  v_fmac_f32 v49, v16, v48
  v_fmac_f32 v57, v17, v56
  v_fmac_f32 v65, v18, v64
  v_fmac_f32 v73, v19, v72
  v_fmac_f32_e64 v81, v20, v80
  v_fmac_f32_dpp v49, v48, v21 quad_perm:[1,0,3,2] row_mask:0xf bank_mask:0xf
  v_fmac_f32_dpp v57, v56, v22 quad_perm:[1,0,3,2] row_mask:0xf bank_mask:0xf
  v_fmac_f32_dpp v65, v64, v23 quad_perm:[1,0,3,2] row_mask:0xf bank_mask:0xf
  v_fmac_f32_dpp v73, v72, v24 quad_perm:[1,0,3,2] row_mask:0xf bank_mask:0xf
  v_fmac_f32_dpp v81, v80, v25 quad_perm:[1,0,3,2] row_mask:0xf bank_mask:0xf
  v_alignbit_b32 v204, v204, v192, 16
  v_alignbit_b32 v205, v205, v193, 16
  v_alignbit_b32 v206, v206, v194, 16
  v_alignbit_b32 v207, v207, v195, 16
  ds_write_b128 v186, v[204:207] offset:4160
  ds_write_b128 v186, v[196:199] offset:8320
  buffer_load_dwordx4 a[36:39], v2, s[52:55], s34 offen offset:1024 sc1
  v_fmac_f32 v50, v16, v49
  v_fmac_f32 v58, v17, v57
  v_fmac_f32 v66, v18, v65
  v_fmac_f32 v74, v19, v73
  v_fmac_f32_e64 v82, v20, v81
  v_fmac_f32_dpp v50, v49, v21 quad_perm:[1,0,3,2] row_mask:0xf bank_mask:0xf
  v_fmac_f32_dpp v58, v57, v22 quad_perm:[1,0,3,2] row_mask:0xf bank_mask:0xf
  v_fmac_f32_dpp v66, v65, v23 quad_perm:[1,0,3,2] row_mask:0xf bank_mask:0xf
  v_fmac_f32_dpp v74, v73, v24 quad_perm:[1,0,3,2] row_mask:0xf bank_mask:0xf
  v_fmac_f32_dpp v82, v81, v25 quad_perm:[1,0,3,2] row_mask:0xf bank_mask:0xf
  v_alignbit_b32 v208, v208, v196, 16
  v_alignbit_b32 v209, v209, v197, 16
  v_alignbit_b32 v210, v210, v198, 16
  v_alignbit_b32 v211, v211, v199, 16
  ds_write_b128 v186, v[208:211] offset:12480
  ds_write_b128 v186, v[200:203] offset:16640
  buffer_load_dwordx4 a[40:43], v2, s[52:55], s34 offen offset:2048 sc1
  v_fmac_f32 v51, v16, v50
  v_fmac_f32 v59, v17, v58
  v_fmac_f32 v67, v18, v66
  v_fmac_f32 v75, v19, v74
  v_fmac_f32_e64 v83, v20, v82
  v_fmac_f32_dpp v51, v50, v21 quad_perm:[1,0,3,2] row_mask:0xf bank_mask:0xf
  v_fmac_f32_dpp v59, v58, v22 quad_perm:[1,0,3,2] row_mask:0xf bank_mask:0xf
  v_fmac_f32_dpp v67, v66, v23 quad_perm:[1,0,3,2] row_mask:0xf bank_mask:0xf
  v_fmac_f32_dpp v75, v74, v24 quad_perm:[1,0,3,2] row_mask:0xf bank_mask:0xf
  v_fmac_f32_dpp v83, v82, v25 quad_perm:[1,0,3,2] row_mask:0xf bank_mask:0xf
  v_alignbit_b32 v212, v212, v200, 16
  v_alignbit_b32 v213, v213, v201, 16
  v_alignbit_b32 v214, v214, v202, 16
  v_alignbit_b32 v215, v215, v203, 16
  ds_write_b128 v186, v[212:215] offset:20800
  buffer_load_dwordx4 a[44:47], v2, s[52:55], s34 offen offset:3072 sc1
  v_fmac_f32 v52, v16, v51
  v_fmac_f32 v60, v17, v59
  v_fmac_f32 v68, v18, v67
  v_fmac_f32 v76, v19, v75
  v_fmac_f32_e64 v84, v20, v83
  v_fmac_f32_dpp v52, v51, v21 quad_perm:[1,0,3,2] row_mask:0xf bank_mask:0xf
  v_fmac_f32_dpp v60, v59, v22 quad_perm:[1,0,3,2] row_mask:0xf bank_mask:0xf
  v_fmac_f32_dpp v68, v67, v23 quad_perm:[1,0,3,2] row_mask:0xf bank_mask:0xf
  v_fmac_f32_dpp v76, v75, v24 quad_perm:[1,0,3,2] row_mask:0xf bank_mask:0xf
  v_fmac_f32_dpp v84, v83, v25 quad_perm:[1,0,3,2] row_mask:0xf bank_mask:0xf
  s_cmp_lg_u32 s7, 0
  s_cbranch_scc1 skip_27
  v_mov_b32 v216, 0
  v_mov_b32 v217, 0
  v_mov_b32 v218, 0
  v_mov_b32 v219, 0
  s_mov_b64 exec, 0xfff
  ds_write_b128 v163, v[216:219]
  s_mov_b64 exec, 1
  ds_write_b16 v163, v192 offset:4190
  ds_write_b16 v163, v196 offset:12510
  ds_write_b16 v163, v200 offset:20830
  s_mov_b64 exec, -1
skip_27:
  s_add_u32 s34, s34, 4096
  buffer_load_dwordx4 a[48:51], v2, s[52:55], s34 offen offset:0 sc1
  v_fmac_f32 v53, v16, v52
  v_fmac_f32 v61, v17, v60
  v_fmac_f32 v69, v18, v68
  v_fmac_f32 v77, v19, v76
  v_fmac_f32_e64 v85, v20, v84
  v_fmac_f32_dpp v53, v52, v21 quad_perm:[1,0,3,2] row_mask:0xf bank_mask:0xf
  v_fmac_f32_dpp v61, v60, v22 quad_perm:[1,0,3,2] row_mask:0xf bank_mask:0xf
  v_fmac_f32_dpp v69, v68, v23 quad_perm:[1,0,3,2] row_mask:0xf bank_mask:0xf
  v_fmac_f32_dpp v77, v76, v24 quad_perm:[1,0,3,2] row_mask:0xf bank_mask:0xf
  v_fmac_f32_dpp v85, v84, v25 quad_perm:[1,0,3,2] row_mask:0xf bank_mask:0xf
  ds_write_b64 v228, v[152:153]
  buffer_load_dwordx4 a[52:55], v2, s[52:55], s34 offen offset:1024 sc1
  v_fmac_f32 v54, v16, v53
  v_fmac_f32 v62, v17, v61
  v_fmac_f32 v70, v18, v69
  v_fmac_f32 v78, v19, v77
  v_fmac_f32_e64 v86, v20, v85
  v_fmac_f32_dpp v54, v53, v21 quad_perm:[1,0,3,2] row_mask:0xf bank_mask:0xf
  v_fmac_f32_dpp v62, v61, v22 quad_perm:[1,0,3,2] row_mask:0xf bank_mask:0xf
  v_fmac_f32_dpp v70, v69, v23 quad_perm:[1,0,3,2] row_mask:0xf bank_mask:0xf
  v_fmac_f32_dpp v78, v77, v24 quad_perm:[1,0,3,2] row_mask:0xf bank_mask:0xf
  v_fmac_f32_dpp v86, v85, v25 quad_perm:[1,0,3,2] row_mask:0xf bank_mask:0xf
  buffer_load_dwordx4 a[56:59], v2, s[52:55], s34 offen offset:2048 sc1
  v_fmac_f32 v55, v16, v54
  v_fmac_f32 v63, v17, v62
  v_fmac_f32 v71, v18, v70
  v_fmac_f32 v79, v19, v78
  v_fmac_f32_e64 v87, v20, v86
  v_fmac_f32_dpp v55, v54, v21 quad_perm:[1,0,3,2] row_mask:0xf bank_mask:0xf
  v_fmac_f32_dpp v63, v62, v22 quad_perm:[1,0,3,2] row_mask:0xf bank_mask:0xf
  v_fmac_f32_dpp v71, v70, v23 quad_perm:[1,0,3,2] row_mask:0xf bank_mask:0xf
  v_fmac_f32_dpp v79, v78, v24 quad_perm:[1,0,3,2] row_mask:0xf bank_mask:0xf
  v_fmac_f32_dpp v87, v86, v25 quad_perm:[1,0,3,2] row_mask:0xf bank_mask:0xf
  v_add_u32 v11, 152320, v9
  v_min_u32 v12, 39, v1
  v_mul_u32_u24 v44, 48, v12
  s_lshl_b32 s12, s7, 3
  s_add_u32 s12, s12, 149504
  v_add_u32 v44, s12, v44
  ds_write_b32 v11, v55 offset:0
  ds_write_b32 v11, v63 offset:1152
  ds_write_b32 v11, v71 offset:2304
  ds_write_b32 v11, v79 offset:3456
  ds_write_b32 v11, v87 offset:4608
  v_mul_u32_u24 v46, 144, v12
  v_add_u32 v46, 152320, v46
  s_waitcnt lgkmcnt(0)
  s_barrier
  ds_read_b128 v[90:93], v46 offset:0
  ds_read_b128 v[94:97], v46 offset:16
  ds_read_b128 v[98:101], v46 offset:32
  ds_read_b128 v[102:105], v46 offset:48
  ds_read_b128 v[106:109], v46 offset:64
  ds_read_b128 v[110:113], v46 offset:80
  ds_read_b128 v[114:117], v46 offset:96
  ds_read_b128 v[118:121], v46 offset:112
  s_waitcnt lgkmcnt(7)
  v_pk_fma_f32 v[92:93], v[90:91], v[36:37], v[92:93] op_sel:[1,1,0] op_sel_hi:[0,1,1] neg_lo:[0,1,0]
  v_pk_fma_f32 v[92:93], v[90:91], v[36:37], v[92:93] op_sel:[0,0,0] op_sel_hi:[1,0,1]
  buffer_load_dwordx4 a[60:63], v2, s[52:55], s34 offen offset:3072 sc1
  s_waitcnt lgkmcnt(6)
  v_pk_fma_f32 v[94:95], v[92:93], v[36:37], v[94:95] op_sel:[1,1,0] op_sel_hi:[0,1,1] neg_lo:[0,1,0]
  v_pk_fma_f32 v[94:95], v[92:93], v[36:37], v[94:95] op_sel:[0,0,0] op_sel_hi:[1,0,1]
  v_pk_fma_f32 v[96:97], v[94:95], v[36:37], v[96:97] op_sel:[1,1,0] op_sel_hi:[0,1,1] neg_lo:[0,1,0]
  v_pk_fma_f32 v[96:97], v[94:95], v[36:37], v[96:97] op_sel:[0,0,0] op_sel_hi:[1,0,1]
  s_waitcnt lgkmcnt(5)
  s_add_u32 s34, s34, 4096
  buffer_load_dwordx4 a[64:67], v2, s[52:55], s34 offen offset:0 sc1
  v_pk_fma_f32 v[98:99], v[96:97], v[36:37], v[98:99] op_sel:[1,1,0] op_sel_hi:[0,1,1] neg_lo:[0,1,0]
  v_pk_fma_f32 v[98:99], v[96:97], v[36:37], v[98:99] op_sel:[0,0,0] op_sel_hi:[1,0,1]
  v_pk_fma_f32 v[100:101], v[98:99], v[36:37], v[100:101] op_sel:[1,1,0] op_sel_hi:[0,1,1] neg_lo:[0,1,0]
  v_pk_fma_f32 v[100:101], v[98:99], v[36:37], v[100:101] op_sel:[0,0,0] op_sel_hi:[1,0,1]
  s_waitcnt lgkmcnt(4)
  v_pk_fma_f32 v[102:103], v[100:101], v[36:37], v[102:103] op_sel:[1,1,0] op_sel_hi:[0,1,1] neg_lo:[0,1,0]
  buffer_load_dwordx4 a[68:71], v2, s[52:55], s34 offen offset:1024 sc1
  v_pk_fma_f32 v[102:103], v[100:101], v[36:37], v[102:103] op_sel:[0,0,0] op_sel_hi:[1,0,1]
  v_pk_fma_f32 v[104:105], v[102:103], v[36:37], v[104:105] op_sel:[1,1,0] op_sel_hi:[0,1,1] neg_lo:[0,1,0]
  v_pk_fma_f32 v[104:105], v[102:103], v[36:37], v[104:105] op_sel:[0,0,0] op_sel_hi:[1,0,1]
  s_waitcnt lgkmcnt(3)
  v_pk_fma_f32 v[106:107], v[104:105], v[36:37], v[106:107] op_sel:[1,1,0] op_sel_hi:[0,1,1] neg_lo:[0,1,0]
  v_pk_fma_f32 v[106:107], v[104:105], v[36:37], v[106:107] op_sel:[0,0,0] op_sel_hi:[1,0,1]
  buffer_load_dwordx4 a[72:75], v2, s[52:55], s34 offen offset:2048 sc1
  v_pk_fma_f32 v[108:109], v[106:107], v[36:37], v[108:109] op_sel:[1,1,0] op_sel_hi:[0,1,1] neg_lo:[0,1,0]
  v_pk_fma_f32 v[108:109], v[106:107], v[36:37], v[108:109] op_sel:[0,0,0] op_sel_hi:[1,0,1]
  s_waitcnt lgkmcnt(2)
  v_pk_fma_f32 v[110:111], v[108:109], v[36:37], v[110:111] op_sel:[1,1,0] op_sel_hi:[0,1,1] neg_lo:[0,1,0]
  v_pk_fma_f32 v[110:111], v[108:109], v[36:37], v[110:111] op_sel:[0,0,0] op_sel_hi:[1,0,1]
  v_pk_fma_f32 v[112:113], v[110:111], v[36:37], v[112:113] op_sel:[1,1,0] op_sel_hi:[0,1,1] neg_lo:[0,1,0]
  buffer_load_dwordx4 a[76:79], v2, s[52:55], s34 offen offset:3072 sc1
  v_pk_fma_f32 v[112:113], v[110:111], v[36:37], v[112:113] op_sel:[0,0,0] op_sel_hi:[1,0,1]
  s_waitcnt lgkmcnt(1)
  v_pk_fma_f32 v[114:115], v[112:113], v[36:37], v[114:115] op_sel:[1,1,0] op_sel_hi:[0,1,1] neg_lo:[0,1,0]
  v_pk_fma_f32 v[114:115], v[112:113], v[36:37], v[114:115] op_sel:[0,0,0] op_sel_hi:[1,0,1]
  v_pk_fma_f32 v[116:117], v[114:115], v[36:37], v[116:117] op_sel:[1,1,0] op_sel_hi:[0,1,1] neg_lo:[0,1,0]
  v_pk_fma_f32 v[116:117], v[114:115], v[36:37], v[116:117] op_sel:[0,0,0] op_sel_hi:[1,0,1]
  s_waitcnt lgkmcnt(0)
  v_pk_fma_f32 v[118:119], v[116:117], v[36:37], v[118:119] op_sel:[1,1,0] op_sel_hi:[0,1,1] neg_lo:[0,1,0]
  v_pk_fma_f32 v[118:119], v[116:117], v[36:37], v[118:119] op_sel:[0,0,0] op_sel_hi:[1,0,1]
  v_pk_fma_f32 v[120:121], v[118:119], v[36:37], v[120:121] op_sel:[1,1,0] op_sel_hi:[0,1,1] neg_lo:[0,1,0]
  v_pk_fma_f32 v[120:121], v[118:119], v[36:37], v[120:121] op_sel:[0,0,0] op_sel_hi:[1,0,1]
  v_mov_b32 v122, s8
  v_mov_b32 v123, s8
  s_add_u32 s12, s83, 10240
  s_mov_b64 exec, s[96:97]
  buffer_store_dwordx4 v[120:123], v2, s[52:55], s12 offen sc1
  s_mov_b64 exec, -1
  v_accvgpr_read_b32 v232, a200
  v_accvgpr_read_b32 v236, a201
  v_accvgpr_read_b32 v240, a202
  v_accvgpr_read_b32 v241, a203
  v_add_u32 v233, 1024, v232
  v_add_u32 v234, 2048, v232
  v_add_u32 v235, 3072, v232
  v_add_u32 v237, 1024, v236
  v_add_u32 v238, 2048, v236
  v_add_u32 v239, 3072, v236
  ds_read2_b32 v[156:157], v235 offset0:128 offset1:129
  ds_read2_b32 v[158:159], v235 offset0:130 offset1:131
  ds_read_b128 v[160:163], v240 offset:3584
  ds_read2_b32 v[152:153], v235 offset0:0 offset1:1
  ds_read2_b32 v[154:155], v235 offset0:2 offset1:3
  ds_read_b128 v[164:167], v240 offset:3072
  ds_read2_b32 v[148:149], v234 offset0:128 offset1:129
  ds_read2_b32 v[150:151], v234 offset0:130 offset1:131
  s_waitcnt lgkmcnt(5)
  v_mfma_f32_16x16x32_bf16 v[220:223], v[156:159], v[160:163], 0
  ds_read_b128 v[168:171], v240 offset:2560
  s_waitcnt lgkmcnt(4)
  v_mfma_f32_16x16x32_bf16 v[216:219], v[152:155], v[160:163], 0
  ds_read2_b32 v[144:145], v234 offset0:0 offset1:1
  ds_read2_b32 v[146:147], v234 offset0:2 offset1:3
  s_waitcnt lgkmcnt(5)
  v_mfma_f32_16x16x32_bf16 v[220:223], v[152:155], v[164:167], v[220:223]
  ds_read_b128 v[172:175], v240 offset:2048
  s_waitcnt lgkmcnt(4)
  v_mfma_f32_16x16x32_bf16 v[212:215], v[148:151], v[160:163], 0
  ds_read2_b32 v[140:141], v233 offset0:128 offset1:129
  ds_read2_b32 v[142:143], v233 offset0:130 offset1:131
  v_subrev_u32 v46, 8576, v46
  v_mov_b32 v88, 0
  v_mov_b32 v89, 0
  s_mov_b32 exec_hi, 0xff
  s_cmp_eq_u32 s7, 1
  s_cbranch_scc1 w1_30
  s_cmp_eq_u32 s7, 2
  s_cbranch_scc1 w2_31
  s_cmp_eq_u32 s7, 3
  s_cbranch_scc1 w3_32
w0_29:
  ds_write_b128 v46, v[88:91] offset:0
  ds_write_b128 v46, v[92:95] offset:16
  s_branch join_28
w1_30:
  ds_write_b128 v46, v[96:99] offset:32
  ds_write_b128 v46, v[100:103] offset:48
  s_branch join_28
w2_31:
  ds_write_b128 v46, v[104:107] offset:64
  ds_write_b128 v46, v[108:111] offset:80
  s_branch join_28
w3_32:
  ds_write_b128 v46, v[112:115] offset:96
  ds_write_b128 v46, v[116:119] offset:112
join_28:
  s_mov_b32 exec_hi, -1
  v_add_u32 v46, 143744, v9
  ds_read_b32 v244, v46 offset:0
  s_add_u32 s34, s34, 4096
  buffer_load_dwordx4 a[80:83], v2, s[52:55], s34 offen offset:0 sc1
  s_add_u32 m0, s48, 0
  s_nop 0
  buffer_load_dwordx4 v224, s[68:71], s20 offen lds
  ds_read_b64 a[226:227], v227
  v_mfma_f32_16x16x32_bf16 v[216:219], v[148:151], v[164:167], v[216:219]
  ds_read_b128 v[176:179], v240 offset:1536
  s_waitcnt lgkmcnt(10)
  v_mfma_f32_16x16x32_bf16 v[220:223], v[148:151], v[168:171], v[220:223]
  ds_read2_b32 v[136:137], v233 offset0:0 offset1:1
  ds_read2_b32 v[138:139], v233 offset0:2 offset1:3
  s_waitcnt lgkmcnt(10)
  v_mfma_f32_16x16x32_bf16 v[208:211], v[144:147], v[160:163], 0
  ds_read_b128 v[180:183], v240 offset:1024
  v_mfma_f32_16x16x32_bf16 v[212:215], v[144:147], v[164:167], v[212:215]
  ds_read2_b32 v[132:133], v232 offset0:128 offset1:129
  ds_read2_b32 v[134:135], v232 offset0:130 offset1:131
  ds_read_b32 v246, v46 offset:1152
  ds_read_b32 v248, v46 offset:2304
  ds_read_b32 v250, v46 offset:3456
  s_add_u32 m0, s48, 1024
  s_nop 0
  buffer_load_dwordx4 v225, s[68:71], s20 offen lds
  v_mfma_f32_16x16x32_bf16 v[216:219], v[144:147], v[168:171], v[216:219]
  ds_read_b32 v252, v46 offset:4608
  v_and_b32 v43, 1, v3
  s_waitcnt lgkmcnt(15)
  v_mfma_f32_16x16x32_bf16 v[220:223], v[144:147], v[172:175], v[220:223]
  v_cvt_f32_u32 v43, v43
  s_waitcnt lgkmcnt(14)
  v_mfma_f32_16x16x32_bf16 v[204:207], v[140:143], v[160:163], 0
  buffer_load_dwordx4 a[84:87], v2, s[52:55], s34 offen offset:1024 sc1
  v_mfma_f32_16x16x32_bf16 v[208:211], v[140:143], v[164:167], v[208:211]
  s_add_u32 m0, s48, 2048
  s_mov_b32 exec_hi, 0
  buffer_load_dwordx4 v226, s[68:71], s20 offen lds
  s_mov_b32 exec_hi, -1
  v_mfma_f32_16x16x32_bf16 v[212:215], v[140:143], v[168:171], v[212:215]
  v_fma_f32 v43, 2.0, v43, -1.0
  s_waitcnt lgkmcnt(0)
  s_nop 0
  v_mul_f32_dpp v245, v244, v43 quad_perm:[1,0,3,2] row_mask:0xf bank_mask:0xf
  v_mfma_f32_16x16x32_bf16 v[216:219], v[140:143], v[172:175], v[216:219]
  ds_read_b128 v[184:187], v240 offset:512
  v_mfma_f32_16x16x32_bf16 v[220:223], v[140:143], v[176:179], v[220:223]
  ds_read2_b32 v[128:129], v232 offset0:0 offset1:1
  ds_read2_b32 v[130:131], v232 offset0:2 offset1:3
  v_mfma_f32_16x16x32_bf16 v[200:203], v[136:139], v[160:163], 0
  s_mov_b32 s64, s32
  s_and_b32 s65, s33, 0xffff
  s_mov_b32 s66, 1280
  s_mov_b32 s67, 0x20000
  s_add_u32 m0, s48, 2560
  s_mul_i32 s12, s6, 160
  s_mov_b64 exec, 0x3ff
  buffer_load_dwordx4 v2, s[64:67], s12 offen lds
  s_mov_b64 exec, -1
  v_mov_b32 v228, -1
  v_mov_b32 v229, -1
  v_mov_b32 v230, -1
  v_mov_b32 v231, -1
  v_lshlrev_b32 v11, 3, v1
  buffer_store_dwordx2 v[228:229], v11, s[52:55], s51 offen sc1
  v_mfma_f32_16x16x32_bf16 v[204:207], v[136:139], v[164:167], v[204:207]
  v_mul_f32_dpp v247, v246, v43 quad_perm:[1,0,3,2] row_mask:0xf bank_mask:0xf
  v_mul_f32_dpp v249, v248, v43 quad_perm:[1,0,3,2] row_mask:0xf bank_mask:0xf
  v_mfma_f32_16x16x32_bf16 v[208:211], v[136:139], v[168:171], v[208:211]
  v_mul_f32_dpp v251, v250, v43 quad_perm:[1,0,3,2] row_mask:0xf bank_mask:0xf
  v_mfma_f32_16x16x32_bf16 v[212:215], v[136:139], v[172:175], v[212:215]
  buffer_load_dwordx4 a[88:91], v2, s[52:55], s34 offen offset:2048 sc1
  v_mfma_f32_16x16x32_bf16 v[216:219], v[136:139], v[176:179], v[216:219]
  buffer_store_dwordx4 v[228:231], v2, s[52:55], s50 offen offset:0 sc1
  v_mfma_f32_16x16x32_bf16 v[220:223], v[136:139], v[180:183], v[220:223]
  v_mul_f32_dpp v253, v252, v43 quad_perm:[1,0,3,2] row_mask:0xf bank_mask:0xf
  v_mfma_f32_16x16x32_bf16 v[196:199], v[132:135], v[160:163], 0
  ds_read_b128 v[188:191], v240 offset:0
  v_mfma_f32_16x16x32_bf16 v[200:203], v[132:135], v[164:167], v[200:203]
  ds_read2_b32 v[156:157], v235 offset0:144 offset1:145
  ds_read2_b32 v[158:159], v235 offset0:146 offset1:147
  v_mfma_f32_16x16x32_bf16 v[204:207], v[132:135], v[168:171], v[204:207]
  ds_read2_b32 v[152:153], v235 offset0:16 offset1:17
  ds_read2_b32 v[154:155], v235 offset0:18 offset1:19
  buffer_store_dwordx4 v[228:231], v2, s[52:55], s50 offen offset:1024 sc1
  v_mfma_f32_16x16x32_bf16 v[208:211], v[132:135], v[172:175], v[208:211]
  buffer_load_dwordx4 a[92:95], v2, s[52:55], s34 offen offset:3072 sc1
  v_mfma_f32_16x16x32_bf16 v[212:215], v[132:135], v[176:179], v[212:215]
  ds_read2_b32 v[148:149], v234 offset0:144 offset1:145
  ds_read2_b32 v[150:151], v234 offset0:146 offset1:147
  v_mfma_f32_16x16x32_bf16 v[216:219], v[132:135], v[180:183], v[216:219]
  s_waitcnt lgkmcnt(9)
  v_mfma_f32_16x16x32_bf16 v[220:223], v[132:135], v[184:187], v[220:223]
  s_waitcnt lgkmcnt(7)
  v_mfma_f32_16x16x32_bf16 v[192:195], v[128:131], v[160:163], 0
  ds_read_b128 v[160:163], v240 offset:3648
  v_mfma_f32_16x16x32_bf16 v[196:199], v[128:131], v[164:167], v[196:199]
  ds_read2_b32 v[144:145], v234 offset0:16 offset1:17
  ds_read2_b32 v[146:147], v234 offset0:18 offset1:19
  v_mfma_f32_16x16x32_bf16 v[200:203], v[128:131], v[168:171], v[200:203]
  ds_read_b128 v[164:167], v240 offset:3136
  v_mfma_f32_16x16x32_bf16 v[204:207], v[128:131], v[172:175], v[204:207]
  ds_read_b128 v[168:171], v240 offset:2624
  v_mfma_f32_16x16x32_bf16 v[208:211], v[128:131], v[176:179], v[208:211]
  ds_read_b128 v[172:175], v240 offset:2112
  v_mfma_f32_16x16x32_bf16 v[212:215], v[128:131], v[180:183], v[212:215]
  ds_read2_b32 v[140:141], v233 offset0:144 offset1:145
  ds_read2_b32 v[142:143], v233 offset0:146 offset1:147
  v_mfma_f32_16x16x32_bf16 v[216:219], v[128:131], v[184:187], v[216:219]
  s_add_u32 s34, s34, 4096
  buffer_load_dwordx4 a[96:99], v2, s[52:55], s34 offen offset:0 sc1
  s_waitcnt lgkmcnt(14)
  v_mfma_f32_16x16x32_bf16 v[220:223], v[128:131], v[188:191], v[220:223]
  s_waitcnt lgkmcnt(7)
  v_mfma_f32_16x16x32_bf16 v[220:223], v[156:159], v[160:163], v[220:223]
  ds_read_b128 v[176:179], v240 offset:1600
  v_mfma_f32_16x16x32_bf16 v[216:219], v[152:155], v[160:163], v[216:219]
  ds_read2_b32 v[136:137], v233 offset0:16 offset1:17
  ds_read2_b32 v[138:139], v233 offset0:18 offset1:19
  s_waitcnt lgkmcnt(7)
  v_mfma_f32_16x16x32_bf16 v[220:223], v[152:155], v[164:167], v[220:223]
  v_mfma_f32_16x16x32_bf16 v[212:215], v[148:151], v[160:163], v[212:215]
  v_mfma_f32_16x16x32_bf16 v[216:219], v[148:151], v[164:167], v[216:219]
  buffer_load_dwordx4 a[100:103], v2, s[52:55], s34 offen offset:1024 sc1
  s_waitcnt lgkmcnt(6)
  v_mfma_f32_16x16x32_bf16 v[220:223], v[148:151], v[168:171], v[220:223]
  s_and_b32 vcc_lo, s1, 7
  s_lshl_b32 vcc_lo, vcc_lo, 2
  s_add_u32 vcc_lo, vcc_lo, s7
  s_lshl_b32 vcc_lo, vcc_lo, 11
  v_lshl_add_u32 v15, v3, 7, vcc_lo
  v_min_u32 v15, L_codeend-L_pc-4, v15
  s_mov_b64 exec, 0xffff
  global_load_dword a250, v15, s[98:99]
  s_mov_b64 exec, -1
  v_mfma_f32_16x16x32_bf16 v[208:211], v[144:147], v[160:163], v[208:211]
  ds_read_b128 v[180:183], v240 offset:1088
  v_mfma_f32_16x16x32_bf16 v[212:215], v[144:147], v[164:167], v[212:215]
  ds_read2_b32 v[132:133], v232 offset0:144 offset1:145
  ds_read2_b32 v[134:135], v232 offset0:146 offset1:147
  v_mfma_f32_16x16x32_bf16 v[216:219], v[144:147], v[168:171], v[216:219]
  s_waitcnt lgkmcnt(8)
  v_mfma_f32_16x16x32_bf16 v[220:223], v[144:147], v[172:175], v[220:223]
  s_waitcnt lgkmcnt(6)
  v_mfma_f32_16x16x32_bf16 v[204:207], v[140:143], v[160:163], v[204:207]
  v_mfma_f32_16x16x32_bf16 v[208:211], v[140:143], v[164:167], v[208:211]
  v_mfma_f32_16x16x32_bf16 v[212:215], v[140:143], v[168:171], v[212:215]
  buffer_load_dwordx4 a[104:107], v2, s[52:55], s34 offen offset:2048 sc1
  v_mfma_f32_16x16x32_bf16 v[216:219], v[140:143], v[172:175], v[216:219]
  ds_read_b128 v[184:187], v240 offset:576
  s_waitcnt lgkmcnt(6)
  v_mfma_f32_16x16x32_bf16 v[220:223], v[140:143], v[176:179], v[220:223]
  ds_read2_b32 v[128:129], v232 offset0:16 offset1:17
  ds_read2_b32 v[130:131], v232 offset0:18 offset1:19
  s_waitcnt lgkmcnt(6)
  v_mfma_f32_16x16x32_bf16 v[200:203], v[136:139], v[160:163], v[200:203]
  s_lshl_b32 s12, s1, 2
  s_add_u32 s12, s12, s7
  s_lshl_b32 s12, s12, 9
  s_mul_i32 s13, s0, 327680
  s_add_u32 s12, s12, s13
  s_add_u32 s12, s12, 4456448
  s_lshl_b32 s13, s5, 3
  s_add_u32 s13, s13, s6
  s_lshl_b32 s13, s13, 2
  s_add_u32 s13, s13, s7
  s_lshl_b32 s13, s13, 10
  s_add_u32 s13, s13, 1310720
  v_lshrrev_b32 v11, 3, v1
  v_lshlrev_b32 v11, 20, v11
  v_add_u32 v11, s13, v11
  v_mov_b32 v12, s12
  v_cmp_gt_u32 vcc, 4, v1
  s_nop 1
  v_cndmask_b32 v11, v11, v12, vcc
  v_and_b32 v12, 3, v1
  v_lshl_add_u32 v11, v12, 7, v11
  s_mov_b64 exec, 0x3ff
  buffer_load_dword a250, v11, s[52:55], 0 offen
  s_mov_b64 exec, -1
  v_mfma_f32_16x16x32_bf16 v[204:207], v[136:139], v[164:167], v[204:207]
  v_mfma_f32_16x16x32_bf16 v[208:211], v[136:139], v[168:171], v[208:211]
  v_mfma_f32_16x16x32_bf16 v[212:215], v[136:139], v[172:175], v[212:215]
  v_mfma_f32_16x16x32_bf16 v[216:219], v[136:139], v[176:179], v[216:219]
  s_waitcnt lgkmcnt(5)
  v_mfma_f32_16x16x32_bf16 v[220:223], v[136:139], v[180:183], v[220:223]
  buffer_load_dwordx4 a[108:111], v2, s[52:55], s34 offen offset:3072 sc1
  s_waitcnt lgkmcnt(3)
  v_mfma_f32_16x16x32_bf16 v[196:199], v[132:135], v[160:163], v[196:199]
  ds_read_b128 v[188:191], v240 offset:64
  v_mfma_f32_16x16x32_bf16 v[200:203], v[132:135], v[164:167], v[200:203]
  ds_read2_b32 v[156:157], v235 offset0:160 offset1:161
  ds_read2_b32 v[158:159], v235 offset0:162 offset1:163
  v_mfma_f32_16x16x32_bf16 v[204:207], v[132:135], v[168:171], v[204:207]
  ds_read2_b32 v[152:153], v235 offset0:32 offset1:33
  ds_read2_b32 v[154:155], v235 offset0:34 offset1:35
  s_waitcnt vmcnt(10)
  ds_read_b64 a[216:217], v242 offset:0
  v_mfma_f32_16x16x32_bf16 v[208:211], v[132:135], v[172:175], v[208:211]
  ds_read_b64 a[218:219], v242 offset:32
  v_mfma_f32_16x16x32_bf16 v[212:215], v[132:135], v[176:179], v[212:215]
  ds_read2_b32 v[148:149], v234 offset0:160 offset1:161
  ds_read2_b32 v[150:151], v234 offset0:162 offset1:163
  v_mfma_f32_16x16x32_bf16 v[216:219], v[132:135], v[180:183], v[216:219]
  ds_read_b64 a[220:221], v242 offset:64
  s_waitcnt lgkmcnt(12)
  v_mfma_f32_16x16x32_bf16 v[220:223], v[132:135], v[184:187], v[220:223]
  s_waitcnt lgkmcnt(10)
  v_mfma_f32_16x16x32_bf16 v[192:195], v[128:131], v[160:163], v[192:195]
  ds_read_b128 v[160:163], v240 offset:3712
  v_mfma_f32_16x16x32_bf16 v[196:199], v[128:131], v[164:167], v[196:199]
  ds_read2_b32 v[144:145], v234 offset0:32 offset1:33
  ds_read2_b32 v[146:147], v234 offset0:34 offset1:35
  v_mfma_f32_16x16x32_bf16 v[200:203], v[128:131], v[168:171], v[200:203]
  ds_read_b128 v[164:167], v240 offset:3200
  v_mfma_f32_16x16x32_bf16 v[204:207], v[128:131], v[172:175], v[204:207]
  ds_read_b128 v[168:171], v240 offset:2688
  s_add_u32 s34, s34, 4096
  buffer_load_dwordx4 a[112:115], v2, s[52:55], s34 offen offset:0 sc1
  ds_read_b64 a[222:223], v242 offset:96
  ds_read_b64 a[224:225], v242 offset:128
  v_mfma_f32_16x16x32_bf16 v[208:211], v[128:131], v[176:179], v[208:211]
  ds_read_b128 v[172:175], v240 offset:2176
  v_mfma_f32_16x16x32_bf16 v[212:215], v[128:131], v[180:183], v[212:215]
  ds_read2_b32 v[140:141], v233 offset0:160 offset1:161
  ds_read2_b32 v[142:143], v233 offset0:162 offset1:163
  v_mfma_f32_16x16x32_bf16 v[216:219], v[128:131], v[184:187], v[216:219]
  ds_read_b64 a[230:231], v243 offset:2560
  s_waitcnt lgkmcnt(15)
  v_mfma_f32_16x16x32_bf16 v[220:223], v[128:131], v[188:191], v[220:223]
  ds_read_b64 a[232:233], v243 offset:2592
  s_waitcnt lgkmcnt(11)
  v_mfma_f32_16x16x32_bf16 v[220:223], v[156:159], v[160:163], v[220:223]
  ds_read_b128 v[176:179], v240 offset:1664
  v_mfma_f32_16x16x32_bf16 v[216:219], v[152:155], v[160:163], v[216:219]
  ds_read2_b32 v[136:137], v233 offset0:32 offset1:33
  ds_read2_b32 v[138:139], v233 offset0:34 offset1:35
  s_waitcnt lgkmcnt(11)
  v_mfma_f32_16x16x32_bf16 v[220:223], v[152:155], v[164:167], v[220:223]
  buffer_load_dwordx4 a[116:119], v2, s[52:55], s34 offen offset:1024 sc1
  ds_read_b64 a[234:235], v243 offset:2624
  v_mfma_f32_16x16x32_bf16 v[212:215], v[148:151], v[160:163], v[212:215]
  ds_read_b64 a[236:237], v243 offset:2656
  v_mfma_f32_16x16x32_bf16 v[216:219], v[148:151], v[164:167], v[216:219]
  ds_read_b64 a[238:239], v243 offset:2688
  s_lshl_b32 s90, s7, 2
  s_waitcnt lgkmcnt(13)
  v_mfma_f32_16x16x32_bf16 v[220:223], v[148:151], v[168:171], v[220:223]
  s_sub_u32 s90, 12, s90
  v_mfma_f32_16x16x32_bf16 v[208:211], v[144:147], v[160:163], v[208:211]
  ds_read_b128 v[180:183], v240 offset:1152
  v_mfma_f32_16x16x32_bf16 v[212:215], v[144:147], v[164:167], v[212:215]
  ds_read2_b32 v[132:133], v232 offset0:160 offset1:161
  ds_read2_b32 v[134:135], v232 offset0:162 offset1:163
  s_mul_i32 s90, s90, 640
  s_add_u32 s90, s90, s83
  v_mfma_f32_16x16x32_bf16 v[216:219], v[144:147], v[168:171], v[216:219]
  s_add_u32 s90, s90, 0
  s_waitcnt lgkmcnt(13)
  v_mfma_f32_16x16x32_bf16 v[220:223], v[144:147], v[172:175], v[220:223]
  v_min_u32 v42, 39, v1
  s_waitcnt lgkmcnt(11)
  v_mfma_f32_16x16x32_bf16 v[204:207], v[140:143], v[160:163], v[204:207]
  v_lshlrev_b32 v42, 4, v42
  v_mfma_f32_16x16x32_bf16 v[208:211], v[140:143], v[164:167], v[208:211]
  v_mfma_f32_16x16x32_bf16 v[212:215], v[140:143], v[168:171], v[212:215]
  buffer_load_dwordx3 v[88:90], v42, s[52:55], s90 offen offset:0 sc1
  v_mfma_f32_16x16x32_bf16 v[216:219], v[140:143], v[172:175], v[216:219]
  ds_read_b128 v[184:187], v240 offset:640
  s_waitcnt lgkmcnt(9)
  v_mfma_f32_16x16x32_bf16 v[220:223], v[140:143], v[176:179], v[220:223]
  ds_read2_b32 v[128:129], v232 offset0:32 offset1:33
  ds_read2_b32 v[130:131], v232 offset0:34 offset1:35
  s_waitcnt lgkmcnt(9)
  v_mfma_f32_16x16x32_bf16 v[200:203], v[136:139], v[160:163], v[200:203]
  buffer_load_dwordx3 v[92:94], v42, s[52:55], s90 offen offset:640 sc1
  v_mfma_f32_16x16x32_bf16 v[204:207], v[136:139], v[164:167], v[204:207]
  buffer_load_dwordx3 v[96:98], v42, s[52:55], s90 offen offset:1280 sc1
  v_mfma_f32_16x16x32_bf16 v[208:211], v[136:139], v[168:171], v[208:211]
  buffer_load_dwordx3 v[100:102], v42, s[52:55], s90 offen offset:1920 sc1
  v_mfma_f32_16x16x32_bf16 v[212:215], v[136:139], v[172:175], v[212:215]
  v_mfma_f32_16x16x32_bf16 v[216:219], v[136:139], v[176:179], v[216:219]
  s_waitcnt lgkmcnt(5)
  v_mfma_f32_16x16x32_bf16 v[220:223], v[136:139], v[180:183], v[220:223]
  s_waitcnt lgkmcnt(3)
  v_mfma_f32_16x16x32_bf16 v[196:199], v[132:135], v[160:163], v[196:199]
  ds_read_b128 v[188:191], v240 offset:128
  v_mfma_f32_16x16x32_bf16 v[200:203], v[132:135], v[164:167], v[200:203]
  v_mfma_f32_16x16x32_bf16 v[204:207], v[132:135], v[168:171], v[204:207]
  v_mfma_f32_16x16x32_bf16 v[208:211], v[132:135], v[172:175], v[208:211]
  v_mfma_f32_16x16x32_bf16 v[212:215], v[132:135], v[176:179], v[212:215]
  v_mfma_f32_16x16x32_bf16 v[216:219], v[132:135], v[180:183], v[216:219]
  s_waitcnt lgkmcnt(3)
  v_mfma_f32_16x16x32_bf16 v[220:223], v[132:135], v[184:187], v[220:223]
  s_waitcnt lgkmcnt(1)
  v_mfma_f32_16x16x32_bf16 v[192:195], v[128:131], v[160:163], v[192:195]
  v_mfma_f32_16x16x32_bf16 v[196:199], v[128:131], v[164:167], v[196:199]
  v_mfma_f32_16x16x32_bf16 v[200:203], v[128:131], v[168:171], v[200:203]
  v_mfma_f32_16x16x32_bf16 v[204:207], v[128:131], v[172:175], v[204:207]
  v_mfma_f32_16x16x32_bf16 v[208:211], v[128:131], v[176:179], v[208:211]
  v_mfma_f32_16x16x32_bf16 v[212:215], v[128:131], v[180:183], v[212:215]
  v_mfma_f32_16x16x32_bf16 v[216:219], v[128:131], v[184:187], v[216:219]
  s_waitcnt lgkmcnt(0)
  v_mfma_f32_16x16x32_bf16 v[220:223], v[128:131], v[188:191], v[220:223]
  v_lshrrev_b32 v11, 1, v3
  v_mul_u32_u24 v12, 80, v11
  v_add_u32 v12, 160640, v12
  v_mul_u32_u24_e64 v11, 48, v11
  v_add_u32 v11, 149504, v11
  ds_read_b128 v[128:131], v12 offset:0
  ds_read_b128 v[132:135], v12 offset:16
  ds_read_b128 v[136:139], v12 offset:32
  ds_read_b128 v[140:143], v12 offset:48
  ds_read_b128 v[144:147], v12 offset:640
  ds_read_b128 v[148:151], v12 offset:656
  ds_read_b128 v[152:155], v12 offset:672
  ds_read_b128 v[156:159], v12 offset:688
  ds_read_b128 v[160:163], v12 offset:1280
  ds_read_b128 v[164:167], v12 offset:1296
  ds_read_b128 v[168:171], v12 offset:1312
  ds_read_b128 v[172:175], v12 offset:1328
  ds_read_b128 v[176:179], v12 offset:1920
  ds_read_b128 v[180:183], v12 offset:1936
  ds_read_b128 v[184:187], v12 offset:1952
  ds_read_b128 v[188:191], v12 offset:1968
  ds_read_b128 v[104:107], v12 offset:2560
  ds_read_b128 v[108:111], v12 offset:2576
  ds_read_b128 v[112:115], v12 offset:2592
  ds_read_b128 v[116:119], v12 offset:2608
  v_accvgpr_read_b32 v254, a240
  v_accvgpr_read_b32 v255, a241
  v_accvgpr_read_b32 v47, a242
  s_waitcnt vmcnt(0)
  v_min3_u32 v14, v90, v94, s8
  v_max3_u32 v15, v90, v94, s8
  v_min3_u32 v14, v14, v98, v102
  v_max3_u32 v15, v15, v98, v102
  v_cmp_ne_u32 vcc, v14, v15
  s_cbranch_vccz ok_34
again_33:
  buffer_load_dwordx3 v[88:90], v42, s[52:55], s90 offen offset:0 sc1
  buffer_load_dwordx3 v[92:94], v42, s[52:55], s90 offen offset:640 sc1
  buffer_load_dwordx3 v[96:98], v42, s[52:55], s90 offen offset:1280 sc1
  buffer_load_dwordx3 v[100:102], v42, s[52:55], s90 offen offset:1920 sc1
  s_sub_u32 s10, s10, 1
  s_cmp_gt_i32 s10, 0
  s_waitcnt vmcnt(0)
  v_min3_u32 v14, v90, v94, s8
  v_max3_u32 v15, v90, v94, s8
  v_min3_u32 v14, v14, v98, v102
  v_max3_u32 v15, v15, v98, v102
  v_cmp_ne_u32 vcc, v14, v15
  s_cbranch_scc0 out_35
  s_cbranch_vccnz again_33
out_35:
ok_34:
  v_pk_fma_f32 v[92:93], v[88:89], v[38:39], v[92:93] op_sel:[1,1,0] op_sel_hi:[0,1,1] neg_lo:[0,1,0]
  v_pk_fma_f32 v[92:93], v[88:89], v[38:39], v[92:93] op_sel:[0,0,0] op_sel_hi:[1,0,1]
  v_pk_fma_f32 v[96:97], v[92:93], v[38:39], v[96:97] op_sel:[1,1,0] op_sel_hi:[0,1,1] neg_lo:[0,1,0]
  v_pk_fma_f32 v[96:97], v[92:93], v[38:39], v[96:97] op_sel:[0,0,0] op_sel_hi:[1,0,1]
  v_pk_fma_f32 v[100:101], v[96:97], v[38:39], v[100:101] op_sel:[1,1,0] op_sel_hi:[0,1,1] neg_lo:[0,1,0]
  v_pk_fma_f32 v[100:101], v[96:97], v[38:39], v[100:101] op_sel:[0,0,0] op_sel_hi:[1,0,1]
  v_pk_mul_f32 v[88:89], v[100:101], v[40:41] op_sel:[1,1] op_sel_hi:[0,1] neg_lo:[0,1]
  v_pk_fma_f32 v[88:89], v[100:101], v[40:41], v[88:89] op_sel:[0,0,0] op_sel_hi:[1,0,1]
  buffer_load_dwordx4 a[120:123], v2, s[52:55], s34 offen offset:2048 sc1
  s_mov_b32 exec_hi, 0xff
  ds_write_b64 v44, v[88:89]
  s_mov_b32 exec_hi, -1
  s_waitcnt lgkmcnt(0)
  s_barrier
  ds_read_b128 v[88:91], v11 offset:0
  ds_read_b128 v[92:95], v11 offset:16
  ds_read_b128 v[96:99], v11 offset:384
  ds_read_b128 v[100:103], v11 offset:400
  ds_read_b128 v[224:227], v11 offset:768
  ds_read_b128 v[228:231], v11 offset:784
  buffer_load_dwordx4 a[124:127], v2, s[52:55], s34 offen offset:3072 sc1
  s_waitcnt lgkmcnt(4)
  v_pk_add_f32 v[88:89], v[88:89], v[90:91]
  v_pk_add_f32 v[92:93], v[92:93], v[94:95]
  v_pk_add_f32 v[88:89], v[88:89], v[92:93]
  v_pk_fma_f32 v[244:245], v[26:27], v[88:89], v[244:245] op_sel:[0,0,0] op_sel_hi:[1,0,1]
  v_pk_fma_f32 v[244:245], v[26:27], v[88:89], v[244:245] op_sel:[1,1,0] op_sel_hi:[0,1,1] neg_hi:[1,0,0]
  ds_read_b128 v[88:91], v11 offset:1152
  ds_read_b128 v[92:95], v11 offset:1168
  s_waitcnt lgkmcnt(4)
  v_pk_add_f32 v[96:97], v[96:97], v[98:99]
  v_pk_add_f32 v[100:101], v[100:101], v[102:103]
  v_pk_add_f32 v[96:97], v[96:97], v[100:101]
  v_pk_fma_f32 v[246:247], v[28:29], v[96:97], v[246:247] op_sel:[0,0,0] op_sel_hi:[1,0,1]
  v_pk_fma_f32 v[246:247], v[28:29], v[96:97], v[246:247] op_sel:[1,1,0] op_sel_hi:[0,1,1] neg_hi:[1,0,0]
  ds_read_b128 v[96:99], v11 offset:1536
  ds_read_b128 v[100:103], v11 offset:1552
  v_pk_fma_f32 v[48:49], v[128:129], v[244:245], v[48:49] op_sel:[0,0,0] op_sel_hi:[1,0,1]
  v_pk_fma_f32 v[50:51], v[130:131], v[244:245], v[50:51] op_sel:[0,0,0] op_sel_hi:[1,0,1]
  v_pk_fma_f32 v[52:53], v[132:133], v[244:245], v[52:53] op_sel:[0,0,0] op_sel_hi:[1,0,1]
  v_pk_fma_f32 v[54:55], v[134:135], v[244:245], v[54:55] op_sel:[0,0,0] op_sel_hi:[1,0,1]
  s_add_u32 s34, s34, 4096
  buffer_load_dwordx4 a[128:131], v2, s[52:55], s34 offen offset:0 sc1
  v_pk_fma_f32 v[48:49], v[136:137], v[244:245], v[48:49] op_sel:[0,1,0] op_sel_hi:[1,1,1]
  v_pk_fma_f32 v[50:51], v[138:139], v[244:245], v[50:51] op_sel:[0,1,0] op_sel_hi:[1,1,1]
  v_pk_fma_f32 v[52:53], v[140:141], v[244:245], v[52:53] op_sel:[0,1,0] op_sel_hi:[1,1,1]
  v_pk_fma_f32 v[54:55], v[142:143], v[244:245], v[54:55] op_sel:[0,1,0] op_sel_hi:[1,1,1]
  v_cvt_pk_bf16_f32 v120, v48, v49
  v_cvt_pk_bf16_f32 v121, v50, v51
  v_cvt_pk_bf16_f32 v122, v52, v53
  v_cvt_pk_bf16_f32 v123, v54, v55
  ds_write_b128 v254, v[120:123]
  buffer_load_dwordx4 a[132:135], v2, s[52:55], s34 offen offset:1024 sc1
  ds_read_b64_tr_b16 v[52:53], v255
  ds_read_b64_tr_b16 v[54:55], v255 offset:640
  s_waitcnt lgkmcnt(7)
  v_pk_add_f32 v[224:225], v[224:225], v[226:227]
  v_pk_add_f32 v[228:229], v[228:229], v[230:231]
  v_pk_add_f32 v[224:225], v[224:225], v[228:229]
  v_pk_fma_f32 v[248:249], v[30:31], v[224:225], v[248:249] op_sel:[0,0,0] op_sel_hi:[1,0,1]
  v_pk_fma_f32 v[248:249], v[30:31], v[224:225], v[248:249] op_sel:[1,1,0] op_sel_hi:[0,1,1] neg_hi:[1,0,0]
  s_lshr_b32 s12, s85, 2
  s_add_u32 s12, s12, 24576
  v_mov_b32 v15, s8
  s_and_b32 exec_lo, s96, 1
  s_mov_b32 exec_hi, 0
  buffer_store_dword v15, off, s[52:55], s12 sc1
  s_mov_b64 exec, -1
  v_pk_fma_f32 v[56:57], v[144:145], v[246:247], v[56:57] op_sel:[0,0,0] op_sel_hi:[1,0,1]
  v_pk_fma_f32 v[58:59], v[146:147], v[246:247], v[58:59] op_sel:[0,0,0] op_sel_hi:[1,0,1]
  v_pk_fma_f32 v[60:61], v[148:149], v[246:247], v[60:61] op_sel:[0,0,0] op_sel_hi:[1,0,1]
  v_pk_fma_f32 v[62:63], v[150:151], v[246:247], v[62:63] op_sel:[0,0,0] op_sel_hi:[1,0,1]
  buffer_load_dwordx4 a[136:139], v2, s[52:55], s34 offen offset:2048 sc1
  v_pk_fma_f32 v[56:57], v[152:153], v[246:247], v[56:57] op_sel:[0,1,0] op_sel_hi:[1,1,1]
  v_pk_fma_f32 v[58:59], v[154:155], v[246:247], v[58:59] op_sel:[0,1,0] op_sel_hi:[1,1,1]
  v_pk_fma_f32 v[60:61], v[156:157], v[246:247], v[60:61] op_sel:[0,1,0] op_sel_hi:[1,1,1]
  v_pk_fma_f32 v[62:63], v[158:159], v[246:247], v[62:63] op_sel:[0,1,0] op_sel_hi:[1,1,1]
  v_cvt_pk_bf16_f32 v124, v56, v57
  v_cvt_pk_bf16_f32 v125, v58, v59
  v_cvt_pk_bf16_f32 v126, v60, v61
  v_cvt_pk_bf16_f32 v127, v62, v63
  ds_write_b128 v254, v[124:127]
  buffer_load_dwordx4 a[140:143], v2, s[52:55], s34 offen offset:3072 sc1
  ds_read_b64_tr_b16 v[60:61], v255
  ds_read_b64_tr_b16 v[62:63], v255 offset:640
  s_waitcnt lgkmcnt(8)
  v_pk_add_f32 v[88:89], v[88:89], v[90:91]
  v_pk_add_f32 v[92:93], v[92:93], v[94:95]
  v_pk_add_f32 v[88:89], v[88:89], v[92:93]
  v_pk_fma_f32 v[250:251], v[32:33], v[88:89], v[250:251] op_sel:[0,0,0] op_sel_hi:[1,0,1]
  v_pk_fma_f32 v[250:251], v[32:33], v[88:89], v[250:251] op_sel:[1,1,0] op_sel_hi:[0,1,1] neg_hi:[1,0,0]
  s_add_u32 s13, s78, 10485760
  s_waitcnt lgkmcnt(3)
  buffer_store_dwordx4 v[52:55], v47, s[52:55], s13 offen sc1
  v_pk_fma_f32 v[64:65], v[160:161], v[248:249], v[64:65] op_sel:[0,0,0] op_sel_hi:[1,0,1]
  v_pk_fma_f32 v[66:67], v[162:163], v[248:249], v[66:67] op_sel:[0,0,0] op_sel_hi:[1,0,1]
  v_pk_fma_f32 v[68:69], v[164:165], v[248:249], v[68:69] op_sel:[0,0,0] op_sel_hi:[1,0,1]
  v_pk_fma_f32 v[70:71], v[166:167], v[248:249], v[70:71] op_sel:[0,0,0] op_sel_hi:[1,0,1]
  s_add_u32 s34, s34, 4096
  buffer_load_dwordx4 a[144:147], v2, s[52:55], s34 offen offset:0 sc1
  v_pk_fma_f32 v[64:65], v[168:169], v[248:249], v[64:65] op_sel:[0,1,0] op_sel_hi:[1,1,1]
  v_pk_fma_f32 v[66:67], v[170:171], v[248:249], v[66:67] op_sel:[0,1,0] op_sel_hi:[1,1,1]
  v_pk_fma_f32 v[68:69], v[172:173], v[248:249], v[68:69] op_sel:[0,1,0] op_sel_hi:[1,1,1]
  v_pk_fma_f32 v[70:71], v[174:175], v[248:249], v[70:71] op_sel:[0,1,0] op_sel_hi:[1,1,1]
  v_cvt_pk_bf16_f32 v120, v64, v65
  v_cvt_pk_bf16_f32 v121, v66, v67
  v_cvt_pk_bf16_f32 v122, v68, v69
  v_cvt_pk_bf16_f32 v123, v70, v71
  ds_write_b128 v254, v[120:123]
  buffer_load_dwordx4 a[148:151], v2, s[52:55], s34 offen offset:1024 sc1
  ds_read_b64_tr_b16 v[68:69], v255
  ds_read_b64_tr_b16 v[70:71], v255 offset:640
  v_pk_add_f32 v[96:97], v[96:97], v[98:99]
  v_pk_add_f32 v[100:101], v[100:101], v[102:103]
  v_pk_add_f32 v[96:97], v[96:97], v[100:101]
  v_pk_fma_f32 v[252:253], v[34:35], v[96:97], v[252:253] op_sel:[0,0,0] op_sel_hi:[1,0,1]
  v_pk_fma_f32 v[252:253], v[34:35], v[96:97], v[252:253] op_sel:[1,1,0] op_sel_hi:[0,1,1] neg_hi:[1,0,0]
  v_pk_fma_f32 v[72:73], v[176:177], v[250:251], v[72:73] op_sel:[0,0,0] op_sel_hi:[1,0,1]
  v_pk_fma_f32 v[74:75], v[178:179], v[250:251], v[74:75] op_sel:[0,0,0] op_sel_hi:[1,0,1]
  v_pk_fma_f32 v[76:77], v[180:181], v[250:251], v[76:77] op_sel:[0,0,0] op_sel_hi:[1,0,1]
  v_pk_fma_f32 v[78:79], v[182:183], v[250:251], v[78:79] op_sel:[0,0,0] op_sel_hi:[1,0,1]
  buffer_load_dwordx4 a[152:155], v2, s[52:55], s34 offen offset:2048 sc1
  v_pk_fma_f32 v[72:73], v[184:185], v[250:251], v[72:73] op_sel:[0,1,0] op_sel_hi:[1,1,1]
  v_pk_fma_f32 v[74:75], v[186:187], v[250:251], v[74:75] op_sel:[0,1,0] op_sel_hi:[1,1,1]
  v_pk_fma_f32 v[76:77], v[188:189], v[250:251], v[76:77] op_sel:[0,1,0] op_sel_hi:[1,1,1]
  v_pk_fma_f32 v[78:79], v[190:191], v[250:251], v[78:79] op_sel:[0,1,0] op_sel_hi:[1,1,1]
  v_cvt_pk_bf16_f32 v124, v72, v73
  v_cvt_pk_bf16_f32 v125, v74, v75
  v_cvt_pk_bf16_f32 v126, v76, v77
  v_cvt_pk_bf16_f32 v127, v78, v79
  ds_write_b128 v254, v[124:127]
  buffer_load_dwordx4 a[156:159], v2, s[52:55], s34 offen offset:3072 sc1
  ds_read_b64_tr_b16 v[76:77], v255
  ds_read_b64_tr_b16 v[78:79], v255 offset:640
  v_pk_fma_f32 v[80:81], v[104:105], v[252:253], v[80:81] op_sel:[0,0,0] op_sel_hi:[1,0,1]
  v_pk_fma_f32 v[82:83], v[106:107], v[252:253], v[82:83] op_sel:[0,0,0] op_sel_hi:[1,0,1]
  v_pk_fma_f32 v[84:85], v[108:109], v[252:253], v[84:85] op_sel:[0,0,0] op_sel_hi:[1,0,1]
  v_pk_fma_f32 v[86:87], v[110:111], v[252:253], v[86:87] op_sel:[0,0,0] op_sel_hi:[1,0,1]
  s_add_u32 s34, s34, 4096
  buffer_load_dwordx4 a[160:163], v2, s[52:55], s34 offen offset:0 sc1
  v_pk_fma_f32 v[80:81], v[112:113], v[252:253], v[80:81] op_sel:[0,1,0] op_sel_hi:[1,1,1]
  v_pk_fma_f32 v[82:83], v[114:115], v[252:253], v[82:83] op_sel:[0,1,0] op_sel_hi:[1,1,1]
  v_pk_fma_f32 v[84:85], v[116:117], v[252:253], v[84:85] op_sel:[0,1,0] op_sel_hi:[1,1,1]
  v_pk_fma_f32 v[86:87], v[118:119], v[252:253], v[86:87] op_sel:[0,1,0] op_sel_hi:[1,1,1]
  v_cvt_pk_bf16_f32 v120, v80, v81
  v_cvt_pk_bf16_f32 v121, v82, v83
  v_cvt_pk_bf16_f32 v122, v84, v85
  v_cvt_pk_bf16_f32 v123, v86, v87
  ds_write_b128 v254, v[120:123]
  buffer_load_dwordx4 a[164:167], v2, s[52:55], s34 offen offset:1024 sc1
  ds_read_b64_tr_b16 v[84:85], v255
  ds_read_b64_tr_b16 v[86:87], v255 offset:640
  v_accvgpr_read_b32 v246, a204
  v_accvgpr_read_b32 v247, a205
  v_accvgpr_read_b32 v248, a206
  v_accvgpr_read_b32 v249, a207
  v_accvgpr_read_b32 v250, a208
  v_accvgpr_read_b32 v251, a209
  v_accvgpr_read_b32 v252, a210
  v_accvgpr_read_b32 v44, a211
  v_accvgpr_read_b32 v45, a212
  v_accvgpr_read_b32 v46, a213
  v_accvgpr_read_b32 v244, a214
  ds_read_b64 v[88:89], v247 offset:1536
  ds_read_b64 v[90:91], v247 offset:1024
  ds_read_b64 v[92:93], v247 offset:512
  ds_read_b64 v[94:95], v247 offset:0
  ds_read_b64 v[96:97], v248
  s_waitcnt lgkmcnt(5)
  s_bitcmp1_b32 s1, 0
  s_cbranch_scc1 type_36
  ds_read2_b32 v[156:157], v235 offset0:176 offset1:177
  ds_read2_b32 v[158:159], v235 offset0:178 offset1:179
  ds_read_b128 v[160:163], v240 offset:3776
  ds_read2_b32 v[152:153], v235 offset0:48 offset1:49
  ds_read2_b32 v[154:155], v235 offset0:50 offset1:51
  ds_read_b128 v[164:167], v240 offset:3264
  ds_read2_b32 v[148:149], v234 offset0:176 offset1:177
  ds_read2_b32 v[150:151], v234 offset0:178 offset1:179
  s_waitcnt lgkmcnt(5)
  v_mfma_f32_16x16x32_bf16 v[220:223], v[156:159], v[160:163], v[220:223]
  ds_read_b128 v[168:171], v240 offset:2752
  s_waitcnt lgkmcnt(4)
  v_mfma_f32_16x16x32_bf16 v[216:219], v[152:155], v[160:163], v[216:219]
  ds_read2_b32 v[144:145], v234 offset0:48 offset1:49
  ds_read2_b32 v[146:147], v234 offset0:50 offset1:51
  s_waitcnt lgkmcnt(5)
  v_mfma_f32_16x16x32_bf16 v[220:223], v[152:155], v[164:167], v[220:223]
  ds_read_b128 v[172:175], v240 offset:2240
  s_waitcnt lgkmcnt(4)
  v_mfma_f32_16x16x32_bf16 v[212:215], v[148:151], v[160:163], v[212:215]
  ds_read2_b32 v[140:141], v233 offset0:176 offset1:177
  ds_read2_b32 v[142:143], v233 offset0:178 offset1:179
  s_add_u32 s13, s79, 10485760
  buffer_store_dwordx4 v[60:63], v47, s[52:55], s13 offen sc1
  v_mfma_f32_16x16x32_bf16 v[216:219], v[148:151], v[164:167], v[216:219]
  ds_read_b128 v[176:179], v240 offset:1728
  s_waitcnt lgkmcnt(6)
  v_mfma_f32_16x16x32_bf16 v[220:223], v[148:151], v[168:171], v[220:223]
  ds_read2_b32 v[136:137], v233 offset0:48 offset1:49
  ds_read2_b32 v[138:139], v233 offset0:50 offset1:51
  s_waitcnt lgkmcnt(6)
  v_mfma_f32_16x16x32_bf16 v[208:211], v[144:147], v[160:163], v[208:211]
  ds_read_b128 v[180:183], v240 offset:1216
  v_mfma_f32_16x16x32_bf16 v[212:215], v[144:147], v[164:167], v[212:215]
  ds_read2_b32 v[132:133], v232 offset0:176 offset1:177
  ds_read2_b32 v[134:135], v232 offset0:178 offset1:179
  s_add_u32 s13, s80, 10485760
  buffer_store_dwordx4 v[68:71], v47, s[52:55], s13 offen sc1
  v_mfma_f32_16x16x32_bf16 v[216:219], v[144:147], v[168:171], v[216:219]
  s_waitcnt lgkmcnt(8)
  v_mfma_f32_16x16x32_bf16 v[220:223], v[144:147], v[172:175], v[220:223]
  s_waitcnt lgkmcnt(6)
  v_mfma_f32_16x16x32_bf16 v[204:207], v[140:143], v[160:163], v[204:207]
  v_mfma_f32_16x16x32_bf16 v[208:211], v[140:143], v[164:167], v[208:211]
  v_mfma_f32_16x16x32_bf16 v[212:215], v[140:143], v[168:171], v[212:215]
  s_add_u32 s13, s81, 10485760
  buffer_store_dwordx4 v[76:79], v47, s[52:55], s13 offen sc1
  v_mfma_f32_16x16x32_bf16 v[216:219], v[140:143], v[172:175], v[216:219]
  ds_read_b128 v[184:187], v240 offset:704
  s_waitcnt lgkmcnt(6)
  v_mfma_f32_16x16x32_bf16 v[220:223], v[140:143], v[176:179], v[220:223]
  ds_read2_b32 v[128:129], v232 offset0:48 offset1:49
  ds_read2_b32 v[130:131], v232 offset0:50 offset1:51
  s_waitcnt lgkmcnt(6)
  v_mfma_f32_16x16x32_bf16 v[200:203], v[136:139], v[160:163], v[200:203]
  v_mfma_f32_16x16x32_bf16 v[204:207], v[136:139], v[164:167], v[204:207]
  s_add_u32 s13, s82, 10485760
  buffer_store_dwordx4 v[84:87], v47, s[52:55], s13 offen sc1
  v_mfma_f32_16x16x32_bf16 v[208:211], v[136:139], v[168:171], v[208:211]
  v_mfma_f32_16x16x32_bf16 v[212:215], v[136:139], v[172:175], v[212:215]
  v_mfma_f32_16x16x32_bf16 v[216:219], v[136:139], v[176:179], v[216:219]
  s_waitcnt lgkmcnt(5)
  v_mfma_f32_16x16x32_bf16 v[220:223], v[136:139], v[180:183], v[220:223]
  s_waitcnt lgkmcnt(3)
  v_mfma_f32_16x16x32_bf16 v[196:199], v[132:135], v[160:163], v[196:199]
  ds_read_b128 v[188:191], v240 offset:192
  v_mfma_f32_16x16x32_bf16 v[200:203], v[132:135], v[164:167], v[200:203]
  ds_read2_b32 v[156:157], v239 offset0:128 offset1:129
  ds_read2_b32 v[158:159], v239 offset0:130 offset1:131
  v_mfma_f32_16x16x32_bf16 v[204:207], v[132:135], v[168:171], v[204:207]
  ds_read2_b32 v[152:153], v239 offset0:0 offset1:1
  ds_read2_b32 v[154:155], v239 offset0:2 offset1:3
  v_mfma_f32_16x16x32_bf16 v[208:211], v[132:135], v[172:175], v[208:211]
  ds_read2_b32 v[148:149], v238 offset0:128 offset1:129
  ds_read2_b32 v[150:151], v238 offset0:130 offset1:131
  v_mfma_f32_16x16x32_bf16 v[212:215], v[132:135], v[176:179], v[212:215]
  ds_read2_b32 v[144:145], v238 offset0:0 offset1:1
  ds_read2_b32 v[146:147], v238 offset0:2 offset1:3
  v_mfma_f32_16x16x32_bf16 v[216:219], v[132:135], v[180:183], v[216:219]
  buffer_load_dwordx4 a[168:171], v2, s[52:55], s34 offen offset:2048 sc1
  s_waitcnt lgkmcnt(11)
  v_mfma_f32_16x16x32_bf16 v[220:223], v[132:135], v[184:187], v[220:223]
  ds_read2_b32 v[140:141], v237 offset0:128 offset1:129
  ds_read2_b32 v[142:143], v237 offset0:130 offset1:131
  s_waitcnt lgkmcnt(11)
  v_mfma_f32_16x16x32_bf16 v[192:195], v[128:131], v[160:163], v[192:195]
  ds_read_b128 v[160:163], v241 offset:3584
  v_mfma_f32_16x16x32_bf16 v[196:199], v[128:131], v[164:167], v[196:199]
  ds_read_b128 v[164:167], v241 offset:3072
  v_mfma_f32_16x16x32_bf16 v[200:203], v[128:131], v[168:171], v[200:203]
  ds_read2_b32 v[136:137], v237 offset0:0 offset1:1
  ds_read2_b32 v[138:139], v237 offset0:2 offset1:3
  v_mfma_f32_16x16x32_bf16 v[204:207], v[128:131], v[172:175], v[204:207]
  ds_read_b128 v[168:171], v241 offset:2560
  buffer_load_dwordx4 a[172:175], v2, s[52:55], s34 offen offset:3072 sc1
  v_mfma_f32_16x16x32_bf16 v[208:211], v[128:131], v[176:179], v[208:211]
  ds_read_b128 v[172:175], v241 offset:2048
  v_mfma_f32_16x16x32_bf16 v[212:215], v[128:131], v[180:183], v[212:215]
  ds_read_b128 v[176:179], v241 offset:1536
  v_mfma_f32_16x16x32_bf16 v[216:219], v[128:131], v[184:187], v[216:219]
  ds_read2_b32 v[132:133], v236 offset0:128 offset1:129
  ds_read2_b32 v[134:135], v236 offset0:130 offset1:131
  s_waitcnt lgkmcnt(15)
  v_mfma_f32_16x16x32_bf16 v[220:223], v[128:131], v[188:191], v[220:223]
  ds_read_b128 v[180:183], v241 offset:1024
  s_add_u32 s34, s34, 4096
  buffer_load_dwordx4 a[176:179], v2, s[52:55], s34 offen offset:0 sc1
  s_waitcnt lgkmcnt(9)
  v_mfma_f32_16x16x32_bf16 v[116:119], v[156:159], v[160:163], 0
  ds_read_b128 v[184:187], v241 offset:512
  s_waitcnt lgkmcnt(9)
  v_mfma_f32_16x16x32_bf16 v[116:119], v[152:155], v[164:167], v[116:119]
  ds_read2_b32 v[128:129], v236 offset0:0 offset1:1
  ds_read2_b32 v[130:131], v236 offset0:2 offset1:3
  s_waitcnt lgkmcnt(8)
  v_mfma_f32_16x16x32_bf16 v[116:119], v[148:151], v[168:171], v[116:119]
  v_mfma_f32_16x16x32_bf16 v[112:115], v[144:147], v[160:163], 0
  ds_read_b128 v[188:191], v241 offset:0
  s_waitcnt lgkmcnt(8)
  v_mfma_f32_16x16x32_bf16 v[116:119], v[144:147], v[172:175], v[116:119]
  ds_read2_b32 v[156:157], v239 offset0:144 offset1:145
  ds_read2_b32 v[158:159], v239 offset0:146 offset1:147
  v_mfma_f32_16x16x32_bf16 v[112:115], v[140:143], v[164:167], v[112:115]
  ds_read2_b32 v[152:153], v239 offset0:16 offset1:17
  ds_read2_b32 v[154:155], v239 offset0:18 offset1:19
  s_waitcnt lgkmcnt(11)
  v_mfma_f32_16x16x32_bf16 v[116:119], v[140:143], v[176:179], v[116:119]
  ds_read2_b32 v[148:149], v238 offset0:144 offset1:145
  ds_read2_b32 v[150:151], v238 offset0:146 offset1:147
  v_mfma_f32_16x16x32_bf16 v[108:111], v[136:139], v[160:163], 0
  ds_read2_b32 v[144:145], v238 offset0:16 offset1:17
  ds_read2_b32 v[146:147], v238 offset0:18 offset1:19
  buffer_load_dwordx4 a[180:183], v2, s[52:55], s34 offen offset:1024 sc1
  s_waitcnt vmcnt(4)
  s_add_u32 s14, s84, 12288
  v_mov_b32 v15, s8
  s_mov_b64 exec, 1
  s_cmp_eq_u32 s9, 0
  s_cbranch_scc1 slow_38
  buffer_store_dword v15, off, s[52:55], s14
back_39:
  s_mov_b64 exec, -1
  s_bitcmp0_b32 s7, 0
  s_cbranch_scc1 skip_40
  v_swap_b32 v192, v208
  v_swap_b32 v193, v209
  v_swap_b32 v194, v210
  v_swap_b32 v195, v211
  v_swap_b32 v196, v212
  v_swap_b32 v197, v213
  v_swap_b32 v198, v214
  v_swap_b32 v199, v215
  v_swap_b32 v200, v216
  v_swap_b32 v201, v217
  v_swap_b32 v202, v218
  v_swap_b32 v203, v219
  v_swap_b32 v204, v220
  v_swap_b32 v205, v221
  v_swap_b32 v206, v222
  v_swap_b32 v207, v223
skip_40:
  v_mfma_f32_16x16x32_bf16 v[112:115], v[136:139], v[168:171], v[112:115]
  buffer_load_dwordx4 a[184:187], v2, s[52:55], s34 offen offset:2048 sc1
  s_waitcnt lgkmcnt(12)
  v_mfma_f32_16x16x32_bf16 v[116:119], v[136:139], v[180:183], v[116:119]
  ds_read2_b32 v[140:141], v237 offset0:144 offset1:145
  ds_read2_b32 v[142:143], v237 offset0:146 offset1:147
  v_mfma_f32_16x16x32_bf16 v[104:107], v[132:135], v[160:163], 0
  ds_read_b128 v[160:163], v241 offset:3648
  v_mfma_f32_16x16x32_bf16 v[108:111], v[132:135], v[164:167], v[108:111]
  ds_read2_b32 v[136:137], v237 offset0:16 offset1:17
  ds_read2_b32 v[138:139], v237 offset0:18 offset1:19
  ds_write_b128 v249, v[208:211] offset:0
  v_mfma_f32_16x16x32_bf16 v[112:115], v[132:135], v[172:175], v[112:115]
  ds_read_b128 v[172:175], v241 offset:2112
  s_waitcnt lgkmcnt(15)
  v_mfma_f32_16x16x32_bf16 v[116:119], v[132:135], v[184:187], v[116:119]
  ds_read_b128 v[180:183], v241 offset:1088
  v_mfma_f32_16x16x32_bf16 v[104:107], v[128:131], v[164:167], v[104:107]
  ds_read_b128 v[164:167], v241 offset:3136
  v_mfma_f32_16x16x32_bf16 v[108:111], v[128:131], v[168:171], v[108:111]
  ds_read2_b32 v[132:133], v236 offset0:144 offset1:145
  ds_read2_b32 v[134:135], v236 offset0:146 offset1:147
  buffer_load_dwordx4 a[188:191], v2, s[52:55], s34 offen offset:3072 sc1
  ds_write_b128 v249, v[212:215] offset:1024
  s_mov_b32 s92, 24576
  buffer_load_dwordx4 v[120:123], v2, s[52:55], s92 offen sc1
  v_mfma_f32_16x16x32_bf16 v[112:115], v[128:131], v[176:179], v[112:115]
  ds_read_b128 v[168:171], v241 offset:2624
  v_mfma_f32_16x16x32_bf16 v[116:119], v[128:131], v[188:191], v[116:119]
  ds_read_b128 v[176:179], v241 offset:1600
  s_waitcnt lgkmcnt(11)
  v_mfma_f32_16x16x32_bf16 v[116:119], v[156:159], v[160:163], v[116:119]
  ds_read_b128 v[184:187], v241 offset:576
  s_waitcnt lgkmcnt(6)
  v_mfma_f32_16x16x32_bf16 v[116:119], v[152:155], v[164:167], v[116:119]
  ds_read2_b32 v[128:129], v236 offset0:16 offset1:17
  ds_read2_b32 v[130:131], v236 offset0:18 offset1:19
  ds_write_b128 v249, v[216:219] offset:2048
  s_barrier
  s_waitcnt lgkmcnt(5)
  v_mfma_f32_16x16x32_bf16 v[116:119], v[148:151], v[168:171], v[116:119]
  s_add_u32 s34, s34, 4096
  buffer_load_dwordx4 a[192:195], v2, s[52:55], s34 offen offset:0 sc1
  v_mfma_f32_16x16x32_bf16 v[112:115], v[144:147], v[160:163], v[112:115]
  ds_read_b128 v[188:191], v241 offset:64
  v_mfma_f32_16x16x32_bf16 v[116:119], v[144:147], v[172:175], v[116:119]
  ds_write_b128 v249, v[220:223] offset:3072
  v_mfma_f32_16x16x32_bf16 v[112:115], v[140:143], v[164:167], v[112:115]
  s_waitcnt lgkmcnt(6)
  v_mfma_f32_16x16x32_bf16 v[116:119], v[140:143], v[176:179], v[116:119]
  buffer_load_dwordx4 a[196:199], v2, s[52:55], s34 offen offset:1024 sc1
  v_mfma_f32_16x16x32_bf16 v[108:111], v[136:139], v[160:163], v[108:111]
  buffer_load_dwordx2 v[42:43], v244, s[52:55], s49 offen sc1
  v_mfma_f32_16x16x32_bf16 v[112:115], v[136:139], v[168:171], v[112:115]
  v_mfma_f32_16x16x32_bf16 v[116:119], v[136:139], v[180:183], v[116:119]
  v_mfma_f32_16x16x32_bf16 v[104:107], v[132:135], v[160:163], v[104:107]
  v_mfma_f32_16x16x32_bf16 v[108:111], v[132:135], v[164:167], v[108:111]
  v_mfma_f32_16x16x32_bf16 v[112:115], v[132:135], v[172:175], v[112:115]
  s_waitcnt lgkmcnt(5)
  v_mfma_f32_16x16x32_bf16 v[116:119], v[132:135], v[184:187], v[116:119]
  s_waitcnt lgkmcnt(3)
  v_mfma_f32_16x16x32_bf16 v[104:107], v[128:131], v[164:167], v[104:107]
  v_mfma_f32_16x16x32_bf16 v[108:111], v[128:131], v[168:171], v[108:111]
  v_mfma_f32_16x16x32_bf16 v[112:115], v[128:131], v[176:179], v[112:115]
  s_waitcnt lgkmcnt(1)
  v_mfma_f32_16x16x32_bf16 v[116:119], v[128:131], v[188:191], v[116:119]
  s_branch join_37
type_36:
  ds_read2_b32 v[156:157], v235 offset0:176 offset1:177
  ds_read2_b32 v[158:159], v235 offset0:178 offset1:179
  ds_read_b128 v[160:163], v240 offset:3776
  ds_read2_b32 v[152:153], v235 offset0:48 offset1:49
  ds_read2_b32 v[154:155], v235 offset0:50 offset1:51
  ds_read_b128 v[164:167], v240 offset:3264
  ds_read2_b32 v[148:149], v234 offset0:176 offset1:177
  ds_read2_b32 v[150:151], v234 offset0:178 offset1:179
  s_waitcnt lgkmcnt(5)
  v_mfma_f32_16x16x32_bf16 v[220:223], v[156:159], v[160:163], v[220:223]
  ds_read_b128 v[168:171], v240 offset:2752
  s_waitcnt lgkmcnt(4)
  v_mfma_f32_16x16x32_bf16 v[216:219], v[152:155], v[160:163], v[216:219]
  ds_read2_b32 v[144:145], v234 offset0:48 offset1:49
  ds_read2_b32 v[146:147], v234 offset0:50 offset1:51
  s_waitcnt lgkmcnt(5)
  v_mfma_f32_16x16x32_bf16 v[220:223], v[152:155], v[164:167], v[220:223]
  ds_read_b128 v[172:175], v240 offset:2240
  s_waitcnt lgkmcnt(4)
  v_mfma_f32_16x16x32_bf16 v[212:215], v[148:151], v[160:163], v[212:215]
  ds_read2_b32 v[140:141], v233 offset0:176 offset1:177
  ds_read2_b32 v[142:143], v233 offset0:178 offset1:179
  s_add_u32 s13, s79, 10485760
  buffer_store_dwordx4 v[60:63], v47, s[52:55], s13 offen sc1
  v_mfma_f32_16x16x32_bf16 v[216:219], v[148:151], v[164:167], v[216:219]
  ds_read_b128 v[176:179], v240 offset:1728
  s_waitcnt lgkmcnt(6)
  v_mfma_f32_16x16x32_bf16 v[220:223], v[148:151], v[168:171], v[220:223]
  ds_read2_b32 v[136:137], v233 offset0:48 offset1:49
  ds_read2_b32 v[138:139], v233 offset0:50 offset1:51
  s_waitcnt lgkmcnt(6)
  v_mfma_f32_16x16x32_bf16 v[208:211], v[144:147], v[160:163], v[208:211]
  ds_read_b128 v[180:183], v240 offset:1216
  v_mfma_f32_16x16x32_bf16 v[212:215], v[144:147], v[164:167], v[212:215]
  ds_read2_b32 v[132:133], v232 offset0:176 offset1:177
  ds_read2_b32 v[134:135], v232 offset0:178 offset1:179
  s_add_u32 s13, s80, 10485760
  buffer_store_dwordx4 v[68:71], v47, s[52:55], s13 offen sc1
  v_mfma_f32_16x16x32_bf16 v[216:219], v[144:147], v[168:171], v[216:219]
  s_waitcnt lgkmcnt(8)
  v_mfma_f32_16x16x32_bf16 v[220:223], v[144:147], v[172:175], v[220:223]
  s_waitcnt lgkmcnt(6)
  v_mfma_f32_16x16x32_bf16 v[204:207], v[140:143], v[160:163], v[204:207]
  v_mfma_f32_16x16x32_bf16 v[208:211], v[140:143], v[164:167], v[208:211]
  v_mfma_f32_16x16x32_bf16 v[212:215], v[140:143], v[168:171], v[212:215]
  s_add_u32 s13, s81, 10485760
  buffer_store_dwordx4 v[76:79], v47, s[52:55], s13 offen sc1
  v_mfma_f32_16x16x32_bf16 v[216:219], v[140:143], v[172:175], v[216:219]
  ds_read_b128 v[184:187], v240 offset:704
  s_waitcnt lgkmcnt(6)
  v_mfma_f32_16x16x32_bf16 v[220:223], v[140:143], v[176:179], v[220:223]
  ds_read2_b32 v[128:129], v232 offset0:48 offset1:49
  ds_read2_b32 v[130:131], v232 offset0:50 offset1:51
  s_waitcnt lgkmcnt(6)
  v_mfma_f32_16x16x32_bf16 v[200:203], v[136:139], v[160:163], v[200:203]
  v_mfma_f32_16x16x32_bf16 v[204:207], v[136:139], v[164:167], v[204:207]
  s_add_u32 s13, s82, 10485760
  buffer_store_dwordx4 v[84:87], v47, s[52:55], s13 offen sc1
  v_mfma_f32_16x16x32_bf16 v[208:211], v[136:139], v[168:171], v[208:211]
  v_mfma_f32_16x16x32_bf16 v[212:215], v[136:139], v[172:175], v[212:215]
  v_mfma_f32_16x16x32_bf16 v[216:219], v[136:139], v[176:179], v[216:219]
  s_waitcnt lgkmcnt(5)
  v_mfma_f32_16x16x32_bf16 v[220:223], v[136:139], v[180:183], v[220:223]
  s_waitcnt lgkmcnt(3)
  v_mfma_f32_16x16x32_bf16 v[196:199], v[132:135], v[160:163], v[196:199]
  ds_read_b128 v[188:191], v240 offset:192
  v_mfma_f32_16x16x32_bf16 v[200:203], v[132:135], v[164:167], v[200:203]
  ds_read2_b32 v[152:153], v239 offset0:0 offset1:1
  ds_read2_b32 v[154:155], v239 offset0:2 offset1:3
  v_mfma_f32_16x16x32_bf16 v[204:207], v[132:135], v[168:171], v[204:207]
  ds_read2_b32 v[148:149], v238 offset0:128 offset1:129
  ds_read2_b32 v[150:151], v238 offset0:130 offset1:131
  v_mfma_f32_16x16x32_bf16 v[208:211], v[132:135], v[172:175], v[208:211]
  buffer_load_dwordx4 a[168:171], v2, s[52:55], s34 offen offset:2048 sc1
  v_mfma_f32_16x16x32_bf16 v[212:215], v[132:135], v[176:179], v[212:215]
  ds_read2_b32 v[144:145], v238 offset0:0 offset1:1
  ds_read2_b32 v[146:147], v238 offset0:2 offset1:3
  v_mfma_f32_16x16x32_bf16 v[216:219], v[132:135], v[180:183], v[216:219]
  s_waitcnt lgkmcnt(9)
  v_mfma_f32_16x16x32_bf16 v[220:223], v[132:135], v[184:187], v[220:223]
  ds_read2_b32 v[140:141], v237 offset0:128 offset1:129
  ds_read2_b32 v[142:143], v237 offset0:130 offset1:131
  s_waitcnt lgkmcnt(9)
  v_mfma_f32_16x16x32_bf16 v[192:195], v[128:131], v[160:163], v[192:195]
  ds_read_b128 v[160:163], v241 offset:3584
  v_mfma_f32_16x16x32_bf16 v[196:199], v[128:131], v[164:167], v[196:199]
  ds_read_b128 v[164:167], v241 offset:3072
  v_mfma_f32_16x16x32_bf16 v[200:203], v[128:131], v[168:171], v[200:203]
  ds_read_b128 v[168:171], v241 offset:2560
  v_mfma_f32_16x16x32_bf16 v[204:207], v[128:131], v[172:175], v[204:207]
  ds_read2_b32 v[136:137], v237 offset0:0 offset1:1
  ds_read2_b32 v[138:139], v237 offset0:2 offset1:3
  buffer_load_dwordx4 a[172:175], v2, s[52:55], s34 offen offset:3072 sc1
  v_mfma_f32_16x16x32_bf16 v[208:211], v[128:131], v[176:179], v[208:211]
  ds_read_b128 v[172:175], v241 offset:2048
  v_mfma_f32_16x16x32_bf16 v[212:215], v[128:131], v[180:183], v[212:215]
  ds_read_b128 v[176:179], v241 offset:1536
  v_mfma_f32_16x16x32_bf16 v[216:219], v[128:131], v[184:187], v[216:219]
  ds_read2_b32 v[132:133], v236 offset0:128 offset1:129
  ds_read2_b32 v[134:135], v236 offset0:130 offset1:131
  s_waitcnt lgkmcnt(15)
  v_mfma_f32_16x16x32_bf16 v[220:223], v[128:131], v[188:191], v[220:223]
  ds_read_b128 v[180:183], v241 offset:1024
  s_add_u32 s34, s34, 4096
  buffer_load_dwordx4 a[176:179], v2, s[52:55], s34 offen offset:0 sc1
  s_waitcnt lgkmcnt(9)
  v_mfma_f32_16x16x32_bf16 v[116:119], v[152:155], v[160:163], 0
  ds_read2_b32 v[128:129], v236 offset0:0 offset1:1
  ds_read2_b32 v[130:131], v236 offset0:2 offset1:3
  v_mfma_f32_16x16x32_bf16 v[112:115], v[148:151], v[160:163], 0
  s_waitcnt lgkmcnt(10)
  v_mfma_f32_16x16x32_bf16 v[116:119], v[148:151], v[164:167], v[116:119]
  v_mfma_f32_16x16x32_bf16 v[112:115], v[144:147], v[164:167], v[112:115]
  ds_read_b128 v[184:187], v241 offset:512
  s_waitcnt lgkmcnt(10)
  v_mfma_f32_16x16x32_bf16 v[116:119], v[144:147], v[168:171], v[116:119]
  ds_read2_b32 v[152:153], v239 offset0:16 offset1:17
  ds_read2_b32 v[154:155], v239 offset0:18 offset1:19
  v_mfma_f32_16x16x32_bf16 v[108:111], v[140:143], v[160:163], 0
  ds_read2_b32 v[148:149], v238 offset0:144 offset1:145
  ds_read2_b32 v[150:151], v238 offset0:146 offset1:147
  v_mfma_f32_16x16x32_bf16 v[112:115], v[140:143], v[168:171], v[112:115]
  buffer_load_dwordx4 a[180:183], v2, s[52:55], s34 offen offset:1024 sc1
  s_waitcnt vmcnt(4)
  s_add_u32 s14, s84, 12288
  v_mov_b32 v15, s8
  s_mov_b64 exec, 1
  s_cmp_eq_u32 s9, 0
  s_cbranch_scc1 slow_41
  buffer_store_dword v15, off, s[52:55], s14
back_42:
  s_mov_b64 exec, -1
  s_waitcnt lgkmcnt(11)
  v_mfma_f32_16x16x32_bf16 v[116:119], v[140:143], v[172:175], v[116:119]
  ds_read2_b32 v[144:145], v238 offset0:16 offset1:17
  ds_read2_b32 v[146:147], v238 offset0:18 offset1:19
  s_bitcmp0_b32 s7, 0
  s_cbranch_scc1 skip_43
  v_swap_b32 v192, v208
  v_swap_b32 v193, v209
  v_swap_b32 v194, v210
  v_swap_b32 v195, v211
  v_swap_b32 v196, v212
  v_swap_b32 v197, v213
  v_swap_b32 v198, v214
  v_swap_b32 v199, v215
  v_swap_b32 v200, v216
  v_swap_b32 v201, v217
  v_swap_b32 v202, v218
  v_swap_b32 v203, v219
  v_swap_b32 v204, v220
  v_swap_b32 v205, v221
  v_swap_b32 v206, v222
  v_swap_b32 v207, v223
skip_43:
  v_mfma_f32_16x16x32_bf16 v[108:111], v[136:139], v[164:167], v[108:111]
  ds_read_b128 v[164:167], v241 offset:3136
  v_mfma_f32_16x16x32_bf16 v[112:115], v[136:139], v[172:175], v[112:115]
  ds_read2_b32 v[140:141], v237 offset0:144 offset1:145
  ds_read2_b32 v[142:143], v237 offset0:146 offset1:147
  s_waitcnt lgkmcnt(15)
  v_mfma_f32_16x16x32_bf16 v[116:119], v[136:139], v[176:179], v[116:119]
  buffer_load_dwordx4 a[184:187], v2, s[52:55], s34 offen offset:2048 sc1
  s_waitcnt lgkmcnt(13)
  v_mfma_f32_16x16x32_bf16 v[108:111], v[132:135], v[168:171], v[108:111]
  ds_read_b128 v[168:171], v241 offset:2624
  ds_write_b128 v249, v[208:211] offset:0
  v_mfma_f32_16x16x32_bf16 v[112:115], v[132:135], v[176:179], v[112:115]
  ds_read2_b32 v[136:137], v237 offset0:16 offset1:17
  ds_read2_b32 v[138:139], v237 offset0:18 offset1:19
  s_waitcnt lgkmcnt(15)
  v_mfma_f32_16x16x32_bf16 v[116:119], v[132:135], v[180:183], v[116:119]
  buffer_load_dwordx4 a[188:191], v2, s[52:55], s34 offen offset:3072 sc1
  s_waitcnt lgkmcnt(14)
  v_mfma_f32_16x16x32_bf16 v[104:107], v[128:131], v[160:163], 0
  ds_read_b128 v[160:163], v241 offset:3648
  v_mfma_f32_16x16x32_bf16 v[108:111], v[128:131], v[172:175], v[108:111]
  ds_read_b128 v[176:179], v241 offset:1600
  ds_write_b128 v249, v[212:215] offset:1024
  s_mov_b32 s92, 24576
  buffer_load_dwordx4 v[120:123], v2, s[52:55], s92 offen sc1
  v_mfma_f32_16x16x32_bf16 v[112:115], v[128:131], v[180:183], v[112:115]
  ds_read_b128 v[172:175], v241 offset:2112
  s_waitcnt lgkmcnt(15)
  v_mfma_f32_16x16x32_bf16 v[116:119], v[128:131], v[184:187], v[116:119]
  ds_read2_b32 v[132:133], v236 offset0:144 offset1:145
  ds_read2_b32 v[134:135], v236 offset0:146 offset1:147
  s_waitcnt lgkmcnt(5)
  v_mfma_f32_16x16x32_bf16 v[116:119], v[152:155], v[160:163], v[116:119]
  ds_read_b128 v[180:183], v241 offset:1088
  v_mfma_f32_16x16x32_bf16 v[112:115], v[148:151], v[160:163], v[112:115]
  ds_read2_b32 v[128:129], v236 offset0:16 offset1:17
  ds_read2_b32 v[130:131], v236 offset0:18 offset1:19
  ds_write_b128 v249, v[216:219] offset:2048
  s_barrier
  v_mfma_f32_16x16x32_bf16 v[116:119], v[148:151], v[164:167], v[116:119]
  s_add_u32 s34, s34, 4096
  buffer_load_dwordx4 a[192:195], v2, s[52:55], s34 offen offset:0 sc1
  v_mfma_f32_16x16x32_bf16 v[112:115], v[144:147], v[164:167], v[112:115]
  ds_read_b128 v[184:187], v241 offset:576
  v_mfma_f32_16x16x32_bf16 v[116:119], v[144:147], v[168:171], v[116:119]
  ds_write_b128 v249, v[220:223] offset:3072
  v_mfma_f32_16x16x32_bf16 v[108:111], v[140:143], v[160:163], v[108:111]
  v_mfma_f32_16x16x32_bf16 v[112:115], v[140:143], v[168:171], v[112:115]
  buffer_load_dwordx4 a[196:199], v2, s[52:55], s34 offen offset:1024 sc1
  s_waitcnt lgkmcnt(8)
  v_mfma_f32_16x16x32_bf16 v[116:119], v[140:143], v[172:175], v[116:119]
  buffer_load_dwordx2 v[42:43], v244, s[52:55], s49 offen sc1
  v_mfma_f32_16x16x32_bf16 v[108:111], v[136:139], v[164:167], v[108:111]
  v_mfma_f32_16x16x32_bf16 v[112:115], v[136:139], v[172:175], v[112:115]
  v_mfma_f32_16x16x32_bf16 v[116:119], v[136:139], v[176:179], v[116:119]
  s_waitcnt lgkmcnt(6)
  v_mfma_f32_16x16x32_bf16 v[108:111], v[132:135], v[168:171], v[108:111]
  v_mfma_f32_16x16x32_bf16 v[112:115], v[132:135], v[176:179], v[112:115]
  s_waitcnt lgkmcnt(5)
  v_mfma_f32_16x16x32_bf16 v[116:119], v[132:135], v[180:183], v[116:119]
  s_waitcnt lgkmcnt(3)
  v_mfma_f32_16x16x32_bf16 v[104:107], v[128:131], v[160:163], v[104:107]
  v_mfma_f32_16x16x32_bf16 v[108:111], v[128:131], v[172:175], v[108:111]
  v_mfma_f32_16x16x32_bf16 v[112:115], v[128:131], v[180:183], v[112:115]
  s_waitcnt lgkmcnt(1)
  v_mfma_f32_16x16x32_bf16 v[116:119], v[128:131], v[184:187], v[116:119]
join_37:
  s_nop 3
  ds_write_b128 v252, v[104:107] offset:0
  ds_write_b128 v252, v[108:111] offset:1024
  ds_write_b128 v252, v[112:115] offset:2048
  s_nop 0
  ds_write_b128 v252, v[116:119] offset:3072
  v_dot2_f32_bf16 v192, v89, s31, v192
  v_dot2_f32_bf16 v193, v89, s30, v193
  v_dot2_f32_bf16 v194, v88, s31, v194
  v_dot2_f32_bf16 v195, v88, s30, v195
  v_dot2_f32_bf16 v196, v91, s31, v196
  v_dot2_f32_bf16 v197, v91, s30, v197
  v_dot2_f32_bf16 v198, v90, s31, v198
  v_dot2_f32_bf16 v199, v90, s30, v199
  v_dot2_f32_bf16 v200, v93, s31, v200
  v_dot2_f32_bf16 v201, v93, s30, v201
  v_dot2_f32_bf16 v202, v92, s31, v202
  v_dot2_f32_bf16 v203, v92, s30, v203
  v_dot2_f32_bf16 v204, v95, s31, v204
  v_dot2_f32_bf16 v205, v95, s30, v205
  v_dot2_f32_bf16 v206, v94, s31, v206
  v_dot2_f32_bf16 v207, v94, s30, v207
  s_waitcnt vmcnt(3)
  v_min3_u32 v15, v120, v121, s8
  v_max3_u32 v14, v120, v121, s8
  v_min3_u32 v15, v15, v122, v123
  v_max3_u32 v14, v14, v122, v123
  v_cmp_ne_u32 vcc, v15, v14
  s_cbranch_vccnz again_44
ok_45:
  s_waitcnt vmcnt(0)
  v_xor_b32 v15, s8, v42
  v_xor_b32 v14, s8, v43
  v_or_b32 v15, v15, v14
  v_cmp_ne_u32 vcc, 0, v15
  s_cbranch_vccz ok_47
again_46:
  buffer_load_dwordx2 v[42:43], v244, s[52:55], s49 offen sc1
  s_sub_u32 s10, s10, 1
  s_cmp_gt_i32 s10, 0
  s_waitcnt vmcnt(0)
  v_xor_b32 v15, s8, v42
  v_xor_b32 v14, s8, v43
  v_or_b32 v15, v15, v14
  v_cmp_ne_u32 vcc, 0, v15
  s_cbranch_scc0 out_48
  s_cbranch_vccnz again_46
out_48:
ok_47:
  buffer_load_dwordx4 v[128:131], v2, s[52:55], s16 offen offset:0 sc1
  buffer_load_dwordx4 v[132:135], v2, s[52:55], s16 offen offset:1024 sc1
  buffer_load_dwordx4 v[136:139], v2, s[52:55], s16 offen offset:2048 sc1
  buffer_load_dwordx4 v[140:143], v2, s[52:55], s16 offen offset:3072 sc1
  s_add_u32 s16, s16, 4096
  buffer_load_dwordx4 v[144:147], v2, s[52:55], s16 offen offset:0 sc1
  buffer_load_dwordx4 v[148:151], v2, s[52:55], s16 offen offset:1024 sc1
  buffer_load_dwordx4 v[152:155], v2, s[52:55], s16 offen offset:2048 sc1
  buffer_load_dwordx4 v[156:159], v2, s[52:55], s16 offen offset:3072 sc1
  s_waitcnt lgkmcnt(0)
  s_barrier
  ds_read_b128 v[208:211], v250 offset:0
  ds_read_b128 v[212:215], v250 offset:1024
  ds_read_b128 v[216:219], v250 offset:2048
  ds_read_b128 v[220:223], v250 offset:3072
  ds_read_b128 v[224:227], v251 offset:0
  ds_read_b128 v[228:231], v251 offset:4096
  ds_read_b128 v[232:235], v251 offset:8192
  ds_read_b128 v[236:239], v251 offset:12288
  s_waitcnt vmcnt(7)
  v_mfma_f32_16x16x32_bf16 v[48:51], a[0:3], v[128:131], 0
  s_add_u32 s16, s16, 4096
  buffer_load_dwordx4 v[160:163], v2, s[52:55], s16 offen offset:0 sc1
  s_waitcnt lgkmcnt(0)
  v_mfma_f32_16x16x32_bf16 v[52:55], a[4:7], v[128:131], 0
  v_add_f32 v208, v192, v208
  v_add_f32_e64 v209, v193, v209
  v_mfma_f32_16x16x32_bf16 v[56:59], a[8:11], v[128:131], 0
  v_add_f32 v210, v194, v210
  v_add_f32 v211, v195, v211
  v_mfma_f32_16x16x32_bf16 v[60:63], a[12:15], v[128:131], 0
  v_cvt_pk_bf16_f32 v208, v208, v209
  v_cvt_pk_bf16_f32 v209, v210, v211
  v_mfma_f32_16x16x32_bf16 v[64:67], a[16:19], v[128:131], 0
  buffer_store_dwordx2 v[208:209], v246, s[52:55], s50 offen offset:0 sc1
  s_waitcnt vmcnt(8)
  v_mfma_f32_16x16x32_bf16 v[48:51], a[20:23], v[132:135], v[48:51]
  buffer_load_dwordx4 v[164:167], v2, s[52:55], s16 offen offset:1024 sc1
  v_add_f32 v212, v196, v212
  v_mfma_f32_16x16x32_bf16 v[52:55], a[24:27], v[132:135], v[52:55]
  v_add_f32 v213, v197, v213
  v_add_f32 v214, v198, v214
  v_mfma_f32_16x16x32_bf16 v[56:59], a[28:31], v[132:135], v[56:59]
  v_add_f32_e64 v215, v199, v215
  v_cvt_pk_bf16_f32 v212, v212, v213
  v_mfma_f32_16x16x32_bf16 v[60:63], a[32:35], v[132:135], v[60:63]
  v_cvt_pk_bf16_f32 v213, v214, v215
  buffer_store_dwordx2 v[212:213], v246, s[52:55], s50 offen offset:512 sc1
  v_mfma_f32_16x16x32_bf16 v[64:67], a[36:39], v[132:135], v[64:67]
  v_add_f32 v216, v200, v216
  s_waitcnt vmcnt(9)
  v_mfma_f32_16x16x32_bf16 v[48:51], a[40:43], v[136:139], v[48:51]
  buffer_load_dwordx4 v[168:171], v2, s[52:55], s17 offen offset:0 sc1
  v_add_f32_e64 v217, v201, v217
  v_mfma_f32_16x16x32_bf16 v[52:55], a[44:47], v[136:139], v[52:55]
  v_add_f32 v218, v202, v218
  v_add_f32 v219, v203, v219
  v_mfma_f32_16x16x32_bf16 v[56:59], a[48:51], v[136:139], v[56:59]
  v_cvt_pk_bf16_f32 v216, v216, v217
  v_cvt_pk_bf16_f32 v217, v218, v219
  v_mfma_f32_16x16x32_bf16 v[60:63], a[52:55], v[136:139], v[60:63]
  buffer_store_dwordx2 v[216:217], v246, s[52:55], s50 offen offset:1024 sc1
  v_add_f32_e64 v220, v204, v220
  v_mfma_f32_16x16x32_bf16 v[64:67], a[56:59], v[136:139], v[64:67]
  v_add_f32 v221, v205, v221
  s_waitcnt vmcnt(10)
  v_mfma_f32_16x16x32_bf16 v[48:51], a[60:63], v[140:143], v[48:51]
  buffer_load_dwordx4 v[172:175], v2, s[52:55], s17 offen offset:1024 sc1
  v_add_f32_e64 v222, v206, v222
  v_mfma_f32_16x16x32_bf16 v[52:55], a[64:67], v[140:143], v[52:55]
  v_add_f32_e64 v223, v207, v223
  v_cvt_pk_bf16_f32 v220, v220, v221
  v_mfma_f32_16x16x32_bf16 v[56:59], a[68:71], v[140:143], v[56:59]
  v_cvt_pk_bf16_f32 v221, v222, v223
  buffer_store_dwordx2 v[220:221], v246, s[52:55], s50 offen offset:1536 sc1
  v_mfma_f32_16x16x32_bf16 v[60:63], a[72:75], v[140:143], v[60:63]
  v_dot2_f32_bf16 v224, v97, s45, v224
  v_dot2_f32_bf16 v225, v97, s25, v225
  v_mfma_f32_16x16x32_bf16 v[64:67], a[76:79], v[140:143], v[64:67]
  v_dot2_f32_bf16 v226, v96, s45, v226
  s_waitcnt vmcnt(11)
  v_mfma_f32_16x16x32_bf16 v[48:51], a[80:83], v[144:147], v[48:51]
  buffer_load_dwordx4 v[176:179], v2, s[52:55], s17 offen offset:2048 sc1
  v_dot2_f32_bf16 v227, v96, s25, v227
  v_mfma_f32_16x16x32_bf16 v[52:55], a[84:87], v[144:147], v[52:55]
  v_add_f32 v228, v228, v232
  v_add_f32_e64 v229, v229, v233
  v_mfma_f32_16x16x32_bf16 v[56:59], a[88:91], v[144:147], v[56:59]
  v_add_f32 v230, v230, v234
  v_add_f32 v231, v231, v235
  v_mfma_f32_16x16x32_bf16 v[60:63], a[92:95], v[144:147], v[60:63]
  v_add_f32 v224, v224, v236
  v_add_f32 v225, v225, v237
  v_mfma_f32_16x16x32_bf16 v[64:67], a[96:99], v[144:147], v[64:67]
  v_add_f32 v226, v226, v238
  s_waitcnt vmcnt(11)
  v_mfma_f32_16x16x32_bf16 v[48:51], a[100:103], v[148:151], v[48:51]
  buffer_load_dwordx4 v[180:183], v2, s[52:55], s17 offen offset:3072 sc1
  v_add_f32_e64 v227, v227, v239
  v_mfma_f32_16x16x32_bf16 v[52:55], a[104:107], v[148:151], v[52:55]
  v_add_f32 v224, v224, v228
  v_add_f32 v225, v225, v229
  v_mfma_f32_16x16x32_bf16 v[56:59], a[108:111], v[148:151], v[56:59]
  v_add_f32 v226, v226, v230
  v_add_f32 v227, v227, v231
  v_mfma_f32_16x16x32_bf16 v[60:63], a[112:115], v[148:151], v[60:63]
  v_cvt_pk_bf16_f32 v224, v224, v225
  v_cvt_pk_bf16_f32 v225, v226, v227
  v_mfma_f32_16x16x32_bf16 v[64:67], a[116:119], v[148:151], v[64:67]
  buffer_store_dwordx2 v[224:225], v246, s[52:55], s51 offen sc1
  s_waitcnt vmcnt(12)
  v_mfma_f32_16x16x32_bf16 v[48:51], a[120:123], v[152:155], v[48:51]
  s_add_u32 s17, s17, 4096
  buffer_load_dwordx4 v[184:187], v2, s[52:55], s17 offen offset:0 sc1
  s_barrier
  v_mfma_f32_16x16x32_bf16 v[52:55], a[124:127], v[152:155], v[52:55]
  v_accvgpr_read_b32 v102, a226
  v_accvgpr_read_b32 v103, a227
  v_mfma_f32_16x16x32_bf16 v[56:59], a[128:131], v[152:155], v[56:59]
  v_mul_f32_e64 v102, v102, v103
  v_accvgpr_read_b32 v98, a216
  v_mfma_f32_16x16x32_bf16 v[60:63], a[132:135], v[152:155], v[60:63]
  v_accvgpr_read_b32 v100, a230
  v_accvgpr_read_b32 v99, a217
  v_mfma_f32_16x16x32_bf16 v[64:67], a[136:139], v[152:155], v[64:67]
  v_accvgpr_read_b32 v101, a231
  v_lshlrev_b32 v108, 16, v98
  s_waitcnt vmcnt(12)
  v_mfma_f32_16x16x32_bf16 v[48:51], a[140:143], v[156:159], v[48:51]
  buffer_load_dwordx4 v[188:191], v2, s[52:55], s17 offen offset:1024 sc1
  v_and_b32 v109, 0xffff0000, v98
  v_mfma_f32_16x16x32_bf16 v[52:55], a[144:147], v[156:159], v[52:55]
  v_lshlrev_b32_e64 v110, 16, v99
  v_and_b32 v111, 0xffff0000, v99
  v_mfma_f32_16x16x32_bf16 v[56:59], a[148:151], v[156:159], v[56:59]
  v_lshlrev_b32_e64 v92, 16, v100
  v_and_b32 v93, 0xffff0000, v100
  v_mfma_f32_16x16x32_bf16 v[60:63], a[152:155], v[156:159], v[60:63]
  v_lshlrev_b32_e64 v94, 16, v101
  v_and_b32 v95, 0xffff0000, v101
  v_mfma_f32_16x16x32_bf16 v[64:67], a[156:159], v[156:159], v[64:67]
  v_fma_f32 v88, v108, v103, -v102
  s_waitcnt vmcnt(12)
  v_mfma_f32_16x16x32_bf16 v[48:51], a[160:163], v[160:163], v[48:51]
  buffer_load_dwordx4 v[128:131], v2, s[52:55], s17 offen offset:2048 sc1
  v_fma_f32 v89, v109, v103, -v102
  v_mfma_f32_16x16x32_bf16 v[52:55], a[164:167], v[160:163], v[52:55]
  v_fma_f32 v90, v110, v103, -v102
  v_fma_f32 v91, v111, v103, -v102
  v_mfma_f32_16x16x32_bf16 v[56:59], a[168:171], v[160:163], v[56:59]
  v_fmac_f32 v108, v88, v92
  v_fmac_f32_e64 v109, v89, v93
  v_mfma_f32_16x16x32_bf16 v[60:63], a[172:175], v[160:163], v[60:63]
  v_fmac_f32 v110, v90, v94
  v_fmac_f32 v111, v91, v95
  v_mfma_f32_16x16x32_bf16 v[64:67], a[176:179], v[160:163], v[64:67]
  v_accvgpr_read_b32 v98, a218
  s_waitcnt vmcnt(11)
  v_mfma_f32_16x16x32_bf16 v[48:51], a[180:183], v[164:167], v[48:51]
  buffer_load_dwordx4 v[132:135], v2, s[52:55], s17 offen offset:3072 sc1
  v_accvgpr_read_b32 v100, a232
  v_mfma_f32_16x16x32_bf16 v[52:55], a[184:187], v[164:167], v[52:55]
  v_accvgpr_read_b32 v99, a219
  v_accvgpr_read_b32 v101, a233
  v_mfma_f32_16x16x32_bf16 v[56:59], a[188:191], v[164:167], v[56:59]
  v_lshlrev_b32 v112, 16, v98
  v_and_b32 v113, 0xffff0000, v98
  v_mfma_f32_16x16x32_bf16 v[60:63], a[192:195], v[164:167], v[60:63]
  v_lshlrev_b32_e64 v114, 16, v99
  v_and_b32 v115, 0xffff0000, v99
  v_mfma_f32_16x16x32_bf16 v[64:67], a[196:199], v[164:167], v[64:67]
  v_lshlrev_b32 v92, 16, v100
  s_waitcnt vmcnt(10)
  v_mfma_f32_16x16x32_bf16 v[68:71], a[0:3], v[168:171], 0
  s_add_u32 s17, s17, 4096
  buffer_load_dwordx4 v[136:139], v2, s[52:55], s17 offen offset:0 sc1
  v_and_b32 v93, 0xffff0000, v100
  v_mfma_f32_16x16x32_bf16 v[72:75], a[4:7], v[168:171], 0
  v_lshlrev_b32_e64 v94, 16, v101
  v_and_b32 v95, 0xffff0000, v101
  v_mfma_f32_16x16x32_bf16 v[76:79], a[8:11], v[168:171], 0
  v_fma_f32 v88, v112, v103, -v102
  v_fma_f32 v89, v113, v103, -v102
  v_mfma_f32_16x16x32_bf16 v[80:83], a[12:15], v[168:171], 0
  v_fma_f32 v90, v114, v103, -v102
  v_fma_f32 v91, v115, v103, -v102
  v_mfma_f32_16x16x32_bf16 v[84:87], a[16:19], v[168:171], 0
  v_fmac_f32 v112, v88, v92
  s_waitcnt vmcnt(9)
  v_mfma_f32_16x16x32_bf16 v[68:71], a[20:23], v[172:175], v[68:71]
  ds_write_b128 v44, v[48:51] offset:0
  ds_write_b128 v44, v[52:55] offset:1024
  buffer_load_dwordx4 v[140:143], v2, s[52:55], s17 offen offset:1024 sc1
  v_mfma_f32_16x16x32_bf16 v[72:75], a[24:27], v[172:175], v[72:75]
  v_fmac_f32 v113, v89, v93
  v_fmac_f32 v114, v90, v94
  v_mfma_f32_16x16x32_bf16 v[76:79], a[28:31], v[172:175], v[76:79]
  v_fmac_f32_e64 v115, v91, v95
  v_accvgpr_read_b32 v98, a220
  v_mfma_f32_16x16x32_bf16 v[80:83], a[32:35], v[172:175], v[80:83]
  v_accvgpr_read_b32 v100, a234
  v_accvgpr_read_b32 v99, a221
  v_mfma_f32_16x16x32_bf16 v[84:87], a[36:39], v[172:175], v[84:87]
  v_accvgpr_read_b32 v101, a235
  v_lshlrev_b32 v116, 16, v98
  s_waitcnt vmcnt(8)
  v_mfma_f32_16x16x32_bf16 v[68:71], a[40:43], v[176:179], v[68:71]
  ds_write_b128 v44, v[56:59] offset:2048
  ds_write_b128 v44, v[60:63] offset:3072
  buffer_load_dwordx4 v[144:147], v2, s[52:55], s18 offen offset:0 sc1
  v_mfma_f32_16x16x32_bf16 v[72:75], a[44:47], v[176:179], v[72:75]
  v_and_b32 v117, 0xffff0000, v98
  v_lshlrev_b32_e64 v118, 16, v99
  v_mfma_f32_16x16x32_bf16 v[76:79], a[48:51], v[176:179], v[76:79]
  v_and_b32 v119, 0xffff0000, v99
  v_lshlrev_b32_e64 v92, 16, v100
  v_mfma_f32_16x16x32_bf16 v[80:83], a[52:55], v[176:179], v[80:83]
  v_and_b32 v93, 0xffff0000, v100
  v_lshlrev_b32_e64 v94, 16, v101
  v_mfma_f32_16x16x32_bf16 v[84:87], a[56:59], v[176:179], v[84:87]
  v_and_b32 v95, 0xffff0000, v101
  v_fma_f32 v88, v116, v103, -v102
  s_waitcnt vmcnt(8)
  v_mfma_f32_16x16x32_bf16 v[68:71], a[60:63], v[180:183], v[68:71]
  ds_write_b128 v44, v[64:67] offset:4096
  buffer_load_dwordx4 v[148:151], v2, s[52:55], s18 offen offset:1024 sc1
  v_mfma_f32_16x16x32_bf16 v[72:75], a[64:67], v[180:183], v[72:75]
  v_fma_f32 v89, v117, v103, -v102
  v_fma_f32 v90, v118, v103, -v102
  v_mfma_f32_16x16x32_bf16 v[76:79], a[68:71], v[180:183], v[76:79]
  v_fma_f32 v91, v119, v103, -v102
  v_fmac_f32 v116, v88, v92
  v_mfma_f32_16x16x32_bf16 v[80:83], a[72:75], v[180:183], v[80:83]
  v_fmac_f32 v117, v89, v93
  v_fmac_f32 v118, v90, v94
  v_mfma_f32_16x16x32_bf16 v[84:87], a[76:79], v[180:183], v[84:87]
  v_fmac_f32_e64 v119, v91, v95
  v_accvgpr_read_b32 v98, a222
  s_waitcnt vmcnt(7)
  v_mfma_f32_16x16x32_bf16 v[68:71], a[80:83], v[184:187], v[68:71]
  buffer_load_dwordx4 v[152:155], v2, s[52:55], s18 offen offset:2048 sc1
  v_accvgpr_read_b32 v100, a236
  v_mfma_f32_16x16x32_bf16 v[72:75], a[84:87], v[184:187], v[72:75]
  v_accvgpr_read_b32 v99, a223
  v_accvgpr_read_b32 v101, a237
  v_mfma_f32_16x16x32_bf16 v[76:79], a[88:91], v[184:187], v[76:79]
  v_lshlrev_b32 v120, 16, v98
  v_and_b32 v121, 0xffff0000, v98
  v_mfma_f32_16x16x32_bf16 v[80:83], a[92:95], v[184:187], v[80:83]
  v_lshlrev_b32_e64 v122, 16, v99
  v_and_b32 v123, 0xffff0000, v99
  v_mfma_f32_16x16x32_bf16 v[84:87], a[96:99], v[184:187], v[84:87]
  v_lshlrev_b32 v92, 16, v100
  s_waitcnt vmcnt(7)
  v_mfma_f32_16x16x32_bf16 v[68:71], a[100:103], v[188:191], v[68:71]
  buffer_load_dwordx4 v[156:159], v2, s[52:55], s18 offen offset:3072 sc1
  v_and_b32 v93, 0xffff0000, v100
  v_mfma_f32_16x16x32_bf16 v[72:75], a[104:107], v[188:191], v[72:75]
  v_lshlrev_b32_e64 v94, 16, v101
  v_and_b32 v95, 0xffff0000, v101
  v_mfma_f32_16x16x32_bf16 v[76:79], a[108:111], v[188:191], v[76:79]
  v_fma_f32 v88, v120, v103, -v102
  v_fma_f32 v89, v121, v103, -v102
  v_mfma_f32_16x16x32_bf16 v[80:83], a[112:115], v[188:191], v[80:83]
  v_fma_f32 v90, v122, v103, -v102
  v_fma_f32 v91, v123, v103, -v102
  v_mfma_f32_16x16x32_bf16 v[84:87], a[116:119], v[188:191], v[84:87]
  v_fmac_f32 v120, v88, v92
  s_waitcnt vmcnt(7)
  v_mfma_f32_16x16x32_bf16 v[68:71], a[120:123], v[128:131], v[68:71]
  s_add_u32 s18, s18, 4096
  buffer_load_dwordx4 v[160:163], v2, s[52:55], s18 offen offset:0 sc1
  v_fmac_f32 v121, v89, v93
  v_fmac_f32 v122, v90, v94
  v_mfma_f32_16x16x32_bf16 v[72:75], a[124:127], v[128:131], v[72:75]
  v_fmac_f32_e64 v123, v91, v95
  v_accvgpr_read_b32 v98, a224
  v_accvgpr_read_b32 v100, a238
  v_mfma_f32_16x16x32_bf16 v[76:79], a[128:131], v[128:131], v[76:79]
  v_accvgpr_read_b32 v99, a225
  v_accvgpr_read_b32 v101, a239
  v_mfma_f32_16x16x32_bf16 v[80:83], a[132:135], v[128:131], v[80:83]
  v_lshlrev_b32_e64 v124, 16, v98
  s_mul_i32 s15, s7, 10240
  v_mfma_f32_16x16x32_bf16 v[84:87], a[136:139], v[128:131], v[84:87]
  s_add_u32 s15, s15, 102400
  v_add_u32 v47, s15, v2
  s_waitcnt vmcnt(7)
  v_mfma_f32_16x16x32_bf16 v[68:71], a[140:143], v[132:135], v[68:71]
  buffer_load_dwordx4 v[164:167], v2, s[52:55], s18 offen offset:1024 sc1
  v_and_b32 v125, 0xffff0000, v98
  v_mfma_f32_16x16x32_bf16 v[72:75], a[144:147], v[132:135], v[72:75]
  v_lshlrev_b32_e64 v126, 16, v99
  v_and_b32 v127, 0xffff0000, v99
  v_mfma_f32_16x16x32_bf16 v[76:79], a[148:151], v[132:135], v[76:79]
  v_lshlrev_b32_e64 v92, 16, v100
  v_and_b32 v93, 0xffff0000, v100
  v_mfma_f32_16x16x32_bf16 v[80:83], a[152:155], v[132:135], v[80:83]
  v_lshlrev_b32_e64 v94, 16, v101
  v_and_b32 v95, 0xffff0000, v101
  v_mfma_f32_16x16x32_bf16 v[84:87], a[156:159], v[132:135], v[84:87]
  v_fma_f32 v88, v124, v103, -v102
  s_waitcnt vmcnt(7)
  v_mfma_f32_16x16x32_bf16 v[68:71], a[160:163], v[136:139], v[68:71]
  buffer_load_dwordx4 v[168:171], v2, s[52:55], s18 offen offset:2048 sc1
  v_fma_f32 v89, v125, v103, -v102
  v_mfma_f32_16x16x32_bf16 v[72:75], a[164:167], v[136:139], v[72:75]
  v_fma_f32 v90, v126, v103, -v102
  v_fma_f32 v91, v127, v103, -v102
  v_mfma_f32_16x16x32_bf16 v[76:79], a[168:171], v[136:139], v[76:79]
  v_fmac_f32 v124, v88, v92
  v_fmac_f32_e64 v125, v89, v93
  v_mfma_f32_16x16x32_bf16 v[80:83], a[172:175], v[136:139], v[80:83]
  v_fmac_f32_e64 v126, v90, v94
  v_mfma_f32_16x16x32_bf16 v[84:87], a[176:179], v[136:139], v[84:87]
  v_fmac_f32 v127, v91, v95
  s_waitcnt vmcnt(7)
  v_mfma_f32_16x16x32_bf16 v[68:71], a[180:183], v[140:143], v[68:71]
  buffer_load_dwordx4 v[172:175], v2, s[52:55], s18 offen offset:3072 sc1
  v_mfma_f32_16x16x32_bf16 v[72:75], a[184:187], v[140:143], v[72:75]
  v_mfma_f32_16x16x32_bf16 v[76:79], a[188:191], v[140:143], v[76:79]
  v_mfma_f32_16x16x32_bf16 v[80:83], a[192:195], v[140:143], v[80:83]
  v_mfma_f32_16x16x32_bf16 v[84:87], a[196:199], v[140:143], v[84:87]
  s_waitcnt vmcnt(7)
  v_mfma_f32_16x16x32_bf16 v[48:51], a[0:3], v[144:147], 0
  s_add_u32 s18, s18, 4096
  buffer_load_dwordx4 v[176:179], v2, s[52:55], s18 offen offset:0 sc1
  v_mfma_f32_16x16x32_bf16 v[52:55], a[4:7], v[144:147], 0
  v_mfma_f32_16x16x32_bf16 v[56:59], a[8:11], v[144:147], 0
  v_mfma_f32_16x16x32_bf16 v[60:63], a[12:15], v[144:147], 0
  v_mfma_f32_16x16x32_bf16 v[64:67], a[16:19], v[144:147], 0
  s_waitcnt vmcnt(7)
  v_mfma_f32_16x16x32_bf16 v[48:51], a[20:23], v[148:151], v[48:51]
  ds_write_b128 v45, v[68:71] offset:0
  v_mfma_f32_16x16x32_bf16 v[52:55], a[24:27], v[148:151], v[52:55]
  ds_write_b128 v45, v[72:75] offset:1024
  v_mfma_f32_16x16x32_bf16 v[56:59], a[28:31], v[148:151], v[56:59]
  buffer_load_dwordx4 v[180:183], v2, s[52:55], s18 offen offset:1024 sc1
  v_mfma_f32_16x16x32_bf16 v[60:63], a[32:35], v[148:151], v[60:63]
  v_mfma_f32_16x16x32_bf16 v[64:67], a[36:39], v[148:151], v[64:67]
  s_waitcnt vmcnt(7)
  v_mfma_f32_16x16x32_bf16 v[48:51], a[40:43], v[152:155], v[48:51]
  ds_write_b128 v45, v[76:79] offset:2048
  v_mfma_f32_16x16x32_bf16 v[52:55], a[44:47], v[152:155], v[52:55]
  ds_write_b128 v45, v[80:83] offset:3072
  v_mfma_f32_16x16x32_bf16 v[56:59], a[48:51], v[152:155], v[56:59]
  buffer_load_dwordx4 v[184:187], v2, s[52:55], s19 offen offset:0 sc1
  v_mfma_f32_16x16x32_bf16 v[60:63], a[52:55], v[152:155], v[60:63]
  v_mfma_f32_16x16x32_bf16 v[64:67], a[56:59], v[152:155], v[64:67]
  s_waitcnt vmcnt(7)
  v_mfma_f32_16x16x32_bf16 v[48:51], a[60:63], v[156:159], v[48:51]
  ds_write_b128 v45, v[84:87] offset:4096
  v_mfma_f32_16x16x32_bf16 v[52:55], a[64:67], v[156:159], v[52:55]
  buffer_load_dwordx4 v[188:191], v2, s[52:55], s19 offen offset:1024 sc1
  v_mfma_f32_16x16x32_bf16 v[56:59], a[68:71], v[156:159], v[56:59]
  v_mfma_f32_16x16x32_bf16 v[60:63], a[72:75], v[156:159], v[60:63]
  v_mfma_f32_16x16x32_bf16 v[64:67], a[76:79], v[156:159], v[64:67]
  s_waitcnt vmcnt(7)
  v_mfma_f32_16x16x32_bf16 v[48:51], a[80:83], v[160:163], v[48:51]
  buffer_load_dwordx4 v[128:131], v2, s[52:55], s19 offen offset:2048 sc1
  s_waitcnt lgkmcnt(0)
  s_barrier
  v_mfma_f32_16x16x32_bf16 v[52:55], a[84:87], v[160:163], v[52:55]
  ds_read_b128 v[192:195], v47 offset:0
  ds_read_b128 v[196:199], v47 offset:1024
  v_mfma_f32_16x16x32_bf16 v[56:59], a[88:91], v[160:163], v[56:59]
  ds_read_b128 v[200:203], v47 offset:2048
  ds_read_b128 v[204:207], v47 offset:3072
  v_mfma_f32_16x16x32_bf16 v[60:63], a[92:95], v[160:163], v[60:63]
  ds_read_b128 v[208:211], v47 offset:4096
  ds_read_b128 v[212:215], v47 offset:5120
  v_mfma_f32_16x16x32_bf16 v[64:67], a[96:99], v[160:163], v[64:67]
  ds_read_b128 v[216:219], v47 offset:6144
  ds_read_b128 v[220:223], v47 offset:7168
  s_waitcnt vmcnt(7)
  v_mfma_f32_16x16x32_bf16 v[48:51], a[100:103], v[164:167], v[48:51]
  buffer_load_dwordx4 v[132:135], v2, s[52:55], s19 offen offset:3072 sc1
  ds_read_b128 v[224:227], v47 offset:8192
  v_mfma_f32_16x16x32_bf16 v[52:55], a[104:107], v[164:167], v[52:55]
  ds_read_b128 v[228:231], v47 offset:9216
  s_waitcnt lgkmcnt(5)
  v_mfma_f32_16x16x32_bf16 v[56:59], a[108:111], v[164:167], v[56:59]
  v_add_f32 v108, v108, v192
  v_add_f32_e64 v109, v109, v193
  v_mfma_f32_16x16x32_bf16 v[60:63], a[112:115], v[164:167], v[60:63]
  v_add_f32 v110, v110, v194
  v_add_f32 v111, v111, v195
  v_mfma_f32_16x16x32_bf16 v[64:67], a[116:119], v[164:167], v[64:67]
  v_add_f32 v112, v112, v196
  v_add_f32 v113, v113, v197
  s_waitcnt vmcnt(7)
  v_mfma_f32_16x16x32_bf16 v[48:51], a[120:123], v[168:171], v[48:51]
  s_add_u32 s19, s19, 4096
  buffer_load_dwordx4 v[136:139], v2, s[52:55], s19 offen offset:0 sc1
  v_add_f32 v114, v114, v198
  v_mfma_f32_16x16x32_bf16 v[52:55], a[124:127], v[168:171], v[52:55]
  v_add_f32 v115, v115, v199
  v_add_f32 v116, v116, v200
  v_mfma_f32_16x16x32_bf16 v[56:59], a[128:131], v[168:171], v[56:59]
  v_add_f32 v117, v117, v201
  v_add_f32 v118, v118, v202
  v_mfma_f32_16x16x32_bf16 v[60:63], a[132:135], v[168:171], v[60:63]
  v_add_f32 v119, v119, v203
  v_add_f32 v120, v120, v204
  v_mfma_f32_16x16x32_bf16 v[64:67], a[136:139], v[168:171], v[64:67]
  v_add_f32 v121, v121, v205
  v_add_f32 v122, v122, v206
  s_waitcnt vmcnt(7)
  v_mfma_f32_16x16x32_bf16 v[48:51], a[140:143], v[172:175], v[48:51]
  buffer_load_dwordx4 v[140:143], v2, s[52:55], s19 offen offset:1024 sc1
  s_mul_i32 s93, s6, 327680
  s_lshl_b32 s12, s5, 7
  s_add_u32 s93, s93, s12
  v_mfma_f32_16x16x32_bf16 v[52:55], a[144:147], v[172:175], v[52:55]
  s_lshr_b32 s12, s7, 1
  s_mul_i32 s94, s12, 5120
  s_add_u32 s94, s94, 143360
  s_lshl_b32 s12, s12, 6
  v_mfma_f32_16x16x32_bf16 v[56:59], a[148:151], v[172:175], v[56:59]
  s_add_u32 s93, s93, s12
  s_add_u32 s93, s93, 19922944
  s_mov_b32 s92, s93
  v_add_f32 v123, v123, v207
  v_mfma_f32_16x16x32_bf16 v[60:63], a[152:155], v[172:175], v[60:63]
  v_add_f32 v124, v124, v208
  v_add_f32 v125, v125, v209
  v_add_f32 v126, v126, v210
  v_add_f32 v127, v127, v211
  v_mfma_f32_16x16x32_bf16 v[64:67], a[156:159], v[172:175], v[64:67]
  s_waitcnt lgkmcnt(0)
  v_add_f32 v108, v108, v212
  v_add_f32 v109, v109, v213
  v_add_f32 v110, v110, v214
  s_waitcnt vmcnt(7)
  v_mfma_f32_16x16x32_bf16 v[48:51], a[160:163], v[176:179], v[48:51]
  buffer_load_dwordx4 v[144:147], v2, s[52:55], s19 offen offset:2048 sc1
  s_and_b32 s12, s7, 1
  s_mul_i32 s13, s12, 196608
  s_add_u32 s93, s93, s13
  s_mul_i32 s13, s12, 3072
  v_mfma_f32_16x16x32_bf16 v[52:55], a[164:167], v[176:179], v[52:55]
  s_add_u32 s95, s94, s13
  s_lshl_b32 s12, s12, 3
  s_add_u32 s94, s94, s12
  v_lshrrev_b32_e64 v252, 2, v1
  v_mfma_f32_16x16x32_bf16 v[56:59], a[168:171], v[176:179], v[56:59]
  v_lshlrev_b32 v252, 12, v252
  v_and_b32 v12, 3, v1
  v_lshl_add_u32 v252, v12, 4, v252
  v_add_f32_e64 v111, v111, v215
  v_mfma_f32_16x16x32_bf16 v[60:63], a[172:175], v[176:179], v[60:63]
  v_add_f32 v112, v112, v216
  v_add_f32 v113, v113, v217
  v_add_f32 v114, v114, v218
  v_add_f32 v115, v115, v219
  v_mfma_f32_16x16x32_bf16 v[64:67], a[176:179], v[176:179], v[64:67]
  v_add_f32 v116, v116, v220
  v_add_f32 v117, v117, v221
  v_add_f32 v118, v118, v222
  v_add_f32 v119, v119, v223
  s_waitcnt vmcnt(7)
  v_mfma_f32_16x16x32_bf16 v[48:51], a[180:183], v[180:183], v[48:51]
  buffer_load_dwordx4 v[148:151], v2, s[52:55], s19 offen offset:3072 sc1
  v_add_f32 v120, v120, v224
  v_mfma_f32_16x16x32_bf16 v[52:55], a[184:187], v[180:183], v[52:55]
  v_add_f32 v121, v121, v225
  v_add_f32 v122, v122, v226
  v_mfma_f32_16x16x32_bf16 v[56:59], a[188:191], v[180:183], v[56:59]
  v_add_f32 v123, v123, v227
  v_add_f32 v124, v124, v228
  v_mfma_f32_16x16x32_bf16 v[60:63], a[192:195], v[180:183], v[60:63]
  v_add_f32 v125, v125, v229
  v_add_f32 v126, v126, v230
  v_mfma_f32_16x16x32_bf16 v[64:67], a[196:199], v[180:183], v[64:67]
  v_add_f32 v127, v127, v231
  s_waitcnt vmcnt(7)
  v_mfma_f32_16x16x32_bf16 v[68:71], a[0:3], v[184:187], v[108:111]
  s_add_u32 s19, s19, 4096
  buffer_load_dwordx4 v[152:155], v2, s[52:55], s19 offen offset:0 sc1
  v_mfma_f32_16x16x32_bf16 v[72:75], a[4:7], v[184:187], v[112:115]
  v_mfma_f32_16x16x32_bf16 v[76:79], a[8:11], v[184:187], v[116:119]
  v_mfma_f32_16x16x32_bf16 v[80:83], a[12:15], v[184:187], v[120:123]
  v_mfma_f32_16x16x32_bf16 v[84:87], a[16:19], v[184:187], v[124:127]
  s_waitcnt vmcnt(7)
  v_mfma_f32_16x16x32_bf16 v[68:71], a[20:23], v[188:191], v[68:71]
  ds_write_b128 v46, v[48:51] offset:0
  v_mfma_f32_16x16x32_bf16 v[72:75], a[24:27], v[188:191], v[72:75]
  ds_write_b128 v46, v[52:55] offset:1024
  v_mfma_f32_16x16x32_bf16 v[76:79], a[28:31], v[188:191], v[76:79]
  buffer_load_dwordx4 v[156:159], v2, s[52:55], s19 offen offset:1024 sc1
  v_mfma_f32_16x16x32_bf16 v[80:83], a[32:35], v[188:191], v[80:83]
  v_mfma_f32_16x16x32_bf16 v[84:87], a[36:39], v[188:191], v[84:87]
  s_waitcnt vmcnt(7)
  v_mfma_f32_16x16x32_bf16 v[68:71], a[40:43], v[128:131], v[68:71]
  ds_write_b128 v46, v[56:59] offset:2048
  v_mfma_f32_16x16x32_bf16 v[72:75], a[44:47], v[128:131], v[72:75]
  ds_write_b128 v46, v[60:63] offset:3072
  v_mfma_f32_16x16x32_bf16 v[76:79], a[48:51], v[128:131], v[76:79]
  s_add_u32 m0, s95, 0
  s_nop 0
  buffer_load_dwordx4 v252, s[52:55], s93 offen sc1 lds
  s_add_u32 s93, s93, 65536
  v_mfma_f32_16x16x32_bf16 v[80:83], a[52:55], v[128:131], v[80:83]
  s_add_u32 m0, s95, 1024
  s_nop 0
  buffer_load_dwordx4 v252, s[52:55], s93 offen sc1 lds
  s_add_u32 s93, s93, 65536
  v_mfma_f32_16x16x32_bf16 v[84:87], a[56:59], v[128:131], v[84:87]
  s_add_u32 m0, s95, 2048
  s_bitcmp1_b32 s7, 0
  s_cselect_b32 s93, 1879048192, s93
  s_cselect_b32 m0, 163840, m0
  s_nop 0
  buffer_load_dwordx4 v252, s[52:55], s93 offen sc1 lds
  s_add_u32 s93, s93, 65536
  s_waitcnt vmcnt(9)
  v_mfma_f32_16x16x32_bf16 v[68:71], a[60:63], v[132:135], v[68:71]
  ds_write_b128 v46, v[64:67] offset:4096
  v_mfma_f32_16x16x32_bf16 v[72:75], a[64:67], v[132:135], v[72:75]
  v_add_u32_e64 v253, s94, v2
  v_mfma_f32_16x16x32_bf16 v[76:79], a[68:71], v[132:135], v[76:79]
  v_mfma_f32_16x16x32_bf16 v[80:83], a[72:75], v[132:135], v[80:83]
  v_mfma_f32_16x16x32_bf16 v[84:87], a[76:79], v[132:135], v[84:87]
  s_waitcnt vmcnt(8)
  v_mfma_f32_16x16x32_bf16 v[68:71], a[80:83], v[136:139], v[68:71]
  s_mul_i32 s15, s7, 5120
  v_mfma_f32_16x16x32_bf16 v[72:75], a[84:87], v[136:139], v[72:75]
  v_add_u32 v47, s15, v2
  v_mfma_f32_16x16x32_bf16 v[76:79], a[88:91], v[136:139], v[76:79]
  v_mfma_f32_16x16x32_bf16 v[80:83], a[92:95], v[136:139], v[80:83]
  v_mfma_f32_16x16x32_bf16 v[84:87], a[96:99], v[136:139], v[84:87]
  s_waitcnt vmcnt(7)
  v_mfma_f32_16x16x32_bf16 v[68:71], a[100:103], v[140:143], v[68:71]
  s_waitcnt lgkmcnt(0)
  s_barrier
  ds_read_b128 v[192:195], v47 offset:0
  v_mfma_f32_16x16x32_bf16 v[72:75], a[104:107], v[140:143], v[72:75]
  ds_read_b128 v[196:199], v47 offset:1024
  v_mfma_f32_16x16x32_bf16 v[76:79], a[108:111], v[140:143], v[76:79]
  ds_read_b128 v[200:203], v47 offset:2048
  v_mfma_f32_16x16x32_bf16 v[80:83], a[112:115], v[140:143], v[80:83]
  ds_read_b128 v[204:207], v47 offset:3072
  v_mfma_f32_16x16x32_bf16 v[84:87], a[116:119], v[140:143], v[84:87]
  ds_read_b128 v[208:211], v47 offset:4096
  s_waitcnt vmcnt(6)
  v_mfma_f32_16x16x32_bf16 v[68:71], a[120:123], v[144:147], v[68:71]
  v_mfma_f32_16x16x32_bf16 v[72:75], a[124:127], v[144:147], v[72:75]
  v_mfma_f32_16x16x32_bf16 v[76:79], a[128:131], v[144:147], v[76:79]
  v_mfma_f32_16x16x32_bf16 v[80:83], a[132:135], v[144:147], v[80:83]
  v_mfma_f32_16x16x32_bf16 v[84:87], a[136:139], v[144:147], v[84:87]
  s_waitcnt vmcnt(5)
  v_mfma_f32_16x16x32_bf16 v[68:71], a[140:143], v[148:151], v[68:71]
  v_mfma_f32_16x16x32_bf16 v[72:75], a[144:147], v[148:151], v[72:75]
  v_mfma_f32_16x16x32_bf16 v[76:79], a[148:151], v[148:151], v[76:79]
  v_mfma_f32_16x16x32_bf16 v[80:83], a[152:155], v[148:151], v[80:83]
  v_mfma_f32_16x16x32_bf16 v[84:87], a[156:159], v[148:151], v[84:87]
  s_waitcnt vmcnt(4)
  v_mfma_f32_16x16x32_bf16 v[68:71], a[160:163], v[152:155], v[68:71]
  v_mfma_f32_16x16x32_bf16 v[72:75], a[164:167], v[152:155], v[72:75]
  v_mfma_f32_16x16x32_bf16 v[76:79], a[168:171], v[152:155], v[76:79]
  v_mfma_f32_16x16x32_bf16 v[80:83], a[172:175], v[152:155], v[80:83]
  v_mfma_f32_16x16x32_bf16 v[84:87], a[176:179], v[152:155], v[84:87]
  s_waitcnt vmcnt(3)
  v_mfma_f32_16x16x32_bf16 v[68:71], a[180:183], v[156:159], v[68:71]
  v_mfma_f32_16x16x32_bf16 v[72:75], a[184:187], v[156:159], v[72:75]
  v_mfma_f32_16x16x32_bf16 v[76:79], a[188:191], v[156:159], v[76:79]
  v_mfma_f32_16x16x32_bf16 v[80:83], a[192:195], v[156:159], v[80:83]
  v_mfma_f32_16x16x32_bf16 v[84:87], a[196:199], v[156:159], v[84:87]
  s_lshl_b32 s12, s5, 15
  s_lshl_b32 s13, s7, 10
  s_add_u32 s12, s12, s13
  s_add_u32 s12, s12, 1310720
  s_lshl_b32 s13, s6, 12
  s_add_u32 s13, s13, s12
  s_waitcnt lgkmcnt(0)
  s_waitcnt vmcnt(0)
  s_barrier
  ds_read_b64_tr_b16 v[232:233], v253 offset:0
  ds_read_b64_tr_b16 v[234:235], v253 offset:1024
  ds_read_b64_tr_b16 v[236:237], v253 offset:2048
  ds_read_b64_tr_b16 v[238:239], v253 offset:3072
  ds_read_b64_tr_b16 v[240:241], v253 offset:4096
  v_accvgpr_read_b32 v244, a243
  v_accvgpr_read_b32 v245, a244
  v_pk_add_f32 v[68:69], v[68:69], v[192:193]
  v_pk_add_f32 v[70:71], v[70:71], v[194:195]
  v_pk_add_f32 v[72:73], v[72:73], v[196:197]
  v_pk_add_f32 v[74:75], v[74:75], v[198:199]
  v_pk_add_f32 v[76:77], v[76:77], v[200:201]
  v_pk_add_f32 v[78:79], v[78:79], v[202:203]
  v_pk_add_f32 v[80:81], v[80:81], v[204:205]
  v_pk_add_f32 v[82:83], v[82:83], v[206:207]
  v_pk_add_f32 v[84:85], v[84:85], v[208:209]
  v_pk_add_f32 v[86:87], v[86:87], v[210:211]
  v_pk_add_f32 v[212:213], v[68:69], v[70:71]
  v_pk_mul_f32 v[214:215], v[68:69], v[68:69]
  v_pk_fma_f32 v[214:215], v[70:71], v[70:71], v[214:215]
  v_pk_add_f32 v[212:213], v[212:213], v[72:73]
  v_pk_fma_f32 v[214:215], v[72:73], v[72:73], v[214:215]
  v_pk_add_f32 v[212:213], v[212:213], v[74:75]
  v_pk_fma_f32 v[214:215], v[74:75], v[74:75], v[214:215]
  v_pk_add_f32 v[212:213], v[212:213], v[76:77]
  v_pk_fma_f32 v[214:215], v[76:77], v[76:77], v[214:215]
  v_pk_add_f32 v[212:213], v[212:213], v[78:79]
  v_pk_fma_f32 v[214:215], v[78:79], v[78:79], v[214:215]
  v_pk_add_f32 v[212:213], v[212:213], v[80:81]
  v_pk_fma_f32 v[214:215], v[80:81], v[80:81], v[214:215]
  v_pk_add_f32 v[212:213], v[212:213], v[82:83]
  v_pk_fma_f32 v[214:215], v[82:83], v[82:83], v[214:215]
  v_pk_add_f32 v[212:213], v[212:213], v[84:85]
  v_pk_fma_f32 v[214:215], v[84:85], v[84:85], v[214:215]
  v_pk_add_f32 v[212:213], v[212:213], v[86:87]
  v_pk_fma_f32 v[214:215], v[86:87], v[86:87], v[214:215]
  s_waitcnt lgkmcnt(0)
  v_pk_max_u16 v15, v232, v233
  v_pk_max_u16 v15, v15, v234
  v_pk_max_u16 v15, v15, v235
  v_pk_max_u16 v15, v15, v236
  v_pk_max_u16 v15, v15, v237
  v_pk_max_u16 v15, v15, v238
  v_pk_max_u16 v15, v15, v239
  v_pk_max_u16 v15, v15, v240
  v_pk_max_u16 v15, v15, v241
  v_lshlrev_b32 v14, 16, v15
  v_max_u32 v15, v15, v14
  v_cmp_le_u32 vcc, 0xffff0000, v15
  s_cbranch_vccnz again_49
ok_50:
  v_lshlrev_b32 v88, 16, v232
  v_and_b32 v89, 0xffff0000, v232
  v_lshlrev_b32_e64 v90, 16, v233
  v_and_b32 v91, 0xffff0000, v233
  s_add_u32 m0, s75, 0
  s_add_u32 s14, s74, 0
  buffer_load_dwordx4 v244, s[56:59], s14 offen lds
  buffer_load_dwordx4 v245, s[56:59], s14 offen offset:2048 lds
  v_pk_mul_f32 v[160:161], v[68:69], v[88:89]
  v_pk_mul_f32 v[226:227], v[88:89], v[88:89]
  v_pk_mul_f32 v[218:219], v[160:161], v[68:69]
  v_pk_mul_f32 v[220:221], v[160:161], v[160:161]
  v_pk_mul_f32 v[222:223], v[160:161], v[88:89]
  v_pk_mul_f32 v[162:163], v[70:71], v[90:91]
  v_pk_add_f32 v[224:225], v[88:89], v[90:91]
  v_pk_fma_f32 v[226:227], v[90:91], v[90:91], v[226:227]
  v_pk_add_f32 v[216:217], v[160:161], v[162:163]
  v_pk_fma_f32 v[218:219], v[162:163], v[70:71], v[218:219]
  v_pk_fma_f32 v[220:221], v[162:163], v[162:163], v[220:221]
  v_pk_fma_f32 v[222:223], v[162:163], v[90:91], v[222:223]
  v_lshlrev_b32_e64 v92, 16, v234
  v_and_b32 v93, 0xffff0000, v234
  v_lshlrev_b32_e64 v94, 16, v235
  v_and_b32 v95, 0xffff0000, v235
  v_pk_mul_f32 v[164:165], v[72:73], v[92:93]
  v_pk_add_f32 v[224:225], v[224:225], v[92:93]
  v_pk_fma_f32 v[226:227], v[92:93], v[92:93], v[226:227]
  v_pk_add_f32 v[216:217], v[216:217], v[164:165]
  v_pk_fma_f32 v[218:219], v[164:165], v[72:73], v[218:219]
  v_pk_fma_f32 v[220:221], v[164:165], v[164:165], v[220:221]
  v_pk_fma_f32 v[222:223], v[164:165], v[92:93], v[222:223]
  v_pk_mul_f32 v[166:167], v[74:75], v[94:95]
  v_pk_add_f32 v[224:225], v[224:225], v[94:95]
  v_pk_fma_f32 v[226:227], v[94:95], v[94:95], v[226:227]
  v_pk_add_f32 v[216:217], v[216:217], v[166:167]
  v_pk_fma_f32 v[218:219], v[166:167], v[74:75], v[218:219]
  v_pk_fma_f32 v[220:221], v[166:167], v[166:167], v[220:221]
  v_pk_fma_f32 v[222:223], v[166:167], v[94:95], v[222:223]
  v_lshlrev_b32_e64 v96, 16, v236
  v_and_b32 v97, 0xffff0000, v236
  v_lshlrev_b32_e64 v98, 16, v237
  v_and_b32 v99, 0xffff0000, v237
  s_add_u32 m0, s75, 4096
  s_add_u32 s14, s74, 20480
  buffer_load_dwordx4 v244, s[56:59], s14 offen lds
  buffer_load_dwordx4 v245, s[56:59], s14 offen offset:2048 lds
  v_pk_mul_f32 v[168:169], v[76:77], v[96:97]
  v_pk_add_f32 v[224:225], v[224:225], v[96:97]
  v_pk_fma_f32 v[226:227], v[96:97], v[96:97], v[226:227]
  v_pk_add_f32 v[216:217], v[216:217], v[168:169]
  v_pk_fma_f32 v[218:219], v[168:169], v[76:77], v[218:219]
  v_pk_fma_f32 v[220:221], v[168:169], v[168:169], v[220:221]
  v_pk_fma_f32 v[222:223], v[168:169], v[96:97], v[222:223]
  v_pk_mul_f32 v[170:171], v[78:79], v[98:99]
  v_pk_add_f32 v[224:225], v[224:225], v[98:99]
  v_pk_fma_f32 v[226:227], v[98:99], v[98:99], v[226:227]
  v_pk_add_f32 v[216:217], v[216:217], v[170:171]
  v_pk_fma_f32 v[218:219], v[170:171], v[78:79], v[218:219]
  v_pk_fma_f32 v[220:221], v[170:171], v[170:171], v[220:221]
  v_pk_fma_f32 v[222:223], v[170:171], v[98:99], v[222:223]
  v_lshlrev_b32_e64 v100, 16, v238
  v_and_b32 v101, 0xffff0000, v238
  v_lshlrev_b32_e64 v102, 16, v239
  v_and_b32 v103, 0xffff0000, v239
  v_pk_mul_f32 v[172:173], v[80:81], v[100:101]
  v_pk_add_f32 v[224:225], v[224:225], v[100:101]
  v_pk_fma_f32 v[226:227], v[100:101], v[100:101], v[226:227]
  v_pk_add_f32 v[216:217], v[216:217], v[172:173]
  v_pk_fma_f32 v[218:219], v[172:173], v[80:81], v[218:219]
  v_pk_fma_f32 v[220:221], v[172:173], v[172:173], v[220:221]
  v_pk_fma_f32 v[222:223], v[172:173], v[100:101], v[222:223]
  v_pk_mul_f32 v[174:175], v[82:83], v[102:103]
  v_pk_add_f32 v[224:225], v[224:225], v[102:103]
  v_pk_fma_f32 v[226:227], v[102:103], v[102:103], v[226:227]
  v_pk_add_f32 v[216:217], v[216:217], v[174:175]
  v_pk_fma_f32 v[218:219], v[174:175], v[82:83], v[218:219]
  v_pk_fma_f32 v[220:221], v[174:175], v[174:175], v[220:221]
  v_pk_fma_f32 v[222:223], v[174:175], v[102:103], v[222:223]
  v_lshlrev_b32_e64 v104, 16, v240
  v_and_b32 v105, 0xffff0000, v240
  v_lshlrev_b32_e64 v106, 16, v241
  v_and_b32 v107, 0xffff0000, v241
  s_add_u32 m0, s75, 8192
  s_add_u32 s14, s74, 40960
  buffer_load_dwordx4 v244, s[56:59], s14 offen lds
  v_pk_mul_f32 v[176:177], v[84:85], v[104:105]
  v_pk_add_f32 v[224:225], v[224:225], v[104:105]
  v_pk_fma_f32 v[226:227], v[104:105], v[104:105], v[226:227]
  v_pk_add_f32 v[216:217], v[216:217], v[176:177]
  v_pk_fma_f32 v[218:219], v[176:177], v[84:85], v[218:219]
  v_pk_fma_f32 v[220:221], v[176:177], v[176:177], v[220:221]
  v_pk_fma_f32 v[222:223], v[176:177], v[104:105], v[222:223]
  v_pk_mul_f32 v[178:179], v[86:87], v[106:107]
  v_pk_add_f32 v[224:225], v[224:225], v[106:107]
  v_pk_fma_f32 v[226:227], v[106:107], v[106:107], v[226:227]
  v_pk_add_f32 v[216:217], v[216:217], v[178:179]
  v_pk_fma_f32 v[218:219], v[178:179], v[86:87], v[218:219]
  v_pk_fma_f32 v[220:221], v[178:179], v[178:179], v[220:221]
  v_pk_fma_f32 v[222:223], v[178:179], v[106:107], v[222:223]
  v_add_f32 v212, v212, v213
  v_add_f32 v214, v214, v215
  v_add_f32 v216, v216, v217
  v_add_f32 v218, v218, v219
  v_add_f32 v220, v220, v221
  v_add_f32 v222, v222, v223
  v_add_f32 v224, v224, v225
  v_add_f32 v226, v226, v227
  v_permlane16_swap_b32 v212, v220
  v_permlane16_swap_b32 v214, v222
  v_permlane16_swap_b32 v216, v224
  v_permlane16_swap_b32 v218, v226
  v_add_f32 v228, v212, v220
  v_add_f32 v229, v214, v222
  v_add_f32 v230, v216, v224
  v_add_f32 v231, v218, v226
  v_mov_b32 v212, v228
  v_mov_b32 v213, v229
  v_mov_b32 v214, v230
  v_mov_b32 v215, v231
  v_permlane32_swap_b32 v228, v212
  v_permlane32_swap_b32 v229, v213
  v_permlane32_swap_b32 v230, v214
  v_permlane32_swap_b32 v231, v215
  s_movk_i32 s14, 0xff
  v_add_f32 v228, v228, v212
  v_add_f32 v229, v229, v213
  v_add_f32 v230, v230, v214
  v_add_f32 v231, v231, v215
  s_lshr_b32 s15, s8, 0
  v_mov_b32_e64 v212, s15
  v_bfi_b32 v228, s14, v212, v228
  s_lshr_b32 s15, s8, 8
  v_mov_b32 v213, s15
  v_bfi_b32 v229, s14, v213, v229
  s_lshr_b32 s15, s8, 16
  v_mov_b32 v214, s15
  v_bfi_b32 v230, s14, v214, v230
  s_lshr_b32 s15, s8, 24
  v_mov_b32 v215, s15
  v_bfi_b32 v231, s14, v215, v231
  s_mov_b32 exec_hi, 0
  s_cmp_eq_u32 s9, 0
  s_cbranch_scc1 slow_51
  buffer_store_dwordx4 v[228:231], v2, s[52:55], s13 offen
back_52:
  s_mov_b32 exec_hi, -1
  v_accvgpr_write_b32 a200, v232
  v_accvgpr_write_b32 a201, v233
  v_accvgpr_write_b32 a202, v234
  v_accvgpr_write_b32 a203, v235
  v_accvgpr_write_b32 a204, v236
  v_accvgpr_write_b32 a205, v237
  v_accvgpr_write_b32 a206, v238
  v_accvgpr_write_b32 a207, v239
  v_accvgpr_write_b32 a208, v240
  v_accvgpr_write_b32 a209, v241
  v_lshrrev_b32_e64 v11, 2, v3
  v_mul_u32_u24 v11, 5120, v11
  v_and_b32_e64 v12, 3, v3
  v_lshl_add_u32 v11, v12, 4, v11
  v_lshrrev_b32_e64 v12, 1, v4
  v_lshl_add_u32 v11, v12, 6, v11
  v_and_b32_e64 v12, 1, v4
  v_lshl_add_u32 v47, v12, 3, v11
  s_lshl_b32 s88, s5, 2
  s_add_u32 s88, s88, s7
  s_mul_i32 s88, s88, 20480
  s_mul_i32 s14, s6, 640
  s_add_u32 s88, s88, s14
  s_add_u32 s88, s88, 4194304
  v_accvgpr_read_b32 v190, a230
  v_accvgpr_read_b32 v191, a231
  v_accvgpr_read_b32 v192, a232
  v_accvgpr_read_b32 v193, a233
  v_accvgpr_read_b32 v194, a234
  v_accvgpr_read_b32 v195, a235
  v_accvgpr_read_b32 v196, a236
  v_accvgpr_read_b32 v197, a237
  v_accvgpr_read_b32 v198, a238
  v_accvgpr_read_b32 v199, a239
  v_lshlrev_b32 v108, 16, v190
  v_and_b32 v109, 0xffff0000, v190
  v_lshlrev_b32_e64 v110, 16, v191
  v_and_b32 v111, 0xffff0000, v191
  v_lshlrev_b32_e64 v112, 16, v192
  v_and_b32 v113, 0xffff0000, v192
  v_lshlrev_b32_e64 v114, 16, v193
  v_and_b32 v115, 0xffff0000, v193
  v_lshlrev_b32_e64 v116, 16, v194
  v_and_b32 v117, 0xffff0000, v194
  v_lshlrev_b32_e64 v118, 16, v195
  v_and_b32 v119, 0xffff0000, v195
  v_lshlrev_b32_e64 v120, 16, v196
  v_and_b32 v121, 0xffff0000, v196
  v_lshlrev_b32_e64 v122, 16, v197
  v_and_b32 v123, 0xffff0000, v197
  v_lshlrev_b32_e64 v124, 16, v198
  v_and_b32 v125, 0xffff0000, v198
  v_lshlrev_b32_e64 v126, 16, v199
  v_and_b32 v127, 0xffff0000, v199
  s_lshl_b32 s87, s3, 8
  s_lshr_b32 s13, s7, 1
  s_lshl_b32 s13, s13, 7
  s_add_u32 s87, s87, s13
  s_and_b32 s13, s7, 1
  s_lshl_b32 s13, s13, 3
  s_add_u32 s87, s87, s13
  s_add_u32 s87, s87, 8192
  v_and_b32 v46, 7, v1
  v_lshlrev_b32_e64 v46, 4, v46
  s_add_u32 s34, s76, 4194304
  s_add_u32 s35, s34, 20480
  s_lshl_b32 s44, s5, 5
  s_lshl_b32 s13, s6, 2
  s_add_u32 s44, s44, s13
  s_add_u32 s44, s44, s7
  v_and_b32 v11, 31, v1
  v_lshlrev_b32 v11, 4, v11
  v_lshrrev_b32_e64 v12, 5, v1
  v_lshl_add_u32 v11, v12, 14, v11
  s_mov_b32 s14, 0x0c0c0400
  s_mov_b32 s15, 0x04000c0c
  s_add_u32 s89, s12, 4096
  s_add_u32 s90, s12, 8192
  s_add_u32 s91, s12, 12288
stpoll_53:
  buffer_load_dwordx4 v[128:131], v11, s[52:55], s12 offen sc1
  buffer_load_dwordx4 v[132:135], v11, s[52:55], s89 offen sc1
  buffer_load_dwordx4 v[136:139], v11, s[52:55], s90 offen sc1
  buffer_load_dwordx4 v[140:143], v11, s[52:55], s91 offen sc1
  s_waitcnt vmcnt(0)
  v_perm_b32 v212, v129, v128, s14
  v_perm_b32 v213, v131, v130, s15
  v_perm_b32 v214, v133, v132, s14
  v_perm_b32 v215, v135, v134, s15
  v_perm_b32 v216, v137, v136, s14
  v_perm_b32 v217, v139, v138, s15
  v_perm_b32 v218, v141, v140, s14
  v_perm_b32 v219, v143, v142, s15
  v_or_b32 v212, v212, v213
  v_or_b32 v214, v214, v215
  v_or_b32 v216, v216, v217
  v_or_b32_e64 v218, v218, v219
  v_min3_u32 v13, v212, v214, s8
  v_max3_u32 v14, v212, v214, s8
  v_min3_u32 v13, v13, v216, v218
  v_max3_u32 v14, v14, v216, v218
  v_cmp_ne_u32 vcc, v13, v14
  s_sub_u32 s10, s10, 1
  s_cmp_gt_i32 s10, 0
  s_cbranch_scc0 giveup_55
  s_cbranch_vccnz stpoll_53
giveup_55:
  v_pk_add_f32 v[128:129], v[128:129], v[132:133]
  v_pk_add_f32 v[136:137], v[136:137], v[140:141]
  v_pk_add_f32 v[130:131], v[130:131], v[134:135]
  v_pk_add_f32 v[138:139], v[138:139], v[142:143]
  v_pk_add_f32 v[128:129], v[128:129], v[136:137]
  v_pk_add_f32 v[130:131], v[130:131], v[138:139]
  v_mov_b32 v132, v128
  v_mov_b32 v133, v129
  v_mov_b32 v134, v130
  v_mov_b32 v135, v131
  v_permlane32_swap_b32 v128, v132
  v_permlane32_swap_b32 v129, v133
  v_permlane32_swap_b32 v130, v134
  v_permlane32_swap_b32 v131, v135
  v_add_f32 v212, v128, v132
  v_add_f32 v213, v129, v133
  v_add_f32 v214, v130, v134
  v_add_f32 v215, v131, v135
  v_mov_b32 v216, v212
  v_mov_b32 v217, v213
  v_mov_b32 v218, v214
  v_mov_b32 v219, v215
  v_permlane16_swap_b32 v212, v216
  v_permlane16_swap_b32 v213, v217
  v_permlane16_swap_b32 v214, v218
  v_permlane16_swap_b32 v215, v219
  v_mul_f32 v200, 0x3acccccd, v212
  v_mul_f32 v204, 0x3acccccd, v213
  v_fma_f32 v204, -v200, v200, v204
  v_max_f32 v204, 0, v204
  v_add_f32 v204, 0x3727c5ac, v204
  v_rsq_f32 v202, v204
  s_nop 0
  v_mul_f32_e64 v203, v200, v202
  v_fma_f32 v204, v202, v214, v212
  v_fma_f32 v204, -v203, v218, v204
  v_mul_f32_e64 v205, v202, v216
  v_fma_f32 v205, 2.0, v215, v205
  v_fma_f32 v205, v202, v205, v213
  v_fma_f32 v214, v202, v217, v214
  v_mul_f32_e64 v219, v203, v219
  v_fma_f32 v214, -2.0, v214, v219
  v_fma_f32 v205, v203, v214, v205
  v_mul_f32 v204, 0x3acccccd, v204
  v_mul_f32 v205, 0x3acccccd, v205
  v_fma_f32 v205, -v204, v204, v205
  v_max_f32_e64 v205, 0, v205
  v_add_f32 v205, 0x3727c5ac, v205
  v_rsq_f32 v206, v205
  s_nop 0
  v_mul_f32_e64 v207, v204, v206
  v_pk_fma_f32 v[160:161], v[68:69], v[202:203], v[202:203] op_sel:[0,0,1] op_sel_hi:[1,0,1] neg_lo:[0,0,1] neg_hi:[0,0,1]
  v_pk_fma_f32 v[162:163], v[70:71], v[202:203], v[202:203] op_sel:[0,0,1] op_sel_hi:[1,0,1] neg_lo:[0,0,1] neg_hi:[0,0,1]
  v_pk_fma_f32 v[164:165], v[72:73], v[202:203], v[202:203] op_sel:[0,0,1] op_sel_hi:[1,0,1] neg_lo:[0,0,1] neg_hi:[0,0,1]
  v_pk_fma_f32 v[166:167], v[74:75], v[202:203], v[202:203] op_sel:[0,0,1] op_sel_hi:[1,0,1] neg_lo:[0,0,1] neg_hi:[0,0,1]
  v_pk_fma_f32 v[168:169], v[76:77], v[202:203], v[202:203] op_sel:[0,0,1] op_sel_hi:[1,0,1] neg_lo:[0,0,1] neg_hi:[0,0,1]
  v_pk_fma_f32 v[170:171], v[78:79], v[202:203], v[202:203] op_sel:[0,0,1] op_sel_hi:[1,0,1] neg_lo:[0,0,1] neg_hi:[0,0,1]
  v_pk_fma_f32 v[172:173], v[80:81], v[202:203], v[202:203] op_sel:[0,0,1] op_sel_hi:[1,0,1] neg_lo:[0,0,1] neg_hi:[0,0,1]
  v_pk_fma_f32 v[174:175], v[82:83], v[202:203], v[202:203] op_sel:[0,0,1] op_sel_hi:[1,0,1] neg_lo:[0,0,1] neg_hi:[0,0,1]
  v_pk_fma_f32 v[176:177], v[84:85], v[202:203], v[202:203] op_sel:[0,0,1] op_sel_hi:[1,0,1] neg_lo:[0,0,1] neg_hi:[0,0,1]
  v_pk_fma_f32 v[178:179], v[86:87], v[202:203], v[202:203] op_sel:[0,0,1] op_sel_hi:[1,0,1] neg_lo:[0,0,1] neg_hi:[0,0,1]
  v_pk_fma_f32 v[68:69], v[160:161], v[88:89], v[68:69]
  v_pk_fma_f32 v[70:71], v[162:163], v[90:91], v[70:71]
  v_pk_fma_f32 v[72:73], v[164:165], v[92:93], v[72:73]
  v_pk_fma_f32 v[74:75], v[166:167], v[94:95], v[74:75]
  v_pk_fma_f32 v[76:77], v[168:169], v[96:97], v[76:77]
  v_pk_fma_f32 v[78:79], v[170:171], v[98:99], v[78:79]
  v_pk_fma_f32 v[80:81], v[172:173], v[100:101], v[80:81]
  v_pk_fma_f32 v[82:83], v[174:175], v[102:103], v[82:83]
  v_pk_fma_f32 v[84:85], v[176:177], v[104:105], v[84:85]
  v_pk_fma_f32 v[86:87], v[178:179], v[106:107], v[86:87]
  v_pk_fma_f32 v[160:161], v[68:69], v[206:207], v[206:207] op_sel:[0,0,1] op_sel_hi:[1,0,1] neg_lo:[0,0,1] neg_hi:[0,0,1]
  v_pk_fma_f32 v[162:163], v[70:71], v[206:207], v[206:207] op_sel:[0,0,1] op_sel_hi:[1,0,1] neg_lo:[0,0,1] neg_hi:[0,0,1]
  v_pk_fma_f32 v[164:165], v[72:73], v[206:207], v[206:207] op_sel:[0,0,1] op_sel_hi:[1,0,1] neg_lo:[0,0,1] neg_hi:[0,0,1]
  v_pk_fma_f32 v[166:167], v[74:75], v[206:207], v[206:207] op_sel:[0,0,1] op_sel_hi:[1,0,1] neg_lo:[0,0,1] neg_hi:[0,0,1]
  v_pk_fma_f32 v[168:169], v[76:77], v[206:207], v[206:207] op_sel:[0,0,1] op_sel_hi:[1,0,1] neg_lo:[0,0,1] neg_hi:[0,0,1]
  v_pk_fma_f32 v[170:171], v[78:79], v[206:207], v[206:207] op_sel:[0,0,1] op_sel_hi:[1,0,1] neg_lo:[0,0,1] neg_hi:[0,0,1]
  v_pk_fma_f32 v[172:173], v[80:81], v[206:207], v[206:207] op_sel:[0,0,1] op_sel_hi:[1,0,1] neg_lo:[0,0,1] neg_hi:[0,0,1]
  v_pk_fma_f32 v[174:175], v[82:83], v[206:207], v[206:207] op_sel:[0,0,1] op_sel_hi:[1,0,1] neg_lo:[0,0,1] neg_hi:[0,0,1]
  v_pk_fma_f32 v[176:177], v[84:85], v[206:207], v[206:207] op_sel:[0,0,1] op_sel_hi:[1,0,1] neg_lo:[0,0,1] neg_hi:[0,0,1]
  v_pk_fma_f32 v[178:179], v[86:87], v[206:207], v[206:207] op_sel:[0,0,1] op_sel_hi:[1,0,1] neg_lo:[0,0,1] neg_hi:[0,0,1]
  v_cvt_pk_bf16_f32 v180, v160, v161
  v_cvt_pk_bf16_f32 v181, v162, v163
  v_cvt_pk_bf16_f32 v182, v164, v165
  v_cvt_pk_bf16_f32 v183, v166, v167
  v_cvt_pk_bf16_f32 v184, v168, v169
  v_cvt_pk_bf16_f32 v185, v170, v171
  v_cvt_pk_bf16_f32 v186, v172, v173
  v_cvt_pk_bf16_f32 v187, v174, v175
  v_cvt_pk_bf16_f32 v188, v176, v177
  v_cvt_pk_bf16_f32 v189, v178, v179
  s_cmp_eq_u32 s9, 0
  s_cbranch_scc1 slow_56
  buffer_store_dwordx2 v[180:181], v47, s[52:55], s88 offen offset:0
  buffer_store_dwordx2 v[182:183], v47, s[52:55], s88 offen offset:128
  buffer_store_dwordx2 v[184:185], v47, s[52:55], s88 offen offset:256
  buffer_store_dwordx2 v[186:187], v47, s[52:55], s88 offen offset:384
  buffer_store_dwordx2 v[188:189], v47, s[52:55], s88 offen offset:512
back_57:
  v_pk_fma_f32 v[68:69], v[160:161], v[108:109], v[68:69]
  v_pk_fma_f32 v[70:71], v[162:163], v[110:111], v[70:71]
  v_pk_fma_f32 v[72:73], v[164:165], v[112:113], v[72:73]
  v_pk_fma_f32 v[74:75], v[166:167], v[114:115], v[74:75]
  v_pk_fma_f32 v[76:77], v[168:169], v[116:117], v[76:77]
  v_pk_fma_f32 v[78:79], v[170:171], v[118:119], v[78:79]
  v_pk_fma_f32 v[80:81], v[172:173], v[120:121], v[80:81]
  v_pk_fma_f32 v[82:83], v[174:175], v[122:123], v[82:83]
  v_pk_fma_f32 v[84:85], v[176:177], v[124:125], v[84:85]
  v_pk_fma_f32 v[86:87], v[178:179], v[126:127], v[86:87]
  v_accvgpr_write_b32 a210, v68
  v_accvgpr_write_b32 a211, v69
  v_accvgpr_write_b32 a212, v70
  v_accvgpr_write_b32 a213, v71
  v_accvgpr_write_b32 a214, v72
  v_accvgpr_write_b32 a215, v73
  v_accvgpr_write_b32 a216, v74
  v_accvgpr_write_b32 a217, v75
  v_accvgpr_write_b32 a218, v76
  v_accvgpr_write_b32 a219, v77
  v_accvgpr_write_b32 a220, v78
  v_accvgpr_write_b32 a221, v79
  v_accvgpr_write_b32 a222, v80
  v_accvgpr_write_b32 a223, v81
  v_accvgpr_write_b32 a224, v82
  v_accvgpr_write_b32 a225, v83
  v_accvgpr_write_b32 a226, v84
  v_accvgpr_write_b32 a227, v85
  v_accvgpr_write_b32 a228, v86
  v_accvgpr_write_b32 a229, v87
  s_add_u32 s13, s84, 8192
  s_waitcnt vmcnt(0)
  v_mov_b32 v15, s8
  s_mov_b64 exec, 1
  s_cmp_eq_u32 s9, 0
  s_cbranch_scc1 slow_58
  buffer_store_dword v15, off, s[52:55], s13
back_59:
  s_mov_b64 exec, -1
  s_cmp_lg_u32 s44, 992
  s_cbranch_scc1 skip_60
  v_mov_b32 v15, s8
  s_mov_b64 exec, 1
  buffer_store_dword v15, off, s[52:55], 0 sc1
  s_mov_b64 exec, -1
skip_60:
again_61:
  buffer_load_dwordx2 v[42:43], v46, s[52:55], s87 offen sc1
  s_sub_u32 s10, s10, 1
  s_cmp_gt_i32 s10, 0
  s_waitcnt vmcnt(0)
  v_xor_b32 v15, s8, v42
  v_xor_b32 v14, s8, v43
  v_or_b32 v15, v15, v14
  v_cmp_ne_u32 vcc, 0, v15
  s_cbranch_scc0 out_63
  s_cbranch_vccnz again_61
out_63:
ok_62:
  buffer_load_dwordx4 v[128:131], v0, s[52:55], s34 offen offset:1024 sc1
  buffer_load_dwordx4 v[132:135], v0, s[52:55], s35 offen offset:1024 sc1
  buffer_load_dwordx4 v[136:139], v0, s[52:55], s34 offen offset:1280 sc1
  buffer_load_dwordx4 v[140:143], v0, s[52:55], s35 offen offset:1280 sc1
  buffer_load_dwordx4 v[144:147], v0, s[52:55], s34 offen offset:1536 sc1
  buffer_load_dwordx4 v[148:151], v0, s[52:55], s35 offen offset:1536 sc1
  buffer_load_dwordx4 v[152:155], v0, s[52:55], s34 offen offset:1792 sc1
  buffer_load_dwordx4 v[156:159], v0, s[52:55], s35 offen offset:1792 sc1
  ds_read_b128 v[88:91], v5 offset:20480
  ds_read_b128 v[92:95], v5 offset:22528
  ds_read_b128 v[96:99], v5 offset:24576
  ds_read_b128 v[100:103], v5 offset:26624
  ds_read_b128 v[104:107], v5 offset:28672
  s_waitcnt vmcnt(6)
  s_waitcnt lgkmcnt(4)
  v_mfma_f32_16x16x32_bf16 v[48:51], v[128:131], v[88:91], 0
  ds_read_b128 v[108:111], v6 offset:20480
  v_mfma_f32_16x16x32_bf16 v[52:55], v[132:135], v[88:91], 0
  buffer_load_dwordx4 v[160:163], v0, s[52:55], s34 offen offset:2048 sc1
  s_waitcnt lgkmcnt(4)
  v_mfma_f32_16x16x32_bf16 v[56:59], v[128:131], v[92:95], 0
  ds_read_b128 v[112:115], v6 offset:22528
  v_mfma_f32_16x16x32_bf16 v[60:63], v[132:135], v[92:95], 0
  buffer_load_dwordx4 v[164:167], v0, s[52:55], s35 offen offset:2048 sc1
  s_waitcnt lgkmcnt(4)
  v_mfma_f32_16x16x32_bf16 v[64:67], v[128:131], v[96:99], 0
  ds_read_b128 v[116:119], v6 offset:24576
  v_mfma_f32_16x16x32_bf16 v[68:71], v[132:135], v[96:99], 0
  s_waitcnt lgkmcnt(4)
  v_mfma_f32_16x16x32_bf16 v[72:75], v[128:131], v[100:103], 0
  ds_read_b128 v[120:123], v6 offset:26624
  v_mfma_f32_16x16x32_bf16 v[76:79], v[132:135], v[100:103], 0
  s_waitcnt lgkmcnt(4)
  v_mfma_f32_16x16x32_bf16 v[80:83], v[128:131], v[104:107], 0
  ds_read_b128 v[124:127], v6 offset:28672
  v_mfma_f32_16x16x32_bf16 v[84:87], v[132:135], v[104:107], 0
  s_waitcnt vmcnt(6)
  s_waitcnt lgkmcnt(2)
  v_mfma_f32_16x16x32_bf16 v[48:51], v[136:139], v[108:111], v[48:51]
  ds_read_b128 v[88:91], v5 offset:30720
  v_mfma_f32_16x16x32_bf16 v[52:55], v[140:143], v[108:111], v[52:55]
  buffer_load_dwordx4 v[168:171], v0, s[52:55], s34 offen offset:2304 sc1
  v_mfma_f32_16x16x32_bf16 v[56:59], v[136:139], v[112:115], v[56:59]
  ds_read_b128 v[92:95], v5 offset:32768
  v_mfma_f32_16x16x32_bf16 v[60:63], v[140:143], v[112:115], v[60:63]
  buffer_load_dwordx4 v[172:175], v0, s[52:55], s35 offen offset:2304 sc1
  v_mfma_f32_16x16x32_bf16 v[64:67], v[136:139], v[116:119], v[64:67]
  ds_read_b128 v[96:99], v5 offset:34816
  v_mfma_f32_16x16x32_bf16 v[68:71], v[140:143], v[116:119], v[68:71]
  s_waitcnt lgkmcnt(3)
  v_mfma_f32_16x16x32_bf16 v[72:75], v[136:139], v[120:123], v[72:75]
  ds_read_b128 v[100:103], v5 offset:36864
  v_mfma_f32_16x16x32_bf16 v[76:79], v[140:143], v[120:123], v[76:79]
  v_mfma_f32_16x16x32_bf16 v[80:83], v[136:139], v[124:127], v[80:83]
  ds_read_b128 v[104:107], v5 offset:38912
  v_mfma_f32_16x16x32_bf16 v[84:87], v[140:143], v[124:127], v[84:87]
  s_waitcnt vmcnt(6)
  s_waitcnt lgkmcnt(2)
  v_mfma_f32_16x16x32_bf16 v[48:51], v[144:147], v[88:91], v[48:51]
  ds_read_b128 v[108:111], v6 offset:30720
  v_mfma_f32_16x16x32_bf16 v[52:55], v[148:151], v[88:91], v[52:55]
  buffer_load_dwordx4 v[176:179], v0, s[52:55], s34 offen offset:2560 sc1
  v_mfma_f32_16x16x32_bf16 v[56:59], v[144:147], v[92:95], v[56:59]
  ds_read_b128 v[112:115], v6 offset:32768
  v_mfma_f32_16x16x32_bf16 v[60:63], v[148:151], v[92:95], v[60:63]
  buffer_load_dwordx4 v[180:183], v0, s[52:55], s35 offen offset:2560 sc1
  v_mfma_f32_16x16x32_bf16 v[64:67], v[144:147], v[96:99], v[64:67]
  ds_read_b128 v[116:119], v6 offset:34816
  v_mfma_f32_16x16x32_bf16 v[68:71], v[148:151], v[96:99], v[68:71]
  s_waitcnt lgkmcnt(3)
  v_mfma_f32_16x16x32_bf16 v[72:75], v[144:147], v[100:103], v[72:75]
  ds_read_b128 v[120:123], v6 offset:36864
  v_mfma_f32_16x16x32_bf16 v[76:79], v[148:151], v[100:103], v[76:79]
  v_mfma_f32_16x16x32_bf16 v[80:83], v[144:147], v[104:107], v[80:83]
  ds_read_b128 v[124:127], v6 offset:38912
  v_mfma_f32_16x16x32_bf16 v[84:87], v[148:151], v[104:107], v[84:87]
  s_waitcnt vmcnt(6)
  s_waitcnt lgkmcnt(2)
  v_mfma_f32_16x16x32_bf16 v[48:51], v[152:155], v[108:111], v[48:51]
  ds_read_b128 v[88:91], v5 offset:40960
  v_mfma_f32_16x16x32_bf16 v[52:55], v[156:159], v[108:111], v[52:55]
  buffer_load_dwordx4 v[184:187], v0, s[52:55], s34 offen offset:2816 sc1
  v_mfma_f32_16x16x32_bf16 v[56:59], v[152:155], v[112:115], v[56:59]
  ds_read_b128 v[92:95], v5 offset:43008
  v_mfma_f32_16x16x32_bf16 v[60:63], v[156:159], v[112:115], v[60:63]
  buffer_load_dwordx4 v[188:191], v0, s[52:55], s35 offen offset:2816 sc1
  v_mfma_f32_16x16x32_bf16 v[64:67], v[152:155], v[116:119], v[64:67]
  ds_read_b128 v[96:99], v5 offset:45056
  v_mfma_f32_16x16x32_bf16 v[68:71], v[156:159], v[116:119], v[68:71]
  s_waitcnt lgkmcnt(3)
  v_mfma_f32_16x16x32_bf16 v[72:75], v[152:155], v[120:123], v[72:75]
  ds_read_b128 v[100:103], v5 offset:47104
  v_mfma_f32_16x16x32_bf16 v[76:79], v[156:159], v[120:123], v[76:79]
  v_mfma_f32_16x16x32_bf16 v[80:83], v[152:155], v[124:127], v[80:83]
  ds_read_b128 v[104:107], v5 offset:49152
  v_mfma_f32_16x16x32_bf16 v[84:87], v[156:159], v[124:127], v[84:87]
  s_waitcnt vmcnt(6)
  s_waitcnt lgkmcnt(2)
  v_mfma_f32_16x16x32_bf16 v[48:51], v[160:163], v[88:91], v[48:51]
  ds_read_b128 v[108:111], v6 offset:40960
  v_mfma_f32_16x16x32_bf16 v[52:55], v[164:167], v[88:91], v[52:55]
  buffer_load_dwordx4 v[128:131], v0, s[52:55], s34 offen offset:3072 sc1
  v_mfma_f32_16x16x32_bf16 v[56:59], v[160:163], v[92:95], v[56:59]
  ds_read_b128 v[112:115], v6 offset:43008
  v_mfma_f32_16x16x32_bf16 v[60:63], v[164:167], v[92:95], v[60:63]
  buffer_load_dwordx4 v[132:135], v0, s[52:55], s35 offen offset:3072 sc1
  v_mfma_f32_16x16x32_bf16 v[64:67], v[160:163], v[96:99], v[64:67]
  ds_read_b128 v[116:119], v6 offset:45056
  v_mfma_f32_16x16x32_bf16 v[68:71], v[164:167], v[96:99], v[68:71]
  s_waitcnt lgkmcnt(3)
  v_mfma_f32_16x16x32_bf16 v[72:75], v[160:163], v[100:103], v[72:75]
  ds_read_b128 v[120:123], v6 offset:47104
  v_mfma_f32_16x16x32_bf16 v[76:79], v[164:167], v[100:103], v[76:79]
  v_mfma_f32_16x16x32_bf16 v[80:83], v[160:163], v[104:107], v[80:83]
  ds_read_b128 v[124:127], v6 offset:49152
  v_mfma_f32_16x16x32_bf16 v[84:87], v[164:167], v[104:107], v[84:87]
  s_waitcnt vmcnt(6)
  s_waitcnt lgkmcnt(2)
  v_mfma_f32_16x16x32_bf16 v[48:51], v[168:171], v[108:111], v[48:51]
  ds_read_b128 v[88:91], v7 offset:0
  v_mfma_f32_16x16x32_bf16 v[52:55], v[172:175], v[108:111], v[52:55]
  buffer_load_dwordx4 v[136:139], v0, s[52:55], s34 offen offset:3328 sc1
  v_mfma_f32_16x16x32_bf16 v[56:59], v[168:171], v[112:115], v[56:59]
  ds_read_b128 v[92:95], v7 offset:2048
  v_mfma_f32_16x16x32_bf16 v[60:63], v[172:175], v[112:115], v[60:63]
  buffer_load_dwordx4 v[140:143], v0, s[52:55], s35 offen offset:3328 sc1
  v_mfma_f32_16x16x32_bf16 v[64:67], v[168:171], v[116:119], v[64:67]
  ds_read_b128 v[96:99], v7 offset:4096
  v_mfma_f32_16x16x32_bf16 v[68:71], v[172:175], v[116:119], v[68:71]
  s_waitcnt lgkmcnt(3)
  v_mfma_f32_16x16x32_bf16 v[72:75], v[168:171], v[120:123], v[72:75]
  ds_read_b128 v[100:103], v7 offset:6144
  v_mfma_f32_16x16x32_bf16 v[76:79], v[172:175], v[120:123], v[76:79]
  v_mfma_f32_16x16x32_bf16 v[80:83], v[168:171], v[124:127], v[80:83]
  ds_read_b128 v[104:107], v7 offset:8192
  v_mfma_f32_16x16x32_bf16 v[84:87], v[172:175], v[124:127], v[84:87]
  s_waitcnt vmcnt(6)
  s_waitcnt lgkmcnt(2)
  v_mfma_f32_16x16x32_bf16 v[48:51], v[176:179], v[88:91], v[48:51]
  ds_read_b128 v[108:111], v8 offset:0
  v_mfma_f32_16x16x32_bf16 v[52:55], v[180:183], v[88:91], v[52:55]
  buffer_load_dwordx4 v[144:147], v0, s[52:55], s34 offen offset:3584 sc1
  v_mfma_f32_16x16x32_bf16 v[56:59], v[176:179], v[92:95], v[56:59]
  ds_read_b128 v[112:115], v8 offset:2048
  v_mfma_f32_16x16x32_bf16 v[60:63], v[180:183], v[92:95], v[60:63]
  buffer_load_dwordx4 v[148:151], v0, s[52:55], s35 offen offset:3584 sc1
  v_mfma_f32_16x16x32_bf16 v[64:67], v[176:179], v[96:99], v[64:67]
  ds_read_b128 v[116:119], v8 offset:4096
  v_mfma_f32_16x16x32_bf16 v[68:71], v[180:183], v[96:99], v[68:71]
  s_waitcnt lgkmcnt(3)
  v_mfma_f32_16x16x32_bf16 v[72:75], v[176:179], v[100:103], v[72:75]
  ds_read_b128 v[120:123], v8 offset:6144
  v_mfma_f32_16x16x32_bf16 v[76:79], v[180:183], v[100:103], v[76:79]
  v_mfma_f32_16x16x32_bf16 v[80:83], v[176:179], v[104:107], v[80:83]
  ds_read_b128 v[124:127], v8 offset:8192
  v_mfma_f32_16x16x32_bf16 v[84:87], v[180:183], v[104:107], v[84:87]
  s_waitcnt vmcnt(6)
  s_waitcnt lgkmcnt(2)
  v_mfma_f32_16x16x32_bf16 v[48:51], v[184:187], v[108:111], v[48:51]
  ds_read_b128 v[88:91], v7 offset:10240
  v_mfma_f32_16x16x32_bf16 v[52:55], v[188:191], v[108:111], v[52:55]
  buffer_load_dwordx4 v[152:155], v0, s[52:55], s34 offen offset:3840 sc1
  v_mfma_f32_16x16x32_bf16 v[56:59], v[184:187], v[112:115], v[56:59]
  ds_read_b128 v[92:95], v7 offset:12288
  v_mfma_f32_16x16x32_bf16 v[60:63], v[188:191], v[112:115], v[60:63]
  buffer_load_dwordx4 v[156:159], v0, s[52:55], s35 offen offset:3840 sc1
  v_mfma_f32_16x16x32_bf16 v[64:67], v[184:187], v[116:119], v[64:67]
  ds_read_b128 v[96:99], v7 offset:14336
  v_mfma_f32_16x16x32_bf16 v[68:71], v[188:191], v[116:119], v[68:71]
  s_waitcnt lgkmcnt(3)
  v_mfma_f32_16x16x32_bf16 v[72:75], v[184:187], v[120:123], v[72:75]
  ds_read_b128 v[100:103], v7 offset:16384
  v_mfma_f32_16x16x32_bf16 v[76:79], v[188:191], v[120:123], v[76:79]
  v_mfma_f32_16x16x32_bf16 v[80:83], v[184:187], v[124:127], v[80:83]
  ds_read_b128 v[104:107], v7 offset:18432
  v_mfma_f32_16x16x32_bf16 v[84:87], v[188:191], v[124:127], v[84:87]
  s_waitcnt vmcnt(6)
  s_waitcnt lgkmcnt(2)
  v_mfma_f32_16x16x32_bf16 v[48:51], v[128:131], v[88:91], v[48:51]
  ds_read_b128 v[108:111], v8 offset:10240
  v_mfma_f32_16x16x32_bf16 v[52:55], v[132:135], v[88:91], v[52:55]
  s_add_u32 s34, s34, 4096
  buffer_load_dwordx4 v[160:163], v0, s[52:55], s34 offen offset:0 sc1
  v_mfma_f32_16x16x32_bf16 v[56:59], v[128:131], v[92:95], v[56:59]
  ds_read_b128 v[112:115], v8 offset:12288
  v_mfma_f32_16x16x32_bf16 v[60:63], v[132:135], v[92:95], v[60:63]
  s_add_u32 s35, s35, 4096
  buffer_load_dwordx4 v[164:167], v0, s[52:55], s35 offen offset:0 sc1
  v_mfma_f32_16x16x32_bf16 v[64:67], v[128:131], v[96:99], v[64:67]
  ds_read_b128 v[116:119], v8 offset:14336
  v_mfma_f32_16x16x32_bf16 v[68:71], v[132:135], v[96:99], v[68:71]
  s_waitcnt lgkmcnt(3)
  v_mfma_f32_16x16x32_bf16 v[72:75], v[128:131], v[100:103], v[72:75]
  ds_read_b128 v[120:123], v8 offset:16384
  v_mfma_f32_16x16x32_bf16 v[76:79], v[132:135], v[100:103], v[76:79]
  v_mfma_f32_16x16x32_bf16 v[80:83], v[128:131], v[104:107], v[80:83]
  ds_read_b128 v[124:127], v8 offset:18432
  v_mfma_f32_16x16x32_bf16 v[84:87], v[132:135], v[104:107], v[84:87]
  s_waitcnt vmcnt(6)
  s_waitcnt lgkmcnt(2)
  v_mfma_f32_16x16x32_bf16 v[48:51], v[136:139], v[108:111], v[48:51]
  ds_read_b128 v[88:91], v7 offset:20480
  v_mfma_f32_16x16x32_bf16 v[52:55], v[140:143], v[108:111], v[52:55]
  buffer_load_dwordx4 v[168:171], v0, s[52:55], s34 offen offset:256 sc1
  v_mfma_f32_16x16x32_bf16 v[56:59], v[136:139], v[112:115], v[56:59]
  ds_read_b128 v[92:95], v7 offset:22528
  v_mfma_f32_16x16x32_bf16 v[60:63], v[140:143], v[112:115], v[60:63]
  buffer_load_dwordx4 v[172:175], v0, s[52:55], s35 offen offset:256 sc1
  v_mfma_f32_16x16x32_bf16 v[64:67], v[136:139], v[116:119], v[64:67]
  ds_read_b128 v[96:99], v7 offset:24576
  v_mfma_f32_16x16x32_bf16 v[68:71], v[140:143], v[116:119], v[68:71]
  s_waitcnt lgkmcnt(3)
  v_mfma_f32_16x16x32_bf16 v[72:75], v[136:139], v[120:123], v[72:75]
  ds_read_b128 v[100:103], v7 offset:26624
  v_mfma_f32_16x16x32_bf16 v[76:79], v[140:143], v[120:123], v[76:79]
  v_mfma_f32_16x16x32_bf16 v[80:83], v[136:139], v[124:127], v[80:83]
  ds_read_b128 v[104:107], v7 offset:28672
  v_mfma_f32_16x16x32_bf16 v[84:87], v[140:143], v[124:127], v[84:87]
  s_waitcnt vmcnt(6)
  s_waitcnt lgkmcnt(2)
  v_mfma_f32_16x16x32_bf16 v[48:51], v[144:147], v[88:91], v[48:51]
  ds_read_b128 v[108:111], v8 offset:20480
  v_mfma_f32_16x16x32_bf16 v[52:55], v[148:151], v[88:91], v[52:55]
  buffer_load_dwordx4 v[176:179], v0, s[52:55], s34 offen offset:512 sc1
  v_mfma_f32_16x16x32_bf16 v[56:59], v[144:147], v[92:95], v[56:59]
  ds_read_b128 v[112:115], v8 offset:22528
  v_mfma_f32_16x16x32_bf16 v[60:63], v[148:151], v[92:95], v[60:63]
  buffer_load_dwordx4 v[180:183], v0, s[52:55], s35 offen offset:512 sc1
  v_mfma_f32_16x16x32_bf16 v[64:67], v[144:147], v[96:99], v[64:67]
  ds_read_b128 v[116:119], v8 offset:24576
  v_mfma_f32_16x16x32_bf16 v[68:71], v[148:151], v[96:99], v[68:71]
  s_waitcnt lgkmcnt(3)
  v_mfma_f32_16x16x32_bf16 v[72:75], v[144:147], v[100:103], v[72:75]
  ds_read_b128 v[120:123], v8 offset:26624
  v_mfma_f32_16x16x32_bf16 v[76:79], v[148:151], v[100:103], v[76:79]
  v_mfma_f32_16x16x32_bf16 v[80:83], v[144:147], v[104:107], v[80:83]
  ds_read_b128 v[124:127], v8 offset:28672
  v_mfma_f32_16x16x32_bf16 v[84:87], v[148:151], v[104:107], v[84:87]
  s_waitcnt vmcnt(6)
  s_waitcnt lgkmcnt(2)
  v_mfma_f32_16x16x32_bf16 v[48:51], v[152:155], v[108:111], v[48:51]
  ds_read_b128 v[88:91], v7 offset:30720
  v_mfma_f32_16x16x32_bf16 v[52:55], v[156:159], v[108:111], v[52:55]
  buffer_load_dwordx4 v[184:187], v0, s[52:55], s34 offen offset:768 sc1
  v_mfma_f32_16x16x32_bf16 v[56:59], v[152:155], v[112:115], v[56:59]
  ds_read_b128 v[92:95], v7 offset:32768
  v_mfma_f32_16x16x32_bf16 v[60:63], v[156:159], v[112:115], v[60:63]
  buffer_load_dwordx4 v[188:191], v0, s[52:55], s35 offen offset:768 sc1
  v_mfma_f32_16x16x32_bf16 v[64:67], v[152:155], v[116:119], v[64:67]
  ds_read_b128 v[96:99], v7 offset:34816
  v_mfma_f32_16x16x32_bf16 v[68:71], v[156:159], v[116:119], v[68:71]
  s_waitcnt lgkmcnt(3)
  v_mfma_f32_16x16x32_bf16 v[72:75], v[152:155], v[120:123], v[72:75]
  ds_read_b128 v[100:103], v7 offset:36864
  v_mfma_f32_16x16x32_bf16 v[76:79], v[156:159], v[120:123], v[76:79]
  v_mfma_f32_16x16x32_bf16 v[80:83], v[152:155], v[124:127], v[80:83]
  ds_read_b128 v[104:107], v7 offset:38912
  v_mfma_f32_16x16x32_bf16 v[84:87], v[156:159], v[124:127], v[84:87]
  s_waitcnt vmcnt(6)
  s_waitcnt lgkmcnt(2)
  v_mfma_f32_16x16x32_bf16 v[48:51], v[160:163], v[88:91], v[48:51]
  ds_read_b128 v[108:111], v8 offset:30720
  v_mfma_f32_16x16x32_bf16 v[52:55], v[164:167], v[88:91], v[52:55]
  s_sub_u32 s34, s34, 4096
  buffer_load_dwordx4 v[128:131], v0, s[52:55], s34 offen offset:0 sc1
  v_mfma_f32_16x16x32_bf16 v[56:59], v[160:163], v[92:95], v[56:59]
  ds_read_b128 v[112:115], v8 offset:32768
  v_mfma_f32_16x16x32_bf16 v[60:63], v[164:167], v[92:95], v[60:63]
  s_sub_u32 s35, s35, 4096
  buffer_load_dwordx4 v[132:135], v0, s[52:55], s35 offen offset:0 sc1
  v_mfma_f32_16x16x32_bf16 v[64:67], v[160:163], v[96:99], v[64:67]
  ds_read_b128 v[116:119], v8 offset:34816
  v_mfma_f32_16x16x32_bf16 v[68:71], v[164:167], v[96:99], v[68:71]
  s_waitcnt lgkmcnt(3)
  v_mfma_f32_16x16x32_bf16 v[72:75], v[160:163], v[100:103], v[72:75]
  ds_read_b128 v[120:123], v8 offset:36864
  v_mfma_f32_16x16x32_bf16 v[76:79], v[164:167], v[100:103], v[76:79]
  v_mfma_f32_16x16x32_bf16 v[80:83], v[160:163], v[104:107], v[80:83]
  ds_read_b128 v[124:127], v8 offset:38912
  v_mfma_f32_16x16x32_bf16 v[84:87], v[164:167], v[104:107], v[84:87]
  s_waitcnt vmcnt(6)
  s_waitcnt lgkmcnt(2)
  v_mfma_f32_16x16x32_bf16 v[48:51], v[168:171], v[108:111], v[48:51]
  ds_read_b128 v[88:91], v7 offset:40960
  v_mfma_f32_16x16x32_bf16 v[52:55], v[172:175], v[108:111], v[52:55]
  buffer_load_dwordx4 v[136:139], v0, s[52:55], s34 offen offset:256 sc1
  v_mfma_f32_16x16x32_bf16 v[56:59], v[168:171], v[112:115], v[56:59]
  ds_read_b128 v[92:95], v7 offset:43008
  v_mfma_f32_16x16x32_bf16 v[60:63], v[172:175], v[112:115], v[60:63]
  buffer_load_dwordx4 v[140:143], v0, s[52:55], s35 offen offset:256 sc1
  v_mfma_f32_16x16x32_bf16 v[64:67], v[168:171], v[116:119], v[64:67]
  ds_read_b128 v[96:99], v7 offset:45056
  v_mfma_f32_16x16x32_bf16 v[68:71], v[172:175], v[116:119], v[68:71]
  s_waitcnt lgkmcnt(3)
  v_mfma_f32_16x16x32_bf16 v[72:75], v[168:171], v[120:123], v[72:75]
  ds_read_b128 v[100:103], v7 offset:47104
  v_mfma_f32_16x16x32_bf16 v[76:79], v[172:175], v[120:123], v[76:79]
  v_mfma_f32_16x16x32_bf16 v[80:83], v[168:171], v[124:127], v[80:83]
  ds_read_b128 v[104:107], v7 offset:49152
  v_mfma_f32_16x16x32_bf16 v[84:87], v[172:175], v[124:127], v[84:87]
  s_waitcnt vmcnt(6)
  s_waitcnt lgkmcnt(2)
  v_mfma_f32_16x16x32_bf16 v[48:51], v[176:179], v[88:91], v[48:51]
  ds_read_b128 v[108:111], v8 offset:40960
  v_mfma_f32_16x16x32_bf16 v[52:55], v[180:183], v[88:91], v[52:55]
  buffer_load_dwordx4 v[144:147], v0, s[52:55], s34 offen offset:512 sc1
  v_mfma_f32_16x16x32_bf16 v[56:59], v[176:179], v[92:95], v[56:59]
  ds_read_b128 v[112:115], v8 offset:43008
  v_mfma_f32_16x16x32_bf16 v[60:63], v[180:183], v[92:95], v[60:63]
  buffer_load_dwordx4 v[148:151], v0, s[52:55], s35 offen offset:512 sc1
  v_mfma_f32_16x16x32_bf16 v[64:67], v[176:179], v[96:99], v[64:67]
  ds_read_b128 v[116:119], v8 offset:45056
  v_mfma_f32_16x16x32_bf16 v[68:71], v[180:183], v[96:99], v[68:71]
  s_waitcnt lgkmcnt(3)
  v_mfma_f32_16x16x32_bf16 v[72:75], v[176:179], v[100:103], v[72:75]
  ds_read_b128 v[120:123], v8 offset:47104
  v_mfma_f32_16x16x32_bf16 v[76:79], v[180:183], v[100:103], v[76:79]
  v_mfma_f32_16x16x32_bf16 v[80:83], v[176:179], v[104:107], v[80:83]
  ds_read_b128 v[124:127], v8 offset:49152
  v_mfma_f32_16x16x32_bf16 v[84:87], v[180:183], v[104:107], v[84:87]
  s_waitcnt vmcnt(6)
  s_barrier
  s_waitcnt lgkmcnt(2)
  v_mfma_f32_16x16x32_bf16 v[48:51], v[184:187], v[108:111], v[48:51]
  ds_read_b128 v[88:91], v5 offset:0
  v_mfma_f32_16x16x32_bf16 v[52:55], v[188:191], v[108:111], v[52:55]
  buffer_load_dwordx4 v[152:155], v0, s[52:55], s34 offen offset:768 sc1
  v_mfma_f32_16x16x32_bf16 v[56:59], v[184:187], v[112:115], v[56:59]
  ds_read_b128 v[92:95], v5 offset:2048
  v_mfma_f32_16x16x32_bf16 v[60:63], v[188:191], v[112:115], v[60:63]
  buffer_load_dwordx4 v[156:159], v0, s[52:55], s35 offen offset:768 sc1
  v_mfma_f32_16x16x32_bf16 v[64:67], v[184:187], v[116:119], v[64:67]
  ds_read_b128 v[96:99], v5 offset:4096
  v_mfma_f32_16x16x32_bf16 v[68:71], v[188:191], v[116:119], v[68:71]
  s_waitcnt lgkmcnt(3)
  v_mfma_f32_16x16x32_bf16 v[72:75], v[184:187], v[120:123], v[72:75]
  ds_read_b128 v[100:103], v5 offset:6144
  v_mfma_f32_16x16x32_bf16 v[76:79], v[188:191], v[120:123], v[76:79]
  v_mfma_f32_16x16x32_bf16 v[80:83], v[184:187], v[124:127], v[80:83]
  ds_read_b128 v[104:107], v5 offset:8192
  v_mfma_f32_16x16x32_bf16 v[84:87], v[188:191], v[124:127], v[84:87]
  s_waitcnt vmcnt(6)
  s_waitcnt lgkmcnt(2)
  v_mfma_f32_16x16x32_bf16 v[48:51], v[128:131], v[88:91], v[48:51]
  ds_read_b128 v[108:111], v6 offset:0
  v_mfma_f32_16x16x32_bf16 v[52:55], v[132:135], v[88:91], v[52:55]
  v_mfma_f32_16x16x32_bf16 v[56:59], v[128:131], v[92:95], v[56:59]
  ds_read_b128 v[112:115], v6 offset:2048
  v_mfma_f32_16x16x32_bf16 v[60:63], v[132:135], v[92:95], v[60:63]
  v_mfma_f32_16x16x32_bf16 v[64:67], v[128:131], v[96:99], v[64:67]
  ds_read_b128 v[116:119], v6 offset:4096
  v_mfma_f32_16x16x32_bf16 v[68:71], v[132:135], v[96:99], v[68:71]
  s_waitcnt lgkmcnt(3)
  v_mfma_f32_16x16x32_bf16 v[72:75], v[128:131], v[100:103], v[72:75]
  ds_read_b128 v[120:123], v6 offset:6144
  v_mfma_f32_16x16x32_bf16 v[76:79], v[132:135], v[100:103], v[76:79]
  v_mfma_f32_16x16x32_bf16 v[80:83], v[128:131], v[104:107], v[80:83]
  ds_read_b128 v[124:127], v6 offset:8192
  v_mfma_f32_16x16x32_bf16 v[84:87], v[132:135], v[104:107], v[84:87]
  s_waitcnt vmcnt(4)
  s_waitcnt lgkmcnt(2)
  v_mfma_f32_16x16x32_bf16 v[48:51], v[136:139], v[108:111], v[48:51]
  ds_read_b128 v[88:91], v5 offset:10240
  v_mfma_f32_16x16x32_bf16 v[52:55], v[140:143], v[108:111], v[52:55]
  v_mfma_f32_16x16x32_bf16 v[56:59], v[136:139], v[112:115], v[56:59]
  ds_read_b128 v[92:95], v5 offset:12288
  v_mfma_f32_16x16x32_bf16 v[60:63], v[140:143], v[112:115], v[60:63]
  v_mfma_f32_16x16x32_bf16 v[64:67], v[136:139], v[116:119], v[64:67]
  ds_read_b128 v[96:99], v5 offset:14336
  v_mfma_f32_16x16x32_bf16 v[68:71], v[140:143], v[116:119], v[68:71]
  s_waitcnt lgkmcnt(3)
  v_mfma_f32_16x16x32_bf16 v[72:75], v[136:139], v[120:123], v[72:75]
  ds_read_b128 v[100:103], v5 offset:16384
  v_mfma_f32_16x16x32_bf16 v[76:79], v[140:143], v[120:123], v[76:79]
  v_mfma_f32_16x16x32_bf16 v[80:83], v[136:139], v[124:127], v[80:83]
  ds_read_b128 v[104:107], v5 offset:18432
  v_mfma_f32_16x16x32_bf16 v[84:87], v[140:143], v[124:127], v[84:87]
  s_waitcnt vmcnt(2)
  s_waitcnt lgkmcnt(2)
  v_mfma_f32_16x16x32_bf16 v[48:51], v[144:147], v[88:91], v[48:51]
  ds_read_b128 v[108:111], v6 offset:10240
  v_mfma_f32_16x16x32_bf16 v[52:55], v[148:151], v[88:91], v[52:55]
  v_mfma_f32_16x16x32_bf16 v[56:59], v[144:147], v[92:95], v[56:59]
  ds_read_b128 v[112:115], v6 offset:12288
  v_mfma_f32_16x16x32_bf16 v[60:63], v[148:151], v[92:95], v[60:63]
  v_mfma_f32_16x16x32_bf16 v[64:67], v[144:147], v[96:99], v[64:67]
  ds_read_b128 v[116:119], v6 offset:14336
  v_mfma_f32_16x16x32_bf16 v[68:71], v[148:151], v[96:99], v[68:71]
  s_waitcnt lgkmcnt(3)
  v_mfma_f32_16x16x32_bf16 v[72:75], v[144:147], v[100:103], v[72:75]
  ds_read_b128 v[120:123], v6 offset:16384
  v_mfma_f32_16x16x32_bf16 v[76:79], v[148:151], v[100:103], v[76:79]
  v_mfma_f32_16x16x32_bf16 v[80:83], v[144:147], v[104:107], v[80:83]
  ds_read_b128 v[124:127], v6 offset:18432
  v_mfma_f32_16x16x32_bf16 v[84:87], v[148:151], v[104:107], v[84:87]
  s_waitcnt vmcnt(0)
  s_waitcnt lgkmcnt(2)
  v_mfma_f32_16x16x32_bf16 v[48:51], v[152:155], v[108:111], v[48:51]
  v_mfma_f32_16x16x32_bf16 v[52:55], v[156:159], v[108:111], v[52:55]
  v_mfma_f32_16x16x32_bf16 v[56:59], v[152:155], v[112:115], v[56:59]
  v_mfma_f32_16x16x32_bf16 v[60:63], v[156:159], v[112:115], v[60:63]
  v_mfma_f32_16x16x32_bf16 v[64:67], v[152:155], v[116:119], v[64:67]
  v_mfma_f32_16x16x32_bf16 v[68:71], v[156:159], v[116:119], v[68:71]
  s_waitcnt lgkmcnt(0)
  v_mfma_f32_16x16x32_bf16 v[72:75], v[152:155], v[120:123], v[72:75]
  v_mfma_f32_16x16x32_bf16 v[76:79], v[156:159], v[120:123], v[76:79]
  v_mfma_f32_16x16x32_bf16 v[80:83], v[152:155], v[124:127], v[80:83]
  v_mfma_f32_16x16x32_bf16 v[84:87], v[156:159], v[124:127], v[84:87]
  v_fmac_f32 v49, v16, v48
  v_fmac_f32 v57, v17, v56
  v_fmac_f32 v65, v18, v64
  s_nop 1
  v_fmac_f32 v73, v19, v72
  s_nop 0
  v_fmac_f32 v81, v20, v80
  v_fmac_f32_dpp v49, v48, v21 quad_perm:[1,0,3,2] row_mask:0xf bank_mask:0xf
  v_fmac_f32_dpp v57, v56, v22 quad_perm:[1,0,3,2] row_mask:0xf bank_mask:0xf
  v_fmac_f32_dpp v65, v64, v23 quad_perm:[1,0,3,2] row_mask:0xf bank_mask:0xf
  v_fmac_f32_dpp v73, v72, v24 quad_perm:[1,0,3,2] row_mask:0xf bank_mask:0xf
  v_fmac_f32_dpp v81, v80, v25 quad_perm:[1,0,3,2] row_mask:0xf bank_mask:0xf
  v_fmac_f32 v50, v16, v49
  v_fmac_f32 v58, v17, v57
  v_fmac_f32 v66, v18, v65
  v_fmac_f32 v74, v19, v73
  v_fmac_f32_e64 v82, v20, v81
  v_fmac_f32_dpp v50, v49, v21 quad_perm:[1,0,3,2] row_mask:0xf bank_mask:0xf
  v_fmac_f32_dpp v58, v57, v22 quad_perm:[1,0,3,2] row_mask:0xf bank_mask:0xf
  v_fmac_f32_dpp v66, v65, v23 quad_perm:[1,0,3,2] row_mask:0xf bank_mask:0xf
  v_fmac_f32_dpp v74, v73, v24 quad_perm:[1,0,3,2] row_mask:0xf bank_mask:0xf
  v_fmac_f32_dpp v82, v81, v25 quad_perm:[1,0,3,2] row_mask:0xf bank_mask:0xf
  v_fmac_f32 v51, v16, v50
  v_fmac_f32 v59, v17, v58
  v_fmac_f32 v67, v18, v66
  v_fmac_f32 v75, v19, v74
  v_fmac_f32_e64 v83, v20, v82
  v_fmac_f32_dpp v51, v50, v21 quad_perm:[1,0,3,2] row_mask:0xf bank_mask:0xf
  v_fmac_f32_dpp v59, v58, v22 quad_perm:[1,0,3,2] row_mask:0xf bank_mask:0xf
  v_fmac_f32_dpp v67, v66, v23 quad_perm:[1,0,3,2] row_mask:0xf bank_mask:0xf
  v_fmac_f32_dpp v75, v74, v24 quad_perm:[1,0,3,2] row_mask:0xf bank_mask:0xf
  v_fmac_f32_dpp v83, v82, v25 quad_perm:[1,0,3,2] row_mask:0xf bank_mask:0xf
  v_fmac_f32 v52, v16, v51
  v_fmac_f32 v60, v17, v59
  v_fmac_f32 v68, v18, v67
  v_fmac_f32 v76, v19, v75
  v_fmac_f32_e64 v84, v20, v83
  v_fmac_f32_dpp v52, v51, v21 quad_perm:[1,0,3,2] row_mask:0xf bank_mask:0xf
  v_fmac_f32_dpp v60, v59, v22 quad_perm:[1,0,3,2] row_mask:0xf bank_mask:0xf
  v_fmac_f32_dpp v68, v67, v23 quad_perm:[1,0,3,2] row_mask:0xf bank_mask:0xf
  v_fmac_f32_dpp v76, v75, v24 quad_perm:[1,0,3,2] row_mask:0xf bank_mask:0xf
  v_fmac_f32_dpp v84, v83, v25 quad_perm:[1,0,3,2] row_mask:0xf bank_mask:0xf
  v_fmac_f32 v53, v16, v52
  v_fmac_f32 v61, v17, v60
  v_fmac_f32 v69, v18, v68
  v_fmac_f32 v77, v19, v76
  v_fmac_f32_e64 v85, v20, v84
  v_fmac_f32_dpp v53, v52, v21 quad_perm:[1,0,3,2] row_mask:0xf bank_mask:0xf
  v_fmac_f32_dpp v61, v60, v22 quad_perm:[1,0,3,2] row_mask:0xf bank_mask:0xf
  v_fmac_f32_dpp v69, v68, v23 quad_perm:[1,0,3,2] row_mask:0xf bank_mask:0xf
  v_fmac_f32_dpp v77, v76, v24 quad_perm:[1,0,3,2] row_mask:0xf bank_mask:0xf
  v_fmac_f32_dpp v85, v84, v25 quad_perm:[1,0,3,2] row_mask:0xf bank_mask:0xf
  v_fmac_f32 v54, v16, v53
  v_fmac_f32 v62, v17, v61
  v_fmac_f32 v70, v18, v69
  v_fmac_f32 v78, v19, v77
  v_fmac_f32_e64 v86, v20, v85
  v_fmac_f32_dpp v54, v53, v21 quad_perm:[1,0,3,2] row_mask:0xf bank_mask:0xf
  v_fmac_f32_dpp v62, v61, v22 quad_perm:[1,0,3,2] row_mask:0xf bank_mask:0xf
  v_fmac_f32_dpp v70, v69, v23 quad_perm:[1,0,3,2] row_mask:0xf bank_mask:0xf
  v_fmac_f32_dpp v78, v77, v24 quad_perm:[1,0,3,2] row_mask:0xf bank_mask:0xf
  v_fmac_f32_dpp v86, v85, v25 quad_perm:[1,0,3,2] row_mask:0xf bank_mask:0xf
  v_fmac_f32 v55, v16, v54
  v_fmac_f32 v63, v17, v62
  v_fmac_f32 v71, v18, v70
  v_fmac_f32 v79, v19, v78
  v_fmac_f32_e64 v87, v20, v86
  v_fmac_f32_dpp v55, v54, v21 quad_perm:[1,0,3,2] row_mask:0xf bank_mask:0xf
  v_fmac_f32_dpp v63, v62, v22 quad_perm:[1,0,3,2] row_mask:0xf bank_mask:0xf
  v_fmac_f32_dpp v71, v70, v23 quad_perm:[1,0,3,2] row_mask:0xf bank_mask:0xf
  v_fmac_f32_dpp v79, v78, v24 quad_perm:[1,0,3,2] row_mask:0xf bank_mask:0xf
  v_fmac_f32_dpp v87, v86, v25 quad_perm:[1,0,3,2] row_mask:0xf bank_mask:0xf
  v_add_u32 v11, 152320, v9
  v_min_u32 v12, 39, v1
  v_mul_u32_u24 v44, 48, v12
  s_lshl_b32 s12, s7, 3
  s_add_u32 s12, s12, 149504
  v_add_u32 v44, s12, v44
  ds_write_b32 v11, v55 offset:0
  ds_write_b32 v11, v63 offset:1152
  ds_write_b32 v11, v71 offset:2304
  ds_write_b32 v11, v79 offset:3456
  ds_write_b32 v11, v87 offset:4608
  v_mul_u32_u24 v46, 144, v12
  v_add_u32 v46, 152320, v46
  s_waitcnt lgkmcnt(0)
  s_barrier
  ds_read_b128 v[90:93], v46 offset:0
  ds_read_b128 v[94:97], v46 offset:16
  ds_read_b128 v[98:101], v46 offset:32
  ds_read_b128 v[102:105], v46 offset:48
  ds_read_b128 v[106:109], v46 offset:64
  ds_read_b128 v[110:113], v46 offset:80
  ds_read_b128 v[114:117], v46 offset:96
  ds_read_b128 v[118:121], v46 offset:112
  s_waitcnt lgkmcnt(7)
  v_pk_fma_f32 v[92:93], v[90:91], v[36:37], v[92:93] op_sel:[1,1,0] op_sel_hi:[0,1,1] neg_lo:[0,1,0]
  v_pk_fma_f32 v[92:93], v[90:91], v[36:37], v[92:93] op_sel:[0,0,0] op_sel_hi:[1,0,1]
  s_waitcnt lgkmcnt(6)
  v_pk_fma_f32 v[94:95], v[92:93], v[36:37], v[94:95] op_sel:[1,1,0] op_sel_hi:[0,1,1] neg_lo:[0,1,0]
  v_pk_fma_f32 v[94:95], v[92:93], v[36:37], v[94:95] op_sel:[0,0,0] op_sel_hi:[1,0,1]
  v_pk_fma_f32 v[96:97], v[94:95], v[36:37], v[96:97] op_sel:[1,1,0] op_sel_hi:[0,1,1] neg_lo:[0,1,0]
  v_pk_fma_f32 v[96:97], v[94:95], v[36:37], v[96:97] op_sel:[0,0,0] op_sel_hi:[1,0,1]
  s_waitcnt lgkmcnt(5)
  v_pk_fma_f32 v[98:99], v[96:97], v[36:37], v[98:99] op_sel:[1,1,0] op_sel_hi:[0,1,1] neg_lo:[0,1,0]
  v_pk_fma_f32 v[98:99], v[96:97], v[36:37], v[98:99] op_sel:[0,0,0] op_sel_hi:[1,0,1]
  v_pk_fma_f32 v[100:101], v[98:99], v[36:37], v[100:101] op_sel:[1,1,0] op_sel_hi:[0,1,1] neg_lo:[0,1,0]
  v_pk_fma_f32 v[100:101], v[98:99], v[36:37], v[100:101] op_sel:[0,0,0] op_sel_hi:[1,0,1]
  s_waitcnt lgkmcnt(4)
  v_pk_fma_f32 v[102:103], v[100:101], v[36:37], v[102:103] op_sel:[1,1,0] op_sel_hi:[0,1,1] neg_lo:[0,1,0]
  v_pk_fma_f32 v[102:103], v[100:101], v[36:37], v[102:103] op_sel:[0,0,0] op_sel_hi:[1,0,1]
  v_pk_fma_f32 v[104:105], v[102:103], v[36:37], v[104:105] op_sel:[1,1,0] op_sel_hi:[0,1,1] neg_lo:[0,1,0]
  v_pk_fma_f32 v[104:105], v[102:103], v[36:37], v[104:105] op_sel:[0,0,0] op_sel_hi:[1,0,1]
  s_waitcnt lgkmcnt(3)
  v_pk_fma_f32 v[106:107], v[104:105], v[36:37], v[106:107] op_sel:[1,1,0] op_sel_hi:[0,1,1] neg_lo:[0,1,0]
  v_pk_fma_f32 v[106:107], v[104:105], v[36:37], v[106:107] op_sel:[0,0,0] op_sel_hi:[1,0,1]
  v_pk_fma_f32 v[108:109], v[106:107], v[36:37], v[108:109] op_sel:[1,1,0] op_sel_hi:[0,1,1] neg_lo:[0,1,0]
  v_pk_fma_f32 v[108:109], v[106:107], v[36:37], v[108:109] op_sel:[0,0,0] op_sel_hi:[1,0,1]
  s_waitcnt lgkmcnt(2)
  v_pk_fma_f32 v[110:111], v[108:109], v[36:37], v[110:111] op_sel:[1,1,0] op_sel_hi:[0,1,1] neg_lo:[0,1,0]
  v_pk_fma_f32 v[110:111], v[108:109], v[36:37], v[110:111] op_sel:[0,0,0] op_sel_hi:[1,0,1]
  v_pk_fma_f32 v[112:113], v[110:111], v[36:37], v[112:113] op_sel:[1,1,0] op_sel_hi:[0,1,1] neg_lo:[0,1,0]
  v_pk_fma_f32 v[112:113], v[110:111], v[36:37], v[112:113] op_sel:[0,0,0] op_sel_hi:[1,0,1]
  s_waitcnt lgkmcnt(1)
  v_pk_fma_f32 v[114:115], v[112:113], v[36:37], v[114:115] op_sel:[1,1,0] op_sel_hi:[0,1,1] neg_lo:[0,1,0]
  v_pk_fma_f32 v[114:115], v[112:113], v[36:37], v[114:115] op_sel:[0,0,0] op_sel_hi:[1,0,1]
  v_pk_fma_f32 v[116:117], v[114:115], v[36:37], v[116:117] op_sel:[1,1,0] op_sel_hi:[0,1,1] neg_lo:[0,1,0]
  v_pk_fma_f32 v[116:117], v[114:115], v[36:37], v[116:117] op_sel:[0,0,0] op_sel_hi:[1,0,1]
  s_waitcnt lgkmcnt(0)
  v_pk_fma_f32 v[118:119], v[116:117], v[36:37], v[118:119] op_sel:[1,1,0] op_sel_hi:[0,1,1] neg_lo:[0,1,0]
  v_pk_fma_f32 v[118:119], v[116:117], v[36:37], v[118:119] op_sel:[0,0,0] op_sel_hi:[1,0,1]
  v_pk_fma_f32 v[120:121], v[118:119], v[36:37], v[120:121] op_sel:[1,1,0] op_sel_hi:[0,1,1] neg_lo:[0,1,0]
  v_pk_fma_f32 v[120:121], v[118:119], v[36:37], v[120:121] op_sel:[0,0,0] op_sel_hi:[1,0,1]
  v_mov_b32 v122, s8
  v_mov_b32 v123, s8
  s_add_u32 s12, s83, 337920
  s_mov_b64 exec, s[96:97]
  buffer_store_dwordx4 v[120:123], v2, s[52:55], s12 offen sc1
  s_mov_b64 exec, -1
  v_subrev_u32 v46, 8576, v46
  v_mov_b32 v88, 0
  v_mov_b32 v89, 0
  s_mov_b32 exec_hi, 0xff
  s_cmp_eq_u32 s7, 1
  s_cbranch_scc1 w1_66
  s_cmp_eq_u32 s7, 2
  s_cbranch_scc1 w2_67
  s_cmp_eq_u32 s7, 3
  s_cbranch_scc1 w3_68
w0_65:
  ds_write_b128 v46, v[88:91] offset:0
  ds_write_b128 v46, v[92:95] offset:16
  s_branch join_64
w1_66:
  ds_write_b128 v46, v[96:99] offset:32
  ds_write_b128 v46, v[100:103] offset:48
  s_branch join_64
w2_67:
  ds_write_b128 v46, v[104:107] offset:64
  ds_write_b128 v46, v[108:111] offset:80
  s_branch join_64
w3_68:
  ds_write_b128 v46, v[112:115] offset:96
  ds_write_b128 v46, v[116:119] offset:112
join_64:
  s_mov_b32 exec_hi, -1
  v_add_u32 v46, 143744, v9
  ds_read_b32 v244, v46 offset:0
  ds_read_b32 v246, v46 offset:1152
  ds_read_b32 v248, v46 offset:2304
  ds_read_b32 v250, v46 offset:3456
  ds_read_b32 v252, v46 offset:4608
  v_and_b32 v43, 1, v3
  v_cvt_f32_u32 v43, v43
  v_fma_f32 v43, 2.0, v43, -1.0
  s_waitcnt lgkmcnt(0)
  s_nop 0
  v_mul_f32_dpp v245, v244, v43 quad_perm:[1,0,3,2] row_mask:0xf bank_mask:0xf
  v_mul_f32_dpp v247, v246, v43 quad_perm:[1,0,3,2] row_mask:0xf bank_mask:0xf
  v_mul_f32_dpp v249, v248, v43 quad_perm:[1,0,3,2] row_mask:0xf bank_mask:0xf
  v_mul_f32_dpp v251, v250, v43 quad_perm:[1,0,3,2] row_mask:0xf bank_mask:0xf
  v_mul_f32_dpp v253, v252, v43 quad_perm:[1,0,3,2] row_mask:0xf bank_mask:0xf
  s_and_b32 vcc_lo, s1, 7
  s_lshl_b32 vcc_lo, vcc_lo, 2
  s_add_u32 vcc_lo, vcc_lo, s7
  s_lshl_b32 vcc_lo, vcc_lo, 11
  v_lshl_add_u32 v15, v3, 7, vcc_lo
  v_min_u32 v15, L_codeend-L_pc-4, v15
  s_mov_b64 exec, 0xffff
  global_load_dword a250, v15, s[98:99]
  s_mov_b64 exec, -1
  s_lshl_b32 s90, s7, 2
  s_sub_u32 s90, 12, s90
  s_mul_i32 s90, s90, 640
  s_add_u32 s90, s90, s83
  s_add_u32 s90, s90, 327680
  v_min_u32 v42, 39, v1
  v_lshlrev_b32 v42, 4, v42
  buffer_load_dwordx3 v[88:90], v42, s[52:55], s90 offen offset:0 sc1
  buffer_load_dwordx3 v[92:94], v42, s[52:55], s90 offen offset:640 sc1
  buffer_load_dwordx3 v[96:98], v42, s[52:55], s90 offen offset:1280 sc1
  buffer_load_dwordx3 v[100:102], v42, s[52:55], s90 offen offset:1920 sc1
  v_lshrrev_b32_e64 v11, 1, v3
  v_mul_u32_u24 v12, 80, v11
  v_add_u32 v12, 160640, v12
  v_mul_u32_u24_e64 v11, 48, v11
  v_add_u32 v11, 149504, v11
  ds_read_b128 v[128:131], v12 offset:0
  ds_read_b128 v[132:135], v12 offset:16
  ds_read_b128 v[136:139], v12 offset:32
  ds_read_b128 v[140:143], v12 offset:48
  ds_read_b128 v[144:147], v12 offset:640
  ds_read_b128 v[148:151], v12 offset:656
  ds_read_b128 v[152:155], v12 offset:672
  ds_read_b128 v[156:159], v12 offset:688
  ds_read_b128 v[160:163], v12 offset:1280
  ds_read_b128 v[164:167], v12 offset:1296
  ds_read_b128 v[168:171], v12 offset:1312
  ds_read_b128 v[172:175], v12 offset:1328
  ds_read_b128 v[176:179], v12 offset:1920
  ds_read_b128 v[180:183], v12 offset:1936
  ds_read_b128 v[184:187], v12 offset:1952
  ds_read_b128 v[188:191], v12 offset:1968
  ds_read_b128 v[104:107], v12 offset:2560
  ds_read_b128 v[108:111], v12 offset:2576
  ds_read_b128 v[112:115], v12 offset:2592
  ds_read_b128 v[116:119], v12 offset:2608
  v_accvgpr_read_b32 v254, a240
  v_accvgpr_read_b32 v255, a241
  v_accvgpr_read_b32 v47, a242
  s_waitcnt vmcnt(0)
  v_min3_u32 v14, v90, v94, s8
  v_max3_u32 v15, v90, v94, s8
  v_min3_u32 v14, v14, v98, v102
  v_max3_u32 v15, v15, v98, v102
  v_cmp_ne_u32 vcc, v14, v15
  s_cbranch_vccz ok_70
again_69:
  buffer_load_dwordx3 v[88:90], v42, s[52:55], s90 offen offset:0 sc1
  buffer_load_dwordx3 v[92:94], v42, s[52:55], s90 offen offset:640 sc1
  buffer_load_dwordx3 v[96:98], v42, s[52:55], s90 offen offset:1280 sc1
  buffer_load_dwordx3 v[100:102], v42, s[52:55], s90 offen offset:1920 sc1
  s_sub_u32 s10, s10, 1
  s_cmp_gt_i32 s10, 0
  s_waitcnt vmcnt(0)
  v_min3_u32 v14, v90, v94, s8
  v_max3_u32 v15, v90, v94, s8
  v_min3_u32 v14, v14, v98, v102
  v_max3_u32 v15, v15, v98, v102
  v_cmp_ne_u32 vcc, v14, v15
  s_cbranch_scc0 out_71
  s_cbranch_vccnz again_69
out_71:
ok_70:
  v_pk_fma_f32 v[92:93], v[88:89], v[38:39], v[92:93] op_sel:[1,1,0] op_sel_hi:[0,1,1] neg_lo:[0,1,0]
  v_pk_fma_f32 v[92:93], v[88:89], v[38:39], v[92:93] op_sel:[0,0,0] op_sel_hi:[1,0,1]
  v_pk_fma_f32 v[96:97], v[92:93], v[38:39], v[96:97] op_sel:[1,1,0] op_sel_hi:[0,1,1] neg_lo:[0,1,0]
  v_pk_fma_f32 v[96:97], v[92:93], v[38:39], v[96:97] op_sel:[0,0,0] op_sel_hi:[1,0,1]
  v_pk_fma_f32 v[100:101], v[96:97], v[38:39], v[100:101] op_sel:[1,1,0] op_sel_hi:[0,1,1] neg_lo:[0,1,0]
  v_pk_fma_f32 v[100:101], v[96:97], v[38:39], v[100:101] op_sel:[0,0,0] op_sel_hi:[1,0,1]
  v_pk_mul_f32 v[88:89], v[100:101], v[40:41] op_sel:[1,1] op_sel_hi:[0,1] neg_lo:[0,1]
  v_pk_fma_f32 v[88:89], v[100:101], v[40:41], v[88:89] op_sel:[0,0,0] op_sel_hi:[1,0,1]
  s_mov_b32 exec_hi, 0xff
  ds_write_b64 v44, v[88:89]
  s_mov_b32 exec_hi, -1
  s_waitcnt lgkmcnt(0)
  s_barrier
  ds_read_b128 v[88:91], v11 offset:0
  ds_read_b128 v[92:95], v11 offset:16
  ds_read_b128 v[96:99], v11 offset:384
  ds_read_b128 v[100:103], v11 offset:400
  ds_read_b128 v[224:227], v11 offset:768
  ds_read_b128 v[228:231], v11 offset:784
  s_waitcnt lgkmcnt(4)
  v_pk_add_f32 v[88:89], v[88:89], v[90:91]
  v_pk_add_f32 v[92:93], v[92:93], v[94:95]
  v_pk_add_f32 v[88:89], v[88:89], v[92:93]
  v_pk_fma_f32 v[244:245], v[26:27], v[88:89], v[244:245] op_sel:[0,0,0] op_sel_hi:[1,0,1]
  v_pk_fma_f32 v[244:245], v[26:27], v[88:89], v[244:245] op_sel:[1,1,0] op_sel_hi:[0,1,1] neg_hi:[1,0,0]
  ds_read_b128 v[88:91], v11 offset:1152
  ds_read_b128 v[92:95], v11 offset:1168
  s_waitcnt lgkmcnt(4)
  v_pk_add_f32 v[96:97], v[96:97], v[98:99]
  v_pk_add_f32 v[100:101], v[100:101], v[102:103]
  v_pk_add_f32 v[96:97], v[96:97], v[100:101]
  v_pk_fma_f32 v[246:247], v[28:29], v[96:97], v[246:247] op_sel:[0,0,0] op_sel_hi:[1,0,1]
  v_pk_fma_f32 v[246:247], v[28:29], v[96:97], v[246:247] op_sel:[1,1,0] op_sel_hi:[0,1,1] neg_hi:[1,0,0]
  ds_read_b128 v[96:99], v11 offset:1536
  ds_read_b128 v[100:103], v11 offset:1552
  v_pk_fma_f32 v[48:49], v[128:129], v[244:245], v[48:49] op_sel:[0,0,0] op_sel_hi:[1,0,1]
  v_pk_fma_f32 v[50:51], v[130:131], v[244:245], v[50:51] op_sel:[0,0,0] op_sel_hi:[1,0,1]
  v_pk_fma_f32 v[52:53], v[132:133], v[244:245], v[52:53] op_sel:[0,0,0] op_sel_hi:[1,0,1]
  v_pk_fma_f32 v[54:55], v[134:135], v[244:245], v[54:55] op_sel:[0,0,0] op_sel_hi:[1,0,1]
  v_pk_fma_f32 v[48:49], v[136:137], v[244:245], v[48:49] op_sel:[0,1,0] op_sel_hi:[1,1,1]
  v_pk_fma_f32 v[50:51], v[138:139], v[244:245], v[50:51] op_sel:[0,1,0] op_sel_hi:[1,1,1]
  v_pk_fma_f32 v[52:53], v[140:141], v[244:245], v[52:53] op_sel:[0,1,0] op_sel_hi:[1,1,1]
  v_pk_fma_f32 v[54:55], v[142:143], v[244:245], v[54:55] op_sel:[0,1,0] op_sel_hi:[1,1,1]
  v_cvt_pk_bf16_f32 v120, v48, v49
  v_cvt_pk_bf16_f32 v121, v50, v51
  v_cvt_pk_bf16_f32 v122, v52, v53
  v_cvt_pk_bf16_f32 v123, v54, v55
  ds_write_b128 v254, v[120:123]
  ds_read_b64_tr_b16 v[52:53], v255
  ds_read_b64_tr_b16 v[54:55], v255 offset:640
  s_waitcnt lgkmcnt(7)
  v_pk_add_f32 v[224:225], v[224:225], v[226:227]
  v_pk_add_f32 v[228:229], v[228:229], v[230:231]
  v_pk_add_f32 v[224:225], v[224:225], v[228:229]
  v_pk_fma_f32 v[248:249], v[30:31], v[224:225], v[248:249] op_sel:[0,0,0] op_sel_hi:[1,0,1]
  v_pk_fma_f32 v[248:249], v[30:31], v[224:225], v[248:249] op_sel:[1,1,0] op_sel_hi:[0,1,1] neg_hi:[1,0,0]
  v_pk_fma_f32 v[56:57], v[144:145], v[246:247], v[56:57] op_sel:[0,0,0] op_sel_hi:[1,0,1]
  v_pk_fma_f32 v[58:59], v[146:147], v[246:247], v[58:59] op_sel:[0,0,0] op_sel_hi:[1,0,1]
  v_pk_fma_f32 v[60:61], v[148:149], v[246:247], v[60:61] op_sel:[0,0,0] op_sel_hi:[1,0,1]
  v_pk_fma_f32 v[62:63], v[150:151], v[246:247], v[62:63] op_sel:[0,0,0] op_sel_hi:[1,0,1]
  v_pk_fma_f32 v[56:57], v[152:153], v[246:247], v[56:57] op_sel:[0,1,0] op_sel_hi:[1,1,1]
  v_pk_fma_f32 v[58:59], v[154:155], v[246:247], v[58:59] op_sel:[0,1,0] op_sel_hi:[1,1,1]
  v_pk_fma_f32 v[60:61], v[156:157], v[246:247], v[60:61] op_sel:[0,1,0] op_sel_hi:[1,1,1]
  v_pk_fma_f32 v[62:63], v[158:159], v[246:247], v[62:63] op_sel:[0,1,0] op_sel_hi:[1,1,1]
  v_cvt_pk_bf16_f32 v124, v56, v57
  v_cvt_pk_bf16_f32 v125, v58, v59
  v_cvt_pk_bf16_f32 v126, v60, v61
  v_cvt_pk_bf16_f32 v127, v62, v63
  ds_write_b128 v254, v[124:127]
  ds_read_b64_tr_b16 v[60:61], v255
  ds_read_b64_tr_b16 v[62:63], v255 offset:640
  s_waitcnt lgkmcnt(8)
  v_pk_add_f32 v[88:89], v[88:89], v[90:91]
  v_pk_add_f32 v[92:93], v[92:93], v[94:95]
  v_pk_add_f32 v[88:89], v[88:89], v[92:93]
  v_pk_fma_f32 v[250:251], v[32:33], v[88:89], v[250:251] op_sel:[0,0,0] op_sel_hi:[1,0,1]
  v_pk_fma_f32 v[250:251], v[32:33], v[88:89], v[250:251] op_sel:[1,1,0] op_sel_hi:[0,1,1] neg_hi:[1,0,0]
  s_add_u32 s13, s78, 10485760
  s_waitcnt lgkmcnt(3)
  s_cmp_eq_u32 s9, 0
  s_cbranch_scc1 slow_72
  buffer_store_dwordx4 v[52:55], v47, s[52:55], s13 offen
back_73:
  v_pk_fma_f32 v[64:65], v[160:161], v[248:249], v[64:65] op_sel:[0,0,0] op_sel_hi:[1,0,1]
  v_pk_fma_f32 v[66:67], v[162:163], v[248:249], v[66:67] op_sel:[0,0,0] op_sel_hi:[1,0,1]
  v_pk_fma_f32 v[68:69], v[164:165], v[248:249], v[68:69] op_sel:[0,0,0] op_sel_hi:[1,0,1]
  v_pk_fma_f32 v[70:71], v[166:167], v[248:249], v[70:71] op_sel:[0,0,0] op_sel_hi:[1,0,1]
  v_pk_fma_f32 v[64:65], v[168:169], v[248:249], v[64:65] op_sel:[0,1,0] op_sel_hi:[1,1,1]
  v_pk_fma_f32 v[66:67], v[170:171], v[248:249], v[66:67] op_sel:[0,1,0] op_sel_hi:[1,1,1]
  v_pk_fma_f32 v[68:69], v[172:173], v[248:249], v[68:69] op_sel:[0,1,0] op_sel_hi:[1,1,1]
  v_pk_fma_f32 v[70:71], v[174:175], v[248:249], v[70:71] op_sel:[0,1,0] op_sel_hi:[1,1,1]
  v_cvt_pk_bf16_f32 v120, v64, v65
  v_cvt_pk_bf16_f32 v121, v66, v67
  v_cvt_pk_bf16_f32 v122, v68, v69
  v_cvt_pk_bf16_f32 v123, v70, v71
  ds_write_b128 v254, v[120:123]
  ds_read_b64_tr_b16 v[68:69], v255
  ds_read_b64_tr_b16 v[70:71], v255 offset:640
  v_pk_add_f32 v[96:97], v[96:97], v[98:99]
  v_pk_add_f32 v[100:101], v[100:101], v[102:103]
  v_pk_add_f32 v[96:97], v[96:97], v[100:101]
  v_pk_fma_f32 v[252:253], v[34:35], v[96:97], v[252:253] op_sel:[0,0,0] op_sel_hi:[1,0,1]
  v_pk_fma_f32 v[252:253], v[34:35], v[96:97], v[252:253] op_sel:[1,1,0] op_sel_hi:[0,1,1] neg_hi:[1,0,0]
  s_add_u32 s13, s79, 10485760
  s_waitcnt lgkmcnt(3)
  s_cmp_eq_u32 s9, 0
  s_cbranch_scc1 slow_74
  buffer_store_dwordx4 v[60:63], v47, s[52:55], s13 offen
back_75:
  v_pk_fma_f32 v[72:73], v[176:177], v[250:251], v[72:73] op_sel:[0,0,0] op_sel_hi:[1,0,1]
  v_pk_fma_f32 v[74:75], v[178:179], v[250:251], v[74:75] op_sel:[0,0,0] op_sel_hi:[1,0,1]
  v_pk_fma_f32 v[76:77], v[180:181], v[250:251], v[76:77] op_sel:[0,0,0] op_sel_hi:[1,0,1]
  v_pk_fma_f32 v[78:79], v[182:183], v[250:251], v[78:79] op_sel:[0,0,0] op_sel_hi:[1,0,1]
  v_pk_fma_f32 v[72:73], v[184:185], v[250:251], v[72:73] op_sel:[0,1,0] op_sel_hi:[1,1,1]
  v_pk_fma_f32 v[74:75], v[186:187], v[250:251], v[74:75] op_sel:[0,1,0] op_sel_hi:[1,1,1]
  v_pk_fma_f32 v[76:77], v[188:189], v[250:251], v[76:77] op_sel:[0,1,0] op_sel_hi:[1,1,1]
  v_pk_fma_f32 v[78:79], v[190:191], v[250:251], v[78:79] op_sel:[0,1,0] op_sel_hi:[1,1,1]
  v_cvt_pk_bf16_f32 v124, v72, v73
  v_cvt_pk_bf16_f32 v125, v74, v75
  v_cvt_pk_bf16_f32 v126, v76, v77
  v_cvt_pk_bf16_f32 v127, v78, v79
  ds_write_b128 v254, v[124:127]
  ds_read_b64_tr_b16 v[76:77], v255
  ds_read_b64_tr_b16 v[78:79], v255 offset:640
  s_add_u32 s13, s80, 10485760
  s_waitcnt lgkmcnt(3)
  s_cmp_eq_u32 s9, 0
  s_cbranch_scc1 slow_76
  buffer_store_dwordx4 v[68:71], v47, s[52:55], s13 offen
back_77:
  v_pk_fma_f32 v[80:81], v[104:105], v[252:253], v[80:81] op_sel:[0,0,0] op_sel_hi:[1,0,1]
  v_pk_fma_f32 v[82:83], v[106:107], v[252:253], v[82:83] op_sel:[0,0,0] op_sel_hi:[1,0,1]
  v_pk_fma_f32 v[84:85], v[108:109], v[252:253], v[84:85] op_sel:[0,0,0] op_sel_hi:[1,0,1]
  v_pk_fma_f32 v[86:87], v[110:111], v[252:253], v[86:87] op_sel:[0,0,0] op_sel_hi:[1,0,1]
  v_pk_fma_f32 v[80:81], v[112:113], v[252:253], v[80:81] op_sel:[0,1,0] op_sel_hi:[1,1,1]
  v_pk_fma_f32 v[82:83], v[114:115], v[252:253], v[82:83] op_sel:[0,1,0] op_sel_hi:[1,1,1]
  v_pk_fma_f32 v[84:85], v[116:117], v[252:253], v[84:85] op_sel:[0,1,0] op_sel_hi:[1,1,1]
  v_pk_fma_f32 v[86:87], v[118:119], v[252:253], v[86:87] op_sel:[0,1,0] op_sel_hi:[1,1,1]
  v_cvt_pk_bf16_f32 v120, v80, v81
  v_cvt_pk_bf16_f32 v121, v82, v83
  v_cvt_pk_bf16_f32 v122, v84, v85
  v_cvt_pk_bf16_f32 v123, v86, v87
  ds_write_b128 v254, v[120:123]
  ds_read_b64_tr_b16 v[84:85], v255
  ds_read_b64_tr_b16 v[86:87], v255 offset:640
  s_add_u32 s13, s81, 10485760
  s_waitcnt lgkmcnt(3)
  s_cmp_eq_u32 s9, 0
  s_cbranch_scc1 slow_78
  buffer_store_dwordx4 v[76:79], v47, s[52:55], s13 offen
back_79:
  s_add_u32 s13, s82, 10485760
  s_waitcnt lgkmcnt(0)
  s_cmp_eq_u32 s9, 0
  s_cbranch_scc1 slow_80
  buffer_store_dwordx4 v[84:87], v47, s[52:55], s13 offen
back_81:
  s_mul_i32 s13, s5, 163840
  s_mul_i32 s14, s7, 10240
  s_add_u32 s13, s13, s14
  s_add_u32 s13, s13, 10485760
  s_add_u32 s14, s7, 1
  s_and_b32 s14, s14, 3
  s_mul_i32 s15, s14, 40960
  s_add_u32 s16, s15, s13
  s_mul_i32 s15, s14, 10240
  s_add_u32 s15, s15, 102400
  v_add_u32 v44, s15, v2
  s_add_u32 s14, s7, 2
  s_and_b32 s14, s14, 3
  s_mul_i32 s15, s14, 40960
  s_add_u32 s17, s15, s13
  s_mul_i32 s15, s14, 10240
  s_add_u32 s15, s15, 107520
  v_add_u32 v45, s15, v2
  s_add_u32 s14, s7, 3
  s_and_b32 s14, s14, 3
  s_mul_i32 s15, s14, 40960
  s_add_u32 s18, s15, s13
  s_mul_i32 s15, s14, 5120
  v_add_u32 v46, s15, v2
  s_add_u32 s14, s7, 4
  s_and_b32 s14, s14, 3
  s_mul_i32 s15, s14, 40960
  s_add_u32 s19, s15, s13
  s_lshl_b32 s49, s3, 8
  s_lshl_b32 s13, s7, 6
  s_add_u32 s49, s49, s13
  s_and_b32 s13, s5, 1
  s_lshl_b32 s13, s13, 3
  s_add_u32 s49, s49, s13
  s_add_u32 s49, s49, 16384
  v_and_b32 v244, 3, v1
  v_lshlrev_b32 v244, 4, v244
  s_waitcnt vmcnt(0)
  s_add_u32 s14, s84, 16384
  v_mov_b32 v15, s8
  s_mov_b64 exec, 1
  s_cmp_eq_u32 s9, 0
  s_cbranch_scc1 slow_82
  buffer_store_dword v15, off, s[52:55], s14
back_83:
  s_mov_b64 exec, -1
  v_accvgpr_read_b32 v108, a210
  v_accvgpr_read_b32 v109, a211
  v_accvgpr_read_b32 v110, a212
  v_accvgpr_read_b32 v111, a213
  v_accvgpr_read_b32 v112, a214
  v_accvgpr_read_b32 v113, a215
  v_accvgpr_read_b32 v114, a216
  v_accvgpr_read_b32 v115, a217
  v_accvgpr_read_b32 v116, a218
  v_accvgpr_read_b32 v117, a219
  v_accvgpr_read_b32 v118, a220
  v_accvgpr_read_b32 v119, a221
  v_accvgpr_read_b32 v120, a222
  v_accvgpr_read_b32 v121, a223
  v_accvgpr_read_b32 v122, a224
  v_accvgpr_read_b32 v123, a225
  v_accvgpr_read_b32 v124, a226
  v_accvgpr_read_b32 v125, a227
  v_accvgpr_read_b32 v126, a228
  v_accvgpr_read_b32 v127, a229
  v_accvgpr_read_b32 v232, a200
  v_accvgpr_read_b32 v233, a201
  v_accvgpr_read_b32 v234, a202
  v_accvgpr_read_b32 v235, a203
  v_accvgpr_read_b32 v236, a204
  v_accvgpr_read_b32 v237, a205
  v_accvgpr_read_b32 v238, a206
  v_accvgpr_read_b32 v239, a207
  v_accvgpr_read_b32 v240, a208
  v_accvgpr_read_b32 v241, a209
  v_lshlrev_b32 v88, 16, v232
  v_and_b32 v89, 0xffff0000, v232
  v_lshlrev_b32_e64 v90, 16, v233
  v_and_b32 v91, 0xffff0000, v233
  v_lshlrev_b32_e64 v92, 16, v234
  v_and_b32 v93, 0xffff0000, v234
  v_lshlrev_b32_e64 v94, 16, v235
  v_and_b32 v95, 0xffff0000, v235
  v_lshlrev_b32_e64 v96, 16, v236
  v_and_b32 v97, 0xffff0000, v236
  v_lshlrev_b32_e64 v98, 16, v237
  v_and_b32 v99, 0xffff0000, v237
  v_lshlrev_b32_e64 v100, 16, v238
  v_and_b32 v101, 0xffff0000, v238
  v_lshlrev_b32_e64 v102, 16, v239
  v_and_b32 v103, 0xffff0000, v239
  v_lshlrev_b32_e64 v104, 16, v240
  v_and_b32 v105, 0xffff0000, v240
  v_lshlrev_b32_e64 v106, 16, v241
  v_and_b32 v107, 0xffff0000, v241
again_84:
  buffer_load_dwordx2 v[42:43], v244, s[52:55], s49 offen sc1
  s_sub_u32 s10, s10, 1
  s_cmp_gt_i32 s10, 0
  s_waitcnt vmcnt(0)
  v_xor_b32 v15, s8, v42
  v_xor_b32 v14, s8, v43
  v_or_b32 v15, v15, v14
  v_cmp_ne_u32 vcc, 0, v15
  s_cbranch_scc0 out_86
  s_cbranch_vccnz again_84
out_86:
ok_85:
  buffer_load_dwordx4 v[128:131], v2, s[52:55], s16 offen offset:0 sc1
  buffer_load_dwordx4 v[132:135], v2, s[52:55], s16 offen offset:1024 sc1
  buffer_load_dwordx4 v[136:139], v2, s[52:55], s16 offen offset:2048 sc1
  buffer_load_dwordx4 v[140:143], v2, s[52:55], s16 offen offset:3072 sc1
  s_add_u32 s16, s16, 4096
  buffer_load_dwordx4 v[144:147], v2, s[52:55], s16 offen offset:0 sc1
  buffer_load_dwordx4 v[148:151], v2, s[52:55], s16 offen offset:1024 sc1
  buffer_load_dwordx4 v[152:155], v2, s[52:55], s16 offen offset:2048 sc1
  buffer_load_dwordx4 v[156:159], v2, s[52:55], s16 offen offset:3072 sc1
  s_waitcnt vmcnt(7)
  v_mfma_f32_16x16x32_bf16 v[48:51], a[0:3], v[128:131], 0
  s_add_u32 s16, s16, 4096
  buffer_load_dwordx4 v[160:163], v2, s[52:55], s16 offen offset:0 sc1
  v_mfma_f32_16x16x32_bf16 v[52:55], a[4:7], v[128:131], 0
  v_mfma_f32_16x16x32_bf16 v[56:59], a[8:11], v[128:131], 0
  v_mfma_f32_16x16x32_bf16 v[60:63], a[12:15], v[128:131], 0
  v_mfma_f32_16x16x32_bf16 v[64:67], a[16:19], v[128:131], 0
  s_waitcnt vmcnt(7)
  v_mfma_f32_16x16x32_bf16 v[48:51], a[20:23], v[132:135], v[48:51]
  buffer_load_dwordx4 v[164:167], v2, s[52:55], s16 offen offset:1024 sc1
  v_mfma_f32_16x16x32_bf16 v[52:55], a[24:27], v[132:135], v[52:55]
  v_mfma_f32_16x16x32_bf16 v[56:59], a[28:31], v[132:135], v[56:59]
  v_mfma_f32_16x16x32_bf16 v[60:63], a[32:35], v[132:135], v[60:63]
  v_mfma_f32_16x16x32_bf16 v[64:67], a[36:39], v[132:135], v[64:67]
  s_waitcnt vmcnt(7)
  v_mfma_f32_16x16x32_bf16 v[48:51], a[40:43], v[136:139], v[48:51]
  buffer_load_dwordx4 v[168:171], v2, s[52:55], s17 offen offset:0 sc1
  v_mfma_f32_16x16x32_bf16 v[52:55], a[44:47], v[136:139], v[52:55]
  v_mfma_f32_16x16x32_bf16 v[56:59], a[48:51], v[136:139], v[56:59]
  v_mfma_f32_16x16x32_bf16 v[60:63], a[52:55], v[136:139], v[60:63]
  v_mfma_f32_16x16x32_bf16 v[64:67], a[56:59], v[136:139], v[64:67]
  s_waitcnt vmcnt(7)
  v_mfma_f32_16x16x32_bf16 v[48:51], a[60:63], v[140:143], v[48:51]
  buffer_load_dwordx4 v[172:175], v2, s[52:55], s17 offen offset:1024 sc1
  v_mfma_f32_16x16x32_bf16 v[52:55], a[64:67], v[140:143], v[52:55]
  v_mfma_f32_16x16x32_bf16 v[56:59], a[68:71], v[140:143], v[56:59]
  v_mfma_f32_16x16x32_bf16 v[60:63], a[72:75], v[140:143], v[60:63]
  v_mfma_f32_16x16x32_bf16 v[64:67], a[76:79], v[140:143], v[64:67]
  s_waitcnt vmcnt(7)
  v_mfma_f32_16x16x32_bf16 v[48:51], a[80:83], v[144:147], v[48:51]
  buffer_load_dwordx4 v[176:179], v2, s[52:55], s17 offen offset:2048 sc1
  v_mfma_f32_16x16x32_bf16 v[52:55], a[84:87], v[144:147], v[52:55]
  v_mfma_f32_16x16x32_bf16 v[56:59], a[88:91], v[144:147], v[56:59]
  v_mfma_f32_16x16x32_bf16 v[60:63], a[92:95], v[144:147], v[60:63]
  v_mfma_f32_16x16x32_bf16 v[64:67], a[96:99], v[144:147], v[64:67]
  s_waitcnt vmcnt(7)
  v_mfma_f32_16x16x32_bf16 v[48:51], a[100:103], v[148:151], v[48:51]
  buffer_load_dwordx4 v[180:183], v2, s[52:55], s17 offen offset:3072 sc1
  v_mfma_f32_16x16x32_bf16 v[52:55], a[104:107], v[148:151], v[52:55]
  v_mfma_f32_16x16x32_bf16 v[56:59], a[108:111], v[148:151], v[56:59]
  v_mfma_f32_16x16x32_bf16 v[60:63], a[112:115], v[148:151], v[60:63]
  v_mfma_f32_16x16x32_bf16 v[64:67], a[116:119], v[148:151], v[64:67]
  s_waitcnt vmcnt(7)
  v_mfma_f32_16x16x32_bf16 v[48:51], a[120:123], v[152:155], v[48:51]
  s_add_u32 s17, s17, 4096
  buffer_load_dwordx4 v[184:187], v2, s[52:55], s17 offen offset:0 sc1
  v_mfma_f32_16x16x32_bf16 v[52:55], a[124:127], v[152:155], v[52:55]
  v_mfma_f32_16x16x32_bf16 v[56:59], a[128:131], v[152:155], v[56:59]
  v_mfma_f32_16x16x32_bf16 v[60:63], a[132:135], v[152:155], v[60:63]
  v_mfma_f32_16x16x32_bf16 v[64:67], a[136:139], v[152:155], v[64:67]
  s_waitcnt vmcnt(7)
  v_mfma_f32_16x16x32_bf16 v[48:51], a[140:143], v[156:159], v[48:51]
  buffer_load_dwordx4 v[188:191], v2, s[52:55], s17 offen offset:1024 sc1
  v_mfma_f32_16x16x32_bf16 v[52:55], a[144:147], v[156:159], v[52:55]
  v_mfma_f32_16x16x32_bf16 v[56:59], a[148:151], v[156:159], v[56:59]
  v_mfma_f32_16x16x32_bf16 v[60:63], a[152:155], v[156:159], v[60:63]
  v_mfma_f32_16x16x32_bf16 v[64:67], a[156:159], v[156:159], v[64:67]
  s_waitcnt vmcnt(7)
  v_mfma_f32_16x16x32_bf16 v[48:51], a[160:163], v[160:163], v[48:51]
  buffer_load_dwordx4 v[128:131], v2, s[52:55], s17 offen offset:2048 sc1
  v_mfma_f32_16x16x32_bf16 v[52:55], a[164:167], v[160:163], v[52:55]
  v_mfma_f32_16x16x32_bf16 v[56:59], a[168:171], v[160:163], v[56:59]
  v_mfma_f32_16x16x32_bf16 v[60:63], a[172:175], v[160:163], v[60:63]
  v_mfma_f32_16x16x32_bf16 v[64:67], a[176:179], v[160:163], v[64:67]
  s_waitcnt vmcnt(7)
  v_mfma_f32_16x16x32_bf16 v[48:51], a[180:183], v[164:167], v[48:51]
  buffer_load_dwordx4 v[132:135], v2, s[52:55], s17 offen offset:3072 sc1
  v_mfma_f32_16x16x32_bf16 v[52:55], a[184:187], v[164:167], v[52:55]
  v_mfma_f32_16x16x32_bf16 v[56:59], a[188:191], v[164:167], v[56:59]
  v_mfma_f32_16x16x32_bf16 v[60:63], a[192:195], v[164:167], v[60:63]
  v_mfma_f32_16x16x32_bf16 v[64:67], a[196:199], v[164:167], v[64:67]
  s_waitcnt vmcnt(7)
  v_mfma_f32_16x16x32_bf16 v[68:71], a[0:3], v[168:171], 0
  s_add_u32 s17, s17, 4096
  buffer_load_dwordx4 v[136:139], v2, s[52:55], s17 offen offset:0 sc1
  v_mfma_f32_16x16x32_bf16 v[72:75], a[4:7], v[168:171], 0
  v_mfma_f32_16x16x32_bf16 v[76:79], a[8:11], v[168:171], 0
  v_mfma_f32_16x16x32_bf16 v[80:83], a[12:15], v[168:171], 0
  v_mfma_f32_16x16x32_bf16 v[84:87], a[16:19], v[168:171], 0
  s_waitcnt vmcnt(7)
  v_mfma_f32_16x16x32_bf16 v[68:71], a[20:23], v[172:175], v[68:71]
  ds_write_b128 v44, v[48:51] offset:0
  v_mfma_f32_16x16x32_bf16 v[72:75], a[24:27], v[172:175], v[72:75]
  ds_write_b128 v44, v[52:55] offset:1024
  v_mfma_f32_16x16x32_bf16 v[76:79], a[28:31], v[172:175], v[76:79]
  buffer_load_dwordx4 v[140:143], v2, s[52:55], s17 offen offset:1024 sc1
  v_mfma_f32_16x16x32_bf16 v[80:83], a[32:35], v[172:175], v[80:83]
  v_mfma_f32_16x16x32_bf16 v[84:87], a[36:39], v[172:175], v[84:87]
  s_waitcnt vmcnt(7)
  v_mfma_f32_16x16x32_bf16 v[68:71], a[40:43], v[176:179], v[68:71]
  ds_write_b128 v44, v[56:59] offset:2048
  v_mfma_f32_16x16x32_bf16 v[72:75], a[44:47], v[176:179], v[72:75]
  ds_write_b128 v44, v[60:63] offset:3072
  v_mfma_f32_16x16x32_bf16 v[76:79], a[48:51], v[176:179], v[76:79]
  buffer_load_dwordx4 v[144:147], v2, s[52:55], s18 offen offset:0 sc1
  v_mfma_f32_16x16x32_bf16 v[80:83], a[52:55], v[176:179], v[80:83]
  v_mfma_f32_16x16x32_bf16 v[84:87], a[56:59], v[176:179], v[84:87]
  s_waitcnt vmcnt(7)
  v_mfma_f32_16x16x32_bf16 v[68:71], a[60:63], v[180:183], v[68:71]
  ds_write_b128 v44, v[64:67] offset:4096
  v_mfma_f32_16x16x32_bf16 v[72:75], a[64:67], v[180:183], v[72:75]
  buffer_load_dwordx4 v[148:151], v2, s[52:55], s18 offen offset:1024 sc1
  v_mfma_f32_16x16x32_bf16 v[76:79], a[68:71], v[180:183], v[76:79]
  v_mfma_f32_16x16x32_bf16 v[80:83], a[72:75], v[180:183], v[80:83]
  v_mfma_f32_16x16x32_bf16 v[84:87], a[76:79], v[180:183], v[84:87]
  s_waitcnt vmcnt(7)
  v_mfma_f32_16x16x32_bf16 v[68:71], a[80:83], v[184:187], v[68:71]
  buffer_load_dwordx4 v[152:155], v2, s[52:55], s18 offen offset:2048 sc1
  v_mfma_f32_16x16x32_bf16 v[72:75], a[84:87], v[184:187], v[72:75]
  v_mfma_f32_16x16x32_bf16 v[76:79], a[88:91], v[184:187], v[76:79]
  v_mfma_f32_16x16x32_bf16 v[80:83], a[92:95], v[184:187], v[80:83]
  v_mfma_f32_16x16x32_bf16 v[84:87], a[96:99], v[184:187], v[84:87]
  s_waitcnt vmcnt(7)
  v_mfma_f32_16x16x32_bf16 v[68:71], a[100:103], v[188:191], v[68:71]
  buffer_load_dwordx4 v[156:159], v2, s[52:55], s18 offen offset:3072 sc1
  v_mfma_f32_16x16x32_bf16 v[72:75], a[104:107], v[188:191], v[72:75]
  v_mfma_f32_16x16x32_bf16 v[76:79], a[108:111], v[188:191], v[76:79]
  v_mfma_f32_16x16x32_bf16 v[80:83], a[112:115], v[188:191], v[80:83]
  v_mfma_f32_16x16x32_bf16 v[84:87], a[116:119], v[188:191], v[84:87]
  s_waitcnt vmcnt(7)
  v_mfma_f32_16x16x32_bf16 v[68:71], a[120:123], v[128:131], v[68:71]
  s_add_u32 s18, s18, 4096
  buffer_load_dwordx4 v[160:163], v2, s[52:55], s18 offen offset:0 sc1
  v_mfma_f32_16x16x32_bf16 v[72:75], a[124:127], v[128:131], v[72:75]
  s_mul_i32 s15, s7, 10240
  v_mfma_f32_16x16x32_bf16 v[76:79], a[128:131], v[128:131], v[76:79]
  s_add_u32 s15, s15, 102400
  v_mfma_f32_16x16x32_bf16 v[80:83], a[132:135], v[128:131], v[80:83]
  v_add_u32_e64 v47, s15, v2
  v_mfma_f32_16x16x32_bf16 v[84:87], a[136:139], v[128:131], v[84:87]
  s_waitcnt vmcnt(7)
  v_mfma_f32_16x16x32_bf16 v[68:71], a[140:143], v[132:135], v[68:71]
  buffer_load_dwordx4 v[164:167], v2, s[52:55], s18 offen offset:1024 sc1
  v_mfma_f32_16x16x32_bf16 v[72:75], a[144:147], v[132:135], v[72:75]
  v_mfma_f32_16x16x32_bf16 v[76:79], a[148:151], v[132:135], v[76:79]
  v_mfma_f32_16x16x32_bf16 v[80:83], a[152:155], v[132:135], v[80:83]
  v_mfma_f32_16x16x32_bf16 v[84:87], a[156:159], v[132:135], v[84:87]
  s_waitcnt vmcnt(7)
  v_mfma_f32_16x16x32_bf16 v[68:71], a[160:163], v[136:139], v[68:71]
  buffer_load_dwordx4 v[168:171], v2, s[52:55], s18 offen offset:2048 sc1
  v_mfma_f32_16x16x32_bf16 v[72:75], a[164:167], v[136:139], v[72:75]
  v_mfma_f32_16x16x32_bf16 v[76:79], a[168:171], v[136:139], v[76:79]
  v_mfma_f32_16x16x32_bf16 v[80:83], a[172:175], v[136:139], v[80:83]
  v_mfma_f32_16x16x32_bf16 v[84:87], a[176:179], v[136:139], v[84:87]
  s_waitcnt vmcnt(7)
  v_mfma_f32_16x16x32_bf16 v[68:71], a[180:183], v[140:143], v[68:71]
  buffer_load_dwordx4 v[172:175], v2, s[52:55], s18 offen offset:3072 sc1
  v_mfma_f32_16x16x32_bf16 v[72:75], a[184:187], v[140:143], v[72:75]
  v_mfma_f32_16x16x32_bf16 v[76:79], a[188:191], v[140:143], v[76:79]
  v_mfma_f32_16x16x32_bf16 v[80:83], a[192:195], v[140:143], v[80:83]
  v_mfma_f32_16x16x32_bf16 v[84:87], a[196:199], v[140:143], v[84:87]
  s_waitcnt vmcnt(7)
  v_mfma_f32_16x16x32_bf16 v[48:51], a[0:3], v[144:147], 0
  s_add_u32 s18, s18, 4096
  buffer_load_dwordx4 v[176:179], v2, s[52:55], s18 offen offset:0 sc1
  v_mfma_f32_16x16x32_bf16 v[52:55], a[4:7], v[144:147], 0
  v_mfma_f32_16x16x32_bf16 v[56:59], a[8:11], v[144:147], 0
  v_mfma_f32_16x16x32_bf16 v[60:63], a[12:15], v[144:147], 0
  v_mfma_f32_16x16x32_bf16 v[64:67], a[16:19], v[144:147], 0
  s_waitcnt vmcnt(7)
  v_mfma_f32_16x16x32_bf16 v[48:51], a[20:23], v[148:151], v[48:51]
  ds_write_b128 v45, v[68:71] offset:0
  v_mfma_f32_16x16x32_bf16 v[52:55], a[24:27], v[148:151], v[52:55]
  ds_write_b128 v45, v[72:75] offset:1024
  v_mfma_f32_16x16x32_bf16 v[56:59], a[28:31], v[148:151], v[56:59]
  buffer_load_dwordx4 v[180:183], v2, s[52:55], s18 offen offset:1024 sc1
  v_mfma_f32_16x16x32_bf16 v[60:63], a[32:35], v[148:151], v[60:63]
  v_mfma_f32_16x16x32_bf16 v[64:67], a[36:39], v[148:151], v[64:67]
  s_waitcnt vmcnt(7)
  v_mfma_f32_16x16x32_bf16 v[48:51], a[40:43], v[152:155], v[48:51]
  ds_write_b128 v45, v[76:79] offset:2048
  v_mfma_f32_16x16x32_bf16 v[52:55], a[44:47], v[152:155], v[52:55]
  ds_write_b128 v45, v[80:83] offset:3072
  v_mfma_f32_16x16x32_bf16 v[56:59], a[48:51], v[152:155], v[56:59]
  buffer_load_dwordx4 v[184:187], v2, s[52:55], s19 offen offset:0 sc1
  v_mfma_f32_16x16x32_bf16 v[60:63], a[52:55], v[152:155], v[60:63]
  v_mfma_f32_16x16x32_bf16 v[64:67], a[56:59], v[152:155], v[64:67]
  s_waitcnt vmcnt(7)
  v_mfma_f32_16x16x32_bf16 v[48:51], a[60:63], v[156:159], v[48:51]
  ds_write_b128 v45, v[84:87] offset:4096
  v_mfma_f32_16x16x32_bf16 v[52:55], a[64:67], v[156:159], v[52:55]
  buffer_load_dwordx4 v[188:191], v2, s[52:55], s19 offen offset:1024 sc1
  v_mfma_f32_16x16x32_bf16 v[56:59], a[68:71], v[156:159], v[56:59]
  v_mfma_f32_16x16x32_bf16 v[60:63], a[72:75], v[156:159], v[60:63]
  v_mfma_f32_16x16x32_bf16 v[64:67], a[76:79], v[156:159], v[64:67]
  s_waitcnt vmcnt(7)
  v_mfma_f32_16x16x32_bf16 v[48:51], a[80:83], v[160:163], v[48:51]
  buffer_load_dwordx4 v[128:131], v2, s[52:55], s19 offen offset:2048 sc1
  s_waitcnt lgkmcnt(0)
  s_barrier
  v_mfma_f32_16x16x32_bf16 v[52:55], a[84:87], v[160:163], v[52:55]
  ds_read_b128 v[192:195], v47 offset:0
  ds_read_b128 v[196:199], v47 offset:1024
  v_mfma_f32_16x16x32_bf16 v[56:59], a[88:91], v[160:163], v[56:59]
  ds_read_b128 v[200:203], v47 offset:2048
  ds_read_b128 v[204:207], v47 offset:3072
  v_mfma_f32_16x16x32_bf16 v[60:63], a[92:95], v[160:163], v[60:63]
  ds_read_b128 v[208:211], v47 offset:4096
  ds_read_b128 v[212:215], v47 offset:5120
  v_mfma_f32_16x16x32_bf16 v[64:67], a[96:99], v[160:163], v[64:67]
  ds_read_b128 v[216:219], v47 offset:6144
  ds_read_b128 v[220:223], v47 offset:7168
  s_waitcnt vmcnt(7)
  v_mfma_f32_16x16x32_bf16 v[48:51], a[100:103], v[164:167], v[48:51]
  buffer_load_dwordx4 v[132:135], v2, s[52:55], s19 offen offset:3072 sc1
  ds_read_b128 v[224:227], v47 offset:8192
  v_mfma_f32_16x16x32_bf16 v[52:55], a[104:107], v[164:167], v[52:55]
  ds_read_b128 v[228:231], v47 offset:9216
  s_waitcnt lgkmcnt(5)
  v_mfma_f32_16x16x32_bf16 v[56:59], a[108:111], v[164:167], v[56:59]
  v_add_f32 v108, v108, v192
  v_add_f32 v109, v109, v193
  v_mfma_f32_16x16x32_bf16 v[60:63], a[112:115], v[164:167], v[60:63]
  v_add_f32 v110, v110, v194
  v_add_f32 v111, v111, v195
  v_mfma_f32_16x16x32_bf16 v[64:67], a[116:119], v[164:167], v[64:67]
  v_add_f32 v112, v112, v196
  v_add_f32 v113, v113, v197
  s_waitcnt vmcnt(7)
  v_mfma_f32_16x16x32_bf16 v[48:51], a[120:123], v[168:171], v[48:51]
  s_add_u32 s19, s19, 4096
  buffer_load_dwordx4 v[136:139], v2, s[52:55], s19 offen offset:0 sc1
  v_add_f32 v114, v114, v198
  v_mfma_f32_16x16x32_bf16 v[52:55], a[124:127], v[168:171], v[52:55]
  v_add_f32 v115, v115, v199
  v_add_f32 v116, v116, v200
  v_mfma_f32_16x16x32_bf16 v[56:59], a[128:131], v[168:171], v[56:59]
  v_add_f32 v117, v117, v201
  v_add_f32 v118, v118, v202
  v_mfma_f32_16x16x32_bf16 v[60:63], a[132:135], v[168:171], v[60:63]
  v_add_f32 v119, v119, v203
  v_add_f32 v120, v120, v204
  v_mfma_f32_16x16x32_bf16 v[64:67], a[136:139], v[168:171], v[64:67]
  v_add_f32 v121, v121, v205
  v_add_f32 v122, v122, v206
  s_waitcnt vmcnt(7)
  v_mfma_f32_16x16x32_bf16 v[48:51], a[140:143], v[172:175], v[48:51]
  buffer_load_dwordx4 v[140:143], v2, s[52:55], s19 offen offset:1024 sc1
  v_add_f32 v123, v123, v207
  v_mfma_f32_16x16x32_bf16 v[52:55], a[144:147], v[172:175], v[52:55]
  v_add_f32 v124, v124, v208
  v_add_f32 v125, v125, v209
  v_mfma_f32_16x16x32_bf16 v[56:59], a[148:151], v[172:175], v[56:59]
  v_add_f32 v126, v126, v210
  v_add_f32 v127, v127, v211
  v_mfma_f32_16x16x32_bf16 v[60:63], a[152:155], v[172:175], v[60:63]
  s_waitcnt lgkmcnt(0)
  v_add_f32 v108, v108, v212
  v_mfma_f32_16x16x32_bf16 v[64:67], a[156:159], v[172:175], v[64:67]
  v_add_f32 v109, v109, v213
  v_add_f32 v110, v110, v214
  s_waitcnt vmcnt(7)
  v_mfma_f32_16x16x32_bf16 v[48:51], a[160:163], v[176:179], v[48:51]
  buffer_load_dwordx4 v[144:147], v2, s[52:55], s19 offen offset:2048 sc1
  v_add_f32 v111, v111, v215
  v_mfma_f32_16x16x32_bf16 v[52:55], a[164:167], v[176:179], v[52:55]
  v_add_f32 v112, v112, v216
  v_add_f32 v113, v113, v217
  v_mfma_f32_16x16x32_bf16 v[56:59], a[168:171], v[176:179], v[56:59]
  v_add_f32 v114, v114, v218
  v_add_f32 v115, v115, v219
  v_mfma_f32_16x16x32_bf16 v[60:63], a[172:175], v[176:179], v[60:63]
  v_add_f32 v116, v116, v220
  v_add_f32 v117, v117, v221
  v_mfma_f32_16x16x32_bf16 v[64:67], a[176:179], v[176:179], v[64:67]
  v_add_f32 v118, v118, v222
  v_add_f32 v119, v119, v223
  s_waitcnt vmcnt(7)
  v_mfma_f32_16x16x32_bf16 v[48:51], a[180:183], v[180:183], v[48:51]
  buffer_load_dwordx4 v[148:151], v2, s[52:55], s19 offen offset:3072 sc1
  v_add_f32 v120, v120, v224
  v_mfma_f32_16x16x32_bf16 v[52:55], a[184:187], v[180:183], v[52:55]
  v_add_f32 v121, v121, v225
  v_add_f32 v122, v122, v226
  v_mfma_f32_16x16x32_bf16 v[56:59], a[188:191], v[180:183], v[56:59]
  v_add_f32 v123, v123, v227
  v_add_f32 v124, v124, v228
  v_mfma_f32_16x16x32_bf16 v[60:63], a[192:195], v[180:183], v[60:63]
  v_add_f32 v125, v125, v229
  v_add_f32 v126, v126, v230
  v_mfma_f32_16x16x32_bf16 v[64:67], a[196:199], v[180:183], v[64:67]
  v_add_f32 v127, v127, v231
  s_waitcnt vmcnt(7)
  v_mfma_f32_16x16x32_bf16 v[68:71], a[0:3], v[184:187], v[108:111]
  s_add_u32 s19, s19, 4096
  buffer_load_dwordx4 v[152:155], v2, s[52:55], s19 offen offset:0 sc1
  v_mfma_f32_16x16x32_bf16 v[72:75], a[4:7], v[184:187], v[112:115]
  v_mfma_f32_16x16x32_bf16 v[76:79], a[8:11], v[184:187], v[116:119]
  v_mfma_f32_16x16x32_bf16 v[80:83], a[12:15], v[184:187], v[120:123]
  v_mfma_f32_16x16x32_bf16 v[84:87], a[16:19], v[184:187], v[124:127]
  s_waitcnt vmcnt(7)
  v_mfma_f32_16x16x32_bf16 v[68:71], a[20:23], v[188:191], v[68:71]
  ds_write_b128 v46, v[48:51] offset:0
  v_mfma_f32_16x16x32_bf16 v[72:75], a[24:27], v[188:191], v[72:75]
  ds_write_b128 v46, v[52:55] offset:1024
  v_mfma_f32_16x16x32_bf16 v[76:79], a[28:31], v[188:191], v[76:79]
  buffer_load_dwordx4 v[156:159], v2, s[52:55], s19 offen offset:1024 sc1
  v_mfma_f32_16x16x32_bf16 v[80:83], a[32:35], v[188:191], v[80:83]
  v_mfma_f32_16x16x32_bf16 v[84:87], a[36:39], v[188:191], v[84:87]
  s_waitcnt vmcnt(7)
  v_mfma_f32_16x16x32_bf16 v[68:71], a[40:43], v[128:131], v[68:71]
  ds_write_b128 v46, v[56:59] offset:2048
  v_mfma_f32_16x16x32_bf16 v[72:75], a[44:47], v[128:131], v[72:75]
  ds_write_b128 v46, v[60:63] offset:3072
  v_mfma_f32_16x16x32_bf16 v[76:79], a[48:51], v[128:131], v[76:79]
  v_mfma_f32_16x16x32_bf16 v[80:83], a[52:55], v[128:131], v[80:83]
  v_mfma_f32_16x16x32_bf16 v[84:87], a[56:59], v[128:131], v[84:87]
  s_waitcnt vmcnt(6)
  v_mfma_f32_16x16x32_bf16 v[68:71], a[60:63], v[132:135], v[68:71]
  ds_write_b128 v46, v[64:67] offset:4096
  v_mfma_f32_16x16x32_bf16 v[72:75], a[64:67], v[132:135], v[72:75]
  s_lshl_b32 vcc_lo, s1, 2
  s_add_u32 vcc_lo, vcc_lo, s7
  s_cmp_lg_u32 vcc_lo, 3
  s_cbranch_scc1 skip_87
  buffer_wbl2 sc1
skip_87:
  v_mfma_f32_16x16x32_bf16 v[76:79], a[68:71], v[132:135], v[76:79]
  v_mfma_f32_16x16x32_bf16 v[80:83], a[72:75], v[132:135], v[80:83]
  v_mfma_f32_16x16x32_bf16 v[84:87], a[76:79], v[132:135], v[84:87]
  s_waitcnt vmcnt(5)
  v_mfma_f32_16x16x32_bf16 v[68:71], a[80:83], v[136:139], v[68:71]
  s_mul_i32 s15, s7, 5120
  v_mfma_f32_16x16x32_bf16 v[72:75], a[84:87], v[136:139], v[72:75]
  v_add_u32_e64 v47, s15, v2
  v_mfma_f32_16x16x32_bf16 v[76:79], a[88:91], v[136:139], v[76:79]
  v_mfma_f32_16x16x32_bf16 v[80:83], a[92:95], v[136:139], v[80:83]
  v_mfma_f32_16x16x32_bf16 v[84:87], a[96:99], v[136:139], v[84:87]
  s_waitcnt vmcnt(4)
  v_mfma_f32_16x16x32_bf16 v[68:71], a[100:103], v[140:143], v[68:71]
  s_waitcnt lgkmcnt(0)
  s_barrier
  ds_read_b128 v[192:195], v47 offset:0
  v_mfma_f32_16x16x32_bf16 v[72:75], a[104:107], v[140:143], v[72:75]
  ds_read_b128 v[196:199], v47 offset:1024
  v_mfma_f32_16x16x32_bf16 v[76:79], a[108:111], v[140:143], v[76:79]
  ds_read_b128 v[200:203], v47 offset:2048
  v_mfma_f32_16x16x32_bf16 v[80:83], a[112:115], v[140:143], v[80:83]
  ds_read_b128 v[204:207], v47 offset:3072
  v_mfma_f32_16x16x32_bf16 v[84:87], a[116:119], v[140:143], v[84:87]
  ds_read_b128 v[208:211], v47 offset:4096
  s_waitcnt vmcnt(3)
  v_mfma_f32_16x16x32_bf16 v[68:71], a[120:123], v[144:147], v[68:71]
  v_mfma_f32_16x16x32_bf16 v[72:75], a[124:127], v[144:147], v[72:75]
  v_mfma_f32_16x16x32_bf16 v[76:79], a[128:131], v[144:147], v[76:79]
  v_mfma_f32_16x16x32_bf16 v[80:83], a[132:135], v[144:147], v[80:83]
  v_mfma_f32_16x16x32_bf16 v[84:87], a[136:139], v[144:147], v[84:87]
  s_waitcnt vmcnt(2)
  v_mfma_f32_16x16x32_bf16 v[68:71], a[140:143], v[148:151], v[68:71]
  v_mfma_f32_16x16x32_bf16 v[72:75], a[144:147], v[148:151], v[72:75]
  v_mfma_f32_16x16x32_bf16 v[76:79], a[148:151], v[148:151], v[76:79]
  v_mfma_f32_16x16x32_bf16 v[80:83], a[152:155], v[148:151], v[80:83]
  v_mfma_f32_16x16x32_bf16 v[84:87], a[156:159], v[148:151], v[84:87]
  s_waitcnt vmcnt(1)
  v_mfma_f32_16x16x32_bf16 v[68:71], a[160:163], v[152:155], v[68:71]
  v_mfma_f32_16x16x32_bf16 v[72:75], a[164:167], v[152:155], v[72:75]
  v_mfma_f32_16x16x32_bf16 v[76:79], a[168:171], v[152:155], v[76:79]
  v_mfma_f32_16x16x32_bf16 v[80:83], a[172:175], v[152:155], v[80:83]
  v_mfma_f32_16x16x32_bf16 v[84:87], a[176:179], v[152:155], v[84:87]
  s_waitcnt vmcnt(0)
  v_mfma_f32_16x16x32_bf16 v[68:71], a[180:183], v[156:159], v[68:71]
  v_mfma_f32_16x16x32_bf16 v[72:75], a[184:187], v[156:159], v[72:75]
  v_mfma_f32_16x16x32_bf16 v[76:79], a[188:191], v[156:159], v[76:79]
  v_mfma_f32_16x16x32_bf16 v[80:83], a[192:195], v[156:159], v[80:83]
  v_mfma_f32_16x16x32_bf16 v[84:87], a[196:199], v[156:159], v[84:87]
  s_lshl_b32 s12, s5, 15
  s_lshl_b32 s13, s7, 10
  s_add_u32 s12, s12, s13
  s_add_u32 s12, s12, 2359296
  s_lshl_b32 s13, s6, 12
  s_add_u32 s13, s13, s12
  s_waitcnt lgkmcnt(0)
  v_pk_add_f32 v[68:69], v[68:69], v[192:193]
  v_pk_add_f32 v[70:71], v[70:71], v[194:195]
  v_pk_add_f32 v[72:73], v[72:73], v[196:197]
  v_pk_add_f32 v[74:75], v[74:75], v[198:199]
  v_pk_add_f32 v[76:77], v[76:77], v[200:201]
  v_pk_add_f32 v[78:79], v[78:79], v[202:203]
  v_pk_add_f32 v[80:81], v[80:81], v[204:205]
  v_pk_add_f32 v[82:83], v[82:83], v[206:207]
  v_pk_add_f32 v[84:85], v[84:85], v[208:209]
  v_pk_add_f32 v[86:87], v[86:87], v[210:211]
  v_pk_add_f32 v[212:213], v[68:69], v[70:71]
  v_pk_mul_f32 v[214:215], v[68:69], v[68:69]
  v_pk_fma_f32 v[214:215], v[70:71], v[70:71], v[214:215]
  v_pk_add_f32 v[212:213], v[212:213], v[72:73]
  v_pk_fma_f32 v[214:215], v[72:73], v[72:73], v[214:215]
  v_pk_add_f32 v[212:213], v[212:213], v[74:75]
  v_pk_fma_f32 v[214:215], v[74:75], v[74:75], v[214:215]
  v_pk_add_f32 v[212:213], v[212:213], v[76:77]
  v_pk_fma_f32 v[214:215], v[76:77], v[76:77], v[214:215]
  v_pk_add_f32 v[212:213], v[212:213], v[78:79]
  v_pk_fma_f32 v[214:215], v[78:79], v[78:79], v[214:215]
  v_pk_add_f32 v[212:213], v[212:213], v[80:81]
  v_pk_fma_f32 v[214:215], v[80:81], v[80:81], v[214:215]
  v_pk_add_f32 v[212:213], v[212:213], v[82:83]
  v_pk_fma_f32 v[214:215], v[82:83], v[82:83], v[214:215]
  v_pk_add_f32 v[212:213], v[212:213], v[84:85]
  v_pk_fma_f32 v[214:215], v[84:85], v[84:85], v[214:215]
  v_pk_add_f32 v[212:213], v[212:213], v[86:87]
  v_pk_fma_f32 v[214:215], v[86:87], v[86:87], v[214:215]
  v_add_f32 v228, v212, v213
  v_add_f32 v229, v214, v215
  v_mov_b32 v230, s8
  v_mov_b32 v231, s8
  v_mov_b32 v212, v228
  v_mov_b32 v213, v229
  s_nop 0
  v_permlane32_swap_b32 v228, v212
  v_permlane32_swap_b32 v229, v213
  v_add_f32 v228, v228, v212
  v_add_f32 v229, v229, v213
  v_mov_b32 v212, v228
  v_mov_b32 v213, v229
  s_nop 0
  v_permlane16_swap_b32 v228, v212
  v_permlane16_swap_b32 v229, v213
  v_add_f32 v228, v228, v212
  v_add_f32_e64 v229, v229, v213
  s_mov_b64 exec, 0xffff
  s_cmp_eq_u32 s9, 0
  s_cbranch_scc1 slow_88
  buffer_store_dwordx4 v[228:231], v2, s[52:55], s13 offen
back_89:
  s_mov_b64 exec, -1
  s_mul_i32 s14, s7, 10240
  s_add_u32 s14, s14, 102400
  v_lshrrev_b32 v12, 1, v3
  v_xor_b32 v12, v12, v4
  v_and_b32 v12, 3, v12
  v_lshlrev_b32_e64 v12, 4, v12
  v_lshl_add_u32 v12, v3, 6, v12
  v_add_u32_e64 v44, s14, v12
  ds_write_b128 v44, v[68:71] offset:0
  ds_write_b128 v44, v[88:91] offset:5120
  ds_write_b128 v44, v[72:75] offset:1024
  ds_write_b128 v44, v[92:95] offset:6144
  ds_write_b128 v44, v[76:79] offset:2048
  ds_write_b128 v44, v[96:99] offset:7168
  ds_write_b128 v44, v[80:83] offset:3072
  ds_write_b128 v44, v[100:103] offset:8192
  ds_write_b128 v44, v[84:87] offset:4096
  ds_write_b128 v44, v[104:107] offset:9216
  v_lshrrev_b32 v12, 3, v1
  v_xor_b32 v12, v12, v1
  v_and_b32 v12, 3, v12
  v_lshlrev_b32 v12, 4, v12
  v_lshrrev_b32_e64 v13, 2, v1
  v_lshl_add_u32 v12, v13, 6, v12
  v_add_u32_e64 v45, s14, v12
  ds_read_b128 v[160:163], v45 offset:0
  ds_read_b128 v[180:183], v45 offset:5120
  ds_read_b128 v[164:167], v45 offset:1024
  ds_read_b128 v[184:187], v45 offset:6144
  ds_read_b128 v[168:171], v45 offset:2048
  ds_read_b128 v[188:191], v45 offset:7168
  ds_read_b128 v[172:175], v45 offset:3072
  ds_read_b128 v[192:195], v45 offset:8192
  ds_read_b128 v[176:179], v45 offset:4096
  ds_read_b128 v[196:199], v45 offset:9216
  v_and_b32 v14, 3, v1
  v_lshlrev_b32 v11, 13, v14
  v_lshl_add_u32 v11, v13, 4, v11
  s_add_u32 s13, s12, 4096
  v_lshrrev_b32_e64 v12, 2, v13
  v_lshl_add_u32 v12, v12, 2, v13
  v_mul_u32_u24 v12, 2560, v12
  v_lshl_add_u32 v46, v14, 4, v12
  s_lshl_b32 s15, s5, 6
  s_lshr_b32 s88, s7, 1
  s_lshl_b32 s88, s88, 5
  s_add_u32 s15, s15, s88
  s_and_b32 s88, s7, 1
  s_lshl_b32 s88, s88, 2
  s_add_u32 s15, s15, s88
  s_mul_i32 s15, s15, 2560
  s_mul_i32 s88, s6, 320
  s_add_u32 s15, s15, s88
  s_mov_b32 s60, s46
  s_and_b32 s61, s47, 0xffff
  s_mov_b32 s62, 5242880
  s_mov_b32 s63, 0x20000
again_90:
  buffer_load_dwordx3 v[128:130], v11, s[52:55], s12 offen sc1
  buffer_load_dwordx3 v[132:134], v11, s[52:55], s13 offen sc1
  s_sub_u32 s10, s10, 1
  s_cmp_gt_i32 s10, 0
  s_waitcnt vmcnt(0)
  v_xor_b32 v15, s8, v130
  v_xor_b32 v14, s8, v134
  v_or_b32 v15, v15, v14
  v_cmp_ne_u32 vcc, 0, v15
  s_cbranch_scc0 out_92
  s_cbranch_vccnz again_90
out_92:
ok_91:
  s_waitcnt lgkmcnt(0)
  v_pk_add_f32 v[128:129], v[128:129], v[132:133]
  s_nop 1
  v_add_f32_dpp v128, v128, v128 quad_perm:[1,0,3,2] row_mask:0xf bank_mask:0xf
  v_add_f32_dpp v129, v129, v129 quad_perm:[1,0,3,2] row_mask:0xf bank_mask:0xf
  s_nop 0
  v_add_f32_dpp v128, v128, v128 quad_perm:[2,3,0,1] row_mask:0xf bank_mask:0xf
  v_add_f32_dpp v129, v129, v129 quad_perm:[2,3,0,1] row_mask:0xf bank_mask:0xf
  v_mul_f32 v128, 0x3acccccd, v128
  v_mul_f32 v202, 0x3acccccd, v129
  v_fma_f32 v202, -v128, v128, v202
  v_max_f32 v202, 0, v202
  v_add_f32 v202, 0x3727c5ac, v202
  v_rsq_f32 v200, v202
  s_nop 0
  v_mul_f32_e64 v201, v128, v200
  v_pk_fma_f32 v[132:133], v[160:161], v[200:201], v[200:201] op_sel:[0,0,1] op_sel_hi:[1,0,1] neg_lo:[0,0,1] neg_hi:[0,0,1]
  v_pk_fma_f32 v[134:135], v[162:163], v[200:201], v[200:201] op_sel:[0,0,1] op_sel_hi:[1,0,1] neg_lo:[0,0,1] neg_hi:[0,0,1]
  v_pk_fma_f32 v[160:161], v[132:133], v[180:181], v[160:161]
  v_pk_fma_f32 v[162:163], v[134:135], v[182:183], v[162:163]
  buffer_store_dwordx4 v[160:163], v46, s[60:63], s15 offen offset:0 sc1
  v_pk_fma_f32 v[136:137], v[164:165], v[200:201], v[200:201] op_sel:[0,0,1] op_sel_hi:[1,0,1] neg_lo:[0,0,1] neg_hi:[0,0,1]
  v_pk_fma_f32 v[138:139], v[166:167], v[200:201], v[200:201] op_sel:[0,0,1] op_sel_hi:[1,0,1] neg_lo:[0,0,1] neg_hi:[0,0,1]
  v_pk_fma_f32 v[164:165], v[136:137], v[184:185], v[164:165]
  v_pk_fma_f32 v[166:167], v[138:139], v[186:187], v[166:167]
  buffer_store_dwordx4 v[164:167], v46, s[60:63], s15 offen offset:64 sc1
  v_pk_fma_f32 v[132:133], v[168:169], v[200:201], v[200:201] op_sel:[0,0,1] op_sel_hi:[1,0,1] neg_lo:[0,0,1] neg_hi:[0,0,1]
  v_pk_fma_f32 v[134:135], v[170:171], v[200:201], v[200:201] op_sel:[0,0,1] op_sel_hi:[1,0,1] neg_lo:[0,0,1] neg_hi:[0,0,1]
  v_pk_fma_f32 v[168:169], v[132:133], v[188:189], v[168:169]
  v_pk_fma_f32 v[170:171], v[134:135], v[190:191], v[170:171]
  buffer_store_dwordx4 v[168:171], v46, s[60:63], s15 offen offset:128 sc1
  v_pk_fma_f32 v[136:137], v[172:173], v[200:201], v[200:201] op_sel:[0,0,1] op_sel_hi:[1,0,1] neg_lo:[0,0,1] neg_hi:[0,0,1]
  v_pk_fma_f32 v[138:139], v[174:175], v[200:201], v[200:201] op_sel:[0,0,1] op_sel_hi:[1,0,1] neg_lo:[0,0,1] neg_hi:[0,0,1]
  v_pk_fma_f32 v[172:173], v[136:137], v[192:193], v[172:173]
  v_pk_fma_f32 v[174:175], v[138:139], v[194:195], v[174:175]
  buffer_store_dwordx4 v[172:175], v46, s[60:63], s15 offen offset:192 sc1
  v_pk_fma_f32 v[132:133], v[176:177], v[200:201], v[200:201] op_sel:[0,0,1] op_sel_hi:[1,0,1] neg_lo:[0,0,1] neg_hi:[0,0,1]
  v_pk_fma_f32 v[134:135], v[178:179], v[200:201], v[200:201] op_sel:[0,0,1] op_sel_hi:[1,0,1] neg_lo:[0,0,1] neg_hi:[0,0,1]
  v_pk_fma_f32 v[176:177], v[132:133], v[196:197], v[176:177]
  v_pk_fma_f32 v[178:179], v[134:135], v[198:199], v[178:179]
  buffer_store_dwordx4 v[176:179], v46, s[60:63], s15 offen offset:256 sc1
L_end:
  s_endpgm
again_13:
  s_sub_u32 s10, s10, 1
  s_cmp_gt_i32 s10, 0
  s_cbranch_scc0 ok_14
  buffer_load_dword v184, v185, s[52:55], s89 offen sc1
  s_waitcnt vmcnt(0)
  v_xor_b32 v15, s8, v184
  v_cmp_lt_u32 vcc, 15, v15
  s_cbranch_vccz ok_14
  s_and_b32 s13, s10, 3
  s_cbranch_scc1 again_13
  buffer_load_dword v184, v185, s[52:55], s89 offen offset:128 sc1
  s_waitcnt vmcnt(0)
  v_xor_b32 v15, s8, v184
  v_cmp_lt_u32 vcc, 15, v15
  s_cbranch_vccnz again_13
  s_branch ok_14
again_15:
  s_sub_u32 s10, s10, 1
  s_cmp_gt_i32 s10, 0
  s_cbranch_scc0 ok_16
  buffer_load_dword v184, v185, s[52:55], s89 offen sc1
  s_waitcnt vmcnt(0)
  v_xor_b32 v15, s8, v184
  v_cmp_lt_u32 vcc, 15, v15
  s_cbranch_vccz ok_16
  s_and_b32 s13, s10, 3
  s_cbranch_scc1 again_15
  buffer_load_dword v184, v185, s[52:55], s89 offen offset:128 sc1
  s_waitcnt vmcnt(0)
  v_xor_b32 v15, s8, v184
  v_cmp_lt_u32 vcc, 15, v15
  s_cbranch_vccnz again_15
  s_branch ok_16
slow_17:
  buffer_store_dword v15, off, s[52:55], s41 sc1
  s_nop 1
  s_branch back_18
again_19:
  s_sub_u32 s10, s10, 1
  s_cmp_gt_i32 s10, 0
  s_cbranch_scc0 ok_20
  buffer_load_dwordx2 v[188:189], v187, s[52:55], s87 offen sc1
  s_waitcnt vmcnt(0)
  v_xor_b32 v15, s8, v188
  v_xor_b32 v14, s8, v189
  v_or_b32 v15, v15, v14
  v_cmp_ne_u32 vcc, 0, v15
  s_cbranch_vccnz again_19
  s_branch ok_20
again_21:
  s_sub_u32 s10, s10, 1
  s_cmp_gt_i32 s10, 0
  s_cbranch_scc0 ok_22
  buffer_load_dwordx4 v[220:223], v2, s[52:55], s36 offen sc1
  s_waitcnt vmcnt(0)
  v_min3_u32 v15, v220, v221, s8
  v_max3_u32 v14, v220, v221, s8
  v_min3_u32 v15, v15, v222, v223
  v_max3_u32 v14, v14, v222, v223
  v_cmp_ne_u32 vcc, v15, v14
  s_cbranch_vccnz again_21
  s_branch ok_22
again_23:
  s_sub_u32 s10, s10, 1
  s_cmp_gt_i32 s10, 0
  s_cbranch_scc0 ok_24
  buffer_load_dwordx4 v[188:191], v187, s[52:55], s88 offen sc1
  s_waitcnt vmcnt(0)
  v_min3_u32 v15, v188, v189, s8
  v_max3_u32 v14, v188, v189, s8
  v_min3_u32 v15, v15, v190, v191
  v_max3_u32 v14, v14, v190, v191
  v_cmp_ne_u32 vcc, v15, v14
  s_cbranch_vccnz again_23
  s_branch ok_24
again_25:
  s_sub_u32 s10, s10, 1
  s_cmp_gt_i32 s10, 0
  s_cbranch_scc0 ok_26
  buffer_load_dwordx3 v[152:154], v160, s[52:55], s93 offen sc1
  buffer_load_dwordx2 v[156:157], v161, s[52:55], s94 offen sc1
  buffer_load_dwordx2 v[158:159], v162, s[52:55], s94 offen offset:512 sc1
  s_waitcnt vmcnt(0)
  v_min3_u32 v15, v154, v154, s8
  v_max3_u32 v14, v154, v154, s8
  v_min3_u32 v15, v15, v157, v159
  v_max3_u32 v14, v14, v157, v159
  v_cmp_ne_u32 vcc, v15, v14
  s_cbranch_vccnz again_25
  s_branch ok_26
slow_38:
  buffer_store_dword v15, off, s[52:55], s14 sc1
  s_nop 1
  s_branch back_39
slow_41:
  buffer_store_dword v15, off, s[52:55], s14 sc1
  s_nop 1
  s_branch back_42
again_44:
  s_sub_u32 s10, s10, 1
  s_cmp_gt_i32 s10, 0
  s_cbranch_scc0 ok_45
  buffer_load_dwordx4 v[120:123], v2, s[52:55], s92 offen sc1
  s_waitcnt vmcnt(0)
  v_min3_u32 v15, v120, v121, s8
  v_max3_u32 v14, v120, v121, s8
  v_min3_u32 v15, v15, v122, v123
  v_max3_u32 v14, v14, v122, v123
  v_cmp_ne_u32 vcc, v15, v14
  s_cbranch_vccnz again_44
  s_branch ok_45
again_49:
  s_sub_u32 s10, s10, 1
  s_cmp_gt_i32 s10, 0
  s_cbranch_scc0 ok_50
  s_mul_i32 s95, s7, 10240
  s_add_u32 s95, s95, 107520
  s_and_b32 s93, s7, 1
  s_lshl_b32 s93, s93, 3
  s_add_u32 s93, s93, s95
  v_add_u32 v253, s93, v2
  s_add_u32 m0, s95, 0
  s_add_u32 s93, s92, 0
  buffer_load_dwordx4 v252, s[52:55], s93 offen sc1 lds
  s_add_u32 m0, s95, 1024
  s_add_u32 s93, s92, 65536
  buffer_load_dwordx4 v252, s[52:55], s93 offen sc1 lds
  s_add_u32 m0, s95, 2048
  s_add_u32 s93, s92, 131072
  buffer_load_dwordx4 v252, s[52:55], s93 offen sc1 lds
  s_add_u32 m0, s95, 3072
  s_add_u32 s93, s92, 196608
  buffer_load_dwordx4 v252, s[52:55], s93 offen sc1 lds
  s_add_u32 m0, s95, 4096
  s_add_u32 s93, s92, 262144
  buffer_load_dwordx4 v252, s[52:55], s93 offen sc1 lds
  s_waitcnt vmcnt(0)
  ds_read_b64_tr_b16 v[232:233], v253 offset:0
  ds_read_b64_tr_b16 v[234:235], v253 offset:1024
  ds_read_b64_tr_b16 v[236:237], v253 offset:2048
  ds_read_b64_tr_b16 v[238:239], v253 offset:3072
  ds_read_b64_tr_b16 v[240:241], v253 offset:4096
  s_waitcnt lgkmcnt(0)
  v_pk_max_u16 v15, v232, v233
  v_pk_max_u16 v15, v15, v234
  v_pk_max_u16 v15, v15, v235
  v_pk_max_u16 v15, v15, v236
  v_pk_max_u16 v15, v15, v237
  v_pk_max_u16 v15, v15, v238
  v_pk_max_u16 v15, v15, v239
  v_pk_max_u16 v15, v15, v240
  v_pk_max_u16 v15, v15, v241
  v_lshlrev_b32 v14, 16, v15
  v_max_u32 v15, v15, v14
  v_cmp_le_u32 vcc, 0xffff0000, v15
  s_cbranch_vccnz again_49
  s_branch ok_50
slow_51:
  buffer_store_dwordx4 v[228:231], v2, s[52:55], s13 offen sc1
  s_nop 1
  s_branch back_52
slow_56:
  buffer_store_dwordx2 v[180:181], v47, s[52:55], s88 offen offset:0 sc1
  buffer_store_dwordx2 v[182:183], v47, s[52:55], s88 offen offset:128 sc1
  buffer_store_dwordx2 v[184:185], v47, s[52:55], s88 offen offset:256 sc1
  buffer_store_dwordx2 v[186:187], v47, s[52:55], s88 offen offset:384 sc1
  buffer_store_dwordx2 v[188:189], v47, s[52:55], s88 offen offset:512 sc1
  s_nop 1
  s_branch back_57
slow_58:
  buffer_store_dword v15, off, s[52:55], s13 sc1
  s_nop 1
  s_branch back_59
slow_72:
  buffer_store_dwordx4 v[52:55], v47, s[52:55], s13 offen sc1
  s_nop 1
  s_branch back_73
slow_74:
  buffer_store_dwordx4 v[60:63], v47, s[52:55], s13 offen sc1
  s_nop 1
  s_branch back_75
slow_76:
  buffer_store_dwordx4 v[68:71], v47, s[52:55], s13 offen sc1
  s_nop 1
  s_branch back_77
slow_78:
  buffer_store_dwordx4 v[76:79], v47, s[52:55], s13 offen sc1
  s_nop 1
  s_branch back_79
slow_80:
  buffer_store_dwordx4 v[84:87], v47, s[52:55], s13 offen sc1
  s_nop 1
  s_branch back_81
slow_82:
  buffer_store_dword v15, off, s[52:55], s14 sc1
  s_nop 1
  s_branch back_83
slow_88:
  buffer_store_dwordx4 v[228:231], v2, s[52:55], s13 offen sc1
  s_nop 1
  s_branch back_89
  s_endpgm
L_codeend:
.section .rodata,"a"
.p2align 6
.amdhsa_kernel interleave_layers__ssm_conv_s5__ssm_conv_h3__prompt_kernel
  .amdhsa_next_free_vgpr 512
  .amdhsa_next_free_sgpr 102
  .amdhsa_accum_offset 256
  .amdhsa_group_segment_fixed_size 0
  .amdhsa_kernarg_size 144
  .amdhsa_user_sgpr_count 2
  .amdhsa_user_sgpr_kernarg_segment_ptr 1
  .amdhsa_system_sgpr_workgroup_id_x 1
.end_amdhsa_kernel
```

```asm
; @launch grid=(256,1,1) block=(256,1,1) lds=163840
.amdgcn_target "amdgcn-amd-amdhsa--gfx950"
.text
.globl interleave_layers__ssm_conv_s5__ssm_conv_h3__prompt_kernel
.p2align 8
.type interleave_layers__ssm_conv_s5__ssm_conv_h3__prompt_kernel,@function
interleave_layers__ssm_conv_s5__ssm_conv_h3__prompt_kernel:
  s_cmp_ge_u32 s2, 256
  s_cbranch_scc1 L_end
  s_load_dwordx16 s[16:31], s[0:1], 0
  s_load_dwordx16 s[32:47], s[0:1], 64
  s_load_dwordx4 s[48:51], s[0:1], 128
  v_and_b32 v1, 63, v0
  v_lshrrev_b32 v11, 6, v0
  v_lshlrev_b32 v2, 4, v1
  v_readfirstlane_b32 s7, v11
  v_and_b32 v3, 15, v1
  v_lshrrev_b32 v4, 4, v1
  s_and_b32 s12, s2, 7
  s_lshr_b32 s13, s2, 3
  s_getpc_b64 s[98:99]
L_pc:
  s_and_b32 s4, s13, 15
  s_lshr_b32 s14, s13, 4
  s_lshl_b32 s3, s12, 1
  s_add_u32 s3, s3, s14
  s_mov_b32 s0, s12
  s_mov_b32 s1, s13
  s_and_b32 vcc_lo, s1, 7
  s_lshl_b32 vcc_lo, vcc_lo, 2
  s_add_u32 vcc_lo, vcc_lo, s7
  s_lshl_b32 vcc_lo, vcc_lo, 11
  v_lshl_add_u32 v15, v3, 7, vcc_lo
  v_min_u32 v15, L_codeend-L_pc-4, v15
  s_mov_b64 exec, 0xffff
  global_load_dword a250, v15, s[98:99]
  s_mov_b64 exec, -1
  v_lshrrev_b32 v11, 3, v1
  v_and_b32_e64 v13, 7, v1
  v_mul_u32_u24 v150, 1280, v11
  v_lshl_add_u32 v150, v13, 4, v150
  s_mul_i32 s12, s1, 81920
  s_lshl_b32 s13, s0, 7
  s_add_u32 s12, s12, s13
  v_add_u32 v169, s12, v150
  s_lshl_b32 s95, s0, 5
  s_add_u32 s95, s95, s1
  s_mul_i32 s12, s95, 10240
  s_add_u32 s12, s12, 1024
  v_add_u32 v170, s12, v150
  s_waitcnt lgkmcnt(0)
  s_load_dword s8, s[50:51], 0
  s_cmp_eq_u32 s7, 1
  s_cbranch_scc1 w1_3
  s_cmp_eq_u32 s7, 2
  s_cbranch_scc1 w2_4
  s_cmp_eq_u32 s7, 3
  s_cbranch_scc1 w3_5
w0_2:
  s_mov_b32 s60, s36
  s_and_b32 s61, s37, 0xffff
  s_mov_b32 s62, 2621440
  s_mov_b32 s63, 0x20000
  s_mov_b32 m0, 119840
  s_nop 0
  buffer_load_dwordx4 v169, s[60:63], 0 offen lds
  s_mov_b32 m0, 120896
  s_mov_b32 s12, 10240
  buffer_load_dwordx4 v169, s[60:63], s12 offen lds
  s_mov_b32 m0, 121952
  s_mov_b32 s12, 20480
  buffer_load_dwordx4 v169, s[60:63], s12 offen lds
  s_mov_b32 m0, 123008
  s_mov_b32 s12, 30720
  buffer_load_dwordx4 v169, s[60:63], s12 offen lds
  s_mov_b32 m0, 124064
  s_mov_b32 s12, 40960
  buffer_load_dwordx4 v169, s[60:63], s12 offen lds
  s_mov_b32 m0, 125120
  s_mov_b32 s12, 51200
  buffer_load_dwordx4 v169, s[60:63], s12 offen lds
  s_mov_b32 m0, 126176
  s_mov_b32 s12, 61440
  buffer_load_dwordx4 v169, s[60:63], s12 offen lds
  v_subrev_u32 v11, 10240, v169
  s_mov_b32 exec_lo, 0
  s_mov_b32 exec_hi, 0xffffff00
  s_mov_b32 m0, 118784
  s_nop 0
  buffer_load_dwordx4 v11, s[60:63], 0 offen lds
  s_mov_b64 exec, -1
  s_mov_b32 s52, s50
  s_and_b32 s53, s51, 0xffff
  s_mov_b32 s54, 41943040
  s_mov_b32 s55, 0x20000
  s_lshl_b32 s12, s3, 4
  s_add_u32 s12, s12, s4
  s_lshl_b32 s12, s12, 12
  s_add_u32 s12, s12, 1310720
  s_sub_u32 s12, s12, 0
  v_mov_b32 v11, s12
  s_lshl_b32 s12, s3, 10
  s_add_u32 s12, s12, 4096
  s_sub_u32 s12, s12, 3072
  v_cmp_lt_u32 vcc, 23, v1
  v_mov_b32 v15, s12
  s_nop 0
  v_cndmask_b32 v11, v11, v15, vcc
  s_lshl_b32 s12, s0, 11
  s_add_u32 s12, s12, 65536
  s_sub_u32 s12, s12, 3840
  v_cmp_lt_u32 vcc, 29, v1
  v_mov_b32 v15, s12
  s_nop 0
  v_cndmask_b32 v11, v11, v15, vcc
  s_lshl_b32 s12, s4, 5
  s_add_u32 s12, s12, s3
  s_mul_i32 s12, s12, 640
  s_add_u32 s12, s12, 337920
  s_sub_u32 s12, s12, 4992
  v_cmp_lt_u32 vcc, 38, v1
  v_mov_b32 v15, s12
  s_nop 0
  v_cndmask_b32 v11, v11, v15, vcc
  s_lshl_b32 s12, s4, 5
  s_add_u32 s12, s12, s3
  s_mul_i32 s12, s12, 640
  s_add_u32 s12, s12, 665600
  s_sub_u32 s12, s12, 5632
  v_cmp_lt_u32 vcc, 43, v1
  v_mov_b32 v15, s12
  s_nop 0
  v_cndmask_b32 v11, v11, v15, vcc
  s_mul_i32 s12, s4, 640
  s_add_u32 s12, s12, 303104
  s_sub_u32 s12, s12, 6272
  v_cmp_lt_u32 vcc, 48, v1
  v_mov_b32 v15, s12
  s_nop 0
  v_cndmask_b32 v11, v11, v15, vcc
  s_lshl_b32 s12, s0, 7
  s_add_u32 s12, s12, 24576
  s_sub_u32 s12, s12, 6912
  v_cmp_lt_u32 vcc, 53, v1
  v_mov_b32 v15, s12
  s_nop 0
  v_cndmask_b32 v11, v11, v15, vcc
  s_lshl_b32 s12, s0, 7
  s_add_u32 s12, s12, 32768
  s_sub_u32 s12, s12, 7040
  v_cmp_lt_u32 vcc, 54, v1
  v_mov_b32 v15, s12
  s_nop 0
  v_cndmask_b32 v11, v11, v15, vcc
  v_lshl_add_u32 v11, v1, 7, v11
  s_mov_b32 exec_hi, 16777215
  buffer_load_dword a250, v11, s[52:55], 0 offen
  s_mov_b32 exec_hi, -1
  s_branch join_1
w1_3:
  v_min_u32_e64 v11, 39, v1
  s_mul_i32 s12, s4, 80
  v_lshl_add_u32 v14, v11, 1, s12
  global_load_ushort v229, v14, s[18:19]
  global_load_ushort v230, v14, s[20:21]
  global_load_ushort v231, v14, s[30:31]
  s_mov_b32 s64, s38
  s_and_b32 s65, s39, 0xffff
  s_mov_b32 s66, 2621440
  s_mov_b32 s67, 0x20000
  s_mov_b32 m0, 132512
  s_nop 0
  buffer_load_dwordx4 v169, s[64:67], 0 offen lds
  s_mov_b32 m0, 133568
  s_mov_b32 s12, 10240
  buffer_load_dwordx4 v169, s[64:67], s12 offen lds
  s_mov_b32 m0, 134624
  s_mov_b32 s12, 20480
  buffer_load_dwordx4 v169, s[64:67], s12 offen lds
  s_mov_b32 m0, 135680
  s_mov_b32 s12, 30720
  buffer_load_dwordx4 v169, s[64:67], s12 offen lds
  s_mov_b32 m0, 136736
  s_mov_b32 s12, 40960
  buffer_load_dwordx4 v169, s[64:67], s12 offen lds
  s_mov_b32 m0, 137792
  s_mov_b32 s12, 51200
  buffer_load_dwordx4 v169, s[64:67], s12 offen lds
  s_mov_b32 m0, 138848
  s_mov_b32 s12, 61440
  buffer_load_dwordx4 v169, s[64:67], s12 offen lds
  s_mov_b32 m0, 139904
  s_mov_b32 s12, 71680
  buffer_load_dwordx4 v169, s[64:67], s12 offen lds
  s_branch join_1
w2_4:
  s_mov_b32 s60, s36
  s_and_b32 s61, s37, 0xffff
  s_mov_b32 s62, 2621440
  s_mov_b32 s63, 0x20000
  s_mov_b32 s64, s38
  s_and_b32 s65, s39, 0xffff
  s_mov_b32 s66, 2621440
  s_mov_b32 s67, 0x20000
  s_mov_b32 m0, 127232
  s_mov_b32 s12, 71680
  buffer_load_dwordx4 v169, s[60:63], s12 offen lds
  s_mov_b32 m0, 129344
  s_nop 0
  buffer_load_dwordx4 v170, s[60:63], 0 offen lds
  s_mov_b32 m0, 142016
  s_nop 0
  buffer_load_dwordx4 v170, s[64:67], 0 offen lds
  s_mov_b32 m0, 131456
  s_mov_b32 s12, 128
  buffer_load_dwordx4 v170, s[60:63], s12 offen lds
  s_mov_b32 m0, 144128
  s_mov_b32 s12, 128
  buffer_load_dwordx4 v170, s[64:67], s12 offen lds
  v_subrev_u32 v11, 10240, v170
  s_mov_b32 exec_lo, 0
  s_mov_b32 exec_hi, 0xffffff00
  s_mov_b32 m0, 128288
  s_nop 0
  buffer_load_dwordx4 v11, s[60:63], 0 offen lds
  s_mov_b64 exec, -1
  v_subrev_u32 v11, 10240, v170
  s_mov_b32 exec_lo, 0
  s_mov_b32 exec_hi, 0xffffff00
  s_mov_b32 m0, 130400
  s_mov_b32 s12, 128
  buffer_load_dwordx4 v11, s[60:63], s12 offen lds
  s_mov_b64 exec, -1
  s_mov_b32 s64, s40
  s_and_b32 s65, s41, 0xffff
  s_mov_b32 s66, 5120
  s_mov_b32 s67, 0x20000
  s_mov_b32 m0, 143072
  s_movk_i32 s12, 4096
  buffer_load_dwordx4 v2, s[64:67], s12 offen lds
  s_mov_b32 m0, 140960
  s_lshl_b32 s12, s0, 9
  s_mov_b32 exec_hi, 0
  buffer_load_dwordx4 v2, s[64:67], s12 offen lds
  s_mov_b32 exec_hi, -1
  s_branch join_1
w3_5:
  s_mov_b32 s68, s16
  s_and_b32 s69, s17, 0xffff
  s_mov_b32 s70, 2621440
  s_mov_b32 s71, 0x20000
  s_lshl_b32 s12, s3, 4
  s_add_u32 s12, s12, s4
  s_mul_i32 s12, s12, 10240
  buffer_load_dwordx4 v[48:51], v150, s[68:71], s12 offen offset:0
  buffer_load_dwordx4 v[52:55], v150, s[68:71], s12 offen offset:128
  buffer_load_dwordx4 v[56:59], v150, s[68:71], s12 offen offset:256
  buffer_load_dwordx4 v[60:63], v150, s[68:71], s12 offen offset:384
  buffer_load_dwordx4 v[64:67], v150, s[68:71], s12 offen offset:512
  buffer_load_dwordx4 v[68:71], v150, s[68:71], s12 offen offset:640
  buffer_load_dwordx4 v[72:75], v150, s[68:71], s12 offen offset:768
  buffer_load_dwordx4 v[76:79], v150, s[68:71], s12 offen offset:896
  buffer_load_dwordx4 v[80:83], v150, s[68:71], s12 offen offset:1024
  buffer_load_dwordx4 v[84:87], v150, s[68:71], s12 offen offset:1152
join_1:
  s_lshl_b32 s86, s95, 1
  s_lshl_b32 s12, s86, 1
  s_load_dword s72, s[44:45], s12
  s_and_b32 s12, s95, 0xfffffffc
  s_add_u32 s12, s12, 1024
  s_load_dword s73, s[44:45], s12
  s_getreg_b32 s11, hwreg(HW_REG_XCC_ID, 0, 4)
  s_mov_b32 s10, 262144
  s_mov_b32 s2, 0x3f803f80
  v_lshrrev_b32 v11, 3, v1
  v_and_b32 v12, 6, v11
  v_and_b32 v13, 7, v1
  s_movk_i32 s15, 0x78
  v_bfe_u32 v14, s15, v12, 2
  v_xor_b32 v14, v14, v13
  v_mul_u32_u24 v146, 1280, v11
  v_lshl_add_u32 v148, v14, 4, v146
  s_and_b32 s12, s7, 1
  s_lshl_b32 s13, s12, 6
  v_xor_b32_e64 v148, s13, v148
  v_add_u32 v149, 8192, v148
  v_xor_b32 v12, v12, v13
  v_and_b32 v11, 4, v11
  v_mul_u32_u24 v11, 1280, v11
  v_lshl_add_u32 v11, v12, 4, v11
  v_add_u32_e64 v146, v11, v146
  v_add_u32 v147, 19456, v146
  s_lshr_b32 s13, s7, 1
  s_mul_i32 s75, s13, 10240
  s_lshl_b32 s12, s12, 10
  s_add_u32 s75, s75, s12
  s_mul_i32 s74, s4, 51200
  s_lshl_b32 s13, s13, 7
  s_add_u32 s74, s74, s13
  s_lshl_b32 s76, s3, 2
  s_add_u32 s76, s76, s7
  s_mul_i32 s76, s76, 40960
  s_lshl_b32 s77, s7, 11
  s_add_u32 s77, s77, 102400
  s_bitcmp1_b32 s7, 0
  s_cselect_b32 s56, s24, s22
  s_cselect_b32 s57, s25, s23
  s_and_b32 s57, s57, 0xffff
  s_mov_b32 s58, 819200
  s_mov_b32 s59, 0x20000
  s_bitcmp1_b32 s3, 3
  s_cselect_b32 s60, s24, s22
  s_cselect_b32 s61, s25, s23
  s_and_b32 s61, s61, 0xffff
  s_mov_b32 s62, 819200
  s_mov_b32 s63, 0x20000
  s_mov_b32 s68, s16
  s_and_b32 s69, s17, 0xffff
  s_mov_b32 s70, 2621440
  s_mov_b32 s71, 0x20000
  s_mov_b32 s52, s50
  s_and_b32 s53, s51, 0xffff
  s_mov_b32 s54, 41943040
  s_mov_b32 s55, 0x20000
  s_lshr_b32 s24, s95, 1
  s_add_u32 s24, s24, 512
  s_lshr_b32 s14, s4, 3
  s_lshl_b32 s5, s3, 1
  s_add_u32 s5, s5, s14
  s_and_b32 s6, s4, 7
  s_lshl_b32 s84, s3, 10
  s_lshl_b32 s13, s4, 4
  s_add_u32 s84, s84, s13
  s_lshl_b32 s13, s7, 2
  s_add_u32 s84, s84, s13
  s_lshl_b32 s85, s0, 11
  s_add_u32 s85, s85, s13
  s_lshl_b32 s13, s1, 4
  s_add_u32 s85, s85, s13
  s_lshl_b32 s83, s4, 5
  s_add_u32 s83, s83, s3
  s_mul_i32 s83, s83, 640
  s_add_u32 s83, s83, 327680
  s_cmp_eq_u32 s7, 0
  s_cselect_b32 s96, -1, 0
  s_cselect_b32 s97, 0xff, 0
  s_lshl_b32 s12, s76, 1
  s_mul_i32 s13, s4, 5
  s_add_u32 s14, s13, 0
  s_lshr_b32 s15, s14, 2
  s_lshl_b32 s15, s15, 11
  s_and_b32 s14, s14, 3
  s_lshl_b32 s14, s14, 8
  s_add_u32 s14, s14, s15
  s_add_u32 s78, s14, s12
  s_add_u32 s14, s13, 1
  s_lshr_b32 s15, s14, 2
  s_lshl_b32 s15, s15, 11
  s_and_b32 s14, s14, 3
  s_lshl_b32 s14, s14, 8
  s_add_u32 s14, s14, s15
  s_add_u32 s79, s14, s12
  s_add_u32 s14, s13, 2
  s_lshr_b32 s15, s14, 2
  s_lshl_b32 s15, s15, 11
  s_and_b32 s14, s14, 3
  s_lshl_b32 s14, s14, 8
  s_add_u32 s14, s14, s15
  s_add_u32 s80, s14, s12
  s_add_u32 s14, s13, 3
  s_lshr_b32 s15, s14, 2
  s_lshl_b32 s15, s15, 11
  s_and_b32 s14, s14, 3
  s_lshl_b32 s14, s14, 8
  s_add_u32 s14, s14, s15
  s_add_u32 s81, s14, s12
  s_add_u32 s14, s13, 4
  s_lshr_b32 s15, s14, 2
  s_lshl_b32 s15, s15, 11
  s_and_b32 s14, s14, 3
  s_lshl_b32 s14, s14, 8
  s_add_u32 s14, s14, s15
  s_add_u32 s82, s14, s12
  s_mul_i32 s12, s7, 1280
  s_add_u32 s12, s12, 13824
  v_mul_u32_u24 v11, 80, v3
  v_lshl_add_u32 v11, v4, 4, v11
  v_add_u32 v42, s12, v11
  v_bfe_u32 v12, v1, 2, 2
  v_mul_u32_u24 v12, 160, v12
  v_and_b32_e64 v13, 3, v1
  v_lshl_add_u32 v12, v13, 4, v12
  v_lshrrev_b32_e64 v13, 1, v4
  v_mul_u32_u24 v14, 80, v13
  v_lshlrev_b32_e64 v13, 10, v13
  v_add3_u32 v12, v12, v14, s12
  v_and_b32_e64 v14, 1, v4
  v_lshl_add_u32 v43, v14, 3, v12
  v_mul_u32_u24 v14, 40960, v14
  v_lshl_add_u32 v13, v3, 4, v13
  v_add_u32_e64 v44, v13, v14
  v_accvgpr_write_b32 a240, v42
  v_accvgpr_write_b32 a241, v43
  v_accvgpr_write_b32 a242, v44
  v_accvgpr_write_b32 a243, v148
  v_accvgpr_write_b32 a244, v149
  v_lshrrev_b32_e64 v11, 2, v3
  v_mul_u32_u24 v11, 5120, v11
  v_and_b32_e64 v12, 3, v3
  v_lshl_add_u32 v11, v12, 4, v11
  v_lshl_add_u32 v0, v4, 6, v11
  v_and_b32 v11, 1, v3
  v_lshrrev_b32 v12, 1, v3
  v_and_b32 v13, 6, v12
  s_movk_i32 s15, 0x78
  v_bfe_u32 v13, s15, v13, 2
  v_xor_b32_e64 v13, v13, v4
  v_lshl_add_u32 v13, v11, 2, v13
  v_lshlrev_b32_e64 v13, 4, v13
  v_lshl_add_u32 v13, v12, 7, v13
  v_lshl_add_u32 v5, v11, 10, v13
  v_xor_b32_e64 v6, 64, v5
  v_add_u32 v7, 51200, v5
  v_add_u32 v8, 51200, v6
  v_mul_u32_u24 v9, 144, v12
  v_lshl_add_u32 v9, v11, 2, v9
  v_lshl_add_u32 v9, v4, 3, v9
  s_lshl_b32 s12, s7, 5
  v_add_u32 v9, s12, v9
  v_and_b32 v11, 6, v3
  v_xor_b32 v11, v11, v4
  v_lshlrev_b32_e64 v11, 4, v11
  v_lshl_add_u32 v11, v3, 7, v11
  v_add_u32 v144, s77, v11
  v_xor_b32 v145, 64, v144
  v_lshrrev_b32 v11, 3, v1
  v_and_b32 v12, 7, v1
  v_mul_u32_u24 v13, 1056, v12
  v_lshl_add_u32 v13, v11, 3, v13
  s_lshl_b32 s12, s7, 6
  s_add_u32 s12, s12, 118784
  v_add_u32 v172, s12, v13
  s_lshl_b32 s12, s7, 8
  s_add_u32 s12, s12, 140960
  v_lshl_add_u32 v173, v11, 5, s12
  v_sub_u32 v13, 7, v12
  v_lshlrev_b32_e64 v13, 4, v13
  v_lshl_add_u32 v171, v11, 14, v13
  s_mul_i32 s12, s0, 80
  s_lshl_b32 s13, s7, 5
  s_add_u32 s12, s12, s13
  s_lshl_b32 s12, s12, 12
  s_lshl_b32 s13, s1, 7
  s_sub_u32 s12, s12, s13
  s_add_u32 s87, s12, 4198272
  s_add_u32 s41, s85, 65536
  s_movk_i32 s36, 4096
  s_cmp_lg_u32 s7, 2
  s_cbranch_scc1 skip_6
  v_bfe_u32 v13, v1, 4, 1
  v_mul_u32_u24 v13, 2112, v13
  v_and_b32_e64 v14, 15, v1
  v_lshl_add_u32 v13, v14, 3, v13
  v_add_u32 v172, 128288, v13
  v_and_b32 v13, 31, v1
  v_lshlrev_b32 v13, 5, v13
  v_add_u32 v173, 143072, v13
  v_cmp_gt_u32_e64 vcc, 32, v1
  v_mov_b32 v14, 1879048192
  s_lshl_b32 s87, s95, 11
  s_add_u32 s87, s87, 26214400
  v_cndmask_b32 v171, v14, v2, vcc
  s_lshl_b32 s41, s95, 2
  s_add_u32 s41, s41, 32768
  s_movk_i32 s36, 512
skip_6:
  s_lshl_b32 s12, s86, 12
  s_lshl_b32 s13, s7, 10
  s_add_u32 s90, s12, s13
  s_add_u32 s91, s90, 4096
  s_lshl_b32 s92, s24, 12
  s_add_u32 s92, s92, s13
  s_add_u32 s13, s13, 102432
  v_add_u32 v186, s13, v2
  v_lshrrev_b32_e64 v11, 1, v1
  v_mul_u32_u24 v11, 4160, v11
  v_and_b32_e64 v12, 1, v1
  v_lshl_add_u32 v11, v12, 4, v11
  v_add_u32 v163, 102400, v11
  s_waitcnt lgkmcnt(0)
  s_lshr_b32 s8, s8, 4
  s_mul_i32 s8, s8, 0x19660d
  s_add_u32 s8, s8, 0x3c6ef35f
  s_lshl_b32 s8, s8, 4
  s_cmp_eq_u32 s7, 1
  s_cbranch_scc1 w1_8
  s_cmp_eq_u32 s7, 2
  s_cbranch_scc1 w2_9
  s_cmp_eq_u32 s7, 3
  s_cbranch_scc1 w3_10
  s_branch join_7
w1_8:
  s_waitcnt vmcnt(8)
  v_lshlrev_b32 v229, 16, v229
  v_lshlrev_b32 v230, 16, v230
  v_lshlrev_b32 v231, 16, v231
  v_mul_f32 v231, 0x3fb8aa3b, v231
  v_exp_f32 v231, v231
  v_min_u32 v104, 39, v1
  v_mul_u32_u24 v102, 80, v104
  v_mul_u32_u24 v103, 176, v104
  v_cvt_pk_bf16_f32 v231, v231, v231
  v_and_b32 v231, 0xffff0000, v231
  v_mul_f32 v96, v231, v229
  v_mul_f32 v97, v231, v230
  v_mul_f32 v96, 0x3fb8aa3b, v96
  v_mul_f32 v97, 0x3e22f983, v97
  v_mul_f32 v98, 1.0, v96
  v_mul_f32 v99, 1.0, v97
  v_exp_f32 v98, v98
  v_fract_f32 v99, v99
  v_sin_f32 v100, v99
  v_cos_f32 v101, v99
  v_mul_f32 v107, v98, v100
  v_mul_f32_e64 v106, v98, v101
  v_mul_f32 v98, 0x41000000, v96
  v_mul_f32 v99, 0x41000000, v97
  v_exp_f32 v98, v98
  v_fract_f32 v99, v99
  v_sin_f32 v100, v99
  v_cos_f32 v101, v99
  v_mul_f32 v51, v98, v100
  v_mul_f32 v50, v98, v101
  v_mul_f32 v98, v229, v229
  v_fmac_f32 v98, v230, v230
  v_rcp_f32 v98, v98
  v_add_f32 v99, -1.0, v106
  v_add_f32 v98, v98, v98
  v_mul_f32 v100, v99, v229
  v_fmac_f32 v100, v107, v230
  v_mul_f32 v101, v107, v229
  v_fma_f32 v101, -v99, v230, v101
  v_mul_f32 v100, v98, v100
  v_mul_f32 v101, v98, v101
  v_and_b32 v98, 1, v104
  v_lshrrev_b32 v104, 1, v104
  v_lshlrev_b32_e64 v104, 4, v104
  v_lshl_add_u32 v104, v98, 2, v104
  v_add_u32 v104, 159744, v104
  v_add_u32 v102, 160640, v102
  v_add_u32 v103, 145184, v103
  ds_write2_b32 v104, v100, v101 offset0:0 offset1:2
  v_mov_b32 v48, 1.0
  v_mov_b32 v49, 0
  v_mov_b32 v84, 1.0
  v_mov_b32 v85, 0
  v_pk_mul_f32 v[52:53], v[50:51], v[50:51] op_sel:[1,1] op_sel_hi:[0,1] neg_lo:[0,1]
  v_pk_mul_f32 v[108:109], v[106:107], v[106:107] op_sel:[1,1] op_sel_hi:[0,1] neg_lo:[0,1]
  v_pk_fma_f32 v[52:53], v[50:51], v[50:51], v[52:53] op_sel:[0,0,0] op_sel_hi:[1,0,1]
  v_pk_fma_f32 v[108:109], v[106:107], v[106:107], v[108:109] op_sel:[0,0,0] op_sel_hi:[1,0,1]
  v_pk_mul_f32 v[54:55], v[52:53], v[50:51] op_sel:[1,1] op_sel_hi:[0,1] neg_lo:[0,1]
  v_pk_mul_f32 v[110:111], v[108:109], v[106:107] op_sel:[1,1] op_sel_hi:[0,1] neg_lo:[0,1]
  v_pk_fma_f32 v[54:55], v[52:53], v[50:51], v[54:55] op_sel:[0,0,0] op_sel_hi:[1,0,1]
  v_pk_fma_f32 v[110:111], v[108:109], v[106:107], v[110:111] op_sel:[0,0,0] op_sel_hi:[1,0,1]
  ds_write_b128 v103, v[48:51] offset:0
  v_pk_mul_f32 v[56:57], v[54:55], v[50:51] op_sel:[1,1] op_sel_hi:[0,1] neg_lo:[0,1]
  v_pk_mul_f32 v[112:113], v[110:111], v[106:107] op_sel:[1,1] op_sel_hi:[0,1] neg_lo:[0,1]
  v_pk_fma_f32 v[56:57], v[54:55], v[50:51], v[56:57] op_sel:[0,0,0] op_sel_hi:[1,0,1]
  v_pk_fma_f32 v[112:113], v[110:111], v[106:107], v[112:113] op_sel:[0,0,0] op_sel_hi:[1,0,1]
  v_pk_mul_f32 v[58:59], v[56:57], v[50:51] op_sel:[1,1] op_sel_hi:[0,1] neg_lo:[0,1]
  v_pk_mul_f32 v[114:115], v[112:113], v[106:107] op_sel:[1,1] op_sel_hi:[0,1] neg_lo:[0,1]
  v_pk_fma_f32 v[58:59], v[56:57], v[50:51], v[58:59] op_sel:[0,0,0] op_sel_hi:[1,0,1]
  v_pk_fma_f32 v[114:115], v[112:113], v[106:107], v[114:115] op_sel:[0,0,0] op_sel_hi:[1,0,1]
  ds_write_b128 v103, v[52:55] offset:16
  v_pk_mul_f32 v[60:61], v[58:59], v[50:51] op_sel:[1,1] op_sel_hi:[0,1] neg_lo:[0,1]
  v_pk_mul_f32 v[116:117], v[114:115], v[106:107] op_sel:[1,1] op_sel_hi:[0,1] neg_lo:[0,1]
  v_pk_fma_f32 v[60:61], v[58:59], v[50:51], v[60:61] op_sel:[0,0,0] op_sel_hi:[1,0,1]
  v_pk_fma_f32 v[116:117], v[114:115], v[106:107], v[116:117] op_sel:[0,0,0] op_sel_hi:[1,0,1]
  v_pk_mul_f32 v[62:63], v[60:61], v[50:51] op_sel:[1,1] op_sel_hi:[0,1] neg_lo:[0,1]
  v_pk_mul_f32 v[118:119], v[116:117], v[106:107] op_sel:[1,1] op_sel_hi:[0,1] neg_lo:[0,1]
  v_pk_fma_f32 v[62:63], v[60:61], v[50:51], v[62:63] op_sel:[0,0,0] op_sel_hi:[1,0,1]
  v_pk_fma_f32 v[118:119], v[116:117], v[106:107], v[118:119] op_sel:[0,0,0] op_sel_hi:[1,0,1]
  ds_write_b128 v103, v[56:59] offset:32
  v_pk_mul_f32 v[64:65], v[62:63], v[50:51] op_sel:[1,1] op_sel_hi:[0,1] neg_lo:[0,1]
  v_pk_fma_f32 v[64:65], v[62:63], v[50:51], v[64:65] op_sel:[0,0,0] op_sel_hi:[1,0,1]
  ds_write2_b32 v102, v106, v107 offset0:0 offset1:8
  v_pk_mul_f32 v[66:67], v[64:65], v[50:51] op_sel:[1,1] op_sel_hi:[0,1] neg_lo:[0,1]
  v_pk_fma_f32 v[66:67], v[64:65], v[50:51], v[66:67] op_sel:[0,0,0] op_sel_hi:[1,0,1]
  ds_write2_b32 v102, v108, v109 offset0:1 offset1:9
  ds_write_b128 v103, v[60:63] offset:48
  v_pk_mul_f32 v[68:69], v[66:67], v[50:51] op_sel:[1,1] op_sel_hi:[0,1] neg_lo:[0,1]
  v_pk_fma_f32 v[68:69], v[66:67], v[50:51], v[68:69] op_sel:[0,0,0] op_sel_hi:[1,0,1]
  ds_write2_b32 v102, v110, v111 offset0:2 offset1:10
  v_pk_mul_f32 v[70:71], v[68:69], v[50:51] op_sel:[1,1] op_sel_hi:[0,1] neg_lo:[0,1]
  v_pk_fma_f32 v[70:71], v[68:69], v[50:51], v[70:71] op_sel:[0,0,0] op_sel_hi:[1,0,1]
  ds_write2_b32 v102, v112, v113 offset0:3 offset1:11
  ds_write_b128 v103, v[64:67] offset:64
  v_pk_mul_f32 v[72:73], v[70:71], v[50:51] op_sel:[1,1] op_sel_hi:[0,1] neg_lo:[0,1]
  v_pk_fma_f32 v[72:73], v[70:71], v[50:51], v[72:73] op_sel:[0,0,0] op_sel_hi:[1,0,1]
  ds_write2_b32 v102, v114, v115 offset0:4 offset1:12
  v_pk_mul_f32 v[74:75], v[72:73], v[50:51] op_sel:[1,1] op_sel_hi:[0,1] neg_lo:[0,1]
  v_pk_fma_f32 v[74:75], v[72:73], v[50:51], v[74:75] op_sel:[0,0,0] op_sel_hi:[1,0,1]
  ds_write2_b32 v102, v116, v117 offset0:5 offset1:13
  ds_write_b128 v103, v[68:71] offset:80
  v_pk_mul_f32 v[76:77], v[74:75], v[50:51] op_sel:[1,1] op_sel_hi:[0,1] neg_lo:[0,1]
  v_pk_fma_f32 v[76:77], v[74:75], v[50:51], v[76:77] op_sel:[0,0,0] op_sel_hi:[1,0,1]
  ds_write2_b32 v102, v118, v119 offset0:6 offset1:14
  v_pk_mul_f32 v[78:79], v[76:77], v[50:51] op_sel:[1,1] op_sel_hi:[0,1] neg_lo:[0,1]
  v_pk_fma_f32 v[78:79], v[76:77], v[50:51], v[78:79] op_sel:[0,0,0] op_sel_hi:[1,0,1]
  ds_write_b128 v103, v[72:75] offset:96
  v_pk_mul_f32 v[80:81], v[78:79], v[50:51] op_sel:[1,1] op_sel_hi:[0,1] neg_lo:[0,1]
  v_pk_fma_f32 v[80:81], v[78:79], v[50:51], v[80:81] op_sel:[0,0,0] op_sel_hi:[1,0,1]
  ds_write2_b32 v102, v50, v51 offset0:7 offset1:15
  ds_write_b128 v103, v[76:79] offset:112
  v_pk_mul_f32 v[98:99], v[80:81], v[80:81] op_sel:[1,1] op_sel_hi:[0,1] neg_lo:[0,1]
  v_pk_fma_f32 v[98:99], v[80:81], v[80:81], v[98:99] op_sel:[0,0,0] op_sel_hi:[1,0,1]
  v_pk_mul_f32 v[86:87], v[98:99], v[98:99] op_sel:[1,1] op_sel_hi:[0,1] neg_lo:[0,1]
  v_pk_fma_f32 v[86:87], v[98:99], v[98:99], v[86:87] op_sel:[0,0,0] op_sel_hi:[1,0,1]
  v_pk_mul_f32 v[88:89], v[86:87], v[86:87] op_sel:[1,1] op_sel_hi:[0,1] neg_lo:[0,1]
  v_pk_fma_f32 v[88:89], v[86:87], v[86:87], v[88:89] op_sel:[0,0,0] op_sel_hi:[1,0,1]
  v_pk_mul_f32 v[90:91], v[88:89], v[86:87] op_sel:[1,1] op_sel_hi:[0,1] neg_lo:[0,1]
  v_pk_fma_f32 v[90:91], v[88:89], v[86:87], v[90:91] op_sel:[0,0,0] op_sel_hi:[1,0,1]
  ds_write_b64 v103, v[80:81] offset:128
  ds_write_b128 v103, v[84:87] offset:144
  ds_write_b128 v103, v[88:91] offset:160
  s_branch join_7
w2_9:
  v_mov_b32 v88, 0
  s_lshl_b32 s12, s0, 11
  s_lshl_b32 s13, s1, 2
  s_add_u32 s12, s12, s13
  s_add_u32 s12, s12, 66560
  s_or_b32 s13, s8, s11
  v_mov_b32 v15, s13
  s_mov_b64 exec, 1
  buffer_store_dword v15, off, s[52:55], s12
  s_mov_b64 exec, -1
  s_lshl_b32 s12, s0, 11
  s_lshl_b32 s13, s1, 2
  s_add_u32 s12, s12, s13
  s_add_u32 s12, s12, 66560
  s_or_b32 s13, s8, s11
  v_mov_b32 v15, s13
  s_mov_b64 exec, 1
  buffer_store_dword v15, off, s[52:55], s12 offset:128 sc1
  s_mov_b64 exec, -1
  v_mov_b32 v89, 0
  v_mov_b32 v90, s8
  v_mov_b32_e64 v91, s8
  s_add_u32 s12, s83, 327680
  s_mov_b32 exec_hi, 0xff
  buffer_store_dwordx4 v[88:91], v2, s[52:55], s83 offen sc1
  buffer_store_dwordx4 v[88:91], v2, s[52:55], s12 offen sc1
  s_mov_b32 exec_hi, -1
  s_branch join_7
w3_10:
  s_waitcnt vmcnt(0)
  v_dot2_f32_bf16 v88, v48, s2, 0
  v_dot2_f32_bf16 v90, v48, v48, 0
  v_dot2_f32_bf16 v88, v49, s2, v88
  v_dot2_f32_bf16 v90, v49, v49, v90
  v_dot2_f32_bf16 v88, v50, s2, v88
  v_dot2_f32_bf16 v90, v50, v50, v90
  v_dot2_f32_bf16 v88, v51, s2, v88
  v_dot2_f32_bf16 v90, v51, v51, v90
  v_dot2_f32_bf16 v88, v52, s2, v88
  v_dot2_f32_bf16 v90, v52, v52, v90
  v_dot2_f32_bf16 v88, v53, s2, v88
  v_dot2_f32_bf16 v90, v53, v53, v90
  v_dot2_f32_bf16 v88, v54, s2, v88
  v_dot2_f32_bf16 v90, v54, v54, v90
  v_dot2_f32_bf16 v88, v55, s2, v88
  v_dot2_f32_bf16 v90, v55, v55, v90
  v_dot2_f32_bf16 v88, v56, s2, v88
  v_dot2_f32_bf16 v90, v56, v56, v90
  v_dot2_f32_bf16 v88, v57, s2, v88
  v_dot2_f32_bf16 v90, v57, v57, v90
  v_dot2_f32_bf16 v88, v58, s2, v88
  v_dot2_f32_bf16 v90, v58, v58, v90
  v_dot2_f32_bf16 v88, v59, s2, v88
  v_dot2_f32_bf16 v90, v59, v59, v90
  v_dot2_f32_bf16 v88, v60, s2, v88
  v_dot2_f32_bf16 v90, v60, v60, v90
  v_dot2_f32_bf16 v88, v61, s2, v88
  v_dot2_f32_bf16 v90, v61, v61, v90
  v_dot2_f32_bf16 v88, v62, s2, v88
  v_dot2_f32_bf16 v90, v62, v62, v90
  v_dot2_f32_bf16 v88, v63, s2, v88
  v_dot2_f32_bf16 v90, v63, v63, v90
  v_dot2_f32_bf16 v88, v64, s2, v88
  v_dot2_f32_bf16 v90, v64, v64, v90
  v_dot2_f32_bf16 v88, v65, s2, v88
  v_dot2_f32_bf16 v90, v65, v65, v90
  v_dot2_f32_bf16 v88, v66, s2, v88
  v_dot2_f32_bf16 v90, v66, v66, v90
  v_dot2_f32_bf16 v88, v67, s2, v88
  v_dot2_f32_bf16 v90, v67, v67, v90
  v_dot2_f32_bf16 v88, v68, s2, v88
  v_dot2_f32_bf16 v90, v68, v68, v90
  v_dot2_f32_bf16 v88, v69, s2, v88
  v_dot2_f32_bf16 v90, v69, v69, v90
  v_dot2_f32_bf16 v88, v70, s2, v88
  v_dot2_f32_bf16 v90, v70, v70, v90
  v_dot2_f32_bf16 v88, v71, s2, v88
  v_dot2_f32_bf16 v90, v71, v71, v90
  v_dot2_f32_bf16 v88, v72, s2, v88
  v_dot2_f32_bf16 v90, v72, v72, v90
  v_dot2_f32_bf16 v88, v73, s2, v88
  v_dot2_f32_bf16 v90, v73, v73, v90
  v_dot2_f32_bf16 v88, v74, s2, v88
  v_dot2_f32_bf16 v90, v74, v74, v90
  v_dot2_f32_bf16 v88, v75, s2, v88
  v_dot2_f32_bf16 v90, v75, v75, v90
  v_dot2_f32_bf16 v88, v76, s2, v88
  v_dot2_f32_bf16 v90, v76, v76, v90
  v_dot2_f32_bf16 v88, v77, s2, v88
  v_dot2_f32_bf16 v90, v77, v77, v90
  v_dot2_f32_bf16 v88, v78, s2, v88
  v_dot2_f32_bf16 v90, v78, v78, v90
  v_dot2_f32_bf16 v88, v79, s2, v88
  v_dot2_f32_bf16 v90, v79, v79, v90
  v_dot2_f32_bf16 v88, v80, s2, v88
  v_dot2_f32_bf16 v90, v80, v80, v90
  v_dot2_f32_bf16 v88, v81, s2, v88
  v_dot2_f32_bf16 v90, v81, v81, v90
  v_dot2_f32_bf16 v88, v82, s2, v88
  v_dot2_f32_bf16 v90, v82, v82, v90
  v_dot2_f32_bf16 v88, v83, s2, v88
  v_dot2_f32_bf16 v90, v83, v83, v90
  v_dot2_f32_bf16 v88, v84, s2, v88
  v_dot2_f32_bf16 v90, v84, v84, v90
  v_dot2_f32_bf16 v88, v85, s2, v88
  v_dot2_f32_bf16 v90, v85, v85, v90
  v_dot2_f32_bf16 v88, v86, s2, v88
  v_dot2_f32_bf16 v90, v86, v86, v90
  v_dot2_f32_bf16 v88, v87, s2, v88
  v_dot2_f32_bf16 v90, v87, v87, v90
  s_nop 1
  v_add_f32_dpp v88, v88, v88 quad_perm:[1,0,3,2] row_mask:0xf bank_mask:0xf
  v_add_f32_dpp v90, v90, v90 quad_perm:[1,0,3,2] row_mask:0xf bank_mask:0xf
  s_nop 0
  v_add_f32_dpp v88, v88, v88 quad_perm:[2,3,0,1] row_mask:0xf bank_mask:0xf
  v_add_f32_dpp v90, v90, v90 quad_perm:[2,3,0,1] row_mask:0xf bank_mask:0xf
  s_nop 0
  v_add_f32_dpp v88, v88, v88 row_half_mirror row_mask:0xf bank_mask:0xf
  v_add_f32_dpp v90, v90, v90 row_half_mirror row_mask:0xf bank_mask:0xf
  v_mul_f32 v88, 0x3acccccd, v88
  v_mul_f32 v90, 0x3acccccd, v90
  v_fma_f32 v90, -v88, v88, v90
  v_max_f32_e64 v90, 0, v90
  v_cvt_pk_bf16_f32 v88, v88, v88
  v_and_b32 v88, 0xffff0000, v88
  v_cvt_pk_bf16_f32 v90, v90, v90
  v_and_b32 v90, 0xffff0000, v90
  v_add_f32 v90, 0x3727c5ac, v90
  v_cvt_pk_bf16_f32 v90, v90, v90
  v_and_b32 v90, 0xffff0000, v90
  v_sqrt_f32 v90, v90
  s_nop 0
  v_cvt_pk_bf16_f32 v90, v90, v90
  v_and_b32 v90, 0xffff0000, v90
  v_rcp_f32 v89, v90
  v_mov_b32 v90, s8
  v_mov_b32 v91, s8
  v_lshlrev_b32 v11, 1, v1
  s_lshl_b32 s12, s3, 4
  s_add_u32 s12, s12, s4
  s_lshl_b32 s12, s12, 7
  s_add_u32 s12, s12, 262144
  s_mov_b32 exec_lo, 0x01010101
  s_mov_b32 exec_hi, 0x01010101
  buffer_store_dwordx4 v[88:91], v11, s[52:55], s12 offen sc1
  s_mov_b64 exec, -1
join_7:
  s_lshl_b32 s93, s3, 11
  s_lshl_b32 s12, s7, 9
  s_add_u32 s93, s93, s12
  s_add_u32 s93, s93, 262144
  v_and_b32 v160, 7, v3
  v_lshlrev_b32_e64 v160, 4, v160
  v_lshl_add_u32 v160, v4, 7, v160
  s_mul_i32 s94, s4, 640
  s_add_u32 s94, s94, 303104
  v_lshlrev_b32 v161, 3, v1
  v_lshlrev_b32 v162, 3, v3
  v_and_b32 v187, 31, v1
  v_lshlrev_b32 v187, 4, v187
  s_lshl_b32 s88, s6, 11
  s_add_u32 s88, s88, 66048
  v_and_b32 v185, 31, v1
  v_lshlrev_b32 v185, 2, v185
  s_lshl_b32 s89, s0, 11
  s_add_u32 s89, s89, 66560
  v_add_u32 v11, 1, v3
  v_and_b32 v12, 1, v11
  v_mul_u32_u24 v12, 4160, v12
  v_lshrrev_b32_e64 v11, 1, v11
  v_lshl_add_u32 v12, v11, 2, v12
  v_lshl_add_u32 v12, v4, 4, v12
  v_sub_u32 v11, 15, v3
  v_lshlrev_b32 v11, 5, v11
  v_lshl_add_u32 v11, v4, 4, v11
  s_lshr_b32 s12, s7, 1
  s_and_b32 s13, s7, 1
  s_lshl_b32 s13, s13, 8
  s_mul_i32 s14, s12, 8320
  s_add_u32 s14, s14, s13
  s_add_u32 s14, s14, 102400
  v_add_u32_e64 v232, s14, v12
  s_mul_i32 s14, s12, 4608
  s_add_u32 s14, s14, s13
  v_add_u32 v240, s14, v11
  s_lshl_b32 s13, s7, 7
  s_add_u32 s14, s13, 119040
  v_add_u32 v236, s14, v12
  s_add_u32 s14, s13, 9216
  v_add_u32_e64 v241, s14, v11
  s_mul_i32 s13, s5, 163840
  s_mul_i32 s14, s7, 10240
  s_add_u32 s13, s13, s14
  s_add_u32 s13, s13, 0
  s_add_u32 s14, s7, 1
  s_and_b32 s14, s14, 3
  s_mul_i32 s15, s14, 40960
  s_add_u32 s16, s15, s13
  s_mul_i32 s15, s14, 10240
  s_add_u32 s15, s15, 102400
  v_add_u32 v44, s15, v2
  s_add_u32 s14, s7, 2
  s_and_b32 s14, s14, 3
  s_mul_i32 s15, s14, 40960
  s_add_u32 s17, s15, s13
  s_mul_i32 s15, s14, 10240
  s_add_u32 s15, s15, 107520
  v_add_u32 v45, s15, v2
  s_add_u32 s14, s7, 3
  s_and_b32 s14, s14, 3
  s_mul_i32 s15, s14, 40960
  s_add_u32 s18, s15, s13
  s_mul_i32 s15, s14, 5120
  v_add_u32 v46, s15, v2
  s_add_u32 s14, s7, 4
  s_and_b32 s14, s14, 3
  s_mul_i32 s15, s14, 40960
  s_add_u32 s19, s15, s13
  s_lshl_b32 s49, s3, 10
  s_lshl_b32 s13, s7, 6
  s_add_u32 s49, s49, s13
  s_and_b32 s13, s5, 1
  s_lshl_b32 s13, s13, 3
  s_add_u32 s49, s49, s13
  s_add_u32 s49, s49, 4352
  v_and_b32 v244, 3, v1
  v_lshlrev_b32 v244, 4, v244
  s_lshr_b32 s13, s7, 1
  s_add_u32 s12, s86, s13
  s_bitcmp1_b32 s12, 0
  s_cselect_b32 s14, 16, 0
  s_lshr_b32 s72, s72, s14
  s_and_b32 s30, s72, 0xffff
  s_lshl_b32 s31, s72, 16
  s_bitcmp1_b32 s24, 0
  s_cselect_b32 s14, 16, 0
  s_lshr_b32 s73, s73, s14
  s_and_b32 s25, s73, 0xffff
  s_lshl_b32 s45, s73, 16
  s_lshl_b32 s50, s12, 12
  s_and_b32 s12, s7, 1
  s_lshl_b32 s12, s12, 11
  s_add_u32 s50, s50, s12
  s_add_u32 s50, s50, 19922944
  s_mul_i32 s13, s13, 4608
  s_sub_u32 s13, s13, s12
  s_add_u32 s13, s13, 2552
  v_lshlrev_b32_e64 v246, 5, v3
  v_lshl_add_u32 v246, v4, 3, v246
  v_sub_u32 v247, s13, v246
  s_bitcmp1_b32 s1, 0
  s_movk_i32 s12, 0x7421
  s_cselect_b32 s12, 0x6530, s12
  s_lshl_b32 s13, s7, 2
  s_lshr_b32 s12, s12, s13
  s_and_b32 s12, s12, 7
  s_lshl_b32 s12, s12, 9
  s_lshl_b32 s51, s24, 12
  s_add_u32 s51, s51, s12
  s_add_u32 s51, s51, 19922944
  s_sub_u32 s12, 13304, s12
  v_sub_u32 v248, s12, v246
  s_lshl_b32 s12, s7, 12
  s_add_u32 s13, s12, 102400
  v_add_u32 v252, s13, v2
  s_add_u32 s13, s12, 127360
  v_add_u32_e64 v249, s13, v2
  s_xor_b32 s13, s12, 4096
  s_add_u32 s13, s13, 127360
  v_add_u32 v250, s13, v2
  s_lshl_b32 s13, s7, 10
  s_add_u32 s13, s13, 102400
  v_add_u32_e64 v251, s13, v2
  v_accvgpr_write_b32 a200, v232
  v_accvgpr_write_b32 a201, v236
  v_accvgpr_write_b32 a202, v240
  v_accvgpr_write_b32 a203, v241
  v_accvgpr_write_b32 a204, v246
  v_accvgpr_write_b32 a205, v247
  v_accvgpr_write_b32 a206, v248
  v_accvgpr_write_b32 a207, v249
  v_accvgpr_write_b32 a208, v250
  v_accvgpr_write_b32 a209, v251
  v_accvgpr_write_b32 a210, v252
  v_accvgpr_write_b32 a211, v44
  v_accvgpr_write_b32 a212, v45
  v_accvgpr_write_b32 a213, v46
  v_accvgpr_write_b32 a214, v244
  s_lshl_b32 s12, s5, 6
  s_lshr_b32 s13, s7, 1
  s_lshl_b32 s13, s13, 5
  s_add_u32 s12, s12, s13
  s_and_b32 s13, s7, 1
  s_lshl_b32 s13, s13, 2
  s_add_u32 s12, s12, s13
  s_mul_i32 s20, s12, 1280
  s_mul_i32 s13, s6, 160
  s_add_u32 s20, s20, s13
  s_lshl_b32 s48, s7, 12
  s_add_u32 s48, s48, 127360
  v_add_u32 v11, 0, v1
  v_mul_u32_u24 v12, 205, v11
  v_lshrrev_b32 v12, 11, v12
  v_lshrrev_b32 v13, 2, v12
  v_mul_u32_u24 v12, 1120, v12
  v_mul_u32_u24 v13, 5120, v13
  v_lshlrev_b32_e64 v11, 4, v11
  v_add3_u32 v224, v11, v12, v13
  v_add_u32_e64 v11, 64, v1
  v_mul_u32_u24 v12, 205, v11
  v_lshrrev_b32 v12, 11, v12
  v_lshrrev_b32 v13, 2, v12
  v_mul_u32_u24 v12, 1120, v12
  v_mul_u32_u24 v13, 5120, v13
  v_lshlrev_b32_e64 v11, 4, v11
  v_add3_u32 v225, v11, v12, v13
  v_add_u32 v11, 128, v1
  v_mul_u32_u24 v12, 205, v11
  v_lshrrev_b32 v12, 11, v12
  v_lshrrev_b32 v13, 2, v12
  v_mul_u32_u24 v12, 1120, v12
  v_mul_u32_u24 v13, 5120, v13
  v_lshlrev_b32_e64 v11, 4, v11
  v_add3_u32 v226, v11, v12, v13
  s_and_b32 s12, s5, 1
  s_lshl_b32 s12, s12, 2
  s_add_u32 s12, s12, s7
  s_lshr_b32 s13, s12, 1
  s_lshl_b32 s13, s13, 8
  s_and_b32 s12, s12, 1
  s_lshl_b32 s12, s12, 5
  s_add_u32 s12, s12, s13
  s_add_u32 s12, s12, 158720
  v_lshrrev_b32 v12, 2, v3
  v_lshlrev_b32 v12, 6, v12
  v_and_b32_e64 v13, 3, v3
  v_lshl_add_u32 v12, v13, 3, v12
  v_add_u32 v227, s12, v12
  v_and_b32 v13, 7, v3
  v_lshlrev_b32_e64 v13, 3, v13
  v_lshl_add_u32 v13, v4, 6, v13
  s_lshl_b32 s12, s7, 8
  s_add_u32 s12, s12, 158720
  v_add_u32 v228, s12, v13
  v_lshl_add_u32 v243, v4, 3, s48
  v_mul_u32_u24 v242, 160, v3
  v_lshl_add_u32 v242, v4, 3, v242
  v_add_u32 v242, s48, v242
  s_lshl_b32 s12, s3, 4
  s_add_u32 s12, s12, s4
  s_lshl_b32 s12, s12, 12
  s_add_u32 s12, s12, 1310720
  s_sub_u32 s12, s12, 0
  v_mov_b32 v11, s12
  s_lshl_b32 s12, s3, 10
  s_add_u32 s12, s12, 4096
  s_sub_u32 s12, s12, 3072
  v_cmp_lt_u32 vcc, 23, v1
  v_mov_b32 v15, s12
  s_nop 0
  v_cndmask_b32 v11, v11, v15, vcc
  v_lshl_add_u32 v11, v1, 7, v11
  v_accvgpr_write_b32 a245, v11
  s_add_u32 m0, s75, 0
  s_add_u32 s14, s74, 0
  buffer_load_dwordx4 v148, s[56:59], s14 offen lds
  buffer_load_dwordx4 v149, s[56:59], s14 offen offset:2048 lds
  s_add_u32 m0, s75, 4096
  s_add_u32 s14, s74, 20480
  buffer_load_dwordx4 v148, s[56:59], s14 offen lds
  buffer_load_dwordx4 v149, s[56:59], s14 offen offset:2048 lds
  s_add_u32 m0, s75, 8192
  s_add_u32 s14, s74, 40960
  buffer_load_dwordx4 v148, s[56:59], s14 offen lds
  s_add_u32 m0, s77, 0
  s_add_u32 s15, s76, 0
  buffer_load_dwordx4 v146, s[68:71], s15 offen lds
  buffer_load_dwordx4 v147, s[68:71], s15 offen offset:1024 lds
  s_add_u32 m0, s77, 8192
  s_add_u32 s15, s76, 5120
  buffer_load_dwordx4 v146, s[68:71], s15 offen lds
  buffer_load_dwordx4 v147, s[68:71], s15 offen offset:1024 lds
  v_mul_u32_u24 v11, 171, v1
  v_lshrrev_b32 v11, 11, v11
  v_mul_u32_u24 v12, 12, v11
  v_sub_u32 v12, v1, v12
  s_mul_i32 s12, s4, 5
  v_min_u32 v13, 4, v11
  v_add_u32 v13, s12, v13
  s_mul_i32 s13, s7, 12
  v_add_u32 v12, s13, v12
  v_cmp_gt_u32 vcc, 40, v12
  v_cmp_gt_u32 s[14:15], 5, v11
  s_lshr_b32 s13, s1, 4
  s_mul_i32 s13, s13, 40
  v_min_u32 v12, 39, v12
  s_and_b64 vcc, vcc, s[14:15]
  v_add_u32_e64 v12, s13, v12
  s_mul_i32 s14, s0, 102400
  v_mul_u32_u24 v14, 1280, v12
  v_lshl_add_u32 v14, v13, 4, v14
  v_add_u32_e64 v14, s14, v14
  global_load_dwordx4 v[176:179], v14, s[26:27]
  global_load_dwordx4 v[180:183], v14, s[28:29]
  v_lshrrev_b32_e64 v14, 2, v13
  v_mul_u32_u24 v14, 10240, v14
  v_and_b32_e64 v13, 3, v13
  v_lshl_add_u32 v14, v13, 8, v14
  v_lshrrev_b32_e64 v13, 4, v12
  v_lshl_add_u32 v14, v13, 10, v14
  v_and_b32_e64 v12, 15, v12
  v_lshl_add_u32 v14, v12, 4, v14
  v_mov_b32 v13, 1879048192
  v_cndmask_b32 v174, v13, v14, vcc
  v_min_u32 v11, 4, v11
  v_lshlrev_b32_e64 v11, 6, v11
  v_add_u32 v175, 159744, v11
  s_waitcnt vmcnt(11)
  s_waitcnt lgkmcnt(0)
  s_barrier
  buffer_load_dword v184, v185, s[52:55], s89 offen sc1
  v_lshrrev_b32 v11, 1, v3
  v_mul_u32_u24 v12, 176, v11
  v_mul_u32_u24 v11, 80, v11
  v_and_b32_e64 v13, 1, v3
  v_lshl_add_u32 v12, v13, 2, v12
  v_lshl_add_u32 v12, v4, 3, v12
  s_lshl_b32 s12, s7, 5
  s_add_u32 s12, s12, 145184
  v_add_u32 v12, s12, v12
  v_add_u32 v11, 160640, v11
  v_cvt_f32_u32 v151, v13
  v_min_u32 v13, 39, v1
  v_mul_u32_u24 v13, 176, v13
  v_fma_f32 v151, 2.0, v151, -1.0
  v_add_u32 v13, 145184, v13
  s_lshl_b32 s12, s7, 3
  ds_read_b32 v16, v11 offset:0
  ds_read_b32 v21, v11 offset:32
  ds_read_b32 v26, v12 offset:0
  ds_read_b32 v17, v11 offset:640
  ds_read_b32 v22, v11 offset:672
  ds_read_b32 v28, v12 offset:1408
  ds_read_b32 v18, v11 offset:1280
  ds_read_b32 v23, v11 offset:1312
  ds_read_b32 v30, v12 offset:2816
  ds_read_b32 v19, v11 offset:1920
  ds_read_b32 v24, v11 offset:1952
  ds_read_b32 v32, v12 offset:4224
  ds_read_b32 v20, v11 offset:2560
  ds_read_b32 v25, v11 offset:2592
  ds_read_b32 v34, v12 offset:5632
  ds_read_b64 v[36:37], v13 offset:8
  ds_read_b64 v[38:39], v13 offset:128
  v_add_u32 v13, s12, v13
  ds_read_b64 v[40:41], v13 offset:144
  s_cmp_eq_u32 s7, 3
  s_cbranch_scc1 w3_11
  ds_read_b128 v[88:91], v173
  ds_read_b128 v[92:95], v173 offset:16
  ds_read_b64 v[48:49], v172 offset:640
  ds_read_b64 v[50:51], v172 offset:768
  ds_read_b64 v[52:53], v172 offset:896
  ds_read_b64 v[54:55], v172 offset:1056
  ds_read_b64 v[56:57], v172 offset:1184
  ds_read_b64 v[58:59], v172 offset:1312
  ds_read_b64 v[60:61], v172 offset:1440
  ds_read_b64 v[62:63], v172 offset:1568
  ds_read_b64 v[64:65], v172 offset:1696
  ds_read_b64 v[66:67], v172 offset:1824
  ds_read_b64 v[68:69], v172 offset:1952
  ds_read_b64 v[70:71], v172 offset:13728
  ds_read_b64 v[72:73], v172 offset:13856
  ds_read_b64 v[74:75], v172 offset:13984
  ds_read_b64 v[76:77], v172 offset:14112
  ds_read_b64 v[78:79], v172 offset:14240
  ds_read_b64 v[80:81], v172 offset:14368
  ds_read_b64 v[82:83], v172 offset:14496
  ds_read_b64 v[84:85], v172 offset:14624
  s_waitcnt lgkmcnt(15)
  v_lshlrev_b32 v96, 16, v88
  v_and_b32 v100, 0xffff0000, v88
  v_lshlrev_b32_e64 v104, 16, v89
  v_and_b32 v108, 0xffff0000, v89
  v_lshlrev_b32_e64 v97, 16, v90
  v_and_b32 v101, 0xffff0000, v90
  v_lshlrev_b32_e64 v105, 16, v91
  v_and_b32 v109, 0xffff0000, v91
  v_lshlrev_b32_e64 v98, 16, v92
  v_and_b32 v102, 0xffff0000, v92
  v_lshlrev_b32_e64 v106, 16, v93
  v_and_b32 v110, 0xffff0000, v93
  v_lshlrev_b32_e64 v99, 16, v94
  v_and_b32 v103, 0xffff0000, v94
  v_lshlrev_b32_e64 v107, 16, v95
  v_and_b32 v111, 0xffff0000, v95
  s_waitcnt lgkmcnt(8)
  v_lshlrev_b32 v216, 16, v48
  v_and_b32 v217, 0xffff0000, v48
  v_pk_mul_f32 v[112:113], v[216:217], v[108:109]
  v_lshlrev_b32_e64 v218, 16, v50
  v_and_b32 v219, 0xffff0000, v50
  v_pk_mul_f32 v[114:115], v[218:219], v[108:109]
  v_lshlrev_b32_e64 v216, 16, v52
  v_and_b32 v217, 0xffff0000, v52
  v_pk_fma_f32 v[112:113], v[218:219], v[104:105], v[112:113]
  v_pk_mul_f32 v[116:117], v[216:217], v[108:109]
  v_lshlrev_b32_e64 v218, 16, v54
  v_and_b32 v219, 0xffff0000, v54
  v_pk_fma_f32 v[114:115], v[216:217], v[104:105], v[114:115]
  v_pk_fma_f32 v[112:113], v[216:217], v[100:101], v[112:113]
  v_pk_mul_f32 v[118:119], v[218:219], v[108:109]
  v_lshlrev_b32_e64 v216, 16, v56
  v_and_b32 v217, 0xffff0000, v56
  v_pk_fma_f32 v[116:117], v[218:219], v[104:105], v[116:117]
  v_pk_fma_f32 v[114:115], v[218:219], v[100:101], v[114:115]
  v_pk_fma_f32 v[112:113], v[218:219], v[96:97], v[112:113]
  v_pk_mul_f32 v[120:121], v[216:217], v[108:109]
  v_lshlrev_b32_e64 v218, 16, v58
  v_and_b32 v219, 0xffff0000, v58
  v_pk_fma_f32 v[118:119], v[216:217], v[104:105], v[118:119]
  v_pk_fma_f32 v[116:117], v[216:217], v[100:101], v[116:117]
  v_pk_fma_f32 v[114:115], v[216:217], v[96:97], v[114:115]
  v_pk_mul_f32 v[122:123], v[218:219], v[108:109]
  v_lshlrev_b32_e64 v216, 16, v60
  v_and_b32 v217, 0xffff0000, v60
  v_pk_fma_f32 v[120:121], v[218:219], v[104:105], v[120:121]
  v_pk_fma_f32 v[118:119], v[218:219], v[100:101], v[118:119]
  v_pk_fma_f32 v[116:117], v[218:219], v[96:97], v[116:117]
  v_pk_mul_f32 v[124:125], v[216:217], v[108:109]
  v_lshlrev_b32_e64 v218, 16, v62
  v_and_b32 v219, 0xffff0000, v62
  v_pk_fma_f32 v[122:123], v[216:217], v[104:105], v[122:123]
  v_pk_fma_f32 v[120:121], v[216:217], v[100:101], v[120:121]
  v_pk_fma_f32 v[118:119], v[216:217], v[96:97], v[118:119]
  v_pk_mul_f32 v[126:127], v[218:219], v[108:109]
  v_lshlrev_b32_e64 v216, 16, v64
  v_and_b32 v217, 0xffff0000, v64
  v_pk_fma_f32 v[124:125], v[218:219], v[104:105], v[124:125]
  v_pk_fma_f32 v[122:123], v[218:219], v[100:101], v[122:123]
  v_pk_fma_f32 v[120:121], v[218:219], v[96:97], v[120:121]
  v_pk_fma_f32 v[126:127], v[216:217], v[104:105], v[126:127]
  v_lshlrev_b32_e64 v218, 16, v66
  v_and_b32 v219, 0xffff0000, v66
  v_pk_fma_f32 v[124:125], v[216:217], v[100:101], v[124:125]
  v_pk_fma_f32 v[122:123], v[216:217], v[96:97], v[122:123]
  v_pk_fma_f32 v[126:127], v[218:219], v[100:101], v[126:127]
  v_lshlrev_b32_e64 v216, 16, v68
  v_and_b32 v217, 0xffff0000, v68
  v_pk_fma_f32 v[124:125], v[218:219], v[96:97], v[124:125]
  v_pk_fma_f32 v[126:127], v[216:217], v[96:97], v[126:127]
  s_waitcnt lgkmcnt(0)
  v_lshlrev_b32 v220, 16, v70
  v_and_b32 v221, 0xffff0000, v70
  v_lshlrev_b32_e64 v222, 16, v72
  v_and_b32 v223, 0xffff0000, v72
  v_pk_mul_f32 v[112:113], v[112:113], v[220:221]
  v_lshlrev_b32_e64 v220, 16, v74
  v_and_b32 v221, 0xffff0000, v74
  v_pk_mul_f32 v[114:115], v[114:115], v[222:223]
  v_lshlrev_b32_e64 v222, 16, v76
  v_and_b32 v223, 0xffff0000, v76
  v_pk_mul_f32 v[116:117], v[116:117], v[220:221]
  v_lshlrev_b32_e64 v220, 16, v78
  v_and_b32 v221, 0xffff0000, v78
  v_pk_mul_f32 v[118:119], v[118:119], v[222:223]
  v_lshlrev_b32_e64 v222, 16, v80
  v_and_b32 v223, 0xffff0000, v80
  v_pk_mul_f32 v[120:121], v[120:121], v[220:221]
  v_lshlrev_b32_e64 v220, 16, v82
  v_and_b32 v221, 0xffff0000, v82
  v_pk_mul_f32 v[122:123], v[122:123], v[222:223]
  v_lshlrev_b32_e64 v222, 16, v84
  v_and_b32 v223, 0xffff0000, v84
  v_pk_mul_f32 v[124:125], v[124:125], v[220:221]
  v_pk_mul_f32 v[126:127], v[126:127], v[222:223]
  v_cvt_pk_bf16_f32 v232, v126, v124
  v_cvt_pk_bf16_f32 v233, v122, v120
  v_cvt_pk_bf16_f32 v234, v118, v116
  v_cvt_pk_bf16_f32 v235, v114, v112
  v_cvt_pk_bf16_f32 v236, v127, v125
  v_cvt_pk_bf16_f32 v237, v123, v121
  v_cvt_pk_bf16_f32 v238, v119, v117
  v_cvt_pk_bf16_f32 v239, v115, v113
  v_lshlrev_b32_e64 v216, 16, v49
  v_and_b32 v217, 0xffff0000, v49
  v_pk_mul_f32 v[112:113], v[216:217], v[110:111]
  v_lshlrev_b32_e64 v218, 16, v51
  v_and_b32 v219, 0xffff0000, v51
  v_pk_mul_f32 v[114:115], v[218:219], v[110:111]
  v_lshlrev_b32_e64 v216, 16, v53
  v_and_b32 v217, 0xffff0000, v53
  v_pk_fma_f32 v[112:113], v[218:219], v[106:107], v[112:113]
  v_pk_mul_f32 v[116:117], v[216:217], v[110:111]
  v_lshlrev_b32_e64 v218, 16, v55
  v_and_b32 v219, 0xffff0000, v55
  v_pk_fma_f32 v[114:115], v[216:217], v[106:107], v[114:115]
  v_pk_fma_f32 v[112:113], v[216:217], v[102:103], v[112:113]
  v_pk_mul_f32 v[118:119], v[218:219], v[110:111]
  v_lshlrev_b32_e64 v216, 16, v57
  v_and_b32 v217, 0xffff0000, v57
  v_pk_fma_f32 v[116:117], v[218:219], v[106:107], v[116:117]
  v_pk_fma_f32 v[114:115], v[218:219], v[102:103], v[114:115]
  v_pk_fma_f32 v[112:113], v[218:219], v[98:99], v[112:113]
  v_pk_mul_f32 v[120:121], v[216:217], v[110:111]
  v_lshlrev_b32_e64 v218, 16, v59
  v_and_b32 v219, 0xffff0000, v59
  v_pk_fma_f32 v[118:119], v[216:217], v[106:107], v[118:119]
  v_pk_fma_f32 v[116:117], v[216:217], v[102:103], v[116:117]
  v_pk_fma_f32 v[114:115], v[216:217], v[98:99], v[114:115]
  v_pk_mul_f32 v[122:123], v[218:219], v[110:111]
  v_lshlrev_b32_e64 v216, 16, v61
  v_and_b32 v217, 0xffff0000, v61
  v_pk_fma_f32 v[120:121], v[218:219], v[106:107], v[120:121]
  v_pk_fma_f32 v[118:119], v[218:219], v[102:103], v[118:119]
  v_pk_fma_f32 v[116:117], v[218:219], v[98:99], v[116:117]
  v_pk_mul_f32 v[124:125], v[216:217], v[110:111]
  v_lshlrev_b32_e64 v218, 16, v63
  v_and_b32 v219, 0xffff0000, v63
  v_pk_fma_f32 v[122:123], v[216:217], v[106:107], v[122:123]
  v_pk_fma_f32 v[120:121], v[216:217], v[102:103], v[120:121]
  v_pk_fma_f32 v[118:119], v[216:217], v[98:99], v[118:119]
  v_pk_mul_f32 v[126:127], v[218:219], v[110:111]
  v_lshlrev_b32_e64 v216, 16, v65
  v_and_b32 v217, 0xffff0000, v65
  v_pk_fma_f32 v[124:125], v[218:219], v[106:107], v[124:125]
  v_pk_fma_f32 v[122:123], v[218:219], v[102:103], v[122:123]
  v_pk_fma_f32 v[120:121], v[218:219], v[98:99], v[120:121]
  v_pk_fma_f32 v[126:127], v[216:217], v[106:107], v[126:127]
  v_lshlrev_b32_e64 v218, 16, v67
  v_and_b32 v219, 0xffff0000, v67
  v_pk_fma_f32 v[124:125], v[216:217], v[102:103], v[124:125]
  v_pk_fma_f32 v[122:123], v[216:217], v[98:99], v[122:123]
  v_pk_fma_f32 v[126:127], v[218:219], v[102:103], v[126:127]
  v_lshlrev_b32_e64 v216, 16, v69
  v_and_b32 v217, 0xffff0000, v69
  v_pk_fma_f32 v[124:125], v[218:219], v[98:99], v[124:125]
  v_pk_fma_f32 v[126:127], v[216:217], v[98:99], v[126:127]
  v_lshlrev_b32_e64 v220, 16, v71
  v_and_b32 v221, 0xffff0000, v71
  v_lshlrev_b32_e64 v222, 16, v73
  v_and_b32 v223, 0xffff0000, v73
  v_pk_mul_f32 v[112:113], v[112:113], v[220:221]
  v_lshlrev_b32_e64 v220, 16, v75
  v_and_b32 v221, 0xffff0000, v75
  v_pk_mul_f32 v[114:115], v[114:115], v[222:223]
  v_lshlrev_b32_e64 v222, 16, v77
  v_and_b32 v223, 0xffff0000, v77
  v_pk_mul_f32 v[116:117], v[116:117], v[220:221]
  v_lshlrev_b32_e64 v220, 16, v79
  v_and_b32 v221, 0xffff0000, v79
  v_pk_mul_f32 v[118:119], v[118:119], v[222:223]
  v_lshlrev_b32_e64 v222, 16, v81
  v_and_b32 v223, 0xffff0000, v81
  v_pk_mul_f32 v[120:121], v[120:121], v[220:221]
  v_lshlrev_b32_e64 v220, 16, v83
  v_and_b32 v221, 0xffff0000, v83
  v_pk_mul_f32 v[122:123], v[122:123], v[222:223]
  v_lshlrev_b32_e64 v222, 16, v85
  v_and_b32 v223, 0xffff0000, v85
  v_pk_mul_f32 v[124:125], v[124:125], v[220:221]
  v_pk_mul_f32 v[126:127], v[126:127], v[222:223]
  v_cvt_pk_bf16_f32 v88, v126, v124
  v_cvt_pk_bf16_f32 v89, v122, v120
  v_cvt_pk_bf16_f32 v90, v118, v116
  v_cvt_pk_bf16_f32 v91, v114, v112
  v_cvt_pk_bf16_f32 v92, v127, v125
  v_cvt_pk_bf16_f32 v93, v123, v121
  v_cvt_pk_bf16_f32 v94, v119, v117
  v_cvt_pk_bf16_f32 v95, v115, v113
  s_waitcnt vmcnt(0)
  v_xor_b32 v15, s8, v184
  v_cmp_lt_u32 vcc, 15, v15
  s_cbranch_vccnz again_13
ok_14:
  s_or_b32 s13, s8, s11
  v_cmp_ne_u32 vcc, s13, v184
  s_cmp_eq_u64 vcc, 0
  s_cselect_b32 s9, 1, 0
  s_cmp_eq_u32 s7, 2
  s_cselect_b32 s40, 0, s9
  buffer_store_dwordx4 v[232:235], v171, s[52:55], s87 offen sc1
  s_add_u32 s87, s87, s36
  buffer_store_dwordx4 v[236:239], v171, s[52:55], s87 offen sc1
  s_add_u32 s87, s87, s36
  buffer_store_dwordx4 v[88:91], v171, s[52:55], s87 offen sc1
  s_add_u32 s87, s87, s36
  buffer_store_dwordx4 v[92:95], v171, s[52:55], s87 offen sc1
  s_branch join_12
w3_11:
  s_lshl_b32 s12, s4, 3
  s_and_b32 s13, s3, 7
  s_add_u32 s12, s12, s13
  s_mul_i32 s12, s12, 6400
  s_mov_b32 exec_hi, 0xff
  buffer_load_dwordx4 v[48:51], v150, s[60:63], s12 offen offset:0
  buffer_load_dwordx4 v[52:55], v150, s[60:63], s12 offen offset:128
  buffer_load_dwordx4 v[56:59], v150, s[60:63], s12 offen offset:256
  buffer_load_dwordx4 v[60:63], v150, s[60:63], s12 offen offset:384
  buffer_load_dwordx4 v[64:67], v150, s[60:63], s12 offen offset:512
  buffer_load_dwordx4 v[68:71], v150, s[60:63], s12 offen offset:640
  buffer_load_dwordx4 v[72:75], v150, s[60:63], s12 offen offset:768
  buffer_load_dwordx4 v[76:79], v150, s[60:63], s12 offen offset:896
  buffer_load_dwordx4 v[80:83], v150, s[60:63], s12 offen offset:1024
  buffer_load_dwordx4 v[84:87], v150, s[60:63], s12 offen offset:1152
  s_mov_b32 exec_hi, -1
  s_mov_b32 s64, s22
  s_and_b32 s65, s23, 0xffff
  s_mov_b32 s66, 819200
  s_mov_b32 s67, 0x20000
  v_xor_b32 v11, 64, v148
  v_xor_b32_e64 v12, 64, v149
  s_mul_i32 s15, s4, 51200
  s_add_u32 s14, s15, 256
  s_mov_b32 m0, 20480
  s_nop 0
  buffer_load_dwordx4 v11, s[64:67], s14 offen lds
  buffer_load_dwordx4 v12, s[64:67], s14 offen offset:2048 lds
  s_mov_b32 m0, 21504
  s_nop 0
  buffer_load_dwordx4 v148, s[56:59], s14 offen lds
  buffer_load_dwordx4 v149, s[56:59], s14 offen offset:2048 lds
  s_add_u32 s14, s15, 20736
  s_mov_b32 m0, 24576
  s_nop 0
  buffer_load_dwordx4 v11, s[64:67], s14 offen lds
  buffer_load_dwordx4 v12, s[64:67], s14 offen offset:2048 lds
  s_mov_b32 m0, 25600
  s_nop 0
  buffer_load_dwordx4 v148, s[56:59], s14 offen lds
  buffer_load_dwordx4 v149, s[56:59], s14 offen offset:2048 lds
  s_add_u32 s14, s15, 41216
  s_mov_b32 m0, 28672
  s_nop 0
  buffer_load_dwordx4 v11, s[64:67], s14 offen lds
  s_mov_b32 m0, 29696
  s_nop 0
  buffer_load_dwordx4 v148, s[56:59], s14 offen lds
  s_add_u32 s14, s15, 384
  s_mov_b32 m0, 30720
  s_nop 0
  buffer_load_dwordx4 v11, s[64:67], s14 offen lds
  buffer_load_dwordx4 v12, s[64:67], s14 offen offset:2048 lds
  s_mov_b32 m0, 31744
  s_nop 0
  buffer_load_dwordx4 v148, s[56:59], s14 offen lds
  buffer_load_dwordx4 v149, s[56:59], s14 offen offset:2048 lds
  s_add_u32 s14, s15, 20864
  s_mov_b32 m0, 34816
  s_nop 0
  buffer_load_dwordx4 v11, s[64:67], s14 offen lds
  buffer_load_dwordx4 v12, s[64:67], s14 offen offset:2048 lds
  s_mov_b32 m0, 35840
  s_nop 0
  buffer_load_dwordx4 v148, s[56:59], s14 offen lds
  buffer_load_dwordx4 v149, s[56:59], s14 offen offset:2048 lds
  s_add_u32 s14, s15, 41344
  s_mov_b32 m0, 38912
  s_nop 0
  buffer_load_dwordx4 v11, s[64:67], s14 offen lds
  s_mov_b32 m0, 39936
  s_nop 0
  buffer_load_dwordx4 v148, s[56:59], s14 offen lds
  s_waitcnt vmcnt(30)
  v_xor_b32 v15, s8, v184
  v_cmp_lt_u32 vcc, 15, v15
  s_cbranch_vccnz again_15
ok_16:
  s_or_b32 s13, s8, s11
  v_cmp_ne_u32 vcc, s13, v184
  s_cmp_eq_u64 vcc, 0
  s_cselect_b32 s9, 1, 0
  s_cmp_eq_u32 s7, 2
  s_cselect_b32 s40, 0, s9
  s_waitcnt vmcnt(20)
  v_dot2_f32_bf16 v88, v48, s2, 0
  v_dot2_f32_bf16 v89, v49, s2, 0
  v_dot2_f32_bf16 v88, v50, s2, v88
  v_dot2_f32_bf16 v89, v51, s2, v89
  v_dot2_f32_bf16 v88, v52, s2, v88
  v_dot2_f32_bf16 v89, v53, s2, v89
  v_dot2_f32_bf16 v88, v54, s2, v88
  v_dot2_f32_bf16 v89, v55, s2, v89
  v_dot2_f32_bf16 v88, v56, s2, v88
  v_dot2_f32_bf16 v89, v57, s2, v89
  v_dot2_f32_bf16 v88, v58, s2, v88
  v_dot2_f32_bf16 v89, v59, s2, v89
  v_dot2_f32_bf16 v88, v60, s2, v88
  v_dot2_f32_bf16 v89, v61, s2, v89
  v_dot2_f32_bf16 v88, v62, s2, v88
  v_dot2_f32_bf16 v89, v63, s2, v89
  v_dot2_f32_bf16 v88, v64, s2, v88
  v_dot2_f32_bf16 v89, v65, s2, v89
  v_dot2_f32_bf16 v88, v66, s2, v88
  v_dot2_f32_bf16 v89, v67, s2, v89
  v_dot2_f32_bf16 v88, v68, s2, v88
  v_dot2_f32_bf16 v89, v69, s2, v89
  v_dot2_f32_bf16 v88, v70, s2, v88
  v_dot2_f32_bf16 v89, v71, s2, v89
  v_dot2_f32_bf16 v88, v72, s2, v88
  v_dot2_f32_bf16 v89, v73, s2, v89
  v_dot2_f32_bf16 v88, v74, s2, v88
  v_dot2_f32_bf16 v89, v75, s2, v89
  v_dot2_f32_bf16 v88, v76, s2, v88
  v_dot2_f32_bf16 v89, v77, s2, v89
  v_dot2_f32_bf16 v88, v78, s2, v88
  v_dot2_f32_bf16 v89, v79, s2, v89
  v_dot2_f32_bf16 v88, v80, s2, v88
  v_dot2_f32_bf16 v89, v81, s2, v89
  v_dot2_f32_bf16 v88, v82, s2, v88
  v_dot2_f32_bf16 v89, v83, s2, v89
  v_dot2_f32_bf16 v88, v84, s2, v88
  v_dot2_f32_bf16 v89, v85, s2, v89
  v_dot2_f32_bf16 v88, v86, s2, v88
  v_dot2_f32_bf16 v89, v87, s2, v89
  s_nop 2
  v_add_f32 v88, v88, v89
  s_nop 1
  v_add_f32_dpp v88, v88, v88 quad_perm:[1,0,3,2] row_mask:0xf bank_mask:0xf
  s_nop 1
  v_add_f32_dpp v88, v88, v88 quad_perm:[2,3,0,1] row_mask:0xf bank_mask:0xf
  s_nop 1
  v_add_f32_dpp v88, v88, v88 row_half_mirror row_mask:0xf bank_mask:0xf
  v_mov_b32 v89, s8
  v_lshlrev_b32 v11, 1, v1
  s_lshl_b32 s12, s4, 3
  s_and_b32 s13, s3, 7
  s_add_u32 s12, s12, s13
  s_mul_i32 s12, s12, 80
  s_and_b32 s13, s3, 8
  s_add_u32 s12, s12, s13
  s_add_u32 s12, s12, 303104
  s_mov_b32 exec_lo, 0x01010101
  s_mov_b32 exec_hi, 1
  buffer_store_dwordx2 v[88:89], v11, s[52:55], s12 offen sc1
  s_mov_b64 exec, -1
join_12:
  s_waitcnt lgkmcnt(0)
  v_mul_f32_e64 v21, v151, v21
  v_mul_f32_dpp v27, v26, v151 quad_perm:[1,0,3,2] row_mask:0xf bank_mask:0xf
  v_mul_f32_e64 v22, v151, v22
  v_mul_f32_dpp v29, v28, v151 quad_perm:[1,0,3,2] row_mask:0xf bank_mask:0xf
  v_mul_f32_e64 v23, v151, v23
  v_mul_f32_dpp v31, v30, v151 quad_perm:[1,0,3,2] row_mask:0xf bank_mask:0xf
  v_mul_f32_e64 v24, v151, v24
  v_mul_f32_dpp v33, v32, v151 quad_perm:[1,0,3,2] row_mask:0xf bank_mask:0xf
  v_mul_f32_e64 v25, v151, v25
  v_mul_f32_dpp v35, v34, v151 quad_perm:[1,0,3,2] row_mask:0xf bank_mask:0xf
  s_waitcnt vmcnt(7)
  s_barrier
  ds_read_b128 v[128:131], v144 offset:0
  ds_read_b128 v[132:135], v144 offset:8192
  ds_read_b128 v[88:91], v5 offset:0
  ds_read_b128 v[92:95], v5 offset:2048
  ds_read_b128 v[96:99], v5 offset:4096
  ds_read_b128 v[100:103], v5 offset:6144
  ds_read_b128 v[104:107], v5 offset:8192
  s_add_u32 m0, s77, 16384
  s_add_u32 s15, s76, 128
  buffer_load_dwordx4 v146, s[68:71], s15 offen lds
  buffer_load_dwordx4 v147, s[68:71], s15 offen offset:1024 lds
  s_add_u32 m0, s77, 24576
  s_add_u32 s15, s76, 5248
  buffer_load_dwordx4 v146, s[68:71], s15 offen lds
  buffer_load_dwordx4 v147, s[68:71], s15 offen offset:1024 lds
  s_waitcnt lgkmcnt(4)
  v_mfma_f32_16x16x32_bf16 v[48:51], v[128:131], v[88:91], 0
  ds_read_b128 v[136:139], v145 offset:0
  ds_read_b128 v[140:143], v145 offset:8192
  ds_read_b128 v[108:111], v6 offset:0
  s_add_u32 m0, s77, 32768
  s_add_u32 s15, s76, 256
  buffer_load_dwordx4 v146, s[68:71], s15 offen lds
  buffer_load_dwordx4 v147, s[68:71], s15 offen offset:1024 lds
  v_mfma_f32_16x16x32_bf16 v[52:55], v[132:135], v[88:91], 0
  s_add_u32 m0, s77, 40960
  s_add_u32 s15, s76, 5376
  buffer_load_dwordx4 v146, s[68:71], s15 offen lds
  buffer_load_dwordx4 v147, s[68:71], s15 offen offset:1024 lds
  s_waitcnt lgkmcnt(6)
  v_mfma_f32_16x16x32_bf16 v[56:59], v[128:131], v[92:95], 0
  ds_read_b128 v[112:115], v6 offset:2048
  s_add_u32 m0, s75, 40960
  s_add_u32 s14, s74, 512
  buffer_load_dwordx4 v148, s[56:59], s14 offen lds
  buffer_load_dwordx4 v149, s[56:59], s14 offen offset:2048 lds
  v_mfma_f32_16x16x32_bf16 v[60:63], v[132:135], v[92:95], 0
  s_add_u32 m0, s75, 45056
  s_add_u32 s14, s74, 20992
  buffer_load_dwordx4 v148, s[56:59], s14 offen lds
  buffer_load_dwordx4 v149, s[56:59], s14 offen offset:2048 lds
  s_waitcnt lgkmcnt(6)
  v_mfma_f32_16x16x32_bf16 v[64:67], v[128:131], v[96:99], 0
  ds_read_b128 v[116:119], v6 offset:4096
  v_mfma_f32_16x16x32_bf16 v[68:71], v[132:135], v[96:99], 0
  s_waitcnt lgkmcnt(6)
  v_mfma_f32_16x16x32_bf16 v[72:75], v[128:131], v[100:103], 0
  ds_read_b128 v[120:123], v6 offset:6144
  v_mfma_f32_16x16x32_bf16 v[76:79], v[132:135], v[100:103], 0
  s_waitcnt lgkmcnt(6)
  v_mfma_f32_16x16x32_bf16 v[80:83], v[128:131], v[104:107], 0
  ds_read_b128 v[124:127], v6 offset:8192
  v_mfma_f32_16x16x32_bf16 v[84:87], v[132:135], v[104:107], 0
  s_waitcnt vmcnt(8)
  s_waitcnt lgkmcnt(2)
  v_mfma_f32_16x16x32_bf16 v[48:51], v[136:139], v[108:111], v[48:51]
  ds_read_b128 v[128:131], v144 offset:16384
  ds_read_b128 v[132:135], v144 offset:24576
  ds_read_b128 v[88:91], v5 offset:10240
  ds_read_b128 v[192:195], v175 offset:0
  ds_read_b128 v[196:199], v175 offset:16
  v_mfma_f32_16x16x32_bf16 v[52:55], v[140:143], v[108:111], v[52:55]
  ds_read_b128 v[200:203], v175 offset:32
  ds_read_b128 v[204:207], v175 offset:48
  v_mfma_f32_16x16x32_bf16 v[56:59], v[136:139], v[112:115], v[56:59]
  ds_read_b128 v[92:95], v5 offset:12288
  s_waitcnt lgkmcnt(1)
  v_lshlrev_b32_e64 v152, 16, v176
  v_mfma_f32_16x16x32_bf16 v[60:63], v[140:143], v[112:115], v[60:63]
  v_and_b32 v153, 0xffff0000, v176
  v_lshlrev_b32_e64 v154, 16, v180
  v_mfma_f32_16x16x32_bf16 v[64:67], v[136:139], v[116:119], v[64:67]
  ds_read_b128 v[96:99], v5 offset:14336
  v_and_b32 v155, 0xffff0000, v180
  v_pk_mul_f32 v[156:157], v[152:153], v[192:193]
  v_mfma_f32_16x16x32_bf16 v[68:71], v[140:143], v[116:119], v[68:71]
  v_pk_mul_f32 v[158:159], v[152:153], v[194:195] neg_lo:[0,1] neg_hi:[0,1]
  v_pk_fma_f32 v[156:157], v[154:155], v[194:195], v[156:157] neg_lo:[0,1,0] neg_hi:[0,1,0]
  v_mfma_f32_16x16x32_bf16 v[72:75], v[136:139], v[120:123], v[72:75]
  ds_read_b128 v[100:103], v5 offset:16384
  v_pk_fma_f32 v[158:159], v[154:155], v[192:193], v[158:159] neg_lo:[0,1,0] neg_hi:[0,1,0]
  v_cvt_pk_bf16_f32 v176, v156, v157
  v_mfma_f32_16x16x32_bf16 v[76:79], v[140:143], v[120:123], v[76:79]
  s_add_u32 m0, s77, 49152
  s_add_u32 s15, s76, 384
  buffer_load_dwordx4 v146, s[68:71], s15 offen lds
  buffer_load_dwordx4 v147, s[68:71], s15 offen offset:1024 lds
  s_add_u32 m0, s77, 0
  s_add_u32 s15, s76, 5504
  buffer_load_dwordx4 v146, s[68:71], s15 offen lds
  buffer_load_dwordx4 v147, s[68:71], s15 offen offset:1024 lds
  v_mfma_f32_16x16x32_bf16 v[80:83], v[136:139], v[124:127], v[80:83]
  ds_read_b128 v[104:107], v5 offset:18432
  s_add_u32 m0, s75, 49152
  s_add_u32 s14, s74, 41472
  buffer_load_dwordx4 v148, s[56:59], s14 offen lds
  s_add_u32 m0, s75, 61440
  s_add_u32 s14, s74, 768
  buffer_load_dwordx4 v148, s[56:59], s14 offen lds
  buffer_load_dwordx4 v149, s[56:59], s14 offen offset:2048 lds
  v_mfma_f32_16x16x32_bf16 v[84:87], v[140:143], v[124:127], v[84:87]
  s_add_u32 m0, s75, 65536
  s_add_u32 s14, s74, 21248
  buffer_load_dwordx4 v148, s[56:59], s14 offen lds
  buffer_load_dwordx4 v149, s[56:59], s14 offen offset:2048 lds
  s_waitcnt lgkmcnt(2)
  v_mfma_f32_16x16x32_bf16 v[48:51], v[128:131], v[88:91], v[48:51]
  ds_read_b128 v[136:139], v145 offset:16384
  ds_read_b128 v[140:143], v145 offset:24576
  ds_read_b128 v[108:111], v6 offset:10240
  v_cvt_pk_bf16_f32 v180, v158, v159
  v_lshlrev_b32_e64 v152, 16, v177
  v_mfma_f32_16x16x32_bf16 v[52:55], v[132:135], v[88:91], v[52:55]
  v_and_b32 v153, 0xffff0000, v177
  v_lshlrev_b32_e64 v154, 16, v181
  v_mfma_f32_16x16x32_bf16 v[56:59], v[128:131], v[92:95], v[56:59]
  ds_read_b128 v[112:115], v6 offset:12288
  v_and_b32 v155, 0xffff0000, v181
  v_pk_mul_f32 v[156:157], v[152:153], v[196:197]
  v_mfma_f32_16x16x32_bf16 v[60:63], v[132:135], v[92:95], v[60:63]
  v_pk_mul_f32 v[158:159], v[152:153], v[198:199] neg_lo:[0,1] neg_hi:[0,1]
  v_pk_fma_f32 v[156:157], v[154:155], v[198:199], v[156:157] neg_lo:[0,1,0] neg_hi:[0,1,0]
  v_mfma_f32_16x16x32_bf16 v[64:67], v[128:131], v[96:99], v[64:67]
  ds_read_b128 v[116:119], v6 offset:14336
  v_pk_fma_f32 v[158:159], v[154:155], v[196:197], v[158:159] neg_lo:[0,1,0] neg_hi:[0,1,0]
  v_cvt_pk_bf16_f32 v177, v156, v157
  v_mfma_f32_16x16x32_bf16 v[68:71], v[132:135], v[96:99], v[68:71]
  v_cvt_pk_bf16_f32 v181, v158, v159
  v_lshlrev_b32 v152, 16, v178
  s_waitcnt lgkmcnt(5)
  v_mfma_f32_16x16x32_bf16 v[72:75], v[128:131], v[100:103], v[72:75]
  ds_read_b128 v[120:123], v6 offset:16384
  v_and_b32 v153, 0xffff0000, v178
  v_mfma_f32_16x16x32_bf16 v[76:79], v[132:135], v[100:103], v[76:79]
  v_lshlrev_b32_e64 v154, 16, v182
  v_mfma_f32_16x16x32_bf16 v[80:83], v[128:131], v[104:107], v[80:83]
  ds_read_b128 v[124:127], v6 offset:18432
  s_add_u32 m0, s77, 8192
  s_add_u32 s15, s76, 512
  buffer_load_dwordx4 v146, s[68:71], s15 offen lds
  buffer_load_dwordx4 v147, s[68:71], s15 offen offset:1024 lds
  v_mfma_f32_16x16x32_bf16 v[84:87], v[132:135], v[104:107], v[84:87]
  s_add_u32 m0, s75, 69632
  s_add_u32 s14, s74, 41728
  buffer_load_dwordx4 v148, s[56:59], s14 offen lds
  s_waitcnt vmcnt(16)
  s_barrier
  s_waitcnt lgkmcnt(2)
  v_mfma_f32_16x16x32_bf16 v[48:51], v[136:139], v[108:111], v[48:51]
  ds_read_b128 v[128:131], v144 offset:32768
  ds_read_b128 v[132:135], v144 offset:40960
  ds_read_b128 v[88:91], v5 offset:20480
  v_and_b32 v155, 0xffff0000, v182
  v_pk_mul_f32 v[156:157], v[152:153], v[200:201]
  v_mfma_f32_16x16x32_bf16 v[52:55], v[140:143], v[108:111], v[52:55]
  v_pk_mul_f32 v[158:159], v[152:153], v[202:203] neg_lo:[0,1] neg_hi:[0,1]
  v_pk_fma_f32 v[156:157], v[154:155], v[202:203], v[156:157] neg_lo:[0,1,0] neg_hi:[0,1,0]
  v_mfma_f32_16x16x32_bf16 v[56:59], v[136:139], v[112:115], v[56:59]
  ds_read_b128 v[92:95], v5 offset:22528
  v_pk_fma_f32 v[158:159], v[154:155], v[200:201], v[158:159] neg_lo:[0,1,0] neg_hi:[0,1,0]
  v_cvt_pk_bf16_f32 v178, v156, v157
  v_mfma_f32_16x16x32_bf16 v[60:63], v[140:143], v[112:115], v[60:63]
  v_cvt_pk_bf16_f32 v182, v158, v159
  v_lshlrev_b32 v152, 16, v179
  v_mfma_f32_16x16x32_bf16 v[64:67], v[136:139], v[116:119], v[64:67]
  ds_read_b128 v[96:99], v5 offset:24576
  v_and_b32 v153, 0xffff0000, v179
  v_lshlrev_b32_e64 v154, 16, v183
  v_mfma_f32_16x16x32_bf16 v[68:71], v[140:143], v[116:119], v[68:71]
  v_and_b32 v155, 0xffff0000, v183
  v_pk_mul_f32 v[156:157], v[152:153], v[204:205]
  s_waitcnt lgkmcnt(5)
  v_mfma_f32_16x16x32_bf16 v[72:75], v[136:139], v[120:123], v[72:75]
  ds_read_b128 v[100:103], v5 offset:26624
  v_pk_mul_f32 v[158:159], v[152:153], v[206:207] neg_lo:[0,1] neg_hi:[0,1]
  v_pk_fma_f32 v[156:157], v[154:155], v[206:207], v[156:157] neg_lo:[0,1,0] neg_hi:[0,1,0]
  v_mfma_f32_16x16x32_bf16 v[76:79], v[140:143], v[120:123], v[76:79]
  s_add_u32 m0, s77, 16384
  s_add_u32 s15, s76, 5632
  buffer_load_dwordx4 v146, s[68:71], s15 offen lds
  buffer_load_dwordx4 v147, s[68:71], s15 offen offset:1024 lds
  v_mfma_f32_16x16x32_bf16 v[80:83], v[136:139], v[124:127], v[80:83]
  ds_read_b128 v[104:107], v5 offset:28672
  s_add_u32 m0, s75, 81920
  s_add_u32 s14, s74, 1024
  buffer_load_dwordx4 v148, s[56:59], s14 offen lds
  buffer_load_dwordx4 v149, s[56:59], s14 offen offset:2048 lds
  v_mfma_f32_16x16x32_bf16 v[84:87], v[140:143], v[124:127], v[84:87]
  s_add_u32 m0, s75, 86016
  s_add_u32 s14, s74, 21504
  buffer_load_dwordx4 v148, s[56:59], s14 offen lds
  buffer_load_dwordx4 v149, s[56:59], s14 offen offset:2048 lds
  s_waitcnt lgkmcnt(2)
  v_mfma_f32_16x16x32_bf16 v[48:51], v[128:131], v[88:91], v[48:51]
  ds_read_b128 v[136:139], v145 offset:32768
  ds_read_b128 v[140:143], v145 offset:40960
  ds_read_b128 v[108:111], v6 offset:20480
  v_pk_fma_f32 v[158:159], v[154:155], v[204:205], v[158:159] neg_lo:[0,1,0] neg_hi:[0,1,0]
  v_mfma_f32_16x16x32_bf16 v[52:55], v[132:135], v[88:91], v[52:55]
  v_cvt_pk_bf16_f32 v179, v156, v157
  v_mfma_f32_16x16x32_bf16 v[56:59], v[128:131], v[92:95], v[56:59]
  ds_read_b128 v[112:115], v6 offset:22528
  v_cvt_pk_bf16_f32 v183, v158, v159
  v_mfma_f32_16x16x32_bf16 v[60:63], v[132:135], v[92:95], v[60:63]
  s_mul_i32 s12, s0, 204800
  s_add_u32 s12, s12, 23068672
  s_add_u32 s13, s12, 5120
  buffer_store_dwordx4 v[176:179], v174, s[52:55], s12 offen sc1
  buffer_store_dwordx4 v[180:183], v174, s[52:55], s13 offen sc1
  v_mfma_f32_16x16x32_bf16 v[64:67], v[128:131], v[96:99], v[64:67]
  ds_read_b128 v[116:119], v6 offset:24576
  s_add_u32 m0, s77, 24576
  s_add_u32 s15, s76, 640
  buffer_load_dwordx4 v146, s[68:71], s15 offen lds
  buffer_load_dwordx4 v147, s[68:71], s15 offen offset:1024 lds
  v_mfma_f32_16x16x32_bf16 v[68:71], v[132:135], v[96:99], v[68:71]
  s_add_u32 m0, s75, 90112
  s_add_u32 s14, s74, 41984
  buffer_load_dwordx4 v148, s[56:59], s14 offen lds
  s_waitcnt lgkmcnt(5)
  v_mfma_f32_16x16x32_bf16 v[72:75], v[128:131], v[100:103], v[72:75]
  ds_read_b128 v[120:123], v6 offset:26624
  v_mfma_f32_16x16x32_bf16 v[76:79], v[132:135], v[100:103], v[76:79]
  v_mfma_f32_16x16x32_bf16 v[80:83], v[128:131], v[104:107], v[80:83]
  ds_read_b128 v[124:127], v6 offset:28672
  v_mfma_f32_16x16x32_bf16 v[84:87], v[132:135], v[104:107], v[84:87]
  s_waitcnt vmcnt(19)
  s_waitcnt lgkmcnt(2)
  v_mfma_f32_16x16x32_bf16 v[48:51], v[136:139], v[108:111], v[48:51]
  ds_read_b128 v[128:131], v144 offset:49152
  ds_read_b128 v[132:135], v144 offset:0
  ds_read_b128 v[88:91], v5 offset:30720
  s_add_u32 m0, s77, 32768
  s_add_u32 s15, s76, 5760
  buffer_load_dwordx4 v146, s[68:71], s15 offen lds
  buffer_load_dwordx4 v147, s[68:71], s15 offen offset:1024 lds
  v_mfma_f32_16x16x32_bf16 v[52:55], v[140:143], v[108:111], v[52:55]
  v_mov_b32 v15, s8
  s_mov_b64 exec, 1
  s_cmp_eq_u32 s40, 0
  s_cbranch_scc1 slow_17
  buffer_store_dword v15, off, s[52:55], s41
back_18:
  s_mov_b64 exec, -1
  v_mfma_f32_16x16x32_bf16 v[56:59], v[136:139], v[112:115], v[56:59]
  ds_read_b128 v[92:95], v5 offset:32768
  v_mfma_f32_16x16x32_bf16 v[60:63], v[140:143], v[112:115], v[60:63]
  v_mfma_f32_16x16x32_bf16 v[64:67], v[136:139], v[116:119], v[64:67]
  ds_read_b128 v[96:99], v5 offset:34816
  v_mfma_f32_16x16x32_bf16 v[68:71], v[140:143], v[116:119], v[68:71]
  s_waitcnt lgkmcnt(5)
  v_mfma_f32_16x16x32_bf16 v[72:75], v[136:139], v[120:123], v[72:75]
  ds_read_b128 v[100:103], v5 offset:36864
  v_mfma_f32_16x16x32_bf16 v[76:79], v[140:143], v[120:123], v[76:79]
  v_mfma_f32_16x16x32_bf16 v[80:83], v[136:139], v[124:127], v[80:83]
  ds_read_b128 v[104:107], v5 offset:38912
  v_mfma_f32_16x16x32_bf16 v[84:87], v[140:143], v[124:127], v[84:87]
  s_waitcnt lgkmcnt(2)
  v_mfma_f32_16x16x32_bf16 v[48:51], v[128:131], v[88:91], v[48:51]
  ds_read_b128 v[136:139], v145 offset:49152
  ds_read_b128 v[140:143], v145 offset:0
  ds_read_b128 v[108:111], v6 offset:30720
  s_add_u32 m0, s77, 40960
  s_add_u32 s15, s76, 768
  buffer_load_dwordx4 v146, s[68:71], s15 offen lds
  buffer_load_dwordx4 v147, s[68:71], s15 offen offset:1024 lds
  v_mfma_f32_16x16x32_bf16 v[52:55], v[132:135], v[88:91], v[52:55]
  v_mfma_f32_16x16x32_bf16 v[56:59], v[128:131], v[92:95], v[56:59]
  ds_read_b128 v[112:115], v6 offset:32768
  v_mfma_f32_16x16x32_bf16 v[60:63], v[132:135], v[92:95], v[60:63]
  v_mfma_f32_16x16x32_bf16 v[64:67], v[128:131], v[96:99], v[64:67]
  ds_read_b128 v[116:119], v6 offset:34816
  v_mfma_f32_16x16x32_bf16 v[68:71], v[132:135], v[96:99], v[68:71]
  s_waitcnt lgkmcnt(5)
  v_mfma_f32_16x16x32_bf16 v[72:75], v[128:131], v[100:103], v[72:75]
  ds_read_b128 v[120:123], v6 offset:36864
  v_mfma_f32_16x16x32_bf16 v[76:79], v[132:135], v[100:103], v[76:79]
  v_mfma_f32_16x16x32_bf16 v[80:83], v[128:131], v[104:107], v[80:83]
  ds_read_b128 v[124:127], v6 offset:38912
  v_mfma_f32_16x16x32_bf16 v[84:87], v[132:135], v[104:107], v[84:87]
  s_waitcnt vmcnt(14)
  s_barrier
  s_waitcnt lgkmcnt(2)
  v_mfma_f32_16x16x32_bf16 v[48:51], v[136:139], v[108:111], v[48:51]
  ds_read_b128 v[128:131], v144 offset:8192
  ds_read_b128 v[132:135], v144 offset:16384
  ds_read_b128 v[88:91], v5 offset:40960
  s_add_u32 m0, s77, 49152
  s_add_u32 s15, s76, 5888
  buffer_load_dwordx4 v146, s[68:71], s15 offen lds
  buffer_load_dwordx4 v147, s[68:71], s15 offen offset:1024 lds
  v_mfma_f32_16x16x32_bf16 v[52:55], v[140:143], v[108:111], v[52:55]
  v_mfma_f32_16x16x32_bf16 v[56:59], v[136:139], v[112:115], v[56:59]
  ds_read_b128 v[92:95], v5 offset:43008
  v_mfma_f32_16x16x32_bf16 v[60:63], v[140:143], v[112:115], v[60:63]
  v_mfma_f32_16x16x32_bf16 v[64:67], v[136:139], v[116:119], v[64:67]
  ds_read_b128 v[96:99], v5 offset:45056
  v_mfma_f32_16x16x32_bf16 v[68:71], v[140:143], v[116:119], v[68:71]
  s_waitcnt lgkmcnt(5)
  v_mfma_f32_16x16x32_bf16 v[72:75], v[136:139], v[120:123], v[72:75]
  ds_read_b128 v[100:103], v5 offset:47104
  v_mfma_f32_16x16x32_bf16 v[76:79], v[140:143], v[120:123], v[76:79]
  v_mfma_f32_16x16x32_bf16 v[80:83], v[136:139], v[124:127], v[80:83]
  ds_read_b128 v[104:107], v5 offset:49152
  v_mfma_f32_16x16x32_bf16 v[84:87], v[140:143], v[124:127], v[84:87]
  s_waitcnt lgkmcnt(2)
  v_mfma_f32_16x16x32_bf16 v[48:51], v[128:131], v[88:91], v[48:51]
  ds_read_b128 v[136:139], v145 offset:8192
  ds_read_b128 v[140:143], v145 offset:16384
  ds_read_b128 v[108:111], v6 offset:40960
  s_add_u32 m0, s77, 0
  s_add_u32 s15, s76, 896
  buffer_load_dwordx4 v146, s[68:71], s15 offen lds
  buffer_load_dwordx4 v147, s[68:71], s15 offen offset:1024 lds
  v_mfma_f32_16x16x32_bf16 v[52:55], v[132:135], v[88:91], v[52:55]
  v_lshrrev_b32 v11, 5, v1
  v_mfma_f32_16x16x32_bf16 v[56:59], v[128:131], v[92:95], v[56:59]
  ds_read_b128 v[112:115], v6 offset:43008
  v_mul_u32_u24 v11, 4096, v11
  v_mfma_f32_16x16x32_bf16 v[60:63], v[132:135], v[92:95], v[60:63]
  v_add_u32_e64 v11, v11, v2
  v_mfma_f32_16x16x32_bf16 v[64:67], v[128:131], v[96:99], v[64:67]
  ds_read_b128 v[116:119], v6 offset:45056
  v_mov_b32_e64 v216, 0
  v_mfma_f32_16x16x32_bf16 v[68:71], v[132:135], v[96:99], v[68:71]
  v_mov_b32 v217, 0
  s_waitcnt lgkmcnt(5)
  v_mfma_f32_16x16x32_bf16 v[72:75], v[128:131], v[100:103], v[72:75]
  ds_read_b128 v[120:123], v6 offset:47104
  v_mov_b32_e64 v218, 0
  v_mfma_f32_16x16x32_bf16 v[76:79], v[132:135], v[100:103], v[76:79]
  v_mov_b32_e64 v219, 0
  v_mfma_f32_16x16x32_bf16 v[80:83], v[128:131], v[104:107], v[80:83]
  ds_read_b128 v[124:127], v6 offset:49152
  ds_write_b128 v11, v[216:219] offset:4096
  v_mfma_f32_16x16x32_bf16 v[84:87], v[132:135], v[104:107], v[84:87]
  ds_write_b128 v11, v[216:219] offset:8704
  s_waitcnt vmcnt(7)
  s_waitcnt lgkmcnt(4)
  v_mfma_f32_16x16x32_bf16 v[48:51], v[136:139], v[108:111], v[48:51]
  ds_read_b128 v[128:131], v144 offset:24576
  ds_read_b128 v[132:135], v144 offset:32768
  ds_read_b128 v[88:91], v7 offset:0
  s_add_u32 m0, s77, 8192
  s_add_u32 s15, s76, 6016
  buffer_load_dwordx4 v146, s[68:71], s15 offen lds
  buffer_load_dwordx4 v147, s[68:71], s15 offen offset:1024 lds
  v_mfma_f32_16x16x32_bf16 v[52:55], v[140:143], v[108:111], v[52:55]
  s_add_u32 s12, s85, 66048
  v_mov_b32 v15, s8
  s_mov_b64 exec, 1
  buffer_store_dword v15, off, s[52:55], s12 sc1
  s_mov_b64 exec, -1
  v_mfma_f32_16x16x32_bf16 v[56:59], v[136:139], v[112:115], v[56:59]
  ds_read_b128 v[92:95], v7 offset:2048
  v_mfma_f32_16x16x32_bf16 v[60:63], v[140:143], v[112:115], v[60:63]
  v_mfma_f32_16x16x32_bf16 v[64:67], v[136:139], v[116:119], v[64:67]
  ds_read_b128 v[96:99], v7 offset:4096
  v_mfma_f32_16x16x32_bf16 v[68:71], v[140:143], v[116:119], v[68:71]
  s_waitcnt lgkmcnt(7)
  v_mfma_f32_16x16x32_bf16 v[72:75], v[136:139], v[120:123], v[72:75]
  ds_read_b128 v[100:103], v7 offset:6144
  v_mfma_f32_16x16x32_bf16 v[76:79], v[140:143], v[120:123], v[76:79]
  v_mfma_f32_16x16x32_bf16 v[80:83], v[136:139], v[124:127], v[80:83]
  ds_read_b128 v[104:107], v7 offset:8192
  v_mfma_f32_16x16x32_bf16 v[84:87], v[140:143], v[124:127], v[84:87]
  s_waitcnt lgkmcnt(2)
  v_mfma_f32_16x16x32_bf16 v[48:51], v[128:131], v[88:91], v[48:51]
  ds_read_b128 v[136:139], v145 offset:24576
  ds_read_b128 v[140:143], v145 offset:32768
  ds_read_b128 v[108:111], v8 offset:0
  s_add_u32 m0, s77, 16384
  s_add_u32 s15, s76, 1024
  buffer_load_dwordx4 v146, s[68:71], s15 offen lds
  buffer_load_dwordx4 v147, s[68:71], s15 offen offset:1024 lds
  v_mfma_f32_16x16x32_bf16 v[52:55], v[132:135], v[88:91], v[52:55]
  s_and_b32 s87, s85, 0x3800
  s_add_u32 s87, s87, 65536
  buffer_load_dwordx2 v[188:189], v187, s[52:55], s87 offen sc1
  v_mfma_f32_16x16x32_bf16 v[56:59], v[128:131], v[92:95], v[56:59]
  ds_read_b128 v[112:115], v8 offset:2048
  v_mfma_f32_16x16x32_bf16 v[60:63], v[132:135], v[92:95], v[60:63]
  v_mfma_f32_16x16x32_bf16 v[64:67], v[128:131], v[96:99], v[64:67]
  ds_read_b128 v[116:119], v8 offset:4096
  v_mfma_f32_16x16x32_bf16 v[68:71], v[132:135], v[96:99], v[68:71]
  s_waitcnt lgkmcnt(5)
  v_mfma_f32_16x16x32_bf16 v[72:75], v[128:131], v[100:103], v[72:75]
  ds_read_b128 v[120:123], v8 offset:6144
  v_mfma_f32_16x16x32_bf16 v[76:79], v[132:135], v[100:103], v[76:79]
  v_mfma_f32_16x16x32_bf16 v[80:83], v[128:131], v[104:107], v[80:83]
  ds_read_b128 v[124:127], v8 offset:8192
  v_mfma_f32_16x16x32_bf16 v[84:87], v[132:135], v[104:107], v[84:87]
  s_waitcnt vmcnt(8)
  s_barrier
  s_waitcnt lgkmcnt(2)
  v_mfma_f32_16x16x32_bf16 v[48:51], v[136:139], v[108:111], v[48:51]
  ds_read_b128 v[128:131], v144 offset:40960
  ds_read_b128 v[132:135], v144 offset:49152
  ds_read_b128 v[88:91], v7 offset:10240
  s_add_u32 m0, s77, 24576
  s_add_u32 s15, s76, 6144
  buffer_load_dwordx4 v146, s[68:71], s15 offen lds
  buffer_load_dwordx4 v147, s[68:71], s15 offen offset:1024 lds
  v_mfma_f32_16x16x32_bf16 v[52:55], v[140:143], v[108:111], v[52:55]
  v_mfma_f32_16x16x32_bf16 v[56:59], v[136:139], v[112:115], v[56:59]
  ds_read_b128 v[92:95], v7 offset:12288
  v_mfma_f32_16x16x32_bf16 v[60:63], v[140:143], v[112:115], v[60:63]
  v_mfma_f32_16x16x32_bf16 v[64:67], v[136:139], v[116:119], v[64:67]
  ds_read_b128 v[96:99], v7 offset:14336
  v_mfma_f32_16x16x32_bf16 v[68:71], v[140:143], v[116:119], v[68:71]
  s_waitcnt lgkmcnt(5)
  v_mfma_f32_16x16x32_bf16 v[72:75], v[136:139], v[120:123], v[72:75]
  ds_read_b128 v[100:103], v7 offset:16384
  v_mfma_f32_16x16x32_bf16 v[76:79], v[140:143], v[120:123], v[76:79]
  v_mfma_f32_16x16x32_bf16 v[80:83], v[136:139], v[124:127], v[80:83]
  ds_read_b128 v[104:107], v7 offset:18432
  v_mfma_f32_16x16x32_bf16 v[84:87], v[140:143], v[124:127], v[84:87]
  s_waitcnt lgkmcnt(2)
  v_mfma_f32_16x16x32_bf16 v[48:51], v[128:131], v[88:91], v[48:51]
  ds_read_b128 v[136:139], v145 offset:40960
  ds_read_b128 v[140:143], v145 offset:49152
  ds_read_b128 v[108:111], v8 offset:10240
  s_add_u32 m0, s77, 32768
  s_add_u32 s15, s76, 1152
  buffer_load_dwordx4 v146, s[68:71], s15 offen lds
  buffer_load_dwordx4 v147, s[68:71], s15 offen offset:1024 lds
  v_mfma_f32_16x16x32_bf16 v[52:55], v[132:135], v[88:91], v[52:55]
  s_waitcnt vmcnt(4)
  v_xor_b32 v15, s8, v188
  v_xor_b32 v14, s8, v189
  v_or_b32 v15, v15, v14
  v_cmp_ne_u32 vcc, 0, v15
  s_cbranch_vccnz again_19
ok_20:
  s_lshl_b32 s12, s0, 16
  s_add_u32 s12, s12, s90
  s_add_u32 s12, s12, 4194304
  s_lshl_b32 m0, s7, 10
  s_nop 0
  buffer_load_dwordx4 v2, s[52:55], s12 offen sc1 lds
  s_lshl_b32 s12, s0, 16
  s_add_u32 s12, s12, s91
  s_add_u32 s12, s12, 4194304
  s_lshl_b32 m0, s7, 10
  s_add_u32 m0, m0, 4608
  s_nop 0
  buffer_load_dwordx4 v2, s[52:55], s12 offen sc1 lds
  v_mfma_f32_16x16x32_bf16 v[56:59], v[128:131], v[92:95], v[56:59]
  ds_read_b128 v[112:115], v8 offset:12288
  v_mfma_f32_16x16x32_bf16 v[60:63], v[132:135], v[92:95], v[60:63]
  v_mfma_f32_16x16x32_bf16 v[64:67], v[128:131], v[96:99], v[64:67]
  ds_read_b128 v[116:119], v8 offset:14336
  v_mfma_f32_16x16x32_bf16 v[68:71], v[132:135], v[96:99], v[68:71]
  s_waitcnt lgkmcnt(5)
  v_mfma_f32_16x16x32_bf16 v[72:75], v[128:131], v[100:103], v[72:75]
  ds_read_b128 v[120:123], v8 offset:16384
  v_mfma_f32_16x16x32_bf16 v[76:79], v[132:135], v[100:103], v[76:79]
  v_mfma_f32_16x16x32_bf16 v[80:83], v[128:131], v[104:107], v[80:83]
  ds_read_b128 v[124:127], v8 offset:18432
  v_mfma_f32_16x16x32_bf16 v[84:87], v[132:135], v[104:107], v[84:87]
  s_waitcnt lgkmcnt(2)
  v_mfma_f32_16x16x32_bf16 v[48:51], v[136:139], v[108:111], v[48:51]
  ds_read_b128 v[128:131], v144 offset:0
  ds_read_b128 v[132:135], v144 offset:8192
  ds_read_b128 v[88:91], v7 offset:20480
  s_add_u32 m0, s77, 40960
  s_add_u32 s15, s76, 6272
  buffer_load_dwordx4 v146, s[68:71], s15 offen lds
  buffer_load_dwordx4 v147, s[68:71], s15 offen offset:1024 lds
  v_mfma_f32_16x16x32_bf16 v[52:55], v[140:143], v[108:111], v[52:55]
  buffer_load_dwordx3 v[152:154], v160, s[52:55], s93 offen sc1
  v_mfma_f32_16x16x32_bf16 v[56:59], v[136:139], v[112:115], v[56:59]
  ds_read_b128 v[92:95], v7 offset:22528
  buffer_load_dwordx2 v[156:157], v161, s[52:55], s94 offen sc1
  v_mfma_f32_16x16x32_bf16 v[60:63], v[140:143], v[112:115], v[60:63]
  buffer_load_dwordx2 v[158:159], v162, s[52:55], s94 offen offset:512 sc1
  v_mfma_f32_16x16x32_bf16 v[64:67], v[136:139], v[116:119], v[64:67]
  ds_read_b128 v[96:99], v7 offset:24576
  s_mov_b32 s36, 32768
  buffer_load_dwordx4 v[220:223], v2, s[52:55], s36 offen sc1
  v_mfma_f32_16x16x32_bf16 v[68:71], v[140:143], v[116:119], v[68:71]
  s_waitcnt lgkmcnt(5)
  v_mfma_f32_16x16x32_bf16 v[72:75], v[136:139], v[120:123], v[72:75]
  ds_read_b128 v[100:103], v7 offset:26624
  v_mfma_f32_16x16x32_bf16 v[76:79], v[140:143], v[120:123], v[76:79]
  v_mfma_f32_16x16x32_bf16 v[80:83], v[136:139], v[124:127], v[80:83]
  ds_read_b128 v[104:107], v7 offset:28672
  v_mfma_f32_16x16x32_bf16 v[84:87], v[140:143], v[124:127], v[84:87]
  s_waitcnt lgkmcnt(2)
  v_mfma_f32_16x16x32_bf16 v[48:51], v[128:131], v[88:91], v[48:51]
  ds_read_b128 v[136:139], v145 offset:0
  ds_read_b128 v[140:143], v145 offset:8192
  ds_read_b128 v[108:111], v8 offset:20480
  s_mov_b32 s64, s42
  s_and_b32 s65, s43, 0xffff
  s_mov_b32 s66, 2621440
  s_mov_b32 s67, 0x20000
  v_mfma_f32_16x16x32_bf16 v[52:55], v[132:135], v[88:91], v[52:55]
  buffer_load_dwordx4 v[192:195], v2, s[64:67], s90 offen
  v_mfma_f32_16x16x32_bf16 v[56:59], v[128:131], v[92:95], v[56:59]
  ds_read_b128 v[112:115], v8 offset:22528
  buffer_load_dwordx4 v[204:207], v2, s[64:67], s90 offen offset:4
  v_mfma_f32_16x16x32_bf16 v[60:63], v[132:135], v[92:95], v[60:63]
  buffer_load_dwordx4 v[188:191], v187, s[52:55], s88 offen sc1
  v_mfma_f32_16x16x32_bf16 v[64:67], v[128:131], v[96:99], v[64:67]
  ds_read_b128 v[116:119], v8 offset:24576
  v_mfma_f32_16x16x32_bf16 v[68:71], v[132:135], v[96:99], v[68:71]
  s_waitcnt lgkmcnt(5)
  v_mfma_f32_16x16x32_bf16 v[72:75], v[128:131], v[100:103], v[72:75]
  ds_read_b128 v[120:123], v8 offset:26624
  v_mfma_f32_16x16x32_bf16 v[76:79], v[132:135], v[100:103], v[76:79]
  v_mfma_f32_16x16x32_bf16 v[80:83], v[128:131], v[104:107], v[80:83]
  ds_read_b128 v[124:127], v8 offset:28672
  v_mfma_f32_16x16x32_bf16 v[84:87], v[132:135], v[104:107], v[84:87]
  s_waitcnt vmcnt(13)
  s_barrier
  s_waitcnt lgkmcnt(2)
  v_mfma_f32_16x16x32_bf16 v[48:51], v[136:139], v[108:111], v[48:51]
  ds_read_b128 v[128:131], v144 offset:16384
  ds_read_b128 v[132:135], v144 offset:24576
  ds_read_b128 v[88:91], v7 offset:30720
  buffer_load_dwordx4 v[196:199], v2, s[64:67], s91 offen
  v_mfma_f32_16x16x32_bf16 v[52:55], v[140:143], v[108:111], v[52:55]
  buffer_load_dwordx4 v[208:211], v2, s[64:67], s91 offen offset:4
  v_mfma_f32_16x16x32_bf16 v[56:59], v[136:139], v[112:115], v[56:59]
  ds_read_b128 v[92:95], v7 offset:32768
  buffer_load_dwordx4 v[200:203], v2, s[64:67], s92 offen
  v_mfma_f32_16x16x32_bf16 v[60:63], v[140:143], v[112:115], v[60:63]
  v_mfma_f32_16x16x32_bf16 v[64:67], v[136:139], v[116:119], v[64:67]
  ds_read_b128 v[96:99], v7 offset:34816
  v_mfma_f32_16x16x32_bf16 v[68:71], v[140:143], v[116:119], v[68:71]
  s_waitcnt lgkmcnt(5)
  v_mfma_f32_16x16x32_bf16 v[72:75], v[136:139], v[120:123], v[72:75]
  ds_read_b128 v[100:103], v7 offset:36864
  v_mfma_f32_16x16x32_bf16 v[76:79], v[140:143], v[120:123], v[76:79]
  v_mfma_f32_16x16x32_bf16 v[80:83], v[136:139], v[124:127], v[80:83]
  ds_read_b128 v[104:107], v7 offset:38912
  v_mfma_f32_16x16x32_bf16 v[84:87], v[140:143], v[124:127], v[84:87]
  s_waitcnt lgkmcnt(2)
  v_mfma_f32_16x16x32_bf16 v[48:51], v[128:131], v[88:91], v[48:51]
  ds_read_b128 v[136:139], v145 offset:16384
  ds_read_b128 v[140:143], v145 offset:24576
  ds_read_b128 v[108:111], v8 offset:30720
  buffer_load_dwordx4 v[212:215], v2, s[64:67], s92 offen offset:4
  v_mfma_f32_16x16x32_bf16 v[52:55], v[132:135], v[88:91], v[52:55]
  v_mfma_f32_16x16x32_bf16 v[56:59], v[128:131], v[92:95], v[56:59]
  ds_read_b128 v[112:115], v8 offset:32768
  v_mfma_f32_16x16x32_bf16 v[60:63], v[132:135], v[92:95], v[60:63]
  v_mfma_f32_16x16x32_bf16 v[64:67], v[128:131], v[96:99], v[64:67]
  ds_read_b128 v[116:119], v8 offset:34816
  v_mfma_f32_16x16x32_bf16 v[68:71], v[132:135], v[96:99], v[68:71]
  s_waitcnt lgkmcnt(5)
  v_mfma_f32_16x16x32_bf16 v[72:75], v[128:131], v[100:103], v[72:75]
  ds_read_b128 v[120:123], v8 offset:36864
  v_mfma_f32_16x16x32_bf16 v[76:79], v[132:135], v[100:103], v[76:79]
  v_mfma_f32_16x16x32_bf16 v[80:83], v[128:131], v[104:107], v[80:83]
  ds_read_b128 v[124:127], v8 offset:38912
  v_mfma_f32_16x16x32_bf16 v[84:87], v[132:135], v[104:107], v[84:87]
  s_waitcnt vmcnt(11)
  s_waitcnt lgkmcnt(2)
  v_mfma_f32_16x16x32_bf16 v[48:51], v[136:139], v[108:111], v[48:51]
  ds_read_b128 v[128:131], v144 offset:32768
  ds_read_b128 v[132:135], v144 offset:40960
  ds_read_b128 v[88:91], v7 offset:40960
  s_waitcnt vmcnt(7)
  v_min3_u32 v15, v220, v221, s8
  v_max3_u32 v14, v220, v221, s8
  v_min3_u32 v15, v15, v222, v223
  v_max3_u32 v14, v14, v222, v223
  v_cmp_ne_u32 vcc, v15, v14
  s_cbranch_vccnz again_21
ok_22:
  s_lshl_b32 s13, s7, 6
  s_sub_u32 s12, 255, s13
  v_sub_u32 v11, s12, v1
  v_lshlrev_b32 v11, 11, v11
  s_and_b32 s12, s24, 3
  s_lshl_b32 s12, s12, 9
  s_bfe_u32 s14, s24, 0x50002
  s_lshl_b32 s14, s14, 4
  s_add_u32 s12, s12, s14
  s_add_u32 s12, s12, 26214400
  s_lshl_b32 s13, s13, 4
  s_add_u32 m0, s13, 9216
  s_nop 0
  buffer_load_dwordx4 v11, s[52:55], s12 offen sc1 lds
  v_mfma_f32_16x16x32_bf16 v[52:55], v[140:143], v[108:111], v[52:55]
  s_waitcnt vmcnt(5)
  v_min3_u32 v15, v188, v189, s8
  v_max3_u32 v14, v188, v189, s8
  v_min3_u32 v15, v15, v190, v191
  v_max3_u32 v14, v14, v190, v191
  v_cmp_ne_u32 vcc, v15, v14
  s_cbranch_vccnz again_23
ok_24:
  s_mul_i32 s34, s6, 200
  s_mul_i32 s12, s7, 50
  s_add_u32 s34, s34, s12
  s_lshl_b32 s34, s34, 10
  s_add_u32 s34, s34, 23068672
  v_mfma_f32_16x16x32_bf16 v[56:59], v[136:139], v[112:115], v[56:59]
  ds_read_b128 v[92:95], v7 offset:43008
  buffer_load_dwordx4 a[0:3], v2, s[52:55], s34 offen offset:0 sc1
  v_mfma_f32_16x16x32_bf16 v[60:63], v[140:143], v[112:115], v[60:63]
  buffer_load_dwordx4 a[4:7], v2, s[52:55], s34 offen offset:1024 sc1
  v_mfma_f32_16x16x32_bf16 v[64:67], v[136:139], v[116:119], v[64:67]
  ds_read_b128 v[96:99], v7 offset:45056
  buffer_load_dwordx4 a[8:11], v2, s[52:55], s34 offen offset:2048 sc1
  v_mfma_f32_16x16x32_bf16 v[68:71], v[140:143], v[116:119], v[68:71]
  s_waitcnt lgkmcnt(5)
  v_mfma_f32_16x16x32_bf16 v[72:75], v[136:139], v[120:123], v[72:75]
  ds_read_b128 v[100:103], v7 offset:47104
  v_mfma_f32_16x16x32_bf16 v[76:79], v[140:143], v[120:123], v[76:79]
  v_mfma_f32_16x16x32_bf16 v[80:83], v[136:139], v[124:127], v[80:83]
  ds_read_b128 v[104:107], v7 offset:49152
  v_mfma_f32_16x16x32_bf16 v[84:87], v[140:143], v[124:127], v[84:87]
  s_waitcnt lgkmcnt(2)
  v_mfma_f32_16x16x32_bf16 v[48:51], v[128:131], v[88:91], v[48:51]
  ds_read_b128 v[136:139], v145 offset:32768
  ds_read_b128 v[140:143], v145 offset:40960
  ds_read_b128 v[108:111], v8 offset:40960
  v_min3_u32 v15, v154, v154, s8
  v_max3_u32 v14, v154, v154, s8
  v_min3_u32 v15, v15, v157, v159
  v_max3_u32 v14, v14, v157, v159
  v_cmp_ne_u32 vcc, v15, v14
  s_cbranch_vccnz again_25
ok_26:
  v_mfma_f32_16x16x32_bf16 v[52:55], v[132:135], v[88:91], v[52:55]
  buffer_load_dwordx4 a[12:15], v2, s[52:55], s34 offen offset:3072 sc1
  v_mfma_f32_16x16x32_bf16 v[56:59], v[128:131], v[92:95], v[56:59]
  ds_read_b128 v[112:115], v8 offset:43008
  s_add_u32 s34, s34, 4096
  buffer_load_dwordx4 a[16:19], v2, s[52:55], s34 offen offset:0 sc1
  v_mfma_f32_16x16x32_bf16 v[60:63], v[132:135], v[92:95], v[60:63]
  buffer_load_dwordx4 a[20:23], v2, s[52:55], s34 offen offset:1024 sc1
  v_mfma_f32_16x16x32_bf16 v[64:67], v[128:131], v[96:99], v[64:67]
  ds_read_b128 v[116:119], v8 offset:45056
  v_mfma_f32_16x16x32_bf16 v[68:71], v[132:135], v[96:99], v[68:71]
  s_waitcnt lgkmcnt(5)
  v_mfma_f32_16x16x32_bf16 v[72:75], v[128:131], v[100:103], v[72:75]
  ds_read_b128 v[120:123], v8 offset:47104
  v_mfma_f32_16x16x32_bf16 v[76:79], v[132:135], v[100:103], v[76:79]
  v_mfma_f32_16x16x32_bf16 v[80:83], v[128:131], v[104:107], v[80:83]
  ds_read_b128 v[124:127], v8 offset:49152
  v_mfma_f32_16x16x32_bf16 v[84:87], v[132:135], v[104:107], v[84:87]
  s_waitcnt lgkmcnt(2)
  s_barrier
  v_mfma_f32_16x16x32_bf16 v[48:51], v[136:139], v[108:111], v[48:51]
  buffer_load_dwordx4 a[24:27], v2, s[52:55], s34 offen offset:2048 sc1
  buffer_load_dwordx4 a[28:31], v2, s[52:55], s34 offen offset:3072 sc1
  v_mov_b32_e64 v246, v156
  v_mfma_f32_16x16x32_bf16 v[52:55], v[140:143], v[108:111], v[52:55]
  v_mov_b32 v247, v156
  v_mov_b32 v250, v158
  s_nop 0
  v_permlane16_swap_b32 v246, v247
  v_mfma_f32_16x16x32_bf16 v[56:59], v[136:139], v[112:115], v[56:59]
  v_mov_b32 v248, v246
  v_mov_b32 v249, v247
  s_nop 0
  v_permlane32_swap_b32 v246, v248
  v_mfma_f32_16x16x32_bf16 v[60:63], v[140:143], v[112:115], v[60:63]
  v_permlane32_swap_b32 v247, v249
  v_mov_b32_dpp v88, v152 row_newbcast:0 row_mask:0xf bank_mask:0xf
  v_mov_b32_dpp v96, v153 row_newbcast:0 row_mask:0xf bank_mask:0xf
  v_mfma_f32_16x16x32_bf16 v[64:67], v[136:139], v[116:119], v[64:67]
  v_mov_b32_dpp v89, v152 row_newbcast:1 row_mask:0xf bank_mask:0xf
  v_mov_b32_dpp v97, v153 row_newbcast:1 row_mask:0xf bank_mask:0xf
  v_mov_b32_dpp v90, v152 row_newbcast:2 row_mask:0xf bank_mask:0xf
  v_mfma_f32_16x16x32_bf16 v[68:71], v[140:143], v[116:119], v[68:71]
  v_mov_b32_dpp v98, v153 row_newbcast:2 row_mask:0xf bank_mask:0xf
  v_mov_b32_dpp v91, v152 row_newbcast:3 row_mask:0xf bank_mask:0xf
  v_mov_b32_dpp v99, v153 row_newbcast:3 row_mask:0xf bank_mask:0xf
  s_waitcnt lgkmcnt(0)
  v_mfma_f32_16x16x32_bf16 v[72:75], v[136:139], v[120:123], v[72:75]
  v_mov_b32_dpp v92, v152 row_newbcast:4 row_mask:0xf bank_mask:0xf
  v_mov_b32_dpp v100, v153 row_newbcast:4 row_mask:0xf bank_mask:0xf
  v_mfma_f32_16x16x32_bf16 v[76:79], v[140:143], v[120:123], v[76:79]
  v_mov_b32_dpp v93, v152 row_newbcast:5 row_mask:0xf bank_mask:0xf
  v_mov_b32_dpp v101, v153 row_newbcast:5 row_mask:0xf bank_mask:0xf
  v_mfma_f32_16x16x32_bf16 v[80:83], v[136:139], v[124:127], v[80:83]
  v_mov_b32_dpp v94, v152 row_newbcast:6 row_mask:0xf bank_mask:0xf
  v_mov_b32_dpp v102, v153 row_newbcast:6 row_mask:0xf bank_mask:0xf
  v_mfma_f32_16x16x32_bf16 v[84:87], v[140:143], v[124:127], v[84:87]
  v_mov_b32_dpp v95, v152 row_newbcast:7 row_mask:0xf bank_mask:0xf
  v_mov_b32_dpp v103, v153 row_newbcast:7 row_mask:0xf bank_mask:0xf
  v_pk_fma_f32 v[48:49], v[88:89], v[246:247], v[48:49] op_sel_hi:[1,0,1] neg_lo:[1,0,0] neg_hi:[1,0,0]
  v_pk_fma_f32 v[50:51], v[90:91], v[246:247], v[50:51] op_sel_hi:[1,0,1] neg_lo:[1,0,0] neg_hi:[1,0,0]
  v_pk_fma_f32 v[52:53], v[92:93], v[246:247], v[52:53] op_sel_hi:[1,0,1] neg_lo:[1,0,0] neg_hi:[1,0,0]
  v_pk_fma_f32 v[54:55], v[94:95], v[246:247], v[54:55] op_sel_hi:[1,0,1] neg_lo:[1,0,0] neg_hi:[1,0,0]
  v_pk_fma_f32 v[56:57], v[88:89], v[246:247], v[56:57] op_sel:[0,1,0] op_sel_hi:[1,1,1] neg_lo:[1,0,0] neg_hi:[1,0,0]
  v_pk_fma_f32 v[58:59], v[90:91], v[246:247], v[58:59] op_sel:[0,1,0] op_sel_hi:[1,1,1] neg_lo:[1,0,0] neg_hi:[1,0,0]
  v_pk_fma_f32 v[60:61], v[92:93], v[246:247], v[60:61] op_sel:[0,1,0] op_sel_hi:[1,1,1] neg_lo:[1,0,0] neg_hi:[1,0,0]
  v_pk_fma_f32 v[62:63], v[94:95], v[246:247], v[62:63] op_sel:[0,1,0] op_sel_hi:[1,1,1] neg_lo:[1,0,0] neg_hi:[1,0,0]
  v_pk_fma_f32 v[64:65], v[88:89], v[248:249], v[64:65] op_sel_hi:[1,0,1] neg_lo:[1,0,0] neg_hi:[1,0,0]
  v_pk_fma_f32 v[66:67], v[90:91], v[248:249], v[66:67] op_sel_hi:[1,0,1] neg_lo:[1,0,0] neg_hi:[1,0,0]
  v_pk_fma_f32 v[68:69], v[92:93], v[248:249], v[68:69] op_sel_hi:[1,0,1] neg_lo:[1,0,0] neg_hi:[1,0,0]
  v_pk_fma_f32 v[70:71], v[94:95], v[248:249], v[70:71] op_sel_hi:[1,0,1] neg_lo:[1,0,0] neg_hi:[1,0,0]
  v_pk_fma_f32 v[72:73], v[88:89], v[248:249], v[72:73] op_sel:[0,1,0] op_sel_hi:[1,1,1] neg_lo:[1,0,0] neg_hi:[1,0,0]
  v_pk_fma_f32 v[74:75], v[90:91], v[248:249], v[74:75] op_sel:[0,1,0] op_sel_hi:[1,1,1] neg_lo:[1,0,0] neg_hi:[1,0,0]
  v_pk_fma_f32 v[76:77], v[92:93], v[248:249], v[76:77] op_sel:[0,1,0] op_sel_hi:[1,1,1] neg_lo:[1,0,0] neg_hi:[1,0,0]
  v_pk_fma_f32 v[78:79], v[94:95], v[248:249], v[78:79] op_sel:[0,1,0] op_sel_hi:[1,1,1] neg_lo:[1,0,0] neg_hi:[1,0,0]
  v_pk_fma_f32 v[80:81], v[88:89], v[250:251], v[80:81] op_sel_hi:[1,0,1] neg_lo:[1,0,0] neg_hi:[1,0,0]
  v_pk_fma_f32 v[82:83], v[90:91], v[250:251], v[82:83] op_sel_hi:[1,0,1] neg_lo:[1,0,0] neg_hi:[1,0,0]
  v_pk_fma_f32 v[84:85], v[92:93], v[250:251], v[84:85] op_sel_hi:[1,0,1] neg_lo:[1,0,0] neg_hi:[1,0,0]
  v_pk_fma_f32 v[86:87], v[94:95], v[250:251], v[86:87] op_sel_hi:[1,0,1] neg_lo:[1,0,0] neg_hi:[1,0,0]
  v_pk_mul_f32 v[48:49], v[48:49], v[96:97]
  v_pk_mul_f32 v[50:51], v[50:51], v[98:99]
  v_pk_mul_f32 v[52:53], v[52:53], v[100:101]
  v_pk_mul_f32 v[54:55], v[54:55], v[102:103]
  v_pk_mul_f32 v[56:57], v[56:57], v[96:97]
  v_pk_mul_f32 v[58:59], v[58:59], v[98:99]
  v_pk_mul_f32 v[60:61], v[60:61], v[100:101]
  v_pk_mul_f32 v[62:63], v[62:63], v[102:103]
  v_pk_mul_f32 v[64:65], v[64:65], v[96:97]
  v_pk_mul_f32 v[66:67], v[66:67], v[98:99]
  v_pk_mul_f32 v[68:69], v[68:69], v[100:101]
  v_pk_mul_f32 v[70:71], v[70:71], v[102:103]
  v_pk_mul_f32 v[72:73], v[72:73], v[96:97]
  v_pk_mul_f32 v[74:75], v[74:75], v[98:99]
  v_pk_mul_f32 v[76:77], v[76:77], v[100:101]
  v_pk_mul_f32 v[78:79], v[78:79], v[102:103]
  v_pk_mul_f32 v[80:81], v[80:81], v[96:97]
  v_pk_mul_f32 v[82:83], v[82:83], v[98:99]
  v_pk_mul_f32 v[84:85], v[84:85], v[100:101]
  v_pk_mul_f32 v[86:87], v[86:87], v[102:103]
  s_waitcnt vmcnt(9)
  ds_write_b128 v186, v[192:195] offset:0
  s_add_u32 s34, s34, 4096
  buffer_load_dwordx4 a[32:35], v2, s[52:55], s34 offen offset:0 sc1
  v_fmac_f32 v49, v16, v48
  v_fmac_f32 v57, v17, v56
  v_fmac_f32 v65, v18, v64
  v_fmac_f32 v73, v19, v72
  v_fmac_f32 v81, v20, v80
  v_fmac_f32_dpp v49, v48, v21 quad_perm:[1,0,3,2] row_mask:0xf bank_mask:0xf
  v_fmac_f32_dpp v57, v56, v22 quad_perm:[1,0,3,2] row_mask:0xf bank_mask:0xf
  v_fmac_f32_dpp v65, v64, v23 quad_perm:[1,0,3,2] row_mask:0xf bank_mask:0xf
  v_fmac_f32_dpp v73, v72, v24 quad_perm:[1,0,3,2] row_mask:0xf bank_mask:0xf
  v_fmac_f32_dpp v81, v80, v25 quad_perm:[1,0,3,2] row_mask:0xf bank_mask:0xf
  v_alignbit_b32 v204, v204, v192, 16
  v_alignbit_b32 v205, v205, v193, 16
  v_alignbit_b32 v206, v206, v194, 16
  v_alignbit_b32 v207, v207, v195, 16
  ds_write_b128 v186, v[204:207] offset:4160
  ds_write_b128 v186, v[196:199] offset:8320
  buffer_load_dwordx4 a[36:39], v2, s[52:55], s34 offen offset:1024 sc1
  v_fmac_f32 v50, v16, v49
  v_fmac_f32 v58, v17, v57
  v_fmac_f32 v66, v18, v65
  v_fmac_f32 v74, v19, v73
  v_fmac_f32_e64 v82, v20, v81
  v_fmac_f32_dpp v50, v49, v21 quad_perm:[1,0,3,2] row_mask:0xf bank_mask:0xf
  v_fmac_f32_dpp v58, v57, v22 quad_perm:[1,0,3,2] row_mask:0xf bank_mask:0xf
  v_fmac_f32_dpp v66, v65, v23 quad_perm:[1,0,3,2] row_mask:0xf bank_mask:0xf
  v_fmac_f32_dpp v74, v73, v24 quad_perm:[1,0,3,2] row_mask:0xf bank_mask:0xf
  v_fmac_f32_dpp v82, v81, v25 quad_perm:[1,0,3,2] row_mask:0xf bank_mask:0xf
  v_alignbit_b32 v208, v208, v196, 16
  v_alignbit_b32 v209, v209, v197, 16
  v_alignbit_b32 v210, v210, v198, 16
  v_alignbit_b32 v211, v211, v199, 16
  ds_write_b128 v186, v[208:211] offset:12480
  ds_write_b128 v186, v[200:203] offset:16640
  buffer_load_dwordx4 a[40:43], v2, s[52:55], s34 offen offset:2048 sc1
  v_fmac_f32 v51, v16, v50
  v_fmac_f32 v59, v17, v58
  v_fmac_f32 v67, v18, v66
  v_fmac_f32 v75, v19, v74
  v_fmac_f32_e64 v83, v20, v82
  v_fmac_f32_dpp v51, v50, v21 quad_perm:[1,0,3,2] row_mask:0xf bank_mask:0xf
  v_fmac_f32_dpp v59, v58, v22 quad_perm:[1,0,3,2] row_mask:0xf bank_mask:0xf
  v_fmac_f32_dpp v67, v66, v23 quad_perm:[1,0,3,2] row_mask:0xf bank_mask:0xf
  v_fmac_f32_dpp v75, v74, v24 quad_perm:[1,0,3,2] row_mask:0xf bank_mask:0xf
  v_fmac_f32_dpp v83, v82, v25 quad_perm:[1,0,3,2] row_mask:0xf bank_mask:0xf
  v_alignbit_b32 v212, v212, v200, 16
  v_alignbit_b32 v213, v213, v201, 16
  v_alignbit_b32 v214, v214, v202, 16
  v_alignbit_b32 v215, v215, v203, 16
  ds_write_b128 v186, v[212:215] offset:20800
  buffer_load_dwordx4 a[44:47], v2, s[52:55], s34 offen offset:3072 sc1
  v_fmac_f32 v52, v16, v51
  v_fmac_f32 v60, v17, v59
  v_fmac_f32 v68, v18, v67
  v_fmac_f32 v76, v19, v75
  v_fmac_f32_e64 v84, v20, v83
  v_fmac_f32_dpp v52, v51, v21 quad_perm:[1,0,3,2] row_mask:0xf bank_mask:0xf
  v_fmac_f32_dpp v60, v59, v22 quad_perm:[1,0,3,2] row_mask:0xf bank_mask:0xf
  v_fmac_f32_dpp v68, v67, v23 quad_perm:[1,0,3,2] row_mask:0xf bank_mask:0xf
  v_fmac_f32_dpp v76, v75, v24 quad_perm:[1,0,3,2] row_mask:0xf bank_mask:0xf
  v_fmac_f32_dpp v84, v83, v25 quad_perm:[1,0,3,2] row_mask:0xf bank_mask:0xf
  s_cmp_lg_u32 s7, 0
  s_cbranch_scc1 skip_27
  v_mov_b32 v216, 0
  v_mov_b32 v217, 0
  v_mov_b32 v218, 0
  v_mov_b32 v219, 0
  s_mov_b64 exec, 0xfff
  ds_write_b128 v163, v[216:219]
  s_mov_b64 exec, 1
  ds_write_b16 v163, v192 offset:4190
  ds_write_b16 v163, v196 offset:12510
  ds_write_b16 v163, v200 offset:20830
  s_mov_b64 exec, -1
skip_27:
  s_add_u32 s34, s34, 4096
  buffer_load_dwordx4 a[48:51], v2, s[52:55], s34 offen offset:0 sc1
  v_fmac_f32 v53, v16, v52
  v_fmac_f32 v61, v17, v60
  v_fmac_f32 v69, v18, v68
  v_fmac_f32 v77, v19, v76
  v_fmac_f32_e64 v85, v20, v84
  v_fmac_f32_dpp v53, v52, v21 quad_perm:[1,0,3,2] row_mask:0xf bank_mask:0xf
  v_fmac_f32_dpp v61, v60, v22 quad_perm:[1,0,3,2] row_mask:0xf bank_mask:0xf
  v_fmac_f32_dpp v69, v68, v23 quad_perm:[1,0,3,2] row_mask:0xf bank_mask:0xf
  v_fmac_f32_dpp v77, v76, v24 quad_perm:[1,0,3,2] row_mask:0xf bank_mask:0xf
  v_fmac_f32_dpp v85, v84, v25 quad_perm:[1,0,3,2] row_mask:0xf bank_mask:0xf
  ds_write_b64 v228, v[152:153]
  buffer_load_dwordx4 a[52:55], v2, s[52:55], s34 offen offset:1024 sc1
  v_fmac_f32 v54, v16, v53
  v_fmac_f32 v62, v17, v61
  v_fmac_f32 v70, v18, v69
  v_fmac_f32 v78, v19, v77
  v_fmac_f32_e64 v86, v20, v85
  v_fmac_f32_dpp v54, v53, v21 quad_perm:[1,0,3,2] row_mask:0xf bank_mask:0xf
  v_fmac_f32_dpp v62, v61, v22 quad_perm:[1,0,3,2] row_mask:0xf bank_mask:0xf
  v_fmac_f32_dpp v70, v69, v23 quad_perm:[1,0,3,2] row_mask:0xf bank_mask:0xf
  v_fmac_f32_dpp v78, v77, v24 quad_perm:[1,0,3,2] row_mask:0xf bank_mask:0xf
  v_fmac_f32_dpp v86, v85, v25 quad_perm:[1,0,3,2] row_mask:0xf bank_mask:0xf
  buffer_load_dwordx4 a[56:59], v2, s[52:55], s34 offen offset:2048 sc1
  v_fmac_f32 v55, v16, v54
  v_fmac_f32 v63, v17, v62
  v_fmac_f32 v71, v18, v70
  v_fmac_f32 v79, v19, v78
  v_fmac_f32_e64 v87, v20, v86
  v_fmac_f32_dpp v55, v54, v21 quad_perm:[1,0,3,2] row_mask:0xf bank_mask:0xf
  v_fmac_f32_dpp v63, v62, v22 quad_perm:[1,0,3,2] row_mask:0xf bank_mask:0xf
  v_fmac_f32_dpp v71, v70, v23 quad_perm:[1,0,3,2] row_mask:0xf bank_mask:0xf
  v_fmac_f32_dpp v79, v78, v24 quad_perm:[1,0,3,2] row_mask:0xf bank_mask:0xf
  v_fmac_f32_dpp v87, v86, v25 quad_perm:[1,0,3,2] row_mask:0xf bank_mask:0xf
  v_add_u32 v11, 152320, v9
  v_min_u32 v12, 39, v1
  v_mul_u32_u24 v44, 48, v12
  s_lshl_b32 s12, s7, 3
  s_add_u32 s12, s12, 149504
  v_add_u32 v44, s12, v44
  ds_write_b32 v11, v55 offset:0
  ds_write_b32 v11, v63 offset:1152
  ds_write_b32 v11, v71 offset:2304
  ds_write_b32 v11, v79 offset:3456
  ds_write_b32 v11, v87 offset:4608
  v_mul_u32_u24 v46, 144, v12
  v_add_u32 v46, 152320, v46
  s_waitcnt lgkmcnt(0)
  s_barrier
  ds_read_b128 v[90:93], v46 offset:0
  ds_read_b128 v[94:97], v46 offset:16
  ds_read_b128 v[98:101], v46 offset:32
  ds_read_b128 v[102:105], v46 offset:48
  ds_read_b128 v[106:109], v46 offset:64
  ds_read_b128 v[110:113], v46 offset:80
  ds_read_b128 v[114:117], v46 offset:96
  ds_read_b128 v[118:121], v46 offset:112
  s_waitcnt lgkmcnt(7)
  v_pk_fma_f32 v[92:93], v[90:91], v[36:37], v[92:93] op_sel:[1,1,0] op_sel_hi:[0,1,1] neg_lo:[0,1,0]
  v_pk_fma_f32 v[92:93], v[90:91], v[36:37], v[92:93] op_sel:[0,0,0] op_sel_hi:[1,0,1]
  buffer_load_dwordx4 a[60:63], v2, s[52:55], s34 offen offset:3072 sc1
  s_waitcnt lgkmcnt(6)
  v_pk_fma_f32 v[94:95], v[92:93], v[36:37], v[94:95] op_sel:[1,1,0] op_sel_hi:[0,1,1] neg_lo:[0,1,0]
  v_pk_fma_f32 v[94:95], v[92:93], v[36:37], v[94:95] op_sel:[0,0,0] op_sel_hi:[1,0,1]
  v_pk_fma_f32 v[96:97], v[94:95], v[36:37], v[96:97] op_sel:[1,1,0] op_sel_hi:[0,1,1] neg_lo:[0,1,0]
  v_pk_fma_f32 v[96:97], v[94:95], v[36:37], v[96:97] op_sel:[0,0,0] op_sel_hi:[1,0,1]
  s_waitcnt lgkmcnt(5)
  s_add_u32 s34, s34, 4096
  buffer_load_dwordx4 a[64:67], v2, s[52:55], s34 offen offset:0 sc1
  v_pk_fma_f32 v[98:99], v[96:97], v[36:37], v[98:99] op_sel:[1,1,0] op_sel_hi:[0,1,1] neg_lo:[0,1,0]
  v_pk_fma_f32 v[98:99], v[96:97], v[36:37], v[98:99] op_sel:[0,0,0] op_sel_hi:[1,0,1]
  v_pk_fma_f32 v[100:101], v[98:99], v[36:37], v[100:101] op_sel:[1,1,0] op_sel_hi:[0,1,1] neg_lo:[0,1,0]
  v_pk_fma_f32 v[100:101], v[98:99], v[36:37], v[100:101] op_sel:[0,0,0] op_sel_hi:[1,0,1]
  s_waitcnt lgkmcnt(4)
  v_pk_fma_f32 v[102:103], v[100:101], v[36:37], v[102:103] op_sel:[1,1,0] op_sel_hi:[0,1,1] neg_lo:[0,1,0]
  buffer_load_dwordx4 a[68:71], v2, s[52:55], s34 offen offset:1024 sc1
  v_pk_fma_f32 v[102:103], v[100:101], v[36:37], v[102:103] op_sel:[0,0,0] op_sel_hi:[1,0,1]
  v_pk_fma_f32 v[104:105], v[102:103], v[36:37], v[104:105] op_sel:[1,1,0] op_sel_hi:[0,1,1] neg_lo:[0,1,0]
  v_pk_fma_f32 v[104:105], v[102:103], v[36:37], v[104:105] op_sel:[0,0,0] op_sel_hi:[1,0,1]
  s_waitcnt lgkmcnt(3)
  v_pk_fma_f32 v[106:107], v[104:105], v[36:37], v[106:107] op_sel:[1,1,0] op_sel_hi:[0,1,1] neg_lo:[0,1,0]
  v_pk_fma_f32 v[106:107], v[104:105], v[36:37], v[106:107] op_sel:[0,0,0] op_sel_hi:[1,0,1]
  buffer_load_dwordx4 a[72:75], v2, s[52:55], s34 offen offset:2048 sc1
  v_pk_fma_f32 v[108:109], v[106:107], v[36:37], v[108:109] op_sel:[1,1,0] op_sel_hi:[0,1,1] neg_lo:[0,1,0]
  v_pk_fma_f32 v[108:109], v[106:107], v[36:37], v[108:109] op_sel:[0,0,0] op_sel_hi:[1,0,1]
  s_waitcnt lgkmcnt(2)
  v_pk_fma_f32 v[110:111], v[108:109], v[36:37], v[110:111] op_sel:[1,1,0] op_sel_hi:[0,1,1] neg_lo:[0,1,0]
  v_pk_fma_f32 v[110:111], v[108:109], v[36:37], v[110:111] op_sel:[0,0,0] op_sel_hi:[1,0,1]
  v_pk_fma_f32 v[112:113], v[110:111], v[36:37], v[112:113] op_sel:[1,1,0] op_sel_hi:[0,1,1] neg_lo:[0,1,0]
  buffer_load_dwordx4 a[76:79], v2, s[52:55], s34 offen offset:3072 sc1
  v_pk_fma_f32 v[112:113], v[110:111], v[36:37], v[112:113] op_sel:[0,0,0] op_sel_hi:[1,0,1]
  s_waitcnt lgkmcnt(1)
  v_pk_fma_f32 v[114:115], v[112:113], v[36:37], v[114:115] op_sel:[1,1,0] op_sel_hi:[0,1,1] neg_lo:[0,1,0]
  v_pk_fma_f32 v[114:115], v[112:113], v[36:37], v[114:115] op_sel:[0,0,0] op_sel_hi:[1,0,1]
  v_pk_fma_f32 v[116:117], v[114:115], v[36:37], v[116:117] op_sel:[1,1,0] op_sel_hi:[0,1,1] neg_lo:[0,1,0]
  v_pk_fma_f32 v[116:117], v[114:115], v[36:37], v[116:117] op_sel:[0,0,0] op_sel_hi:[1,0,1]
  s_waitcnt lgkmcnt(0)
  v_pk_fma_f32 v[118:119], v[116:117], v[36:37], v[118:119] op_sel:[1,1,0] op_sel_hi:[0,1,1] neg_lo:[0,1,0]
  v_pk_fma_f32 v[118:119], v[116:117], v[36:37], v[118:119] op_sel:[0,0,0] op_sel_hi:[1,0,1]
  v_pk_fma_f32 v[120:121], v[118:119], v[36:37], v[120:121] op_sel:[1,1,0] op_sel_hi:[0,1,1] neg_lo:[0,1,0]
  v_pk_fma_f32 v[120:121], v[118:119], v[36:37], v[120:121] op_sel:[0,0,0] op_sel_hi:[1,0,1]
  v_mov_b32 v122, s8
  v_mov_b32 v123, s8
  s_add_u32 s12, s83, 10240
  s_mov_b64 exec, s[96:97]
  buffer_store_dwordx4 v[120:123], v2, s[52:55], s12 offen sc1
  s_mov_b64 exec, -1
  v_accvgpr_read_b32 v232, a200
  v_accvgpr_read_b32 v236, a201
  v_accvgpr_read_b32 v240, a202
  v_accvgpr_read_b32 v241, a203
  v_add_u32 v233, 1024, v232
  v_add_u32 v234, 2048, v232
  v_add_u32 v235, 3072, v232
  v_add_u32 v237, 1024, v236
  v_add_u32 v238, 2048, v236
  v_add_u32 v239, 3072, v236
  ds_read2_b32 v[156:157], v235 offset0:128 offset1:129
  ds_read2_b32 v[158:159], v235 offset0:130 offset1:131
  ds_read_b128 v[160:163], v240 offset:3584
  ds_read2_b32 v[152:153], v235 offset0:0 offset1:1
  ds_read2_b32 v[154:155], v235 offset0:2 offset1:3
  ds_read_b128 v[164:167], v240 offset:3072
  ds_read2_b32 v[148:149], v234 offset0:128 offset1:129
  ds_read2_b32 v[150:151], v234 offset0:130 offset1:131
  s_waitcnt lgkmcnt(5)
  v_mfma_f32_16x16x32_bf16 v[220:223], v[156:159], v[160:163], 0
  ds_read_b128 v[168:171], v240 offset:2560
  s_waitcnt lgkmcnt(4)
  v_mfma_f32_16x16x32_bf16 v[216:219], v[152:155], v[160:163], 0
  ds_read2_b32 v[144:145], v234 offset0:0 offset1:1
  ds_read2_b32 v[146:147], v234 offset0:2 offset1:3
  s_waitcnt lgkmcnt(5)
  v_mfma_f32_16x16x32_bf16 v[220:223], v[152:155], v[164:167], v[220:223]
  ds_read_b128 v[172:175], v240 offset:2048
  s_waitcnt lgkmcnt(4)
  v_mfma_f32_16x16x32_bf16 v[212:215], v[148:151], v[160:163], 0
  ds_read2_b32 v[140:141], v233 offset0:128 offset1:129
  ds_read2_b32 v[142:143], v233 offset0:130 offset1:131
  v_subrev_u32 v46, 8576, v46
  v_mov_b32 v88, 0
  v_mov_b32 v89, 0
  s_mov_b32 exec_hi, 0xff
  s_cmp_eq_u32 s7, 1
  s_cbranch_scc1 w1_30
  s_cmp_eq_u32 s7, 2
  s_cbranch_scc1 w2_31
  s_cmp_eq_u32 s7, 3
  s_cbranch_scc1 w3_32
w0_29:
  ds_write_b128 v46, v[88:91] offset:0
  ds_write_b128 v46, v[92:95] offset:16
  s_branch join_28
w1_30:
  ds_write_b128 v46, v[96:99] offset:32
  ds_write_b128 v46, v[100:103] offset:48
  s_branch join_28
w2_31:
  ds_write_b128 v46, v[104:107] offset:64
  ds_write_b128 v46, v[108:111] offset:80
  s_branch join_28
w3_32:
  ds_write_b128 v46, v[112:115] offset:96
  ds_write_b128 v46, v[116:119] offset:112
join_28:
  s_mov_b32 exec_hi, -1
  v_add_u32 v46, 143744, v9
  ds_read_b32 v244, v46 offset:0
  s_add_u32 s34, s34, 4096
  buffer_load_dwordx4 a[80:83], v2, s[52:55], s34 offen offset:0 sc1
  s_add_u32 m0, s48, 0
  s_nop 0
  buffer_load_dwordx4 v224, s[68:71], s20 offen lds
  ds_read_b64 a[226:227], v227
  v_mfma_f32_16x16x32_bf16 v[216:219], v[148:151], v[164:167], v[216:219]
  ds_read_b128 v[176:179], v240 offset:1536
  s_waitcnt lgkmcnt(10)
  v_mfma_f32_16x16x32_bf16 v[220:223], v[148:151], v[168:171], v[220:223]
  ds_read2_b32 v[136:137], v233 offset0:0 offset1:1
  ds_read2_b32 v[138:139], v233 offset0:2 offset1:3
  s_waitcnt lgkmcnt(10)
  v_mfma_f32_16x16x32_bf16 v[208:211], v[144:147], v[160:163], 0
  ds_read_b128 v[180:183], v240 offset:1024
  v_mfma_f32_16x16x32_bf16 v[212:215], v[144:147], v[164:167], v[212:215]
  ds_read2_b32 v[132:133], v232 offset0:128 offset1:129
  ds_read2_b32 v[134:135], v232 offset0:130 offset1:131
  ds_read_b32 v246, v46 offset:1152
  ds_read_b32 v248, v46 offset:2304
  ds_read_b32 v250, v46 offset:3456
  s_add_u32 m0, s48, 1024
  s_nop 0
  buffer_load_dwordx4 v225, s[68:71], s20 offen lds
  s_mov_b32 s60, s46
  s_and_b32 s61, s47, 0xffff
  s_mov_b32 s62, 5242880
  s_mov_b32 s63, 0x20000
  v_mfma_f32_16x16x32_bf16 v[216:219], v[144:147], v[168:171], v[216:219]
  ds_read_b32 v252, v46 offset:4608
  v_and_b32 v43, 1, v3
  s_waitcnt lgkmcnt(15)
  v_mfma_f32_16x16x32_bf16 v[220:223], v[144:147], v[172:175], v[220:223]
  v_cvt_f32_u32 v43, v43
  s_waitcnt lgkmcnt(14)
  v_mfma_f32_16x16x32_bf16 v[204:207], v[140:143], v[160:163], 0
  buffer_load_dwordx4 a[84:87], v2, s[52:55], s34 offen offset:1024 sc1
  v_mfma_f32_16x16x32_bf16 v[208:211], v[140:143], v[164:167], v[208:211]
  s_add_u32 m0, s48, 2048
  s_mov_b32 exec_hi, 0
  buffer_load_dwordx4 v226, s[68:71], s20 offen lds
  s_mov_b32 exec_hi, -1
  v_mfma_f32_16x16x32_bf16 v[212:215], v[140:143], v[168:171], v[212:215]
  v_fma_f32 v43, 2.0, v43, -1.0
  s_waitcnt lgkmcnt(0)
  s_nop 0
  v_mul_f32_dpp v245, v244, v43 quad_perm:[1,0,3,2] row_mask:0xf bank_mask:0xf
  v_mfma_f32_16x16x32_bf16 v[216:219], v[140:143], v[172:175], v[216:219]
  ds_read_b128 v[184:187], v240 offset:512
  v_mfma_f32_16x16x32_bf16 v[220:223], v[140:143], v[176:179], v[220:223]
  ds_read2_b32 v[128:129], v232 offset0:0 offset1:1
  ds_read2_b32 v[130:131], v232 offset0:2 offset1:3
  v_mfma_f32_16x16x32_bf16 v[200:203], v[136:139], v[160:163], 0
  s_mov_b32 s64, s32
  s_and_b32 s65, s33, 0xffff
  s_mov_b32 s66, 1280
  s_mov_b32 s67, 0x20000
  s_add_u32 m0, s48, 2560
  s_mul_i32 s12, s6, 160
  s_mov_b64 exec, 0x3ff
  buffer_load_dwordx4 v2, s[64:67], s12 offen lds
  s_mov_b64 exec, -1
  v_mov_b32 v228, -1
  v_mov_b32 v229, -1
  v_mov_b32 v230, -1
  v_mov_b32 v231, -1
  v_lshlrev_b32_e64 v11, 3, v1
  buffer_store_dwordx2 v[228:229], v11, s[52:55], s51 offen sc1
  v_mfma_f32_16x16x32_bf16 v[204:207], v[136:139], v[164:167], v[204:207]
  v_mul_f32_dpp v247, v246, v43 quad_perm:[1,0,3,2] row_mask:0xf bank_mask:0xf
  v_mul_f32_dpp v249, v248, v43 quad_perm:[1,0,3,2] row_mask:0xf bank_mask:0xf
  v_mfma_f32_16x16x32_bf16 v[208:211], v[136:139], v[168:171], v[208:211]
  v_mul_f32_dpp v251, v250, v43 quad_perm:[1,0,3,2] row_mask:0xf bank_mask:0xf
  v_mfma_f32_16x16x32_bf16 v[212:215], v[136:139], v[172:175], v[212:215]
  buffer_load_dwordx4 a[88:91], v2, s[52:55], s34 offen offset:2048 sc1
  v_mfma_f32_16x16x32_bf16 v[216:219], v[136:139], v[176:179], v[216:219]
  buffer_store_dwordx4 v[228:231], v2, s[52:55], s50 offen offset:0 sc1
  v_mfma_f32_16x16x32_bf16 v[220:223], v[136:139], v[180:183], v[220:223]
  v_mul_f32_dpp v253, v252, v43 quad_perm:[1,0,3,2] row_mask:0xf bank_mask:0xf
  v_mfma_f32_16x16x32_bf16 v[196:199], v[132:135], v[160:163], 0
  ds_read_b128 v[188:191], v240 offset:0
  v_mfma_f32_16x16x32_bf16 v[200:203], v[132:135], v[164:167], v[200:203]
  ds_read2_b32 v[156:157], v235 offset0:144 offset1:145
  ds_read2_b32 v[158:159], v235 offset0:146 offset1:147
  v_mfma_f32_16x16x32_bf16 v[204:207], v[132:135], v[168:171], v[204:207]
  ds_read2_b32 v[152:153], v235 offset0:16 offset1:17
  ds_read2_b32 v[154:155], v235 offset0:18 offset1:19
  buffer_store_dwordx4 v[228:231], v2, s[52:55], s50 offen offset:1024 sc1
  v_mfma_f32_16x16x32_bf16 v[208:211], v[132:135], v[172:175], v[208:211]
  buffer_load_dwordx4 a[92:95], v2, s[52:55], s34 offen offset:3072 sc1
  v_mfma_f32_16x16x32_bf16 v[212:215], v[132:135], v[176:179], v[212:215]
  ds_read2_b32 v[148:149], v234 offset0:144 offset1:145
  ds_read2_b32 v[150:151], v234 offset0:146 offset1:147
  v_mfma_f32_16x16x32_bf16 v[216:219], v[132:135], v[180:183], v[216:219]
  s_waitcnt lgkmcnt(9)
  v_mfma_f32_16x16x32_bf16 v[220:223], v[132:135], v[184:187], v[220:223]
  s_waitcnt lgkmcnt(7)
  v_mfma_f32_16x16x32_bf16 v[192:195], v[128:131], v[160:163], 0
  ds_read_b128 v[160:163], v240 offset:3648
  v_mfma_f32_16x16x32_bf16 v[196:199], v[128:131], v[164:167], v[196:199]
  ds_read2_b32 v[144:145], v234 offset0:16 offset1:17
  ds_read2_b32 v[146:147], v234 offset0:18 offset1:19
  v_mfma_f32_16x16x32_bf16 v[200:203], v[128:131], v[168:171], v[200:203]
  ds_read_b128 v[164:167], v240 offset:3136
  v_mfma_f32_16x16x32_bf16 v[204:207], v[128:131], v[172:175], v[204:207]
  ds_read_b128 v[168:171], v240 offset:2624
  v_mfma_f32_16x16x32_bf16 v[208:211], v[128:131], v[176:179], v[208:211]
  ds_read_b128 v[172:175], v240 offset:2112
  v_mfma_f32_16x16x32_bf16 v[212:215], v[128:131], v[180:183], v[212:215]
  ds_read2_b32 v[140:141], v233 offset0:144 offset1:145
  ds_read2_b32 v[142:143], v233 offset0:146 offset1:147
  v_mfma_f32_16x16x32_bf16 v[216:219], v[128:131], v[184:187], v[216:219]
  s_add_u32 s34, s34, 4096
  buffer_load_dwordx4 a[96:99], v2, s[52:55], s34 offen offset:0 sc1
  s_waitcnt lgkmcnt(14)
  v_mfma_f32_16x16x32_bf16 v[220:223], v[128:131], v[188:191], v[220:223]
  s_waitcnt lgkmcnt(7)
  v_mfma_f32_16x16x32_bf16 v[220:223], v[156:159], v[160:163], v[220:223]
  ds_read_b128 v[176:179], v240 offset:1600
  v_mfma_f32_16x16x32_bf16 v[216:219], v[152:155], v[160:163], v[216:219]
  ds_read2_b32 v[136:137], v233 offset0:16 offset1:17
  ds_read2_b32 v[138:139], v233 offset0:18 offset1:19
  s_waitcnt lgkmcnt(7)
  v_mfma_f32_16x16x32_bf16 v[220:223], v[152:155], v[164:167], v[220:223]
  v_mfma_f32_16x16x32_bf16 v[212:215], v[148:151], v[160:163], v[212:215]
  v_mfma_f32_16x16x32_bf16 v[216:219], v[148:151], v[164:167], v[216:219]
  buffer_load_dwordx4 a[100:103], v2, s[52:55], s34 offen offset:1024 sc1
  s_waitcnt lgkmcnt(6)
  v_mfma_f32_16x16x32_bf16 v[220:223], v[148:151], v[168:171], v[220:223]
  s_and_b32 vcc_lo, s1, 7
  s_lshl_b32 vcc_lo, vcc_lo, 2
  s_add_u32 vcc_lo, vcc_lo, s7
  s_lshl_b32 vcc_lo, vcc_lo, 11
  v_lshl_add_u32 v15, v3, 7, vcc_lo
  v_min_u32 v15, L_codeend-L_pc-4, v15
  s_mov_b64 exec, 0xffff
  global_load_dword a250, v15, s[98:99]
  s_mov_b64 exec, -1
  v_mfma_f32_16x16x32_bf16 v[208:211], v[144:147], v[160:163], v[208:211]
  ds_read_b128 v[180:183], v240 offset:1088
  v_mfma_f32_16x16x32_bf16 v[212:215], v[144:147], v[164:167], v[212:215]
  ds_read2_b32 v[132:133], v232 offset0:144 offset1:145
  ds_read2_b32 v[134:135], v232 offset0:146 offset1:147
  v_mfma_f32_16x16x32_bf16 v[216:219], v[144:147], v[168:171], v[216:219]
  s_waitcnt lgkmcnt(8)
  v_mfma_f32_16x16x32_bf16 v[220:223], v[144:147], v[172:175], v[220:223]
  s_waitcnt lgkmcnt(6)
  v_mfma_f32_16x16x32_bf16 v[204:207], v[140:143], v[160:163], v[204:207]
  v_mfma_f32_16x16x32_bf16 v[208:211], v[140:143], v[164:167], v[208:211]
  v_mfma_f32_16x16x32_bf16 v[212:215], v[140:143], v[168:171], v[212:215]
  buffer_load_dwordx4 a[104:107], v2, s[52:55], s34 offen offset:2048 sc1
  v_mfma_f32_16x16x32_bf16 v[216:219], v[140:143], v[172:175], v[216:219]
  ds_read_b128 v[184:187], v240 offset:576
  s_waitcnt lgkmcnt(6)
  v_mfma_f32_16x16x32_bf16 v[220:223], v[140:143], v[176:179], v[220:223]
  ds_read2_b32 v[128:129], v232 offset0:16 offset1:17
  ds_read2_b32 v[130:131], v232 offset0:18 offset1:19
  s_waitcnt lgkmcnt(6)
  v_mfma_f32_16x16x32_bf16 v[200:203], v[136:139], v[160:163], v[200:203]
  v_accvgpr_read_b32 v11, a245
  s_and_b32 exec_lo, s96, 0x3fffffff
  s_mov_b32 exec_hi, 0
  buffer_load_dword a250, v11, s[52:55], 0 offen
  s_mov_b64 exec, -1
  v_mfma_f32_16x16x32_bf16 v[204:207], v[136:139], v[164:167], v[204:207]
  v_mfma_f32_16x16x32_bf16 v[208:211], v[136:139], v[168:171], v[208:211]
  v_mfma_f32_16x16x32_bf16 v[212:215], v[136:139], v[172:175], v[212:215]
  v_mfma_f32_16x16x32_bf16 v[216:219], v[136:139], v[176:179], v[216:219]
  s_waitcnt lgkmcnt(5)
  v_mfma_f32_16x16x32_bf16 v[220:223], v[136:139], v[180:183], v[220:223]
  buffer_load_dwordx4 a[108:111], v2, s[52:55], s34 offen offset:3072 sc1
  s_waitcnt lgkmcnt(3)
  v_mfma_f32_16x16x32_bf16 v[196:199], v[132:135], v[160:163], v[196:199]
  ds_read_b128 v[188:191], v240 offset:64
  v_mfma_f32_16x16x32_bf16 v[200:203], v[132:135], v[164:167], v[200:203]
  ds_read2_b32 v[156:157], v235 offset0:160 offset1:161
  ds_read2_b32 v[158:159], v235 offset0:162 offset1:163
  v_mfma_f32_16x16x32_bf16 v[204:207], v[132:135], v[168:171], v[204:207]
  ds_read2_b32 v[152:153], v235 offset0:32 offset1:33
  ds_read2_b32 v[154:155], v235 offset0:34 offset1:35
  s_waitcnt vmcnt(9)
  ds_read_b64 a[216:217], v242 offset:0
  v_mfma_f32_16x16x32_bf16 v[208:211], v[132:135], v[172:175], v[208:211]
  ds_read_b64 a[218:219], v242 offset:32
  v_mfma_f32_16x16x32_bf16 v[212:215], v[132:135], v[176:179], v[212:215]
  ds_read2_b32 v[148:149], v234 offset0:160 offset1:161
  ds_read2_b32 v[150:151], v234 offset0:162 offset1:163
  v_mfma_f32_16x16x32_bf16 v[216:219], v[132:135], v[180:183], v[216:219]
  ds_read_b64 a[220:221], v242 offset:64
  s_waitcnt lgkmcnt(12)
  v_mfma_f32_16x16x32_bf16 v[220:223], v[132:135], v[184:187], v[220:223]
  s_waitcnt lgkmcnt(10)
  v_mfma_f32_16x16x32_bf16 v[192:195], v[128:131], v[160:163], v[192:195]
  ds_read_b128 v[160:163], v240 offset:3712
  v_mfma_f32_16x16x32_bf16 v[196:199], v[128:131], v[164:167], v[196:199]
  ds_read2_b32 v[144:145], v234 offset0:32 offset1:33
  ds_read2_b32 v[146:147], v234 offset0:34 offset1:35
  v_mfma_f32_16x16x32_bf16 v[200:203], v[128:131], v[168:171], v[200:203]
  ds_read_b128 v[164:167], v240 offset:3200
  v_mfma_f32_16x16x32_bf16 v[204:207], v[128:131], v[172:175], v[204:207]
  ds_read_b128 v[168:171], v240 offset:2688
  s_add_u32 s34, s34, 4096
  buffer_load_dwordx4 a[112:115], v2, s[52:55], s34 offen offset:0 sc1
  ds_read_b64 a[222:223], v242 offset:96
  ds_read_b64 a[224:225], v242 offset:128
  v_mfma_f32_16x16x32_bf16 v[208:211], v[128:131], v[176:179], v[208:211]
  ds_read_b128 v[172:175], v240 offset:2176
  v_mfma_f32_16x16x32_bf16 v[212:215], v[128:131], v[180:183], v[212:215]
  ds_read2_b32 v[140:141], v233 offset0:160 offset1:161
  ds_read2_b32 v[142:143], v233 offset0:162 offset1:163
  v_mfma_f32_16x16x32_bf16 v[216:219], v[128:131], v[184:187], v[216:219]
  ds_read_b64 a[230:231], v243 offset:2560
  s_waitcnt lgkmcnt(15)
  v_mfma_f32_16x16x32_bf16 v[220:223], v[128:131], v[188:191], v[220:223]
  ds_read_b64 a[232:233], v243 offset:2592
  s_waitcnt lgkmcnt(11)
  v_mfma_f32_16x16x32_bf16 v[220:223], v[156:159], v[160:163], v[220:223]
  ds_read_b128 v[176:179], v240 offset:1664
  v_mfma_f32_16x16x32_bf16 v[216:219], v[152:155], v[160:163], v[216:219]
  ds_read2_b32 v[136:137], v233 offset0:32 offset1:33
  ds_read2_b32 v[138:139], v233 offset0:34 offset1:35
  s_waitcnt lgkmcnt(11)
  v_mfma_f32_16x16x32_bf16 v[220:223], v[152:155], v[164:167], v[220:223]
  buffer_load_dwordx4 a[116:119], v2, s[52:55], s34 offen offset:1024 sc1
  ds_read_b64 a[234:235], v243 offset:2624
  v_mfma_f32_16x16x32_bf16 v[212:215], v[148:151], v[160:163], v[212:215]
  ds_read_b64 a[236:237], v243 offset:2656
  v_mfma_f32_16x16x32_bf16 v[216:219], v[148:151], v[164:167], v[216:219]
  ds_read_b64 a[238:239], v243 offset:2688
  s_lshl_b32 s90, s7, 2
  s_waitcnt lgkmcnt(13)
  v_mfma_f32_16x16x32_bf16 v[220:223], v[148:151], v[168:171], v[220:223]
  s_sub_u32 s90, 12, s90
  v_mfma_f32_16x16x32_bf16 v[208:211], v[144:147], v[160:163], v[208:211]
  ds_read_b128 v[180:183], v240 offset:1152
  v_mfma_f32_16x16x32_bf16 v[212:215], v[144:147], v[164:167], v[212:215]
  ds_read2_b32 v[132:133], v232 offset0:160 offset1:161
  ds_read2_b32 v[134:135], v232 offset0:162 offset1:163
  s_mul_i32 s90, s90, 640
  s_add_u32 s90, s90, s83
  v_mfma_f32_16x16x32_bf16 v[216:219], v[144:147], v[168:171], v[216:219]
  s_add_u32 s90, s90, 0
  s_waitcnt lgkmcnt(13)
  v_mfma_f32_16x16x32_bf16 v[220:223], v[144:147], v[172:175], v[220:223]
  v_min_u32 v42, 39, v1
  s_waitcnt lgkmcnt(11)
  v_mfma_f32_16x16x32_bf16 v[204:207], v[140:143], v[160:163], v[204:207]
  v_lshlrev_b32 v42, 4, v42
  v_mfma_f32_16x16x32_bf16 v[208:211], v[140:143], v[164:167], v[208:211]
  v_mfma_f32_16x16x32_bf16 v[212:215], v[140:143], v[168:171], v[212:215]
  buffer_load_dwordx3 v[88:90], v42, s[52:55], s90 offen offset:0 sc1
  v_mfma_f32_16x16x32_bf16 v[216:219], v[140:143], v[172:175], v[216:219]
  ds_read_b128 v[184:187], v240 offset:640
  s_waitcnt lgkmcnt(9)
  v_mfma_f32_16x16x32_bf16 v[220:223], v[140:143], v[176:179], v[220:223]
  ds_read2_b32 v[128:129], v232 offset0:32 offset1:33
  ds_read2_b32 v[130:131], v232 offset0:34 offset1:35
  s_waitcnt lgkmcnt(9)
  v_mfma_f32_16x16x32_bf16 v[200:203], v[136:139], v[160:163], v[200:203]
  buffer_load_dwordx3 v[92:94], v42, s[52:55], s90 offen offset:640 sc1
  v_mfma_f32_16x16x32_bf16 v[204:207], v[136:139], v[164:167], v[204:207]
  buffer_load_dwordx3 v[96:98], v42, s[52:55], s90 offen offset:1280 sc1
  v_mfma_f32_16x16x32_bf16 v[208:211], v[136:139], v[168:171], v[208:211]
  buffer_load_dwordx3 v[100:102], v42, s[52:55], s90 offen offset:1920 sc1
  v_mfma_f32_16x16x32_bf16 v[212:215], v[136:139], v[172:175], v[212:215]
  v_mfma_f32_16x16x32_bf16 v[216:219], v[136:139], v[176:179], v[216:219]
  s_waitcnt lgkmcnt(5)
  v_mfma_f32_16x16x32_bf16 v[220:223], v[136:139], v[180:183], v[220:223]
  s_waitcnt lgkmcnt(3)
  v_mfma_f32_16x16x32_bf16 v[196:199], v[132:135], v[160:163], v[196:199]
  ds_read_b128 v[188:191], v240 offset:128
  v_mfma_f32_16x16x32_bf16 v[200:203], v[132:135], v[164:167], v[200:203]
  v_mfma_f32_16x16x32_bf16 v[204:207], v[132:135], v[168:171], v[204:207]
  v_mfma_f32_16x16x32_bf16 v[208:211], v[132:135], v[172:175], v[208:211]
  v_mfma_f32_16x16x32_bf16 v[212:215], v[132:135], v[176:179], v[212:215]
  v_mfma_f32_16x16x32_bf16 v[216:219], v[132:135], v[180:183], v[216:219]
  s_waitcnt lgkmcnt(3)
  v_mfma_f32_16x16x32_bf16 v[220:223], v[132:135], v[184:187], v[220:223]
  s_waitcnt lgkmcnt(1)
  v_mfma_f32_16x16x32_bf16 v[192:195], v[128:131], v[160:163], v[192:195]
  v_mfma_f32_16x16x32_bf16 v[196:199], v[128:131], v[164:167], v[196:199]
  v_mfma_f32_16x16x32_bf16 v[200:203], v[128:131], v[168:171], v[200:203]
  v_mfma_f32_16x16x32_bf16 v[204:207], v[128:131], v[172:175], v[204:207]
  v_mfma_f32_16x16x32_bf16 v[208:211], v[128:131], v[176:179], v[208:211]
  v_mfma_f32_16x16x32_bf16 v[212:215], v[128:131], v[180:183], v[212:215]
  v_mfma_f32_16x16x32_bf16 v[216:219], v[128:131], v[184:187], v[216:219]
  s_waitcnt lgkmcnt(0)
  v_mfma_f32_16x16x32_bf16 v[220:223], v[128:131], v[188:191], v[220:223]
  v_lshrrev_b32 v11, 1, v3
  v_mul_u32_u24 v12, 80, v11
  v_add_u32 v12, 160640, v12
  v_mul_u32_u24_e64 v11, 48, v11
  v_add_u32 v11, 149504, v11
  ds_read_b128 v[128:131], v12 offset:0
  ds_read_b128 v[132:135], v12 offset:16
  ds_read_b128 v[136:139], v12 offset:32
  ds_read_b128 v[140:143], v12 offset:48
  ds_read_b128 v[144:147], v12 offset:640
  ds_read_b128 v[148:151], v12 offset:656
  ds_read_b128 v[152:155], v12 offset:672
  ds_read_b128 v[156:159], v12 offset:688
  v_accvgpr_read_b32 v254, a240
  v_accvgpr_read_b32 v255, a241
  v_accvgpr_read_b32 v47, a242
  s_waitcnt vmcnt(0)
  v_min3_u32 v14, v90, v94, s8
  v_max3_u32 v15, v90, v94, s8
  v_min3_u32 v14, v14, v98, v102
  v_max3_u32 v15, v15, v98, v102
  v_cmp_ne_u32 vcc, v14, v15
  s_cbranch_vccz ok_34
again_33:
  buffer_load_dwordx3 v[88:90], v42, s[52:55], s90 offen offset:0 sc1
  buffer_load_dwordx3 v[92:94], v42, s[52:55], s90 offen offset:640 sc1
  buffer_load_dwordx3 v[96:98], v42, s[52:55], s90 offen offset:1280 sc1
  buffer_load_dwordx3 v[100:102], v42, s[52:55], s90 offen offset:1920 sc1
  s_sub_u32 s10, s10, 1
  s_cmp_gt_i32 s10, 0
  s_waitcnt vmcnt(0)
  v_min3_u32 v14, v90, v94, s8
  v_max3_u32 v15, v90, v94, s8
  v_min3_u32 v14, v14, v98, v102
  v_max3_u32 v15, v15, v98, v102
  v_cmp_ne_u32 vcc, v14, v15
  s_cbranch_scc0 out_35
  s_cbranch_vccnz again_33
out_35:
ok_34:
  v_pk_fma_f32 v[92:93], v[88:89], v[38:39], v[92:93] op_sel:[1,1,0] op_sel_hi:[0,1,1] neg_lo:[0,1,0]
  v_pk_fma_f32 v[92:93], v[88:89], v[38:39], v[92:93] op_sel:[0,0,0] op_sel_hi:[1,0,1]
  v_pk_fma_f32 v[96:97], v[92:93], v[38:39], v[96:97] op_sel:[1,1,0] op_sel_hi:[0,1,1] neg_lo:[0,1,0]
  v_pk_fma_f32 v[96:97], v[92:93], v[38:39], v[96:97] op_sel:[0,0,0] op_sel_hi:[1,0,1]
  v_pk_fma_f32 v[100:101], v[96:97], v[38:39], v[100:101] op_sel:[1,1,0] op_sel_hi:[0,1,1] neg_lo:[0,1,0]
  v_pk_fma_f32 v[100:101], v[96:97], v[38:39], v[100:101] op_sel:[0,0,0] op_sel_hi:[1,0,1]
  v_pk_mul_f32 v[88:89], v[100:101], v[40:41] op_sel:[1,1] op_sel_hi:[0,1] neg_lo:[0,1]
  v_pk_fma_f32 v[88:89], v[100:101], v[40:41], v[88:89] op_sel:[0,0,0] op_sel_hi:[1,0,1]
  buffer_load_dwordx4 a[120:123], v2, s[52:55], s34 offen offset:2048 sc1
  s_mov_b32 exec_hi, 0xff
  ds_write_b64 v44, v[88:89]
  s_mov_b32 exec_hi, -1
  s_waitcnt lgkmcnt(0)
  s_barrier
  ds_read_b128 v[88:91], v11 offset:0
  ds_read_b128 v[92:95], v11 offset:16
  ds_read_b128 v[96:99], v11 offset:384
  ds_read_b128 v[100:103], v11 offset:400
  ds_read_b128 v[224:227], v11 offset:768
  ds_read_b128 v[228:231], v11 offset:784
  ds_read_b128 v[160:163], v12 offset:1280
  ds_read_b128 v[164:167], v12 offset:1296
  ds_read_b128 v[168:171], v12 offset:1312
  ds_read_b128 v[172:175], v12 offset:1328
  buffer_load_dwordx4 a[124:127], v2, s[52:55], s34 offen offset:3072 sc1
  s_waitcnt lgkmcnt(8)
  v_pk_add_f32 v[88:89], v[88:89], v[90:91]
  v_pk_add_f32 v[92:93], v[92:93], v[94:95]
  v_pk_add_f32 v[88:89], v[88:89], v[92:93]
  v_pk_fma_f32 v[244:245], v[26:27], v[88:89], v[244:245] op_sel:[0,0,0] op_sel_hi:[1,0,1]
  v_pk_fma_f32 v[244:245], v[26:27], v[88:89], v[244:245] op_sel:[1,1,0] op_sel_hi:[0,1,1] neg_hi:[1,0,0]
  ds_read_b128 v[88:91], v11 offset:1152
  ds_read_b128 v[92:95], v11 offset:1168
  s_waitcnt lgkmcnt(8)
  v_pk_add_f32 v[96:97], v[96:97], v[98:99]
  v_pk_add_f32 v[100:101], v[100:101], v[102:103]
  v_pk_add_f32 v[96:97], v[96:97], v[100:101]
  v_pk_fma_f32 v[246:247], v[28:29], v[96:97], v[246:247] op_sel:[0,0,0] op_sel_hi:[1,0,1]
  v_pk_fma_f32 v[246:247], v[28:29], v[96:97], v[246:247] op_sel:[1,1,0] op_sel_hi:[0,1,1] neg_hi:[1,0,0]
  ds_read_b128 v[96:99], v11 offset:1536
  ds_read_b128 v[100:103], v11 offset:1552
  ds_read_b128 v[176:179], v12 offset:1920
  ds_read_b128 v[180:183], v12 offset:1936
  ds_read_b128 v[184:187], v12 offset:1952
  ds_read_b128 v[188:191], v12 offset:1968
  v_pk_fma_f32 v[48:49], v[128:129], v[244:245], v[48:49] op_sel:[0,0,0] op_sel_hi:[1,0,1]
  v_pk_fma_f32 v[50:51], v[130:131], v[244:245], v[50:51] op_sel:[0,0,0] op_sel_hi:[1,0,1]
  v_pk_fma_f32 v[52:53], v[132:133], v[244:245], v[52:53] op_sel:[0,0,0] op_sel_hi:[1,0,1]
  v_pk_fma_f32 v[54:55], v[134:135], v[244:245], v[54:55] op_sel:[0,0,0] op_sel_hi:[1,0,1]
  s_add_u32 s34, s34, 4096
  buffer_load_dwordx4 a[128:131], v2, s[52:55], s34 offen offset:0 sc1
  v_pk_fma_f32 v[48:49], v[136:137], v[244:245], v[48:49] op_sel:[0,1,0] op_sel_hi:[1,1,1]
  v_pk_fma_f32 v[50:51], v[138:139], v[244:245], v[50:51] op_sel:[0,1,0] op_sel_hi:[1,1,1]
  v_pk_fma_f32 v[52:53], v[140:141], v[244:245], v[52:53] op_sel:[0,1,0] op_sel_hi:[1,1,1]
  v_pk_fma_f32 v[54:55], v[142:143], v[244:245], v[54:55] op_sel:[0,1,0] op_sel_hi:[1,1,1]
  v_cvt_pk_bf16_f32 v120, v48, v49
  v_cvt_pk_bf16_f32 v121, v50, v51
  v_cvt_pk_bf16_f32 v122, v52, v53
  v_cvt_pk_bf16_f32 v123, v54, v55
  ds_write_b128 v254, v[120:123]
  buffer_load_dwordx4 a[132:135], v2, s[52:55], s34 offen offset:1024 sc1
  ds_read_b64_tr_b16 v[52:53], v255
  ds_read_b64_tr_b16 v[54:55], v255 offset:640
  s_waitcnt lgkmcnt(15)
  v_pk_add_f32 v[224:225], v[224:225], v[226:227]
  v_pk_add_f32 v[228:229], v[228:229], v[230:231]
  v_pk_add_f32 v[224:225], v[224:225], v[228:229]
  v_pk_fma_f32 v[248:249], v[30:31], v[224:225], v[248:249] op_sel:[0,0,0] op_sel_hi:[1,0,1]
  v_pk_fma_f32 v[248:249], v[30:31], v[224:225], v[248:249] op_sel:[1,1,0] op_sel_hi:[0,1,1] neg_hi:[1,0,0]
  s_lshl_b32 s12, s86, 1
  s_add_u32 s12, s12, 24576
  v_mov_b32 v15, s8
  s_and_b32 exec_lo, s96, 1
  s_mov_b32 exec_hi, 0
  buffer_store_dword v15, off, s[52:55], s12 sc1
  s_mov_b64 exec, -1
  ds_read_b128 v[104:107], v12 offset:2560
  ds_read_b128 v[108:111], v12 offset:2576
  ds_read_b128 v[112:115], v12 offset:2592
  ds_read_b128 v[116:119], v12 offset:2608
  v_pk_fma_f32 v[56:57], v[144:145], v[246:247], v[56:57] op_sel:[0,0,0] op_sel_hi:[1,0,1]
  v_pk_fma_f32 v[58:59], v[146:147], v[246:247], v[58:59] op_sel:[0,0,0] op_sel_hi:[1,0,1]
  v_pk_fma_f32 v[60:61], v[148:149], v[246:247], v[60:61] op_sel:[0,0,0] op_sel_hi:[1,0,1]
  v_pk_fma_f32 v[62:63], v[150:151], v[246:247], v[62:63] op_sel:[0,0,0] op_sel_hi:[1,0,1]
  buffer_load_dwordx4 a[136:139], v2, s[52:55], s34 offen offset:2048 sc1
  v_pk_fma_f32 v[56:57], v[152:153], v[246:247], v[56:57] op_sel:[0,1,0] op_sel_hi:[1,1,1]
  v_pk_fma_f32 v[58:59], v[154:155], v[246:247], v[58:59] op_sel:[0,1,0] op_sel_hi:[1,1,1]
  v_pk_fma_f32 v[60:61], v[156:157], v[246:247], v[60:61] op_sel:[0,1,0] op_sel_hi:[1,1,1]
  v_pk_fma_f32 v[62:63], v[158:159], v[246:247], v[62:63] op_sel:[0,1,0] op_sel_hi:[1,1,1]
  v_cvt_pk_bf16_f32 v124, v56, v57
  v_cvt_pk_bf16_f32 v125, v58, v59
  v_cvt_pk_bf16_f32 v126, v60, v61
  v_cvt_pk_bf16_f32 v127, v62, v63
  ds_write_b128 v254, v[124:127]
  buffer_load_dwordx4 a[140:143], v2, s[52:55], s34 offen offset:3072 sc1
  ds_read_b64_tr_b16 v[60:61], v255
  ds_read_b64_tr_b16 v[62:63], v255 offset:640
  s_waitcnt lgkmcnt(15)
  v_pk_add_f32 v[88:89], v[88:89], v[90:91]
  v_pk_add_f32 v[92:93], v[92:93], v[94:95]
  v_pk_add_f32 v[88:89], v[88:89], v[92:93]
  v_pk_fma_f32 v[250:251], v[32:33], v[88:89], v[250:251] op_sel:[0,0,0] op_sel_hi:[1,0,1]
  v_pk_fma_f32 v[250:251], v[32:33], v[88:89], v[250:251] op_sel:[1,1,0] op_sel_hi:[0,1,1] neg_hi:[1,0,0]
  s_add_u32 s13, s78, 0
  s_waitcnt lgkmcnt(7)
  buffer_store_dwordx4 v[52:55], v47, s[60:63], s13 offen sc1
  v_pk_fma_f32 v[64:65], v[160:161], v[248:249], v[64:65] op_sel:[0,0,0] op_sel_hi:[1,0,1]
  v_pk_fma_f32 v[66:67], v[162:163], v[248:249], v[66:67] op_sel:[0,0,0] op_sel_hi:[1,0,1]
  v_pk_fma_f32 v[68:69], v[164:165], v[248:249], v[68:69] op_sel:[0,0,0] op_sel_hi:[1,0,1]
  v_pk_fma_f32 v[70:71], v[166:167], v[248:249], v[70:71] op_sel:[0,0,0] op_sel_hi:[1,0,1]
  s_add_u32 s34, s34, 4096
  buffer_load_dwordx4 a[144:147], v2, s[52:55], s34 offen offset:0 sc1
  v_pk_fma_f32 v[64:65], v[168:169], v[248:249], v[64:65] op_sel:[0,1,0] op_sel_hi:[1,1,1]
  v_pk_fma_f32 v[66:67], v[170:171], v[248:249], v[66:67] op_sel:[0,1,0] op_sel_hi:[1,1,1]
  v_pk_fma_f32 v[68:69], v[172:173], v[248:249], v[68:69] op_sel:[0,1,0] op_sel_hi:[1,1,1]
  v_pk_fma_f32 v[70:71], v[174:175], v[248:249], v[70:71] op_sel:[0,1,0] op_sel_hi:[1,1,1]
  v_cvt_pk_bf16_f32 v120, v64, v65
  v_cvt_pk_bf16_f32 v121, v66, v67
  v_cvt_pk_bf16_f32 v122, v68, v69
  v_cvt_pk_bf16_f32 v123, v70, v71
  ds_write_b128 v254, v[120:123]
  buffer_load_dwordx4 a[148:151], v2, s[52:55], s34 offen offset:1024 sc1
  ds_read_b64_tr_b16 v[68:69], v255
  ds_read_b64_tr_b16 v[70:71], v255 offset:640
  v_pk_add_f32 v[96:97], v[96:97], v[98:99]
  v_pk_add_f32 v[100:101], v[100:101], v[102:103]
  v_pk_add_f32 v[96:97], v[96:97], v[100:101]
  v_pk_fma_f32 v[252:253], v[34:35], v[96:97], v[252:253] op_sel:[0,0,0] op_sel_hi:[1,0,1]
  v_pk_fma_f32 v[252:253], v[34:35], v[96:97], v[252:253] op_sel:[1,1,0] op_sel_hi:[0,1,1] neg_hi:[1,0,0]
  v_pk_fma_f32 v[72:73], v[176:177], v[250:251], v[72:73] op_sel:[0,0,0] op_sel_hi:[1,0,1]
  v_pk_fma_f32 v[74:75], v[178:179], v[250:251], v[74:75] op_sel:[0,0,0] op_sel_hi:[1,0,1]
  v_pk_fma_f32 v[76:77], v[180:181], v[250:251], v[76:77] op_sel:[0,0,0] op_sel_hi:[1,0,1]
  v_pk_fma_f32 v[78:79], v[182:183], v[250:251], v[78:79] op_sel:[0,0,0] op_sel_hi:[1,0,1]
  buffer_load_dwordx4 a[152:155], v2, s[52:55], s34 offen offset:2048 sc1
  v_pk_fma_f32 v[72:73], v[184:185], v[250:251], v[72:73] op_sel:[0,1,0] op_sel_hi:[1,1,1]
  v_pk_fma_f32 v[74:75], v[186:187], v[250:251], v[74:75] op_sel:[0,1,0] op_sel_hi:[1,1,1]
  v_pk_fma_f32 v[76:77], v[188:189], v[250:251], v[76:77] op_sel:[0,1,0] op_sel_hi:[1,1,1]
  v_pk_fma_f32 v[78:79], v[190:191], v[250:251], v[78:79] op_sel:[0,1,0] op_sel_hi:[1,1,1]
  v_cvt_pk_bf16_f32 v124, v72, v73
  v_cvt_pk_bf16_f32 v125, v74, v75
  v_cvt_pk_bf16_f32 v126, v76, v77
  v_cvt_pk_bf16_f32 v127, v78, v79
  ds_write_b128 v254, v[124:127]
  buffer_load_dwordx4 a[156:159], v2, s[52:55], s34 offen offset:3072 sc1
  ds_read_b64_tr_b16 v[76:77], v255
  ds_read_b64_tr_b16 v[78:79], v255 offset:640
  s_waitcnt lgkmcnt(9)
  v_pk_fma_f32 v[80:81], v[104:105], v[252:253], v[80:81] op_sel:[0,0,0] op_sel_hi:[1,0,1]
  v_pk_fma_f32 v[82:83], v[106:107], v[252:253], v[82:83] op_sel:[0,0,0] op_sel_hi:[1,0,1]
  v_pk_fma_f32 v[84:85], v[108:109], v[252:253], v[84:85] op_sel:[0,0,0] op_sel_hi:[1,0,1]
  v_pk_fma_f32 v[86:87], v[110:111], v[252:253], v[86:87] op_sel:[0,0,0] op_sel_hi:[1,0,1]
  s_add_u32 s34, s34, 4096
  buffer_load_dwordx4 a[160:163], v2, s[52:55], s34 offen offset:0 sc1
  v_pk_fma_f32 v[80:81], v[112:113], v[252:253], v[80:81] op_sel:[0,1,0] op_sel_hi:[1,1,1]
  v_pk_fma_f32 v[82:83], v[114:115], v[252:253], v[82:83] op_sel:[0,1,0] op_sel_hi:[1,1,1]
  v_pk_fma_f32 v[84:85], v[116:117], v[252:253], v[84:85] op_sel:[0,1,0] op_sel_hi:[1,1,1]
  v_pk_fma_f32 v[86:87], v[118:119], v[252:253], v[86:87] op_sel:[0,1,0] op_sel_hi:[1,1,1]
  v_cvt_pk_bf16_f32 v120, v80, v81
  v_cvt_pk_bf16_f32 v121, v82, v83
  v_cvt_pk_bf16_f32 v122, v84, v85
  v_cvt_pk_bf16_f32 v123, v86, v87
  ds_write_b128 v254, v[120:123]
  buffer_load_dwordx4 a[164:167], v2, s[52:55], s34 offen offset:1024 sc1
  ds_read_b64_tr_b16 v[84:85], v255
  ds_read_b64_tr_b16 v[86:87], v255 offset:640
  v_accvgpr_read_b32 v246, a204
  v_accvgpr_read_b32 v247, a205
  v_accvgpr_read_b32 v248, a206
  v_accvgpr_read_b32 v249, a207
  v_accvgpr_read_b32 v250, a208
  v_accvgpr_read_b32 v251, a209
  v_accvgpr_read_b32 v252, a210
  v_accvgpr_read_b32 v44, a211
  v_accvgpr_read_b32 v45, a212
  v_accvgpr_read_b32 v46, a213
  v_accvgpr_read_b32 v244, a214
  ds_read_b64 v[88:89], v247 offset:1536
  ds_read_b64 v[90:91], v247 offset:1024
  ds_read_b64 v[92:93], v247 offset:512
  ds_read_b64 v[94:95], v247 offset:0
  ds_read_b64 v[96:97], v248
  s_waitcnt lgkmcnt(5)
  s_bitcmp1_b32 s1, 0
  s_cbranch_scc1 type_36
  ds_read2_b32 v[156:157], v235 offset0:176 offset1:177
  ds_read2_b32 v[158:159], v235 offset0:178 offset1:179
  ds_read_b128 v[160:163], v240 offset:3776
  ds_read2_b32 v[152:153], v235 offset0:48 offset1:49
  ds_read2_b32 v[154:155], v235 offset0:50 offset1:51
  ds_read_b128 v[164:167], v240 offset:3264
  ds_read2_b32 v[148:149], v234 offset0:176 offset1:177
  ds_read2_b32 v[150:151], v234 offset0:178 offset1:179
  s_waitcnt lgkmcnt(5)
  v_mfma_f32_16x16x32_bf16 v[220:223], v[156:159], v[160:163], v[220:223]
  ds_read_b128 v[168:171], v240 offset:2752
  s_waitcnt lgkmcnt(4)
  v_mfma_f32_16x16x32_bf16 v[216:219], v[152:155], v[160:163], v[216:219]
  ds_read2_b32 v[144:145], v234 offset0:48 offset1:49
  ds_read2_b32 v[146:147], v234 offset0:50 offset1:51
  s_waitcnt lgkmcnt(5)
  v_mfma_f32_16x16x32_bf16 v[220:223], v[152:155], v[164:167], v[220:223]
  ds_read_b128 v[172:175], v240 offset:2240
  s_waitcnt lgkmcnt(4)
  v_mfma_f32_16x16x32_bf16 v[212:215], v[148:151], v[160:163], v[212:215]
  ds_read2_b32 v[140:141], v233 offset0:176 offset1:177
  ds_read2_b32 v[142:143], v233 offset0:178 offset1:179
  s_add_u32 s13, s79, 0
  buffer_store_dwordx4 v[60:63], v47, s[60:63], s13 offen sc1
  v_mfma_f32_16x16x32_bf16 v[216:219], v[148:151], v[164:167], v[216:219]
  ds_read_b128 v[176:179], v240 offset:1728
  s_waitcnt lgkmcnt(6)
  v_mfma_f32_16x16x32_bf16 v[220:223], v[148:151], v[168:171], v[220:223]
  ds_read2_b32 v[136:137], v233 offset0:48 offset1:49
  ds_read2_b32 v[138:139], v233 offset0:50 offset1:51
  s_waitcnt lgkmcnt(6)
  v_mfma_f32_16x16x32_bf16 v[208:211], v[144:147], v[160:163], v[208:211]
  ds_read_b128 v[180:183], v240 offset:1216
  v_mfma_f32_16x16x32_bf16 v[212:215], v[144:147], v[164:167], v[212:215]
  ds_read2_b32 v[132:133], v232 offset0:176 offset1:177
  ds_read2_b32 v[134:135], v232 offset0:178 offset1:179
  s_add_u32 s13, s80, 0
  buffer_store_dwordx4 v[68:71], v47, s[60:63], s13 offen sc1
  v_mfma_f32_16x16x32_bf16 v[216:219], v[144:147], v[168:171], v[216:219]
  s_waitcnt lgkmcnt(8)
  v_mfma_f32_16x16x32_bf16 v[220:223], v[144:147], v[172:175], v[220:223]
  s_waitcnt lgkmcnt(6)
  v_mfma_f32_16x16x32_bf16 v[204:207], v[140:143], v[160:163], v[204:207]
  v_mfma_f32_16x16x32_bf16 v[208:211], v[140:143], v[164:167], v[208:211]
  v_mfma_f32_16x16x32_bf16 v[212:215], v[140:143], v[168:171], v[212:215]
  s_add_u32 s13, s81, 0
  buffer_store_dwordx4 v[76:79], v47, s[60:63], s13 offen sc1
  v_mfma_f32_16x16x32_bf16 v[216:219], v[140:143], v[172:175], v[216:219]
  ds_read_b128 v[184:187], v240 offset:704
  s_waitcnt lgkmcnt(6)
  v_mfma_f32_16x16x32_bf16 v[220:223], v[140:143], v[176:179], v[220:223]
  ds_read2_b32 v[128:129], v232 offset0:48 offset1:49
  ds_read2_b32 v[130:131], v232 offset0:50 offset1:51
  s_waitcnt lgkmcnt(6)
  v_mfma_f32_16x16x32_bf16 v[200:203], v[136:139], v[160:163], v[200:203]
  v_mfma_f32_16x16x32_bf16 v[204:207], v[136:139], v[164:167], v[204:207]
  s_add_u32 s13, s82, 0
  buffer_store_dwordx4 v[84:87], v47, s[60:63], s13 offen sc1
  v_mfma_f32_16x16x32_bf16 v[208:211], v[136:139], v[168:171], v[208:211]
  v_mfma_f32_16x16x32_bf16 v[212:215], v[136:139], v[172:175], v[212:215]
  v_mfma_f32_16x16x32_bf16 v[216:219], v[136:139], v[176:179], v[216:219]
  s_waitcnt lgkmcnt(5)
  v_mfma_f32_16x16x32_bf16 v[220:223], v[136:139], v[180:183], v[220:223]
  s_waitcnt lgkmcnt(3)
  v_mfma_f32_16x16x32_bf16 v[196:199], v[132:135], v[160:163], v[196:199]
  ds_read_b128 v[188:191], v240 offset:192
  v_mfma_f32_16x16x32_bf16 v[200:203], v[132:135], v[164:167], v[200:203]
  ds_read2_b32 v[156:157], v239 offset0:128 offset1:129
  ds_read2_b32 v[158:159], v239 offset0:130 offset1:131
  v_mfma_f32_16x16x32_bf16 v[204:207], v[132:135], v[168:171], v[204:207]
  ds_read2_b32 v[152:153], v239 offset0:0 offset1:1
  ds_read2_b32 v[154:155], v239 offset0:2 offset1:3
  v_mfma_f32_16x16x32_bf16 v[208:211], v[132:135], v[172:175], v[208:211]
  ds_read2_b32 v[148:149], v238 offset0:128 offset1:129
  ds_read2_b32 v[150:151], v238 offset0:130 offset1:131
  v_mfma_f32_16x16x32_bf16 v[212:215], v[132:135], v[176:179], v[212:215]
  ds_read2_b32 v[144:145], v238 offset0:0 offset1:1
  ds_read2_b32 v[146:147], v238 offset0:2 offset1:3
  v_mfma_f32_16x16x32_bf16 v[216:219], v[132:135], v[180:183], v[216:219]
  buffer_load_dwordx4 a[168:171], v2, s[52:55], s34 offen offset:2048 sc1
  s_waitcnt lgkmcnt(11)
  v_mfma_f32_16x16x32_bf16 v[220:223], v[132:135], v[184:187], v[220:223]
  ds_read2_b32 v[140:141], v237 offset0:128 offset1:129
  ds_read2_b32 v[142:143], v237 offset0:130 offset1:131
  s_waitcnt lgkmcnt(11)
  v_mfma_f32_16x16x32_bf16 v[192:195], v[128:131], v[160:163], v[192:195]
  ds_read_b128 v[160:163], v241 offset:3584
  v_mfma_f32_16x16x32_bf16 v[196:199], v[128:131], v[164:167], v[196:199]
  ds_read_b128 v[164:167], v241 offset:3072
  v_mfma_f32_16x16x32_bf16 v[200:203], v[128:131], v[168:171], v[200:203]
  ds_read2_b32 v[136:137], v237 offset0:0 offset1:1
  ds_read2_b32 v[138:139], v237 offset0:2 offset1:3
  v_mfma_f32_16x16x32_bf16 v[204:207], v[128:131], v[172:175], v[204:207]
  ds_read_b128 v[168:171], v241 offset:2560
  buffer_load_dwordx4 a[172:175], v2, s[52:55], s34 offen offset:3072 sc1
  v_mfma_f32_16x16x32_bf16 v[208:211], v[128:131], v[176:179], v[208:211]
  ds_read_b128 v[172:175], v241 offset:2048
  v_mfma_f32_16x16x32_bf16 v[212:215], v[128:131], v[180:183], v[212:215]
  ds_read_b128 v[176:179], v241 offset:1536
  v_mfma_f32_16x16x32_bf16 v[216:219], v[128:131], v[184:187], v[216:219]
  ds_read2_b32 v[132:133], v236 offset0:128 offset1:129
  ds_read2_b32 v[134:135], v236 offset0:130 offset1:131
  s_waitcnt lgkmcnt(15)
  v_mfma_f32_16x16x32_bf16 v[220:223], v[128:131], v[188:191], v[220:223]
  ds_read_b128 v[180:183], v241 offset:1024
  s_add_u32 s34, s34, 4096
  buffer_load_dwordx4 a[176:179], v2, s[52:55], s34 offen offset:0 sc1
  s_waitcnt lgkmcnt(9)
  v_mfma_f32_16x16x32_bf16 v[116:119], v[156:159], v[160:163], 0
  ds_read_b128 v[184:187], v241 offset:512
  s_waitcnt lgkmcnt(9)
  v_mfma_f32_16x16x32_bf16 v[116:119], v[152:155], v[164:167], v[116:119]
  ds_read2_b32 v[128:129], v236 offset0:0 offset1:1
  ds_read2_b32 v[130:131], v236 offset0:2 offset1:3
  s_waitcnt lgkmcnt(8)
  v_mfma_f32_16x16x32_bf16 v[116:119], v[148:151], v[168:171], v[116:119]
  v_mfma_f32_16x16x32_bf16 v[112:115], v[144:147], v[160:163], 0
  ds_read_b128 v[188:191], v241 offset:0
  s_waitcnt lgkmcnt(8)
  v_mfma_f32_16x16x32_bf16 v[116:119], v[144:147], v[172:175], v[116:119]
  ds_read2_b32 v[156:157], v239 offset0:144 offset1:145
  ds_read2_b32 v[158:159], v239 offset0:146 offset1:147
  v_mfma_f32_16x16x32_bf16 v[112:115], v[140:143], v[164:167], v[112:115]
  ds_read2_b32 v[152:153], v239 offset0:16 offset1:17
  ds_read2_b32 v[154:155], v239 offset0:18 offset1:19
  s_waitcnt lgkmcnt(11)
  v_mfma_f32_16x16x32_bf16 v[116:119], v[140:143], v[176:179], v[116:119]
  ds_read2_b32 v[148:149], v238 offset0:144 offset1:145
  ds_read2_b32 v[150:151], v238 offset0:146 offset1:147
  v_mfma_f32_16x16x32_bf16 v[108:111], v[136:139], v[160:163], 0
  ds_read2_b32 v[144:145], v238 offset0:16 offset1:17
  ds_read2_b32 v[146:147], v238 offset0:18 offset1:19
  buffer_load_dwordx4 a[180:183], v2, s[52:55], s34 offen offset:1024 sc1
  s_bitcmp0_b32 s7, 0
  s_cbranch_scc1 skip_38
  v_swap_b32 v192, v208
  v_swap_b32 v193, v209
  v_swap_b32 v194, v210
  v_swap_b32 v195, v211
  v_swap_b32 v196, v212
  v_swap_b32 v197, v213
  v_swap_b32 v198, v214
  v_swap_b32 v199, v215
  v_swap_b32 v200, v216
  v_swap_b32 v201, v217
  v_swap_b32 v202, v218
  v_swap_b32 v203, v219
  v_swap_b32 v204, v220
  v_swap_b32 v205, v221
  v_swap_b32 v206, v222
  v_swap_b32 v207, v223
skip_38:
  v_mfma_f32_16x16x32_bf16 v[112:115], v[136:139], v[168:171], v[112:115]
  buffer_load_dwordx4 a[184:187], v2, s[52:55], s34 offen offset:2048 sc1
  s_waitcnt lgkmcnt(12)
  v_mfma_f32_16x16x32_bf16 v[116:119], v[136:139], v[180:183], v[116:119]
  ds_read2_b32 v[140:141], v237 offset0:144 offset1:145
  ds_read2_b32 v[142:143], v237 offset0:146 offset1:147
  v_mfma_f32_16x16x32_bf16 v[104:107], v[132:135], v[160:163], 0
  ds_read_b128 v[160:163], v241 offset:3648
  v_mfma_f32_16x16x32_bf16 v[108:111], v[132:135], v[164:167], v[108:111]
  ds_read2_b32 v[136:137], v237 offset0:16 offset1:17
  ds_read2_b32 v[138:139], v237 offset0:18 offset1:19
  ds_write_b128 v249, v[208:211] offset:0
  v_mfma_f32_16x16x32_bf16 v[112:115], v[132:135], v[172:175], v[112:115]
  ds_read_b128 v[172:175], v241 offset:2112
  s_waitcnt lgkmcnt(15)
  v_mfma_f32_16x16x32_bf16 v[116:119], v[132:135], v[184:187], v[116:119]
  ds_read_b128 v[180:183], v241 offset:1088
  v_mfma_f32_16x16x32_bf16 v[104:107], v[128:131], v[164:167], v[104:107]
  ds_read_b128 v[164:167], v241 offset:3136
  v_mfma_f32_16x16x32_bf16 v[108:111], v[128:131], v[168:171], v[108:111]
  ds_read2_b32 v[132:133], v236 offset0:144 offset1:145
  ds_read2_b32 v[134:135], v236 offset0:146 offset1:147
  buffer_load_dwordx4 a[188:191], v2, s[52:55], s34 offen offset:3072 sc1
  s_waitcnt vmcnt(6)
  s_add_u32 s14, s84, 4352
  v_mov_b32 v15, s8
  s_mov_b64 exec, 1
  s_cmp_eq_u32 s9, 0
  s_cbranch_scc1 slow_39
  buffer_store_dword v15, off, s[52:55], s14
back_40:
  s_mov_b64 exec, -1
  ds_write_b128 v249, v[212:215] offset:1024
  s_mov_b32 s92, 24576
  buffer_load_dwordx4 v[120:123], v2, s[52:55], s92 offen sc1
  v_mfma_f32_16x16x32_bf16 v[112:115], v[128:131], v[176:179], v[112:115]
  ds_read_b128 v[168:171], v241 offset:2624
  v_mfma_f32_16x16x32_bf16 v[116:119], v[128:131], v[188:191], v[116:119]
  ds_read_b128 v[176:179], v241 offset:1600
  s_waitcnt lgkmcnt(11)
  v_mfma_f32_16x16x32_bf16 v[116:119], v[156:159], v[160:163], v[116:119]
  ds_read_b128 v[184:187], v241 offset:576
  s_waitcnt lgkmcnt(6)
  v_mfma_f32_16x16x32_bf16 v[116:119], v[152:155], v[164:167], v[116:119]
  ds_read2_b32 v[128:129], v236 offset0:16 offset1:17
  ds_read2_b32 v[130:131], v236 offset0:18 offset1:19
  ds_write_b128 v249, v[216:219] offset:2048
  s_barrier
  s_waitcnt lgkmcnt(5)
  v_mfma_f32_16x16x32_bf16 v[116:119], v[148:151], v[168:171], v[116:119]
  s_add_u32 s34, s34, 4096
  buffer_load_dwordx4 a[192:195], v2, s[52:55], s34 offen offset:0 sc1
  v_mfma_f32_16x16x32_bf16 v[112:115], v[144:147], v[160:163], v[112:115]
  ds_read_b128 v[188:191], v241 offset:64
  v_mfma_f32_16x16x32_bf16 v[116:119], v[144:147], v[172:175], v[116:119]
  ds_write_b128 v249, v[220:223] offset:3072
  v_mfma_f32_16x16x32_bf16 v[112:115], v[140:143], v[164:167], v[112:115]
  s_waitcnt lgkmcnt(6)
  v_mfma_f32_16x16x32_bf16 v[116:119], v[140:143], v[176:179], v[116:119]
  buffer_load_dwordx4 a[196:199], v2, s[52:55], s34 offen offset:1024 sc1
  v_mfma_f32_16x16x32_bf16 v[108:111], v[136:139], v[160:163], v[108:111]
  v_mfma_f32_16x16x32_bf16 v[112:115], v[136:139], v[168:171], v[112:115]
  v_mfma_f32_16x16x32_bf16 v[116:119], v[136:139], v[180:183], v[116:119]
  v_mfma_f32_16x16x32_bf16 v[104:107], v[132:135], v[160:163], v[104:107]
  buffer_load_dwordx2 v[42:43], v244, s[52:55], s49 offen sc1
  v_mfma_f32_16x16x32_bf16 v[108:111], v[132:135], v[164:167], v[108:111]
  v_mfma_f32_16x16x32_bf16 v[112:115], v[132:135], v[172:175], v[112:115]
  s_waitcnt lgkmcnt(5)
  v_mfma_f32_16x16x32_bf16 v[116:119], v[132:135], v[184:187], v[116:119]
  s_waitcnt lgkmcnt(3)
  v_mfma_f32_16x16x32_bf16 v[104:107], v[128:131], v[164:167], v[104:107]
  v_mfma_f32_16x16x32_bf16 v[108:111], v[128:131], v[168:171], v[108:111]
  v_mfma_f32_16x16x32_bf16 v[112:115], v[128:131], v[176:179], v[112:115]
  s_waitcnt lgkmcnt(1)
  v_mfma_f32_16x16x32_bf16 v[116:119], v[128:131], v[188:191], v[116:119]
  s_branch join_37
type_36:
  ds_read2_b32 v[156:157], v235 offset0:176 offset1:177
  ds_read2_b32 v[158:159], v235 offset0:178 offset1:179
  ds_read_b128 v[160:163], v240 offset:3776
  ds_read2_b32 v[152:153], v235 offset0:48 offset1:49
  ds_read2_b32 v[154:155], v235 offset0:50 offset1:51
  ds_read_b128 v[164:167], v240 offset:3264
  ds_read2_b32 v[148:149], v234 offset0:176 offset1:177
  ds_read2_b32 v[150:151], v234 offset0:178 offset1:179
  s_waitcnt lgkmcnt(5)
  v_mfma_f32_16x16x32_bf16 v[220:223], v[156:159], v[160:163], v[220:223]
  ds_read_b128 v[168:171], v240 offset:2752
  s_waitcnt lgkmcnt(4)
  v_mfma_f32_16x16x32_bf16 v[216:219], v[152:155], v[160:163], v[216:219]
  ds_read2_b32 v[144:145], v234 offset0:48 offset1:49
  ds_read2_b32 v[146:147], v234 offset0:50 offset1:51
  s_waitcnt lgkmcnt(5)
  v_mfma_f32_16x16x32_bf16 v[220:223], v[152:155], v[164:167], v[220:223]
  ds_read_b128 v[172:175], v240 offset:2240
  s_waitcnt lgkmcnt(4)
  v_mfma_f32_16x16x32_bf16 v[212:215], v[148:151], v[160:163], v[212:215]
  ds_read2_b32 v[140:141], v233 offset0:176 offset1:177
  ds_read2_b32 v[142:143], v233 offset0:178 offset1:179
  s_add_u32 s13, s79, 0
  buffer_store_dwordx4 v[60:63], v47, s[60:63], s13 offen sc1
  v_mfma_f32_16x16x32_bf16 v[216:219], v[148:151], v[164:167], v[216:219]
  ds_read_b128 v[176:179], v240 offset:1728
  s_waitcnt lgkmcnt(6)
  v_mfma_f32_16x16x32_bf16 v[220:223], v[148:151], v[168:171], v[220:223]
  ds_read2_b32 v[136:137], v233 offset0:48 offset1:49
  ds_read2_b32 v[138:139], v233 offset0:50 offset1:51
  s_waitcnt lgkmcnt(6)
  v_mfma_f32_16x16x32_bf16 v[208:211], v[144:147], v[160:163], v[208:211]
  ds_read_b128 v[180:183], v240 offset:1216
  v_mfma_f32_16x16x32_bf16 v[212:215], v[144:147], v[164:167], v[212:215]
  ds_read2_b32 v[132:133], v232 offset0:176 offset1:177
  ds_read2_b32 v[134:135], v232 offset0:178 offset1:179
  s_add_u32 s13, s80, 0
  buffer_store_dwordx4 v[68:71], v47, s[60:63], s13 offen sc1
  v_mfma_f32_16x16x32_bf16 v[216:219], v[144:147], v[168:171], v[216:219]
  s_waitcnt lgkmcnt(8)
  v_mfma_f32_16x16x32_bf16 v[220:223], v[144:147], v[172:175], v[220:223]
  s_waitcnt lgkmcnt(6)
  v_mfma_f32_16x16x32_bf16 v[204:207], v[140:143], v[160:163], v[204:207]
  v_mfma_f32_16x16x32_bf16 v[208:211], v[140:143], v[164:167], v[208:211]
  v_mfma_f32_16x16x32_bf16 v[212:215], v[140:143], v[168:171], v[212:215]
  s_add_u32 s13, s81, 0
  buffer_store_dwordx4 v[76:79], v47, s[60:63], s13 offen sc1
  v_mfma_f32_16x16x32_bf16 v[216:219], v[140:143], v[172:175], v[216:219]
  ds_read_b128 v[184:187], v240 offset:704
  s_waitcnt lgkmcnt(6)
  v_mfma_f32_16x16x32_bf16 v[220:223], v[140:143], v[176:179], v[220:223]
  ds_read2_b32 v[128:129], v232 offset0:48 offset1:49
  ds_read2_b32 v[130:131], v232 offset0:50 offset1:51
  s_waitcnt lgkmcnt(6)
  v_mfma_f32_16x16x32_bf16 v[200:203], v[136:139], v[160:163], v[200:203]
  v_mfma_f32_16x16x32_bf16 v[204:207], v[136:139], v[164:167], v[204:207]
  s_add_u32 s13, s82, 0
  buffer_store_dwordx4 v[84:87], v47, s[60:63], s13 offen sc1
  v_mfma_f32_16x16x32_bf16 v[208:211], v[136:139], v[168:171], v[208:211]
  v_mfma_f32_16x16x32_bf16 v[212:215], v[136:139], v[172:175], v[212:215]
  v_mfma_f32_16x16x32_bf16 v[216:219], v[136:139], v[176:179], v[216:219]
  s_waitcnt lgkmcnt(5)
  v_mfma_f32_16x16x32_bf16 v[220:223], v[136:139], v[180:183], v[220:223]
  s_waitcnt lgkmcnt(3)
  v_mfma_f32_16x16x32_bf16 v[196:199], v[132:135], v[160:163], v[196:199]
  ds_read_b128 v[188:191], v240 offset:192
  v_mfma_f32_16x16x32_bf16 v[200:203], v[132:135], v[164:167], v[200:203]
  ds_read2_b32 v[152:153], v239 offset0:0 offset1:1
  ds_read2_b32 v[154:155], v239 offset0:2 offset1:3
  v_mfma_f32_16x16x32_bf16 v[204:207], v[132:135], v[168:171], v[204:207]
  ds_read2_b32 v[148:149], v238 offset0:128 offset1:129
  ds_read2_b32 v[150:151], v238 offset0:130 offset1:131
  v_mfma_f32_16x16x32_bf16 v[208:211], v[132:135], v[172:175], v[208:211]
  buffer_load_dwordx4 a[168:171], v2, s[52:55], s34 offen offset:2048 sc1
  v_mfma_f32_16x16x32_bf16 v[212:215], v[132:135], v[176:179], v[212:215]
  ds_read2_b32 v[144:145], v238 offset0:0 offset1:1
  ds_read2_b32 v[146:147], v238 offset0:2 offset1:3
  v_mfma_f32_16x16x32_bf16 v[216:219], v[132:135], v[180:183], v[216:219]
  s_waitcnt lgkmcnt(9)
  v_mfma_f32_16x16x32_bf16 v[220:223], v[132:135], v[184:187], v[220:223]
  ds_read2_b32 v[140:141], v237 offset0:128 offset1:129
  ds_read2_b32 v[142:143], v237 offset0:130 offset1:131
  s_waitcnt lgkmcnt(9)
  v_mfma_f32_16x16x32_bf16 v[192:195], v[128:131], v[160:163], v[192:195]
  ds_read_b128 v[160:163], v241 offset:3584
  v_mfma_f32_16x16x32_bf16 v[196:199], v[128:131], v[164:167], v[196:199]
  ds_read_b128 v[164:167], v241 offset:3072
  v_mfma_f32_16x16x32_bf16 v[200:203], v[128:131], v[168:171], v[200:203]
  ds_read_b128 v[168:171], v241 offset:2560
  v_mfma_f32_16x16x32_bf16 v[204:207], v[128:131], v[172:175], v[204:207]
  ds_read2_b32 v[136:137], v237 offset0:0 offset1:1
  ds_read2_b32 v[138:139], v237 offset0:2 offset1:3
  buffer_load_dwordx4 a[172:175], v2, s[52:55], s34 offen offset:3072 sc1
  v_mfma_f32_16x16x32_bf16 v[208:211], v[128:131], v[176:179], v[208:211]
  ds_read_b128 v[172:175], v241 offset:2048
  v_mfma_f32_16x16x32_bf16 v[212:215], v[128:131], v[180:183], v[212:215]
  ds_read_b128 v[176:179], v241 offset:1536
  v_mfma_f32_16x16x32_bf16 v[216:219], v[128:131], v[184:187], v[216:219]
  ds_read2_b32 v[132:133], v236 offset0:128 offset1:129
  ds_read2_b32 v[134:135], v236 offset0:130 offset1:131
  s_waitcnt lgkmcnt(15)
  v_mfma_f32_16x16x32_bf16 v[220:223], v[128:131], v[188:191], v[220:223]
  ds_read_b128 v[180:183], v241 offset:1024
  s_add_u32 s34, s34, 4096
  buffer_load_dwordx4 a[176:179], v2, s[52:55], s34 offen offset:0 sc1
  s_waitcnt lgkmcnt(9)
  v_mfma_f32_16x16x32_bf16 v[116:119], v[152:155], v[160:163], 0
  ds_read2_b32 v[128:129], v236 offset0:0 offset1:1
  ds_read2_b32 v[130:131], v236 offset0:2 offset1:3
  v_mfma_f32_16x16x32_bf16 v[112:115], v[148:151], v[160:163], 0
  s_waitcnt lgkmcnt(10)
  v_mfma_f32_16x16x32_bf16 v[116:119], v[148:151], v[164:167], v[116:119]
  v_mfma_f32_16x16x32_bf16 v[112:115], v[144:147], v[164:167], v[112:115]
  ds_read_b128 v[184:187], v241 offset:512
  s_waitcnt lgkmcnt(10)
  v_mfma_f32_16x16x32_bf16 v[116:119], v[144:147], v[168:171], v[116:119]
  ds_read2_b32 v[152:153], v239 offset0:16 offset1:17
  ds_read2_b32 v[154:155], v239 offset0:18 offset1:19
  v_mfma_f32_16x16x32_bf16 v[108:111], v[140:143], v[160:163], 0
  ds_read2_b32 v[148:149], v238 offset0:144 offset1:145
  ds_read2_b32 v[150:151], v238 offset0:146 offset1:147
  v_mfma_f32_16x16x32_bf16 v[112:115], v[140:143], v[168:171], v[112:115]
  buffer_load_dwordx4 a[180:183], v2, s[52:55], s34 offen offset:1024 sc1
  s_waitcnt lgkmcnt(11)
  v_mfma_f32_16x16x32_bf16 v[116:119], v[140:143], v[172:175], v[116:119]
  ds_read2_b32 v[144:145], v238 offset0:16 offset1:17
  ds_read2_b32 v[146:147], v238 offset0:18 offset1:19
  s_bitcmp0_b32 s7, 0
  s_cbranch_scc1 skip_41
  v_swap_b32 v192, v208
  v_swap_b32 v193, v209
  v_swap_b32 v194, v210
  v_swap_b32 v195, v211
  v_swap_b32 v196, v212
  v_swap_b32 v197, v213
  v_swap_b32 v198, v214
  v_swap_b32 v199, v215
  v_swap_b32 v200, v216
  v_swap_b32 v201, v217
  v_swap_b32 v202, v218
  v_swap_b32 v203, v219
  v_swap_b32 v204, v220
  v_swap_b32 v205, v221
  v_swap_b32 v206, v222
  v_swap_b32 v207, v223
skip_41:
  v_mfma_f32_16x16x32_bf16 v[108:111], v[136:139], v[164:167], v[108:111]
  ds_read_b128 v[164:167], v241 offset:3136
  v_mfma_f32_16x16x32_bf16 v[112:115], v[136:139], v[172:175], v[112:115]
  ds_read2_b32 v[140:141], v237 offset0:144 offset1:145
  ds_read2_b32 v[142:143], v237 offset0:146 offset1:147
  s_waitcnt lgkmcnt(15)
  v_mfma_f32_16x16x32_bf16 v[116:119], v[136:139], v[176:179], v[116:119]
  buffer_load_dwordx4 a[184:187], v2, s[52:55], s34 offen offset:2048 sc1
  s_waitcnt lgkmcnt(13)
  v_mfma_f32_16x16x32_bf16 v[108:111], v[132:135], v[168:171], v[108:111]
  ds_read_b128 v[168:171], v241 offset:2624
  ds_write_b128 v249, v[208:211] offset:0
  v_mfma_f32_16x16x32_bf16 v[112:115], v[132:135], v[176:179], v[112:115]
  ds_read2_b32 v[136:137], v237 offset0:16 offset1:17
  ds_read2_b32 v[138:139], v237 offset0:18 offset1:19
  s_waitcnt lgkmcnt(15)
  v_mfma_f32_16x16x32_bf16 v[116:119], v[132:135], v[180:183], v[116:119]
  buffer_load_dwordx4 a[188:191], v2, s[52:55], s34 offen offset:3072 sc1
  s_waitcnt vmcnt(6)
  s_add_u32 s14, s84, 4352
  v_mov_b32 v15, s8
  s_mov_b64 exec, 1
  s_cmp_eq_u32 s9, 0
  s_cbranch_scc1 slow_42
  buffer_store_dword v15, off, s[52:55], s14
back_43:
  s_mov_b64 exec, -1
  s_waitcnt lgkmcnt(14)
  v_mfma_f32_16x16x32_bf16 v[104:107], v[128:131], v[160:163], 0
  ds_read_b128 v[160:163], v241 offset:3648
  v_mfma_f32_16x16x32_bf16 v[108:111], v[128:131], v[172:175], v[108:111]
  ds_read_b128 v[176:179], v241 offset:1600
  ds_write_b128 v249, v[212:215] offset:1024
  s_mov_b32 s92, 24576
  buffer_load_dwordx4 v[120:123], v2, s[52:55], s92 offen sc1
  v_mfma_f32_16x16x32_bf16 v[112:115], v[128:131], v[180:183], v[112:115]
  ds_read_b128 v[172:175], v241 offset:2112
  s_waitcnt lgkmcnt(15)
  v_mfma_f32_16x16x32_bf16 v[116:119], v[128:131], v[184:187], v[116:119]
  ds_read2_b32 v[132:133], v236 offset0:144 offset1:145
  ds_read2_b32 v[134:135], v236 offset0:146 offset1:147
  s_waitcnt lgkmcnt(5)
  v_mfma_f32_16x16x32_bf16 v[116:119], v[152:155], v[160:163], v[116:119]
  ds_read_b128 v[180:183], v241 offset:1088
  v_mfma_f32_16x16x32_bf16 v[112:115], v[148:151], v[160:163], v[112:115]
  ds_read2_b32 v[128:129], v236 offset0:16 offset1:17
  ds_read2_b32 v[130:131], v236 offset0:18 offset1:19
  ds_write_b128 v249, v[216:219] offset:2048
  s_barrier
  v_mfma_f32_16x16x32_bf16 v[116:119], v[148:151], v[164:167], v[116:119]
  s_add_u32 s34, s34, 4096
  buffer_load_dwordx4 a[192:195], v2, s[52:55], s34 offen offset:0 sc1
  v_mfma_f32_16x16x32_bf16 v[112:115], v[144:147], v[164:167], v[112:115]
  ds_read_b128 v[184:187], v241 offset:576
  v_mfma_f32_16x16x32_bf16 v[116:119], v[144:147], v[168:171], v[116:119]
  ds_write_b128 v249, v[220:223] offset:3072
  v_mfma_f32_16x16x32_bf16 v[108:111], v[140:143], v[160:163], v[108:111]
  v_mfma_f32_16x16x32_bf16 v[112:115], v[140:143], v[168:171], v[112:115]
  buffer_load_dwordx4 a[196:199], v2, s[52:55], s34 offen offset:1024 sc1
  s_waitcnt lgkmcnt(8)
  v_mfma_f32_16x16x32_bf16 v[116:119], v[140:143], v[172:175], v[116:119]
  v_mfma_f32_16x16x32_bf16 v[108:111], v[136:139], v[164:167], v[108:111]
  v_mfma_f32_16x16x32_bf16 v[112:115], v[136:139], v[172:175], v[112:115]
  v_mfma_f32_16x16x32_bf16 v[116:119], v[136:139], v[176:179], v[116:119]
  buffer_load_dwordx2 v[42:43], v244, s[52:55], s49 offen sc1
  s_waitcnt lgkmcnt(6)
  v_mfma_f32_16x16x32_bf16 v[108:111], v[132:135], v[168:171], v[108:111]
  v_mfma_f32_16x16x32_bf16 v[112:115], v[132:135], v[176:179], v[112:115]
  s_waitcnt lgkmcnt(5)
  v_mfma_f32_16x16x32_bf16 v[116:119], v[132:135], v[180:183], v[116:119]
  s_waitcnt lgkmcnt(3)
  v_mfma_f32_16x16x32_bf16 v[104:107], v[128:131], v[160:163], v[104:107]
  v_mfma_f32_16x16x32_bf16 v[108:111], v[128:131], v[172:175], v[108:111]
  v_mfma_f32_16x16x32_bf16 v[112:115], v[128:131], v[180:183], v[112:115]
  s_waitcnt lgkmcnt(1)
  v_mfma_f32_16x16x32_bf16 v[116:119], v[128:131], v[184:187], v[116:119]
join_37:
  s_nop 3
  ds_write_b128 v252, v[104:107] offset:0
  ds_write_b128 v252, v[108:111] offset:1024
  ds_write_b128 v252, v[112:115] offset:2048
  s_nop 0
  ds_write_b128 v252, v[116:119] offset:3072
  v_dot2_f32_bf16 v192, v89, s31, v192
  v_dot2_f32_bf16 v193, v89, s30, v193
  v_dot2_f32_bf16 v194, v88, s31, v194
  v_dot2_f32_bf16 v195, v88, s30, v195
  v_dot2_f32_bf16 v196, v91, s31, v196
  v_dot2_f32_bf16 v197, v91, s30, v197
  v_dot2_f32_bf16 v198, v90, s31, v198
  v_dot2_f32_bf16 v199, v90, s30, v199
  v_dot2_f32_bf16 v200, v93, s31, v200
  v_dot2_f32_bf16 v201, v93, s30, v201
  v_dot2_f32_bf16 v202, v92, s31, v202
  v_dot2_f32_bf16 v203, v92, s30, v203
  v_dot2_f32_bf16 v204, v95, s31, v204
  v_dot2_f32_bf16 v205, v95, s30, v205
  v_dot2_f32_bf16 v206, v94, s31, v206
  v_dot2_f32_bf16 v207, v94, s30, v207
  s_waitcnt vmcnt(3)
  v_min3_u32 v15, v120, v121, s8
  v_max3_u32 v14, v120, v121, s8
  v_min3_u32 v15, v15, v122, v123
  v_max3_u32 v14, v14, v122, v123
  v_cmp_ne_u32 vcc, v15, v14
  s_cbranch_vccnz again_44
ok_45:
  s_waitcnt vmcnt(0)
  v_xor_b32 v15, s8, v42
  v_xor_b32 v14, s8, v43
  v_or_b32 v15, v15, v14
  v_cmp_ne_u32 vcc, 0, v15
  s_cbranch_vccz ok_47
again_46:
  buffer_load_dwordx2 v[42:43], v244, s[52:55], s49 offen sc1
  s_sub_u32 s10, s10, 1
  s_cmp_gt_i32 s10, 0
  s_waitcnt vmcnt(0)
  v_xor_b32 v15, s8, v42
  v_xor_b32 v14, s8, v43
  v_or_b32 v15, v15, v14
  v_cmp_ne_u32 vcc, 0, v15
  s_cbranch_scc0 out_48
  s_cbranch_vccnz again_46
out_48:
ok_47:
  buffer_load_dwordx4 v[128:131], v2, s[60:63], s16 offen offset:0 sc1
  buffer_load_dwordx4 v[132:135], v2, s[60:63], s16 offen offset:1024 sc1
  buffer_load_dwordx4 v[136:139], v2, s[60:63], s16 offen offset:2048 sc1
  buffer_load_dwordx4 v[140:143], v2, s[60:63], s16 offen offset:3072 sc1
  s_add_u32 s16, s16, 4096
  buffer_load_dwordx4 v[144:147], v2, s[60:63], s16 offen offset:0 sc1
  buffer_load_dwordx4 v[148:151], v2, s[60:63], s16 offen offset:1024 sc1
  buffer_load_dwordx4 v[152:155], v2, s[60:63], s16 offen offset:2048 sc1
  buffer_load_dwordx4 v[156:159], v2, s[60:63], s16 offen offset:3072 sc1
  s_waitcnt lgkmcnt(0)
  s_barrier
  ds_read_b128 v[208:211], v250 offset:0
  ds_read_b128 v[212:215], v250 offset:1024
  ds_read_b128 v[216:219], v250 offset:2048
  ds_read_b128 v[220:223], v250 offset:3072
  ds_read_b128 v[224:227], v251 offset:0
  ds_read_b128 v[228:231], v251 offset:4096
  ds_read_b128 v[232:235], v251 offset:8192
  ds_read_b128 v[236:239], v251 offset:12288
  s_waitcnt vmcnt(7)
  v_mfma_f32_16x16x32_bf16 v[48:51], a[0:3], v[128:131], 0
  s_add_u32 s16, s16, 4096
  buffer_load_dwordx4 v[160:163], v2, s[60:63], s16 offen offset:0 sc1
  s_waitcnt lgkmcnt(0)
  v_mfma_f32_16x16x32_bf16 v[52:55], a[4:7], v[128:131], 0
  v_add_f32 v208, v192, v208
  v_add_f32_e64 v209, v193, v209
  v_mfma_f32_16x16x32_bf16 v[56:59], a[8:11], v[128:131], 0
  v_add_f32 v210, v194, v210
  v_add_f32 v211, v195, v211
  v_mfma_f32_16x16x32_bf16 v[60:63], a[12:15], v[128:131], 0
  v_cvt_pk_bf16_f32 v208, v208, v209
  v_cvt_pk_bf16_f32 v209, v210, v211
  v_mfma_f32_16x16x32_bf16 v[64:67], a[16:19], v[128:131], 0
  buffer_store_dwordx2 v[208:209], v246, s[52:55], s50 offen offset:0 sc1
  s_waitcnt vmcnt(8)
  v_mfma_f32_16x16x32_bf16 v[48:51], a[20:23], v[132:135], v[48:51]
  buffer_load_dwordx4 v[164:167], v2, s[60:63], s16 offen offset:1024 sc1
  v_add_f32 v212, v196, v212
  v_mfma_f32_16x16x32_bf16 v[52:55], a[24:27], v[132:135], v[52:55]
  v_add_f32 v213, v197, v213
  v_add_f32 v214, v198, v214
  v_mfma_f32_16x16x32_bf16 v[56:59], a[28:31], v[132:135], v[56:59]
  v_add_f32_e64 v215, v199, v215
  v_cvt_pk_bf16_f32 v212, v212, v213
  v_mfma_f32_16x16x32_bf16 v[60:63], a[32:35], v[132:135], v[60:63]
  v_cvt_pk_bf16_f32 v213, v214, v215
  buffer_store_dwordx2 v[212:213], v246, s[52:55], s50 offen offset:512 sc1
  v_mfma_f32_16x16x32_bf16 v[64:67], a[36:39], v[132:135], v[64:67]
  v_add_f32 v216, v200, v216
  s_waitcnt vmcnt(9)
  v_mfma_f32_16x16x32_bf16 v[48:51], a[40:43], v[136:139], v[48:51]
  buffer_load_dwordx4 v[168:171], v2, s[60:63], s17 offen offset:0 sc1
  v_add_f32_e64 v217, v201, v217
  v_mfma_f32_16x16x32_bf16 v[52:55], a[44:47], v[136:139], v[52:55]
  v_add_f32 v218, v202, v218
  v_add_f32 v219, v203, v219
  v_mfma_f32_16x16x32_bf16 v[56:59], a[48:51], v[136:139], v[56:59]
  v_cvt_pk_bf16_f32 v216, v216, v217
  v_cvt_pk_bf16_f32 v217, v218, v219
  v_mfma_f32_16x16x32_bf16 v[60:63], a[52:55], v[136:139], v[60:63]
  buffer_store_dwordx2 v[216:217], v246, s[52:55], s50 offen offset:1024 sc1
  v_add_f32_e64 v220, v204, v220
  v_mfma_f32_16x16x32_bf16 v[64:67], a[56:59], v[136:139], v[64:67]
  v_add_f32 v221, v205, v221
  s_waitcnt vmcnt(10)
  v_mfma_f32_16x16x32_bf16 v[48:51], a[60:63], v[140:143], v[48:51]
  buffer_load_dwordx4 v[172:175], v2, s[60:63], s17 offen offset:1024 sc1
  v_add_f32_e64 v222, v206, v222
  v_mfma_f32_16x16x32_bf16 v[52:55], a[64:67], v[140:143], v[52:55]
  v_add_f32_e64 v223, v207, v223
  v_cvt_pk_bf16_f32 v220, v220, v221
  v_mfma_f32_16x16x32_bf16 v[56:59], a[68:71], v[140:143], v[56:59]
  v_cvt_pk_bf16_f32 v221, v222, v223
  buffer_store_dwordx2 v[220:221], v246, s[52:55], s50 offen offset:1536 sc1
  v_mfma_f32_16x16x32_bf16 v[60:63], a[72:75], v[140:143], v[60:63]
  v_dot2_f32_bf16 v224, v97, s45, v224
  v_dot2_f32_bf16 v225, v97, s25, v225
  v_mfma_f32_16x16x32_bf16 v[64:67], a[76:79], v[140:143], v[64:67]
  v_dot2_f32_bf16 v226, v96, s45, v226
  s_waitcnt vmcnt(11)
  v_mfma_f32_16x16x32_bf16 v[48:51], a[80:83], v[144:147], v[48:51]
  buffer_load_dwordx4 v[176:179], v2, s[60:63], s17 offen offset:2048 sc1
  v_dot2_f32_bf16 v227, v96, s25, v227
  v_mfma_f32_16x16x32_bf16 v[52:55], a[84:87], v[144:147], v[52:55]
  v_add_f32 v228, v228, v232
  v_add_f32_e64 v229, v229, v233
  v_mfma_f32_16x16x32_bf16 v[56:59], a[88:91], v[144:147], v[56:59]
  v_add_f32 v230, v230, v234
  v_add_f32 v231, v231, v235
  v_mfma_f32_16x16x32_bf16 v[60:63], a[92:95], v[144:147], v[60:63]
  v_add_f32 v224, v224, v236
  v_add_f32 v225, v225, v237
  v_mfma_f32_16x16x32_bf16 v[64:67], a[96:99], v[144:147], v[64:67]
  v_add_f32 v226, v226, v238
  s_waitcnt vmcnt(11)
  v_mfma_f32_16x16x32_bf16 v[48:51], a[100:103], v[148:151], v[48:51]
  buffer_load_dwordx4 v[180:183], v2, s[60:63], s17 offen offset:3072 sc1
  v_add_f32_e64 v227, v227, v239
  v_mfma_f32_16x16x32_bf16 v[52:55], a[104:107], v[148:151], v[52:55]
  v_add_f32 v224, v224, v228
  v_add_f32 v225, v225, v229
  v_mfma_f32_16x16x32_bf16 v[56:59], a[108:111], v[148:151], v[56:59]
  v_add_f32 v226, v226, v230
  v_add_f32 v227, v227, v231
  v_mfma_f32_16x16x32_bf16 v[60:63], a[112:115], v[148:151], v[60:63]
  v_cvt_pk_bf16_f32 v224, v224, v225
  v_cvt_pk_bf16_f32 v225, v226, v227
  v_mfma_f32_16x16x32_bf16 v[64:67], a[116:119], v[148:151], v[64:67]
  buffer_store_dwordx2 v[224:225], v246, s[52:55], s51 offen sc1
  s_waitcnt vmcnt(12)
  v_mfma_f32_16x16x32_bf16 v[48:51], a[120:123], v[152:155], v[48:51]
  s_add_u32 s17, s17, 4096
  buffer_load_dwordx4 v[184:187], v2, s[60:63], s17 offen offset:0 sc1
  s_barrier
  v_mfma_f32_16x16x32_bf16 v[52:55], a[124:127], v[152:155], v[52:55]
  v_accvgpr_read_b32 v102, a226
  v_accvgpr_read_b32 v103, a227
  v_mfma_f32_16x16x32_bf16 v[56:59], a[128:131], v[152:155], v[56:59]
  v_mul_f32_e64 v102, v102, v103
  v_accvgpr_read_b32 v98, a216
  v_mfma_f32_16x16x32_bf16 v[60:63], a[132:135], v[152:155], v[60:63]
  v_accvgpr_read_b32 v100, a230
  v_accvgpr_read_b32 v99, a217
  v_mfma_f32_16x16x32_bf16 v[64:67], a[136:139], v[152:155], v[64:67]
  v_accvgpr_read_b32 v101, a231
  v_lshlrev_b32 v108, 16, v98
  s_waitcnt vmcnt(12)
  v_mfma_f32_16x16x32_bf16 v[48:51], a[140:143], v[156:159], v[48:51]
  buffer_load_dwordx4 v[188:191], v2, s[60:63], s17 offen offset:1024 sc1
  v_and_b32 v109, 0xffff0000, v98
  v_mfma_f32_16x16x32_bf16 v[52:55], a[144:147], v[156:159], v[52:55]
  v_lshlrev_b32_e64 v110, 16, v99
  v_and_b32 v111, 0xffff0000, v99
  v_mfma_f32_16x16x32_bf16 v[56:59], a[148:151], v[156:159], v[56:59]
  v_lshlrev_b32_e64 v92, 16, v100
  v_and_b32 v93, 0xffff0000, v100
  v_mfma_f32_16x16x32_bf16 v[60:63], a[152:155], v[156:159], v[60:63]
  v_lshlrev_b32_e64 v94, 16, v101
  v_and_b32 v95, 0xffff0000, v101
  v_mfma_f32_16x16x32_bf16 v[64:67], a[156:159], v[156:159], v[64:67]
  v_fma_f32 v88, v108, v103, -v102
  s_waitcnt vmcnt(12)
  v_mfma_f32_16x16x32_bf16 v[48:51], a[160:163], v[160:163], v[48:51]
  buffer_load_dwordx4 v[128:131], v2, s[60:63], s17 offen offset:2048 sc1
  v_fma_f32 v89, v109, v103, -v102
  v_mfma_f32_16x16x32_bf16 v[52:55], a[164:167], v[160:163], v[52:55]
  v_fma_f32 v90, v110, v103, -v102
  v_fma_f32 v91, v111, v103, -v102
  v_mfma_f32_16x16x32_bf16 v[56:59], a[168:171], v[160:163], v[56:59]
  v_fmac_f32 v108, v88, v92
  v_fmac_f32_e64 v109, v89, v93
  v_mfma_f32_16x16x32_bf16 v[60:63], a[172:175], v[160:163], v[60:63]
  v_fmac_f32 v110, v90, v94
  v_fmac_f32 v111, v91, v95
  v_mfma_f32_16x16x32_bf16 v[64:67], a[176:179], v[160:163], v[64:67]
  v_accvgpr_read_b32 v98, a218
  s_waitcnt vmcnt(11)
  v_mfma_f32_16x16x32_bf16 v[48:51], a[180:183], v[164:167], v[48:51]
  buffer_load_dwordx4 v[132:135], v2, s[60:63], s17 offen offset:3072 sc1
  v_accvgpr_read_b32 v100, a232
  v_mfma_f32_16x16x32_bf16 v[52:55], a[184:187], v[164:167], v[52:55]
  v_accvgpr_read_b32 v99, a219
  v_accvgpr_read_b32 v101, a233
  v_mfma_f32_16x16x32_bf16 v[56:59], a[188:191], v[164:167], v[56:59]
  v_lshlrev_b32 v112, 16, v98
  v_and_b32 v113, 0xffff0000, v98
  v_mfma_f32_16x16x32_bf16 v[60:63], a[192:195], v[164:167], v[60:63]
  v_lshlrev_b32_e64 v114, 16, v99
  v_and_b32 v115, 0xffff0000, v99
  v_mfma_f32_16x16x32_bf16 v[64:67], a[196:199], v[164:167], v[64:67]
  v_lshlrev_b32 v92, 16, v100
  s_waitcnt vmcnt(10)
  v_mfma_f32_16x16x32_bf16 v[68:71], a[0:3], v[168:171], 0
  s_add_u32 s17, s17, 4096
  buffer_load_dwordx4 v[136:139], v2, s[60:63], s17 offen offset:0 sc1
  v_and_b32 v93, 0xffff0000, v100
  v_mfma_f32_16x16x32_bf16 v[72:75], a[4:7], v[168:171], 0
  v_lshlrev_b32_e64 v94, 16, v101
  v_and_b32 v95, 0xffff0000, v101
  v_mfma_f32_16x16x32_bf16 v[76:79], a[8:11], v[168:171], 0
  v_fma_f32 v88, v112, v103, -v102
  v_fma_f32 v89, v113, v103, -v102
  v_mfma_f32_16x16x32_bf16 v[80:83], a[12:15], v[168:171], 0
  v_fma_f32 v90, v114, v103, -v102
  v_fma_f32 v91, v115, v103, -v102
  v_mfma_f32_16x16x32_bf16 v[84:87], a[16:19], v[168:171], 0
  v_fmac_f32 v112, v88, v92
  s_waitcnt vmcnt(9)
  v_mfma_f32_16x16x32_bf16 v[68:71], a[20:23], v[172:175], v[68:71]
  ds_write_b128 v44, v[48:51] offset:0
  ds_write_b128 v44, v[52:55] offset:1024
  buffer_load_dwordx4 v[140:143], v2, s[60:63], s17 offen offset:1024 sc1
  v_mfma_f32_16x16x32_bf16 v[72:75], a[24:27], v[172:175], v[72:75]
  v_fmac_f32 v113, v89, v93
  v_fmac_f32 v114, v90, v94
  v_mfma_f32_16x16x32_bf16 v[76:79], a[28:31], v[172:175], v[76:79]
  v_fmac_f32_e64 v115, v91, v95
  v_accvgpr_read_b32 v98, a220
  v_mfma_f32_16x16x32_bf16 v[80:83], a[32:35], v[172:175], v[80:83]
  v_accvgpr_read_b32 v100, a234
  v_accvgpr_read_b32 v99, a221
  v_mfma_f32_16x16x32_bf16 v[84:87], a[36:39], v[172:175], v[84:87]
  v_accvgpr_read_b32 v101, a235
  v_lshlrev_b32 v116, 16, v98
  s_waitcnt vmcnt(8)
  v_mfma_f32_16x16x32_bf16 v[68:71], a[40:43], v[176:179], v[68:71]
  ds_write_b128 v44, v[56:59] offset:2048
  ds_write_b128 v44, v[60:63] offset:3072
  buffer_load_dwordx4 v[144:147], v2, s[60:63], s18 offen offset:0 sc1
  v_mfma_f32_16x16x32_bf16 v[72:75], a[44:47], v[176:179], v[72:75]
  v_and_b32 v117, 0xffff0000, v98
  v_lshlrev_b32_e64 v118, 16, v99
  v_mfma_f32_16x16x32_bf16 v[76:79], a[48:51], v[176:179], v[76:79]
  v_and_b32 v119, 0xffff0000, v99
  v_lshlrev_b32_e64 v92, 16, v100
  v_mfma_f32_16x16x32_bf16 v[80:83], a[52:55], v[176:179], v[80:83]
  v_and_b32 v93, 0xffff0000, v100
  v_lshlrev_b32_e64 v94, 16, v101
  v_mfma_f32_16x16x32_bf16 v[84:87], a[56:59], v[176:179], v[84:87]
  v_and_b32 v95, 0xffff0000, v101
  v_fma_f32 v88, v116, v103, -v102
  s_waitcnt vmcnt(8)
  v_mfma_f32_16x16x32_bf16 v[68:71], a[60:63], v[180:183], v[68:71]
  ds_write_b128 v44, v[64:67] offset:4096
  buffer_load_dwordx4 v[148:151], v2, s[60:63], s18 offen offset:1024 sc1
  v_mfma_f32_16x16x32_bf16 v[72:75], a[64:67], v[180:183], v[72:75]
  v_fma_f32 v89, v117, v103, -v102
  v_fma_f32 v90, v118, v103, -v102
  v_mfma_f32_16x16x32_bf16 v[76:79], a[68:71], v[180:183], v[76:79]
  v_fma_f32 v91, v119, v103, -v102
  v_fmac_f32 v116, v88, v92
  v_mfma_f32_16x16x32_bf16 v[80:83], a[72:75], v[180:183], v[80:83]
  v_fmac_f32 v117, v89, v93
  v_fmac_f32 v118, v90, v94
  v_mfma_f32_16x16x32_bf16 v[84:87], a[76:79], v[180:183], v[84:87]
  v_fmac_f32_e64 v119, v91, v95
  v_accvgpr_read_b32 v98, a222
  s_waitcnt vmcnt(7)
  v_mfma_f32_16x16x32_bf16 v[68:71], a[80:83], v[184:187], v[68:71]
  buffer_load_dwordx4 v[152:155], v2, s[60:63], s18 offen offset:2048 sc1
  v_accvgpr_read_b32 v100, a236
  v_mfma_f32_16x16x32_bf16 v[72:75], a[84:87], v[184:187], v[72:75]
  v_accvgpr_read_b32 v99, a223
  v_accvgpr_read_b32 v101, a237
  v_mfma_f32_16x16x32_bf16 v[76:79], a[88:91], v[184:187], v[76:79]
  v_lshlrev_b32 v120, 16, v98
  v_and_b32 v121, 0xffff0000, v98
  v_mfma_f32_16x16x32_bf16 v[80:83], a[92:95], v[184:187], v[80:83]
  v_lshlrev_b32_e64 v122, 16, v99
  v_and_b32 v123, 0xffff0000, v99
  v_mfma_f32_16x16x32_bf16 v[84:87], a[96:99], v[184:187], v[84:87]
  v_lshlrev_b32 v92, 16, v100
  s_waitcnt vmcnt(7)
  v_mfma_f32_16x16x32_bf16 v[68:71], a[100:103], v[188:191], v[68:71]
  buffer_load_dwordx4 v[156:159], v2, s[60:63], s18 offen offset:3072 sc1
  v_and_b32 v93, 0xffff0000, v100
  v_mfma_f32_16x16x32_bf16 v[72:75], a[104:107], v[188:191], v[72:75]
  v_lshlrev_b32_e64 v94, 16, v101
  v_and_b32 v95, 0xffff0000, v101
  v_mfma_f32_16x16x32_bf16 v[76:79], a[108:111], v[188:191], v[76:79]
  v_fma_f32 v88, v120, v103, -v102
  v_fma_f32 v89, v121, v103, -v102
  v_mfma_f32_16x16x32_bf16 v[80:83], a[112:115], v[188:191], v[80:83]
  v_fma_f32 v90, v122, v103, -v102
  v_fma_f32 v91, v123, v103, -v102
  v_mfma_f32_16x16x32_bf16 v[84:87], a[116:119], v[188:191], v[84:87]
  v_fmac_f32 v120, v88, v92
  s_waitcnt vmcnt(7)
  v_mfma_f32_16x16x32_bf16 v[68:71], a[120:123], v[128:131], v[68:71]
  s_add_u32 s18, s18, 4096
  buffer_load_dwordx4 v[160:163], v2, s[60:63], s18 offen offset:0 sc1
  v_fmac_f32 v121, v89, v93
  v_fmac_f32 v122, v90, v94
  v_mfma_f32_16x16x32_bf16 v[72:75], a[124:127], v[128:131], v[72:75]
  v_fmac_f32_e64 v123, v91, v95
  v_accvgpr_read_b32 v98, a224
  v_accvgpr_read_b32 v100, a238
  v_mfma_f32_16x16x32_bf16 v[76:79], a[128:131], v[128:131], v[76:79]
  v_accvgpr_read_b32 v99, a225
  v_accvgpr_read_b32 v101, a239
  v_mfma_f32_16x16x32_bf16 v[80:83], a[132:135], v[128:131], v[80:83]
  v_lshlrev_b32_e64 v124, 16, v98
  s_mul_i32 s15, s7, 10240
  v_mfma_f32_16x16x32_bf16 v[84:87], a[136:139], v[128:131], v[84:87]
  s_add_u32 s15, s15, 102400
  v_add_u32 v47, s15, v2
  s_waitcnt vmcnt(7)
  v_mfma_f32_16x16x32_bf16 v[68:71], a[140:143], v[132:135], v[68:71]
  buffer_load_dwordx4 v[164:167], v2, s[60:63], s18 offen offset:1024 sc1
  v_and_b32 v125, 0xffff0000, v98
  v_mfma_f32_16x16x32_bf16 v[72:75], a[144:147], v[132:135], v[72:75]
  v_lshlrev_b32_e64 v126, 16, v99
  v_and_b32 v127, 0xffff0000, v99
  v_mfma_f32_16x16x32_bf16 v[76:79], a[148:151], v[132:135], v[76:79]
  v_lshlrev_b32_e64 v92, 16, v100
  v_and_b32 v93, 0xffff0000, v100
  v_mfma_f32_16x16x32_bf16 v[80:83], a[152:155], v[132:135], v[80:83]
  v_lshlrev_b32_e64 v94, 16, v101
  v_and_b32 v95, 0xffff0000, v101
  v_mfma_f32_16x16x32_bf16 v[84:87], a[156:159], v[132:135], v[84:87]
  v_fma_f32 v88, v124, v103, -v102
  s_waitcnt vmcnt(7)
  v_mfma_f32_16x16x32_bf16 v[68:71], a[160:163], v[136:139], v[68:71]
  buffer_load_dwordx4 v[168:171], v2, s[60:63], s18 offen offset:2048 sc1
  v_fma_f32 v89, v125, v103, -v102
  v_mfma_f32_16x16x32_bf16 v[72:75], a[164:167], v[136:139], v[72:75]
  v_fma_f32 v90, v126, v103, -v102
  v_fma_f32 v91, v127, v103, -v102
  v_mfma_f32_16x16x32_bf16 v[76:79], a[168:171], v[136:139], v[76:79]
  v_fmac_f32 v124, v88, v92
  v_fmac_f32_e64 v125, v89, v93
  v_mfma_f32_16x16x32_bf16 v[80:83], a[172:175], v[136:139], v[80:83]
  v_fmac_f32_e64 v126, v90, v94
  v_mfma_f32_16x16x32_bf16 v[84:87], a[176:179], v[136:139], v[84:87]
  v_fmac_f32 v127, v91, v95
  s_waitcnt vmcnt(7)
  v_mfma_f32_16x16x32_bf16 v[68:71], a[180:183], v[140:143], v[68:71]
  buffer_load_dwordx4 v[172:175], v2, s[60:63], s18 offen offset:3072 sc1
  v_mfma_f32_16x16x32_bf16 v[72:75], a[184:187], v[140:143], v[72:75]
  v_mfma_f32_16x16x32_bf16 v[76:79], a[188:191], v[140:143], v[76:79]
  v_mfma_f32_16x16x32_bf16 v[80:83], a[192:195], v[140:143], v[80:83]
  v_mfma_f32_16x16x32_bf16 v[84:87], a[196:199], v[140:143], v[84:87]
  s_waitcnt vmcnt(7)
  v_mfma_f32_16x16x32_bf16 v[48:51], a[0:3], v[144:147], 0
  s_add_u32 s18, s18, 4096
  buffer_load_dwordx4 v[176:179], v2, s[60:63], s18 offen offset:0 sc1
  v_mfma_f32_16x16x32_bf16 v[52:55], a[4:7], v[144:147], 0
  v_mfma_f32_16x16x32_bf16 v[56:59], a[8:11], v[144:147], 0
  v_mfma_f32_16x16x32_bf16 v[60:63], a[12:15], v[144:147], 0
  v_mfma_f32_16x16x32_bf16 v[64:67], a[16:19], v[144:147], 0
  s_waitcnt vmcnt(7)
  v_mfma_f32_16x16x32_bf16 v[48:51], a[20:23], v[148:151], v[48:51]
  ds_write_b128 v45, v[68:71] offset:0
  v_mfma_f32_16x16x32_bf16 v[52:55], a[24:27], v[148:151], v[52:55]
  ds_write_b128 v45, v[72:75] offset:1024
  v_mfma_f32_16x16x32_bf16 v[56:59], a[28:31], v[148:151], v[56:59]
  buffer_load_dwordx4 v[180:183], v2, s[60:63], s18 offen offset:1024 sc1
  v_mfma_f32_16x16x32_bf16 v[60:63], a[32:35], v[148:151], v[60:63]
  v_mfma_f32_16x16x32_bf16 v[64:67], a[36:39], v[148:151], v[64:67]
  s_waitcnt vmcnt(7)
  v_mfma_f32_16x16x32_bf16 v[48:51], a[40:43], v[152:155], v[48:51]
  ds_write_b128 v45, v[76:79] offset:2048
  v_mfma_f32_16x16x32_bf16 v[52:55], a[44:47], v[152:155], v[52:55]
  ds_write_b128 v45, v[80:83] offset:3072
  v_mfma_f32_16x16x32_bf16 v[56:59], a[48:51], v[152:155], v[56:59]
  buffer_load_dwordx4 v[184:187], v2, s[60:63], s19 offen offset:0 sc1
  v_mfma_f32_16x16x32_bf16 v[60:63], a[52:55], v[152:155], v[60:63]
  v_mfma_f32_16x16x32_bf16 v[64:67], a[56:59], v[152:155], v[64:67]
  s_waitcnt vmcnt(7)
  v_mfma_f32_16x16x32_bf16 v[48:51], a[60:63], v[156:159], v[48:51]
  ds_write_b128 v45, v[84:87] offset:4096
  v_mfma_f32_16x16x32_bf16 v[52:55], a[64:67], v[156:159], v[52:55]
  buffer_load_dwordx4 v[188:191], v2, s[60:63], s19 offen offset:1024 sc1
  v_mfma_f32_16x16x32_bf16 v[56:59], a[68:71], v[156:159], v[56:59]
  v_mfma_f32_16x16x32_bf16 v[60:63], a[72:75], v[156:159], v[60:63]
  v_mfma_f32_16x16x32_bf16 v[64:67], a[76:79], v[156:159], v[64:67]
  s_waitcnt vmcnt(7)
  v_mfma_f32_16x16x32_bf16 v[48:51], a[80:83], v[160:163], v[48:51]
  buffer_load_dwordx4 v[128:131], v2, s[60:63], s19 offen offset:2048 sc1
  s_waitcnt lgkmcnt(0)
  s_barrier
  v_mfma_f32_16x16x32_bf16 v[52:55], a[84:87], v[160:163], v[52:55]
  ds_read_b128 v[192:195], v47 offset:0
  ds_read_b128 v[196:199], v47 offset:1024
  v_mfma_f32_16x16x32_bf16 v[56:59], a[88:91], v[160:163], v[56:59]
  ds_read_b128 v[200:203], v47 offset:2048
  ds_read_b128 v[204:207], v47 offset:3072
  v_mfma_f32_16x16x32_bf16 v[60:63], a[92:95], v[160:163], v[60:63]
  ds_read_b128 v[208:211], v47 offset:4096
  ds_read_b128 v[212:215], v47 offset:5120
  v_mfma_f32_16x16x32_bf16 v[64:67], a[96:99], v[160:163], v[64:67]
  ds_read_b128 v[216:219], v47 offset:6144
  ds_read_b128 v[220:223], v47 offset:7168
  s_waitcnt vmcnt(7)
  v_mfma_f32_16x16x32_bf16 v[48:51], a[100:103], v[164:167], v[48:51]
  buffer_load_dwordx4 v[132:135], v2, s[60:63], s19 offen offset:3072 sc1
  ds_read_b128 v[224:227], v47 offset:8192
  v_mfma_f32_16x16x32_bf16 v[52:55], a[104:107], v[164:167], v[52:55]
  ds_read_b128 v[228:231], v47 offset:9216
  s_waitcnt lgkmcnt(5)
  v_mfma_f32_16x16x32_bf16 v[56:59], a[108:111], v[164:167], v[56:59]
  v_add_f32 v108, v108, v192
  v_add_f32_e64 v109, v109, v193
  v_mfma_f32_16x16x32_bf16 v[60:63], a[112:115], v[164:167], v[60:63]
  v_add_f32 v110, v110, v194
  v_add_f32 v111, v111, v195
  v_mfma_f32_16x16x32_bf16 v[64:67], a[116:119], v[164:167], v[64:67]
  v_add_f32 v112, v112, v196
  v_add_f32 v113, v113, v197
  s_waitcnt vmcnt(7)
  v_mfma_f32_16x16x32_bf16 v[48:51], a[120:123], v[168:171], v[48:51]
  s_add_u32 s19, s19, 4096
  buffer_load_dwordx4 v[136:139], v2, s[60:63], s19 offen offset:0 sc1
  v_add_f32 v114, v114, v198
  v_mfma_f32_16x16x32_bf16 v[52:55], a[124:127], v[168:171], v[52:55]
  v_add_f32 v115, v115, v199
  v_add_f32 v116, v116, v200
  v_mfma_f32_16x16x32_bf16 v[56:59], a[128:131], v[168:171], v[56:59]
  v_add_f32 v117, v117, v201
  v_add_f32 v118, v118, v202
  v_mfma_f32_16x16x32_bf16 v[60:63], a[132:135], v[168:171], v[60:63]
  v_add_f32 v119, v119, v203
  v_add_f32 v120, v120, v204
  v_mfma_f32_16x16x32_bf16 v[64:67], a[136:139], v[168:171], v[64:67]
  v_add_f32 v121, v121, v205
  v_add_f32 v122, v122, v206
  s_waitcnt vmcnt(7)
  v_mfma_f32_16x16x32_bf16 v[48:51], a[140:143], v[172:175], v[48:51]
  buffer_load_dwordx4 v[140:143], v2, s[60:63], s19 offen offset:1024 sc1
  s_mul_i32 s93, s6, 327680
  s_lshl_b32 s12, s5, 7
  s_add_u32 s93, s93, s12
  v_mfma_f32_16x16x32_bf16 v[52:55], a[144:147], v[172:175], v[52:55]
  s_lshr_b32 s12, s7, 1
  s_mul_i32 s94, s12, 5120
  s_add_u32 s94, s94, 143360
  s_lshl_b32 s12, s12, 6
  v_mfma_f32_16x16x32_bf16 v[56:59], a[148:151], v[172:175], v[56:59]
  s_add_u32 s93, s93, s12
  s_add_u32 s93, s93, 19922944
  s_mov_b32 s92, s93
  v_add_f32 v123, v123, v207
  v_mfma_f32_16x16x32_bf16 v[60:63], a[152:155], v[172:175], v[60:63]
  v_add_f32 v124, v124, v208
  v_add_f32 v125, v125, v209
  v_add_f32 v126, v126, v210
  v_add_f32 v127, v127, v211
  v_mfma_f32_16x16x32_bf16 v[64:67], a[156:159], v[172:175], v[64:67]
  s_waitcnt lgkmcnt(0)
  v_add_f32 v108, v108, v212
  v_add_f32 v109, v109, v213
  v_add_f32 v110, v110, v214
  s_waitcnt vmcnt(7)
  v_mfma_f32_16x16x32_bf16 v[48:51], a[160:163], v[176:179], v[48:51]
  buffer_load_dwordx4 v[144:147], v2, s[60:63], s19 offen offset:2048 sc1
  s_and_b32 s12, s7, 1
  s_mul_i32 s13, s12, 196608
  s_add_u32 s93, s93, s13
  s_mul_i32 s13, s12, 3072
  v_mfma_f32_16x16x32_bf16 v[52:55], a[164:167], v[176:179], v[52:55]
  s_add_u32 s95, s94, s13
  s_lshl_b32 s12, s12, 3
  s_add_u32 s94, s94, s12
  v_lshrrev_b32_e64 v252, 2, v1
  v_mfma_f32_16x16x32_bf16 v[56:59], a[168:171], v[176:179], v[56:59]
  v_lshlrev_b32 v252, 12, v252
  v_and_b32 v12, 3, v1
  v_lshl_add_u32 v252, v12, 4, v252
  v_add_f32_e64 v111, v111, v215
  v_mfma_f32_16x16x32_bf16 v[60:63], a[172:175], v[176:179], v[60:63]
  v_add_f32 v112, v112, v216
  v_add_f32 v113, v113, v217
  v_add_f32 v114, v114, v218
  v_add_f32 v115, v115, v219
  v_mfma_f32_16x16x32_bf16 v[64:67], a[176:179], v[176:179], v[64:67]
  v_add_f32 v116, v116, v220
  v_add_f32 v117, v117, v221
  v_add_f32 v118, v118, v222
  v_add_f32 v119, v119, v223
  s_waitcnt vmcnt(7)
  v_mfma_f32_16x16x32_bf16 v[48:51], a[180:183], v[180:183], v[48:51]
  buffer_load_dwordx4 v[148:151], v2, s[60:63], s19 offen offset:3072 sc1
  v_add_f32 v120, v120, v224
  v_mfma_f32_16x16x32_bf16 v[52:55], a[184:187], v[180:183], v[52:55]
  v_add_f32 v121, v121, v225
  v_add_f32 v122, v122, v226
  v_mfma_f32_16x16x32_bf16 v[56:59], a[188:191], v[180:183], v[56:59]
  v_add_f32 v123, v123, v227
  v_add_f32 v124, v124, v228
  v_mfma_f32_16x16x32_bf16 v[60:63], a[192:195], v[180:183], v[60:63]
  v_add_f32 v125, v125, v229
  v_add_f32 v126, v126, v230
  v_mfma_f32_16x16x32_bf16 v[64:67], a[196:199], v[180:183], v[64:67]
  v_add_f32 v127, v127, v231
  s_waitcnt vmcnt(7)
  v_mfma_f32_16x16x32_bf16 v[68:71], a[0:3], v[184:187], v[108:111]
  s_add_u32 s19, s19, 4096
  buffer_load_dwordx4 v[152:155], v2, s[60:63], s19 offen offset:0 sc1
  v_mfma_f32_16x16x32_bf16 v[72:75], a[4:7], v[184:187], v[112:115]
  v_mfma_f32_16x16x32_bf16 v[76:79], a[8:11], v[184:187], v[116:119]
  v_mfma_f32_16x16x32_bf16 v[80:83], a[12:15], v[184:187], v[120:123]
  v_mfma_f32_16x16x32_bf16 v[84:87], a[16:19], v[184:187], v[124:127]
  s_waitcnt vmcnt(7)
  v_mfma_f32_16x16x32_bf16 v[68:71], a[20:23], v[188:191], v[68:71]
  ds_write_b128 v46, v[48:51] offset:0
  v_mfma_f32_16x16x32_bf16 v[72:75], a[24:27], v[188:191], v[72:75]
  ds_write_b128 v46, v[52:55] offset:1024
  v_mfma_f32_16x16x32_bf16 v[76:79], a[28:31], v[188:191], v[76:79]
  buffer_load_dwordx4 v[156:159], v2, s[60:63], s19 offen offset:1024 sc1
  v_mfma_f32_16x16x32_bf16 v[80:83], a[32:35], v[188:191], v[80:83]
  v_mfma_f32_16x16x32_bf16 v[84:87], a[36:39], v[188:191], v[84:87]
  s_waitcnt vmcnt(7)
  v_mfma_f32_16x16x32_bf16 v[68:71], a[40:43], v[128:131], v[68:71]
  ds_write_b128 v46, v[56:59] offset:2048
  v_mfma_f32_16x16x32_bf16 v[72:75], a[44:47], v[128:131], v[72:75]
  ds_write_b128 v46, v[60:63] offset:3072
  v_mfma_f32_16x16x32_bf16 v[76:79], a[48:51], v[128:131], v[76:79]
  s_add_u32 m0, s95, 0
  s_nop 0
  buffer_load_dwordx4 v252, s[52:55], s93 offen sc1 lds
  s_add_u32 s93, s93, 65536
  v_mfma_f32_16x16x32_bf16 v[80:83], a[52:55], v[128:131], v[80:83]
  s_add_u32 m0, s95, 1024
  s_nop 0
  buffer_load_dwordx4 v252, s[52:55], s93 offen sc1 lds
  s_add_u32 s93, s93, 65536
  v_mfma_f32_16x16x32_bf16 v[84:87], a[56:59], v[128:131], v[84:87]
  s_add_u32 m0, s95, 2048
  s_bitcmp1_b32 s7, 0
  s_cselect_b32 s93, 1879048192, s93
  s_cselect_b32 m0, 163840, m0
  s_nop 0
  buffer_load_dwordx4 v252, s[52:55], s93 offen sc1 lds
  s_add_u32 s93, s93, 65536
  s_waitcnt vmcnt(9)
  v_mfma_f32_16x16x32_bf16 v[68:71], a[60:63], v[132:135], v[68:71]
  ds_write_b128 v46, v[64:67] offset:4096
  v_mfma_f32_16x16x32_bf16 v[72:75], a[64:67], v[132:135], v[72:75]
  v_add_u32_e64 v253, s94, v2
  v_mfma_f32_16x16x32_bf16 v[76:79], a[68:71], v[132:135], v[76:79]
  v_mfma_f32_16x16x32_bf16 v[80:83], a[72:75], v[132:135], v[80:83]
  v_mfma_f32_16x16x32_bf16 v[84:87], a[76:79], v[132:135], v[84:87]
  s_waitcnt vmcnt(8)
  v_mfma_f32_16x16x32_bf16 v[68:71], a[80:83], v[136:139], v[68:71]
  s_mul_i32 s15, s7, 5120
  v_mfma_f32_16x16x32_bf16 v[72:75], a[84:87], v[136:139], v[72:75]
  v_add_u32 v47, s15, v2
  v_mfma_f32_16x16x32_bf16 v[76:79], a[88:91], v[136:139], v[76:79]
  v_mfma_f32_16x16x32_bf16 v[80:83], a[92:95], v[136:139], v[80:83]
  v_mfma_f32_16x16x32_bf16 v[84:87], a[96:99], v[136:139], v[84:87]
  s_waitcnt vmcnt(7)
  v_mfma_f32_16x16x32_bf16 v[68:71], a[100:103], v[140:143], v[68:71]
  s_waitcnt lgkmcnt(0)
  s_barrier
  ds_read_b128 v[192:195], v47 offset:0
  v_mfma_f32_16x16x32_bf16 v[72:75], a[104:107], v[140:143], v[72:75]
  ds_read_b128 v[196:199], v47 offset:1024
  v_mfma_f32_16x16x32_bf16 v[76:79], a[108:111], v[140:143], v[76:79]
  ds_read_b128 v[200:203], v47 offset:2048
  v_mfma_f32_16x16x32_bf16 v[80:83], a[112:115], v[140:143], v[80:83]
  ds_read_b128 v[204:207], v47 offset:3072
  v_mfma_f32_16x16x32_bf16 v[84:87], a[116:119], v[140:143], v[84:87]
  ds_read_b128 v[208:211], v47 offset:4096
  s_waitcnt vmcnt(6)
  v_mfma_f32_16x16x32_bf16 v[68:71], a[120:123], v[144:147], v[68:71]
  v_mfma_f32_16x16x32_bf16 v[72:75], a[124:127], v[144:147], v[72:75]
  v_mfma_f32_16x16x32_bf16 v[76:79], a[128:131], v[144:147], v[76:79]
  v_mfma_f32_16x16x32_bf16 v[80:83], a[132:135], v[144:147], v[80:83]
  v_mfma_f32_16x16x32_bf16 v[84:87], a[136:139], v[144:147], v[84:87]
  s_waitcnt vmcnt(5)
  v_mfma_f32_16x16x32_bf16 v[68:71], a[140:143], v[148:151], v[68:71]
  v_mfma_f32_16x16x32_bf16 v[72:75], a[144:147], v[148:151], v[72:75]
  v_mfma_f32_16x16x32_bf16 v[76:79], a[148:151], v[148:151], v[76:79]
  v_mfma_f32_16x16x32_bf16 v[80:83], a[152:155], v[148:151], v[80:83]
  v_mfma_f32_16x16x32_bf16 v[84:87], a[156:159], v[148:151], v[84:87]
  s_waitcnt vmcnt(4)
  v_mfma_f32_16x16x32_bf16 v[68:71], a[160:163], v[152:155], v[68:71]
  v_mfma_f32_16x16x32_bf16 v[72:75], a[164:167], v[152:155], v[72:75]
  v_mfma_f32_16x16x32_bf16 v[76:79], a[168:171], v[152:155], v[76:79]
  v_mfma_f32_16x16x32_bf16 v[80:83], a[172:175], v[152:155], v[80:83]
  v_mfma_f32_16x16x32_bf16 v[84:87], a[176:179], v[152:155], v[84:87]
  s_waitcnt vmcnt(3)
  v_mfma_f32_16x16x32_bf16 v[68:71], a[180:183], v[156:159], v[68:71]
  v_mfma_f32_16x16x32_bf16 v[72:75], a[184:187], v[156:159], v[72:75]
  v_mfma_f32_16x16x32_bf16 v[76:79], a[188:191], v[156:159], v[76:79]
  v_mfma_f32_16x16x32_bf16 v[80:83], a[192:195], v[156:159], v[80:83]
  v_mfma_f32_16x16x32_bf16 v[84:87], a[196:199], v[156:159], v[84:87]
  s_lshl_b32 s12, s5, 15
  s_lshl_b32 s13, s7, 9
  s_add_u32 s12, s12, s13
  s_add_u32 s12, s12, 1310720
  s_lshl_b32 s13, s6, 12
  s_add_u32 s13, s13, s12
  s_waitcnt lgkmcnt(0)
  s_waitcnt vmcnt(0)
  s_barrier
  ds_read_b64_tr_b16 v[232:233], v253 offset:0
  ds_read_b64_tr_b16 v[234:235], v253 offset:1024
  ds_read_b64_tr_b16 v[236:237], v253 offset:2048
  ds_read_b64_tr_b16 v[238:239], v253 offset:3072
  ds_read_b64_tr_b16 v[240:241], v253 offset:4096
  v_accvgpr_read_b32 v244, a243
  v_accvgpr_read_b32 v245, a244
  v_pk_add_f32 v[68:69], v[68:69], v[192:193]
  v_pk_add_f32 v[70:71], v[70:71], v[194:195]
  v_pk_add_f32 v[72:73], v[72:73], v[196:197]
  v_pk_add_f32 v[74:75], v[74:75], v[198:199]
  v_pk_add_f32 v[76:77], v[76:77], v[200:201]
  v_pk_add_f32 v[78:79], v[78:79], v[202:203]
  v_pk_add_f32 v[80:81], v[80:81], v[204:205]
  v_pk_add_f32 v[82:83], v[82:83], v[206:207]
  v_pk_add_f32 v[84:85], v[84:85], v[208:209]
  v_pk_add_f32 v[86:87], v[86:87], v[210:211]
  v_pk_add_f32 v[212:213], v[68:69], v[70:71]
  v_pk_mul_f32 v[214:215], v[68:69], v[68:69]
  v_pk_fma_f32 v[214:215], v[70:71], v[70:71], v[214:215]
  v_pk_add_f32 v[212:213], v[212:213], v[72:73]
  v_pk_fma_f32 v[214:215], v[72:73], v[72:73], v[214:215]
  v_pk_add_f32 v[212:213], v[212:213], v[74:75]
  v_pk_fma_f32 v[214:215], v[74:75], v[74:75], v[214:215]
  v_pk_add_f32 v[212:213], v[212:213], v[76:77]
  v_pk_fma_f32 v[214:215], v[76:77], v[76:77], v[214:215]
  v_pk_add_f32 v[212:213], v[212:213], v[78:79]
  v_pk_fma_f32 v[214:215], v[78:79], v[78:79], v[214:215]
  v_pk_add_f32 v[212:213], v[212:213], v[80:81]
  v_pk_fma_f32 v[214:215], v[80:81], v[80:81], v[214:215]
  v_pk_add_f32 v[212:213], v[212:213], v[82:83]
  v_pk_fma_f32 v[214:215], v[82:83], v[82:83], v[214:215]
  v_pk_add_f32 v[212:213], v[212:213], v[84:85]
  v_pk_fma_f32 v[214:215], v[84:85], v[84:85], v[214:215]
  v_pk_add_f32 v[212:213], v[212:213], v[86:87]
  v_pk_fma_f32 v[214:215], v[86:87], v[86:87], v[214:215]
  s_waitcnt lgkmcnt(0)
  v_pk_max_u16 v15, v232, v233
  v_pk_max_u16 v15, v15, v234
  v_pk_max_u16 v15, v15, v235
  v_pk_max_u16 v15, v15, v236
  v_pk_max_u16 v15, v15, v237
  v_pk_max_u16 v15, v15, v238
  v_pk_max_u16 v15, v15, v239
  v_pk_max_u16 v15, v15, v240
  v_pk_max_u16 v15, v15, v241
  v_lshlrev_b32 v14, 16, v15
  v_max_u32 v15, v15, v14
  v_cmp_le_u32 vcc, 0xffff0000, v15
  s_cbranch_vccnz again_49
ok_50:
  v_lshlrev_b32 v88, 16, v232
  v_and_b32 v89, 0xffff0000, v232
  v_lshlrev_b32_e64 v90, 16, v233
  v_and_b32 v91, 0xffff0000, v233
  s_add_u32 m0, s75, 0
  s_add_u32 s14, s74, 0
  buffer_load_dwordx4 v244, s[56:59], s14 offen lds
  buffer_load_dwordx4 v245, s[56:59], s14 offen offset:2048 lds
  v_pk_mul_f32 v[160:161], v[68:69], v[88:89]
  v_pk_mul_f32 v[226:227], v[88:89], v[88:89]
  v_pk_mul_f32 v[218:219], v[160:161], v[68:69]
  v_pk_mul_f32 v[220:221], v[160:161], v[160:161]
  v_pk_mul_f32 v[222:223], v[160:161], v[88:89]
  v_pk_mul_f32 v[162:163], v[70:71], v[90:91]
  v_pk_add_f32 v[224:225], v[88:89], v[90:91]
  v_pk_fma_f32 v[226:227], v[90:91], v[90:91], v[226:227]
  v_pk_add_f32 v[216:217], v[160:161], v[162:163]
  v_pk_fma_f32 v[218:219], v[162:163], v[70:71], v[218:219]
  v_pk_fma_f32 v[220:221], v[162:163], v[162:163], v[220:221]
  v_pk_fma_f32 v[222:223], v[162:163], v[90:91], v[222:223]
  v_lshlrev_b32_e64 v92, 16, v234
  v_and_b32 v93, 0xffff0000, v234
  v_lshlrev_b32_e64 v94, 16, v235
  v_and_b32 v95, 0xffff0000, v235
  v_pk_mul_f32 v[164:165], v[72:73], v[92:93]
  v_pk_add_f32 v[224:225], v[224:225], v[92:93]
  v_pk_fma_f32 v[226:227], v[92:93], v[92:93], v[226:227]
  v_pk_add_f32 v[216:217], v[216:217], v[164:165]
  v_pk_fma_f32 v[218:219], v[164:165], v[72:73], v[218:219]
  v_pk_fma_f32 v[220:221], v[164:165], v[164:165], v[220:221]
  v_pk_fma_f32 v[222:223], v[164:165], v[92:93], v[222:223]
  v_pk_mul_f32 v[166:167], v[74:75], v[94:95]
  v_pk_add_f32 v[224:225], v[224:225], v[94:95]
  v_pk_fma_f32 v[226:227], v[94:95], v[94:95], v[226:227]
  v_pk_add_f32 v[216:217], v[216:217], v[166:167]
  v_pk_fma_f32 v[218:219], v[166:167], v[74:75], v[218:219]
  v_pk_fma_f32 v[220:221], v[166:167], v[166:167], v[220:221]
  v_pk_fma_f32 v[222:223], v[166:167], v[94:95], v[222:223]
  v_lshlrev_b32_e64 v96, 16, v236
  v_and_b32 v97, 0xffff0000, v236
  v_lshlrev_b32_e64 v98, 16, v237
  v_and_b32 v99, 0xffff0000, v237
  s_add_u32 m0, s75, 4096
  s_add_u32 s14, s74, 20480
  buffer_load_dwordx4 v244, s[56:59], s14 offen lds
  buffer_load_dwordx4 v245, s[56:59], s14 offen offset:2048 lds
  v_pk_mul_f32 v[168:169], v[76:77], v[96:97]
  v_pk_add_f32 v[224:225], v[224:225], v[96:97]
  v_pk_fma_f32 v[226:227], v[96:97], v[96:97], v[226:227]
  v_pk_add_f32 v[216:217], v[216:217], v[168:169]
  v_pk_fma_f32 v[218:219], v[168:169], v[76:77], v[218:219]
  v_pk_fma_f32 v[220:221], v[168:169], v[168:169], v[220:221]
  v_pk_fma_f32 v[222:223], v[168:169], v[96:97], v[222:223]
  v_pk_mul_f32 v[170:171], v[78:79], v[98:99]
  v_pk_add_f32 v[224:225], v[224:225], v[98:99]
  v_pk_fma_f32 v[226:227], v[98:99], v[98:99], v[226:227]
  v_pk_add_f32 v[216:217], v[216:217], v[170:171]
  v_pk_fma_f32 v[218:219], v[170:171], v[78:79], v[218:219]
  v_pk_fma_f32 v[220:221], v[170:171], v[170:171], v[220:221]
  v_pk_fma_f32 v[222:223], v[170:171], v[98:99], v[222:223]
  v_lshlrev_b32_e64 v100, 16, v238
  v_and_b32 v101, 0xffff0000, v238
  v_lshlrev_b32_e64 v102, 16, v239
  v_and_b32 v103, 0xffff0000, v239
  v_pk_mul_f32 v[172:173], v[80:81], v[100:101]
  v_pk_add_f32 v[224:225], v[224:225], v[100:101]
  v_pk_fma_f32 v[226:227], v[100:101], v[100:101], v[226:227]
  v_pk_add_f32 v[216:217], v[216:217], v[172:173]
  v_pk_fma_f32 v[218:219], v[172:173], v[80:81], v[218:219]
  v_pk_fma_f32 v[220:221], v[172:173], v[172:173], v[220:221]
  v_pk_fma_f32 v[222:223], v[172:173], v[100:101], v[222:223]
  v_pk_mul_f32 v[174:175], v[82:83], v[102:103]
  v_pk_add_f32 v[224:225], v[224:225], v[102:103]
  v_pk_fma_f32 v[226:227], v[102:103], v[102:103], v[226:227]
  v_pk_add_f32 v[216:217], v[216:217], v[174:175]
  v_pk_fma_f32 v[218:219], v[174:175], v[82:83], v[218:219]
  v_pk_fma_f32 v[220:221], v[174:175], v[174:175], v[220:221]
  v_pk_fma_f32 v[222:223], v[174:175], v[102:103], v[222:223]
  v_lshlrev_b32_e64 v104, 16, v240
  v_and_b32 v105, 0xffff0000, v240
  v_lshlrev_b32_e64 v106, 16, v241
  v_and_b32 v107, 0xffff0000, v241
  s_add_u32 m0, s75, 8192
  s_add_u32 s14, s74, 40960
  buffer_load_dwordx4 v244, s[56:59], s14 offen lds
  v_pk_mul_f32 v[176:177], v[84:85], v[104:105]
  v_pk_add_f32 v[224:225], v[224:225], v[104:105]
  v_pk_fma_f32 v[226:227], v[104:105], v[104:105], v[226:227]
  v_pk_add_f32 v[216:217], v[216:217], v[176:177]
  v_pk_fma_f32 v[218:219], v[176:177], v[84:85], v[218:219]
  v_pk_fma_f32 v[220:221], v[176:177], v[176:177], v[220:221]
  v_pk_fma_f32 v[222:223], v[176:177], v[104:105], v[222:223]
  v_pk_mul_f32 v[178:179], v[86:87], v[106:107]
  v_pk_add_f32 v[224:225], v[224:225], v[106:107]
  v_pk_fma_f32 v[226:227], v[106:107], v[106:107], v[226:227]
  v_pk_add_f32 v[216:217], v[216:217], v[178:179]
  v_pk_fma_f32 v[218:219], v[178:179], v[86:87], v[218:219]
  v_pk_fma_f32 v[220:221], v[178:179], v[178:179], v[220:221]
  v_pk_fma_f32 v[222:223], v[178:179], v[106:107], v[222:223]
  v_add_f32 v212, v212, v213
  v_add_f32 v214, v214, v215
  v_add_f32 v216, v216, v217
  v_add_f32 v218, v218, v219
  v_add_f32 v220, v220, v221
  v_add_f32 v222, v222, v223
  v_add_f32 v224, v224, v225
  v_add_f32 v226, v226, v227
  v_permlane16_swap_b32 v212, v220
  v_permlane16_swap_b32 v214, v222
  v_permlane16_swap_b32 v216, v224
  v_permlane16_swap_b32 v218, v226
  v_add_f32 v228, v212, v220
  v_add_f32 v229, v214, v222
  v_add_f32 v230, v216, v224
  v_add_f32 v231, v218, v226
  v_mov_b32 v212, v228
  v_mov_b32 v213, v229
  v_mov_b32 v214, v230
  v_mov_b32 v215, v231
  v_permlane32_swap_b32 v228, v212
  v_permlane32_swap_b32 v229, v213
  v_permlane32_swap_b32 v230, v214
  v_permlane32_swap_b32 v231, v215
  s_movk_i32 s14, 0xff
  v_add_f32 v228, v228, v212
  v_add_f32 v229, v229, v213
  v_add_f32 v230, v230, v214
  v_add_f32 v231, v231, v215
  s_lshr_b32 s15, s8, 0
  v_mov_b32_e64 v212, s15
  v_bfi_b32 v228, s14, v212, v228
  s_lshr_b32 s15, s8, 8
  v_mov_b32 v213, s15
  v_bfi_b32 v229, s14, v213, v229
  s_lshr_b32 s15, s8, 16
  v_mov_b32 v214, s15
  v_bfi_b32 v230, s14, v214, v230
  s_lshr_b32 s15, s8, 24
  v_mov_b32 v215, s15
  v_bfi_b32 v231, s14, v215, v231
  s_mov_b32 exec_hi, 0
  s_cmp_eq_u32 s9, 0
  s_cbranch_scc1 slow_51
  buffer_store_dwordx4 v[228:231], v2, s[52:55], s13 offen
back_52:
  s_mov_b32 exec_hi, -1
  v_accvgpr_write_b32 a200, v232
  v_accvgpr_write_b32 a201, v233
  v_accvgpr_write_b32 a202, v234
  v_accvgpr_write_b32 a203, v235
  v_accvgpr_write_b32 a204, v236
  v_accvgpr_write_b32 a205, v237
  v_accvgpr_write_b32 a206, v238
  v_accvgpr_write_b32 a207, v239
  v_accvgpr_write_b32 a208, v240
  v_accvgpr_write_b32 a209, v241
  v_lshrrev_b32_e64 v11, 2, v3
  v_mul_u32_u24 v11, 5120, v11
  v_and_b32_e64 v12, 3, v3
  v_lshl_add_u32 v11, v12, 4, v11
  v_lshrrev_b32_e64 v12, 1, v4
  v_lshl_add_u32 v11, v12, 6, v11
  v_and_b32_e64 v12, 1, v4
  v_lshl_add_u32 v47, v12, 3, v11
  s_lshl_b32 s88, s5, 2
  s_add_u32 s88, s88, s7
  s_mul_i32 s88, s88, 20480
  s_mul_i32 s14, s6, 640
  s_add_u32 s88, s88, s14
  s_add_u32 s88, s88, 4194304
  v_accvgpr_read_b32 v190, a230
  v_accvgpr_read_b32 v191, a231
  v_accvgpr_read_b32 v192, a232
  v_accvgpr_read_b32 v193, a233
  v_accvgpr_read_b32 v194, a234
  v_accvgpr_read_b32 v195, a235
  v_accvgpr_read_b32 v196, a236
  v_accvgpr_read_b32 v197, a237
  v_accvgpr_read_b32 v198, a238
  v_accvgpr_read_b32 v199, a239
  v_lshlrev_b32 v108, 16, v190
  v_and_b32 v109, 0xffff0000, v190
  v_lshlrev_b32_e64 v110, 16, v191
  v_and_b32 v111, 0xffff0000, v191
  v_lshlrev_b32_e64 v112, 16, v192
  v_and_b32 v113, 0xffff0000, v192
  v_lshlrev_b32_e64 v114, 16, v193
  v_and_b32 v115, 0xffff0000, v193
  v_lshlrev_b32_e64 v116, 16, v194
  v_and_b32 v117, 0xffff0000, v194
  v_lshlrev_b32_e64 v118, 16, v195
  v_and_b32 v119, 0xffff0000, v195
  v_lshlrev_b32_e64 v120, 16, v196
  v_and_b32 v121, 0xffff0000, v196
  v_lshlrev_b32_e64 v122, 16, v197
  v_and_b32 v123, 0xffff0000, v197
  v_lshlrev_b32_e64 v124, 16, v198
  v_and_b32 v125, 0xffff0000, v198
  v_lshlrev_b32_e64 v126, 16, v199
  v_and_b32 v127, 0xffff0000, v199
  s_lshl_b32 s87, s3, 10
  s_lshr_b32 s13, s7, 1
  s_lshl_b32 s13, s13, 7
  s_add_u32 s87, s87, s13
  s_and_b32 s13, s7, 1
  s_lshl_b32 s13, s13, 3
  s_add_u32 s87, s87, s13
  s_add_u32 s87, s87, 4096
  v_and_b32 v46, 7, v1
  v_lshlrev_b32_e64 v46, 4, v46
  s_add_u32 s34, s76, 4194304
  s_add_u32 s35, s34, 20480
  s_lshl_b32 s44, s5, 5
  s_lshl_b32 s13, s6, 2
  s_add_u32 s44, s44, s13
  s_add_u32 s44, s44, s7
  v_and_b32 v11, 31, v1
  v_lshlrev_b32 v11, 4, v11
  v_lshrrev_b32_e64 v12, 5, v1
  v_lshl_add_u32 v11, v12, 14, v11
  s_mov_b32 s14, 0x0c0c0400
  s_mov_b32 s15, 0x04000c0c
  s_add_u32 s89, s12, 4096
  s_add_u32 s90, s12, 8192
  s_add_u32 s91, s12, 12288
stpoll_53:
  buffer_load_dwordx4 v[128:131], v11, s[52:55], s12 offen sc1
  buffer_load_dwordx4 v[132:135], v11, s[52:55], s89 offen sc1
  buffer_load_dwordx4 v[136:139], v11, s[52:55], s90 offen sc1
  buffer_load_dwordx4 v[140:143], v11, s[52:55], s91 offen sc1
  s_waitcnt vmcnt(0)
  v_perm_b32 v212, v129, v128, s14
  v_perm_b32 v213, v131, v130, s15
  v_perm_b32 v214, v133, v132, s14
  v_perm_b32 v215, v135, v134, s15
  v_perm_b32 v216, v137, v136, s14
  v_perm_b32 v217, v139, v138, s15
  v_perm_b32 v218, v141, v140, s14
  v_perm_b32 v219, v143, v142, s15
  v_or_b32 v212, v212, v213
  v_or_b32 v214, v214, v215
  v_or_b32 v216, v216, v217
  v_or_b32_e64 v218, v218, v219
  v_min3_u32 v13, v212, v214, s8
  v_max3_u32 v14, v212, v214, s8
  v_min3_u32 v13, v13, v216, v218
  v_max3_u32 v14, v14, v216, v218
  v_cmp_ne_u32 vcc, v13, v14
  s_sub_u32 s10, s10, 1
  s_cmp_gt_i32 s10, 0
  s_cbranch_scc0 giveup_55
  s_cbranch_vccnz stpoll_53
giveup_55:
  v_pk_add_f32 v[128:129], v[128:129], v[132:133]
  v_pk_add_f32 v[136:137], v[136:137], v[140:141]
  v_pk_add_f32 v[130:131], v[130:131], v[134:135]
  v_pk_add_f32 v[138:139], v[138:139], v[142:143]
  v_pk_add_f32 v[128:129], v[128:129], v[136:137]
  v_pk_add_f32 v[130:131], v[130:131], v[138:139]
  v_mov_b32 v132, v128
  v_mov_b32 v133, v129
  v_mov_b32 v134, v130
  v_mov_b32 v135, v131
  v_permlane32_swap_b32 v128, v132
  v_permlane32_swap_b32 v129, v133
  v_permlane32_swap_b32 v130, v134
  v_permlane32_swap_b32 v131, v135
  v_add_f32 v212, v128, v132
  v_add_f32 v213, v129, v133
  v_add_f32 v214, v130, v134
  v_add_f32 v215, v131, v135
  v_mov_b32 v216, v212
  v_mov_b32 v217, v213
  v_mov_b32 v218, v214
  v_mov_b32 v219, v215
  v_permlane16_swap_b32 v212, v216
  v_permlane16_swap_b32 v213, v217
  v_permlane16_swap_b32 v214, v218
  v_permlane16_swap_b32 v215, v219
  v_mul_f32 v200, 0x3acccccd, v212
  v_mul_f32 v204, 0x3acccccd, v213
  v_fma_f32 v204, -v200, v200, v204
  v_max_f32 v204, 0, v204
  v_add_f32 v204, 0x3727c5ac, v204
  v_rsq_f32 v202, v204
  s_nop 0
  v_mul_f32_e64 v203, v200, v202
  v_fma_f32 v204, v202, v214, v212
  v_fma_f32 v204, -v203, v218, v204
  v_mul_f32_e64 v205, v202, v216
  v_fma_f32 v205, 2.0, v215, v205
  v_fma_f32 v205, v202, v205, v213
  v_fma_f32 v214, v202, v217, v214
  v_mul_f32_e64 v219, v203, v219
  v_fma_f32 v214, -2.0, v214, v219
  v_fma_f32 v205, v203, v214, v205
  v_mul_f32 v204, 0x3acccccd, v204
  v_mul_f32 v205, 0x3acccccd, v205
  v_fma_f32 v205, -v204, v204, v205
  v_max_f32_e64 v205, 0, v205
  v_add_f32 v205, 0x3727c5ac, v205
  v_rsq_f32 v206, v205
  s_nop 0
  v_mul_f32_e64 v207, v204, v206
  v_pk_fma_f32 v[160:161], v[68:69], v[202:203], v[202:203] op_sel:[0,0,1] op_sel_hi:[1,0,1] neg_lo:[0,0,1] neg_hi:[0,0,1]
  v_pk_fma_f32 v[162:163], v[70:71], v[202:203], v[202:203] op_sel:[0,0,1] op_sel_hi:[1,0,1] neg_lo:[0,0,1] neg_hi:[0,0,1]
  v_pk_fma_f32 v[164:165], v[72:73], v[202:203], v[202:203] op_sel:[0,0,1] op_sel_hi:[1,0,1] neg_lo:[0,0,1] neg_hi:[0,0,1]
  v_pk_fma_f32 v[166:167], v[74:75], v[202:203], v[202:203] op_sel:[0,0,1] op_sel_hi:[1,0,1] neg_lo:[0,0,1] neg_hi:[0,0,1]
  v_pk_fma_f32 v[168:169], v[76:77], v[202:203], v[202:203] op_sel:[0,0,1] op_sel_hi:[1,0,1] neg_lo:[0,0,1] neg_hi:[0,0,1]
  v_pk_fma_f32 v[170:171], v[78:79], v[202:203], v[202:203] op_sel:[0,0,1] op_sel_hi:[1,0,1] neg_lo:[0,0,1] neg_hi:[0,0,1]
  v_pk_fma_f32 v[172:173], v[80:81], v[202:203], v[202:203] op_sel:[0,0,1] op_sel_hi:[1,0,1] neg_lo:[0,0,1] neg_hi:[0,0,1]
  v_pk_fma_f32 v[174:175], v[82:83], v[202:203], v[202:203] op_sel:[0,0,1] op_sel_hi:[1,0,1] neg_lo:[0,0,1] neg_hi:[0,0,1]
  v_pk_fma_f32 v[176:177], v[84:85], v[202:203], v[202:203] op_sel:[0,0,1] op_sel_hi:[1,0,1] neg_lo:[0,0,1] neg_hi:[0,0,1]
  v_pk_fma_f32 v[178:179], v[86:87], v[202:203], v[202:203] op_sel:[0,0,1] op_sel_hi:[1,0,1] neg_lo:[0,0,1] neg_hi:[0,0,1]
  v_pk_fma_f32 v[68:69], v[160:161], v[88:89], v[68:69]
  v_pk_fma_f32 v[70:71], v[162:163], v[90:91], v[70:71]
  v_pk_fma_f32 v[72:73], v[164:165], v[92:93], v[72:73]
  v_pk_fma_f32 v[74:75], v[166:167], v[94:95], v[74:75]
  v_pk_fma_f32 v[76:77], v[168:169], v[96:97], v[76:77]
  v_pk_fma_f32 v[78:79], v[170:171], v[98:99], v[78:79]
  v_pk_fma_f32 v[80:81], v[172:173], v[100:101], v[80:81]
  v_pk_fma_f32 v[82:83], v[174:175], v[102:103], v[82:83]
  v_pk_fma_f32 v[84:85], v[176:177], v[104:105], v[84:85]
  v_pk_fma_f32 v[86:87], v[178:179], v[106:107], v[86:87]
  v_pk_fma_f32 v[160:161], v[68:69], v[206:207], v[206:207] op_sel:[0,0,1] op_sel_hi:[1,0,1] neg_lo:[0,0,1] neg_hi:[0,0,1]
  v_pk_fma_f32 v[162:163], v[70:71], v[206:207], v[206:207] op_sel:[0,0,1] op_sel_hi:[1,0,1] neg_lo:[0,0,1] neg_hi:[0,0,1]
  v_pk_fma_f32 v[164:165], v[72:73], v[206:207], v[206:207] op_sel:[0,0,1] op_sel_hi:[1,0,1] neg_lo:[0,0,1] neg_hi:[0,0,1]
  v_pk_fma_f32 v[166:167], v[74:75], v[206:207], v[206:207] op_sel:[0,0,1] op_sel_hi:[1,0,1] neg_lo:[0,0,1] neg_hi:[0,0,1]
  v_pk_fma_f32 v[168:169], v[76:77], v[206:207], v[206:207] op_sel:[0,0,1] op_sel_hi:[1,0,1] neg_lo:[0,0,1] neg_hi:[0,0,1]
  v_pk_fma_f32 v[170:171], v[78:79], v[206:207], v[206:207] op_sel:[0,0,1] op_sel_hi:[1,0,1] neg_lo:[0,0,1] neg_hi:[0,0,1]
  v_pk_fma_f32 v[172:173], v[80:81], v[206:207], v[206:207] op_sel:[0,0,1] op_sel_hi:[1,0,1] neg_lo:[0,0,1] neg_hi:[0,0,1]
  v_pk_fma_f32 v[174:175], v[82:83], v[206:207], v[206:207] op_sel:[0,0,1] op_sel_hi:[1,0,1] neg_lo:[0,0,1] neg_hi:[0,0,1]
  v_pk_fma_f32 v[176:177], v[84:85], v[206:207], v[206:207] op_sel:[0,0,1] op_sel_hi:[1,0,1] neg_lo:[0,0,1] neg_hi:[0,0,1]
  v_pk_fma_f32 v[178:179], v[86:87], v[206:207], v[206:207] op_sel:[0,0,1] op_sel_hi:[1,0,1] neg_lo:[0,0,1] neg_hi:[0,0,1]
  v_cvt_pk_bf16_f32 v180, v160, v161
  v_cvt_pk_bf16_f32 v181, v162, v163
  v_cvt_pk_bf16_f32 v182, v164, v165
  v_cvt_pk_bf16_f32 v183, v166, v167
  v_cvt_pk_bf16_f32 v184, v168, v169
  v_cvt_pk_bf16_f32 v185, v170, v171
  v_cvt_pk_bf16_f32 v186, v172, v173
  v_cvt_pk_bf16_f32 v187, v174, v175
  v_cvt_pk_bf16_f32 v188, v176, v177
  v_cvt_pk_bf16_f32 v189, v178, v179
  buffer_store_dwordx2 v[180:181], v47, s[52:55], s88 offen offset:0 sc1
  buffer_store_dwordx2 v[182:183], v47, s[52:55], s88 offen offset:128 sc1
  buffer_store_dwordx2 v[184:185], v47, s[52:55], s88 offen offset:256 sc1
  buffer_store_dwordx2 v[186:187], v47, s[52:55], s88 offen offset:384 sc1
  buffer_store_dwordx2 v[188:189], v47, s[52:55], s88 offen offset:512 sc1
  v_pk_fma_f32 v[68:69], v[160:161], v[108:109], v[68:69]
  v_pk_fma_f32 v[70:71], v[162:163], v[110:111], v[70:71]
  v_pk_fma_f32 v[72:73], v[164:165], v[112:113], v[72:73]
  v_pk_fma_f32 v[74:75], v[166:167], v[114:115], v[74:75]
  v_pk_fma_f32 v[76:77], v[168:169], v[116:117], v[76:77]
  v_pk_fma_f32 v[78:79], v[170:171], v[118:119], v[78:79]
  v_pk_fma_f32 v[80:81], v[172:173], v[120:121], v[80:81]
  v_pk_fma_f32 v[82:83], v[174:175], v[122:123], v[82:83]
  v_pk_fma_f32 v[84:85], v[176:177], v[124:125], v[84:85]
  v_pk_fma_f32 v[86:87], v[178:179], v[126:127], v[86:87]
  v_accvgpr_write_b32 a210, v68
  v_accvgpr_write_b32 a211, v69
  v_accvgpr_write_b32 a212, v70
  v_accvgpr_write_b32 a213, v71
  v_accvgpr_write_b32 a214, v72
  v_accvgpr_write_b32 a215, v73
  v_accvgpr_write_b32 a216, v74
  v_accvgpr_write_b32 a217, v75
  v_accvgpr_write_b32 a218, v76
  v_accvgpr_write_b32 a219, v77
  v_accvgpr_write_b32 a220, v78
  v_accvgpr_write_b32 a221, v79
  v_accvgpr_write_b32 a222, v80
  v_accvgpr_write_b32 a223, v81
  v_accvgpr_write_b32 a224, v82
  v_accvgpr_write_b32 a225, v83
  v_accvgpr_write_b32 a226, v84
  v_accvgpr_write_b32 a227, v85
  v_accvgpr_write_b32 a228, v86
  v_accvgpr_write_b32 a229, v87
  s_add_u32 s13, s84, 4096
  s_waitcnt vmcnt(0)
  v_mov_b32 v15, s8
  s_mov_b64 exec, 1
  s_cmp_eq_u32 s9, 0
  s_cbranch_scc1 slow_56
  buffer_store_dword v15, off, s[52:55], s13
back_57:
  s_mov_b64 exec, -1
  s_cmp_lg_u32 s44, 992
  s_cbranch_scc1 skip_58
  v_mov_b32 v15, s8
  s_mov_b64 exec, 1
  buffer_store_dword v15, off, s[52:55], 0 sc1
  s_mov_b64 exec, -1
skip_58:
again_59:
  buffer_load_dwordx2 v[42:43], v46, s[52:55], s87 offen sc1
  s_sub_u32 s10, s10, 1
  s_cmp_gt_i32 s10, 0
  s_waitcnt vmcnt(0)
  v_xor_b32 v15, s8, v42
  v_xor_b32 v14, s8, v43
  v_or_b32 v15, v15, v14
  v_cmp_ne_u32 vcc, 0, v15
  s_cbranch_scc0 out_61
  s_cbranch_vccnz again_59
out_61:
ok_60:
  buffer_load_dwordx4 v[128:131], v0, s[52:55], s34 offen offset:1024 sc1
  buffer_load_dwordx4 v[132:135], v0, s[52:55], s35 offen offset:1024 sc1
  buffer_load_dwordx4 v[136:139], v0, s[52:55], s34 offen offset:1280 sc1
  buffer_load_dwordx4 v[140:143], v0, s[52:55], s35 offen offset:1280 sc1
  buffer_load_dwordx4 v[144:147], v0, s[52:55], s34 offen offset:1536 sc1
  buffer_load_dwordx4 v[148:151], v0, s[52:55], s35 offen offset:1536 sc1
  buffer_load_dwordx4 v[152:155], v0, s[52:55], s34 offen offset:1792 sc1
  buffer_load_dwordx4 v[156:159], v0, s[52:55], s35 offen offset:1792 sc1
  ds_read_b128 v[88:91], v5 offset:20480
  ds_read_b128 v[92:95], v5 offset:22528
  ds_read_b128 v[96:99], v5 offset:24576
  ds_read_b128 v[100:103], v5 offset:26624
  ds_read_b128 v[104:107], v5 offset:28672
  s_waitcnt vmcnt(6)
  s_waitcnt lgkmcnt(4)
  v_mfma_f32_16x16x32_bf16 v[48:51], v[128:131], v[88:91], 0
  ds_read_b128 v[108:111], v6 offset:20480
  v_mfma_f32_16x16x32_bf16 v[52:55], v[132:135], v[88:91], 0
  buffer_load_dwordx4 v[160:163], v0, s[52:55], s34 offen offset:2048 sc1
  s_waitcnt lgkmcnt(4)
  v_mfma_f32_16x16x32_bf16 v[56:59], v[128:131], v[92:95], 0
  ds_read_b128 v[112:115], v6 offset:22528
  v_mfma_f32_16x16x32_bf16 v[60:63], v[132:135], v[92:95], 0
  buffer_load_dwordx4 v[164:167], v0, s[52:55], s35 offen offset:2048 sc1
  s_waitcnt lgkmcnt(4)
  v_mfma_f32_16x16x32_bf16 v[64:67], v[128:131], v[96:99], 0
  ds_read_b128 v[116:119], v6 offset:24576
  v_mfma_f32_16x16x32_bf16 v[68:71], v[132:135], v[96:99], 0
  s_waitcnt lgkmcnt(4)
  v_mfma_f32_16x16x32_bf16 v[72:75], v[128:131], v[100:103], 0
  ds_read_b128 v[120:123], v6 offset:26624
  v_mfma_f32_16x16x32_bf16 v[76:79], v[132:135], v[100:103], 0
  s_waitcnt lgkmcnt(4)
  v_mfma_f32_16x16x32_bf16 v[80:83], v[128:131], v[104:107], 0
  ds_read_b128 v[124:127], v6 offset:28672
  v_mfma_f32_16x16x32_bf16 v[84:87], v[132:135], v[104:107], 0
  s_waitcnt vmcnt(6)
  s_waitcnt lgkmcnt(2)
  v_mfma_f32_16x16x32_bf16 v[48:51], v[136:139], v[108:111], v[48:51]
  ds_read_b128 v[88:91], v5 offset:30720
  v_mfma_f32_16x16x32_bf16 v[52:55], v[140:143], v[108:111], v[52:55]
  buffer_load_dwordx4 v[168:171], v0, s[52:55], s34 offen offset:2304 sc1
  v_mfma_f32_16x16x32_bf16 v[56:59], v[136:139], v[112:115], v[56:59]
  ds_read_b128 v[92:95], v5 offset:32768
  v_mfma_f32_16x16x32_bf16 v[60:63], v[140:143], v[112:115], v[60:63]
  buffer_load_dwordx4 v[172:175], v0, s[52:55], s35 offen offset:2304 sc1
  v_mfma_f32_16x16x32_bf16 v[64:67], v[136:139], v[116:119], v[64:67]
  ds_read_b128 v[96:99], v5 offset:34816
  v_mfma_f32_16x16x32_bf16 v[68:71], v[140:143], v[116:119], v[68:71]
  s_waitcnt lgkmcnt(3)
  v_mfma_f32_16x16x32_bf16 v[72:75], v[136:139], v[120:123], v[72:75]
  ds_read_b128 v[100:103], v5 offset:36864
  v_mfma_f32_16x16x32_bf16 v[76:79], v[140:143], v[120:123], v[76:79]
  v_mfma_f32_16x16x32_bf16 v[80:83], v[136:139], v[124:127], v[80:83]
  ds_read_b128 v[104:107], v5 offset:38912
  v_mfma_f32_16x16x32_bf16 v[84:87], v[140:143], v[124:127], v[84:87]
  s_waitcnt vmcnt(6)
  s_waitcnt lgkmcnt(2)
  v_mfma_f32_16x16x32_bf16 v[48:51], v[144:147], v[88:91], v[48:51]
  ds_read_b128 v[108:111], v6 offset:30720
  v_mfma_f32_16x16x32_bf16 v[52:55], v[148:151], v[88:91], v[52:55]
  buffer_load_dwordx4 v[176:179], v0, s[52:55], s34 offen offset:2560 sc1
  v_mfma_f32_16x16x32_bf16 v[56:59], v[144:147], v[92:95], v[56:59]
  ds_read_b128 v[112:115], v6 offset:32768
  v_mfma_f32_16x16x32_bf16 v[60:63], v[148:151], v[92:95], v[60:63]
  buffer_load_dwordx4 v[180:183], v0, s[52:55], s35 offen offset:2560 sc1
  v_mfma_f32_16x16x32_bf16 v[64:67], v[144:147], v[96:99], v[64:67]
  ds_read_b128 v[116:119], v6 offset:34816
  v_mfma_f32_16x16x32_bf16 v[68:71], v[148:151], v[96:99], v[68:71]
  s_waitcnt lgkmcnt(3)
  v_mfma_f32_16x16x32_bf16 v[72:75], v[144:147], v[100:103], v[72:75]
  ds_read_b128 v[120:123], v6 offset:36864
  v_mfma_f32_16x16x32_bf16 v[76:79], v[148:151], v[100:103], v[76:79]
  v_mfma_f32_16x16x32_bf16 v[80:83], v[144:147], v[104:107], v[80:83]
  ds_read_b128 v[124:127], v6 offset:38912
  v_mfma_f32_16x16x32_bf16 v[84:87], v[148:151], v[104:107], v[84:87]
  s_waitcnt vmcnt(6)
  s_waitcnt lgkmcnt(2)
  v_mfma_f32_16x16x32_bf16 v[48:51], v[152:155], v[108:111], v[48:51]
  ds_read_b128 v[88:91], v5 offset:40960
  v_mfma_f32_16x16x32_bf16 v[52:55], v[156:159], v[108:111], v[52:55]
  buffer_load_dwordx4 v[184:187], v0, s[52:55], s34 offen offset:2816 sc1
  v_mfma_f32_16x16x32_bf16 v[56:59], v[152:155], v[112:115], v[56:59]
  ds_read_b128 v[92:95], v5 offset:43008
  v_mfma_f32_16x16x32_bf16 v[60:63], v[156:159], v[112:115], v[60:63]
  buffer_load_dwordx4 v[188:191], v0, s[52:55], s35 offen offset:2816 sc1
  v_mfma_f32_16x16x32_bf16 v[64:67], v[152:155], v[116:119], v[64:67]
  ds_read_b128 v[96:99], v5 offset:45056
  v_mfma_f32_16x16x32_bf16 v[68:71], v[156:159], v[116:119], v[68:71]
  s_waitcnt lgkmcnt(3)
  v_mfma_f32_16x16x32_bf16 v[72:75], v[152:155], v[120:123], v[72:75]
  ds_read_b128 v[100:103], v5 offset:47104
  v_mfma_f32_16x16x32_bf16 v[76:79], v[156:159], v[120:123], v[76:79]
  v_mfma_f32_16x16x32_bf16 v[80:83], v[152:155], v[124:127], v[80:83]
  ds_read_b128 v[104:107], v5 offset:49152
  v_mfma_f32_16x16x32_bf16 v[84:87], v[156:159], v[124:127], v[84:87]
  s_waitcnt vmcnt(6)
  s_waitcnt lgkmcnt(2)
  v_mfma_f32_16x16x32_bf16 v[48:51], v[160:163], v[88:91], v[48:51]
  ds_read_b128 v[108:111], v6 offset:40960
  v_mfma_f32_16x16x32_bf16 v[52:55], v[164:167], v[88:91], v[52:55]
  buffer_load_dwordx4 v[128:131], v0, s[52:55], s34 offen offset:3072 sc1
  v_mfma_f32_16x16x32_bf16 v[56:59], v[160:163], v[92:95], v[56:59]
  ds_read_b128 v[112:115], v6 offset:43008
  v_mfma_f32_16x16x32_bf16 v[60:63], v[164:167], v[92:95], v[60:63]
  buffer_load_dwordx4 v[132:135], v0, s[52:55], s35 offen offset:3072 sc1
  v_mfma_f32_16x16x32_bf16 v[64:67], v[160:163], v[96:99], v[64:67]
  ds_read_b128 v[116:119], v6 offset:45056
  v_mfma_f32_16x16x32_bf16 v[68:71], v[164:167], v[96:99], v[68:71]
  s_waitcnt lgkmcnt(3)
  v_mfma_f32_16x16x32_bf16 v[72:75], v[160:163], v[100:103], v[72:75]
  ds_read_b128 v[120:123], v6 offset:47104
  v_mfma_f32_16x16x32_bf16 v[76:79], v[164:167], v[100:103], v[76:79]
  v_mfma_f32_16x16x32_bf16 v[80:83], v[160:163], v[104:107], v[80:83]
  ds_read_b128 v[124:127], v6 offset:49152
  v_mfma_f32_16x16x32_bf16 v[84:87], v[164:167], v[104:107], v[84:87]
  s_waitcnt vmcnt(6)
  s_waitcnt lgkmcnt(2)
  v_mfma_f32_16x16x32_bf16 v[48:51], v[168:171], v[108:111], v[48:51]
  ds_read_b128 v[88:91], v7 offset:0
  v_mfma_f32_16x16x32_bf16 v[52:55], v[172:175], v[108:111], v[52:55]
  buffer_load_dwordx4 v[136:139], v0, s[52:55], s34 offen offset:3328 sc1
  v_mfma_f32_16x16x32_bf16 v[56:59], v[168:171], v[112:115], v[56:59]
  ds_read_b128 v[92:95], v7 offset:2048
  v_mfma_f32_16x16x32_bf16 v[60:63], v[172:175], v[112:115], v[60:63]
  buffer_load_dwordx4 v[140:143], v0, s[52:55], s35 offen offset:3328 sc1
  v_mfma_f32_16x16x32_bf16 v[64:67], v[168:171], v[116:119], v[64:67]
  ds_read_b128 v[96:99], v7 offset:4096
  v_mfma_f32_16x16x32_bf16 v[68:71], v[172:175], v[116:119], v[68:71]
  s_waitcnt lgkmcnt(3)
  v_mfma_f32_16x16x32_bf16 v[72:75], v[168:171], v[120:123], v[72:75]
  ds_read_b128 v[100:103], v7 offset:6144
  v_mfma_f32_16x16x32_bf16 v[76:79], v[172:175], v[120:123], v[76:79]
  v_mfma_f32_16x16x32_bf16 v[80:83], v[168:171], v[124:127], v[80:83]
  ds_read_b128 v[104:107], v7 offset:8192
  v_mfma_f32_16x16x32_bf16 v[84:87], v[172:175], v[124:127], v[84:87]
  s_waitcnt vmcnt(6)
  s_waitcnt lgkmcnt(2)
  v_mfma_f32_16x16x32_bf16 v[48:51], v[176:179], v[88:91], v[48:51]
  ds_read_b128 v[108:111], v8 offset:0
  v_mfma_f32_16x16x32_bf16 v[52:55], v[180:183], v[88:91], v[52:55]
  buffer_load_dwordx4 v[144:147], v0, s[52:55], s34 offen offset:3584 sc1
  v_mfma_f32_16x16x32_bf16 v[56:59], v[176:179], v[92:95], v[56:59]
  ds_read_b128 v[112:115], v8 offset:2048
  v_mfma_f32_16x16x32_bf16 v[60:63], v[180:183], v[92:95], v[60:63]
  buffer_load_dwordx4 v[148:151], v0, s[52:55], s35 offen offset:3584 sc1
  v_mfma_f32_16x16x32_bf16 v[64:67], v[176:179], v[96:99], v[64:67]
  ds_read_b128 v[116:119], v8 offset:4096
  v_mfma_f32_16x16x32_bf16 v[68:71], v[180:183], v[96:99], v[68:71]
  s_waitcnt lgkmcnt(3)
  v_mfma_f32_16x16x32_bf16 v[72:75], v[176:179], v[100:103], v[72:75]
  ds_read_b128 v[120:123], v8 offset:6144
  v_mfma_f32_16x16x32_bf16 v[76:79], v[180:183], v[100:103], v[76:79]
  v_mfma_f32_16x16x32_bf16 v[80:83], v[176:179], v[104:107], v[80:83]
  ds_read_b128 v[124:127], v8 offset:8192
  v_mfma_f32_16x16x32_bf16 v[84:87], v[180:183], v[104:107], v[84:87]
  s_waitcnt vmcnt(6)
  s_waitcnt lgkmcnt(2)
  v_mfma_f32_16x16x32_bf16 v[48:51], v[184:187], v[108:111], v[48:51]
  ds_read_b128 v[88:91], v7 offset:10240
  v_mfma_f32_16x16x32_bf16 v[52:55], v[188:191], v[108:111], v[52:55]
  buffer_load_dwordx4 v[152:155], v0, s[52:55], s34 offen offset:3840 sc1
  v_mfma_f32_16x16x32_bf16 v[56:59], v[184:187], v[112:115], v[56:59]
  ds_read_b128 v[92:95], v7 offset:12288
  v_mfma_f32_16x16x32_bf16 v[60:63], v[188:191], v[112:115], v[60:63]
  buffer_load_dwordx4 v[156:159], v0, s[52:55], s35 offen offset:3840 sc1
  v_mfma_f32_16x16x32_bf16 v[64:67], v[184:187], v[116:119], v[64:67]
  ds_read_b128 v[96:99], v7 offset:14336
  v_mfma_f32_16x16x32_bf16 v[68:71], v[188:191], v[116:119], v[68:71]
  s_waitcnt lgkmcnt(3)
  v_mfma_f32_16x16x32_bf16 v[72:75], v[184:187], v[120:123], v[72:75]
  ds_read_b128 v[100:103], v7 offset:16384
  v_mfma_f32_16x16x32_bf16 v[76:79], v[188:191], v[120:123], v[76:79]
  v_mfma_f32_16x16x32_bf16 v[80:83], v[184:187], v[124:127], v[80:83]
  ds_read_b128 v[104:107], v7 offset:18432
  v_mfma_f32_16x16x32_bf16 v[84:87], v[188:191], v[124:127], v[84:87]
  s_waitcnt vmcnt(6)
  s_waitcnt lgkmcnt(2)
  v_mfma_f32_16x16x32_bf16 v[48:51], v[128:131], v[88:91], v[48:51]
  ds_read_b128 v[108:111], v8 offset:10240
  v_mfma_f32_16x16x32_bf16 v[52:55], v[132:135], v[88:91], v[52:55]
  s_add_u32 s34, s34, 4096
  buffer_load_dwordx4 v[160:163], v0, s[52:55], s34 offen offset:0 sc1
  v_mfma_f32_16x16x32_bf16 v[56:59], v[128:131], v[92:95], v[56:59]
  ds_read_b128 v[112:115], v8 offset:12288
  v_mfma_f32_16x16x32_bf16 v[60:63], v[132:135], v[92:95], v[60:63]
  s_add_u32 s35, s35, 4096
  buffer_load_dwordx4 v[164:167], v0, s[52:55], s35 offen offset:0 sc1
  v_mfma_f32_16x16x32_bf16 v[64:67], v[128:131], v[96:99], v[64:67]
  ds_read_b128 v[116:119], v8 offset:14336
  v_mfma_f32_16x16x32_bf16 v[68:71], v[132:135], v[96:99], v[68:71]
  s_waitcnt lgkmcnt(3)
  v_mfma_f32_16x16x32_bf16 v[72:75], v[128:131], v[100:103], v[72:75]
  ds_read_b128 v[120:123], v8 offset:16384
  v_mfma_f32_16x16x32_bf16 v[76:79], v[132:135], v[100:103], v[76:79]
  v_mfma_f32_16x16x32_bf16 v[80:83], v[128:131], v[104:107], v[80:83]
  ds_read_b128 v[124:127], v8 offset:18432
  v_mfma_f32_16x16x32_bf16 v[84:87], v[132:135], v[104:107], v[84:87]
  s_waitcnt vmcnt(6)
  s_waitcnt lgkmcnt(2)
  v_mfma_f32_16x16x32_bf16 v[48:51], v[136:139], v[108:111], v[48:51]
  ds_read_b128 v[88:91], v7 offset:20480
  v_mfma_f32_16x16x32_bf16 v[52:55], v[140:143], v[108:111], v[52:55]
  buffer_load_dwordx4 v[168:171], v0, s[52:55], s34 offen offset:256 sc1
  v_mfma_f32_16x16x32_bf16 v[56:59], v[136:139], v[112:115], v[56:59]
  ds_read_b128 v[92:95], v7 offset:22528
  v_mfma_f32_16x16x32_bf16 v[60:63], v[140:143], v[112:115], v[60:63]
  buffer_load_dwordx4 v[172:175], v0, s[52:55], s35 offen offset:256 sc1
  v_mfma_f32_16x16x32_bf16 v[64:67], v[136:139], v[116:119], v[64:67]
  ds_read_b128 v[96:99], v7 offset:24576
  v_mfma_f32_16x16x32_bf16 v[68:71], v[140:143], v[116:119], v[68:71]
  s_waitcnt lgkmcnt(3)
  v_mfma_f32_16x16x32_bf16 v[72:75], v[136:139], v[120:123], v[72:75]
  ds_read_b128 v[100:103], v7 offset:26624
  v_mfma_f32_16x16x32_bf16 v[76:79], v[140:143], v[120:123], v[76:79]
  v_mfma_f32_16x16x32_bf16 v[80:83], v[136:139], v[124:127], v[80:83]
  ds_read_b128 v[104:107], v7 offset:28672
  v_mfma_f32_16x16x32_bf16 v[84:87], v[140:143], v[124:127], v[84:87]
  s_waitcnt vmcnt(6)
  s_waitcnt lgkmcnt(2)
  v_mfma_f32_16x16x32_bf16 v[48:51], v[144:147], v[88:91], v[48:51]
  ds_read_b128 v[108:111], v8 offset:20480
  v_mfma_f32_16x16x32_bf16 v[52:55], v[148:151], v[88:91], v[52:55]
  buffer_load_dwordx4 v[176:179], v0, s[52:55], s34 offen offset:512 sc1
  v_mfma_f32_16x16x32_bf16 v[56:59], v[144:147], v[92:95], v[56:59]
  ds_read_b128 v[112:115], v8 offset:22528
  v_mfma_f32_16x16x32_bf16 v[60:63], v[148:151], v[92:95], v[60:63]
  buffer_load_dwordx4 v[180:183], v0, s[52:55], s35 offen offset:512 sc1
  v_mfma_f32_16x16x32_bf16 v[64:67], v[144:147], v[96:99], v[64:67]
  ds_read_b128 v[116:119], v8 offset:24576
  v_mfma_f32_16x16x32_bf16 v[68:71], v[148:151], v[96:99], v[68:71]
  s_waitcnt lgkmcnt(3)
  v_mfma_f32_16x16x32_bf16 v[72:75], v[144:147], v[100:103], v[72:75]
  ds_read_b128 v[120:123], v8 offset:26624
  v_mfma_f32_16x16x32_bf16 v[76:79], v[148:151], v[100:103], v[76:79]
  v_mfma_f32_16x16x32_bf16 v[80:83], v[144:147], v[104:107], v[80:83]
  ds_read_b128 v[124:127], v8 offset:28672
  v_mfma_f32_16x16x32_bf16 v[84:87], v[148:151], v[104:107], v[84:87]
  s_waitcnt vmcnt(6)
  s_waitcnt lgkmcnt(2)
  v_mfma_f32_16x16x32_bf16 v[48:51], v[152:155], v[108:111], v[48:51]
  ds_read_b128 v[88:91], v7 offset:30720
  v_mfma_f32_16x16x32_bf16 v[52:55], v[156:159], v[108:111], v[52:55]
  buffer_load_dwordx4 v[184:187], v0, s[52:55], s34 offen offset:768 sc1
  v_mfma_f32_16x16x32_bf16 v[56:59], v[152:155], v[112:115], v[56:59]
  ds_read_b128 v[92:95], v7 offset:32768
  v_mfma_f32_16x16x32_bf16 v[60:63], v[156:159], v[112:115], v[60:63]
  buffer_load_dwordx4 v[188:191], v0, s[52:55], s35 offen offset:768 sc1
  v_mfma_f32_16x16x32_bf16 v[64:67], v[152:155], v[116:119], v[64:67]
  ds_read_b128 v[96:99], v7 offset:34816
  v_mfma_f32_16x16x32_bf16 v[68:71], v[156:159], v[116:119], v[68:71]
  s_waitcnt lgkmcnt(3)
  v_mfma_f32_16x16x32_bf16 v[72:75], v[152:155], v[120:123], v[72:75]
  ds_read_b128 v[100:103], v7 offset:36864
  v_mfma_f32_16x16x32_bf16 v[76:79], v[156:159], v[120:123], v[76:79]
  v_mfma_f32_16x16x32_bf16 v[80:83], v[152:155], v[124:127], v[80:83]
  ds_read_b128 v[104:107], v7 offset:38912
  v_mfma_f32_16x16x32_bf16 v[84:87], v[156:159], v[124:127], v[84:87]
  s_waitcnt vmcnt(6)
  s_waitcnt lgkmcnt(2)
  v_mfma_f32_16x16x32_bf16 v[48:51], v[160:163], v[88:91], v[48:51]
  ds_read_b128 v[108:111], v8 offset:30720
  v_mfma_f32_16x16x32_bf16 v[52:55], v[164:167], v[88:91], v[52:55]
  s_sub_u32 s34, s34, 4096
  buffer_load_dwordx4 v[128:131], v0, s[52:55], s34 offen offset:0 sc1
  v_mfma_f32_16x16x32_bf16 v[56:59], v[160:163], v[92:95], v[56:59]
  ds_read_b128 v[112:115], v8 offset:32768
  v_mfma_f32_16x16x32_bf16 v[60:63], v[164:167], v[92:95], v[60:63]
  s_sub_u32 s35, s35, 4096
  buffer_load_dwordx4 v[132:135], v0, s[52:55], s35 offen offset:0 sc1
  v_mfma_f32_16x16x32_bf16 v[64:67], v[160:163], v[96:99], v[64:67]
  ds_read_b128 v[116:119], v8 offset:34816
  v_mfma_f32_16x16x32_bf16 v[68:71], v[164:167], v[96:99], v[68:71]
  s_waitcnt lgkmcnt(3)
  v_mfma_f32_16x16x32_bf16 v[72:75], v[160:163], v[100:103], v[72:75]
  ds_read_b128 v[120:123], v8 offset:36864
  v_mfma_f32_16x16x32_bf16 v[76:79], v[164:167], v[100:103], v[76:79]
  v_mfma_f32_16x16x32_bf16 v[80:83], v[160:163], v[104:107], v[80:83]
  ds_read_b128 v[124:127], v8 offset:38912
  v_mfma_f32_16x16x32_bf16 v[84:87], v[164:167], v[104:107], v[84:87]
  s_waitcnt vmcnt(6)
  s_waitcnt lgkmcnt(2)
  v_mfma_f32_16x16x32_bf16 v[48:51], v[168:171], v[108:111], v[48:51]
  ds_read_b128 v[88:91], v7 offset:40960
  v_mfma_f32_16x16x32_bf16 v[52:55], v[172:175], v[108:111], v[52:55]
  buffer_load_dwordx4 v[136:139], v0, s[52:55], s34 offen offset:256 sc1
  v_mfma_f32_16x16x32_bf16 v[56:59], v[168:171], v[112:115], v[56:59]
  ds_read_b128 v[92:95], v7 offset:43008
  v_mfma_f32_16x16x32_bf16 v[60:63], v[172:175], v[112:115], v[60:63]
  buffer_load_dwordx4 v[140:143], v0, s[52:55], s35 offen offset:256 sc1
  v_mfma_f32_16x16x32_bf16 v[64:67], v[168:171], v[116:119], v[64:67]
  ds_read_b128 v[96:99], v7 offset:45056
  v_mfma_f32_16x16x32_bf16 v[68:71], v[172:175], v[116:119], v[68:71]
  s_waitcnt lgkmcnt(3)
  v_mfma_f32_16x16x32_bf16 v[72:75], v[168:171], v[120:123], v[72:75]
  ds_read_b128 v[100:103], v7 offset:47104
  v_mfma_f32_16x16x32_bf16 v[76:79], v[172:175], v[120:123], v[76:79]
  v_mfma_f32_16x16x32_bf16 v[80:83], v[168:171], v[124:127], v[80:83]
  ds_read_b128 v[104:107], v7 offset:49152
  v_mfma_f32_16x16x32_bf16 v[84:87], v[172:175], v[124:127], v[84:87]
  s_waitcnt vmcnt(6)
  s_waitcnt lgkmcnt(2)
  v_mfma_f32_16x16x32_bf16 v[48:51], v[176:179], v[88:91], v[48:51]
  ds_read_b128 v[108:111], v8 offset:40960
  v_mfma_f32_16x16x32_bf16 v[52:55], v[180:183], v[88:91], v[52:55]
  buffer_load_dwordx4 v[144:147], v0, s[52:55], s34 offen offset:512 sc1
  v_mfma_f32_16x16x32_bf16 v[56:59], v[176:179], v[92:95], v[56:59]
  ds_read_b128 v[112:115], v8 offset:43008
  v_mfma_f32_16x16x32_bf16 v[60:63], v[180:183], v[92:95], v[60:63]
  buffer_load_dwordx4 v[148:151], v0, s[52:55], s35 offen offset:512 sc1
  v_mfma_f32_16x16x32_bf16 v[64:67], v[176:179], v[96:99], v[64:67]
  ds_read_b128 v[116:119], v8 offset:45056
  v_mfma_f32_16x16x32_bf16 v[68:71], v[180:183], v[96:99], v[68:71]
  s_waitcnt lgkmcnt(3)
  v_mfma_f32_16x16x32_bf16 v[72:75], v[176:179], v[100:103], v[72:75]
  ds_read_b128 v[120:123], v8 offset:47104
  v_mfma_f32_16x16x32_bf16 v[76:79], v[180:183], v[100:103], v[76:79]
  v_mfma_f32_16x16x32_bf16 v[80:83], v[176:179], v[104:107], v[80:83]
  ds_read_b128 v[124:127], v8 offset:49152
  v_mfma_f32_16x16x32_bf16 v[84:87], v[180:183], v[104:107], v[84:87]
  s_waitcnt vmcnt(6)
  s_barrier
  s_waitcnt lgkmcnt(2)
  v_mfma_f32_16x16x32_bf16 v[48:51], v[184:187], v[108:111], v[48:51]
  ds_read_b128 v[88:91], v5 offset:0
  v_mfma_f32_16x16x32_bf16 v[52:55], v[188:191], v[108:111], v[52:55]
  buffer_load_dwordx4 v[152:155], v0, s[52:55], s34 offen offset:768 sc1
  v_mfma_f32_16x16x32_bf16 v[56:59], v[184:187], v[112:115], v[56:59]
  ds_read_b128 v[92:95], v5 offset:2048
  v_mfma_f32_16x16x32_bf16 v[60:63], v[188:191], v[112:115], v[60:63]
  buffer_load_dwordx4 v[156:159], v0, s[52:55], s35 offen offset:768 sc1
  v_mfma_f32_16x16x32_bf16 v[64:67], v[184:187], v[116:119], v[64:67]
  ds_read_b128 v[96:99], v5 offset:4096
  v_mfma_f32_16x16x32_bf16 v[68:71], v[188:191], v[116:119], v[68:71]
  s_waitcnt lgkmcnt(3)
  v_mfma_f32_16x16x32_bf16 v[72:75], v[184:187], v[120:123], v[72:75]
  ds_read_b128 v[100:103], v5 offset:6144
  v_mfma_f32_16x16x32_bf16 v[76:79], v[188:191], v[120:123], v[76:79]
  v_mfma_f32_16x16x32_bf16 v[80:83], v[184:187], v[124:127], v[80:83]
  ds_read_b128 v[104:107], v5 offset:8192
  v_mfma_f32_16x16x32_bf16 v[84:87], v[188:191], v[124:127], v[84:87]
  s_waitcnt vmcnt(6)
  s_waitcnt lgkmcnt(2)
  v_mfma_f32_16x16x32_bf16 v[48:51], v[128:131], v[88:91], v[48:51]
  ds_read_b128 v[108:111], v6 offset:0
  v_mfma_f32_16x16x32_bf16 v[52:55], v[132:135], v[88:91], v[52:55]
  v_mfma_f32_16x16x32_bf16 v[56:59], v[128:131], v[92:95], v[56:59]
  ds_read_b128 v[112:115], v6 offset:2048
  v_mfma_f32_16x16x32_bf16 v[60:63], v[132:135], v[92:95], v[60:63]
  v_mfma_f32_16x16x32_bf16 v[64:67], v[128:131], v[96:99], v[64:67]
  ds_read_b128 v[116:119], v6 offset:4096
  v_mfma_f32_16x16x32_bf16 v[68:71], v[132:135], v[96:99], v[68:71]
  s_waitcnt lgkmcnt(3)
  v_mfma_f32_16x16x32_bf16 v[72:75], v[128:131], v[100:103], v[72:75]
  ds_read_b128 v[120:123], v6 offset:6144
  v_mfma_f32_16x16x32_bf16 v[76:79], v[132:135], v[100:103], v[76:79]
  v_mfma_f32_16x16x32_bf16 v[80:83], v[128:131], v[104:107], v[80:83]
  ds_read_b128 v[124:127], v6 offset:8192
  v_mfma_f32_16x16x32_bf16 v[84:87], v[132:135], v[104:107], v[84:87]
  s_waitcnt vmcnt(4)
  s_waitcnt lgkmcnt(2)
  v_mfma_f32_16x16x32_bf16 v[48:51], v[136:139], v[108:111], v[48:51]
  ds_read_b128 v[88:91], v5 offset:10240
  v_mfma_f32_16x16x32_bf16 v[52:55], v[140:143], v[108:111], v[52:55]
  v_accvgpr_read_b32 v11, a245
  s_and_b32 exec_lo, s96, 0x3fffffff
  s_mov_b32 exec_hi, 0
  buffer_load_dword a250, v11, s[52:55], 0 offen
  s_mov_b64 exec, -1
  v_mfma_f32_16x16x32_bf16 v[56:59], v[136:139], v[112:115], v[56:59]
  ds_read_b128 v[92:95], v5 offset:12288
  v_mfma_f32_16x16x32_bf16 v[60:63], v[140:143], v[112:115], v[60:63]
  v_mfma_f32_16x16x32_bf16 v[64:67], v[136:139], v[116:119], v[64:67]
  ds_read_b128 v[96:99], v5 offset:14336
  v_mfma_f32_16x16x32_bf16 v[68:71], v[140:143], v[116:119], v[68:71]
  s_waitcnt lgkmcnt(3)
  v_mfma_f32_16x16x32_bf16 v[72:75], v[136:139], v[120:123], v[72:75]
  ds_read_b128 v[100:103], v5 offset:16384
  v_mfma_f32_16x16x32_bf16 v[76:79], v[140:143], v[120:123], v[76:79]
  v_mfma_f32_16x16x32_bf16 v[80:83], v[136:139], v[124:127], v[80:83]
  ds_read_b128 v[104:107], v5 offset:18432
  v_mfma_f32_16x16x32_bf16 v[84:87], v[140:143], v[124:127], v[84:87]
  s_waitcnt vmcnt(2)
  s_waitcnt lgkmcnt(2)
  v_mfma_f32_16x16x32_bf16 v[48:51], v[144:147], v[88:91], v[48:51]
  ds_read_b128 v[108:111], v6 offset:10240
  v_mfma_f32_16x16x32_bf16 v[52:55], v[148:151], v[88:91], v[52:55]
  v_mfma_f32_16x16x32_bf16 v[56:59], v[144:147], v[92:95], v[56:59]
  ds_read_b128 v[112:115], v6 offset:12288
  v_mfma_f32_16x16x32_bf16 v[60:63], v[148:151], v[92:95], v[60:63]
  v_mfma_f32_16x16x32_bf16 v[64:67], v[144:147], v[96:99], v[64:67]
  ds_read_b128 v[116:119], v6 offset:14336
  v_mfma_f32_16x16x32_bf16 v[68:71], v[148:151], v[96:99], v[68:71]
  s_waitcnt lgkmcnt(3)
  v_mfma_f32_16x16x32_bf16 v[72:75], v[144:147], v[100:103], v[72:75]
  ds_read_b128 v[120:123], v6 offset:16384
  v_mfma_f32_16x16x32_bf16 v[76:79], v[148:151], v[100:103], v[76:79]
  v_mfma_f32_16x16x32_bf16 v[80:83], v[144:147], v[104:107], v[80:83]
  ds_read_b128 v[124:127], v6 offset:18432
  v_mfma_f32_16x16x32_bf16 v[84:87], v[148:151], v[104:107], v[84:87]
  s_waitcnt vmcnt(0)
  s_waitcnt lgkmcnt(2)
  v_mfma_f32_16x16x32_bf16 v[48:51], v[152:155], v[108:111], v[48:51]
  v_mfma_f32_16x16x32_bf16 v[52:55], v[156:159], v[108:111], v[52:55]
  v_mfma_f32_16x16x32_bf16 v[56:59], v[152:155], v[112:115], v[56:59]
  v_mfma_f32_16x16x32_bf16 v[60:63], v[156:159], v[112:115], v[60:63]
  v_mfma_f32_16x16x32_bf16 v[64:67], v[152:155], v[116:119], v[64:67]
  v_mfma_f32_16x16x32_bf16 v[68:71], v[156:159], v[116:119], v[68:71]
  s_waitcnt lgkmcnt(0)
  v_mfma_f32_16x16x32_bf16 v[72:75], v[152:155], v[120:123], v[72:75]
  v_mfma_f32_16x16x32_bf16 v[76:79], v[156:159], v[120:123], v[76:79]
  v_mfma_f32_16x16x32_bf16 v[80:83], v[152:155], v[124:127], v[80:83]
  v_mfma_f32_16x16x32_bf16 v[84:87], v[156:159], v[124:127], v[84:87]
  v_fmac_f32 v49, v16, v48
  v_fmac_f32 v57, v17, v56
  v_fmac_f32 v65, v18, v64
  s_nop 1
  v_fmac_f32 v73, v19, v72
  s_nop 0
  v_fmac_f32 v81, v20, v80
  v_fmac_f32_dpp v49, v48, v21 quad_perm:[1,0,3,2] row_mask:0xf bank_mask:0xf
  v_fmac_f32_dpp v57, v56, v22 quad_perm:[1,0,3,2] row_mask:0xf bank_mask:0xf
  v_fmac_f32_dpp v65, v64, v23 quad_perm:[1,0,3,2] row_mask:0xf bank_mask:0xf
  v_fmac_f32_dpp v73, v72, v24 quad_perm:[1,0,3,2] row_mask:0xf bank_mask:0xf
  v_fmac_f32_dpp v81, v80, v25 quad_perm:[1,0,3,2] row_mask:0xf bank_mask:0xf
  v_fmac_f32 v50, v16, v49
  v_fmac_f32 v58, v17, v57
  v_fmac_f32 v66, v18, v65
  v_fmac_f32 v74, v19, v73
  v_fmac_f32_e64 v82, v20, v81
  v_fmac_f32_dpp v50, v49, v21 quad_perm:[1,0,3,2] row_mask:0xf bank_mask:0xf
  v_fmac_f32_dpp v58, v57, v22 quad_perm:[1,0,3,2] row_mask:0xf bank_mask:0xf
  v_fmac_f32_dpp v66, v65, v23 quad_perm:[1,0,3,2] row_mask:0xf bank_mask:0xf
  v_fmac_f32_dpp v74, v73, v24 quad_perm:[1,0,3,2] row_mask:0xf bank_mask:0xf
  v_fmac_f32_dpp v82, v81, v25 quad_perm:[1,0,3,2] row_mask:0xf bank_mask:0xf
  v_fmac_f32 v51, v16, v50
  v_fmac_f32 v59, v17, v58
  v_fmac_f32 v67, v18, v66
  v_fmac_f32 v75, v19, v74
  v_fmac_f32_e64 v83, v20, v82
  v_fmac_f32_dpp v51, v50, v21 quad_perm:[1,0,3,2] row_mask:0xf bank_mask:0xf
  v_fmac_f32_dpp v59, v58, v22 quad_perm:[1,0,3,2] row_mask:0xf bank_mask:0xf
  v_fmac_f32_dpp v67, v66, v23 quad_perm:[1,0,3,2] row_mask:0xf bank_mask:0xf
  v_fmac_f32_dpp v75, v74, v24 quad_perm:[1,0,3,2] row_mask:0xf bank_mask:0xf
  v_fmac_f32_dpp v83, v82, v25 quad_perm:[1,0,3,2] row_mask:0xf bank_mask:0xf
  v_fmac_f32 v52, v16, v51
  v_fmac_f32 v60, v17, v59
  v_fmac_f32 v68, v18, v67
  v_fmac_f32 v76, v19, v75
  v_fmac_f32_e64 v84, v20, v83
  v_fmac_f32_dpp v52, v51, v21 quad_perm:[1,0,3,2] row_mask:0xf bank_mask:0xf
  v_fmac_f32_dpp v60, v59, v22 quad_perm:[1,0,3,2] row_mask:0xf bank_mask:0xf
  v_fmac_f32_dpp v68, v67, v23 quad_perm:[1,0,3,2] row_mask:0xf bank_mask:0xf
  v_fmac_f32_dpp v76, v75, v24 quad_perm:[1,0,3,2] row_mask:0xf bank_mask:0xf
  v_fmac_f32_dpp v84, v83, v25 quad_perm:[1,0,3,2] row_mask:0xf bank_mask:0xf
  v_fmac_f32 v53, v16, v52
  v_fmac_f32 v61, v17, v60
  v_fmac_f32 v69, v18, v68
  v_fmac_f32 v77, v19, v76
  v_fmac_f32_e64 v85, v20, v84
  v_fmac_f32_dpp v53, v52, v21 quad_perm:[1,0,3,2] row_mask:0xf bank_mask:0xf
  v_fmac_f32_dpp v61, v60, v22 quad_perm:[1,0,3,2] row_mask:0xf bank_mask:0xf
  v_fmac_f32_dpp v69, v68, v23 quad_perm:[1,0,3,2] row_mask:0xf bank_mask:0xf
  v_fmac_f32_dpp v77, v76, v24 quad_perm:[1,0,3,2] row_mask:0xf bank_mask:0xf
  v_fmac_f32_dpp v85, v84, v25 quad_perm:[1,0,3,2] row_mask:0xf bank_mask:0xf
  v_fmac_f32 v54, v16, v53
  v_fmac_f32 v62, v17, v61
  v_fmac_f32 v70, v18, v69
  v_fmac_f32 v78, v19, v77
  v_fmac_f32_e64 v86, v20, v85
  v_fmac_f32_dpp v54, v53, v21 quad_perm:[1,0,3,2] row_mask:0xf bank_mask:0xf
  v_fmac_f32_dpp v62, v61, v22 quad_perm:[1,0,3,2] row_mask:0xf bank_mask:0xf
  v_fmac_f32_dpp v70, v69, v23 quad_perm:[1,0,3,2] row_mask:0xf bank_mask:0xf
  v_fmac_f32_dpp v78, v77, v24 quad_perm:[1,0,3,2] row_mask:0xf bank_mask:0xf
  v_fmac_f32_dpp v86, v85, v25 quad_perm:[1,0,3,2] row_mask:0xf bank_mask:0xf
  v_fmac_f32 v55, v16, v54
  v_fmac_f32 v63, v17, v62
  v_fmac_f32 v71, v18, v70
  v_fmac_f32 v79, v19, v78
  v_fmac_f32_e64 v87, v20, v86
  v_fmac_f32_dpp v55, v54, v21 quad_perm:[1,0,3,2] row_mask:0xf bank_mask:0xf
  v_fmac_f32_dpp v63, v62, v22 quad_perm:[1,0,3,2] row_mask:0xf bank_mask:0xf
  v_fmac_f32_dpp v71, v70, v23 quad_perm:[1,0,3,2] row_mask:0xf bank_mask:0xf
  v_fmac_f32_dpp v79, v78, v24 quad_perm:[1,0,3,2] row_mask:0xf bank_mask:0xf
  v_fmac_f32_dpp v87, v86, v25 quad_perm:[1,0,3,2] row_mask:0xf bank_mask:0xf
  v_add_u32 v11, 152320, v9
  v_min_u32 v12, 39, v1
  v_mul_u32_u24 v44, 48, v12
  s_lshl_b32 s12, s7, 3
  s_add_u32 s12, s12, 149504
  v_add_u32 v44, s12, v44
  ds_write_b32 v11, v55 offset:0
  ds_write_b32 v11, v63 offset:1152
  ds_write_b32 v11, v71 offset:2304
  ds_write_b32 v11, v79 offset:3456
  ds_write_b32 v11, v87 offset:4608
  v_mul_u32_u24 v46, 144, v12
  v_add_u32 v46, 152320, v46
  s_waitcnt lgkmcnt(0)
  s_barrier
  ds_read_b128 v[90:93], v46 offset:0
  ds_read_b128 v[94:97], v46 offset:16
  ds_read_b128 v[98:101], v46 offset:32
  ds_read_b128 v[102:105], v46 offset:48
  ds_read_b128 v[106:109], v46 offset:64
  ds_read_b128 v[110:113], v46 offset:80
  ds_read_b128 v[114:117], v46 offset:96
  ds_read_b128 v[118:121], v46 offset:112
  s_waitcnt lgkmcnt(7)
  v_pk_fma_f32 v[92:93], v[90:91], v[36:37], v[92:93] op_sel:[1,1,0] op_sel_hi:[0,1,1] neg_lo:[0,1,0]
  v_pk_fma_f32 v[92:93], v[90:91], v[36:37], v[92:93] op_sel:[0,0,0] op_sel_hi:[1,0,1]
  s_waitcnt lgkmcnt(6)
  v_pk_fma_f32 v[94:95], v[92:93], v[36:37], v[94:95] op_sel:[1,1,0] op_sel_hi:[0,1,1] neg_lo:[0,1,0]
  v_pk_fma_f32 v[94:95], v[92:93], v[36:37], v[94:95] op_sel:[0,0,0] op_sel_hi:[1,0,1]
  v_pk_fma_f32 v[96:97], v[94:95], v[36:37], v[96:97] op_sel:[1,1,0] op_sel_hi:[0,1,1] neg_lo:[0,1,0]
  v_pk_fma_f32 v[96:97], v[94:95], v[36:37], v[96:97] op_sel:[0,0,0] op_sel_hi:[1,0,1]
  s_waitcnt lgkmcnt(5)
  v_pk_fma_f32 v[98:99], v[96:97], v[36:37], v[98:99] op_sel:[1,1,0] op_sel_hi:[0,1,1] neg_lo:[0,1,0]
  v_pk_fma_f32 v[98:99], v[96:97], v[36:37], v[98:99] op_sel:[0,0,0] op_sel_hi:[1,0,1]
  v_pk_fma_f32 v[100:101], v[98:99], v[36:37], v[100:101] op_sel:[1,1,0] op_sel_hi:[0,1,1] neg_lo:[0,1,0]
  v_pk_fma_f32 v[100:101], v[98:99], v[36:37], v[100:101] op_sel:[0,0,0] op_sel_hi:[1,0,1]
  s_waitcnt lgkmcnt(4)
  v_pk_fma_f32 v[102:103], v[100:101], v[36:37], v[102:103] op_sel:[1,1,0] op_sel_hi:[0,1,1] neg_lo:[0,1,0]
  v_pk_fma_f32 v[102:103], v[100:101], v[36:37], v[102:103] op_sel:[0,0,0] op_sel_hi:[1,0,1]
  v_pk_fma_f32 v[104:105], v[102:103], v[36:37], v[104:105] op_sel:[1,1,0] op_sel_hi:[0,1,1] neg_lo:[0,1,0]
  v_pk_fma_f32 v[104:105], v[102:103], v[36:37], v[104:105] op_sel:[0,0,0] op_sel_hi:[1,0,1]
  s_waitcnt lgkmcnt(3)
  v_pk_fma_f32 v[106:107], v[104:105], v[36:37], v[106:107] op_sel:[1,1,0] op_sel_hi:[0,1,1] neg_lo:[0,1,0]
  v_pk_fma_f32 v[106:107], v[104:105], v[36:37], v[106:107] op_sel:[0,0,0] op_sel_hi:[1,0,1]
  v_pk_fma_f32 v[108:109], v[106:107], v[36:37], v[108:109] op_sel:[1,1,0] op_sel_hi:[0,1,1] neg_lo:[0,1,0]
  v_pk_fma_f32 v[108:109], v[106:107], v[36:37], v[108:109] op_sel:[0,0,0] op_sel_hi:[1,0,1]
  s_waitcnt lgkmcnt(2)
  v_pk_fma_f32 v[110:111], v[108:109], v[36:37], v[110:111] op_sel:[1,1,0] op_sel_hi:[0,1,1] neg_lo:[0,1,0]
  v_pk_fma_f32 v[110:111], v[108:109], v[36:37], v[110:111] op_sel:[0,0,0] op_sel_hi:[1,0,1]
  v_pk_fma_f32 v[112:113], v[110:111], v[36:37], v[112:113] op_sel:[1,1,0] op_sel_hi:[0,1,1] neg_lo:[0,1,0]
  v_pk_fma_f32 v[112:113], v[110:111], v[36:37], v[112:113] op_sel:[0,0,0] op_sel_hi:[1,0,1]
  s_waitcnt lgkmcnt(1)
  v_pk_fma_f32 v[114:115], v[112:113], v[36:37], v[114:115] op_sel:[1,1,0] op_sel_hi:[0,1,1] neg_lo:[0,1,0]
  v_pk_fma_f32 v[114:115], v[112:113], v[36:37], v[114:115] op_sel:[0,0,0] op_sel_hi:[1,0,1]
  v_pk_fma_f32 v[116:117], v[114:115], v[36:37], v[116:117] op_sel:[1,1,0] op_sel_hi:[0,1,1] neg_lo:[0,1,0]
  v_pk_fma_f32 v[116:117], v[114:115], v[36:37], v[116:117] op_sel:[0,0,0] op_sel_hi:[1,0,1]
  s_waitcnt lgkmcnt(0)
  v_pk_fma_f32 v[118:119], v[116:117], v[36:37], v[118:119] op_sel:[1,1,0] op_sel_hi:[0,1,1] neg_lo:[0,1,0]
  v_pk_fma_f32 v[118:119], v[116:117], v[36:37], v[118:119] op_sel:[0,0,0] op_sel_hi:[1,0,1]
  v_pk_fma_f32 v[120:121], v[118:119], v[36:37], v[120:121] op_sel:[1,1,0] op_sel_hi:[0,1,1] neg_lo:[0,1,0]
  v_pk_fma_f32 v[120:121], v[118:119], v[36:37], v[120:121] op_sel:[0,0,0] op_sel_hi:[1,0,1]
  v_mov_b32 v122, s8
  v_mov_b32 v123, s8
  s_add_u32 s12, s83, 337920
  s_mov_b64 exec, s[96:97]
  buffer_store_dwordx4 v[120:123], v2, s[52:55], s12 offen sc1
  s_mov_b64 exec, -1
  v_subrev_u32 v46, 8576, v46
  v_mov_b32 v88, 0
  v_mov_b32 v89, 0
  s_mov_b32 exec_hi, 0xff
  s_cmp_eq_u32 s7, 1
  s_cbranch_scc1 w1_64
  s_cmp_eq_u32 s7, 2
  s_cbranch_scc1 w2_65
  s_cmp_eq_u32 s7, 3
  s_cbranch_scc1 w3_66
w0_63:
  ds_write_b128 v46, v[88:91] offset:0
  ds_write_b128 v46, v[92:95] offset:16
  s_branch join_62
w1_64:
  ds_write_b128 v46, v[96:99] offset:32
  ds_write_b128 v46, v[100:103] offset:48
  s_branch join_62
w2_65:
  ds_write_b128 v46, v[104:107] offset:64
  ds_write_b128 v46, v[108:111] offset:80
  s_branch join_62
w3_66:
  ds_write_b128 v46, v[112:115] offset:96
  ds_write_b128 v46, v[116:119] offset:112
join_62:
  s_mov_b32 exec_hi, -1
  v_add_u32 v46, 143744, v9
  ds_read_b32 v244, v46 offset:0
  ds_read_b32 v246, v46 offset:1152
  ds_read_b32 v248, v46 offset:2304
  ds_read_b32 v250, v46 offset:3456
  ds_read_b32 v252, v46 offset:4608
  v_and_b32 v43, 1, v3
  v_cvt_f32_u32 v43, v43
  v_fma_f32 v43, 2.0, v43, -1.0
  s_waitcnt lgkmcnt(0)
  s_nop 0
  v_mul_f32_dpp v245, v244, v43 quad_perm:[1,0,3,2] row_mask:0xf bank_mask:0xf
  v_mul_f32_dpp v247, v246, v43 quad_perm:[1,0,3,2] row_mask:0xf bank_mask:0xf
  v_mul_f32_dpp v249, v248, v43 quad_perm:[1,0,3,2] row_mask:0xf bank_mask:0xf
  v_mul_f32_dpp v251, v250, v43 quad_perm:[1,0,3,2] row_mask:0xf bank_mask:0xf
  v_mul_f32_dpp v253, v252, v43 quad_perm:[1,0,3,2] row_mask:0xf bank_mask:0xf
  s_and_b32 vcc_lo, s1, 7
  s_lshl_b32 vcc_lo, vcc_lo, 2
  s_add_u32 vcc_lo, vcc_lo, s7
  s_lshl_b32 vcc_lo, vcc_lo, 11
  v_lshl_add_u32 v15, v3, 7, vcc_lo
  v_min_u32 v15, L_codeend-L_pc-4, v15
  s_mov_b64 exec, 0xffff
  global_load_dword a250, v15, s[98:99]
  s_mov_b64 exec, -1
  s_lshl_b32 s90, s7, 2
  s_sub_u32 s90, 12, s90
  s_mul_i32 s90, s90, 640
  s_add_u32 s90, s90, s83
  s_add_u32 s90, s90, 327680
  v_min_u32 v42, 39, v1
  v_lshlrev_b32 v42, 4, v42
  buffer_load_dwordx3 v[88:90], v42, s[52:55], s90 offen offset:0 sc1
  buffer_load_dwordx3 v[92:94], v42, s[52:55], s90 offen offset:640 sc1
  buffer_load_dwordx3 v[96:98], v42, s[52:55], s90 offen offset:1280 sc1
  buffer_load_dwordx3 v[100:102], v42, s[52:55], s90 offen offset:1920 sc1
  v_lshrrev_b32_e64 v11, 1, v3
  v_mul_u32_u24 v12, 80, v11
  v_add_u32 v12, 160640, v12
  v_mul_u32_u24_e64 v11, 48, v11
  v_add_u32 v11, 149504, v11
  ds_read_b128 v[128:131], v12 offset:0
  ds_read_b128 v[132:135], v12 offset:16
  ds_read_b128 v[136:139], v12 offset:32
  ds_read_b128 v[140:143], v12 offset:48
  ds_read_b128 v[144:147], v12 offset:640
  ds_read_b128 v[148:151], v12 offset:656
  ds_read_b128 v[152:155], v12 offset:672
  ds_read_b128 v[156:159], v12 offset:688
  ds_read_b128 v[160:163], v12 offset:1280
  ds_read_b128 v[164:167], v12 offset:1296
  ds_read_b128 v[168:171], v12 offset:1312
  ds_read_b128 v[172:175], v12 offset:1328
  ds_read_b128 v[176:179], v12 offset:1920
  ds_read_b128 v[180:183], v12 offset:1936
  ds_read_b128 v[184:187], v12 offset:1952
  ds_read_b128 v[188:191], v12 offset:1968
  ds_read_b128 v[104:107], v12 offset:2560
  ds_read_b128 v[108:111], v12 offset:2576
  ds_read_b128 v[112:115], v12 offset:2592
  ds_read_b128 v[116:119], v12 offset:2608
  v_accvgpr_read_b32 v254, a240
  v_accvgpr_read_b32 v255, a241
  v_accvgpr_read_b32 v47, a242
  s_waitcnt vmcnt(0)
  v_min3_u32 v14, v90, v94, s8
  v_max3_u32 v15, v90, v94, s8
  v_min3_u32 v14, v14, v98, v102
  v_max3_u32 v15, v15, v98, v102
  v_cmp_ne_u32 vcc, v14, v15
  s_cbranch_vccz ok_68
again_67:
  buffer_load_dwordx3 v[88:90], v42, s[52:55], s90 offen offset:0 sc1
  buffer_load_dwordx3 v[92:94], v42, s[52:55], s90 offen offset:640 sc1
  buffer_load_dwordx3 v[96:98], v42, s[52:55], s90 offen offset:1280 sc1
  buffer_load_dwordx3 v[100:102], v42, s[52:55], s90 offen offset:1920 sc1
  s_sub_u32 s10, s10, 1
  s_cmp_gt_i32 s10, 0
  s_waitcnt vmcnt(0)
  v_min3_u32 v14, v90, v94, s8
  v_max3_u32 v15, v90, v94, s8
  v_min3_u32 v14, v14, v98, v102
  v_max3_u32 v15, v15, v98, v102
  v_cmp_ne_u32 vcc, v14, v15
  s_cbranch_scc0 out_69
  s_cbranch_vccnz again_67
out_69:
ok_68:
  v_pk_fma_f32 v[92:93], v[88:89], v[38:39], v[92:93] op_sel:[1,1,0] op_sel_hi:[0,1,1] neg_lo:[0,1,0]
  v_pk_fma_f32 v[92:93], v[88:89], v[38:39], v[92:93] op_sel:[0,0,0] op_sel_hi:[1,0,1]
  v_pk_fma_f32 v[96:97], v[92:93], v[38:39], v[96:97] op_sel:[1,1,0] op_sel_hi:[0,1,1] neg_lo:[0,1,0]
  v_pk_fma_f32 v[96:97], v[92:93], v[38:39], v[96:97] op_sel:[0,0,0] op_sel_hi:[1,0,1]
  v_pk_fma_f32 v[100:101], v[96:97], v[38:39], v[100:101] op_sel:[1,1,0] op_sel_hi:[0,1,1] neg_lo:[0,1,0]
  v_pk_fma_f32 v[100:101], v[96:97], v[38:39], v[100:101] op_sel:[0,0,0] op_sel_hi:[1,0,1]
  v_pk_mul_f32 v[88:89], v[100:101], v[40:41] op_sel:[1,1] op_sel_hi:[0,1] neg_lo:[0,1]
  v_pk_fma_f32 v[88:89], v[100:101], v[40:41], v[88:89] op_sel:[0,0,0] op_sel_hi:[1,0,1]
  s_mov_b32 exec_hi, 0xff
  ds_write_b64 v44, v[88:89]
  s_mov_b32 exec_hi, -1
  s_waitcnt lgkmcnt(0)
  s_barrier
  ds_read_b128 v[88:91], v11 offset:0
  ds_read_b128 v[92:95], v11 offset:16
  ds_read_b128 v[96:99], v11 offset:384
  ds_read_b128 v[100:103], v11 offset:400
  ds_read_b128 v[224:227], v11 offset:768
  ds_read_b128 v[228:231], v11 offset:784
  s_waitcnt lgkmcnt(4)
  v_pk_add_f32 v[88:89], v[88:89], v[90:91]
  v_pk_add_f32 v[92:93], v[92:93], v[94:95]
  v_pk_add_f32 v[88:89], v[88:89], v[92:93]
  v_pk_fma_f32 v[244:245], v[26:27], v[88:89], v[244:245] op_sel:[0,0,0] op_sel_hi:[1,0,1]
  v_pk_fma_f32 v[244:245], v[26:27], v[88:89], v[244:245] op_sel:[1,1,0] op_sel_hi:[0,1,1] neg_hi:[1,0,0]
  ds_read_b128 v[88:91], v11 offset:1152
  ds_read_b128 v[92:95], v11 offset:1168
  s_waitcnt lgkmcnt(4)
  v_pk_add_f32 v[96:97], v[96:97], v[98:99]
  v_pk_add_f32 v[100:101], v[100:101], v[102:103]
  v_pk_add_f32 v[96:97], v[96:97], v[100:101]
  v_pk_fma_f32 v[246:247], v[28:29], v[96:97], v[246:247] op_sel:[0,0,0] op_sel_hi:[1,0,1]
  v_pk_fma_f32 v[246:247], v[28:29], v[96:97], v[246:247] op_sel:[1,1,0] op_sel_hi:[0,1,1] neg_hi:[1,0,0]
  ds_read_b128 v[96:99], v11 offset:1536
  ds_read_b128 v[100:103], v11 offset:1552
  v_pk_fma_f32 v[48:49], v[128:129], v[244:245], v[48:49] op_sel:[0,0,0] op_sel_hi:[1,0,1]
  v_pk_fma_f32 v[50:51], v[130:131], v[244:245], v[50:51] op_sel:[0,0,0] op_sel_hi:[1,0,1]
  v_pk_fma_f32 v[52:53], v[132:133], v[244:245], v[52:53] op_sel:[0,0,0] op_sel_hi:[1,0,1]
  v_pk_fma_f32 v[54:55], v[134:135], v[244:245], v[54:55] op_sel:[0,0,0] op_sel_hi:[1,0,1]
  v_pk_fma_f32 v[48:49], v[136:137], v[244:245], v[48:49] op_sel:[0,1,0] op_sel_hi:[1,1,1]
  v_pk_fma_f32 v[50:51], v[138:139], v[244:245], v[50:51] op_sel:[0,1,0] op_sel_hi:[1,1,1]
  v_pk_fma_f32 v[52:53], v[140:141], v[244:245], v[52:53] op_sel:[0,1,0] op_sel_hi:[1,1,1]
  v_pk_fma_f32 v[54:55], v[142:143], v[244:245], v[54:55] op_sel:[0,1,0] op_sel_hi:[1,1,1]
  v_cvt_pk_bf16_f32 v120, v48, v49
  v_cvt_pk_bf16_f32 v121, v50, v51
  v_cvt_pk_bf16_f32 v122, v52, v53
  v_cvt_pk_bf16_f32 v123, v54, v55
  ds_write_b128 v254, v[120:123]
  ds_read_b64_tr_b16 v[52:53], v255
  ds_read_b64_tr_b16 v[54:55], v255 offset:640
  s_waitcnt lgkmcnt(7)
  v_pk_add_f32 v[224:225], v[224:225], v[226:227]
  v_pk_add_f32 v[228:229], v[228:229], v[230:231]
  v_pk_add_f32 v[224:225], v[224:225], v[228:229]
  v_pk_fma_f32 v[248:249], v[30:31], v[224:225], v[248:249] op_sel:[0,0,0] op_sel_hi:[1,0,1]
  v_pk_fma_f32 v[248:249], v[30:31], v[224:225], v[248:249] op_sel:[1,1,0] op_sel_hi:[0,1,1] neg_hi:[1,0,0]
  v_pk_fma_f32 v[56:57], v[144:145], v[246:247], v[56:57] op_sel:[0,0,0] op_sel_hi:[1,0,1]
  v_pk_fma_f32 v[58:59], v[146:147], v[246:247], v[58:59] op_sel:[0,0,0] op_sel_hi:[1,0,1]
  v_pk_fma_f32 v[60:61], v[148:149], v[246:247], v[60:61] op_sel:[0,0,0] op_sel_hi:[1,0,1]
  v_pk_fma_f32 v[62:63], v[150:151], v[246:247], v[62:63] op_sel:[0,0,0] op_sel_hi:[1,0,1]
  v_pk_fma_f32 v[56:57], v[152:153], v[246:247], v[56:57] op_sel:[0,1,0] op_sel_hi:[1,1,1]
  v_pk_fma_f32 v[58:59], v[154:155], v[246:247], v[58:59] op_sel:[0,1,0] op_sel_hi:[1,1,1]
  v_pk_fma_f32 v[60:61], v[156:157], v[246:247], v[60:61] op_sel:[0,1,0] op_sel_hi:[1,1,1]
  v_pk_fma_f32 v[62:63], v[158:159], v[246:247], v[62:63] op_sel:[0,1,0] op_sel_hi:[1,1,1]
  v_cvt_pk_bf16_f32 v124, v56, v57
  v_cvt_pk_bf16_f32 v125, v58, v59
  v_cvt_pk_bf16_f32 v126, v60, v61
  v_cvt_pk_bf16_f32 v127, v62, v63
  ds_write_b128 v254, v[124:127]
  ds_read_b64_tr_b16 v[60:61], v255
  ds_read_b64_tr_b16 v[62:63], v255 offset:640
  s_waitcnt lgkmcnt(8)
  v_pk_add_f32 v[88:89], v[88:89], v[90:91]
  v_pk_add_f32 v[92:93], v[92:93], v[94:95]
  v_pk_add_f32 v[88:89], v[88:89], v[92:93]
  v_pk_fma_f32 v[250:251], v[32:33], v[88:89], v[250:251] op_sel:[0,0,0] op_sel_hi:[1,0,1]
  v_pk_fma_f32 v[250:251], v[32:33], v[88:89], v[250:251] op_sel:[1,1,0] op_sel_hi:[0,1,1] neg_hi:[1,0,0]
  s_add_u32 s13, s78, 0
  s_waitcnt lgkmcnt(3)
  s_cmp_eq_u32 s9, 0
  s_cbranch_scc1 slow_70
  buffer_store_dwordx4 v[52:55], v47, s[60:63], s13 offen
back_71:
  v_pk_fma_f32 v[64:65], v[160:161], v[248:249], v[64:65] op_sel:[0,0,0] op_sel_hi:[1,0,1]
  v_pk_fma_f32 v[66:67], v[162:163], v[248:249], v[66:67] op_sel:[0,0,0] op_sel_hi:[1,0,1]
  v_pk_fma_f32 v[68:69], v[164:165], v[248:249], v[68:69] op_sel:[0,0,0] op_sel_hi:[1,0,1]
  v_pk_fma_f32 v[70:71], v[166:167], v[248:249], v[70:71] op_sel:[0,0,0] op_sel_hi:[1,0,1]
  v_pk_fma_f32 v[64:65], v[168:169], v[248:249], v[64:65] op_sel:[0,1,0] op_sel_hi:[1,1,1]
  v_pk_fma_f32 v[66:67], v[170:171], v[248:249], v[66:67] op_sel:[0,1,0] op_sel_hi:[1,1,1]
  v_pk_fma_f32 v[68:69], v[172:173], v[248:249], v[68:69] op_sel:[0,1,0] op_sel_hi:[1,1,1]
  v_pk_fma_f32 v[70:71], v[174:175], v[248:249], v[70:71] op_sel:[0,1,0] op_sel_hi:[1,1,1]
  v_cvt_pk_bf16_f32 v120, v64, v65
  v_cvt_pk_bf16_f32 v121, v66, v67
  v_cvt_pk_bf16_f32 v122, v68, v69
  v_cvt_pk_bf16_f32 v123, v70, v71
  ds_write_b128 v254, v[120:123]
  ds_read_b64_tr_b16 v[68:69], v255
  ds_read_b64_tr_b16 v[70:71], v255 offset:640
  v_pk_add_f32 v[96:97], v[96:97], v[98:99]
  v_pk_add_f32 v[100:101], v[100:101], v[102:103]
  v_pk_add_f32 v[96:97], v[96:97], v[100:101]
  v_pk_fma_f32 v[252:253], v[34:35], v[96:97], v[252:253] op_sel:[0,0,0] op_sel_hi:[1,0,1]
  v_pk_fma_f32 v[252:253], v[34:35], v[96:97], v[252:253] op_sel:[1,1,0] op_sel_hi:[0,1,1] neg_hi:[1,0,0]
  s_add_u32 s13, s79, 0
  s_waitcnt lgkmcnt(3)
  s_cmp_eq_u32 s9, 0
  s_cbranch_scc1 slow_72
  buffer_store_dwordx4 v[60:63], v47, s[60:63], s13 offen
back_73:
  v_pk_fma_f32 v[72:73], v[176:177], v[250:251], v[72:73] op_sel:[0,0,0] op_sel_hi:[1,0,1]
  v_pk_fma_f32 v[74:75], v[178:179], v[250:251], v[74:75] op_sel:[0,0,0] op_sel_hi:[1,0,1]
  v_pk_fma_f32 v[76:77], v[180:181], v[250:251], v[76:77] op_sel:[0,0,0] op_sel_hi:[1,0,1]
  v_pk_fma_f32 v[78:79], v[182:183], v[250:251], v[78:79] op_sel:[0,0,0] op_sel_hi:[1,0,1]
  v_pk_fma_f32 v[72:73], v[184:185], v[250:251], v[72:73] op_sel:[0,1,0] op_sel_hi:[1,1,1]
  v_pk_fma_f32 v[74:75], v[186:187], v[250:251], v[74:75] op_sel:[0,1,0] op_sel_hi:[1,1,1]
  v_pk_fma_f32 v[76:77], v[188:189], v[250:251], v[76:77] op_sel:[0,1,0] op_sel_hi:[1,1,1]
  v_pk_fma_f32 v[78:79], v[190:191], v[250:251], v[78:79] op_sel:[0,1,0] op_sel_hi:[1,1,1]
  v_cvt_pk_bf16_f32 v124, v72, v73
  v_cvt_pk_bf16_f32 v125, v74, v75
  v_cvt_pk_bf16_f32 v126, v76, v77
  v_cvt_pk_bf16_f32 v127, v78, v79
  ds_write_b128 v254, v[124:127]
  ds_read_b64_tr_b16 v[76:77], v255
  ds_read_b64_tr_b16 v[78:79], v255 offset:640
  s_add_u32 s13, s80, 0
  s_waitcnt lgkmcnt(3)
  s_cmp_eq_u32 s9, 0
  s_cbranch_scc1 slow_74
  buffer_store_dwordx4 v[68:71], v47, s[60:63], s13 offen
back_75:
  v_pk_fma_f32 v[80:81], v[104:105], v[252:253], v[80:81] op_sel:[0,0,0] op_sel_hi:[1,0,1]
  v_pk_fma_f32 v[82:83], v[106:107], v[252:253], v[82:83] op_sel:[0,0,0] op_sel_hi:[1,0,1]
  v_pk_fma_f32 v[84:85], v[108:109], v[252:253], v[84:85] op_sel:[0,0,0] op_sel_hi:[1,0,1]
  v_pk_fma_f32 v[86:87], v[110:111], v[252:253], v[86:87] op_sel:[0,0,0] op_sel_hi:[1,0,1]
  v_pk_fma_f32 v[80:81], v[112:113], v[252:253], v[80:81] op_sel:[0,1,0] op_sel_hi:[1,1,1]
  v_pk_fma_f32 v[82:83], v[114:115], v[252:253], v[82:83] op_sel:[0,1,0] op_sel_hi:[1,1,1]
  v_pk_fma_f32 v[84:85], v[116:117], v[252:253], v[84:85] op_sel:[0,1,0] op_sel_hi:[1,1,1]
  v_pk_fma_f32 v[86:87], v[118:119], v[252:253], v[86:87] op_sel:[0,1,0] op_sel_hi:[1,1,1]
  v_cvt_pk_bf16_f32 v120, v80, v81
  v_cvt_pk_bf16_f32 v121, v82, v83
  v_cvt_pk_bf16_f32 v122, v84, v85
  v_cvt_pk_bf16_f32 v123, v86, v87
  ds_write_b128 v254, v[120:123]
  ds_read_b64_tr_b16 v[84:85], v255
  ds_read_b64_tr_b16 v[86:87], v255 offset:640
  s_add_u32 s13, s81, 0
  s_waitcnt lgkmcnt(3)
  s_cmp_eq_u32 s9, 0
  s_cbranch_scc1 slow_76
  buffer_store_dwordx4 v[76:79], v47, s[60:63], s13 offen
back_77:
  s_add_u32 s13, s82, 0
  s_waitcnt lgkmcnt(0)
  s_cmp_eq_u32 s9, 0
  s_cbranch_scc1 slow_78
  buffer_store_dwordx4 v[84:87], v47, s[60:63], s13 offen
back_79:
  s_mul_i32 s13, s5, 163840
  s_mul_i32 s14, s7, 10240
  s_add_u32 s13, s13, s14
  s_add_u32 s13, s13, 0
  s_add_u32 s14, s7, 1
  s_and_b32 s14, s14, 3
  s_mul_i32 s15, s14, 40960
  s_add_u32 s16, s15, s13
  s_mul_i32 s15, s14, 10240
  s_add_u32 s15, s15, 102400
  v_add_u32 v44, s15, v2
  s_add_u32 s14, s7, 2
  s_and_b32 s14, s14, 3
  s_mul_i32 s15, s14, 40960
  s_add_u32 s17, s15, s13
  s_mul_i32 s15, s14, 10240
  s_add_u32 s15, s15, 107520
  v_add_u32 v45, s15, v2
  s_add_u32 s14, s7, 3
  s_and_b32 s14, s14, 3
  s_mul_i32 s15, s14, 40960
  s_add_u32 s18, s15, s13
  s_mul_i32 s15, s14, 5120
  v_add_u32 v46, s15, v2
  s_add_u32 s14, s7, 4
  s_and_b32 s14, s14, 3
  s_mul_i32 s15, s14, 40960
  s_add_u32 s19, s15, s13
  s_lshl_b32 s49, s3, 10
  s_lshl_b32 s13, s7, 6
  s_add_u32 s49, s49, s13
  s_and_b32 s13, s5, 1
  s_lshl_b32 s13, s13, 3
  s_add_u32 s49, s49, s13
  s_add_u32 s49, s49, 4608
  v_and_b32 v244, 3, v1
  v_lshlrev_b32 v244, 4, v244
  s_waitcnt vmcnt(0)
  s_add_u32 s14, s84, 4608
  v_mov_b32 v15, s8
  s_mov_b64 exec, 1
  s_cmp_eq_u32 s9, 0
  s_cbranch_scc1 slow_80
  buffer_store_dword v15, off, s[52:55], s14
back_81:
  s_mov_b64 exec, -1
  s_mul_i32 s12, s7, 2560
  s_add_u32 s12, s12, 24576
  v_lshlrev_b32 v11, 5, v3
  v_lshl_add_u32 v11, v4, 3, v11
  v_add_u32_e64 v11, s12, v11
  v_lshl_add_u32 v12, v1, 3, s12
  ds_write_b64 v11, a[200:201] offset:0
  ds_write_b64 v11, a[202:203] offset:512
  ds_write_b64 v11, a[204:205] offset:1024
  ds_write_b64 v11, a[206:207] offset:1536
  ds_write_b64 v11, a[208:209] offset:2048
  ds_read_b64 v[232:233], v12 offset:0
  ds_read_b64 v[234:235], v12 offset:512
  ds_read_b64 v[236:237], v12 offset:1024
  ds_read_b64 v[238:239], v12 offset:1536
  ds_read_b64 v[240:241], v12 offset:2048
  v_accvgpr_read_b32 v108, a210
  v_accvgpr_read_b32 v109, a211
  v_accvgpr_read_b32 v110, a212
  v_accvgpr_read_b32 v111, a213
  v_accvgpr_read_b32 v112, a214
  v_accvgpr_read_b32 v113, a215
  v_accvgpr_read_b32 v114, a216
  v_accvgpr_read_b32 v115, a217
  v_accvgpr_read_b32 v116, a218
  v_accvgpr_read_b32 v117, a219
  v_accvgpr_read_b32 v118, a220
  v_accvgpr_read_b32 v119, a221
  v_accvgpr_read_b32 v120, a222
  v_accvgpr_read_b32 v121, a223
  v_accvgpr_read_b32 v122, a224
  v_accvgpr_read_b32 v123, a225
  v_accvgpr_read_b32 v124, a226
  v_accvgpr_read_b32 v125, a227
  v_accvgpr_read_b32 v126, a228
  v_accvgpr_read_b32 v127, a229
  s_waitcnt lgkmcnt(0)
  v_lshlrev_b32 v88, 16, v232
  v_and_b32 v89, 0xffff0000, v232
  v_lshlrev_b32_e64 v90, 16, v233
  v_and_b32 v91, 0xffff0000, v233
  v_lshlrev_b32_e64 v92, 16, v234
  v_and_b32 v93, 0xffff0000, v234
  v_lshlrev_b32_e64 v94, 16, v235
  v_and_b32 v95, 0xffff0000, v235
  v_lshlrev_b32_e64 v96, 16, v236
  v_and_b32 v97, 0xffff0000, v236
  v_lshlrev_b32_e64 v98, 16, v237
  v_and_b32 v99, 0xffff0000, v237
  v_lshlrev_b32_e64 v100, 16, v238
  v_and_b32 v101, 0xffff0000, v238
  v_lshlrev_b32_e64 v102, 16, v239
  v_and_b32 v103, 0xffff0000, v239
  v_lshlrev_b32_e64 v104, 16, v240
  v_and_b32 v105, 0xffff0000, v240
  v_lshlrev_b32_e64 v106, 16, v241
  v_and_b32 v107, 0xffff0000, v241
again_82:
  buffer_load_dwordx2 v[42:43], v244, s[52:55], s49 offen sc1
  s_sub_u32 s10, s10, 1
  s_cmp_gt_i32 s10, 0
  s_waitcnt vmcnt(0)
  v_xor_b32 v15, s8, v42
  v_xor_b32 v14, s8, v43
  v_or_b32 v15, v15, v14
  v_cmp_ne_u32 vcc, 0, v15
  s_cbranch_scc0 out_84
  s_cbranch_vccnz again_82
out_84:
ok_83:
  buffer_load_dwordx4 v[128:131], v2, s[60:63], s16 offen offset:0 sc1
  buffer_load_dwordx4 v[132:135], v2, s[60:63], s16 offen offset:1024 sc1
  buffer_load_dwordx4 v[136:139], v2, s[60:63], s16 offen offset:2048 sc1
  buffer_load_dwordx4 v[140:143], v2, s[60:63], s16 offen offset:3072 sc1
  s_add_u32 s16, s16, 4096
  buffer_load_dwordx4 v[144:147], v2, s[60:63], s16 offen offset:0 sc1
  buffer_load_dwordx4 v[148:151], v2, s[60:63], s16 offen offset:1024 sc1
  buffer_load_dwordx4 v[152:155], v2, s[60:63], s16 offen offset:2048 sc1
  buffer_load_dwordx4 v[156:159], v2, s[60:63], s16 offen offset:3072 sc1
  s_waitcnt vmcnt(7)
  v_mfma_f32_16x16x32_bf16 v[48:51], a[0:3], v[128:131], 0
  s_add_u32 s16, s16, 4096
  buffer_load_dwordx4 v[160:163], v2, s[60:63], s16 offen offset:0 sc1
  v_mfma_f32_16x16x32_bf16 v[52:55], a[4:7], v[128:131], 0
  v_mfma_f32_16x16x32_bf16 v[56:59], a[8:11], v[128:131], 0
  v_mfma_f32_16x16x32_bf16 v[60:63], a[12:15], v[128:131], 0
  v_mfma_f32_16x16x32_bf16 v[64:67], a[16:19], v[128:131], 0
  s_waitcnt vmcnt(7)
  v_mfma_f32_16x16x32_bf16 v[48:51], a[20:23], v[132:135], v[48:51]
  buffer_load_dwordx4 v[164:167], v2, s[60:63], s16 offen offset:1024 sc1
  v_mfma_f32_16x16x32_bf16 v[52:55], a[24:27], v[132:135], v[52:55]
  v_mfma_f32_16x16x32_bf16 v[56:59], a[28:31], v[132:135], v[56:59]
  v_mfma_f32_16x16x32_bf16 v[60:63], a[32:35], v[132:135], v[60:63]
  v_mfma_f32_16x16x32_bf16 v[64:67], a[36:39], v[132:135], v[64:67]
  s_waitcnt vmcnt(7)
  v_mfma_f32_16x16x32_bf16 v[48:51], a[40:43], v[136:139], v[48:51]
  buffer_load_dwordx4 v[168:171], v2, s[60:63], s17 offen offset:0 sc1
  v_mfma_f32_16x16x32_bf16 v[52:55], a[44:47], v[136:139], v[52:55]
  v_mfma_f32_16x16x32_bf16 v[56:59], a[48:51], v[136:139], v[56:59]
  v_mfma_f32_16x16x32_bf16 v[60:63], a[52:55], v[136:139], v[60:63]
  v_mfma_f32_16x16x32_bf16 v[64:67], a[56:59], v[136:139], v[64:67]
  s_waitcnt vmcnt(7)
  v_mfma_f32_16x16x32_bf16 v[48:51], a[60:63], v[140:143], v[48:51]
  buffer_load_dwordx4 v[172:175], v2, s[60:63], s17 offen offset:1024 sc1
  v_mfma_f32_16x16x32_bf16 v[52:55], a[64:67], v[140:143], v[52:55]
  v_mfma_f32_16x16x32_bf16 v[56:59], a[68:71], v[140:143], v[56:59]
  v_mfma_f32_16x16x32_bf16 v[60:63], a[72:75], v[140:143], v[60:63]
  v_mfma_f32_16x16x32_bf16 v[64:67], a[76:79], v[140:143], v[64:67]
  s_waitcnt vmcnt(7)
  v_mfma_f32_16x16x32_bf16 v[48:51], a[80:83], v[144:147], v[48:51]
  buffer_load_dwordx4 v[176:179], v2, s[60:63], s17 offen offset:2048 sc1
  v_mfma_f32_16x16x32_bf16 v[52:55], a[84:87], v[144:147], v[52:55]
  v_mfma_f32_16x16x32_bf16 v[56:59], a[88:91], v[144:147], v[56:59]
  v_mfma_f32_16x16x32_bf16 v[60:63], a[92:95], v[144:147], v[60:63]
  v_mfma_f32_16x16x32_bf16 v[64:67], a[96:99], v[144:147], v[64:67]
  s_waitcnt vmcnt(7)
  v_mfma_f32_16x16x32_bf16 v[48:51], a[100:103], v[148:151], v[48:51]
  buffer_load_dwordx4 v[180:183], v2, s[60:63], s17 offen offset:3072 sc1
  v_mfma_f32_16x16x32_bf16 v[52:55], a[104:107], v[148:151], v[52:55]
  v_mfma_f32_16x16x32_bf16 v[56:59], a[108:111], v[148:151], v[56:59]
  v_mfma_f32_16x16x32_bf16 v[60:63], a[112:115], v[148:151], v[60:63]
  v_mfma_f32_16x16x32_bf16 v[64:67], a[116:119], v[148:151], v[64:67]
  s_waitcnt vmcnt(7)
  v_mfma_f32_16x16x32_bf16 v[48:51], a[120:123], v[152:155], v[48:51]
  s_add_u32 s17, s17, 4096
  buffer_load_dwordx4 v[184:187], v2, s[60:63], s17 offen offset:0 sc1
  v_mfma_f32_16x16x32_bf16 v[52:55], a[124:127], v[152:155], v[52:55]
  v_mfma_f32_16x16x32_bf16 v[56:59], a[128:131], v[152:155], v[56:59]
  v_mfma_f32_16x16x32_bf16 v[60:63], a[132:135], v[152:155], v[60:63]
  v_mfma_f32_16x16x32_bf16 v[64:67], a[136:139], v[152:155], v[64:67]
  s_waitcnt vmcnt(7)
  v_mfma_f32_16x16x32_bf16 v[48:51], a[140:143], v[156:159], v[48:51]
  buffer_load_dwordx4 v[188:191], v2, s[60:63], s17 offen offset:1024 sc1
  v_mfma_f32_16x16x32_bf16 v[52:55], a[144:147], v[156:159], v[52:55]
  v_mfma_f32_16x16x32_bf16 v[56:59], a[148:151], v[156:159], v[56:59]
  v_mfma_f32_16x16x32_bf16 v[60:63], a[152:155], v[156:159], v[60:63]
  v_mfma_f32_16x16x32_bf16 v[64:67], a[156:159], v[156:159], v[64:67]
  s_waitcnt vmcnt(7)
  v_mfma_f32_16x16x32_bf16 v[48:51], a[160:163], v[160:163], v[48:51]
  buffer_load_dwordx4 v[128:131], v2, s[60:63], s17 offen offset:2048 sc1
  v_mfma_f32_16x16x32_bf16 v[52:55], a[164:167], v[160:163], v[52:55]
  v_mfma_f32_16x16x32_bf16 v[56:59], a[168:171], v[160:163], v[56:59]
  v_mfma_f32_16x16x32_bf16 v[60:63], a[172:175], v[160:163], v[60:63]
  v_mfma_f32_16x16x32_bf16 v[64:67], a[176:179], v[160:163], v[64:67]
  s_waitcnt vmcnt(7)
  v_mfma_f32_16x16x32_bf16 v[48:51], a[180:183], v[164:167], v[48:51]
  buffer_load_dwordx4 v[132:135], v2, s[60:63], s17 offen offset:3072 sc1
  v_mfma_f32_16x16x32_bf16 v[52:55], a[184:187], v[164:167], v[52:55]
  v_mfma_f32_16x16x32_bf16 v[56:59], a[188:191], v[164:167], v[56:59]
  v_mfma_f32_16x16x32_bf16 v[60:63], a[192:195], v[164:167], v[60:63]
  v_mfma_f32_16x16x32_bf16 v[64:67], a[196:199], v[164:167], v[64:67]
  s_waitcnt vmcnt(7)
  v_mfma_f32_16x16x32_bf16 v[68:71], a[0:3], v[168:171], 0
  s_add_u32 s17, s17, 4096
  buffer_load_dwordx4 v[136:139], v2, s[60:63], s17 offen offset:0 sc1
  v_mfma_f32_16x16x32_bf16 v[72:75], a[4:7], v[168:171], 0
  v_mfma_f32_16x16x32_bf16 v[76:79], a[8:11], v[168:171], 0
  v_mfma_f32_16x16x32_bf16 v[80:83], a[12:15], v[168:171], 0
  v_mfma_f32_16x16x32_bf16 v[84:87], a[16:19], v[168:171], 0
  s_waitcnt vmcnt(7)
  v_mfma_f32_16x16x32_bf16 v[68:71], a[20:23], v[172:175], v[68:71]
  ds_write_b128 v44, v[48:51] offset:0
  v_mfma_f32_16x16x32_bf16 v[72:75], a[24:27], v[172:175], v[72:75]
  ds_write_b128 v44, v[52:55] offset:1024
  v_mfma_f32_16x16x32_bf16 v[76:79], a[28:31], v[172:175], v[76:79]
  buffer_load_dwordx4 v[140:143], v2, s[60:63], s17 offen offset:1024 sc1
  v_mfma_f32_16x16x32_bf16 v[80:83], a[32:35], v[172:175], v[80:83]
  v_mfma_f32_16x16x32_bf16 v[84:87], a[36:39], v[172:175], v[84:87]
  s_waitcnt vmcnt(7)
  v_mfma_f32_16x16x32_bf16 v[68:71], a[40:43], v[176:179], v[68:71]
  ds_write_b128 v44, v[56:59] offset:2048
  v_mfma_f32_16x16x32_bf16 v[72:75], a[44:47], v[176:179], v[72:75]
  ds_write_b128 v44, v[60:63] offset:3072
  v_mfma_f32_16x16x32_bf16 v[76:79], a[48:51], v[176:179], v[76:79]
  buffer_load_dwordx4 v[144:147], v2, s[60:63], s18 offen offset:0 sc1
  v_mfma_f32_16x16x32_bf16 v[80:83], a[52:55], v[176:179], v[80:83]
  v_mfma_f32_16x16x32_bf16 v[84:87], a[56:59], v[176:179], v[84:87]
  s_waitcnt vmcnt(7)
  v_mfma_f32_16x16x32_bf16 v[68:71], a[60:63], v[180:183], v[68:71]
  ds_write_b128 v44, v[64:67] offset:4096
  v_mfma_f32_16x16x32_bf16 v[72:75], a[64:67], v[180:183], v[72:75]
  buffer_load_dwordx4 v[148:151], v2, s[60:63], s18 offen offset:1024 sc1
  v_mfma_f32_16x16x32_bf16 v[76:79], a[68:71], v[180:183], v[76:79]
  v_mfma_f32_16x16x32_bf16 v[80:83], a[72:75], v[180:183], v[80:83]
  v_mfma_f32_16x16x32_bf16 v[84:87], a[76:79], v[180:183], v[84:87]
  s_waitcnt vmcnt(7)
  v_mfma_f32_16x16x32_bf16 v[68:71], a[80:83], v[184:187], v[68:71]
  buffer_load_dwordx4 v[152:155], v2, s[60:63], s18 offen offset:2048 sc1
  v_mfma_f32_16x16x32_bf16 v[72:75], a[84:87], v[184:187], v[72:75]
  v_mfma_f32_16x16x32_bf16 v[76:79], a[88:91], v[184:187], v[76:79]
  v_mfma_f32_16x16x32_bf16 v[80:83], a[92:95], v[184:187], v[80:83]
  v_mfma_f32_16x16x32_bf16 v[84:87], a[96:99], v[184:187], v[84:87]
  s_waitcnt vmcnt(7)
  v_mfma_f32_16x16x32_bf16 v[68:71], a[100:103], v[188:191], v[68:71]
  buffer_load_dwordx4 v[156:159], v2, s[60:63], s18 offen offset:3072 sc1
  v_mfma_f32_16x16x32_bf16 v[72:75], a[104:107], v[188:191], v[72:75]
  v_mfma_f32_16x16x32_bf16 v[76:79], a[108:111], v[188:191], v[76:79]
  v_mfma_f32_16x16x32_bf16 v[80:83], a[112:115], v[188:191], v[80:83]
  v_mfma_f32_16x16x32_bf16 v[84:87], a[116:119], v[188:191], v[84:87]
  s_waitcnt vmcnt(7)
  v_mfma_f32_16x16x32_bf16 v[68:71], a[120:123], v[128:131], v[68:71]
  s_add_u32 s18, s18, 4096
  buffer_load_dwordx4 v[160:163], v2, s[60:63], s18 offen offset:0 sc1
  v_mfma_f32_16x16x32_bf16 v[72:75], a[124:127], v[128:131], v[72:75]
  s_mul_i32 s15, s7, 10240
  v_mfma_f32_16x16x32_bf16 v[76:79], a[128:131], v[128:131], v[76:79]
  s_add_u32 s15, s15, 102400
  v_mfma_f32_16x16x32_bf16 v[80:83], a[132:135], v[128:131], v[80:83]
  v_add_u32_e64 v47, s15, v2
  v_mfma_f32_16x16x32_bf16 v[84:87], a[136:139], v[128:131], v[84:87]
  s_waitcnt vmcnt(7)
  v_mfma_f32_16x16x32_bf16 v[68:71], a[140:143], v[132:135], v[68:71]
  buffer_load_dwordx4 v[164:167], v2, s[60:63], s18 offen offset:1024 sc1
  v_mfma_f32_16x16x32_bf16 v[72:75], a[144:147], v[132:135], v[72:75]
  v_mfma_f32_16x16x32_bf16 v[76:79], a[148:151], v[132:135], v[76:79]
  v_mfma_f32_16x16x32_bf16 v[80:83], a[152:155], v[132:135], v[80:83]
  v_mfma_f32_16x16x32_bf16 v[84:87], a[156:159], v[132:135], v[84:87]
  s_waitcnt vmcnt(7)
  v_mfma_f32_16x16x32_bf16 v[68:71], a[160:163], v[136:139], v[68:71]
  buffer_load_dwordx4 v[168:171], v2, s[60:63], s18 offen offset:2048 sc1
  v_mfma_f32_16x16x32_bf16 v[72:75], a[164:167], v[136:139], v[72:75]
  v_mfma_f32_16x16x32_bf16 v[76:79], a[168:171], v[136:139], v[76:79]
  v_mfma_f32_16x16x32_bf16 v[80:83], a[172:175], v[136:139], v[80:83]
  v_mfma_f32_16x16x32_bf16 v[84:87], a[176:179], v[136:139], v[84:87]
  s_waitcnt vmcnt(7)
  v_mfma_f32_16x16x32_bf16 v[68:71], a[180:183], v[140:143], v[68:71]
  buffer_load_dwordx4 v[172:175], v2, s[60:63], s18 offen offset:3072 sc1
  v_mfma_f32_16x16x32_bf16 v[72:75], a[184:187], v[140:143], v[72:75]
  v_mfma_f32_16x16x32_bf16 v[76:79], a[188:191], v[140:143], v[76:79]
  v_mfma_f32_16x16x32_bf16 v[80:83], a[192:195], v[140:143], v[80:83]
  v_mfma_f32_16x16x32_bf16 v[84:87], a[196:199], v[140:143], v[84:87]
  s_waitcnt vmcnt(7)
  v_mfma_f32_16x16x32_bf16 v[48:51], a[0:3], v[144:147], 0
  s_add_u32 s18, s18, 4096
  buffer_load_dwordx4 v[176:179], v2, s[60:63], s18 offen offset:0 sc1
  v_mfma_f32_16x16x32_bf16 v[52:55], a[4:7], v[144:147], 0
  v_mfma_f32_16x16x32_bf16 v[56:59], a[8:11], v[144:147], 0
  v_mfma_f32_16x16x32_bf16 v[60:63], a[12:15], v[144:147], 0
  v_mfma_f32_16x16x32_bf16 v[64:67], a[16:19], v[144:147], 0
  s_waitcnt vmcnt(7)
  v_mfma_f32_16x16x32_bf16 v[48:51], a[20:23], v[148:151], v[48:51]
  ds_write_b128 v45, v[68:71] offset:0
  v_mfma_f32_16x16x32_bf16 v[52:55], a[24:27], v[148:151], v[52:55]
  ds_write_b128 v45, v[72:75] offset:1024
  v_mfma_f32_16x16x32_bf16 v[56:59], a[28:31], v[148:151], v[56:59]
  buffer_load_dwordx4 v[180:183], v2, s[60:63], s18 offen offset:1024 sc1
  v_mfma_f32_16x16x32_bf16 v[60:63], a[32:35], v[148:151], v[60:63]
  v_mfma_f32_16x16x32_bf16 v[64:67], a[36:39], v[148:151], v[64:67]
  s_waitcnt vmcnt(7)
  v_mfma_f32_16x16x32_bf16 v[48:51], a[40:43], v[152:155], v[48:51]
  ds_write_b128 v45, v[76:79] offset:2048
  v_mfma_f32_16x16x32_bf16 v[52:55], a[44:47], v[152:155], v[52:55]
  ds_write_b128 v45, v[80:83] offset:3072
  v_mfma_f32_16x16x32_bf16 v[56:59], a[48:51], v[152:155], v[56:59]
  buffer_load_dwordx4 v[184:187], v2, s[60:63], s19 offen offset:0 sc1
  v_mfma_f32_16x16x32_bf16 v[60:63], a[52:55], v[152:155], v[60:63]
  v_mfma_f32_16x16x32_bf16 v[64:67], a[56:59], v[152:155], v[64:67]
  s_waitcnt vmcnt(7)
  v_mfma_f32_16x16x32_bf16 v[48:51], a[60:63], v[156:159], v[48:51]
  ds_write_b128 v45, v[84:87] offset:4096
  v_mfma_f32_16x16x32_bf16 v[52:55], a[64:67], v[156:159], v[52:55]
  buffer_load_dwordx4 v[188:191], v2, s[60:63], s19 offen offset:1024 sc1
  v_mfma_f32_16x16x32_bf16 v[56:59], a[68:71], v[156:159], v[56:59]
  v_mfma_f32_16x16x32_bf16 v[60:63], a[72:75], v[156:159], v[60:63]
  v_mfma_f32_16x16x32_bf16 v[64:67], a[76:79], v[156:159], v[64:67]
  s_waitcnt vmcnt(7)
  v_mfma_f32_16x16x32_bf16 v[48:51], a[80:83], v[160:163], v[48:51]
  buffer_load_dwordx4 v[128:131], v2, s[60:63], s19 offen offset:2048 sc1
  s_waitcnt lgkmcnt(0)
  s_barrier
  v_mfma_f32_16x16x32_bf16 v[52:55], a[84:87], v[160:163], v[52:55]
  ds_read_b128 v[192:195], v47 offset:0
  ds_read_b128 v[196:199], v47 offset:1024
  v_mfma_f32_16x16x32_bf16 v[56:59], a[88:91], v[160:163], v[56:59]
  ds_read_b128 v[200:203], v47 offset:2048
  ds_read_b128 v[204:207], v47 offset:3072
  v_mfma_f32_16x16x32_bf16 v[60:63], a[92:95], v[160:163], v[60:63]
  ds_read_b128 v[208:211], v47 offset:4096
  ds_read_b128 v[212:215], v47 offset:5120
  v_mfma_f32_16x16x32_bf16 v[64:67], a[96:99], v[160:163], v[64:67]
  ds_read_b128 v[216:219], v47 offset:6144
  ds_read_b128 v[220:223], v47 offset:7168
  s_waitcnt vmcnt(7)
  v_mfma_f32_16x16x32_bf16 v[48:51], a[100:103], v[164:167], v[48:51]
  buffer_load_dwordx4 v[132:135], v2, s[60:63], s19 offen offset:3072 sc1
  ds_read_b128 v[224:227], v47 offset:8192
  v_mfma_f32_16x16x32_bf16 v[52:55], a[104:107], v[164:167], v[52:55]
  ds_read_b128 v[228:231], v47 offset:9216
  s_waitcnt lgkmcnt(5)
  v_mfma_f32_16x16x32_bf16 v[56:59], a[108:111], v[164:167], v[56:59]
  v_add_f32 v108, v108, v192
  v_add_f32 v109, v109, v193
  v_mfma_f32_16x16x32_bf16 v[60:63], a[112:115], v[164:167], v[60:63]
  v_add_f32 v110, v110, v194
  v_add_f32 v111, v111, v195
  v_mfma_f32_16x16x32_bf16 v[64:67], a[116:119], v[164:167], v[64:67]
  v_add_f32 v112, v112, v196
  v_add_f32 v113, v113, v197
  s_waitcnt vmcnt(7)
  v_mfma_f32_16x16x32_bf16 v[48:51], a[120:123], v[168:171], v[48:51]
  s_add_u32 s19, s19, 4096
  buffer_load_dwordx4 v[136:139], v2, s[60:63], s19 offen offset:0 sc1
  v_add_f32 v114, v114, v198
  v_mfma_f32_16x16x32_bf16 v[52:55], a[124:127], v[168:171], v[52:55]
  v_add_f32 v115, v115, v199
  v_add_f32 v116, v116, v200
  v_mfma_f32_16x16x32_bf16 v[56:59], a[128:131], v[168:171], v[56:59]
  v_add_f32 v117, v117, v201
  v_add_f32 v118, v118, v202
  v_mfma_f32_16x16x32_bf16 v[60:63], a[132:135], v[168:171], v[60:63]
  v_add_f32 v119, v119, v203
  v_add_f32 v120, v120, v204
  v_mfma_f32_16x16x32_bf16 v[64:67], a[136:139], v[168:171], v[64:67]
  v_add_f32 v121, v121, v205
  v_add_f32 v122, v122, v206
  s_waitcnt vmcnt(7)
  v_mfma_f32_16x16x32_bf16 v[48:51], a[140:143], v[172:175], v[48:51]
  buffer_load_dwordx4 v[140:143], v2, s[60:63], s19 offen offset:1024 sc1
  v_add_f32 v123, v123, v207
  v_mfma_f32_16x16x32_bf16 v[52:55], a[144:147], v[172:175], v[52:55]
  v_add_f32 v124, v124, v208
  v_add_f32 v125, v125, v209
  v_mfma_f32_16x16x32_bf16 v[56:59], a[148:151], v[172:175], v[56:59]
  v_add_f32 v126, v126, v210
  v_add_f32 v127, v127, v211
  v_mfma_f32_16x16x32_bf16 v[60:63], a[152:155], v[172:175], v[60:63]
  s_waitcnt lgkmcnt(0)
  v_add_f32 v108, v108, v212
  v_mfma_f32_16x16x32_bf16 v[64:67], a[156:159], v[172:175], v[64:67]
  v_add_f32 v109, v109, v213
  v_add_f32 v110, v110, v214
  s_waitcnt vmcnt(7)
  v_mfma_f32_16x16x32_bf16 v[48:51], a[160:163], v[176:179], v[48:51]
  buffer_load_dwordx4 v[144:147], v2, s[60:63], s19 offen offset:2048 sc1
  v_add_f32 v111, v111, v215
  v_mfma_f32_16x16x32_bf16 v[52:55], a[164:167], v[176:179], v[52:55]
  v_add_f32 v112, v112, v216
  v_add_f32 v113, v113, v217
  v_mfma_f32_16x16x32_bf16 v[56:59], a[168:171], v[176:179], v[56:59]
  v_add_f32 v114, v114, v218
  v_add_f32 v115, v115, v219
  v_mfma_f32_16x16x32_bf16 v[60:63], a[172:175], v[176:179], v[60:63]
  v_add_f32 v116, v116, v220
  v_add_f32 v117, v117, v221
  v_mfma_f32_16x16x32_bf16 v[64:67], a[176:179], v[176:179], v[64:67]
  v_add_f32 v118, v118, v222
  v_add_f32 v119, v119, v223
  s_waitcnt vmcnt(7)
  v_mfma_f32_16x16x32_bf16 v[48:51], a[180:183], v[180:183], v[48:51]
  buffer_load_dwordx4 v[148:151], v2, s[60:63], s19 offen offset:3072 sc1
  v_add_f32 v120, v120, v224
  v_mfma_f32_16x16x32_bf16 v[52:55], a[184:187], v[180:183], v[52:55]
  v_add_f32 v121, v121, v225
  v_add_f32 v122, v122, v226
  v_mfma_f32_16x16x32_bf16 v[56:59], a[188:191], v[180:183], v[56:59]
  v_add_f32 v123, v123, v227
  v_add_f32 v124, v124, v228
  v_mfma_f32_16x16x32_bf16 v[60:63], a[192:195], v[180:183], v[60:63]
  v_add_f32 v125, v125, v229
  v_add_f32 v126, v126, v230
  v_mfma_f32_16x16x32_bf16 v[64:67], a[196:199], v[180:183], v[64:67]
  v_add_f32 v127, v127, v231
  s_waitcnt vmcnt(7)
  v_mfma_f32_16x16x32_bf16 v[68:71], a[0:3], v[184:187], v[108:111]
  s_add_u32 s19, s19, 4096
  buffer_load_dwordx4 v[152:155], v2, s[60:63], s19 offen offset:0 sc1
  v_mfma_f32_16x16x32_bf16 v[72:75], a[4:7], v[184:187], v[112:115]
  v_mfma_f32_16x16x32_bf16 v[76:79], a[8:11], v[184:187], v[116:119]
  v_mfma_f32_16x16x32_bf16 v[80:83], a[12:15], v[184:187], v[120:123]
  v_mfma_f32_16x16x32_bf16 v[84:87], a[16:19], v[184:187], v[124:127]
  s_waitcnt vmcnt(7)
  v_mfma_f32_16x16x32_bf16 v[68:71], a[20:23], v[188:191], v[68:71]
  ds_write_b128 v46, v[48:51] offset:0
  v_mfma_f32_16x16x32_bf16 v[72:75], a[24:27], v[188:191], v[72:75]
  ds_write_b128 v46, v[52:55] offset:1024
  v_mfma_f32_16x16x32_bf16 v[76:79], a[28:31], v[188:191], v[76:79]
  buffer_load_dwordx4 v[156:159], v2, s[60:63], s19 offen offset:1024 sc1
  v_mfma_f32_16x16x32_bf16 v[80:83], a[32:35], v[188:191], v[80:83]
  v_mfma_f32_16x16x32_bf16 v[84:87], a[36:39], v[188:191], v[84:87]
  s_waitcnt vmcnt(7)
  v_mfma_f32_16x16x32_bf16 v[68:71], a[40:43], v[128:131], v[68:71]
  ds_write_b128 v46, v[56:59] offset:2048
  v_mfma_f32_16x16x32_bf16 v[72:75], a[44:47], v[128:131], v[72:75]
  ds_write_b128 v46, v[60:63] offset:3072
  v_mfma_f32_16x16x32_bf16 v[76:79], a[48:51], v[128:131], v[76:79]
  v_mfma_f32_16x16x32_bf16 v[80:83], a[52:55], v[128:131], v[80:83]
  v_mfma_f32_16x16x32_bf16 v[84:87], a[56:59], v[128:131], v[84:87]
  s_waitcnt vmcnt(6)
  v_mfma_f32_16x16x32_bf16 v[68:71], a[60:63], v[132:135], v[68:71]
  ds_write_b128 v46, v[64:67] offset:4096
  v_mfma_f32_16x16x32_bf16 v[72:75], a[64:67], v[132:135], v[72:75]
  v_mfma_f32_16x16x32_bf16 v[76:79], a[68:71], v[132:135], v[76:79]
  v_mfma_f32_16x16x32_bf16 v[80:83], a[72:75], v[132:135], v[80:83]
  v_mfma_f32_16x16x32_bf16 v[84:87], a[76:79], v[132:135], v[84:87]
  s_waitcnt vmcnt(5)
  v_mfma_f32_16x16x32_bf16 v[68:71], a[80:83], v[136:139], v[68:71]
  s_mul_i32 s15, s7, 5120
  v_mfma_f32_16x16x32_bf16 v[72:75], a[84:87], v[136:139], v[72:75]
  v_add_u32_e64 v47, s15, v2
  v_mfma_f32_16x16x32_bf16 v[76:79], a[88:91], v[136:139], v[76:79]
  v_mfma_f32_16x16x32_bf16 v[80:83], a[92:95], v[136:139], v[80:83]
  v_mfma_f32_16x16x32_bf16 v[84:87], a[96:99], v[136:139], v[84:87]
  s_waitcnt vmcnt(4)
  v_mfma_f32_16x16x32_bf16 v[68:71], a[100:103], v[140:143], v[68:71]
  s_waitcnt vmcnt(0)
  s_waitcnt lgkmcnt(0)
  s_barrier
  ds_read_b128 v[192:195], v47 offset:0
  v_mfma_f32_16x16x32_bf16 v[72:75], a[104:107], v[140:143], v[72:75]
  ds_read_b128 v[196:199], v47 offset:1024
  v_mfma_f32_16x16x32_bf16 v[76:79], a[108:111], v[140:143], v[76:79]
  ds_read_b128 v[200:203], v47 offset:2048
  v_mfma_f32_16x16x32_bf16 v[80:83], a[112:115], v[140:143], v[80:83]
  ds_read_b128 v[204:207], v47 offset:3072
  v_mfma_f32_16x16x32_bf16 v[84:87], a[116:119], v[140:143], v[84:87]
  ds_read_b128 v[208:211], v47 offset:4096
  v_mfma_f32_16x16x32_bf16 v[68:71], a[120:123], v[144:147], v[68:71]
  v_mfma_f32_16x16x32_bf16 v[72:75], a[124:127], v[144:147], v[72:75]
  v_mfma_f32_16x16x32_bf16 v[76:79], a[128:131], v[144:147], v[76:79]
  v_mfma_f32_16x16x32_bf16 v[80:83], a[132:135], v[144:147], v[80:83]
  v_mfma_f32_16x16x32_bf16 v[84:87], a[136:139], v[144:147], v[84:87]
  v_mfma_f32_16x16x32_bf16 v[68:71], a[140:143], v[148:151], v[68:71]
  v_mfma_f32_16x16x32_bf16 v[72:75], a[144:147], v[148:151], v[72:75]
  v_mfma_f32_16x16x32_bf16 v[76:79], a[148:151], v[148:151], v[76:79]
  v_mfma_f32_16x16x32_bf16 v[80:83], a[152:155], v[148:151], v[80:83]
  v_mfma_f32_16x16x32_bf16 v[84:87], a[156:159], v[148:151], v[84:87]
  v_mfma_f32_16x16x32_bf16 v[68:71], a[160:163], v[152:155], v[68:71]
  v_mfma_f32_16x16x32_bf16 v[72:75], a[164:167], v[152:155], v[72:75]
  v_mfma_f32_16x16x32_bf16 v[76:79], a[168:171], v[152:155], v[76:79]
  v_mfma_f32_16x16x32_bf16 v[80:83], a[172:175], v[152:155], v[80:83]
  v_mfma_f32_16x16x32_bf16 v[84:87], a[176:179], v[152:155], v[84:87]
  v_mfma_f32_16x16x32_bf16 v[68:71], a[180:183], v[156:159], v[68:71]
  v_mfma_f32_16x16x32_bf16 v[72:75], a[184:187], v[156:159], v[72:75]
  v_mfma_f32_16x16x32_bf16 v[76:79], a[188:191], v[156:159], v[76:79]
  v_mfma_f32_16x16x32_bf16 v[80:83], a[192:195], v[156:159], v[80:83]
  v_mfma_f32_16x16x32_bf16 v[84:87], a[196:199], v[156:159], v[84:87]
  s_lshl_b32 s12, s5, 15
  s_lshl_b32 s13, s7, 8
  s_add_u32 s12, s12, s13
  s_add_u32 s12, s12, 1312768
  s_lshl_b32 s13, s6, 12
  s_add_u32 s13, s13, s12
  s_waitcnt lgkmcnt(0)
  v_pk_add_f32 v[68:69], v[68:69], v[192:193]
  v_pk_add_f32 v[70:71], v[70:71], v[194:195]
  v_pk_add_f32 v[72:73], v[72:73], v[196:197]
  v_pk_add_f32 v[74:75], v[74:75], v[198:199]
  v_pk_add_f32 v[76:77], v[76:77], v[200:201]
  v_pk_add_f32 v[78:79], v[78:79], v[202:203]
  v_pk_add_f32 v[80:81], v[80:81], v[204:205]
  v_pk_add_f32 v[82:83], v[82:83], v[206:207]
  v_pk_add_f32 v[84:85], v[84:85], v[208:209]
  v_pk_add_f32 v[86:87], v[86:87], v[210:211]
  v_pk_add_f32 v[212:213], v[68:69], v[70:71]
  v_pk_mul_f32 v[214:215], v[68:69], v[68:69]
  v_pk_fma_f32 v[214:215], v[70:71], v[70:71], v[214:215]
  v_pk_add_f32 v[212:213], v[212:213], v[72:73]
  v_pk_fma_f32 v[214:215], v[72:73], v[72:73], v[214:215]
  v_pk_add_f32 v[212:213], v[212:213], v[74:75]
  v_pk_fma_f32 v[214:215], v[74:75], v[74:75], v[214:215]
  v_pk_add_f32 v[212:213], v[212:213], v[76:77]
  v_pk_fma_f32 v[214:215], v[76:77], v[76:77], v[214:215]
  v_pk_add_f32 v[212:213], v[212:213], v[78:79]
  v_pk_fma_f32 v[214:215], v[78:79], v[78:79], v[214:215]
  v_pk_add_f32 v[212:213], v[212:213], v[80:81]
  v_pk_fma_f32 v[214:215], v[80:81], v[80:81], v[214:215]
  v_pk_add_f32 v[212:213], v[212:213], v[82:83]
  v_pk_fma_f32 v[214:215], v[82:83], v[82:83], v[214:215]
  v_pk_add_f32 v[212:213], v[212:213], v[84:85]
  v_pk_fma_f32 v[214:215], v[84:85], v[84:85], v[214:215]
  v_pk_add_f32 v[212:213], v[212:213], v[86:87]
  v_pk_fma_f32 v[214:215], v[86:87], v[86:87], v[214:215]
  v_add_f32 v228, v212, v213
  v_add_f32 v229, v214, v215
  v_mov_b32 v230, s8
  v_mov_b32 v231, s8
  v_mov_b32 v212, v228
  v_mov_b32 v213, v229
  s_nop 0
  v_permlane32_swap_b32 v228, v212
  v_permlane32_swap_b32 v229, v213
  v_add_f32 v228, v228, v212
  v_add_f32 v229, v229, v213
  v_mov_b32 v212, v228
  v_mov_b32 v213, v229
  s_nop 0
  v_permlane16_swap_b32 v228, v212
  v_permlane16_swap_b32 v229, v213
  v_add_f32 v228, v228, v212
  v_add_f32 v229, v229, v213
  s_mov_b64 exec, 0xffff
  s_cmp_eq_u32 s9, 0
  s_cbranch_scc1 slow_85
  buffer_store_dwordx4 v[228:231], v2, s[52:55], s13 offen
back_86:
  s_mov_b64 exec, -1
  s_mul_i32 s14, s7, 10240
  s_add_u32 s14, s14, 102400
  v_lshrrev_b32 v12, 1, v3
  v_xor_b32 v12, v12, v4
  v_and_b32 v12, 3, v12
  v_lshlrev_b32_e64 v12, 4, v12
  v_lshl_add_u32 v12, v3, 6, v12
  v_add_u32_e64 v44, s14, v12
  ds_write_b128 v44, v[68:71] offset:0
  ds_write_b128 v44, v[72:75] offset:1024
  ds_write_b128 v44, v[76:79] offset:2048
  ds_write_b128 v44, v[80:83] offset:3072
  ds_write_b128 v44, v[84:87] offset:4096
  v_lshrrev_b32 v12, 3, v1
  v_xor_b32 v12, v12, v1
  v_and_b32 v12, 3, v12
  v_lshlrev_b32 v12, 4, v12
  v_lshrrev_b32_e64 v13, 2, v1
  v_lshl_add_u32 v12, v13, 6, v12
  v_add_u32_e64 v45, s14, v12
  ds_read_b128 v[160:163], v45 offset:0
  ds_read_b128 v[164:167], v45 offset:1024
  ds_read_b128 v[168:171], v45 offset:2048
  ds_read_b128 v[172:175], v45 offset:3072
  ds_read_b128 v[176:179], v45 offset:4096
  v_and_b32 v14, 3, v1
  v_lshlrev_b32 v11, 13, v14
  v_lshl_add_u32 v11, v13, 4, v11
  s_add_u32 s13, s12, 4096
  v_lshrrev_b32_e64 v12, 2, v13
  v_lshl_add_u32 v12, v12, 2, v13
  v_mul_u32_u24 v12, 2560, v12
  v_lshl_add_u32 v46, v14, 4, v12
  s_lshl_b32 s15, s5, 6
  s_lshr_b32 s88, s7, 1
  s_lshl_b32 s88, s88, 5
  s_add_u32 s15, s15, s88
  s_and_b32 s88, s7, 1
  s_lshl_b32 s88, s88, 2
  s_add_u32 s15, s15, s88
  s_mul_i32 s15, s15, 2560
  s_mul_i32 s88, s6, 320
  s_add_u32 s15, s15, s88
again_87:
  buffer_load_dwordx3 v[128:130], v11, s[52:55], s12 offen sc1
  buffer_load_dwordx3 v[132:134], v11, s[52:55], s13 offen sc1
  s_sub_u32 s10, s10, 1
  s_cmp_gt_i32 s10, 0
  s_waitcnt vmcnt(0)
  v_xor_b32 v15, s8, v130
  v_xor_b32 v14, s8, v134
  v_or_b32 v15, v15, v14
  v_cmp_ne_u32 vcc, 0, v15
  s_cbranch_scc0 out_89
  s_cbranch_vccnz again_87
out_89:
ok_88:
  s_waitcnt lgkmcnt(0)
  v_pk_add_f32 v[128:129], v[128:129], v[132:133]
  s_nop 1
  v_add_f32_dpp v128, v128, v128 quad_perm:[1,0,3,2] row_mask:0xf bank_mask:0xf
  v_add_f32_dpp v129, v129, v129 quad_perm:[1,0,3,2] row_mask:0xf bank_mask:0xf
  s_nop 0
  v_add_f32_dpp v128, v128, v128 quad_perm:[2,3,0,1] row_mask:0xf bank_mask:0xf
  v_add_f32_dpp v129, v129, v129 quad_perm:[2,3,0,1] row_mask:0xf bank_mask:0xf
  v_mul_f32 v128, 0x3acccccd, v128
  v_mul_f32 v202, 0x3acccccd, v129
  v_fma_f32 v202, -v128, v128, v202
  v_max_f32_e64 v202, 0, v202
  v_add_f32 v202, 0x3727c5ac, v202
  v_rsq_f32 v200, v202
  s_nop 0
  v_mul_f32_e64 v201, v128, v200
  v_pk_fma_f32 v[132:133], v[160:161], v[200:201], v[200:201] op_sel:[0,0,1] op_sel_hi:[1,0,1] neg_lo:[0,0,1] neg_hi:[0,0,1]
  v_pk_fma_f32 v[134:135], v[162:163], v[200:201], v[200:201] op_sel:[0,0,1] op_sel_hi:[1,0,1] neg_lo:[0,0,1] neg_hi:[0,0,1]
  v_pk_fma_f32 v[160:161], v[132:133], v[88:89], v[160:161]
  v_pk_fma_f32 v[162:163], v[134:135], v[90:91], v[162:163]
  s_cmp_eq_u32 s9, 0
  s_cbranch_scc1 slow_90
  buffer_store_dwordx4 v[160:163], v46, s[60:63], s15 offen offset:0
back_91:
  v_pk_fma_f32 v[136:137], v[164:165], v[200:201], v[200:201] op_sel:[0,0,1] op_sel_hi:[1,0,1] neg_lo:[0,0,1] neg_hi:[0,0,1]
  v_pk_fma_f32 v[138:139], v[166:167], v[200:201], v[200:201] op_sel:[0,0,1] op_sel_hi:[1,0,1] neg_lo:[0,0,1] neg_hi:[0,0,1]
  v_pk_fma_f32 v[164:165], v[136:137], v[92:93], v[164:165]
  v_pk_fma_f32 v[166:167], v[138:139], v[94:95], v[166:167]
  s_cmp_eq_u32 s9, 0
  s_cbranch_scc1 slow_92
  buffer_store_dwordx4 v[164:167], v46, s[60:63], s15 offen offset:64
back_93:
  v_pk_fma_f32 v[132:133], v[168:169], v[200:201], v[200:201] op_sel:[0,0,1] op_sel_hi:[1,0,1] neg_lo:[0,0,1] neg_hi:[0,0,1]
  v_pk_fma_f32 v[134:135], v[170:171], v[200:201], v[200:201] op_sel:[0,0,1] op_sel_hi:[1,0,1] neg_lo:[0,0,1] neg_hi:[0,0,1]
  v_pk_fma_f32 v[168:169], v[132:133], v[96:97], v[168:169]
  v_pk_fma_f32 v[170:171], v[134:135], v[98:99], v[170:171]
  s_cmp_eq_u32 s9, 0
  s_cbranch_scc1 slow_94
  buffer_store_dwordx4 v[168:171], v46, s[60:63], s15 offen offset:128
back_95:
  v_pk_fma_f32 v[136:137], v[172:173], v[200:201], v[200:201] op_sel:[0,0,1] op_sel_hi:[1,0,1] neg_lo:[0,0,1] neg_hi:[0,0,1]
  v_pk_fma_f32 v[138:139], v[174:175], v[200:201], v[200:201] op_sel:[0,0,1] op_sel_hi:[1,0,1] neg_lo:[0,0,1] neg_hi:[0,0,1]
  v_pk_fma_f32 v[172:173], v[136:137], v[100:101], v[172:173]
  v_pk_fma_f32 v[174:175], v[138:139], v[102:103], v[174:175]
  s_cmp_eq_u32 s9, 0
  s_cbranch_scc1 slow_96
  buffer_store_dwordx4 v[172:175], v46, s[60:63], s15 offen offset:192
back_97:
  v_pk_fma_f32 v[132:133], v[176:177], v[200:201], v[200:201] op_sel:[0,0,1] op_sel_hi:[1,0,1] neg_lo:[0,0,1] neg_hi:[0,0,1]
  v_pk_fma_f32 v[134:135], v[178:179], v[200:201], v[200:201] op_sel:[0,0,1] op_sel_hi:[1,0,1] neg_lo:[0,0,1] neg_hi:[0,0,1]
  v_pk_fma_f32 v[176:177], v[132:133], v[104:105], v[176:177]
  v_pk_fma_f32 v[178:179], v[134:135], v[106:107], v[178:179]
  s_cmp_eq_u32 s9, 0
  s_cbranch_scc1 slow_98
  buffer_store_dwordx4 v[176:179], v46, s[60:63], s15 offen offset:256
back_99:
L_end:
  s_endpgm
again_13:
  s_sub_u32 s10, s10, 1
  s_cmp_gt_i32 s10, 0
  s_cbranch_scc0 ok_14
  buffer_load_dword v184, v185, s[52:55], s89 offen sc1
  s_waitcnt vmcnt(0)
  v_xor_b32 v15, s8, v184
  v_cmp_lt_u32 vcc, 15, v15
  s_cbranch_vccz ok_14
  s_and_b32 s13, s10, 3
  s_cbranch_scc1 again_13
  buffer_load_dword v184, v185, s[52:55], s89 offen offset:128 sc1
  s_waitcnt vmcnt(0)
  v_xor_b32 v15, s8, v184
  v_cmp_lt_u32 vcc, 15, v15
  s_cbranch_vccnz again_13
  s_branch ok_14
again_15:
  s_sub_u32 s10, s10, 1
  s_cmp_gt_i32 s10, 0
  s_cbranch_scc0 ok_16
  buffer_load_dword v184, v185, s[52:55], s89 offen sc1
  s_waitcnt vmcnt(0)
  v_xor_b32 v15, s8, v184
  v_cmp_lt_u32 vcc, 15, v15
  s_cbranch_vccz ok_16
  s_and_b32 s13, s10, 3
  s_cbranch_scc1 again_15
  buffer_load_dword v184, v185, s[52:55], s89 offen offset:128 sc1
  s_waitcnt vmcnt(0)
  v_xor_b32 v15, s8, v184
  v_cmp_lt_u32 vcc, 15, v15
  s_cbranch_vccnz again_15
  s_branch ok_16
slow_17:
  buffer_store_dword v15, off, s[52:55], s41 sc1
  s_nop 1
  s_branch back_18
again_19:
  s_sub_u32 s10, s10, 1
  s_cmp_gt_i32 s10, 0
  s_cbranch_scc0 ok_20
  buffer_load_dwordx2 v[188:189], v187, s[52:55], s87 offen sc1
  s_waitcnt vmcnt(0)
  v_xor_b32 v15, s8, v188
  v_xor_b32 v14, s8, v189
  v_or_b32 v15, v15, v14
  v_cmp_ne_u32 vcc, 0, v15
  s_cbranch_vccnz again_19
  s_branch ok_20
again_21:
  s_sub_u32 s10, s10, 1
  s_cmp_gt_i32 s10, 0
  s_cbranch_scc0 ok_22
  buffer_load_dwordx4 v[220:223], v2, s[52:55], s36 offen sc1
  s_waitcnt vmcnt(0)
  v_min3_u32 v15, v220, v221, s8
  v_max3_u32 v14, v220, v221, s8
  v_min3_u32 v15, v15, v222, v223
  v_max3_u32 v14, v14, v222, v223
  v_cmp_ne_u32 vcc, v15, v14
  s_cbranch_vccnz again_21
  s_branch ok_22
again_23:
  s_sub_u32 s10, s10, 1
  s_cmp_gt_i32 s10, 0
  s_cbranch_scc0 ok_24
  buffer_load_dwordx4 v[188:191], v187, s[52:55], s88 offen sc1
  s_waitcnt vmcnt(0)
  v_min3_u32 v15, v188, v189, s8
  v_max3_u32 v14, v188, v189, s8
  v_min3_u32 v15, v15, v190, v191
  v_max3_u32 v14, v14, v190, v191
  v_cmp_ne_u32 vcc, v15, v14
  s_cbranch_vccnz again_23
  s_branch ok_24
again_25:
  s_sub_u32 s10, s10, 1
  s_cmp_gt_i32 s10, 0
  s_cbranch_scc0 ok_26
  buffer_load_dwordx3 v[152:154], v160, s[52:55], s93 offen sc1
  buffer_load_dwordx2 v[156:157], v161, s[52:55], s94 offen sc1
  buffer_load_dwordx2 v[158:159], v162, s[52:55], s94 offen offset:512 sc1
  s_waitcnt vmcnt(0)
  v_min3_u32 v15, v154, v154, s8
  v_max3_u32 v14, v154, v154, s8
  v_min3_u32 v15, v15, v157, v159
  v_max3_u32 v14, v14, v157, v159
  v_cmp_ne_u32 vcc, v15, v14
  s_cbranch_vccnz again_25
  s_branch ok_26
slow_39:
  buffer_store_dword v15, off, s[52:55], s14 sc1
  s_nop 1
  s_branch back_40
slow_42:
  buffer_store_dword v15, off, s[52:55], s14 sc1
  s_nop 1
  s_branch back_43
again_44:
  s_sub_u32 s10, s10, 1
  s_cmp_gt_i32 s10, 0
  s_cbranch_scc0 ok_45
  buffer_load_dwordx4 v[120:123], v2, s[52:55], s92 offen sc1
  s_waitcnt vmcnt(0)
  v_min3_u32 v15, v120, v121, s8
  v_max3_u32 v14, v120, v121, s8
  v_min3_u32 v15, v15, v122, v123
  v_max3_u32 v14, v14, v122, v123
  v_cmp_ne_u32 vcc, v15, v14
  s_cbranch_vccnz again_44
  s_branch ok_45
again_49:
  s_sub_u32 s10, s10, 1
  s_cmp_gt_i32 s10, 0
  s_cbranch_scc0 ok_50
  s_mul_i32 s95, s7, 10240
  s_add_u32 s95, s95, 107520
  s_and_b32 s93, s7, 1
  s_lshl_b32 s93, s93, 3
  s_add_u32 s93, s93, s95
  v_add_u32 v253, s93, v2
  s_add_u32 m0, s95, 0
  s_add_u32 s93, s92, 0
  buffer_load_dwordx4 v252, s[52:55], s93 offen sc1 lds
  s_add_u32 m0, s95, 1024
  s_add_u32 s93, s92, 65536
  buffer_load_dwordx4 v252, s[52:55], s93 offen sc1 lds
  s_add_u32 m0, s95, 2048
  s_add_u32 s93, s92, 131072
  buffer_load_dwordx4 v252, s[52:55], s93 offen sc1 lds
  s_add_u32 m0, s95, 3072
  s_add_u32 s93, s92, 196608
  buffer_load_dwordx4 v252, s[52:55], s93 offen sc1 lds
  s_add_u32 m0, s95, 4096
  s_add_u32 s93, s92, 262144
  buffer_load_dwordx4 v252, s[52:55], s93 offen sc1 lds
  s_waitcnt vmcnt(0)
  ds_read_b64_tr_b16 v[232:233], v253 offset:0
  ds_read_b64_tr_b16 v[234:235], v253 offset:1024
  ds_read_b64_tr_b16 v[236:237], v253 offset:2048
  ds_read_b64_tr_b16 v[238:239], v253 offset:3072
  ds_read_b64_tr_b16 v[240:241], v253 offset:4096
  s_waitcnt lgkmcnt(0)
  v_pk_max_u16 v15, v232, v233
  v_pk_max_u16 v15, v15, v234
  v_pk_max_u16 v15, v15, v235
  v_pk_max_u16 v15, v15, v236
  v_pk_max_u16 v15, v15, v237
  v_pk_max_u16 v15, v15, v238
  v_pk_max_u16 v15, v15, v239
  v_pk_max_u16 v15, v15, v240
  v_pk_max_u16 v15, v15, v241
  v_lshlrev_b32 v14, 16, v15
  v_max_u32 v15, v15, v14
  v_cmp_le_u32 vcc, 0xffff0000, v15
  s_cbranch_vccnz again_49
  s_branch ok_50
slow_51:
  buffer_store_dwordx4 v[228:231], v2, s[52:55], s13 offen sc1
  s_nop 1
  s_branch back_52
slow_56:
  buffer_store_dword v15, off, s[52:55], s13 sc1
  s_nop 1
  s_branch back_57
slow_70:
  buffer_store_dwordx4 v[52:55], v47, s[60:63], s13 offen sc1
  s_nop 1
  s_branch back_71
slow_72:
  buffer_store_dwordx4 v[60:63], v47, s[60:63], s13 offen sc1
  s_nop 1
  s_branch back_73
slow_74:
  buffer_store_dwordx4 v[68:71], v47, s[60:63], s13 offen sc1
  s_nop 1
  s_branch back_75
slow_76:
  buffer_store_dwordx4 v[76:79], v47, s[60:63], s13 offen sc1
  s_nop 1
  s_branch back_77
slow_78:
  buffer_store_dwordx4 v[84:87], v47, s[60:63], s13 offen sc1
  s_nop 1
  s_branch back_79
slow_80:
  buffer_store_dword v15, off, s[52:55], s14 sc1
  s_nop 1
  s_branch back_81
slow_85:
  buffer_store_dwordx4 v[228:231], v2, s[52:55], s13 offen sc1
  s_nop 1
  s_branch back_86
slow_90:
  buffer_store_dwordx4 v[160:163], v46, s[60:63], s15 offen offset:0 sc1
  s_nop 1
  s_branch back_91
slow_92:
  buffer_store_dwordx4 v[164:167], v46, s[60:63], s15 offen offset:64 sc1
  s_nop 1
  s_branch back_93
slow_94:
  buffer_store_dwordx4 v[168:171], v46, s[60:63], s15 offen offset:128 sc1
  s_nop 1
  s_branch back_95
slow_96:
  buffer_store_dwordx4 v[172:175], v46, s[60:63], s15 offen offset:192 sc1
  s_nop 1
  s_branch back_97
slow_98:
  buffer_store_dwordx4 v[176:179], v46, s[60:63], s15 offen offset:256 sc1
  s_nop 1
  s_branch back_99
  s_endpgm
L_codeend:
.section .rodata,"a"
.p2align 6
.amdhsa_kernel interleave_layers__ssm_conv_s5__ssm_conv_h3__prompt_kernel
  .amdhsa_next_free_vgpr 512
  .amdhsa_next_free_sgpr 102
  .amdhsa_accum_offset 256
  .amdhsa_group_segment_fixed_size 0
  .amdhsa_kernarg_size 144
  .amdhsa_user_sgpr_count 2
  .amdhsa_user_sgpr_kernarg_segment_ptr 1
  .amdhsa_system_sgpr_workgroup_id_x 1
.end_amdhsa_kernel
```

```asm
; @launch grid=(256,1,1) block=(256,1,1) lds=163840
.amdgcn_target "amdgcn-amd-amdhsa--gfx950"
.text
.globl interleave_layers__ssm_conv_s5__ssm_conv_h3__prompt_kernel
.p2align 8
.type interleave_layers__ssm_conv_s5__ssm_conv_h3__prompt_kernel,@function
interleave_layers__ssm_conv_s5__ssm_conv_h3__prompt_kernel:
  s_cmp_ge_u32 s2, 256
  s_cbranch_scc1 L_end
  s_load_dwordx16 s[16:31], s[0:1], 0
  s_load_dwordx16 s[32:47], s[0:1], 64
  s_load_dwordx4 s[48:51], s[0:1], 128
  v_and_b32 v1, 63, v0
  v_lshrrev_b32 v11, 6, v0
  v_lshlrev_b32 v2, 4, v1
  v_readfirstlane_b32 s7, v11
  v_and_b32 v3, 15, v1
  v_lshrrev_b32 v4, 4, v1
  s_and_b32 s12, s2, 7
  s_lshr_b32 s13, s2, 3
  s_getpc_b64 s[98:99]
L_pc:
  s_and_b32 s4, s13, 15
  s_lshr_b32 s14, s13, 4
  s_lshl_b32 s3, s12, 1
  s_add_u32 s3, s3, s14
  s_mov_b32 s0, s12
  s_mov_b32 s1, s13
  s_and_b32 vcc_lo, s1, 7
  s_lshl_b32 vcc_lo, vcc_lo, 2
  s_add_u32 vcc_lo, vcc_lo, s7
  s_lshl_b32 vcc_lo, vcc_lo, 11
  v_lshl_add_u32 v15, v3, 7, vcc_lo
  v_min_u32 v15, L_codeend-L_pc-4, v15
  s_mov_b64 exec, 0xffff
  global_load_dword a250, v15, s[98:99]
  s_mov_b64 exec, -1
  v_lshrrev_b32 v11, 3, v1
  v_and_b32_e64 v13, 7, v1
  v_mul_u32_u24 v150, 1280, v11
  v_lshl_add_u32 v150, v13, 4, v150
  s_mul_i32 s12, s1, 81920
  s_lshl_b32 s13, s0, 7
  s_add_u32 s12, s12, s13
  v_add_u32 v169, s12, v150
  s_lshl_b32 s95, s0, 5
  s_add_u32 s95, s95, s1
  s_mul_i32 s12, s95, 10240
  s_add_u32 s12, s12, 1024
  v_add_u32 v170, s12, v150
  s_cmp_eq_u32 s7, 1
  s_cbranch_scc1 w1_3
  s_cmp_eq_u32 s7, 2
  s_cbranch_scc1 w2_4
  s_cmp_eq_u32 s7, 3
  s_cbranch_scc1 w3_5
w0_2:
  s_waitcnt lgkmcnt(0)
  s_mov_b32 s60, s36
  s_and_b32 s61, s37, 0xffff
  s_mov_b32 s62, 2621440
  s_mov_b32 s63, 0x20000
  s_mov_b32 m0, 119840
  s_nop 0
  buffer_load_dwordx4 v169, s[60:63], 0 offen lds
  s_mov_b32 m0, 120896
  s_mov_b32 s12, 10240
  buffer_load_dwordx4 v169, s[60:63], s12 offen lds
  s_mov_b32 m0, 121952
  s_mov_b32 s12, 20480
  buffer_load_dwordx4 v169, s[60:63], s12 offen lds
  s_mov_b32 m0, 123008
  s_mov_b32 s12, 30720
  buffer_load_dwordx4 v169, s[60:63], s12 offen lds
  s_mov_b32 m0, 124064
  s_mov_b32 s12, 40960
  buffer_load_dwordx4 v169, s[60:63], s12 offen lds
  s_mov_b32 m0, 125120
  s_mov_b32 s12, 51200
  buffer_load_dwordx4 v169, s[60:63], s12 offen lds
  s_mov_b32 m0, 126176
  s_mov_b32 s12, 61440
  buffer_load_dwordx4 v169, s[60:63], s12 offen lds
  v_subrev_u32 v11, 10240, v169
  s_mov_b32 exec_lo, 0
  s_mov_b32 exec_hi, 0xffffff00
  s_mov_b32 m0, 118784
  s_nop 0
  buffer_load_dwordx4 v11, s[60:63], 0 offen lds
  s_mov_b64 exec, -1
  s_mov_b32 s52, s50
  s_and_b32 s53, s51, 0xffff
  s_mov_b32 s54, 41943040
  s_mov_b32 s55, 0x20000
  s_lshl_b32 s12, s3, 4
  s_add_u32 s12, s12, s4
  s_lshl_b32 s12, s12, 12
  s_add_u32 s12, s12, 1310720
  s_sub_u32 s12, s12, 0
  v_mov_b32 v11, s12
  s_lshl_b32 s12, s3, 10
  s_add_u32 s12, s12, 4096
  s_sub_u32 s12, s12, 3072
  v_cmp_lt_u32 vcc, 23, v1
  v_mov_b32 v15, s12
  s_nop 0
  v_cndmask_b32 v11, v11, v15, vcc
  s_lshl_b32 s12, s0, 11
  s_add_u32 s12, s12, 65536
  s_sub_u32 s12, s12, 3840
  v_cmp_lt_u32 vcc, 29, v1
  v_mov_b32 v15, s12
  s_nop 0
  v_cndmask_b32 v11, v11, v15, vcc
  s_lshl_b32 s12, s4, 5
  s_add_u32 s12, s12, s3
  s_mul_i32 s12, s12, 640
  s_add_u32 s12, s12, 337920
  s_sub_u32 s12, s12, 4992
  v_cmp_lt_u32 vcc, 38, v1
  v_mov_b32 v15, s12
  s_nop 0
  v_cndmask_b32 v11, v11, v15, vcc
  s_lshl_b32 s12, s4, 5
  s_add_u32 s12, s12, s3
  s_mul_i32 s12, s12, 640
  s_add_u32 s12, s12, 665600
  s_sub_u32 s12, s12, 5632
  v_cmp_lt_u32 vcc, 43, v1
  v_mov_b32 v15, s12
  s_nop 0
  v_cndmask_b32 v11, v11, v15, vcc
  s_mul_i32 s12, s4, 640
  s_add_u32 s12, s12, 303104
  s_sub_u32 s12, s12, 6272
  v_cmp_lt_u32 vcc, 48, v1
  v_mov_b32 v15, s12
  s_nop 0
  v_cndmask_b32 v11, v11, v15, vcc
  s_lshl_b32 s12, s0, 7
  s_add_u32 s12, s12, 24576
  s_sub_u32 s12, s12, 6912
  v_cmp_lt_u32 vcc, 53, v1
  v_mov_b32 v15, s12
  s_nop 0
  v_cndmask_b32 v11, v11, v15, vcc
  s_lshl_b32 s12, s0, 7
  s_add_u32 s12, s12, 32768
  s_sub_u32 s12, s12, 7040
  v_cmp_lt_u32 vcc, 54, v1
  v_mov_b32 v15, s12
  s_nop 0
  v_cndmask_b32 v11, v11, v15, vcc
  v_lshl_add_u32 v11, v1, 7, v11
  s_mov_b32 exec_hi, 16777215
  buffer_load_dword a250, v11, s[52:55], 0 offen
  s_mov_b32 exec_hi, -1
  s_branch join_1
w1_3:
  s_waitcnt lgkmcnt(0)
  v_min_u32 v11, 39, v1
  s_mul_i32 s12, s4, 80
  v_lshl_add_u32 v14, v11, 1, s12
  global_load_ushort v229, v14, s[18:19]
  global_load_ushort v230, v14, s[20:21]
  global_load_ushort v231, v14, s[30:31]
  s_mov_b32 s64, s38
  s_and_b32 s65, s39, 0xffff
  s_mov_b32 s66, 2621440
  s_mov_b32 s67, 0x20000
  s_mov_b32 m0, 132512
  s_nop 0
  buffer_load_dwordx4 v169, s[64:67], 0 offen lds
  s_mov_b32 m0, 133568
  s_mov_b32 s12, 10240
  buffer_load_dwordx4 v169, s[64:67], s12 offen lds
  s_mov_b32 m0, 134624
  s_mov_b32 s12, 20480
  buffer_load_dwordx4 v169, s[64:67], s12 offen lds
  s_mov_b32 m0, 135680
  s_mov_b32 s12, 30720
  buffer_load_dwordx4 v169, s[64:67], s12 offen lds
  s_mov_b32 m0, 136736
  s_mov_b32 s12, 40960
  buffer_load_dwordx4 v169, s[64:67], s12 offen lds
  s_mov_b32 m0, 137792
  s_mov_b32 s12, 51200
  buffer_load_dwordx4 v169, s[64:67], s12 offen lds
  s_mov_b32 m0, 138848
  s_mov_b32 s12, 61440
  buffer_load_dwordx4 v169, s[64:67], s12 offen lds
  s_mov_b32 m0, 139904
  s_mov_b32 s12, 71680
  buffer_load_dwordx4 v169, s[64:67], s12 offen lds
  s_branch join_1
w2_4:
  s_waitcnt lgkmcnt(0)
  s_mov_b32 s60, s36
  s_and_b32 s61, s37, 0xffff
  s_mov_b32 s62, 2621440
  s_mov_b32 s63, 0x20000
  s_mov_b32 s64, s38
  s_and_b32 s65, s39, 0xffff
  s_mov_b32 s66, 2621440
  s_mov_b32 s67, 0x20000
  s_mov_b32 m0, 127232
  s_mov_b32 s12, 71680
  buffer_load_dwordx4 v169, s[60:63], s12 offen lds
  s_mov_b32 m0, 129344
  s_nop 0
  buffer_load_dwordx4 v170, s[60:63], 0 offen lds
  s_mov_b32 m0, 142016
  s_nop 0
  buffer_load_dwordx4 v170, s[64:67], 0 offen lds
  s_mov_b32 m0, 131456
  s_mov_b32 s12, 128
  buffer_load_dwordx4 v170, s[60:63], s12 offen lds
  s_mov_b32 m0, 144128
  s_mov_b32 s12, 128
  buffer_load_dwordx4 v170, s[64:67], s12 offen lds
  v_subrev_u32 v11, 10240, v170
  s_mov_b32 exec_lo, 0
  s_mov_b32 exec_hi, 0xffffff00
  s_mov_b32 m0, 128288
  s_nop 0
  buffer_load_dwordx4 v11, s[60:63], 0 offen lds
  s_mov_b64 exec, -1
  v_subrev_u32 v11, 10240, v170
  s_mov_b32 exec_lo, 0
  s_mov_b32 exec_hi, 0xffffff00
  s_mov_b32 m0, 130400
  s_mov_b32 s12, 128
  buffer_load_dwordx4 v11, s[60:63], s12 offen lds
  s_mov_b64 exec, -1
  s_mov_b32 s64, s40
  s_and_b32 s65, s41, 0xffff
  s_mov_b32 s66, 5120
  s_mov_b32 s67, 0x20000
  s_mov_b32 m0, 143072
  s_movk_i32 s12, 4096
  buffer_load_dwordx4 v2, s[64:67], s12 offen lds
  s_mov_b32 m0, 140960
  s_lshl_b32 s12, s0, 9
  s_mov_b32 exec_hi, 0
  buffer_load_dwordx4 v2, s[64:67], s12 offen lds
  s_mov_b32 exec_hi, -1
  s_branch join_1
w3_5:
  s_waitcnt lgkmcnt(0)
  s_mov_b32 s68, s16
  s_and_b32 s69, s17, 0xffff
  s_mov_b32 s70, 2621440
  s_mov_b32 s71, 0x20000
  s_lshl_b32 s12, s3, 4
  s_add_u32 s12, s12, s4
  s_mul_i32 s12, s12, 10240
  buffer_load_dwordx4 v[48:51], v150, s[68:71], s12 offen offset:0
  buffer_load_dwordx4 v[52:55], v150, s[68:71], s12 offen offset:128
  buffer_load_dwordx4 v[56:59], v150, s[68:71], s12 offen offset:256
  buffer_load_dwordx4 v[60:63], v150, s[68:71], s12 offen offset:384
  buffer_load_dwordx4 v[64:67], v150, s[68:71], s12 offen offset:512
  buffer_load_dwordx4 v[68:71], v150, s[68:71], s12 offen offset:640
  buffer_load_dwordx4 v[72:75], v150, s[68:71], s12 offen offset:768
  buffer_load_dwordx4 v[76:79], v150, s[68:71], s12 offen offset:896
  buffer_load_dwordx4 v[80:83], v150, s[68:71], s12 offen offset:1024
  buffer_load_dwordx4 v[84:87], v150, s[68:71], s12 offen offset:1152
join_1:
  s_load_dword s8, s[50:51], 0
  s_lshl_b32 s86, s95, 1
  s_lshl_b32 s12, s86, 1
  s_load_dword s72, s[44:45], s12
  s_and_b32 s12, s95, 0xfffffffc
  s_add_u32 s12, s12, 1024
  s_load_dword s73, s[44:45], s12
  s_getreg_b32 s11, hwreg(HW_REG_XCC_ID, 0, 4)
  s_mov_b32 s10, 262144
  s_mov_b32 s2, 0x3f803f80
  v_lshrrev_b32 v11, 3, v1
  v_and_b32 v12, 6, v11
  v_and_b32 v13, 7, v1
  s_movk_i32 s15, 0x78
  v_bfe_u32 v14, s15, v12, 2
  v_xor_b32 v14, v14, v13
  v_mul_u32_u24 v146, 1280, v11
  v_lshl_add_u32 v148, v14, 4, v146
  s_and_b32 s12, s7, 1
  s_lshl_b32 s13, s12, 6
  v_xor_b32_e64 v148, s13, v148
  v_add_u32 v149, 8192, v148
  v_xor_b32 v12, v12, v13
  v_and_b32 v11, 4, v11
  v_mul_u32_u24 v11, 1280, v11
  v_lshl_add_u32 v11, v12, 4, v11
  v_add_u32_e64 v146, v11, v146
  v_add_u32 v147, 19456, v146
  s_lshr_b32 s13, s7, 1
  s_mul_i32 s75, s13, 10240
  s_lshl_b32 s12, s12, 10
  s_add_u32 s75, s75, s12
  s_mul_i32 s74, s4, 51200
  s_lshl_b32 s13, s13, 7
  s_add_u32 s74, s74, s13
  s_lshl_b32 s76, s3, 2
  s_add_u32 s76, s76, s7
  s_mul_i32 s76, s76, 40960
  s_lshl_b32 s77, s7, 11
  s_add_u32 s77, s77, 102400
  s_bitcmp1_b32 s7, 0
  s_cselect_b32 s56, s24, s22
  s_cselect_b32 s57, s25, s23
  s_and_b32 s57, s57, 0xffff
  s_mov_b32 s58, 819200
  s_mov_b32 s59, 0x20000
  s_bitcmp1_b32 s3, 3
  s_cselect_b32 s60, s24, s22
  s_cselect_b32 s61, s25, s23
  s_and_b32 s61, s61, 0xffff
  s_mov_b32 s62, 819200
  s_mov_b32 s63, 0x20000
  s_mov_b32 s68, s16
  s_and_b32 s69, s17, 0xffff
  s_mov_b32 s70, 2621440
  s_mov_b32 s71, 0x20000
  s_mov_b32 s52, s50
  s_and_b32 s53, s51, 0xffff
  s_mov_b32 s54, 41943040
  s_mov_b32 s55, 0x20000
  s_lshr_b32 s24, s95, 1
  s_add_u32 s24, s24, 512
  s_lshr_b32 s14, s4, 3
  s_lshl_b32 s5, s3, 1
  s_add_u32 s5, s5, s14
  s_and_b32 s6, s4, 7
  s_lshl_b32 s84, s3, 10
  s_lshl_b32 s13, s4, 4
  s_add_u32 s84, s84, s13
  s_lshl_b32 s13, s7, 2
  s_add_u32 s84, s84, s13
  s_lshl_b32 s85, s0, 11
  s_add_u32 s85, s85, s13
  s_lshl_b32 s13, s1, 4
  s_add_u32 s85, s85, s13
  s_lshl_b32 s83, s4, 5
  s_add_u32 s83, s83, s3
  s_mul_i32 s83, s83, 640
  s_add_u32 s83, s83, 327680
  s_cmp_eq_u32 s7, 0
  s_cselect_b32 s96, -1, 0
  s_cselect_b32 s97, 0xff, 0
  s_lshl_b32 s12, s76, 1
  s_mul_i32 s13, s4, 5
  s_add_u32 s14, s13, 0
  s_lshr_b32 s15, s14, 2
  s_lshl_b32 s15, s15, 11
  s_and_b32 s14, s14, 3
  s_lshl_b32 s14, s14, 8
  s_add_u32 s14, s14, s15
  s_add_u32 s78, s14, s12
  s_add_u32 s14, s13, 1
  s_lshr_b32 s15, s14, 2
  s_lshl_b32 s15, s15, 11
  s_and_b32 s14, s14, 3
  s_lshl_b32 s14, s14, 8
  s_add_u32 s14, s14, s15
  s_add_u32 s79, s14, s12
  s_add_u32 s14, s13, 2
  s_lshr_b32 s15, s14, 2
  s_lshl_b32 s15, s15, 11
  s_and_b32 s14, s14, 3
  s_lshl_b32 s14, s14, 8
  s_add_u32 s14, s14, s15
  s_add_u32 s80, s14, s12
  s_add_u32 s14, s13, 3
  s_lshr_b32 s15, s14, 2
  s_lshl_b32 s15, s15, 11
  s_and_b32 s14, s14, 3
  s_lshl_b32 s14, s14, 8
  s_add_u32 s14, s14, s15
  s_add_u32 s81, s14, s12
  s_add_u32 s14, s13, 4
  s_lshr_b32 s15, s14, 2
  s_lshl_b32 s15, s15, 11
  s_and_b32 s14, s14, 3
  s_lshl_b32 s14, s14, 8
  s_add_u32 s14, s14, s15
  s_add_u32 s82, s14, s12
  s_mul_i32 s12, s7, 1280
  s_add_u32 s12, s12, 13824
  v_mul_u32_u24 v11, 80, v3
  v_lshl_add_u32 v11, v4, 4, v11
  v_add_u32 v42, s12, v11
  v_bfe_u32 v12, v1, 2, 2
  v_mul_u32_u24 v12, 160, v12
  v_and_b32_e64 v13, 3, v1
  v_lshl_add_u32 v12, v13, 4, v12
  v_lshrrev_b32_e64 v13, 1, v4
  v_mul_u32_u24 v14, 80, v13
  v_lshlrev_b32_e64 v13, 10, v13
  v_add3_u32 v12, v12, v14, s12
  v_and_b32_e64 v14, 1, v4
  v_lshl_add_u32 v43, v14, 3, v12
  v_mul_u32_u24 v14, 40960, v14
  v_lshl_add_u32 v13, v3, 4, v13
  v_add_u32_e64 v44, v13, v14
  v_accvgpr_write_b32 a240, v42
  v_accvgpr_write_b32 a241, v43
  v_accvgpr_write_b32 a242, v44
  v_accvgpr_write_b32 a243, v148
  v_accvgpr_write_b32 a244, v149
  v_lshrrev_b32_e64 v11, 2, v3
  v_mul_u32_u24 v11, 5120, v11
  v_and_b32_e64 v12, 3, v3
  v_lshl_add_u32 v11, v12, 4, v11
  v_lshl_add_u32 v0, v4, 6, v11
  v_and_b32 v11, 1, v3
  v_lshrrev_b32 v12, 1, v3
  v_and_b32 v13, 6, v12
  s_movk_i32 s15, 0x78
  v_bfe_u32 v13, s15, v13, 2
  v_xor_b32_e64 v13, v13, v4
  v_lshl_add_u32 v13, v11, 2, v13
  v_lshlrev_b32_e64 v13, 4, v13
  v_lshl_add_u32 v13, v12, 7, v13
  v_lshl_add_u32 v5, v11, 10, v13
  v_xor_b32_e64 v6, 64, v5
  v_add_u32 v7, 51200, v5
  v_add_u32 v8, 51200, v6
  v_mul_u32_u24 v9, 144, v12
  v_lshl_add_u32 v9, v11, 2, v9
  v_lshl_add_u32 v9, v4, 3, v9
  s_lshl_b32 s12, s7, 5
  v_add_u32 v9, s12, v9
  v_and_b32 v11, 6, v3
  v_xor_b32 v11, v11, v4
  v_lshlrev_b32_e64 v11, 4, v11
  v_lshl_add_u32 v11, v3, 7, v11
  v_add_u32 v144, s77, v11
  v_xor_b32 v145, 64, v144
  v_lshrrev_b32 v11, 3, v1
  v_and_b32 v12, 7, v1
  v_mul_u32_u24 v13, 1056, v12
  v_lshl_add_u32 v13, v11, 3, v13
  s_lshl_b32 s12, s7, 6
  s_add_u32 s12, s12, 118784
  v_add_u32 v172, s12, v13
  s_lshl_b32 s12, s7, 8
  s_add_u32 s12, s12, 140960
  v_lshl_add_u32 v173, v11, 5, s12
  v_sub_u32 v13, 7, v12
  v_lshlrev_b32_e64 v13, 4, v13
  v_lshl_add_u32 v171, v11, 14, v13
  s_mul_i32 s12, s0, 80
  s_lshl_b32 s13, s7, 5
  s_add_u32 s12, s12, s13
  s_lshl_b32 s12, s12, 12
  s_lshl_b32 s13, s1, 7
  s_sub_u32 s12, s12, s13
  s_add_u32 s87, s12, 4198272
  s_add_u32 s41, s85, 65536
  s_movk_i32 s36, 4096
  s_cmp_lg_u32 s7, 2
  s_cbranch_scc1 skip_6
  v_bfe_u32 v13, v1, 4, 1
  v_mul_u32_u24 v13, 2112, v13
  v_and_b32_e64 v14, 15, v1
  v_lshl_add_u32 v13, v14, 3, v13
  v_add_u32 v172, 128288, v13
  v_and_b32 v13, 31, v1
  v_lshlrev_b32 v13, 5, v13
  v_add_u32 v173, 143072, v13
  v_cmp_gt_u32_e64 vcc, 32, v1
  v_mov_b32 v14, 1879048192
  s_lshl_b32 s87, s95, 11
  s_add_u32 s87, s87, 26214400
  v_cndmask_b32 v171, v14, v2, vcc
  s_lshl_b32 s41, s95, 2
  s_add_u32 s41, s41, 32768
  s_movk_i32 s36, 512
skip_6:
  s_lshl_b32 s12, s86, 12
  s_lshl_b32 s13, s7, 10
  s_add_u32 s90, s12, s13
  s_add_u32 s91, s90, 4096
  s_lshl_b32 s92, s24, 12
  s_add_u32 s92, s92, s13
  s_add_u32 s13, s13, 102432
  v_add_u32 v186, s13, v2
  v_lshrrev_b32_e64 v11, 1, v1
  v_mul_u32_u24 v11, 4160, v11
  v_and_b32_e64 v12, 1, v1
  v_lshl_add_u32 v11, v12, 4, v11
  v_add_u32 v163, 102400, v11
  s_waitcnt lgkmcnt(0)
  s_lshr_b32 s8, s8, 4
  s_mul_i32 s8, s8, 0x19660d
  s_add_u32 s8, s8, 0x3c6ef35f
  s_lshl_b32 s8, s8, 4
  s_cmp_eq_u32 s7, 1
  s_cbranch_scc1 w1_8
  s_cmp_eq_u32 s7, 2
  s_cbranch_scc1 w2_9
  s_cmp_eq_u32 s7, 3
  s_cbranch_scc1 w3_10
  s_branch join_7
w1_8:
  s_waitcnt vmcnt(8)
  v_lshlrev_b32 v229, 16, v229
  v_lshlrev_b32 v230, 16, v230
  v_lshlrev_b32 v231, 16, v231
  v_mul_f32 v231, 0x3fb8aa3b, v231
  v_exp_f32 v231, v231
  v_min_u32 v104, 39, v1
  v_mul_u32_u24 v102, 80, v104
  v_mul_u32_u24 v103, 176, v104
  v_cvt_pk_bf16_f32 v231, v231, v231
  v_and_b32 v231, 0xffff0000, v231
  v_mul_f32 v96, v231, v229
  v_mul_f32 v97, v231, v230
  v_mul_f32 v96, 0x3fb8aa3b, v96
  v_mul_f32 v97, 0x3e22f983, v97
  v_mul_f32 v98, 1.0, v96
  v_mul_f32 v99, 1.0, v97
  v_exp_f32 v98, v98
  v_fract_f32 v99, v99
  v_sin_f32 v100, v99
  v_cos_f32 v101, v99
  v_mul_f32 v107, v98, v100
  v_mul_f32_e64 v106, v98, v101
  v_mul_f32 v98, 0x41000000, v96
  v_mul_f32 v99, 0x41000000, v97
  v_exp_f32 v98, v98
  v_fract_f32 v99, v99
  v_sin_f32 v100, v99
  v_cos_f32 v101, v99
  v_mul_f32 v51, v98, v100
  v_mul_f32 v50, v98, v101
  v_mul_f32 v98, v229, v229
  v_fmac_f32 v98, v230, v230
  v_rcp_f32 v98, v98
  v_add_f32 v99, -1.0, v106
  v_add_f32 v98, v98, v98
  v_mul_f32 v100, v99, v229
  v_fmac_f32 v100, v107, v230
  v_mul_f32 v101, v107, v229
  v_fma_f32 v101, -v99, v230, v101
  v_mul_f32 v100, v98, v100
  v_mul_f32 v101, v98, v101
  v_and_b32 v98, 1, v104
  v_lshrrev_b32 v104, 1, v104
  v_lshlrev_b32_e64 v104, 4, v104
  v_lshl_add_u32 v104, v98, 2, v104
  v_add_u32 v104, 159744, v104
  v_add_u32 v102, 160640, v102
  v_add_u32 v103, 145184, v103
  ds_write2_b32 v104, v100, v101 offset0:0 offset1:2
  v_mov_b32 v48, 1.0
  v_mov_b32 v49, 0
  v_mov_b32 v84, 1.0
  v_mov_b32 v85, 0
  v_pk_mul_f32 v[52:53], v[50:51], v[50:51] op_sel:[1,1] op_sel_hi:[0,1] neg_lo:[0,1]
  v_pk_mul_f32 v[108:109], v[106:107], v[106:107] op_sel:[1,1] op_sel_hi:[0,1] neg_lo:[0,1]
  v_pk_fma_f32 v[52:53], v[50:51], v[50:51], v[52:53] op_sel:[0,0,0] op_sel_hi:[1,0,1]
  v_pk_fma_f32 v[108:109], v[106:107], v[106:107], v[108:109] op_sel:[0,0,0] op_sel_hi:[1,0,1]
  v_pk_mul_f32 v[54:55], v[52:53], v[50:51] op_sel:[1,1] op_sel_hi:[0,1] neg_lo:[0,1]
  v_pk_mul_f32 v[110:111], v[108:109], v[106:107] op_sel:[1,1] op_sel_hi:[0,1] neg_lo:[0,1]
  v_pk_fma_f32 v[54:55], v[52:53], v[50:51], v[54:55] op_sel:[0,0,0] op_sel_hi:[1,0,1]
  v_pk_fma_f32 v[110:111], v[108:109], v[106:107], v[110:111] op_sel:[0,0,0] op_sel_hi:[1,0,1]
  ds_write_b128 v103, v[48:51] offset:0
  v_pk_mul_f32 v[56:57], v[54:55], v[50:51] op_sel:[1,1] op_sel_hi:[0,1] neg_lo:[0,1]
  v_pk_mul_f32 v[112:113], v[110:111], v[106:107] op_sel:[1,1] op_sel_hi:[0,1] neg_lo:[0,1]
  v_pk_fma_f32 v[56:57], v[54:55], v[50:51], v[56:57] op_sel:[0,0,0] op_sel_hi:[1,0,1]
  v_pk_fma_f32 v[112:113], v[110:111], v[106:107], v[112:113] op_sel:[0,0,0] op_sel_hi:[1,0,1]
  v_pk_mul_f32 v[58:59], v[56:57], v[50:51] op_sel:[1,1] op_sel_hi:[0,1] neg_lo:[0,1]
  v_pk_mul_f32 v[114:115], v[112:113], v[106:107] op_sel:[1,1] op_sel_hi:[0,1] neg_lo:[0,1]
  v_pk_fma_f32 v[58:59], v[56:57], v[50:51], v[58:59] op_sel:[0,0,0] op_sel_hi:[1,0,1]
  v_pk_fma_f32 v[114:115], v[112:113], v[106:107], v[114:115] op_sel:[0,0,0] op_sel_hi:[1,0,1]
  ds_write_b128 v103, v[52:55] offset:16
  v_pk_mul_f32 v[60:61], v[58:59], v[50:51] op_sel:[1,1] op_sel_hi:[0,1] neg_lo:[0,1]
  v_pk_mul_f32 v[116:117], v[114:115], v[106:107] op_sel:[1,1] op_sel_hi:[0,1] neg_lo:[0,1]
  v_pk_fma_f32 v[60:61], v[58:59], v[50:51], v[60:61] op_sel:[0,0,0] op_sel_hi:[1,0,1]
  v_pk_fma_f32 v[116:117], v[114:115], v[106:107], v[116:117] op_sel:[0,0,0] op_sel_hi:[1,0,1]
  v_pk_mul_f32 v[62:63], v[60:61], v[50:51] op_sel:[1,1] op_sel_hi:[0,1] neg_lo:[0,1]
  v_pk_mul_f32 v[118:119], v[116:117], v[106:107] op_sel:[1,1] op_sel_hi:[0,1] neg_lo:[0,1]
  v_pk_fma_f32 v[62:63], v[60:61], v[50:51], v[62:63] op_sel:[0,0,0] op_sel_hi:[1,0,1]
  v_pk_fma_f32 v[118:119], v[116:117], v[106:107], v[118:119] op_sel:[0,0,0] op_sel_hi:[1,0,1]
  ds_write_b128 v103, v[56:59] offset:32
  v_pk_mul_f32 v[64:65], v[62:63], v[50:51] op_sel:[1,1] op_sel_hi:[0,1] neg_lo:[0,1]
  v_pk_fma_f32 v[64:65], v[62:63], v[50:51], v[64:65] op_sel:[0,0,0] op_sel_hi:[1,0,1]
  ds_write2_b32 v102, v106, v107 offset0:0 offset1:8
  v_pk_mul_f32 v[66:67], v[64:65], v[50:51] op_sel:[1,1] op_sel_hi:[0,1] neg_lo:[0,1]
  v_pk_fma_f32 v[66:67], v[64:65], v[50:51], v[66:67] op_sel:[0,0,0] op_sel_hi:[1,0,1]
  ds_write2_b32 v102, v108, v109 offset0:1 offset1:9
  ds_write_b128 v103, v[60:63] offset:48
  v_pk_mul_f32 v[68:69], v[66:67], v[50:51] op_sel:[1,1] op_sel_hi:[0,1] neg_lo:[0,1]
  v_pk_fma_f32 v[68:69], v[66:67], v[50:51], v[68:69] op_sel:[0,0,0] op_sel_hi:[1,0,1]
  ds_write2_b32 v102, v110, v111 offset0:2 offset1:10
  v_pk_mul_f32 v[70:71], v[68:69], v[50:51] op_sel:[1,1] op_sel_hi:[0,1] neg_lo:[0,1]
  v_pk_fma_f32 v[70:71], v[68:69], v[50:51], v[70:71] op_sel:[0,0,0] op_sel_hi:[1,0,1]
  ds_write2_b32 v102, v112, v113 offset0:3 offset1:11
  ds_write_b128 v103, v[64:67] offset:64
  v_pk_mul_f32 v[72:73], v[70:71], v[50:51] op_sel:[1,1] op_sel_hi:[0,1] neg_lo:[0,1]
  v_pk_fma_f32 v[72:73], v[70:71], v[50:51], v[72:73] op_sel:[0,0,0] op_sel_hi:[1,0,1]
  ds_write2_b32 v102, v114, v115 offset0:4 offset1:12
  v_pk_mul_f32 v[74:75], v[72:73], v[50:51] op_sel:[1,1] op_sel_hi:[0,1] neg_lo:[0,1]
  v_pk_fma_f32 v[74:75], v[72:73], v[50:51], v[74:75] op_sel:[0,0,0] op_sel_hi:[1,0,1]
  ds_write2_b32 v102, v116, v117 offset0:5 offset1:13
  ds_write_b128 v103, v[68:71] offset:80
  v_pk_mul_f32 v[76:77], v[74:75], v[50:51] op_sel:[1,1] op_sel_hi:[0,1] neg_lo:[0,1]
  v_pk_fma_f32 v[76:77], v[74:75], v[50:51], v[76:77] op_sel:[0,0,0] op_sel_hi:[1,0,1]
  ds_write2_b32 v102, v118, v119 offset0:6 offset1:14
  v_pk_mul_f32 v[78:79], v[76:77], v[50:51] op_sel:[1,1] op_sel_hi:[0,1] neg_lo:[0,1]
  v_pk_fma_f32 v[78:79], v[76:77], v[50:51], v[78:79] op_sel:[0,0,0] op_sel_hi:[1,0,1]
  ds_write_b128 v103, v[72:75] offset:96
  v_pk_mul_f32 v[80:81], v[78:79], v[50:51] op_sel:[1,1] op_sel_hi:[0,1] neg_lo:[0,1]
  v_pk_fma_f32 v[80:81], v[78:79], v[50:51], v[80:81] op_sel:[0,0,0] op_sel_hi:[1,0,1]
  ds_write2_b32 v102, v50, v51 offset0:7 offset1:15
  ds_write_b128 v103, v[76:79] offset:112
  v_pk_mul_f32 v[98:99], v[80:81], v[80:81] op_sel:[1,1] op_sel_hi:[0,1] neg_lo:[0,1]
  v_pk_fma_f32 v[98:99], v[80:81], v[80:81], v[98:99] op_sel:[0,0,0] op_sel_hi:[1,0,1]
  v_pk_mul_f32 v[86:87], v[98:99], v[98:99] op_sel:[1,1] op_sel_hi:[0,1] neg_lo:[0,1]
  v_pk_fma_f32 v[86:87], v[98:99], v[98:99], v[86:87] op_sel:[0,0,0] op_sel_hi:[1,0,1]
  v_pk_mul_f32 v[88:89], v[86:87], v[86:87] op_sel:[1,1] op_sel_hi:[0,1] neg_lo:[0,1]
  v_pk_fma_f32 v[88:89], v[86:87], v[86:87], v[88:89] op_sel:[0,0,0] op_sel_hi:[1,0,1]
  v_pk_mul_f32 v[90:91], v[88:89], v[86:87] op_sel:[1,1] op_sel_hi:[0,1] neg_lo:[0,1]
  v_pk_fma_f32 v[90:91], v[88:89], v[86:87], v[90:91] op_sel:[0,0,0] op_sel_hi:[1,0,1]
  ds_write_b64 v103, v[80:81] offset:128
  ds_write_b128 v103, v[84:87] offset:144
  ds_write_b128 v103, v[88:91] offset:160
  s_branch join_7
w2_9:
  v_mov_b32 v88, 0
  s_lshl_b32 s12, s0, 11
  s_lshl_b32 s13, s1, 2
  s_add_u32 s12, s12, s13
  s_add_u32 s12, s12, 66560
  s_or_b32 s13, s8, s11
  v_mov_b32 v15, s13
  s_mov_b64 exec, 1
  buffer_store_dword v15, off, s[52:55], s12
  s_mov_b64 exec, -1
  s_lshl_b32 s12, s0, 11
  s_lshl_b32 s13, s1, 2
  s_add_u32 s12, s12, s13
  s_add_u32 s12, s12, 66560
  s_or_b32 s13, s8, s11
  v_mov_b32 v15, s13
  s_mov_b64 exec, 1
  buffer_store_dword v15, off, s[52:55], s12 offset:128 sc1
  s_mov_b64 exec, -1
  v_mov_b32 v89, 0
  v_mov_b32 v90, s8
  v_mov_b32_e64 v91, s8
  s_add_u32 s12, s83, 327680
  s_mov_b32 exec_hi, 0xff
  buffer_store_dwordx4 v[88:91], v2, s[52:55], s83 offen sc1
  buffer_store_dwordx4 v[88:91], v2, s[52:55], s12 offen sc1
  s_mov_b32 exec_hi, -1
  s_branch join_7
w3_10:
  s_waitcnt vmcnt(0)
  v_dot2_f32_bf16 v88, v48, s2, 0
  v_dot2_f32_bf16 v90, v48, v48, 0
  v_dot2_f32_bf16 v88, v49, s2, v88
  v_dot2_f32_bf16 v90, v49, v49, v90
  v_dot2_f32_bf16 v88, v50, s2, v88
  v_dot2_f32_bf16 v90, v50, v50, v90
  v_dot2_f32_bf16 v88, v51, s2, v88
  v_dot2_f32_bf16 v90, v51, v51, v90
  v_dot2_f32_bf16 v88, v52, s2, v88
  v_dot2_f32_bf16 v90, v52, v52, v90
  v_dot2_f32_bf16 v88, v53, s2, v88
  v_dot2_f32_bf16 v90, v53, v53, v90
  v_dot2_f32_bf16 v88, v54, s2, v88
  v_dot2_f32_bf16 v90, v54, v54, v90
  v_dot2_f32_bf16 v88, v55, s2, v88
  v_dot2_f32_bf16 v90, v55, v55, v90
  v_dot2_f32_bf16 v88, v56, s2, v88
  v_dot2_f32_bf16 v90, v56, v56, v90
  v_dot2_f32_bf16 v88, v57, s2, v88
  v_dot2_f32_bf16 v90, v57, v57, v90
  v_dot2_f32_bf16 v88, v58, s2, v88
  v_dot2_f32_bf16 v90, v58, v58, v90
  v_dot2_f32_bf16 v88, v59, s2, v88
  v_dot2_f32_bf16 v90, v59, v59, v90
  v_dot2_f32_bf16 v88, v60, s2, v88
  v_dot2_f32_bf16 v90, v60, v60, v90
  v_dot2_f32_bf16 v88, v61, s2, v88
  v_dot2_f32_bf16 v90, v61, v61, v90
  v_dot2_f32_bf16 v88, v62, s2, v88
  v_dot2_f32_bf16 v90, v62, v62, v90
  v_dot2_f32_bf16 v88, v63, s2, v88
  v_dot2_f32_bf16 v90, v63, v63, v90
  v_dot2_f32_bf16 v88, v64, s2, v88
  v_dot2_f32_bf16 v90, v64, v64, v90
  v_dot2_f32_bf16 v88, v65, s2, v88
  v_dot2_f32_bf16 v90, v65, v65, v90
  v_dot2_f32_bf16 v88, v66, s2, v88
  v_dot2_f32_bf16 v90, v66, v66, v90
  v_dot2_f32_bf16 v88, v67, s2, v88
  v_dot2_f32_bf16 v90, v67, v67, v90
  v_dot2_f32_bf16 v88, v68, s2, v88
  v_dot2_f32_bf16 v90, v68, v68, v90
  v_dot2_f32_bf16 v88, v69, s2, v88
  v_dot2_f32_bf16 v90, v69, v69, v90
  v_dot2_f32_bf16 v88, v70, s2, v88
  v_dot2_f32_bf16 v90, v70, v70, v90
  v_dot2_f32_bf16 v88, v71, s2, v88
  v_dot2_f32_bf16 v90, v71, v71, v90
  v_dot2_f32_bf16 v88, v72, s2, v88
  v_dot2_f32_bf16 v90, v72, v72, v90
  v_dot2_f32_bf16 v88, v73, s2, v88
  v_dot2_f32_bf16 v90, v73, v73, v90
  v_dot2_f32_bf16 v88, v74, s2, v88
  v_dot2_f32_bf16 v90, v74, v74, v90
  v_dot2_f32_bf16 v88, v75, s2, v88
  v_dot2_f32_bf16 v90, v75, v75, v90
  v_dot2_f32_bf16 v88, v76, s2, v88
  v_dot2_f32_bf16 v90, v76, v76, v90
  v_dot2_f32_bf16 v88, v77, s2, v88
  v_dot2_f32_bf16 v90, v77, v77, v90
  v_dot2_f32_bf16 v88, v78, s2, v88
  v_dot2_f32_bf16 v90, v78, v78, v90
  v_dot2_f32_bf16 v88, v79, s2, v88
  v_dot2_f32_bf16 v90, v79, v79, v90
  v_dot2_f32_bf16 v88, v80, s2, v88
  v_dot2_f32_bf16 v90, v80, v80, v90
  v_dot2_f32_bf16 v88, v81, s2, v88
  v_dot2_f32_bf16 v90, v81, v81, v90
  v_dot2_f32_bf16 v88, v82, s2, v88
  v_dot2_f32_bf16 v90, v82, v82, v90
  v_dot2_f32_bf16 v88, v83, s2, v88
  v_dot2_f32_bf16 v90, v83, v83, v90
  v_dot2_f32_bf16 v88, v84, s2, v88
  v_dot2_f32_bf16 v90, v84, v84, v90
  v_dot2_f32_bf16 v88, v85, s2, v88
  v_dot2_f32_bf16 v90, v85, v85, v90
  v_dot2_f32_bf16 v88, v86, s2, v88
  v_dot2_f32_bf16 v90, v86, v86, v90
  v_dot2_f32_bf16 v88, v87, s2, v88
  v_dot2_f32_bf16 v90, v87, v87, v90
  s_nop 1
  v_add_f32_dpp v88, v88, v88 quad_perm:[1,0,3,2] row_mask:0xf bank_mask:0xf
  v_add_f32_dpp v90, v90, v90 quad_perm:[1,0,3,2] row_mask:0xf bank_mask:0xf
  s_nop 0
  v_add_f32_dpp v88, v88, v88 quad_perm:[2,3,0,1] row_mask:0xf bank_mask:0xf
  v_add_f32_dpp v90, v90, v90 quad_perm:[2,3,0,1] row_mask:0xf bank_mask:0xf
  s_nop 0
  v_add_f32_dpp v88, v88, v88 row_half_mirror row_mask:0xf bank_mask:0xf
  v_add_f32_dpp v90, v90, v90 row_half_mirror row_mask:0xf bank_mask:0xf
  v_mul_f32 v88, 0x3acccccd, v88
  v_mul_f32 v90, 0x3acccccd, v90
  v_fma_f32 v90, -v88, v88, v90
  v_max_f32_e64 v90, 0, v90
  v_cvt_pk_bf16_f32 v88, v88, v88
  v_and_b32 v88, 0xffff0000, v88
  v_cvt_pk_bf16_f32 v90, v90, v90
  v_and_b32 v90, 0xffff0000, v90
  v_add_f32 v90, 0x3727c5ac, v90
  v_cvt_pk_bf16_f32 v90, v90, v90
  v_and_b32 v90, 0xffff0000, v90
  v_sqrt_f32 v90, v90
  s_nop 0
  v_cvt_pk_bf16_f32 v90, v90, v90
  v_and_b32 v90, 0xffff0000, v90
  v_rcp_f32 v89, v90
  v_mov_b32 v90, s8
  v_mov_b32 v91, s8
  v_lshlrev_b32 v11, 1, v1
  s_lshl_b32 s12, s3, 4
  s_add_u32 s12, s12, s4
  s_lshl_b32 s12, s12, 7
  s_add_u32 s12, s12, 262144
  s_mov_b32 exec_lo, 0x01010101
  s_mov_b32 exec_hi, 0x01010101
  buffer_store_dwordx4 v[88:91], v11, s[52:55], s12 offen sc1
  s_mov_b64 exec, -1
join_7:
  s_lshl_b32 s93, s3, 11
  s_lshl_b32 s12, s7, 9
  s_add_u32 s93, s93, s12
  s_add_u32 s93, s93, 262144
  v_and_b32 v160, 7, v3
  v_lshlrev_b32_e64 v160, 4, v160
  v_lshl_add_u32 v160, v4, 7, v160
  s_mul_i32 s94, s4, 640
  s_add_u32 s94, s94, 303104
  v_lshlrev_b32 v161, 3, v1
  v_lshlrev_b32 v162, 3, v3
  v_and_b32 v187, 31, v1
  v_lshlrev_b32 v187, 4, v187
  s_lshl_b32 s88, s6, 11
  s_add_u32 s88, s88, 66048
  v_and_b32 v185, 31, v1
  v_lshlrev_b32 v185, 2, v185
  s_lshl_b32 s89, s0, 11
  s_add_u32 s89, s89, 66560
  v_add_u32 v11, 1, v3
  v_and_b32 v12, 1, v11
  v_mul_u32_u24 v12, 4160, v12
  v_lshrrev_b32_e64 v11, 1, v11
  v_lshl_add_u32 v12, v11, 2, v12
  v_lshl_add_u32 v12, v4, 4, v12
  v_sub_u32 v11, 15, v3
  v_lshlrev_b32 v11, 5, v11
  v_lshl_add_u32 v11, v4, 4, v11
  s_lshr_b32 s12, s7, 1
  s_and_b32 s13, s7, 1
  s_lshl_b32 s13, s13, 8
  s_mul_i32 s14, s12, 8320
  s_add_u32 s14, s14, s13
  s_add_u32 s14, s14, 102400
  v_add_u32_e64 v232, s14, v12
  s_mul_i32 s14, s12, 4608
  s_add_u32 s14, s14, s13
  v_add_u32 v240, s14, v11
  s_lshl_b32 s13, s7, 7
  s_add_u32 s14, s13, 119040
  v_add_u32 v236, s14, v12
  s_add_u32 s14, s13, 9216
  v_add_u32_e64 v241, s14, v11
  s_mul_i32 s13, s5, 163840
  s_mul_i32 s14, s7, 10240
  s_add_u32 s13, s13, s14
  s_add_u32 s13, s13, 0
  s_add_u32 s14, s7, 1
  s_and_b32 s14, s14, 3
  s_mul_i32 s15, s14, 40960
  s_add_u32 s16, s15, s13
  s_mul_i32 s15, s14, 10240
  s_add_u32 s15, s15, 102400
  v_add_u32 v44, s15, v2
  s_add_u32 s14, s7, 2
  s_and_b32 s14, s14, 3
  s_mul_i32 s15, s14, 40960
  s_add_u32 s17, s15, s13
  s_mul_i32 s15, s14, 10240
  s_add_u32 s15, s15, 107520
  v_add_u32 v45, s15, v2
  s_add_u32 s14, s7, 3
  s_and_b32 s14, s14, 3
  s_mul_i32 s15, s14, 40960
  s_add_u32 s18, s15, s13
  s_mul_i32 s15, s14, 5120
  v_add_u32 v46, s15, v2
  s_add_u32 s14, s7, 4
  s_and_b32 s14, s14, 3
  s_mul_i32 s15, s14, 40960
  s_add_u32 s19, s15, s13
  s_lshl_b32 s49, s3, 10
  s_lshl_b32 s13, s7, 6
  s_add_u32 s49, s49, s13
  s_and_b32 s13, s5, 1
  s_lshl_b32 s13, s13, 3
  s_add_u32 s49, s49, s13
  s_add_u32 s49, s49, 4352
  v_and_b32 v244, 3, v1
  v_lshlrev_b32 v244, 4, v244
  s_lshr_b32 s13, s7, 1
  s_add_u32 s12, s86, s13
  s_bitcmp1_b32 s12, 0
  s_cselect_b32 s14, 16, 0
  s_lshr_b32 s72, s72, s14
  s_and_b32 s30, s72, 0xffff
  s_lshl_b32 s31, s72, 16
  s_bitcmp1_b32 s24, 0
  s_cselect_b32 s14, 16, 0
  s_lshr_b32 s73, s73, s14
  s_and_b32 s25, s73, 0xffff
  s_lshl_b32 s45, s73, 16
  s_lshl_b32 s50, s12, 12
  s_and_b32 s12, s7, 1
  s_lshl_b32 s12, s12, 11
  s_add_u32 s50, s50, s12
  s_add_u32 s50, s50, 19922944
  s_mul_i32 s13, s13, 4608
  s_sub_u32 s13, s13, s12
  s_add_u32 s13, s13, 2552
  v_lshlrev_b32_e64 v246, 5, v3
  v_lshl_add_u32 v246, v4, 3, v246
  v_sub_u32 v247, s13, v246
  s_bitcmp1_b32 s1, 0
  s_movk_i32 s12, 0x7421
  s_cselect_b32 s12, 0x6530, s12
  s_lshl_b32 s13, s7, 2
  s_lshr_b32 s12, s12, s13
  s_and_b32 s12, s12, 7
  s_lshl_b32 s12, s12, 9
  s_lshl_b32 s51, s24, 12
  s_add_u32 s51, s51, s12
  s_add_u32 s51, s51, 19922944
  s_sub_u32 s12, 13304, s12
  v_sub_u32 v248, s12, v246
  s_lshl_b32 s12, s7, 12
  s_add_u32 s13, s12, 102400
  v_add_u32 v252, s13, v2
  s_add_u32 s13, s12, 127360
  v_add_u32_e64 v249, s13, v2
  s_xor_b32 s13, s12, 4096
  s_add_u32 s13, s13, 127360
  v_add_u32 v250, s13, v2
  s_lshl_b32 s13, s7, 10
  s_add_u32 s13, s13, 102400
  v_add_u32_e64 v251, s13, v2
  v_accvgpr_write_b32 a200, v232
  v_accvgpr_write_b32 a201, v236
  v_accvgpr_write_b32 a202, v240
  v_accvgpr_write_b32 a203, v241
  v_accvgpr_write_b32 a204, v246
  v_accvgpr_write_b32 a205, v247
  v_accvgpr_write_b32 a206, v248
  v_accvgpr_write_b32 a207, v249
  v_accvgpr_write_b32 a208, v250
  v_accvgpr_write_b32 a209, v251
  v_accvgpr_write_b32 a210, v252
  v_accvgpr_write_b32 a211, v44
  v_accvgpr_write_b32 a212, v45
  v_accvgpr_write_b32 a213, v46
  v_accvgpr_write_b32 a214, v244
  s_lshl_b32 s12, s5, 6
  s_lshr_b32 s13, s7, 1
  s_lshl_b32 s13, s13, 5
  s_add_u32 s12, s12, s13
  s_and_b32 s13, s7, 1
  s_lshl_b32 s13, s13, 2
  s_add_u32 s12, s12, s13
  s_mul_i32 s20, s12, 1280
  s_mul_i32 s13, s6, 160
  s_add_u32 s20, s20, s13
  s_lshl_b32 s48, s7, 12
  s_add_u32 s48, s48, 127360
  v_add_u32 v11, 0, v1
  v_mul_u32_u24 v12, 205, v11
  v_lshrrev_b32 v12, 11, v12
  v_lshrrev_b32 v13, 2, v12
  v_mul_u32_u24 v12, 1120, v12
  v_mul_u32_u24 v13, 5120, v13
  v_lshlrev_b32_e64 v11, 4, v11
  v_add3_u32 v224, v11, v12, v13
  v_add_u32_e64 v11, 64, v1
  v_mul_u32_u24 v12, 205, v11
  v_lshrrev_b32 v12, 11, v12
  v_lshrrev_b32 v13, 2, v12
  v_mul_u32_u24 v12, 1120, v12
  v_mul_u32_u24 v13, 5120, v13
  v_lshlrev_b32_e64 v11, 4, v11
  v_add3_u32 v225, v11, v12, v13
  v_add_u32 v11, 128, v1
  v_mul_u32_u24 v12, 205, v11
  v_lshrrev_b32 v12, 11, v12
  v_lshrrev_b32 v13, 2, v12
  v_mul_u32_u24 v12, 1120, v12
  v_mul_u32_u24 v13, 5120, v13
  v_lshlrev_b32_e64 v11, 4, v11
  v_add3_u32 v226, v11, v12, v13
  s_and_b32 s12, s5, 1
  s_lshl_b32 s12, s12, 2
  s_add_u32 s12, s12, s7
  s_lshr_b32 s13, s12, 1
  s_lshl_b32 s13, s13, 8
  s_and_b32 s12, s12, 1
  s_lshl_b32 s12, s12, 5
  s_add_u32 s12, s12, s13
  s_add_u32 s12, s12, 158720
  v_lshrrev_b32 v12, 2, v3
  v_lshlrev_b32 v12, 6, v12
  v_and_b32_e64 v13, 3, v3
  v_lshl_add_u32 v12, v13, 3, v12
  v_add_u32 v227, s12, v12
  v_and_b32 v13, 7, v3
  v_lshlrev_b32_e64 v13, 3, v13
  v_lshl_add_u32 v13, v4, 6, v13
  s_lshl_b32 s12, s7, 8
  s_add_u32 s12, s12, 158720
  v_add_u32 v228, s12, v13
  v_lshl_add_u32 v243, v4, 3, s48
  v_mul_u32_u24 v242, 160, v3
  v_lshl_add_u32 v242, v4, 3, v242
  v_add_u32 v242, s48, v242
  s_lshl_b32 s12, s3, 4
  s_add_u32 s12, s12, s4
  s_lshl_b32 s12, s12, 12
  s_add_u32 s12, s12, 1310720
  s_sub_u32 s12, s12, 0
  v_mov_b32 v11, s12
  s_lshl_b32 s12, s3, 10
  s_add_u32 s12, s12, 4096
  s_sub_u32 s12, s12, 3072
  v_cmp_lt_u32 vcc, 23, v1
  v_mov_b32 v15, s12
  s_nop 0
  v_cndmask_b32 v11, v11, v15, vcc
  v_lshl_add_u32 v11, v1, 7, v11
  v_accvgpr_write_b32 a245, v11
  s_add_u32 m0, s75, 0
  s_add_u32 s14, s74, 0
  buffer_load_dwordx4 v148, s[56:59], s14 offen lds
  buffer_load_dwordx4 v149, s[56:59], s14 offen offset:2048 lds
  s_add_u32 m0, s75, 4096
  s_add_u32 s14, s74, 20480
  buffer_load_dwordx4 v148, s[56:59], s14 offen lds
  buffer_load_dwordx4 v149, s[56:59], s14 offen offset:2048 lds
  s_add_u32 m0, s75, 8192
  s_add_u32 s14, s74, 40960
  buffer_load_dwordx4 v148, s[56:59], s14 offen lds
  s_add_u32 m0, s77, 0
  s_add_u32 s15, s76, 0
  buffer_load_dwordx4 v146, s[68:71], s15 offen lds
  buffer_load_dwordx4 v147, s[68:71], s15 offen offset:1024 lds
  s_add_u32 m0, s77, 8192
  s_add_u32 s15, s76, 5120
  buffer_load_dwordx4 v146, s[68:71], s15 offen lds
  buffer_load_dwordx4 v147, s[68:71], s15 offen offset:1024 lds
  v_mul_u32_u24 v11, 171, v1
  v_lshrrev_b32 v11, 11, v11
  v_mul_u32_u24 v12, 12, v11
  v_sub_u32 v12, v1, v12
  s_mul_i32 s12, s4, 5
  v_min_u32 v13, 4, v11
  v_add_u32 v13, s12, v13
  s_mul_i32 s13, s7, 12
  v_add_u32 v12, s13, v12
  v_cmp_gt_u32 vcc, 40, v12
  v_cmp_gt_u32 s[14:15], 5, v11
  s_lshr_b32 s13, s1, 4
  s_mul_i32 s13, s13, 40
  v_min_u32 v12, 39, v12
  s_and_b64 vcc, vcc, s[14:15]
  v_add_u32_e64 v12, s13, v12
  s_mul_i32 s14, s0, 102400
  v_mul_u32_u24 v14, 1280, v12
  v_lshl_add_u32 v14, v13, 4, v14
  v_add_u32_e64 v14, s14, v14
  global_load_dwordx4 v[176:179], v14, s[26:27]
  global_load_dwordx4 v[180:183], v14, s[28:29]
  v_lshrrev_b32_e64 v14, 2, v13
  v_mul_u32_u24 v14, 10240, v14
  v_and_b32_e64 v13, 3, v13
  v_lshl_add_u32 v14, v13, 8, v14
  v_lshrrev_b32_e64 v13, 4, v12
  v_lshl_add_u32 v14, v13, 10, v14
  v_and_b32_e64 v12, 15, v12
  v_lshl_add_u32 v14, v12, 4, v14
  v_mov_b32 v13, 1879048192
  v_cndmask_b32 v174, v13, v14, vcc
  v_min_u32 v11, 4, v11
  v_lshlrev_b32_e64 v11, 6, v11
  v_add_u32 v175, 159744, v11
  s_waitcnt vmcnt(11)
  s_waitcnt lgkmcnt(0)
  s_barrier
  buffer_load_dword v184, v185, s[52:55], s89 offen sc1
  v_lshrrev_b32 v11, 1, v3
  v_mul_u32_u24 v12, 176, v11
  v_mul_u32_u24 v11, 80, v11
  v_and_b32_e64 v13, 1, v3
  v_lshl_add_u32 v12, v13, 2, v12
  v_lshl_add_u32 v12, v4, 3, v12
  s_lshl_b32 s12, s7, 5
  s_add_u32 s12, s12, 145184
  v_add_u32 v12, s12, v12
  v_add_u32 v11, 160640, v11
  v_cvt_f32_u32 v151, v13
  v_min_u32 v13, 39, v1
  v_mul_u32_u24 v13, 176, v13
  v_fma_f32 v151, 2.0, v151, -1.0
  v_add_u32 v13, 145184, v13
  s_lshl_b32 s12, s7, 3
  ds_read_b32 v16, v11 offset:0
  ds_read_b32 v21, v11 offset:32
  ds_read_b32 v26, v12 offset:0
  ds_read_b32 v17, v11 offset:640
  ds_read_b32 v22, v11 offset:672
  ds_read_b32 v28, v12 offset:1408
  ds_read_b32 v18, v11 offset:1280
  ds_read_b32 v23, v11 offset:1312
  ds_read_b32 v30, v12 offset:2816
  ds_read_b32 v19, v11 offset:1920
  ds_read_b32 v24, v11 offset:1952
  ds_read_b32 v32, v12 offset:4224
  ds_read_b32 v20, v11 offset:2560
  ds_read_b32 v25, v11 offset:2592
  ds_read_b32 v34, v12 offset:5632
  ds_read_b64 v[36:37], v13 offset:8
  ds_read_b64 v[38:39], v13 offset:128
  v_add_u32 v13, s12, v13
  ds_read_b64 v[40:41], v13 offset:144
  s_cmp_eq_u32 s7, 3
  s_cbranch_scc1 w3_11
  ds_read_b128 v[88:91], v173
  ds_read_b128 v[92:95], v173 offset:16
  ds_read_b64 v[48:49], v172 offset:640
  ds_read_b64 v[50:51], v172 offset:768
  ds_read_b64 v[52:53], v172 offset:896
  ds_read_b64 v[54:55], v172 offset:1056
  ds_read_b64 v[56:57], v172 offset:1184
  ds_read_b64 v[58:59], v172 offset:1312
  ds_read_b64 v[60:61], v172 offset:1440
  ds_read_b64 v[62:63], v172 offset:1568
  ds_read_b64 v[64:65], v172 offset:1696
  ds_read_b64 v[66:67], v172 offset:1824
  ds_read_b64 v[68:69], v172 offset:1952
  ds_read_b64 v[70:71], v172 offset:13728
  ds_read_b64 v[72:73], v172 offset:13856
  ds_read_b64 v[74:75], v172 offset:13984
  ds_read_b64 v[76:77], v172 offset:14112
  ds_read_b64 v[78:79], v172 offset:14240
  ds_read_b64 v[80:81], v172 offset:14368
  ds_read_b64 v[82:83], v172 offset:14496
  ds_read_b64 v[84:85], v172 offset:14624
  s_waitcnt lgkmcnt(15)
  v_lshlrev_b32 v96, 16, v88
  v_and_b32 v100, 0xffff0000, v88
  v_lshlrev_b32_e64 v104, 16, v89
  v_and_b32 v108, 0xffff0000, v89
  v_lshlrev_b32_e64 v97, 16, v90
  v_and_b32 v101, 0xffff0000, v90
  v_lshlrev_b32_e64 v105, 16, v91
  v_and_b32 v109, 0xffff0000, v91
  v_lshlrev_b32_e64 v98, 16, v92
  v_and_b32 v102, 0xffff0000, v92
  v_lshlrev_b32_e64 v106, 16, v93
  v_and_b32 v110, 0xffff0000, v93
  v_lshlrev_b32_e64 v99, 16, v94
  v_and_b32 v103, 0xffff0000, v94
  v_lshlrev_b32_e64 v107, 16, v95
  v_and_b32 v111, 0xffff0000, v95
  s_waitcnt lgkmcnt(8)
  v_lshlrev_b32 v216, 16, v48
  v_and_b32 v217, 0xffff0000, v48
  v_pk_mul_f32 v[112:113], v[216:217], v[108:109]
  v_lshlrev_b32_e64 v218, 16, v50
  v_and_b32 v219, 0xffff0000, v50
  v_pk_mul_f32 v[114:115], v[218:219], v[108:109]
  v_lshlrev_b32_e64 v216, 16, v52
  v_and_b32 v217, 0xffff0000, v52
  v_pk_fma_f32 v[112:113], v[218:219], v[104:105], v[112:113]
  v_pk_mul_f32 v[116:117], v[216:217], v[108:109]
  v_lshlrev_b32_e64 v218, 16, v54
  v_and_b32 v219, 0xffff0000, v54
  v_pk_fma_f32 v[114:115], v[216:217], v[104:105], v[114:115]
  v_pk_fma_f32 v[112:113], v[216:217], v[100:101], v[112:113]
  v_pk_mul_f32 v[118:119], v[218:219], v[108:109]
  v_lshlrev_b32_e64 v216, 16, v56
  v_and_b32 v217, 0xffff0000, v56
  v_pk_fma_f32 v[116:117], v[218:219], v[104:105], v[116:117]
  v_pk_fma_f32 v[114:115], v[218:219], v[100:101], v[114:115]
  v_pk_fma_f32 v[112:113], v[218:219], v[96:97], v[112:113]
  v_pk_mul_f32 v[120:121], v[216:217], v[108:109]
  v_lshlrev_b32_e64 v218, 16, v58
  v_and_b32 v219, 0xffff0000, v58
  v_pk_fma_f32 v[118:119], v[216:217], v[104:105], v[118:119]
  v_pk_fma_f32 v[116:117], v[216:217], v[100:101], v[116:117]
  v_pk_fma_f32 v[114:115], v[216:217], v[96:97], v[114:115]
  v_pk_mul_f32 v[122:123], v[218:219], v[108:109]
  v_lshlrev_b32_e64 v216, 16, v60
  v_and_b32 v217, 0xffff0000, v60
  v_pk_fma_f32 v[120:121], v[218:219], v[104:105], v[120:121]
  v_pk_fma_f32 v[118:119], v[218:219], v[100:101], v[118:119]
  v_pk_fma_f32 v[116:117], v[218:219], v[96:97], v[116:117]
  v_pk_mul_f32 v[124:125], v[216:217], v[108:109]
  v_lshlrev_b32_e64 v218, 16, v62
  v_and_b32 v219, 0xffff0000, v62
  v_pk_fma_f32 v[122:123], v[216:217], v[104:105], v[122:123]
  v_pk_fma_f32 v[120:121], v[216:217], v[100:101], v[120:121]
  v_pk_fma_f32 v[118:119], v[216:217], v[96:97], v[118:119]
  v_pk_mul_f32 v[126:127], v[218:219], v[108:109]
  v_lshlrev_b32_e64 v216, 16, v64
  v_and_b32 v217, 0xffff0000, v64
  v_pk_fma_f32 v[124:125], v[218:219], v[104:105], v[124:125]
  v_pk_fma_f32 v[122:123], v[218:219], v[100:101], v[122:123]
  v_pk_fma_f32 v[120:121], v[218:219], v[96:97], v[120:121]
  v_pk_fma_f32 v[126:127], v[216:217], v[104:105], v[126:127]
  v_lshlrev_b32_e64 v218, 16, v66
  v_and_b32 v219, 0xffff0000, v66
  v_pk_fma_f32 v[124:125], v[216:217], v[100:101], v[124:125]
  v_pk_fma_f32 v[122:123], v[216:217], v[96:97], v[122:123]
  v_pk_fma_f32 v[126:127], v[218:219], v[100:101], v[126:127]
  v_lshlrev_b32_e64 v216, 16, v68
  v_and_b32 v217, 0xffff0000, v68
  v_pk_fma_f32 v[124:125], v[218:219], v[96:97], v[124:125]
  v_pk_fma_f32 v[126:127], v[216:217], v[96:97], v[126:127]
  s_waitcnt lgkmcnt(0)
  v_lshlrev_b32 v220, 16, v70
  v_and_b32 v221, 0xffff0000, v70
  v_lshlrev_b32_e64 v222, 16, v72
  v_and_b32 v223, 0xffff0000, v72
  v_pk_mul_f32 v[112:113], v[112:113], v[220:221]
  v_lshlrev_b32_e64 v220, 16, v74
  v_and_b32 v221, 0xffff0000, v74
  v_pk_mul_f32 v[114:115], v[114:115], v[222:223]
  v_lshlrev_b32_e64 v222, 16, v76
  v_and_b32 v223, 0xffff0000, v76
  v_pk_mul_f32 v[116:117], v[116:117], v[220:221]
  v_lshlrev_b32_e64 v220, 16, v78
  v_and_b32 v221, 0xffff0000, v78
  v_pk_mul_f32 v[118:119], v[118:119], v[222:223]
  v_lshlrev_b32_e64 v222, 16, v80
  v_and_b32 v223, 0xffff0000, v80
  v_pk_mul_f32 v[120:121], v[120:121], v[220:221]
  v_lshlrev_b32_e64 v220, 16, v82
  v_and_b32 v221, 0xffff0000, v82
  v_pk_mul_f32 v[122:123], v[122:123], v[222:223]
  v_lshlrev_b32_e64 v222, 16, v84
  v_and_b32 v223, 0xffff0000, v84
  v_pk_mul_f32 v[124:125], v[124:125], v[220:221]
  v_pk_mul_f32 v[126:127], v[126:127], v[222:223]
  v_cvt_pk_bf16_f32 v232, v126, v124
  v_cvt_pk_bf16_f32 v233, v122, v120
  v_cvt_pk_bf16_f32 v234, v118, v116
  v_cvt_pk_bf16_f32 v235, v114, v112
  v_cvt_pk_bf16_f32 v236, v127, v125
  v_cvt_pk_bf16_f32 v237, v123, v121
  v_cvt_pk_bf16_f32 v238, v119, v117
  v_cvt_pk_bf16_f32 v239, v115, v113
  v_lshlrev_b32_e64 v216, 16, v49
  v_and_b32 v217, 0xffff0000, v49
  v_pk_mul_f32 v[112:113], v[216:217], v[110:111]
  v_lshlrev_b32_e64 v218, 16, v51
  v_and_b32 v219, 0xffff0000, v51
  v_pk_mul_f32 v[114:115], v[218:219], v[110:111]
  v_lshlrev_b32_e64 v216, 16, v53
  v_and_b32 v217, 0xffff0000, v53
  v_pk_fma_f32 v[112:113], v[218:219], v[106:107], v[112:113]
  v_pk_mul_f32 v[116:117], v[216:217], v[110:111]
  v_lshlrev_b32_e64 v218, 16, v55
  v_and_b32 v219, 0xffff0000, v55
  v_pk_fma_f32 v[114:115], v[216:217], v[106:107], v[114:115]
  v_pk_fma_f32 v[112:113], v[216:217], v[102:103], v[112:113]
  v_pk_mul_f32 v[118:119], v[218:219], v[110:111]
  v_lshlrev_b32_e64 v216, 16, v57
  v_and_b32 v217, 0xffff0000, v57
  v_pk_fma_f32 v[116:117], v[218:219], v[106:107], v[116:117]
  v_pk_fma_f32 v[114:115], v[218:219], v[102:103], v[114:115]
  v_pk_fma_f32 v[112:113], v[218:219], v[98:99], v[112:113]
  v_pk_mul_f32 v[120:121], v[216:217], v[110:111]
  v_lshlrev_b32_e64 v218, 16, v59
  v_and_b32 v219, 0xffff0000, v59
  v_pk_fma_f32 v[118:119], v[216:217], v[106:107], v[118:119]
  v_pk_fma_f32 v[116:117], v[216:217], v[102:103], v[116:117]
  v_pk_fma_f32 v[114:115], v[216:217], v[98:99], v[114:115]
  v_pk_mul_f32 v[122:123], v[218:219], v[110:111]
  v_lshlrev_b32_e64 v216, 16, v61
  v_and_b32 v217, 0xffff0000, v61
  v_pk_fma_f32 v[120:121], v[218:219], v[106:107], v[120:121]
  v_pk_fma_f32 v[118:119], v[218:219], v[102:103], v[118:119]
  v_pk_fma_f32 v[116:117], v[218:219], v[98:99], v[116:117]
  v_pk_mul_f32 v[124:125], v[216:217], v[110:111]
  v_lshlrev_b32_e64 v218, 16, v63
  v_and_b32 v219, 0xffff0000, v63
  v_pk_fma_f32 v[122:123], v[216:217], v[106:107], v[122:123]
  v_pk_fma_f32 v[120:121], v[216:217], v[102:103], v[120:121]
  v_pk_fma_f32 v[118:119], v[216:217], v[98:99], v[118:119]
  v_pk_mul_f32 v[126:127], v[218:219], v[110:111]
  v_lshlrev_b32_e64 v216, 16, v65
  v_and_b32 v217, 0xffff0000, v65
  v_pk_fma_f32 v[124:125], v[218:219], v[106:107], v[124:125]
  v_pk_fma_f32 v[122:123], v[218:219], v[102:103], v[122:123]
  v_pk_fma_f32 v[120:121], v[218:219], v[98:99], v[120:121]
  v_pk_fma_f32 v[126:127], v[216:217], v[106:107], v[126:127]
  v_lshlrev_b32_e64 v218, 16, v67
  v_and_b32 v219, 0xffff0000, v67
  v_pk_fma_f32 v[124:125], v[216:217], v[102:103], v[124:125]
  v_pk_fma_f32 v[122:123], v[216:217], v[98:99], v[122:123]
  v_pk_fma_f32 v[126:127], v[218:219], v[102:103], v[126:127]
  v_lshlrev_b32_e64 v216, 16, v69
  v_and_b32 v217, 0xffff0000, v69
  v_pk_fma_f32 v[124:125], v[218:219], v[98:99], v[124:125]
  v_pk_fma_f32 v[126:127], v[216:217], v[98:99], v[126:127]
  v_lshlrev_b32_e64 v220, 16, v71
  v_and_b32 v221, 0xffff0000, v71
  v_lshlrev_b32_e64 v222, 16, v73
  v_and_b32 v223, 0xffff0000, v73
  v_pk_mul_f32 v[112:113], v[112:113], v[220:221]
  v_lshlrev_b32_e64 v220, 16, v75
  v_and_b32 v221, 0xffff0000, v75
  v_pk_mul_f32 v[114:115], v[114:115], v[222:223]
  v_lshlrev_b32_e64 v222, 16, v77
  v_and_b32 v223, 0xffff0000, v77
  v_pk_mul_f32 v[116:117], v[116:117], v[220:221]
  v_lshlrev_b32_e64 v220, 16, v79
  v_and_b32 v221, 0xffff0000, v79
  v_pk_mul_f32 v[118:119], v[118:119], v[222:223]
  v_lshlrev_b32_e64 v222, 16, v81
  v_and_b32 v223, 0xffff0000, v81
  v_pk_mul_f32 v[120:121], v[120:121], v[220:221]
  v_lshlrev_b32_e64 v220, 16, v83
  v_and_b32 v221, 0xffff0000, v83
  v_pk_mul_f32 v[122:123], v[122:123], v[222:223]
  v_lshlrev_b32_e64 v222, 16, v85
  v_and_b32 v223, 0xffff0000, v85
  v_pk_mul_f32 v[124:125], v[124:125], v[220:221]
  v_pk_mul_f32 v[126:127], v[126:127], v[222:223]
  v_cvt_pk_bf16_f32 v88, v126, v124
  v_cvt_pk_bf16_f32 v89, v122, v120
  v_cvt_pk_bf16_f32 v90, v118, v116
  v_cvt_pk_bf16_f32 v91, v114, v112
  v_cvt_pk_bf16_f32 v92, v127, v125
  v_cvt_pk_bf16_f32 v93, v123, v121
  v_cvt_pk_bf16_f32 v94, v119, v117
  v_cvt_pk_bf16_f32 v95, v115, v113
  s_waitcnt vmcnt(0)
  v_xor_b32 v15, s8, v184
  v_cmp_lt_u32 vcc, 15, v15
  s_cbranch_vccnz again_13
ok_14:
  s_or_b32 s13, s8, s11
  v_cmp_ne_u32 vcc, s13, v184
  s_cmp_eq_u64 vcc, 0
  s_cselect_b32 s9, 1, 0
  s_cmp_eq_u32 s7, 2
  s_cselect_b32 s40, 0, s9
  buffer_store_dwordx4 v[232:235], v171, s[52:55], s87 offen sc1
  s_add_u32 s87, s87, s36
  buffer_store_dwordx4 v[236:239], v171, s[52:55], s87 offen sc1
  s_add_u32 s87, s87, s36
  buffer_store_dwordx4 v[88:91], v171, s[52:55], s87 offen sc1
  s_add_u32 s87, s87, s36
  buffer_store_dwordx4 v[92:95], v171, s[52:55], s87 offen sc1
  s_branch join_12
w3_11:
  s_lshl_b32 s12, s4, 3
  s_and_b32 s13, s3, 7
  s_add_u32 s12, s12, s13
  s_mul_i32 s12, s12, 6400
  s_mov_b32 exec_hi, 0xff
  buffer_load_dwordx4 v[48:51], v150, s[60:63], s12 offen offset:0
  buffer_load_dwordx4 v[52:55], v150, s[60:63], s12 offen offset:128
  buffer_load_dwordx4 v[56:59], v150, s[60:63], s12 offen offset:256
  buffer_load_dwordx4 v[60:63], v150, s[60:63], s12 offen offset:384
  buffer_load_dwordx4 v[64:67], v150, s[60:63], s12 offen offset:512
  buffer_load_dwordx4 v[68:71], v150, s[60:63], s12 offen offset:640
  buffer_load_dwordx4 v[72:75], v150, s[60:63], s12 offen offset:768
  buffer_load_dwordx4 v[76:79], v150, s[60:63], s12 offen offset:896
  buffer_load_dwordx4 v[80:83], v150, s[60:63], s12 offen offset:1024
  buffer_load_dwordx4 v[84:87], v150, s[60:63], s12 offen offset:1152
  s_mov_b32 exec_hi, -1
  s_mov_b32 s64, s22
  s_and_b32 s65, s23, 0xffff
  s_mov_b32 s66, 819200
  s_mov_b32 s67, 0x20000
  v_xor_b32 v11, 64, v148
  v_xor_b32_e64 v12, 64, v149
  s_mul_i32 s15, s4, 51200
  s_add_u32 s14, s15, 256
  s_mov_b32 m0, 20480
  s_nop 0
  buffer_load_dwordx4 v11, s[64:67], s14 offen lds
  buffer_load_dwordx4 v12, s[64:67], s14 offen offset:2048 lds
  s_mov_b32 m0, 21504
  s_nop 0
  buffer_load_dwordx4 v148, s[56:59], s14 offen lds
  buffer_load_dwordx4 v149, s[56:59], s14 offen offset:2048 lds
  s_add_u32 s14, s15, 20736
  s_mov_b32 m0, 24576
  s_nop 0
  buffer_load_dwordx4 v11, s[64:67], s14 offen lds
  buffer_load_dwordx4 v12, s[64:67], s14 offen offset:2048 lds
  s_mov_b32 m0, 25600
  s_nop 0
  buffer_load_dwordx4 v148, s[56:59], s14 offen lds
  buffer_load_dwordx4 v149, s[56:59], s14 offen offset:2048 lds
  s_add_u32 s14, s15, 41216
  s_mov_b32 m0, 28672
  s_nop 0
  buffer_load_dwordx4 v11, s[64:67], s14 offen lds
  s_mov_b32 m0, 29696
  s_nop 0
  buffer_load_dwordx4 v148, s[56:59], s14 offen lds
  s_add_u32 s14, s15, 384
  s_mov_b32 m0, 30720
  s_nop 0
  buffer_load_dwordx4 v11, s[64:67], s14 offen lds
  buffer_load_dwordx4 v12, s[64:67], s14 offen offset:2048 lds
  s_mov_b32 m0, 31744
  s_nop 0
  buffer_load_dwordx4 v148, s[56:59], s14 offen lds
  buffer_load_dwordx4 v149, s[56:59], s14 offen offset:2048 lds
  s_add_u32 s14, s15, 20864
  s_mov_b32 m0, 34816
  s_nop 0
  buffer_load_dwordx4 v11, s[64:67], s14 offen lds
  buffer_load_dwordx4 v12, s[64:67], s14 offen offset:2048 lds
  s_mov_b32 m0, 35840
  s_nop 0
  buffer_load_dwordx4 v148, s[56:59], s14 offen lds
  buffer_load_dwordx4 v149, s[56:59], s14 offen offset:2048 lds
  s_add_u32 s14, s15, 41344
  s_mov_b32 m0, 38912
  s_nop 0
  buffer_load_dwordx4 v11, s[64:67], s14 offen lds
  s_mov_b32 m0, 39936
  s_nop 0
  buffer_load_dwordx4 v148, s[56:59], s14 offen lds
  s_waitcnt vmcnt(30)
  v_xor_b32 v15, s8, v184
  v_cmp_lt_u32 vcc, 15, v15
  s_cbranch_vccnz again_15
ok_16:
  s_or_b32 s13, s8, s11
  v_cmp_ne_u32 vcc, s13, v184
  s_cmp_eq_u64 vcc, 0
  s_cselect_b32 s9, 1, 0
  s_cmp_eq_u32 s7, 2
  s_cselect_b32 s40, 0, s9
  s_waitcnt vmcnt(20)
  v_dot2_f32_bf16 v88, v48, s2, 0
  v_dot2_f32_bf16 v89, v49, s2, 0
  v_dot2_f32_bf16 v88, v50, s2, v88
  v_dot2_f32_bf16 v89, v51, s2, v89
  v_dot2_f32_bf16 v88, v52, s2, v88
  v_dot2_f32_bf16 v89, v53, s2, v89
  v_dot2_f32_bf16 v88, v54, s2, v88
  v_dot2_f32_bf16 v89, v55, s2, v89
  v_dot2_f32_bf16 v88, v56, s2, v88
  v_dot2_f32_bf16 v89, v57, s2, v89
  v_dot2_f32_bf16 v88, v58, s2, v88
  v_dot2_f32_bf16 v89, v59, s2, v89
  v_dot2_f32_bf16 v88, v60, s2, v88
  v_dot2_f32_bf16 v89, v61, s2, v89
  v_dot2_f32_bf16 v88, v62, s2, v88
  v_dot2_f32_bf16 v89, v63, s2, v89
  v_dot2_f32_bf16 v88, v64, s2, v88
  v_dot2_f32_bf16 v89, v65, s2, v89
  v_dot2_f32_bf16 v88, v66, s2, v88
  v_dot2_f32_bf16 v89, v67, s2, v89
  v_dot2_f32_bf16 v88, v68, s2, v88
  v_dot2_f32_bf16 v89, v69, s2, v89
  v_dot2_f32_bf16 v88, v70, s2, v88
  v_dot2_f32_bf16 v89, v71, s2, v89
  v_dot2_f32_bf16 v88, v72, s2, v88
  v_dot2_f32_bf16 v89, v73, s2, v89
  v_dot2_f32_bf16 v88, v74, s2, v88
  v_dot2_f32_bf16 v89, v75, s2, v89
  v_dot2_f32_bf16 v88, v76, s2, v88
  v_dot2_f32_bf16 v89, v77, s2, v89
  v_dot2_f32_bf16 v88, v78, s2, v88
  v_dot2_f32_bf16 v89, v79, s2, v89
  v_dot2_f32_bf16 v88, v80, s2, v88
  v_dot2_f32_bf16 v89, v81, s2, v89
  v_dot2_f32_bf16 v88, v82, s2, v88
  v_dot2_f32_bf16 v89, v83, s2, v89
  v_dot2_f32_bf16 v88, v84, s2, v88
  v_dot2_f32_bf16 v89, v85, s2, v89
  v_dot2_f32_bf16 v88, v86, s2, v88
  v_dot2_f32_bf16 v89, v87, s2, v89
  s_nop 2
  v_add_f32 v88, v88, v89
  s_nop 1
  v_add_f32_dpp v88, v88, v88 quad_perm:[1,0,3,2] row_mask:0xf bank_mask:0xf
  s_nop 1
  v_add_f32_dpp v88, v88, v88 quad_perm:[2,3,0,1] row_mask:0xf bank_mask:0xf
  s_nop 1
  v_add_f32_dpp v88, v88, v88 row_half_mirror row_mask:0xf bank_mask:0xf
  v_mov_b32 v89, s8
  v_lshlrev_b32 v11, 1, v1
  s_lshl_b32 s12, s4, 3
  s_and_b32 s13, s3, 7
  s_add_u32 s12, s12, s13
  s_mul_i32 s12, s12, 80
  s_and_b32 s13, s3, 8
  s_add_u32 s12, s12, s13
  s_add_u32 s12, s12, 303104
  s_mov_b32 exec_lo, 0x01010101
  s_mov_b32 exec_hi, 1
  buffer_store_dwordx2 v[88:89], v11, s[52:55], s12 offen sc1
  s_mov_b64 exec, -1
join_12:
  s_waitcnt lgkmcnt(0)
  v_mul_f32_e64 v21, v151, v21
  v_mul_f32_dpp v27, v26, v151 quad_perm:[1,0,3,2] row_mask:0xf bank_mask:0xf
  v_mul_f32_e64 v22, v151, v22
  v_mul_f32_dpp v29, v28, v151 quad_perm:[1,0,3,2] row_mask:0xf bank_mask:0xf
  v_mul_f32_e64 v23, v151, v23
  v_mul_f32_dpp v31, v30, v151 quad_perm:[1,0,3,2] row_mask:0xf bank_mask:0xf
  v_mul_f32_e64 v24, v151, v24
  v_mul_f32_dpp v33, v32, v151 quad_perm:[1,0,3,2] row_mask:0xf bank_mask:0xf
  v_mul_f32_e64 v25, v151, v25
  v_mul_f32_dpp v35, v34, v151 quad_perm:[1,0,3,2] row_mask:0xf bank_mask:0xf
  s_waitcnt vmcnt(7)
  s_barrier
  ds_read_b128 v[128:131], v144 offset:0
  ds_read_b128 v[132:135], v144 offset:8192
  ds_read_b128 v[88:91], v5 offset:0
  ds_read_b128 v[92:95], v5 offset:2048
  ds_read_b128 v[96:99], v5 offset:4096
  ds_read_b128 v[100:103], v5 offset:6144
  ds_read_b128 v[104:107], v5 offset:8192
  s_add_u32 m0, s77, 16384
  s_add_u32 s15, s76, 128
  buffer_load_dwordx4 v146, s[68:71], s15 offen lds
  buffer_load_dwordx4 v147, s[68:71], s15 offen offset:1024 lds
  s_add_u32 m0, s77, 24576
  s_add_u32 s15, s76, 5248
  buffer_load_dwordx4 v146, s[68:71], s15 offen lds
  buffer_load_dwordx4 v147, s[68:71], s15 offen offset:1024 lds
  s_waitcnt lgkmcnt(4)
  v_mfma_f32_16x16x32_bf16 v[48:51], v[128:131], v[88:91], 0
  ds_read_b128 v[136:139], v145 offset:0
  ds_read_b128 v[140:143], v145 offset:8192
  ds_read_b128 v[108:111], v6 offset:0
  ds_read_b128 v[192:195], v175 offset:0
  ds_read_b128 v[196:199], v175 offset:16
  v_mfma_f32_16x16x32_bf16 v[52:55], v[132:135], v[88:91], 0
  ds_read_b128 v[200:203], v175 offset:32
  ds_read_b128 v[204:207], v175 offset:48
  s_waitcnt lgkmcnt(10)
  v_mfma_f32_16x16x32_bf16 v[56:59], v[128:131], v[92:95], 0
  ds_read_b128 v[112:115], v6 offset:2048
  s_waitcnt vmcnt(9)
  s_waitcnt lgkmcnt(1)
  v_lshlrev_b32_e64 v152, 16, v176
  v_mfma_f32_16x16x32_bf16 v[60:63], v[132:135], v[92:95], 0
  v_and_b32 v153, 0xffff0000, v176
  v_lshlrev_b32_e64 v154, 16, v180
  v_mfma_f32_16x16x32_bf16 v[64:67], v[128:131], v[96:99], 0
  ds_read_b128 v[116:119], v6 offset:4096
  v_and_b32 v155, 0xffff0000, v180
  v_pk_mul_f32 v[156:157], v[152:153], v[192:193]
  v_mfma_f32_16x16x32_bf16 v[68:71], v[132:135], v[96:99], 0
  v_pk_mul_f32 v[158:159], v[152:153], v[194:195] neg_lo:[0,1] neg_hi:[0,1]
  v_pk_fma_f32 v[156:157], v[154:155], v[194:195], v[156:157] neg_lo:[0,1,0] neg_hi:[0,1,0]
  v_mfma_f32_16x16x32_bf16 v[72:75], v[128:131], v[100:103], 0
  ds_read_b128 v[120:123], v6 offset:6144
  v_pk_fma_f32 v[158:159], v[154:155], v[192:193], v[158:159] neg_lo:[0,1,0] neg_hi:[0,1,0]
  v_cvt_pk_bf16_f32 v176, v156, v157
  v_mfma_f32_16x16x32_bf16 v[76:79], v[132:135], v[100:103], 0
  s_add_u32 m0, s77, 32768
  s_add_u32 s15, s76, 256
  buffer_load_dwordx4 v146, s[68:71], s15 offen lds
  buffer_load_dwordx4 v147, s[68:71], s15 offen offset:1024 lds
  s_add_u32 m0, s77, 40960
  s_add_u32 s15, s76, 5376
  buffer_load_dwordx4 v146, s[68:71], s15 offen lds
  buffer_load_dwordx4 v147, s[68:71], s15 offen offset:1024 lds
  v_mfma_f32_16x16x32_bf16 v[80:83], v[128:131], v[104:107], 0
  ds_read_b128 v[124:127], v6 offset:8192
  s_add_u32 m0, s75, 40960
  s_add_u32 s14, s74, 512
  buffer_load_dwordx4 v148, s[56:59], s14 offen lds
  buffer_load_dwordx4 v149, s[56:59], s14 offen offset:2048 lds
  v_mfma_f32_16x16x32_bf16 v[84:87], v[132:135], v[104:107], 0
  s_add_u32 m0, s75, 45056
  s_add_u32 s14, s74, 20992
  buffer_load_dwordx4 v148, s[56:59], s14 offen lds
  buffer_load_dwordx4 v149, s[56:59], s14 offen offset:2048 lds
  s_waitcnt vmcnt(8)
  s_waitcnt lgkmcnt(2)
  v_mfma_f32_16x16x32_bf16 v[48:51], v[136:139], v[108:111], v[48:51]
  ds_read_b128 v[128:131], v144 offset:16384
  ds_read_b128 v[132:135], v144 offset:24576
  ds_read_b128 v[88:91], v5 offset:10240
  v_cvt_pk_bf16_f32 v180, v158, v159
  v_lshlrev_b32_e64 v152, 16, v177
  v_mfma_f32_16x16x32_bf16 v[52:55], v[140:143], v[108:111], v[52:55]
  v_and_b32 v153, 0xffff0000, v177
  v_lshlrev_b32_e64 v154, 16, v181
  v_mfma_f32_16x16x32_bf16 v[56:59], v[136:139], v[112:115], v[56:59]
  ds_read_b128 v[92:95], v5 offset:12288
  v_and_b32 v155, 0xffff0000, v181
  v_pk_mul_f32 v[156:157], v[152:153], v[196:197]
  v_mfma_f32_16x16x32_bf16 v[60:63], v[140:143], v[112:115], v[60:63]
  v_pk_mul_f32 v[158:159], v[152:153], v[198:199] neg_lo:[0,1] neg_hi:[0,1]
  v_pk_fma_f32 v[156:157], v[154:155], v[198:199], v[156:157] neg_lo:[0,1,0] neg_hi:[0,1,0]
  v_mfma_f32_16x16x32_bf16 v[64:67], v[136:139], v[116:119], v[64:67]
  ds_read_b128 v[96:99], v5 offset:14336
  v_pk_fma_f32 v[158:159], v[154:155], v[196:197], v[158:159] neg_lo:[0,1,0] neg_hi:[0,1,0]
  v_cvt_pk_bf16_f32 v177, v156, v157
  v_mfma_f32_16x16x32_bf16 v[68:71], v[140:143], v[116:119], v[68:71]
  v_cvt_pk_bf16_f32 v181, v158, v159
  v_lshlrev_b32 v152, 16, v178
  s_waitcnt lgkmcnt(5)
  v_mfma_f32_16x16x32_bf16 v[72:75], v[136:139], v[120:123], v[72:75]
  ds_read_b128 v[100:103], v5 offset:16384
  v_and_b32 v153, 0xffff0000, v178
  v_lshlrev_b32_e64 v154, 16, v182
  v_mfma_f32_16x16x32_bf16 v[76:79], v[140:143], v[120:123], v[76:79]
  s_add_u32 m0, s77, 49152
  s_add_u32 s15, s76, 384
  buffer_load_dwordx4 v146, s[68:71], s15 offen lds
  buffer_load_dwordx4 v147, s[68:71], s15 offen offset:1024 lds
  s_add_u32 m0, s77, 0
  s_add_u32 s15, s76, 5504
  buffer_load_dwordx4 v146, s[68:71], s15 offen lds
  buffer_load_dwordx4 v147, s[68:71], s15 offen offset:1024 lds
  v_mfma_f32_16x16x32_bf16 v[80:83], v[136:139], v[124:127], v[80:83]
  ds_read_b128 v[104:107], v5 offset:18432
  s_add_u32 m0, s75, 49152
  s_add_u32 s14, s74, 41472
  buffer_load_dwordx4 v148, s[56:59], s14 offen lds
  s_add_u32 m0, s75, 61440
  s_add_u32 s14, s74, 768
  buffer_load_dwordx4 v148, s[56:59], s14 offen lds
  buffer_load_dwordx4 v149, s[56:59], s14 offen offset:2048 lds
  v_mfma_f32_16x16x32_bf16 v[84:87], v[140:143], v[124:127], v[84:87]
  s_add_u32 m0, s75, 65536
  s_add_u32 s14, s74, 21248
  buffer_load_dwordx4 v148, s[56:59], s14 offen lds
  buffer_load_dwordx4 v149, s[56:59], s14 offen offset:2048 lds
  s_waitcnt lgkmcnt(2)
  v_mfma_f32_16x16x32_bf16 v[48:51], v[128:131], v[88:91], v[48:51]
  ds_read_b128 v[136:139], v145 offset:16384
  ds_read_b128 v[140:143], v145 offset:24576
  ds_read_b128 v[108:111], v6 offset:10240
  v_and_b32 v155, 0xffff0000, v182
  v_pk_mul_f32 v[156:157], v[152:153], v[200:201]
  v_mfma_f32_16x16x32_bf16 v[52:55], v[132:135], v[88:91], v[52:55]
  v_pk_mul_f32 v[158:159], v[152:153], v[202:203] neg_lo:[0,1] neg_hi:[0,1]
  v_pk_fma_f32 v[156:157], v[154:155], v[202:203], v[156:157] neg_lo:[0,1,0] neg_hi:[0,1,0]
  v_mfma_f32_16x16x32_bf16 v[56:59], v[128:131], v[92:95], v[56:59]
  ds_read_b128 v[112:115], v6 offset:12288
  v_pk_fma_f32 v[158:159], v[154:155], v[200:201], v[158:159] neg_lo:[0,1,0] neg_hi:[0,1,0]
  v_cvt_pk_bf16_f32 v178, v156, v157
  v_mfma_f32_16x16x32_bf16 v[60:63], v[132:135], v[92:95], v[60:63]
  v_cvt_pk_bf16_f32 v182, v158, v159
  v_lshlrev_b32_e64 v152, 16, v179
  v_mfma_f32_16x16x32_bf16 v[64:67], v[128:131], v[96:99], v[64:67]
  ds_read_b128 v[116:119], v6 offset:14336
  v_and_b32 v153, 0xffff0000, v179
  v_lshlrev_b32_e64 v154, 16, v183
  v_mfma_f32_16x16x32_bf16 v[68:71], v[132:135], v[96:99], v[68:71]
  v_and_b32 v155, 0xffff0000, v183
  v_pk_mul_f32 v[156:157], v[152:153], v[204:205]
  s_waitcnt lgkmcnt(5)
  v_mfma_f32_16x16x32_bf16 v[72:75], v[128:131], v[100:103], v[72:75]
  ds_read_b128 v[120:123], v6 offset:16384
  v_pk_mul_f32 v[158:159], v[152:153], v[206:207] neg_lo:[0,1] neg_hi:[0,1]
  v_mfma_f32_16x16x32_bf16 v[76:79], v[132:135], v[100:103], v[76:79]
  v_pk_fma_f32 v[156:157], v[154:155], v[206:207], v[156:157] neg_lo:[0,1,0] neg_hi:[0,1,0]
  v_mfma_f32_16x16x32_bf16 v[80:83], v[128:131], v[104:107], v[80:83]
  ds_read_b128 v[124:127], v6 offset:18432
  s_add_u32 m0, s77, 8192
  s_add_u32 s15, s76, 512
  buffer_load_dwordx4 v146, s[68:71], s15 offen lds
  buffer_load_dwordx4 v147, s[68:71], s15 offen offset:1024 lds
  v_mfma_f32_16x16x32_bf16 v[84:87], v[132:135], v[104:107], v[84:87]
  s_add_u32 m0, s75, 69632
  s_add_u32 s14, s74, 41728
  buffer_load_dwordx4 v148, s[56:59], s14 offen lds
  s_waitcnt vmcnt(16)
  s_barrier
  s_waitcnt lgkmcnt(2)
  v_mfma_f32_16x16x32_bf16 v[48:51], v[136:139], v[108:111], v[48:51]
  ds_read_b128 v[128:131], v144 offset:32768
  ds_read_b128 v[132:135], v144 offset:40960
  ds_read_b128 v[88:91], v5 offset:20480
  v_pk_fma_f32 v[158:159], v[154:155], v[204:205], v[158:159] neg_lo:[0,1,0] neg_hi:[0,1,0]
  v_mfma_f32_16x16x32_bf16 v[52:55], v[140:143], v[108:111], v[52:55]
  v_cvt_pk_bf16_f32 v179, v156, v157
  v_mfma_f32_16x16x32_bf16 v[56:59], v[136:139], v[112:115], v[56:59]
  ds_read_b128 v[92:95], v5 offset:22528
  v_cvt_pk_bf16_f32 v183, v158, v159
  v_mfma_f32_16x16x32_bf16 v[60:63], v[140:143], v[112:115], v[60:63]
  s_mul_i32 s12, s0, 204800
  s_add_u32 s12, s12, 23068672
  s_add_u32 s13, s12, 5120
  buffer_store_dwordx4 v[176:179], v174, s[52:55], s12 offen sc1
  buffer_store_dwordx4 v[180:183], v174, s[52:55], s13 offen sc1
  v_mfma_f32_16x16x32_bf16 v[64:67], v[136:139], v[116:119], v[64:67]
  ds_read_b128 v[96:99], v5 offset:24576
  s_add_u32 m0, s77, 16384
  s_add_u32 s15, s76, 5632
  buffer_load_dwordx4 v146, s[68:71], s15 offen lds
  buffer_load_dwordx4 v147, s[68:71], s15 offen offset:1024 lds
  v_mfma_f32_16x16x32_bf16 v[68:71], v[140:143], v[116:119], v[68:71]
  s_add_u32 m0, s75, 81920
  s_add_u32 s14, s74, 1024
  buffer_load_dwordx4 v148, s[56:59], s14 offen lds
  buffer_load_dwordx4 v149, s[56:59], s14 offen offset:2048 lds
  s_waitcnt lgkmcnt(5)
  v_mfma_f32_16x16x32_bf16 v[72:75], v[136:139], v[120:123], v[72:75]
  ds_read_b128 v[100:103], v5 offset:26624
  s_add_u32 m0, s75, 86016
  s_add_u32 s14, s74, 21504
  buffer_load_dwordx4 v148, s[56:59], s14 offen lds
  buffer_load_dwordx4 v149, s[56:59], s14 offen offset:2048 lds
  v_mfma_f32_16x16x32_bf16 v[76:79], v[140:143], v[120:123], v[76:79]
  v_mfma_f32_16x16x32_bf16 v[80:83], v[136:139], v[124:127], v[80:83]
  ds_read_b128 v[104:107], v5 offset:28672
  v_mfma_f32_16x16x32_bf16 v[84:87], v[140:143], v[124:127], v[84:87]
  s_waitcnt lgkmcnt(2)
  v_mfma_f32_16x16x32_bf16 v[48:51], v[128:131], v[88:91], v[48:51]
  ds_read_b128 v[136:139], v145 offset:32768
  ds_read_b128 v[140:143], v145 offset:40960
  ds_read_b128 v[108:111], v6 offset:20480
  s_add_u32 m0, s77, 24576
  s_add_u32 s15, s76, 640
  buffer_load_dwordx4 v146, s[68:71], s15 offen lds
  buffer_load_dwordx4 v147, s[68:71], s15 offen offset:1024 lds
  v_mfma_f32_16x16x32_bf16 v[52:55], v[132:135], v[88:91], v[52:55]
  s_add_u32 m0, s75, 90112
  s_add_u32 s14, s74, 41984
  buffer_load_dwordx4 v148, s[56:59], s14 offen lds
  v_mfma_f32_16x16x32_bf16 v[56:59], v[128:131], v[92:95], v[56:59]
  ds_read_b128 v[112:115], v6 offset:22528
  v_mfma_f32_16x16x32_bf16 v[60:63], v[132:135], v[92:95], v[60:63]
  v_mfma_f32_16x16x32_bf16 v[64:67], v[128:131], v[96:99], v[64:67]
  ds_read_b128 v[116:119], v6 offset:24576
  v_mfma_f32_16x16x32_bf16 v[68:71], v[132:135], v[96:99], v[68:71]
  s_waitcnt lgkmcnt(5)
  v_mfma_f32_16x16x32_bf16 v[72:75], v[128:131], v[100:103], v[72:75]
  ds_read_b128 v[120:123], v6 offset:26624
  v_mfma_f32_16x16x32_bf16 v[76:79], v[132:135], v[100:103], v[76:79]
  v_mfma_f32_16x16x32_bf16 v[80:83], v[128:131], v[104:107], v[80:83]
  ds_read_b128 v[124:127], v6 offset:28672
  v_mfma_f32_16x16x32_bf16 v[84:87], v[132:135], v[104:107], v[84:87]
  s_waitcnt vmcnt(19)
  s_waitcnt lgkmcnt(2)
  v_mfma_f32_16x16x32_bf16 v[48:51], v[136:139], v[108:111], v[48:51]
  ds_read_b128 v[128:131], v144 offset:49152
  ds_read_b128 v[132:135], v144 offset:0
  ds_read_b128 v[88:91], v5 offset:30720
  s_add_u32 m0, s77, 32768
  s_add_u32 s15, s76, 5760
  buffer_load_dwordx4 v146, s[68:71], s15 offen lds
  buffer_load_dwordx4 v147, s[68:71], s15 offen offset:1024 lds
  v_mfma_f32_16x16x32_bf16 v[52:55], v[140:143], v[108:111], v[52:55]
  v_mov_b32 v15, s8
  s_mov_b64 exec, 1
  s_cmp_eq_u32 s40, 0
  s_cbranch_scc1 slow_17
  buffer_store_dword v15, off, s[52:55], s41
back_18:
  s_mov_b64 exec, -1
  v_mfma_f32_16x16x32_bf16 v[56:59], v[136:139], v[112:115], v[56:59]
  ds_read_b128 v[92:95], v5 offset:32768
  v_mfma_f32_16x16x32_bf16 v[60:63], v[140:143], v[112:115], v[60:63]
  v_mfma_f32_16x16x32_bf16 v[64:67], v[136:139], v[116:119], v[64:67]
  ds_read_b128 v[96:99], v5 offset:34816
  v_mfma_f32_16x16x32_bf16 v[68:71], v[140:143], v[116:119], v[68:71]
  s_waitcnt lgkmcnt(5)
  v_mfma_f32_16x16x32_bf16 v[72:75], v[136:139], v[120:123], v[72:75]
  ds_read_b128 v[100:103], v5 offset:36864
  v_mfma_f32_16x16x32_bf16 v[76:79], v[140:143], v[120:123], v[76:79]
  v_mfma_f32_16x16x32_bf16 v[80:83], v[136:139], v[124:127], v[80:83]
  ds_read_b128 v[104:107], v5 offset:38912
  v_mfma_f32_16x16x32_bf16 v[84:87], v[140:143], v[124:127], v[84:87]
  s_waitcnt lgkmcnt(2)
  v_mfma_f32_16x16x32_bf16 v[48:51], v[128:131], v[88:91], v[48:51]
  ds_read_b128 v[136:139], v145 offset:49152
  ds_read_b128 v[140:143], v145 offset:0
  ds_read_b128 v[108:111], v6 offset:30720
  s_add_u32 m0, s77, 40960
  s_add_u32 s15, s76, 768
  buffer_load_dwordx4 v146, s[68:71], s15 offen lds
  buffer_load_dwordx4 v147, s[68:71], s15 offen offset:1024 lds
  v_mfma_f32_16x16x32_bf16 v[52:55], v[132:135], v[88:91], v[52:55]
  v_mfma_f32_16x16x32_bf16 v[56:59], v[128:131], v[92:95], v[56:59]
  ds_read_b128 v[112:115], v6 offset:32768
  v_mfma_f32_16x16x32_bf16 v[60:63], v[132:135], v[92:95], v[60:63]
  v_mfma_f32_16x16x32_bf16 v[64:67], v[128:131], v[96:99], v[64:67]
  ds_read_b128 v[116:119], v6 offset:34816
  v_mfma_f32_16x16x32_bf16 v[68:71], v[132:135], v[96:99], v[68:71]
  s_waitcnt lgkmcnt(5)
  v_mfma_f32_16x16x32_bf16 v[72:75], v[128:131], v[100:103], v[72:75]
  ds_read_b128 v[120:123], v6 offset:36864
  v_mfma_f32_16x16x32_bf16 v[76:79], v[132:135], v[100:103], v[76:79]
  v_mfma_f32_16x16x32_bf16 v[80:83], v[128:131], v[104:107], v[80:83]
  ds_read_b128 v[124:127], v6 offset:38912
  v_mfma_f32_16x16x32_bf16 v[84:87], v[132:135], v[104:107], v[84:87]
  s_waitcnt vmcnt(12)
  s_barrier
  s_waitcnt lgkmcnt(2)
  v_mfma_f32_16x16x32_bf16 v[48:51], v[136:139], v[108:111], v[48:51]
  ds_read_b128 v[128:131], v144 offset:8192
  ds_read_b128 v[132:135], v144 offset:16384
  ds_read_b128 v[88:91], v5 offset:40960
  s_add_u32 m0, s77, 49152
  s_add_u32 s15, s76, 5888
  buffer_load_dwordx4 v146, s[68:71], s15 offen lds
  buffer_load_dwordx4 v147, s[68:71], s15 offen offset:1024 lds
  v_mfma_f32_16x16x32_bf16 v[52:55], v[140:143], v[108:111], v[52:55]
  s_add_u32 s12, s85, 66048
  v_mov_b32 v15, s8
  s_mov_b64 exec, 1
  buffer_store_dword v15, off, s[52:55], s12 sc1
  s_mov_b64 exec, -1
  v_mfma_f32_16x16x32_bf16 v[56:59], v[136:139], v[112:115], v[56:59]
  ds_read_b128 v[92:95], v5 offset:43008
  v_mfma_f32_16x16x32_bf16 v[60:63], v[140:143], v[112:115], v[60:63]
  v_mfma_f32_16x16x32_bf16 v[64:67], v[136:139], v[116:119], v[64:67]
  ds_read_b128 v[96:99], v5 offset:45056
  v_mfma_f32_16x16x32_bf16 v[68:71], v[140:143], v[116:119], v[68:71]
  s_waitcnt lgkmcnt(5)
  v_mfma_f32_16x16x32_bf16 v[72:75], v[136:139], v[120:123], v[72:75]
  ds_read_b128 v[100:103], v5 offset:47104
  v_mfma_f32_16x16x32_bf16 v[76:79], v[140:143], v[120:123], v[76:79]
  v_mfma_f32_16x16x32_bf16 v[80:83], v[136:139], v[124:127], v[80:83]
  ds_read_b128 v[104:107], v5 offset:49152
  v_mfma_f32_16x16x32_bf16 v[84:87], v[140:143], v[124:127], v[84:87]
  s_waitcnt lgkmcnt(2)
  v_mfma_f32_16x16x32_bf16 v[48:51], v[128:131], v[88:91], v[48:51]
  ds_read_b128 v[136:139], v145 offset:8192
  ds_read_b128 v[140:143], v145 offset:16384
  ds_read_b128 v[108:111], v6 offset:40960
  s_add_u32 m0, s77, 0
  s_add_u32 s15, s76, 896
  buffer_load_dwordx4 v146, s[68:71], s15 offen lds
  buffer_load_dwordx4 v147, s[68:71], s15 offen offset:1024 lds
  v_mfma_f32_16x16x32_bf16 v[52:55], v[132:135], v[88:91], v[52:55]
  v_lshrrev_b32_e64 v11, 5, v1
  v_mfma_f32_16x16x32_bf16 v[56:59], v[128:131], v[92:95], v[56:59]
  ds_read_b128 v[112:115], v6 offset:43008
  v_mul_u32_u24 v11, 4096, v11
  v_mfma_f32_16x16x32_bf16 v[60:63], v[132:135], v[92:95], v[60:63]
  v_add_u32_e64 v11, v11, v2
  v_mfma_f32_16x16x32_bf16 v[64:67], v[128:131], v[96:99], v[64:67]
  ds_read_b128 v[116:119], v6 offset:45056
  v_mov_b32_e64 v216, 0
  v_mfma_f32_16x16x32_bf16 v[68:71], v[132:135], v[96:99], v[68:71]
  v_mov_b32 v217, 0
  s_waitcnt lgkmcnt(5)
  v_mfma_f32_16x16x32_bf16 v[72:75], v[128:131], v[100:103], v[72:75]
  ds_read_b128 v[120:123], v6 offset:47104
  v_mov_b32_e64 v218, 0
  v_mfma_f32_16x16x32_bf16 v[76:79], v[132:135], v[100:103], v[76:79]
  v_mov_b32_e64 v219, 0
  v_mfma_f32_16x16x32_bf16 v[80:83], v[128:131], v[104:107], v[80:83]
  ds_read_b128 v[124:127], v6 offset:49152
  ds_write_b128 v11, v[216:219] offset:4096
  v_mfma_f32_16x16x32_bf16 v[84:87], v[132:135], v[104:107], v[84:87]
  ds_write_b128 v11, v[216:219] offset:8704
  s_waitcnt vmcnt(8)
  s_waitcnt lgkmcnt(4)
  v_mfma_f32_16x16x32_bf16 v[48:51], v[136:139], v[108:111], v[48:51]
  ds_read_b128 v[128:131], v144 offset:24576
  ds_read_b128 v[132:135], v144 offset:32768
  ds_read_b128 v[88:91], v7 offset:0
  s_add_u32 m0, s77, 8192
  s_add_u32 s15, s76, 6016
  buffer_load_dwordx4 v146, s[68:71], s15 offen lds
  buffer_load_dwordx4 v147, s[68:71], s15 offen offset:1024 lds
  v_mfma_f32_16x16x32_bf16 v[52:55], v[140:143], v[108:111], v[52:55]
  v_mfma_f32_16x16x32_bf16 v[56:59], v[136:139], v[112:115], v[56:59]
  ds_read_b128 v[92:95], v7 offset:2048
  v_mfma_f32_16x16x32_bf16 v[60:63], v[140:143], v[112:115], v[60:63]
  v_mfma_f32_16x16x32_bf16 v[64:67], v[136:139], v[116:119], v[64:67]
  ds_read_b128 v[96:99], v7 offset:4096
  v_mfma_f32_16x16x32_bf16 v[68:71], v[140:143], v[116:119], v[68:71]
  s_waitcnt lgkmcnt(7)
  v_mfma_f32_16x16x32_bf16 v[72:75], v[136:139], v[120:123], v[72:75]
  ds_read_b128 v[100:103], v7 offset:6144
  v_mfma_f32_16x16x32_bf16 v[76:79], v[140:143], v[120:123], v[76:79]
  v_mfma_f32_16x16x32_bf16 v[80:83], v[136:139], v[124:127], v[80:83]
  ds_read_b128 v[104:107], v7 offset:8192
  v_mfma_f32_16x16x32_bf16 v[84:87], v[140:143], v[124:127], v[84:87]
  s_waitcnt lgkmcnt(2)
  v_mfma_f32_16x16x32_bf16 v[48:51], v[128:131], v[88:91], v[48:51]
  ds_read_b128 v[136:139], v145 offset:24576
  ds_read_b128 v[140:143], v145 offset:32768
  ds_read_b128 v[108:111], v8 offset:0
  s_add_u32 m0, s77, 16384
  s_add_u32 s15, s76, 1024
  buffer_load_dwordx4 v146, s[68:71], s15 offen lds
  buffer_load_dwordx4 v147, s[68:71], s15 offen offset:1024 lds
  v_mfma_f32_16x16x32_bf16 v[52:55], v[132:135], v[88:91], v[52:55]
  s_and_b32 s87, s85, 0x3800
  s_add_u32 s87, s87, 65536
  buffer_load_dwordx2 v[188:189], v187, s[52:55], s87 offen sc1
  v_mfma_f32_16x16x32_bf16 v[56:59], v[128:131], v[92:95], v[56:59]
  ds_read_b128 v[112:115], v8 offset:2048
  v_mfma_f32_16x16x32_bf16 v[60:63], v[132:135], v[92:95], v[60:63]
  v_mfma_f32_16x16x32_bf16 v[64:67], v[128:131], v[96:99], v[64:67]
  ds_read_b128 v[116:119], v8 offset:4096
  v_mfma_f32_16x16x32_bf16 v[68:71], v[132:135], v[96:99], v[68:71]
  s_waitcnt lgkmcnt(5)
  v_mfma_f32_16x16x32_bf16 v[72:75], v[128:131], v[100:103], v[72:75]
  ds_read_b128 v[120:123], v8 offset:6144
  v_mfma_f32_16x16x32_bf16 v[76:79], v[132:135], v[100:103], v[76:79]
  v_mfma_f32_16x16x32_bf16 v[80:83], v[128:131], v[104:107], v[80:83]
  ds_read_b128 v[124:127], v8 offset:8192
  v_mfma_f32_16x16x32_bf16 v[84:87], v[132:135], v[104:107], v[84:87]
  s_waitcnt vmcnt(8)
  s_barrier
  s_waitcnt lgkmcnt(2)
  v_mfma_f32_16x16x32_bf16 v[48:51], v[136:139], v[108:111], v[48:51]
  ds_read_b128 v[128:131], v144 offset:40960
  ds_read_b128 v[132:135], v144 offset:49152
  ds_read_b128 v[88:91], v7 offset:10240
  s_add_u32 m0, s77, 24576
  s_add_u32 s15, s76, 6144
  buffer_load_dwordx4 v146, s[68:71], s15 offen lds
  buffer_load_dwordx4 v147, s[68:71], s15 offen offset:1024 lds
  v_mfma_f32_16x16x32_bf16 v[52:55], v[140:143], v[108:111], v[52:55]
  v_mfma_f32_16x16x32_bf16 v[56:59], v[136:139], v[112:115], v[56:59]
  ds_read_b128 v[92:95], v7 offset:12288
  v_mfma_f32_16x16x32_bf16 v[60:63], v[140:143], v[112:115], v[60:63]
  v_mfma_f32_16x16x32_bf16 v[64:67], v[136:139], v[116:119], v[64:67]
  ds_read_b128 v[96:99], v7 offset:14336
  v_mfma_f32_16x16x32_bf16 v[68:71], v[140:143], v[116:119], v[68:71]
  s_waitcnt lgkmcnt(5)
  v_mfma_f32_16x16x32_bf16 v[72:75], v[136:139], v[120:123], v[72:75]
  ds_read_b128 v[100:103], v7 offset:16384
  v_mfma_f32_16x16x32_bf16 v[76:79], v[140:143], v[120:123], v[76:79]
  v_mfma_f32_16x16x32_bf16 v[80:83], v[136:139], v[124:127], v[80:83]
  ds_read_b128 v[104:107], v7 offset:18432
  v_mfma_f32_16x16x32_bf16 v[84:87], v[140:143], v[124:127], v[84:87]
  s_waitcnt lgkmcnt(2)
  v_mfma_f32_16x16x32_bf16 v[48:51], v[128:131], v[88:91], v[48:51]
  ds_read_b128 v[136:139], v145 offset:40960
  ds_read_b128 v[140:143], v145 offset:49152
  ds_read_b128 v[108:111], v8 offset:10240
  s_add_u32 m0, s77, 32768
  s_add_u32 s15, s76, 1152
  buffer_load_dwordx4 v146, s[68:71], s15 offen lds
  buffer_load_dwordx4 v147, s[68:71], s15 offen offset:1024 lds
  v_mfma_f32_16x16x32_bf16 v[52:55], v[132:135], v[88:91], v[52:55]
  s_waitcnt vmcnt(4)
  v_xor_b32 v15, s8, v188
  v_xor_b32 v14, s8, v189
  v_or_b32 v15, v15, v14
  v_cmp_ne_u32 vcc, 0, v15
  s_cbranch_vccnz again_19
ok_20:
  s_lshl_b32 s12, s0, 16
  s_add_u32 s12, s12, s90
  s_add_u32 s12, s12, 4194304
  s_lshl_b32 m0, s7, 10
  s_nop 0
  buffer_load_dwordx4 v2, s[52:55], s12 offen sc1 lds
  s_lshl_b32 s12, s0, 16
  s_add_u32 s12, s12, s91
  s_add_u32 s12, s12, 4194304
  s_lshl_b32 m0, s7, 10
  s_add_u32 m0, m0, 4608
  s_nop 0
  buffer_load_dwordx4 v2, s[52:55], s12 offen sc1 lds
  v_mfma_f32_16x16x32_bf16 v[56:59], v[128:131], v[92:95], v[56:59]
  ds_read_b128 v[112:115], v8 offset:12288
  v_mfma_f32_16x16x32_bf16 v[60:63], v[132:135], v[92:95], v[60:63]
  v_mfma_f32_16x16x32_bf16 v[64:67], v[128:131], v[96:99], v[64:67]
  ds_read_b128 v[116:119], v8 offset:14336
  v_mfma_f32_16x16x32_bf16 v[68:71], v[132:135], v[96:99], v[68:71]
  s_waitcnt lgkmcnt(5)
  v_mfma_f32_16x16x32_bf16 v[72:75], v[128:131], v[100:103], v[72:75]
  ds_read_b128 v[120:123], v8 offset:16384
  v_mfma_f32_16x16x32_bf16 v[76:79], v[132:135], v[100:103], v[76:79]
  v_mfma_f32_16x16x32_bf16 v[80:83], v[128:131], v[104:107], v[80:83]
  ds_read_b128 v[124:127], v8 offset:18432
  v_mfma_f32_16x16x32_bf16 v[84:87], v[132:135], v[104:107], v[84:87]
  s_waitcnt lgkmcnt(2)
  v_mfma_f32_16x16x32_bf16 v[48:51], v[136:139], v[108:111], v[48:51]
  ds_read_b128 v[128:131], v144 offset:0
  ds_read_b128 v[132:135], v144 offset:8192
  ds_read_b128 v[88:91], v7 offset:20480
  s_add_u32 m0, s77, 40960
  s_add_u32 s15, s76, 6272
  buffer_load_dwordx4 v146, s[68:71], s15 offen lds
  buffer_load_dwordx4 v147, s[68:71], s15 offen offset:1024 lds
  v_mfma_f32_16x16x32_bf16 v[52:55], v[140:143], v[108:111], v[52:55]
  buffer_load_dwordx3 v[152:154], v160, s[52:55], s93 offen sc1
  v_mfma_f32_16x16x32_bf16 v[56:59], v[136:139], v[112:115], v[56:59]
  ds_read_b128 v[92:95], v7 offset:22528
  buffer_load_dwordx2 v[156:157], v161, s[52:55], s94 offen sc1
  v_mfma_f32_16x16x32_bf16 v[60:63], v[140:143], v[112:115], v[60:63]
  buffer_load_dwordx2 v[158:159], v162, s[52:55], s94 offen offset:512 sc1
  v_mfma_f32_16x16x32_bf16 v[64:67], v[136:139], v[116:119], v[64:67]
  ds_read_b128 v[96:99], v7 offset:24576
  s_mov_b32 s36, 32768
  buffer_load_dwordx4 v[220:223], v2, s[52:55], s36 offen sc1
  v_mfma_f32_16x16x32_bf16 v[68:71], v[140:143], v[116:119], v[68:71]
  s_waitcnt lgkmcnt(5)
  v_mfma_f32_16x16x32_bf16 v[72:75], v[136:139], v[120:123], v[72:75]
  ds_read_b128 v[100:103], v7 offset:26624
  v_mfma_f32_16x16x32_bf16 v[76:79], v[140:143], v[120:123], v[76:79]
  v_mfma_f32_16x16x32_bf16 v[80:83], v[136:139], v[124:127], v[80:83]
  ds_read_b128 v[104:107], v7 offset:28672
  v_mfma_f32_16x16x32_bf16 v[84:87], v[140:143], v[124:127], v[84:87]
  s_waitcnt lgkmcnt(2)
  v_mfma_f32_16x16x32_bf16 v[48:51], v[128:131], v[88:91], v[48:51]
  ds_read_b128 v[136:139], v145 offset:0
  ds_read_b128 v[140:143], v145 offset:8192
  ds_read_b128 v[108:111], v8 offset:20480
  s_mov_b32 s64, s42
  s_and_b32 s65, s43, 0xffff
  s_mov_b32 s66, 2621440
  s_mov_b32 s67, 0x20000
  v_mfma_f32_16x16x32_bf16 v[52:55], v[132:135], v[88:91], v[52:55]
  buffer_load_dwordx4 v[192:195], v2, s[64:67], s90 offen
  v_mfma_f32_16x16x32_bf16 v[56:59], v[128:131], v[92:95], v[56:59]
  ds_read_b128 v[112:115], v8 offset:22528
  buffer_load_dwordx4 v[204:207], v2, s[64:67], s90 offen offset:4
  v_mfma_f32_16x16x32_bf16 v[60:63], v[132:135], v[92:95], v[60:63]
  buffer_load_dwordx4 v[188:191], v187, s[52:55], s88 offen sc1
  v_mfma_f32_16x16x32_bf16 v[64:67], v[128:131], v[96:99], v[64:67]
  ds_read_b128 v[116:119], v8 offset:24576
  v_mfma_f32_16x16x32_bf16 v[68:71], v[132:135], v[96:99], v[68:71]
  s_waitcnt lgkmcnt(5)
  v_mfma_f32_16x16x32_bf16 v[72:75], v[128:131], v[100:103], v[72:75]
  ds_read_b128 v[120:123], v8 offset:26624
  v_mfma_f32_16x16x32_bf16 v[76:79], v[132:135], v[100:103], v[76:79]
  v_mfma_f32_16x16x32_bf16 v[80:83], v[128:131], v[104:107], v[80:83]
  ds_read_b128 v[124:127], v8 offset:28672
  v_mfma_f32_16x16x32_bf16 v[84:87], v[132:135], v[104:107], v[84:87]
  s_waitcnt vmcnt(13)
  s_barrier
  s_waitcnt lgkmcnt(2)
  v_mfma_f32_16x16x32_bf16 v[48:51], v[136:139], v[108:111], v[48:51]
  ds_read_b128 v[128:131], v144 offset:16384
  ds_read_b128 v[132:135], v144 offset:24576
  ds_read_b128 v[88:91], v7 offset:30720
  buffer_load_dwordx4 v[196:199], v2, s[64:67], s91 offen
  v_mfma_f32_16x16x32_bf16 v[52:55], v[140:143], v[108:111], v[52:55]
  buffer_load_dwordx4 v[208:211], v2, s[64:67], s91 offen offset:4
  v_mfma_f32_16x16x32_bf16 v[56:59], v[136:139], v[112:115], v[56:59]
  ds_read_b128 v[92:95], v7 offset:32768
  buffer_load_dwordx4 v[200:203], v2, s[64:67], s92 offen
  v_mfma_f32_16x16x32_bf16 v[60:63], v[140:143], v[112:115], v[60:63]
  v_mfma_f32_16x16x32_bf16 v[64:67], v[136:139], v[116:119], v[64:67]
  ds_read_b128 v[96:99], v7 offset:34816
  v_mfma_f32_16x16x32_bf16 v[68:71], v[140:143], v[116:119], v[68:71]
  s_waitcnt lgkmcnt(5)
  v_mfma_f32_16x16x32_bf16 v[72:75], v[136:139], v[120:123], v[72:75]
  ds_read_b128 v[100:103], v7 offset:36864
  v_mfma_f32_16x16x32_bf16 v[76:79], v[140:143], v[120:123], v[76:79]
  v_mfma_f32_16x16x32_bf16 v[80:83], v[136:139], v[124:127], v[80:83]
  ds_read_b128 v[104:107], v7 offset:38912
  v_mfma_f32_16x16x32_bf16 v[84:87], v[140:143], v[124:127], v[84:87]
  s_waitcnt lgkmcnt(2)
  v_mfma_f32_16x16x32_bf16 v[48:51], v[128:131], v[88:91], v[48:51]
  ds_read_b128 v[136:139], v145 offset:16384
  ds_read_b128 v[140:143], v145 offset:24576
  ds_read_b128 v[108:111], v8 offset:30720
  buffer_load_dwordx4 v[212:215], v2, s[64:67], s92 offen offset:4
  v_mfma_f32_16x16x32_bf16 v[52:55], v[132:135], v[88:91], v[52:55]
  v_mfma_f32_16x16x32_bf16 v[56:59], v[128:131], v[92:95], v[56:59]
  ds_read_b128 v[112:115], v8 offset:32768
  v_mfma_f32_16x16x32_bf16 v[60:63], v[132:135], v[92:95], v[60:63]
  v_mfma_f32_16x16x32_bf16 v[64:67], v[128:131], v[96:99], v[64:67]
  ds_read_b128 v[116:119], v8 offset:34816
  v_mfma_f32_16x16x32_bf16 v[68:71], v[132:135], v[96:99], v[68:71]
  s_waitcnt lgkmcnt(5)
  v_mfma_f32_16x16x32_bf16 v[72:75], v[128:131], v[100:103], v[72:75]
  ds_read_b128 v[120:123], v8 offset:36864
  v_mfma_f32_16x16x32_bf16 v[76:79], v[132:135], v[100:103], v[76:79]
  v_mfma_f32_16x16x32_bf16 v[80:83], v[128:131], v[104:107], v[80:83]
  ds_read_b128 v[124:127], v8 offset:38912
  v_mfma_f32_16x16x32_bf16 v[84:87], v[132:135], v[104:107], v[84:87]
  s_waitcnt vmcnt(11)
  s_waitcnt lgkmcnt(2)
  v_mfma_f32_16x16x32_bf16 v[48:51], v[136:139], v[108:111], v[48:51]
  ds_read_b128 v[128:131], v144 offset:32768
  ds_read_b128 v[132:135], v144 offset:40960
  ds_read_b128 v[88:91], v7 offset:40960
  s_waitcnt vmcnt(8)
  v_min3_u32 v15, v154, v154, s8
  v_max3_u32 v14, v154, v154, s8
  v_min3_u32 v15, v15, v157, v159
  v_max3_u32 v14, v14, v157, v159
  v_cmp_ne_u32 vcc, v15, v14
  s_cbranch_vccnz again_21
ok_22:
  v_mfma_f32_16x16x32_bf16 v[52:55], v[140:143], v[108:111], v[52:55]
  s_waitcnt vmcnt(7)
  v_min3_u32 v15, v220, v221, s8
  v_max3_u32 v14, v220, v221, s8
  v_min3_u32 v15, v15, v222, v223
  v_max3_u32 v14, v14, v222, v223
  v_cmp_ne_u32 vcc, v15, v14
  s_cbranch_vccnz again_23
ok_24:
  s_lshl_b32 s13, s7, 6
  s_sub_u32 s12, 255, s13
  v_sub_u32 v11, s12, v1
  v_lshlrev_b32 v11, 11, v11
  s_and_b32 s12, s24, 3
  s_lshl_b32 s12, s12, 9
  s_bfe_u32 s14, s24, 0x50002
  s_lshl_b32 s14, s14, 4
  s_add_u32 s12, s12, s14
  s_add_u32 s12, s12, 26214400
  s_lshl_b32 s13, s13, 4
  s_add_u32 m0, s13, 9216
  s_nop 0
  buffer_load_dwordx4 v11, s[52:55], s12 offen sc1 lds
  v_mfma_f32_16x16x32_bf16 v[56:59], v[136:139], v[112:115], v[56:59]
  ds_read_b128 v[92:95], v7 offset:43008
  s_waitcnt vmcnt(5)
  v_min3_u32 v15, v188, v189, s8
  v_max3_u32 v14, v188, v189, s8
  v_min3_u32 v15, v15, v190, v191
  v_max3_u32 v14, v14, v190, v191
  v_cmp_ne_u32 vcc, v15, v14
  s_cbranch_vccnz again_25
ok_26:
  s_mul_i32 s34, s6, 200
  s_mul_i32 s12, s7, 50
  s_add_u32 s34, s34, s12
  s_lshl_b32 s34, s34, 10
  s_add_u32 s34, s34, 23068672
  v_mfma_f32_16x16x32_bf16 v[60:63], v[140:143], v[112:115], v[60:63]
  buffer_load_dwordx4 a[0:3], v2, s[52:55], s34 offen offset:0 sc1
  v_mfma_f32_16x16x32_bf16 v[64:67], v[136:139], v[116:119], v[64:67]
  ds_read_b128 v[96:99], v7 offset:45056
  buffer_load_dwordx4 a[4:7], v2, s[52:55], s34 offen offset:1024 sc1
  v_mfma_f32_16x16x32_bf16 v[68:71], v[140:143], v[116:119], v[68:71]
  buffer_load_dwordx4 a[8:11], v2, s[52:55], s34 offen offset:2048 sc1
  s_waitcnt lgkmcnt(5)
  v_mfma_f32_16x16x32_bf16 v[72:75], v[136:139], v[120:123], v[72:75]
  ds_read_b128 v[100:103], v7 offset:47104
  v_mfma_f32_16x16x32_bf16 v[76:79], v[140:143], v[120:123], v[76:79]
  v_mfma_f32_16x16x32_bf16 v[80:83], v[136:139], v[124:127], v[80:83]
  ds_read_b128 v[104:107], v7 offset:49152
  v_mfma_f32_16x16x32_bf16 v[84:87], v[140:143], v[124:127], v[84:87]
  s_waitcnt lgkmcnt(2)
  v_mfma_f32_16x16x32_bf16 v[48:51], v[128:131], v[88:91], v[48:51]
  ds_read_b128 v[136:139], v145 offset:32768
  ds_read_b128 v[140:143], v145 offset:40960
  ds_read_b128 v[108:111], v8 offset:40960
  buffer_load_dwordx4 a[12:15], v2, s[52:55], s34 offen offset:3072 sc1
  v_mfma_f32_16x16x32_bf16 v[52:55], v[132:135], v[88:91], v[52:55]
  s_add_u32 s34, s34, 4096
  buffer_load_dwordx4 a[16:19], v2, s[52:55], s34 offen offset:0 sc1
  v_mfma_f32_16x16x32_bf16 v[56:59], v[128:131], v[92:95], v[56:59]
  ds_read_b128 v[112:115], v8 offset:43008
  buffer_load_dwordx4 a[20:23], v2, s[52:55], s34 offen offset:1024 sc1
  v_mfma_f32_16x16x32_bf16 v[60:63], v[132:135], v[92:95], v[60:63]
  v_mfma_f32_16x16x32_bf16 v[64:67], v[128:131], v[96:99], v[64:67]
  ds_read_b128 v[116:119], v8 offset:45056
  v_mfma_f32_16x16x32_bf16 v[68:71], v[132:135], v[96:99], v[68:71]
  s_waitcnt lgkmcnt(5)
  v_mfma_f32_16x16x32_bf16 v[72:75], v[128:131], v[100:103], v[72:75]
  ds_read_b128 v[120:123], v8 offset:47104
  v_mfma_f32_16x16x32_bf16 v[76:79], v[132:135], v[100:103], v[76:79]
  v_mfma_f32_16x16x32_bf16 v[80:83], v[128:131], v[104:107], v[80:83]
  ds_read_b128 v[124:127], v8 offset:49152
  v_mfma_f32_16x16x32_bf16 v[84:87], v[132:135], v[104:107], v[84:87]
  s_waitcnt lgkmcnt(2)
  s_barrier
  v_mfma_f32_16x16x32_bf16 v[48:51], v[136:139], v[108:111], v[48:51]
  buffer_load_dwordx4 a[24:27], v2, s[52:55], s34 offen offset:2048 sc1
  buffer_load_dwordx4 a[28:31], v2, s[52:55], s34 offen offset:3072 sc1
  v_mov_b32_e64 v246, v156
  v_mfma_f32_16x16x32_bf16 v[52:55], v[140:143], v[108:111], v[52:55]
  v_mov_b32 v247, v156
  v_mov_b32 v250, v158
  s_nop 0
  v_permlane16_swap_b32 v246, v247
  v_mfma_f32_16x16x32_bf16 v[56:59], v[136:139], v[112:115], v[56:59]
  v_mov_b32 v248, v246
  v_mov_b32 v249, v247
  s_nop 0
  v_permlane32_swap_b32 v246, v248
  v_mfma_f32_16x16x32_bf16 v[60:63], v[140:143], v[112:115], v[60:63]
  v_permlane32_swap_b32 v247, v249
  v_mov_b32_dpp v88, v152 row_newbcast:0 row_mask:0xf bank_mask:0xf
  v_mov_b32_dpp v96, v153 row_newbcast:0 row_mask:0xf bank_mask:0xf
  v_mfma_f32_16x16x32_bf16 v[64:67], v[136:139], v[116:119], v[64:67]
  v_mov_b32_dpp v89, v152 row_newbcast:1 row_mask:0xf bank_mask:0xf
  v_mov_b32_dpp v97, v153 row_newbcast:1 row_mask:0xf bank_mask:0xf
  v_mov_b32_dpp v90, v152 row_newbcast:2 row_mask:0xf bank_mask:0xf
  v_mfma_f32_16x16x32_bf16 v[68:71], v[140:143], v[116:119], v[68:71]
  v_mov_b32_dpp v98, v153 row_newbcast:2 row_mask:0xf bank_mask:0xf
  v_mov_b32_dpp v91, v152 row_newbcast:3 row_mask:0xf bank_mask:0xf
  v_mov_b32_dpp v99, v153 row_newbcast:3 row_mask:0xf bank_mask:0xf
  s_waitcnt lgkmcnt(0)
  v_mfma_f32_16x16x32_bf16 v[72:75], v[136:139], v[120:123], v[72:75]
  v_mov_b32_dpp v92, v152 row_newbcast:4 row_mask:0xf bank_mask:0xf
  v_mov_b32_dpp v100, v153 row_newbcast:4 row_mask:0xf bank_mask:0xf
  v_mfma_f32_16x16x32_bf16 v[76:79], v[140:143], v[120:123], v[76:79]
  v_mov_b32_dpp v93, v152 row_newbcast:5 row_mask:0xf bank_mask:0xf
  v_mov_b32_dpp v101, v153 row_newbcast:5 row_mask:0xf bank_mask:0xf
  v_mfma_f32_16x16x32_bf16 v[80:83], v[136:139], v[124:127], v[80:83]
  v_mov_b32_dpp v94, v152 row_newbcast:6 row_mask:0xf bank_mask:0xf
  v_mov_b32_dpp v102, v153 row_newbcast:6 row_mask:0xf bank_mask:0xf
  v_mfma_f32_16x16x32_bf16 v[84:87], v[140:143], v[124:127], v[84:87]
  v_mov_b32_dpp v95, v152 row_newbcast:7 row_mask:0xf bank_mask:0xf
  v_mov_b32_dpp v103, v153 row_newbcast:7 row_mask:0xf bank_mask:0xf
  v_pk_fma_f32 v[48:49], v[88:89], v[246:247], v[48:49] op_sel_hi:[1,0,1] neg_lo:[1,0,0] neg_hi:[1,0,0]
  v_pk_fma_f32 v[50:51], v[90:91], v[246:247], v[50:51] op_sel_hi:[1,0,1] neg_lo:[1,0,0] neg_hi:[1,0,0]
  v_pk_fma_f32 v[52:53], v[92:93], v[246:247], v[52:53] op_sel_hi:[1,0,1] neg_lo:[1,0,0] neg_hi:[1,0,0]
  v_pk_fma_f32 v[54:55], v[94:95], v[246:247], v[54:55] op_sel_hi:[1,0,1] neg_lo:[1,0,0] neg_hi:[1,0,0]
  v_pk_fma_f32 v[56:57], v[88:89], v[246:247], v[56:57] op_sel:[0,1,0] op_sel_hi:[1,1,1] neg_lo:[1,0,0] neg_hi:[1,0,0]
  v_pk_fma_f32 v[58:59], v[90:91], v[246:247], v[58:59] op_sel:[0,1,0] op_sel_hi:[1,1,1] neg_lo:[1,0,0] neg_hi:[1,0,0]
  v_pk_fma_f32 v[60:61], v[92:93], v[246:247], v[60:61] op_sel:[0,1,0] op_sel_hi:[1,1,1] neg_lo:[1,0,0] neg_hi:[1,0,0]
  v_pk_fma_f32 v[62:63], v[94:95], v[246:247], v[62:63] op_sel:[0,1,0] op_sel_hi:[1,1,1] neg_lo:[1,0,0] neg_hi:[1,0,0]
  v_pk_fma_f32 v[64:65], v[88:89], v[248:249], v[64:65] op_sel_hi:[1,0,1] neg_lo:[1,0,0] neg_hi:[1,0,0]
  v_pk_fma_f32 v[66:67], v[90:91], v[248:249], v[66:67] op_sel_hi:[1,0,1] neg_lo:[1,0,0] neg_hi:[1,0,0]
  v_pk_fma_f32 v[68:69], v[92:93], v[248:249], v[68:69] op_sel_hi:[1,0,1] neg_lo:[1,0,0] neg_hi:[1,0,0]
  v_pk_fma_f32 v[70:71], v[94:95], v[248:249], v[70:71] op_sel_hi:[1,0,1] neg_lo:[1,0,0] neg_hi:[1,0,0]
  v_pk_fma_f32 v[72:73], v[88:89], v[248:249], v[72:73] op_sel:[0,1,0] op_sel_hi:[1,1,1] neg_lo:[1,0,0] neg_hi:[1,0,0]
  v_pk_fma_f32 v[74:75], v[90:91], v[248:249], v[74:75] op_sel:[0,1,0] op_sel_hi:[1,1,1] neg_lo:[1,0,0] neg_hi:[1,0,0]
  v_pk_fma_f32 v[76:77], v[92:93], v[248:249], v[76:77] op_sel:[0,1,0] op_sel_hi:[1,1,1] neg_lo:[1,0,0] neg_hi:[1,0,0]
  v_pk_fma_f32 v[78:79], v[94:95], v[248:249], v[78:79] op_sel:[0,1,0] op_sel_hi:[1,1,1] neg_lo:[1,0,0] neg_hi:[1,0,0]
  v_pk_fma_f32 v[80:81], v[88:89], v[250:251], v[80:81] op_sel_hi:[1,0,1] neg_lo:[1,0,0] neg_hi:[1,0,0]
  v_pk_fma_f32 v[82:83], v[90:91], v[250:251], v[82:83] op_sel_hi:[1,0,1] neg_lo:[1,0,0] neg_hi:[1,0,0]
  v_pk_fma_f32 v[84:85], v[92:93], v[250:251], v[84:85] op_sel_hi:[1,0,1] neg_lo:[1,0,0] neg_hi:[1,0,0]
  v_pk_fma_f32 v[86:87], v[94:95], v[250:251], v[86:87] op_sel_hi:[1,0,1] neg_lo:[1,0,0] neg_hi:[1,0,0]
  v_pk_mul_f32 v[48:49], v[48:49], v[96:97]
  v_pk_mul_f32 v[50:51], v[50:51], v[98:99]
  v_pk_mul_f32 v[52:53], v[52:53], v[100:101]
  v_pk_mul_f32 v[54:55], v[54:55], v[102:103]
  v_pk_mul_f32 v[56:57], v[56:57], v[96:97]
  v_pk_mul_f32 v[58:59], v[58:59], v[98:99]
  v_pk_mul_f32 v[60:61], v[60:61], v[100:101]
  v_pk_mul_f32 v[62:63], v[62:63], v[102:103]
  v_pk_mul_f32 v[64:65], v[64:65], v[96:97]
  v_pk_mul_f32 v[66:67], v[66:67], v[98:99]
  v_pk_mul_f32 v[68:69], v[68:69], v[100:101]
  v_pk_mul_f32 v[70:71], v[70:71], v[102:103]
  v_pk_mul_f32 v[72:73], v[72:73], v[96:97]
  v_pk_mul_f32 v[74:75], v[74:75], v[98:99]
  v_pk_mul_f32 v[76:77], v[76:77], v[100:101]
  v_pk_mul_f32 v[78:79], v[78:79], v[102:103]
  v_pk_mul_f32 v[80:81], v[80:81], v[96:97]
  v_pk_mul_f32 v[82:83], v[82:83], v[98:99]
  v_pk_mul_f32 v[84:85], v[84:85], v[100:101]
  v_pk_mul_f32 v[86:87], v[86:87], v[102:103]
  s_waitcnt vmcnt(9)
  ds_write_b128 v186, v[192:195] offset:0
  s_add_u32 s34, s34, 4096
  buffer_load_dwordx4 a[32:35], v2, s[52:55], s34 offen offset:0 sc1
  v_fmac_f32 v49, v16, v48
  v_fmac_f32 v57, v17, v56
  v_fmac_f32 v65, v18, v64
  v_fmac_f32 v73, v19, v72
  v_fmac_f32 v81, v20, v80
  v_fmac_f32_dpp v49, v48, v21 quad_perm:[1,0,3,2] row_mask:0xf bank_mask:0xf
  v_fmac_f32_dpp v57, v56, v22 quad_perm:[1,0,3,2] row_mask:0xf bank_mask:0xf
  v_fmac_f32_dpp v65, v64, v23 quad_perm:[1,0,3,2] row_mask:0xf bank_mask:0xf
  v_fmac_f32_dpp v73, v72, v24 quad_perm:[1,0,3,2] row_mask:0xf bank_mask:0xf
  v_fmac_f32_dpp v81, v80, v25 quad_perm:[1,0,3,2] row_mask:0xf bank_mask:0xf
  v_alignbit_b32 v204, v204, v192, 16
  v_alignbit_b32 v205, v205, v193, 16
  v_alignbit_b32 v206, v206, v194, 16
  v_alignbit_b32 v207, v207, v195, 16
  ds_write_b128 v186, v[204:207] offset:4160
  ds_write_b128 v186, v[196:199] offset:8320
  buffer_load_dwordx4 a[36:39], v2, s[52:55], s34 offen offset:1024 sc1
  v_fmac_f32 v50, v16, v49
  v_fmac_f32 v58, v17, v57
  v_fmac_f32 v66, v18, v65
  v_fmac_f32 v74, v19, v73
  v_fmac_f32_e64 v82, v20, v81
  v_fmac_f32_dpp v50, v49, v21 quad_perm:[1,0,3,2] row_mask:0xf bank_mask:0xf
  v_fmac_f32_dpp v58, v57, v22 quad_perm:[1,0,3,2] row_mask:0xf bank_mask:0xf
  v_fmac_f32_dpp v66, v65, v23 quad_perm:[1,0,3,2] row_mask:0xf bank_mask:0xf
  v_fmac_f32_dpp v74, v73, v24 quad_perm:[1,0,3,2] row_mask:0xf bank_mask:0xf
  v_fmac_f32_dpp v82, v81, v25 quad_perm:[1,0,3,2] row_mask:0xf bank_mask:0xf
  v_alignbit_b32 v208, v208, v196, 16
  v_alignbit_b32 v209, v209, v197, 16
  v_alignbit_b32 v210, v210, v198, 16
  v_alignbit_b32 v211, v211, v199, 16
  ds_write_b128 v186, v[208:211] offset:12480
  ds_write_b128 v186, v[200:203] offset:16640
  buffer_load_dwordx4 a[40:43], v2, s[52:55], s34 offen offset:2048 sc1
  v_fmac_f32 v51, v16, v50
  v_fmac_f32 v59, v17, v58
  v_fmac_f32 v67, v18, v66
  v_fmac_f32 v75, v19, v74
  v_fmac_f32_e64 v83, v20, v82
  v_fmac_f32_dpp v51, v50, v21 quad_perm:[1,0,3,2] row_mask:0xf bank_mask:0xf
  v_fmac_f32_dpp v59, v58, v22 quad_perm:[1,0,3,2] row_mask:0xf bank_mask:0xf
  v_fmac_f32_dpp v67, v66, v23 quad_perm:[1,0,3,2] row_mask:0xf bank_mask:0xf
  v_fmac_f32_dpp v75, v74, v24 quad_perm:[1,0,3,2] row_mask:0xf bank_mask:0xf
  v_fmac_f32_dpp v83, v82, v25 quad_perm:[1,0,3,2] row_mask:0xf bank_mask:0xf
  v_alignbit_b32 v212, v212, v200, 16
  v_alignbit_b32 v213, v213, v201, 16
  v_alignbit_b32 v214, v214, v202, 16
  v_alignbit_b32 v215, v215, v203, 16
  ds_write_b128 v186, v[212:215] offset:20800
  buffer_load_dwordx4 a[44:47], v2, s[52:55], s34 offen offset:3072 sc1
  v_fmac_f32 v52, v16, v51
  v_fmac_f32 v60, v17, v59
  v_fmac_f32 v68, v18, v67
  v_fmac_f32 v76, v19, v75
  v_fmac_f32_e64 v84, v20, v83
  v_fmac_f32_dpp v52, v51, v21 quad_perm:[1,0,3,2] row_mask:0xf bank_mask:0xf
  v_fmac_f32_dpp v60, v59, v22 quad_perm:[1,0,3,2] row_mask:0xf bank_mask:0xf
  v_fmac_f32_dpp v68, v67, v23 quad_perm:[1,0,3,2] row_mask:0xf bank_mask:0xf
  v_fmac_f32_dpp v76, v75, v24 quad_perm:[1,0,3,2] row_mask:0xf bank_mask:0xf
  v_fmac_f32_dpp v84, v83, v25 quad_perm:[1,0,3,2] row_mask:0xf bank_mask:0xf
  s_cmp_lg_u32 s7, 0
  s_cbranch_scc1 skip_27
  v_mov_b32 v216, 0
  v_mov_b32 v217, 0
  v_mov_b32 v218, 0
  v_mov_b32 v219, 0
  s_mov_b64 exec, 0xfff
  ds_write_b128 v163, v[216:219]
  s_mov_b64 exec, 1
  ds_write_b16 v163, v192 offset:4190
  ds_write_b16 v163, v196 offset:12510
  ds_write_b16 v163, v200 offset:20830
  s_mov_b64 exec, -1
skip_27:
  s_add_u32 s34, s34, 4096
  buffer_load_dwordx4 a[48:51], v2, s[52:55], s34 offen offset:0 sc1
  v_fmac_f32 v53, v16, v52
  v_fmac_f32 v61, v17, v60
  v_fmac_f32 v69, v18, v68
  v_fmac_f32 v77, v19, v76
  v_fmac_f32_e64 v85, v20, v84
  v_fmac_f32_dpp v53, v52, v21 quad_perm:[1,0,3,2] row_mask:0xf bank_mask:0xf
  v_fmac_f32_dpp v61, v60, v22 quad_perm:[1,0,3,2] row_mask:0xf bank_mask:0xf
  v_fmac_f32_dpp v69, v68, v23 quad_perm:[1,0,3,2] row_mask:0xf bank_mask:0xf
  v_fmac_f32_dpp v77, v76, v24 quad_perm:[1,0,3,2] row_mask:0xf bank_mask:0xf
  v_fmac_f32_dpp v85, v84, v25 quad_perm:[1,0,3,2] row_mask:0xf bank_mask:0xf
  ds_write_b64 v228, v[152:153]
  buffer_load_dwordx4 a[52:55], v2, s[52:55], s34 offen offset:1024 sc1
  v_fmac_f32 v54, v16, v53
  v_fmac_f32 v62, v17, v61
  v_fmac_f32 v70, v18, v69
  v_fmac_f32 v78, v19, v77
  v_fmac_f32_e64 v86, v20, v85
  v_fmac_f32_dpp v54, v53, v21 quad_perm:[1,0,3,2] row_mask:0xf bank_mask:0xf
  v_fmac_f32_dpp v62, v61, v22 quad_perm:[1,0,3,2] row_mask:0xf bank_mask:0xf
  v_fmac_f32_dpp v70, v69, v23 quad_perm:[1,0,3,2] row_mask:0xf bank_mask:0xf
  v_fmac_f32_dpp v78, v77, v24 quad_perm:[1,0,3,2] row_mask:0xf bank_mask:0xf
  v_fmac_f32_dpp v86, v85, v25 quad_perm:[1,0,3,2] row_mask:0xf bank_mask:0xf
  buffer_load_dwordx4 a[56:59], v2, s[52:55], s34 offen offset:2048 sc1
  v_fmac_f32 v55, v16, v54
  v_fmac_f32 v63, v17, v62
  v_fmac_f32 v71, v18, v70
  v_fmac_f32 v79, v19, v78
  v_fmac_f32_e64 v87, v20, v86
  v_fmac_f32_dpp v55, v54, v21 quad_perm:[1,0,3,2] row_mask:0xf bank_mask:0xf
  v_fmac_f32_dpp v63, v62, v22 quad_perm:[1,0,3,2] row_mask:0xf bank_mask:0xf
  v_fmac_f32_dpp v71, v70, v23 quad_perm:[1,0,3,2] row_mask:0xf bank_mask:0xf
  v_fmac_f32_dpp v79, v78, v24 quad_perm:[1,0,3,2] row_mask:0xf bank_mask:0xf
  v_fmac_f32_dpp v87, v86, v25 quad_perm:[1,0,3,2] row_mask:0xf bank_mask:0xf
  v_add_u32 v11, 152320, v9
  v_min_u32 v12, 39, v1
  v_mul_u32_u24 v44, 48, v12
  s_lshl_b32 s12, s7, 3
  s_add_u32 s12, s12, 149504
  v_add_u32 v44, s12, v44
  ds_write_b32 v11, v55 offset:0
  ds_write_b32 v11, v63 offset:1152
  ds_write_b32 v11, v71 offset:2304
  ds_write_b32 v11, v79 offset:3456
  ds_write_b32 v11, v87 offset:4608
  v_mul_u32_u24 v46, 144, v12
  v_add_u32 v46, 152320, v46
  s_waitcnt lgkmcnt(0)
  s_barrier
  ds_read_b128 v[90:93], v46 offset:0
  ds_read_b128 v[94:97], v46 offset:16
  ds_read_b128 v[98:101], v46 offset:32
  ds_read_b128 v[102:105], v46 offset:48
  ds_read_b128 v[106:109], v46 offset:64
  ds_read_b128 v[110:113], v46 offset:80
  ds_read_b128 v[114:117], v46 offset:96
  ds_read_b128 v[118:121], v46 offset:112
  s_waitcnt lgkmcnt(7)
  v_pk_fma_f32 v[92:93], v[90:91], v[36:37], v[92:93] op_sel:[1,1,0] op_sel_hi:[0,1,1] neg_lo:[0,1,0]
  v_pk_fma_f32 v[92:93], v[90:91], v[36:37], v[92:93] op_sel:[0,0,0] op_sel_hi:[1,0,1]
  buffer_load_dwordx4 a[60:63], v2, s[52:55], s34 offen offset:3072 sc1
  s_waitcnt lgkmcnt(6)
  v_pk_fma_f32 v[94:95], v[92:93], v[36:37], v[94:95] op_sel:[1,1,0] op_sel_hi:[0,1,1] neg_lo:[0,1,0]
  v_pk_fma_f32 v[94:95], v[92:93], v[36:37], v[94:95] op_sel:[0,0,0] op_sel_hi:[1,0,1]
  v_pk_fma_f32 v[96:97], v[94:95], v[36:37], v[96:97] op_sel:[1,1,0] op_sel_hi:[0,1,1] neg_lo:[0,1,0]
  v_pk_fma_f32 v[96:97], v[94:95], v[36:37], v[96:97] op_sel:[0,0,0] op_sel_hi:[1,0,1]
  s_waitcnt lgkmcnt(5)
  s_add_u32 s34, s34, 4096
  buffer_load_dwordx4 a[64:67], v2, s[52:55], s34 offen offset:0 sc1
  v_pk_fma_f32 v[98:99], v[96:97], v[36:37], v[98:99] op_sel:[1,1,0] op_sel_hi:[0,1,1] neg_lo:[0,1,0]
  v_pk_fma_f32 v[98:99], v[96:97], v[36:37], v[98:99] op_sel:[0,0,0] op_sel_hi:[1,0,1]
  v_pk_fma_f32 v[100:101], v[98:99], v[36:37], v[100:101] op_sel:[1,1,0] op_sel_hi:[0,1,1] neg_lo:[0,1,0]
  v_pk_fma_f32 v[100:101], v[98:99], v[36:37], v[100:101] op_sel:[0,0,0] op_sel_hi:[1,0,1]
  s_waitcnt lgkmcnt(4)
  v_pk_fma_f32 v[102:103], v[100:101], v[36:37], v[102:103] op_sel:[1,1,0] op_sel_hi:[0,1,1] neg_lo:[0,1,0]
  buffer_load_dwordx4 a[68:71], v2, s[52:55], s34 offen offset:1024 sc1
  v_pk_fma_f32 v[102:103], v[100:101], v[36:37], v[102:103] op_sel:[0,0,0] op_sel_hi:[1,0,1]
  v_pk_fma_f32 v[104:105], v[102:103], v[36:37], v[104:105] op_sel:[1,1,0] op_sel_hi:[0,1,1] neg_lo:[0,1,0]
  v_pk_fma_f32 v[104:105], v[102:103], v[36:37], v[104:105] op_sel:[0,0,0] op_sel_hi:[1,0,1]
  s_waitcnt lgkmcnt(3)
  v_pk_fma_f32 v[106:107], v[104:105], v[36:37], v[106:107] op_sel:[1,1,0] op_sel_hi:[0,1,1] neg_lo:[0,1,0]
  v_pk_fma_f32 v[106:107], v[104:105], v[36:37], v[106:107] op_sel:[0,0,0] op_sel_hi:[1,0,1]
  buffer_load_dwordx4 a[72:75], v2, s[52:55], s34 offen offset:2048 sc1
  v_pk_fma_f32 v[108:109], v[106:107], v[36:37], v[108:109] op_sel:[1,1,0] op_sel_hi:[0,1,1] neg_lo:[0,1,0]
  v_pk_fma_f32 v[108:109], v[106:107], v[36:37], v[108:109] op_sel:[0,0,0] op_sel_hi:[1,0,1]
  s_waitcnt lgkmcnt(2)
  v_pk_fma_f32 v[110:111], v[108:109], v[36:37], v[110:111] op_sel:[1,1,0] op_sel_hi:[0,1,1] neg_lo:[0,1,0]
  v_pk_fma_f32 v[110:111], v[108:109], v[36:37], v[110:111] op_sel:[0,0,0] op_sel_hi:[1,0,1]
  v_pk_fma_f32 v[112:113], v[110:111], v[36:37], v[112:113] op_sel:[1,1,0] op_sel_hi:[0,1,1] neg_lo:[0,1,0]
  buffer_load_dwordx4 a[76:79], v2, s[52:55], s34 offen offset:3072 sc1
  v_pk_fma_f32 v[112:113], v[110:111], v[36:37], v[112:113] op_sel:[0,0,0] op_sel_hi:[1,0,1]
  s_waitcnt lgkmcnt(1)
  v_pk_fma_f32 v[114:115], v[112:113], v[36:37], v[114:115] op_sel:[1,1,0] op_sel_hi:[0,1,1] neg_lo:[0,1,0]
  v_pk_fma_f32 v[114:115], v[112:113], v[36:37], v[114:115] op_sel:[0,0,0] op_sel_hi:[1,0,1]
  v_pk_fma_f32 v[116:117], v[114:115], v[36:37], v[116:117] op_sel:[1,1,0] op_sel_hi:[0,1,1] neg_lo:[0,1,0]
  v_pk_fma_f32 v[116:117], v[114:115], v[36:37], v[116:117] op_sel:[0,0,0] op_sel_hi:[1,0,1]
  s_waitcnt lgkmcnt(0)
  v_pk_fma_f32 v[118:119], v[116:117], v[36:37], v[118:119] op_sel:[1,1,0] op_sel_hi:[0,1,1] neg_lo:[0,1,0]
  v_pk_fma_f32 v[118:119], v[116:117], v[36:37], v[118:119] op_sel:[0,0,0] op_sel_hi:[1,0,1]
  v_pk_fma_f32 v[120:121], v[118:119], v[36:37], v[120:121] op_sel:[1,1,0] op_sel_hi:[0,1,1] neg_lo:[0,1,0]
  v_pk_fma_f32 v[120:121], v[118:119], v[36:37], v[120:121] op_sel:[0,0,0] op_sel_hi:[1,0,1]
  v_mov_b32 v122, s8
  v_mov_b32 v123, s8
  s_add_u32 s12, s83, 10240
  s_mov_b64 exec, s[96:97]
  buffer_store_dwordx4 v[120:123], v2, s[52:55], s12 offen sc1
  s_mov_b64 exec, -1
  v_accvgpr_read_b32 v232, a200
  v_accvgpr_read_b32 v236, a201
  v_accvgpr_read_b32 v240, a202
  v_accvgpr_read_b32 v241, a203
  v_add_u32 v233, 1024, v232
  v_add_u32 v234, 2048, v232
  v_add_u32 v235, 3072, v232
  v_add_u32 v237, 1024, v236
  v_add_u32 v238, 2048, v236
  v_add_u32 v239, 3072, v236
  ds_read2_b32 v[156:157], v235 offset0:128 offset1:129
  ds_read2_b32 v[158:159], v235 offset0:130 offset1:131
  ds_read_b128 v[160:163], v240 offset:3584
  ds_read2_b32 v[152:153], v235 offset0:0 offset1:1
  ds_read2_b32 v[154:155], v235 offset0:2 offset1:3
  ds_read_b128 v[164:167], v240 offset:3072
  ds_read2_b32 v[148:149], v234 offset0:128 offset1:129
  ds_read2_b32 v[150:151], v234 offset0:130 offset1:131
  s_waitcnt lgkmcnt(5)
  v_mfma_f32_16x16x32_bf16 v[220:223], v[156:159], v[160:163], 0
  ds_read_b128 v[168:171], v240 offset:2560
  s_waitcnt lgkmcnt(4)
  v_mfma_f32_16x16x32_bf16 v[216:219], v[152:155], v[160:163], 0
  ds_read2_b32 v[144:145], v234 offset0:0 offset1:1
  ds_read2_b32 v[146:147], v234 offset0:2 offset1:3
  s_waitcnt lgkmcnt(5)
  v_mfma_f32_16x16x32_bf16 v[220:223], v[152:155], v[164:167], v[220:223]
  ds_read_b128 v[172:175], v240 offset:2048
  s_waitcnt lgkmcnt(4)
  v_mfma_f32_16x16x32_bf16 v[212:215], v[148:151], v[160:163], 0
  ds_read2_b32 v[140:141], v233 offset0:128 offset1:129
  ds_read2_b32 v[142:143], v233 offset0:130 offset1:131
  v_subrev_u32 v46, 8576, v46
  v_mov_b32 v88, 0
  v_mov_b32 v89, 0
  s_mov_b32 exec_hi, 0xff
  s_cmp_eq_u32 s7, 1
  s_cbranch_scc1 w1_30
  s_cmp_eq_u32 s7, 2
  s_cbranch_scc1 w2_31
  s_cmp_eq_u32 s7, 3
  s_cbranch_scc1 w3_32
w0_29:
  ds_write_b128 v46, v[88:91] offset:0
  ds_write_b128 v46, v[92:95] offset:16
  s_branch join_28
w1_30:
  ds_write_b128 v46, v[96:99] offset:32
  ds_write_b128 v46, v[100:103] offset:48
  s_branch join_28
w2_31:
  ds_write_b128 v46, v[104:107] offset:64
  ds_write_b128 v46, v[108:111] offset:80
  s_branch join_28
w3_32:
  ds_write_b128 v46, v[112:115] offset:96
  ds_write_b128 v46, v[116:119] offset:112
join_28:
  s_mov_b32 exec_hi, -1
  v_add_u32 v46, 143744, v9
  ds_read_b32 v244, v46 offset:0
  s_add_u32 s34, s34, 4096
  buffer_load_dwordx4 a[80:83], v2, s[52:55], s34 offen offset:0 sc1
  s_add_u32 m0, s48, 0
  s_nop 0
  buffer_load_dwordx4 v224, s[68:71], s20 offen lds
  ds_read_b64 a[226:227], v227
  v_mfma_f32_16x16x32_bf16 v[216:219], v[148:151], v[164:167], v[216:219]
  ds_read_b128 v[176:179], v240 offset:1536
  s_waitcnt lgkmcnt(10)
  v_mfma_f32_16x16x32_bf16 v[220:223], v[148:151], v[168:171], v[220:223]
  ds_read2_b32 v[136:137], v233 offset0:0 offset1:1
  ds_read2_b32 v[138:139], v233 offset0:2 offset1:3
  s_waitcnt lgkmcnt(10)
  v_mfma_f32_16x16x32_bf16 v[208:211], v[144:147], v[160:163], 0
  ds_read_b128 v[180:183], v240 offset:1024
  v_mfma_f32_16x16x32_bf16 v[212:215], v[144:147], v[164:167], v[212:215]
  ds_read2_b32 v[132:133], v232 offset0:128 offset1:129
  ds_read2_b32 v[134:135], v232 offset0:130 offset1:131
  ds_read_b32 v246, v46 offset:1152
  ds_read_b32 v248, v46 offset:2304
  ds_read_b32 v250, v46 offset:3456
  s_add_u32 m0, s48, 1024
  s_nop 0
  buffer_load_dwordx4 v225, s[68:71], s20 offen lds
  s_mov_b32 s60, s46
  s_and_b32 s61, s47, 0xffff
  s_mov_b32 s62, 5242880
  s_mov_b32 s63, 0x20000
  v_mfma_f32_16x16x32_bf16 v[216:219], v[144:147], v[168:171], v[216:219]
  ds_read_b32 v252, v46 offset:4608
  v_and_b32 v43, 1, v3
  s_waitcnt lgkmcnt(15)
  v_mfma_f32_16x16x32_bf16 v[220:223], v[144:147], v[172:175], v[220:223]
  v_cvt_f32_u32 v43, v43
  s_waitcnt lgkmcnt(14)
  v_mfma_f32_16x16x32_bf16 v[204:207], v[140:143], v[160:163], 0
  buffer_load_dwordx4 a[84:87], v2, s[52:55], s34 offen offset:1024 sc1
  v_mfma_f32_16x16x32_bf16 v[208:211], v[140:143], v[164:167], v[208:211]
  s_add_u32 m0, s48, 2048
  s_mov_b32 exec_hi, 0
  buffer_load_dwordx4 v226, s[68:71], s20 offen lds
  s_mov_b32 exec_hi, -1
  v_mfma_f32_16x16x32_bf16 v[212:215], v[140:143], v[168:171], v[212:215]
  v_fma_f32 v43, 2.0, v43, -1.0
  s_waitcnt lgkmcnt(0)
  s_nop 0
  v_mul_f32_dpp v245, v244, v43 quad_perm:[1,0,3,2] row_mask:0xf bank_mask:0xf
  v_mfma_f32_16x16x32_bf16 v[216:219], v[140:143], v[172:175], v[216:219]
  ds_read_b128 v[184:187], v240 offset:512
  v_mfma_f32_16x16x32_bf16 v[220:223], v[140:143], v[176:179], v[220:223]
  ds_read2_b32 v[128:129], v232 offset0:0 offset1:1
  ds_read2_b32 v[130:131], v232 offset0:2 offset1:3
  v_mfma_f32_16x16x32_bf16 v[200:203], v[136:139], v[160:163], 0
  s_mov_b32 s64, s32
  s_and_b32 s65, s33, 0xffff
  s_mov_b32 s66, 1280
  s_mov_b32 s67, 0x20000
  s_add_u32 m0, s48, 2560
  s_mul_i32 s12, s6, 160
  s_mov_b64 exec, 0x3ff
  buffer_load_dwordx4 v2, s[64:67], s12 offen lds
  s_mov_b64 exec, -1
  v_mov_b32 v228, -1
  v_mov_b32 v229, -1
  v_mov_b32 v230, -1
  v_mov_b32 v231, -1
  v_lshlrev_b32_e64 v11, 3, v1
  buffer_store_dwordx2 v[228:229], v11, s[52:55], s51 offen sc1
  v_mfma_f32_16x16x32_bf16 v[204:207], v[136:139], v[164:167], v[204:207]
  v_mul_f32_dpp v247, v246, v43 quad_perm:[1,0,3,2] row_mask:0xf bank_mask:0xf
  v_mul_f32_dpp v249, v248, v43 quad_perm:[1,0,3,2] row_mask:0xf bank_mask:0xf
  v_mfma_f32_16x16x32_bf16 v[208:211], v[136:139], v[168:171], v[208:211]
  v_mul_f32_dpp v251, v250, v43 quad_perm:[1,0,3,2] row_mask:0xf bank_mask:0xf
  v_mfma_f32_16x16x32_bf16 v[212:215], v[136:139], v[172:175], v[212:215]
  buffer_load_dwordx4 a[88:91], v2, s[52:55], s34 offen offset:2048 sc1
  v_mfma_f32_16x16x32_bf16 v[216:219], v[136:139], v[176:179], v[216:219]
  buffer_store_dwordx4 v[228:231], v2, s[52:55], s50 offen offset:0 sc1
  v_mfma_f32_16x16x32_bf16 v[220:223], v[136:139], v[180:183], v[220:223]
  v_mul_f32_dpp v253, v252, v43 quad_perm:[1,0,3,2] row_mask:0xf bank_mask:0xf
  v_mfma_f32_16x16x32_bf16 v[196:199], v[132:135], v[160:163], 0
  ds_read_b128 v[188:191], v240 offset:0
  v_mfma_f32_16x16x32_bf16 v[200:203], v[132:135], v[164:167], v[200:203]
  ds_read2_b32 v[156:157], v235 offset0:144 offset1:145
  ds_read2_b32 v[158:159], v235 offset0:146 offset1:147
  v_mfma_f32_16x16x32_bf16 v[204:207], v[132:135], v[168:171], v[204:207]
  ds_read2_b32 v[152:153], v235 offset0:16 offset1:17
  ds_read2_b32 v[154:155], v235 offset0:18 offset1:19
  buffer_store_dwordx4 v[228:231], v2, s[52:55], s50 offen offset:1024 sc1
  v_mfma_f32_16x16x32_bf16 v[208:211], v[132:135], v[172:175], v[208:211]
  buffer_load_dwordx4 a[92:95], v2, s[52:55], s34 offen offset:3072 sc1
  v_mfma_f32_16x16x32_bf16 v[212:215], v[132:135], v[176:179], v[212:215]
  ds_read2_b32 v[148:149], v234 offset0:144 offset1:145
  ds_read2_b32 v[150:151], v234 offset0:146 offset1:147
  v_mfma_f32_16x16x32_bf16 v[216:219], v[132:135], v[180:183], v[216:219]
  s_waitcnt lgkmcnt(9)
  v_mfma_f32_16x16x32_bf16 v[220:223], v[132:135], v[184:187], v[220:223]
  s_waitcnt lgkmcnt(7)
  v_mfma_f32_16x16x32_bf16 v[192:195], v[128:131], v[160:163], 0
  ds_read_b128 v[160:163], v240 offset:3648
  v_mfma_f32_16x16x32_bf16 v[196:199], v[128:131], v[164:167], v[196:199]
  ds_read2_b32 v[144:145], v234 offset0:16 offset1:17
  ds_read2_b32 v[146:147], v234 offset0:18 offset1:19
  v_mfma_f32_16x16x32_bf16 v[200:203], v[128:131], v[168:171], v[200:203]
  ds_read_b128 v[164:167], v240 offset:3136
  v_mfma_f32_16x16x32_bf16 v[204:207], v[128:131], v[172:175], v[204:207]
  ds_read_b128 v[168:171], v240 offset:2624
  v_mfma_f32_16x16x32_bf16 v[208:211], v[128:131], v[176:179], v[208:211]
  ds_read_b128 v[172:175], v240 offset:2112
  v_mfma_f32_16x16x32_bf16 v[212:215], v[128:131], v[180:183], v[212:215]
  ds_read2_b32 v[140:141], v233 offset0:144 offset1:145
  ds_read2_b32 v[142:143], v233 offset0:146 offset1:147
  v_mfma_f32_16x16x32_bf16 v[216:219], v[128:131], v[184:187], v[216:219]
  s_add_u32 s34, s34, 4096
  buffer_load_dwordx4 a[96:99], v2, s[52:55], s34 offen offset:0 sc1
  s_waitcnt lgkmcnt(14)
  v_mfma_f32_16x16x32_bf16 v[220:223], v[128:131], v[188:191], v[220:223]
  s_waitcnt lgkmcnt(7)
  v_mfma_f32_16x16x32_bf16 v[220:223], v[156:159], v[160:163], v[220:223]
  ds_read_b128 v[176:179], v240 offset:1600
  v_mfma_f32_16x16x32_bf16 v[216:219], v[152:155], v[160:163], v[216:219]
  ds_read2_b32 v[136:137], v233 offset0:16 offset1:17
  ds_read2_b32 v[138:139], v233 offset0:18 offset1:19
  s_waitcnt lgkmcnt(7)
  v_mfma_f32_16x16x32_bf16 v[220:223], v[152:155], v[164:167], v[220:223]
  v_mfma_f32_16x16x32_bf16 v[212:215], v[148:151], v[160:163], v[212:215]
  v_mfma_f32_16x16x32_bf16 v[216:219], v[148:151], v[164:167], v[216:219]
  buffer_load_dwordx4 a[100:103], v2, s[52:55], s34 offen offset:1024 sc1
  s_waitcnt lgkmcnt(6)
  v_mfma_f32_16x16x32_bf16 v[220:223], v[148:151], v[168:171], v[220:223]
  s_and_b32 vcc_lo, s1, 7
  s_lshl_b32 vcc_lo, vcc_lo, 2
  s_add_u32 vcc_lo, vcc_lo, s7
  s_lshl_b32 vcc_lo, vcc_lo, 11
  v_lshl_add_u32 v15, v3, 7, vcc_lo
  v_min_u32 v15, L_codeend-L_pc-4, v15
  s_mov_b64 exec, 0xffff
  global_load_dword a250, v15, s[98:99]
  s_mov_b64 exec, -1
  v_mfma_f32_16x16x32_bf16 v[208:211], v[144:147], v[160:163], v[208:211]
  ds_read_b128 v[180:183], v240 offset:1088
  v_mfma_f32_16x16x32_bf16 v[212:215], v[144:147], v[164:167], v[212:215]
  ds_read2_b32 v[132:133], v232 offset0:144 offset1:145
  ds_read2_b32 v[134:135], v232 offset0:146 offset1:147
  v_mfma_f32_16x16x32_bf16 v[216:219], v[144:147], v[168:171], v[216:219]
  s_waitcnt lgkmcnt(8)
  v_mfma_f32_16x16x32_bf16 v[220:223], v[144:147], v[172:175], v[220:223]
  s_waitcnt lgkmcnt(6)
  v_mfma_f32_16x16x32_bf16 v[204:207], v[140:143], v[160:163], v[204:207]
  v_mfma_f32_16x16x32_bf16 v[208:211], v[140:143], v[164:167], v[208:211]
  v_mfma_f32_16x16x32_bf16 v[212:215], v[140:143], v[168:171], v[212:215]
  buffer_load_dwordx4 a[104:107], v2, s[52:55], s34 offen offset:2048 sc1
  v_mfma_f32_16x16x32_bf16 v[216:219], v[140:143], v[172:175], v[216:219]
  ds_read_b128 v[184:187], v240 offset:576
  s_waitcnt lgkmcnt(6)
  v_mfma_f32_16x16x32_bf16 v[220:223], v[140:143], v[176:179], v[220:223]
  ds_read2_b32 v[128:129], v232 offset0:16 offset1:17
  ds_read2_b32 v[130:131], v232 offset0:18 offset1:19
  s_waitcnt lgkmcnt(6)
  v_mfma_f32_16x16x32_bf16 v[200:203], v[136:139], v[160:163], v[200:203]
  v_accvgpr_read_b32 v11, a245
  s_and_b32 exec_lo, s96, 0x3fffffff
  s_mov_b32 exec_hi, 0
  buffer_load_dword a250, v11, s[52:55], 0 offen
  s_mov_b64 exec, -1
  v_mfma_f32_16x16x32_bf16 v[204:207], v[136:139], v[164:167], v[204:207]
  v_mfma_f32_16x16x32_bf16 v[208:211], v[136:139], v[168:171], v[208:211]
  v_mfma_f32_16x16x32_bf16 v[212:215], v[136:139], v[172:175], v[212:215]
  v_mfma_f32_16x16x32_bf16 v[216:219], v[136:139], v[176:179], v[216:219]
  s_waitcnt lgkmcnt(5)
  v_mfma_f32_16x16x32_bf16 v[220:223], v[136:139], v[180:183], v[220:223]
  buffer_load_dwordx4 a[108:111], v2, s[52:55], s34 offen offset:3072 sc1
  s_waitcnt lgkmcnt(3)
  v_mfma_f32_16x16x32_bf16 v[196:199], v[132:135], v[160:163], v[196:199]
  ds_read_b128 v[188:191], v240 offset:64
  v_mfma_f32_16x16x32_bf16 v[200:203], v[132:135], v[164:167], v[200:203]
  ds_read2_b32 v[156:157], v235 offset0:160 offset1:161
  ds_read2_b32 v[158:159], v235 offset0:162 offset1:163
  v_mfma_f32_16x16x32_bf16 v[204:207], v[132:135], v[168:171], v[204:207]
  ds_read2_b32 v[152:153], v235 offset0:32 offset1:33
  ds_read2_b32 v[154:155], v235 offset0:34 offset1:35
  s_waitcnt vmcnt(9)
  ds_read_b64 a[216:217], v242 offset:0
  v_mfma_f32_16x16x32_bf16 v[208:211], v[132:135], v[172:175], v[208:211]
  ds_read_b64 a[218:219], v242 offset:32
  v_mfma_f32_16x16x32_bf16 v[212:215], v[132:135], v[176:179], v[212:215]
  ds_read2_b32 v[148:149], v234 offset0:160 offset1:161
  ds_read2_b32 v[150:151], v234 offset0:162 offset1:163
  v_mfma_f32_16x16x32_bf16 v[216:219], v[132:135], v[180:183], v[216:219]
  ds_read_b64 a[220:221], v242 offset:64
  s_waitcnt lgkmcnt(12)
  v_mfma_f32_16x16x32_bf16 v[220:223], v[132:135], v[184:187], v[220:223]
  s_waitcnt lgkmcnt(10)
  v_mfma_f32_16x16x32_bf16 v[192:195], v[128:131], v[160:163], v[192:195]
  ds_read_b128 v[160:163], v240 offset:3712
  v_mfma_f32_16x16x32_bf16 v[196:199], v[128:131], v[164:167], v[196:199]
  ds_read2_b32 v[144:145], v234 offset0:32 offset1:33
  ds_read2_b32 v[146:147], v234 offset0:34 offset1:35
  v_mfma_f32_16x16x32_bf16 v[200:203], v[128:131], v[168:171], v[200:203]
  ds_read_b128 v[164:167], v240 offset:3200
  v_mfma_f32_16x16x32_bf16 v[204:207], v[128:131], v[172:175], v[204:207]
  ds_read_b128 v[168:171], v240 offset:2688
  s_add_u32 s34, s34, 4096
  buffer_load_dwordx4 a[112:115], v2, s[52:55], s34 offen offset:0 sc1
  ds_read_b64 a[222:223], v242 offset:96
  ds_read_b64 a[224:225], v242 offset:128
  v_mfma_f32_16x16x32_bf16 v[208:211], v[128:131], v[176:179], v[208:211]
  ds_read_b128 v[172:175], v240 offset:2176
  v_mfma_f32_16x16x32_bf16 v[212:215], v[128:131], v[180:183], v[212:215]
  ds_read2_b32 v[140:141], v233 offset0:160 offset1:161
  ds_read2_b32 v[142:143], v233 offset0:162 offset1:163
  v_mfma_f32_16x16x32_bf16 v[216:219], v[128:131], v[184:187], v[216:219]
  ds_read_b64 a[230:231], v243 offset:2560
  s_waitcnt lgkmcnt(15)
  v_mfma_f32_16x16x32_bf16 v[220:223], v[128:131], v[188:191], v[220:223]
  ds_read_b64 a[232:233], v243 offset:2592
  s_waitcnt lgkmcnt(11)
  v_mfma_f32_16x16x32_bf16 v[220:223], v[156:159], v[160:163], v[220:223]
  ds_read_b128 v[176:179], v240 offset:1664
  v_mfma_f32_16x16x32_bf16 v[216:219], v[152:155], v[160:163], v[216:219]
  ds_read2_b32 v[136:137], v233 offset0:32 offset1:33
  ds_read2_b32 v[138:139], v233 offset0:34 offset1:35
  s_waitcnt lgkmcnt(11)
  v_mfma_f32_16x16x32_bf16 v[220:223], v[152:155], v[164:167], v[220:223]
  buffer_load_dwordx4 a[116:119], v2, s[52:55], s34 offen offset:1024 sc1
  ds_read_b64 a[234:235], v243 offset:2624
  v_mfma_f32_16x16x32_bf16 v[212:215], v[148:151], v[160:163], v[212:215]
  ds_read_b64 a[236:237], v243 offset:2656
  v_mfma_f32_16x16x32_bf16 v[216:219], v[148:151], v[164:167], v[216:219]
  ds_read_b64 a[238:239], v243 offset:2688
  s_lshl_b32 s90, s7, 2
  s_waitcnt lgkmcnt(13)
  v_mfma_f32_16x16x32_bf16 v[220:223], v[148:151], v[168:171], v[220:223]
  s_sub_u32 s90, 12, s90
  v_mfma_f32_16x16x32_bf16 v[208:211], v[144:147], v[160:163], v[208:211]
  ds_read_b128 v[180:183], v240 offset:1152
  v_mfma_f32_16x16x32_bf16 v[212:215], v[144:147], v[164:167], v[212:215]
  ds_read2_b32 v[132:133], v232 offset0:160 offset1:161
  ds_read2_b32 v[134:135], v232 offset0:162 offset1:163
  s_mul_i32 s90, s90, 640
  s_add_u32 s90, s90, s83
  v_mfma_f32_16x16x32_bf16 v[216:219], v[144:147], v[168:171], v[216:219]
  s_add_u32 s90, s90, 0
  s_waitcnt lgkmcnt(13)
  v_mfma_f32_16x16x32_bf16 v[220:223], v[144:147], v[172:175], v[220:223]
  v_min_u32 v42, 39, v1
  s_waitcnt lgkmcnt(11)
  v_mfma_f32_16x16x32_bf16 v[204:207], v[140:143], v[160:163], v[204:207]
  v_lshlrev_b32 v42, 4, v42
  v_mfma_f32_16x16x32_bf16 v[208:211], v[140:143], v[164:167], v[208:211]
  v_mfma_f32_16x16x32_bf16 v[212:215], v[140:143], v[168:171], v[212:215]
  buffer_load_dwordx3 v[88:90], v42, s[52:55], s90 offen offset:0 sc1
  v_mfma_f32_16x16x32_bf16 v[216:219], v[140:143], v[172:175], v[216:219]
  ds_read_b128 v[184:187], v240 offset:640
  s_waitcnt lgkmcnt(9)
  v_mfma_f32_16x16x32_bf16 v[220:223], v[140:143], v[176:179], v[220:223]
  ds_read2_b32 v[128:129], v232 offset0:32 offset1:33
  ds_read2_b32 v[130:131], v232 offset0:34 offset1:35
  s_waitcnt lgkmcnt(9)
  v_mfma_f32_16x16x32_bf16 v[200:203], v[136:139], v[160:163], v[200:203]
  buffer_load_dwordx3 v[92:94], v42, s[52:55], s90 offen offset:640 sc1
  v_mfma_f32_16x16x32_bf16 v[204:207], v[136:139], v[164:167], v[204:207]
  buffer_load_dwordx3 v[96:98], v42, s[52:55], s90 offen offset:1280 sc1
  v_mfma_f32_16x16x32_bf16 v[208:211], v[136:139], v[168:171], v[208:211]
  buffer_load_dwordx3 v[100:102], v42, s[52:55], s90 offen offset:1920 sc1
  v_mfma_f32_16x16x32_bf16 v[212:215], v[136:139], v[172:175], v[212:215]
  v_mfma_f32_16x16x32_bf16 v[216:219], v[136:139], v[176:179], v[216:219]
  s_waitcnt lgkmcnt(5)
  v_mfma_f32_16x16x32_bf16 v[220:223], v[136:139], v[180:183], v[220:223]
  s_waitcnt lgkmcnt(3)
  v_mfma_f32_16x16x32_bf16 v[196:199], v[132:135], v[160:163], v[196:199]
  ds_read_b128 v[188:191], v240 offset:128
  v_mfma_f32_16x16x32_bf16 v[200:203], v[132:135], v[164:167], v[200:203]
  v_mfma_f32_16x16x32_bf16 v[204:207], v[132:135], v[168:171], v[204:207]
  v_mfma_f32_16x16x32_bf16 v[208:211], v[132:135], v[172:175], v[208:211]
  v_mfma_f32_16x16x32_bf16 v[212:215], v[132:135], v[176:179], v[212:215]
  v_mfma_f32_16x16x32_bf16 v[216:219], v[132:135], v[180:183], v[216:219]
  s_waitcnt lgkmcnt(3)
  v_mfma_f32_16x16x32_bf16 v[220:223], v[132:135], v[184:187], v[220:223]
  s_waitcnt lgkmcnt(1)
  v_mfma_f32_16x16x32_bf16 v[192:195], v[128:131], v[160:163], v[192:195]
  v_mfma_f32_16x16x32_bf16 v[196:199], v[128:131], v[164:167], v[196:199]
  v_mfma_f32_16x16x32_bf16 v[200:203], v[128:131], v[168:171], v[200:203]
  v_mfma_f32_16x16x32_bf16 v[204:207], v[128:131], v[172:175], v[204:207]
  v_mfma_f32_16x16x32_bf16 v[208:211], v[128:131], v[176:179], v[208:211]
  v_mfma_f32_16x16x32_bf16 v[212:215], v[128:131], v[180:183], v[212:215]
  v_mfma_f32_16x16x32_bf16 v[216:219], v[128:131], v[184:187], v[216:219]
  s_waitcnt lgkmcnt(0)
  v_mfma_f32_16x16x32_bf16 v[220:223], v[128:131], v[188:191], v[220:223]
  v_lshrrev_b32 v11, 1, v3
  v_mul_u32_u24 v12, 80, v11
  v_add_u32 v12, 160640, v12
  v_mul_u32_u24_e64 v11, 48, v11
  v_add_u32 v11, 149504, v11
  ds_read_b128 v[128:131], v12 offset:0
  ds_read_b128 v[132:135], v12 offset:16
  ds_read_b128 v[136:139], v12 offset:32
  ds_read_b128 v[140:143], v12 offset:48
  ds_read_b128 v[144:147], v12 offset:640
  ds_read_b128 v[148:151], v12 offset:656
  ds_read_b128 v[152:155], v12 offset:672
  ds_read_b128 v[156:159], v12 offset:688
  v_accvgpr_read_b32 v254, a240
  v_accvgpr_read_b32 v255, a241
  v_accvgpr_read_b32 v47, a242
  s_waitcnt vmcnt(0)
  v_min3_u32 v14, v90, v94, s8
  v_max3_u32 v15, v90, v94, s8
  v_min3_u32 v14, v14, v98, v102
  v_max3_u32 v15, v15, v98, v102
  v_cmp_ne_u32 vcc, v14, v15
  s_cbranch_vccz ok_34
again_33:
  buffer_load_dwordx3 v[88:90], v42, s[52:55], s90 offen offset:0 sc1
  buffer_load_dwordx3 v[92:94], v42, s[52:55], s90 offen offset:640 sc1
  buffer_load_dwordx3 v[96:98], v42, s[52:55], s90 offen offset:1280 sc1
  buffer_load_dwordx3 v[100:102], v42, s[52:55], s90 offen offset:1920 sc1
  s_sub_u32 s10, s10, 1
  s_cmp_gt_i32 s10, 0
  s_waitcnt vmcnt(0)
  v_min3_u32 v14, v90, v94, s8
  v_max3_u32 v15, v90, v94, s8
  v_min3_u32 v14, v14, v98, v102
  v_max3_u32 v15, v15, v98, v102
  v_cmp_ne_u32 vcc, v14, v15
  s_cbranch_scc0 out_35
  s_cbranch_vccnz again_33
out_35:
ok_34:
  v_pk_fma_f32 v[92:93], v[88:89], v[38:39], v[92:93] op_sel:[1,1,0] op_sel_hi:[0,1,1] neg_lo:[0,1,0]
  v_pk_fma_f32 v[92:93], v[88:89], v[38:39], v[92:93] op_sel:[0,0,0] op_sel_hi:[1,0,1]
  v_pk_fma_f32 v[96:97], v[92:93], v[38:39], v[96:97] op_sel:[1,1,0] op_sel_hi:[0,1,1] neg_lo:[0,1,0]
  v_pk_fma_f32 v[96:97], v[92:93], v[38:39], v[96:97] op_sel:[0,0,0] op_sel_hi:[1,0,1]
  v_pk_fma_f32 v[100:101], v[96:97], v[38:39], v[100:101] op_sel:[1,1,0] op_sel_hi:[0,1,1] neg_lo:[0,1,0]
  v_pk_fma_f32 v[100:101], v[96:97], v[38:39], v[100:101] op_sel:[0,0,0] op_sel_hi:[1,0,1]
  v_pk_mul_f32 v[88:89], v[100:101], v[40:41] op_sel:[1,1] op_sel_hi:[0,1] neg_lo:[0,1]
  v_pk_fma_f32 v[88:89], v[100:101], v[40:41], v[88:89] op_sel:[0,0,0] op_sel_hi:[1,0,1]
  buffer_load_dwordx4 a[120:123], v2, s[52:55], s34 offen offset:2048 sc1
  s_mov_b32 exec_hi, 0xff
  ds_write_b64 v44, v[88:89]
  s_mov_b32 exec_hi, -1
  s_waitcnt lgkmcnt(0)
  s_barrier
  ds_read_b128 v[88:91], v11 offset:0
  ds_read_b128 v[92:95], v11 offset:16
  ds_read_b128 v[96:99], v11 offset:384
  ds_read_b128 v[100:103], v11 offset:400
  ds_read_b128 v[224:227], v11 offset:768
  ds_read_b128 v[228:231], v11 offset:784
  ds_read_b128 v[160:163], v12 offset:1280
  ds_read_b128 v[164:167], v12 offset:1296
  ds_read_b128 v[168:171], v12 offset:1312
  ds_read_b128 v[172:175], v12 offset:1328
  buffer_load_dwordx4 a[124:127], v2, s[52:55], s34 offen offset:3072 sc1
  s_waitcnt lgkmcnt(8)
  v_pk_add_f32 v[88:89], v[88:89], v[90:91]
  v_pk_add_f32 v[92:93], v[92:93], v[94:95]
  v_pk_add_f32 v[88:89], v[88:89], v[92:93]
  v_pk_fma_f32 v[244:245], v[26:27], v[88:89], v[244:245] op_sel:[0,0,0] op_sel_hi:[1,0,1]
  v_pk_fma_f32 v[244:245], v[26:27], v[88:89], v[244:245] op_sel:[1,1,0] op_sel_hi:[0,1,1] neg_hi:[1,0,0]
  ds_read_b128 v[88:91], v11 offset:1152
  ds_read_b128 v[92:95], v11 offset:1168
  s_waitcnt lgkmcnt(8)
  v_pk_add_f32 v[96:97], v[96:97], v[98:99]
  v_pk_add_f32 v[100:101], v[100:101], v[102:103]
  v_pk_add_f32 v[96:97], v[96:97], v[100:101]
  v_pk_fma_f32 v[246:247], v[28:29], v[96:97], v[246:247] op_sel:[0,0,0] op_sel_hi:[1,0,1]
  v_pk_fma_f32 v[246:247], v[28:29], v[96:97], v[246:247] op_sel:[1,1,0] op_sel_hi:[0,1,1] neg_hi:[1,0,0]
  ds_read_b128 v[96:99], v11 offset:1536
  ds_read_b128 v[100:103], v11 offset:1552
  ds_read_b128 v[176:179], v12 offset:1920
  ds_read_b128 v[180:183], v12 offset:1936
  ds_read_b128 v[184:187], v12 offset:1952
  ds_read_b128 v[188:191], v12 offset:1968
  v_pk_fma_f32 v[48:49], v[128:129], v[244:245], v[48:49] op_sel:[0,0,0] op_sel_hi:[1,0,1]
  v_pk_fma_f32 v[50:51], v[130:131], v[244:245], v[50:51] op_sel:[0,0,0] op_sel_hi:[1,0,1]
  v_pk_fma_f32 v[52:53], v[132:133], v[244:245], v[52:53] op_sel:[0,0,0] op_sel_hi:[1,0,1]
  v_pk_fma_f32 v[54:55], v[134:135], v[244:245], v[54:55] op_sel:[0,0,0] op_sel_hi:[1,0,1]
  s_add_u32 s34, s34, 4096
  buffer_load_dwordx4 a[128:131], v2, s[52:55], s34 offen offset:0 sc1
  v_pk_fma_f32 v[48:49], v[136:137], v[244:245], v[48:49] op_sel:[0,1,0] op_sel_hi:[1,1,1]
  v_pk_fma_f32 v[50:51], v[138:139], v[244:245], v[50:51] op_sel:[0,1,0] op_sel_hi:[1,1,1]
  v_pk_fma_f32 v[52:53], v[140:141], v[244:245], v[52:53] op_sel:[0,1,0] op_sel_hi:[1,1,1]
  v_pk_fma_f32 v[54:55], v[142:143], v[244:245], v[54:55] op_sel:[0,1,0] op_sel_hi:[1,1,1]
  v_cvt_pk_bf16_f32 v120, v48, v49
  v_cvt_pk_bf16_f32 v121, v50, v51
  v_cvt_pk_bf16_f32 v122, v52, v53
  v_cvt_pk_bf16_f32 v123, v54, v55
  ds_write_b128 v254, v[120:123]
  buffer_load_dwordx4 a[132:135], v2, s[52:55], s34 offen offset:1024 sc1
  ds_read_b64_tr_b16 v[52:53], v255
  ds_read_b64_tr_b16 v[54:55], v255 offset:640
  s_waitcnt lgkmcnt(15)
  v_pk_add_f32 v[224:225], v[224:225], v[226:227]
  v_pk_add_f32 v[228:229], v[228:229], v[230:231]
  v_pk_add_f32 v[224:225], v[224:225], v[228:229]
  v_pk_fma_f32 v[248:249], v[30:31], v[224:225], v[248:249] op_sel:[0,0,0] op_sel_hi:[1,0,1]
  v_pk_fma_f32 v[248:249], v[30:31], v[224:225], v[248:249] op_sel:[1,1,0] op_sel_hi:[0,1,1] neg_hi:[1,0,0]
  s_lshl_b32 s12, s86, 1
  s_add_u32 s12, s12, 24576
  v_mov_b32 v15, s8
  s_and_b32 exec_lo, s96, 1
  s_mov_b32 exec_hi, 0
  buffer_store_dword v15, off, s[52:55], s12 sc1
  s_mov_b64 exec, -1
  ds_read_b128 v[104:107], v12 offset:2560
  ds_read_b128 v[108:111], v12 offset:2576
  ds_read_b128 v[112:115], v12 offset:2592
  ds_read_b128 v[116:119], v12 offset:2608
  v_pk_fma_f32 v[56:57], v[144:145], v[246:247], v[56:57] op_sel:[0,0,0] op_sel_hi:[1,0,1]
  v_pk_fma_f32 v[58:59], v[146:147], v[246:247], v[58:59] op_sel:[0,0,0] op_sel_hi:[1,0,1]
  v_pk_fma_f32 v[60:61], v[148:149], v[246:247], v[60:61] op_sel:[0,0,0] op_sel_hi:[1,0,1]
  v_pk_fma_f32 v[62:63], v[150:151], v[246:247], v[62:63] op_sel:[0,0,0] op_sel_hi:[1,0,1]
  buffer_load_dwordx4 a[136:139], v2, s[52:55], s34 offen offset:2048 sc1
  v_pk_fma_f32 v[56:57], v[152:153], v[246:247], v[56:57] op_sel:[0,1,0] op_sel_hi:[1,1,1]
  v_pk_fma_f32 v[58:59], v[154:155], v[246:247], v[58:59] op_sel:[0,1,0] op_sel_hi:[1,1,1]
  v_pk_fma_f32 v[60:61], v[156:157], v[246:247], v[60:61] op_sel:[0,1,0] op_sel_hi:[1,1,1]
  v_pk_fma_f32 v[62:63], v[158:159], v[246:247], v[62:63] op_sel:[0,1,0] op_sel_hi:[1,1,1]
  v_cvt_pk_bf16_f32 v124, v56, v57
  v_cvt_pk_bf16_f32 v125, v58, v59
  v_cvt_pk_bf16_f32 v126, v60, v61
  v_cvt_pk_bf16_f32 v127, v62, v63
  ds_write_b128 v254, v[124:127]
  buffer_load_dwordx4 a[140:143], v2, s[52:55], s34 offen offset:3072 sc1
  ds_read_b64_tr_b16 v[60:61], v255
  ds_read_b64_tr_b16 v[62:63], v255 offset:640
  s_waitcnt lgkmcnt(15)
  v_pk_add_f32 v[88:89], v[88:89], v[90:91]
  v_pk_add_f32 v[92:93], v[92:93], v[94:95]
  v_pk_add_f32 v[88:89], v[88:89], v[92:93]
  v_pk_fma_f32 v[250:251], v[32:33], v[88:89], v[250:251] op_sel:[0,0,0] op_sel_hi:[1,0,1]
  v_pk_fma_f32 v[250:251], v[32:33], v[88:89], v[250:251] op_sel:[1,1,0] op_sel_hi:[0,1,1] neg_hi:[1,0,0]
  s_add_u32 s13, s78, 0
  s_waitcnt lgkmcnt(7)
  buffer_store_dwordx4 v[52:55], v47, s[60:63], s13 offen sc1
  v_pk_fma_f32 v[64:65], v[160:161], v[248:249], v[64:65] op_sel:[0,0,0] op_sel_hi:[1,0,1]
  v_pk_fma_f32 v[66:67], v[162:163], v[248:249], v[66:67] op_sel:[0,0,0] op_sel_hi:[1,0,1]
  v_pk_fma_f32 v[68:69], v[164:165], v[248:249], v[68:69] op_sel:[0,0,0] op_sel_hi:[1,0,1]
  v_pk_fma_f32 v[70:71], v[166:167], v[248:249], v[70:71] op_sel:[0,0,0] op_sel_hi:[1,0,1]
  s_add_u32 s34, s34, 4096
  buffer_load_dwordx4 a[144:147], v2, s[52:55], s34 offen offset:0 sc1
  v_pk_fma_f32 v[64:65], v[168:169], v[248:249], v[64:65] op_sel:[0,1,0] op_sel_hi:[1,1,1]
  v_pk_fma_f32 v[66:67], v[170:171], v[248:249], v[66:67] op_sel:[0,1,0] op_sel_hi:[1,1,1]
  v_pk_fma_f32 v[68:69], v[172:173], v[248:249], v[68:69] op_sel:[0,1,0] op_sel_hi:[1,1,1]
  v_pk_fma_f32 v[70:71], v[174:175], v[248:249], v[70:71] op_sel:[0,1,0] op_sel_hi:[1,1,1]
  v_cvt_pk_bf16_f32 v120, v64, v65
  v_cvt_pk_bf16_f32 v121, v66, v67
  v_cvt_pk_bf16_f32 v122, v68, v69
  v_cvt_pk_bf16_f32 v123, v70, v71
  ds_write_b128 v254, v[120:123]
  buffer_load_dwordx4 a[148:151], v2, s[52:55], s34 offen offset:1024 sc1
  ds_read_b64_tr_b16 v[68:69], v255
  ds_read_b64_tr_b16 v[70:71], v255 offset:640
  v_pk_add_f32 v[96:97], v[96:97], v[98:99]
  v_pk_add_f32 v[100:101], v[100:101], v[102:103]
  v_pk_add_f32 v[96:97], v[96:97], v[100:101]
  v_pk_fma_f32 v[252:253], v[34:35], v[96:97], v[252:253] op_sel:[0,0,0] op_sel_hi:[1,0,1]
  v_pk_fma_f32 v[252:253], v[34:35], v[96:97], v[252:253] op_sel:[1,1,0] op_sel_hi:[0,1,1] neg_hi:[1,0,0]
  s_add_u32 s13, s79, 0
  s_waitcnt lgkmcnt(3)
  buffer_store_dwordx4 v[60:63], v47, s[60:63], s13 offen sc1
  v_pk_fma_f32 v[72:73], v[176:177], v[250:251], v[72:73] op_sel:[0,0,0] op_sel_hi:[1,0,1]
  v_pk_fma_f32 v[74:75], v[178:179], v[250:251], v[74:75] op_sel:[0,0,0] op_sel_hi:[1,0,1]
  v_pk_fma_f32 v[76:77], v[180:181], v[250:251], v[76:77] op_sel:[0,0,0] op_sel_hi:[1,0,1]
  v_pk_fma_f32 v[78:79], v[182:183], v[250:251], v[78:79] op_sel:[0,0,0] op_sel_hi:[1,0,1]
  v_pk_fma_f32 v[72:73], v[184:185], v[250:251], v[72:73] op_sel:[0,1,0] op_sel_hi:[1,1,1]
  v_pk_fma_f32 v[74:75], v[186:187], v[250:251], v[74:75] op_sel:[0,1,0] op_sel_hi:[1,1,1]
  v_pk_fma_f32 v[76:77], v[188:189], v[250:251], v[76:77] op_sel:[0,1,0] op_sel_hi:[1,1,1]
  v_pk_fma_f32 v[78:79], v[190:191], v[250:251], v[78:79] op_sel:[0,1,0] op_sel_hi:[1,1,1]
  v_cvt_pk_bf16_f32 v124, v72, v73
  v_cvt_pk_bf16_f32 v125, v74, v75
  v_cvt_pk_bf16_f32 v126, v76, v77
  v_cvt_pk_bf16_f32 v127, v78, v79
  ds_write_b128 v254, v[124:127]
  ds_read_b64_tr_b16 v[76:77], v255
  ds_read_b64_tr_b16 v[78:79], v255 offset:640
  s_add_u32 s13, s80, 0
  s_waitcnt lgkmcnt(3)
  buffer_store_dwordx4 v[68:71], v47, s[60:63], s13 offen sc1
  v_pk_fma_f32 v[80:81], v[104:105], v[252:253], v[80:81] op_sel:[0,0,0] op_sel_hi:[1,0,1]
  v_pk_fma_f32 v[82:83], v[106:107], v[252:253], v[82:83] op_sel:[0,0,0] op_sel_hi:[1,0,1]
  v_pk_fma_f32 v[84:85], v[108:109], v[252:253], v[84:85] op_sel:[0,0,0] op_sel_hi:[1,0,1]
  v_pk_fma_f32 v[86:87], v[110:111], v[252:253], v[86:87] op_sel:[0,0,0] op_sel_hi:[1,0,1]
  v_pk_fma_f32 v[80:81], v[112:113], v[252:253], v[80:81] op_sel:[0,1,0] op_sel_hi:[1,1,1]
  v_pk_fma_f32 v[82:83], v[114:115], v[252:253], v[82:83] op_sel:[0,1,0] op_sel_hi:[1,1,1]
  v_pk_fma_f32 v[84:85], v[116:117], v[252:253], v[84:85] op_sel:[0,1,0] op_sel_hi:[1,1,1]
  v_pk_fma_f32 v[86:87], v[118:119], v[252:253], v[86:87] op_sel:[0,1,0] op_sel_hi:[1,1,1]
  v_cvt_pk_bf16_f32 v120, v80, v81
  v_cvt_pk_bf16_f32 v121, v82, v83
  v_cvt_pk_bf16_f32 v122, v84, v85
  v_cvt_pk_bf16_f32 v123, v86, v87
  ds_write_b128 v254, v[120:123]
  ds_read_b64_tr_b16 v[84:85], v255
  ds_read_b64_tr_b16 v[86:87], v255 offset:640
  v_accvgpr_read_b32 v246, a204
  v_accvgpr_read_b32 v247, a205
  v_accvgpr_read_b32 v248, a206
  v_accvgpr_read_b32 v249, a207
  v_accvgpr_read_b32 v250, a208
  v_accvgpr_read_b32 v251, a209
  v_accvgpr_read_b32 v252, a210
  v_accvgpr_read_b32 v44, a211
  v_accvgpr_read_b32 v45, a212
  v_accvgpr_read_b32 v46, a213
  v_accvgpr_read_b32 v244, a214
  ds_read_b64 v[88:89], v247 offset:1536
  ds_read_b64 v[90:91], v247 offset:1024
  ds_read_b64 v[92:93], v247 offset:512
  ds_read_b64 v[94:95], v247 offset:0
  ds_read_b64 v[96:97], v248
  s_waitcnt lgkmcnt(5)
  s_bitcmp1_b32 s1, 0
  s_cbranch_scc1 type_36
  ds_read2_b32 v[156:157], v235 offset0:176 offset1:177
  ds_read2_b32 v[158:159], v235 offset0:178 offset1:179
  ds_read_b128 v[160:163], v240 offset:3776
  ds_read2_b32 v[152:153], v235 offset0:48 offset1:49
  ds_read2_b32 v[154:155], v235 offset0:50 offset1:51
  ds_read_b128 v[164:167], v240 offset:3264
  ds_read2_b32 v[148:149], v234 offset0:176 offset1:177
  ds_read2_b32 v[150:151], v234 offset0:178 offset1:179
  s_waitcnt lgkmcnt(5)
  v_mfma_f32_16x16x32_bf16 v[220:223], v[156:159], v[160:163], v[220:223]
  ds_read_b128 v[168:171], v240 offset:2752
  s_waitcnt lgkmcnt(4)
  v_mfma_f32_16x16x32_bf16 v[216:219], v[152:155], v[160:163], v[216:219]
  ds_read2_b32 v[144:145], v234 offset0:48 offset1:49
  ds_read2_b32 v[146:147], v234 offset0:50 offset1:51
  s_waitcnt lgkmcnt(5)
  v_mfma_f32_16x16x32_bf16 v[220:223], v[152:155], v[164:167], v[220:223]
  ds_read_b128 v[172:175], v240 offset:2240
  s_waitcnt lgkmcnt(4)
  v_mfma_f32_16x16x32_bf16 v[212:215], v[148:151], v[160:163], v[212:215]
  ds_read2_b32 v[140:141], v233 offset0:176 offset1:177
  ds_read2_b32 v[142:143], v233 offset0:178 offset1:179
  s_add_u32 s13, s81, 0
  buffer_store_dwordx4 v[76:79], v47, s[60:63], s13 offen sc1
  v_mfma_f32_16x16x32_bf16 v[216:219], v[148:151], v[164:167], v[216:219]
  ds_read_b128 v[176:179], v240 offset:1728
  s_waitcnt lgkmcnt(6)
  v_mfma_f32_16x16x32_bf16 v[220:223], v[148:151], v[168:171], v[220:223]
  ds_read2_b32 v[136:137], v233 offset0:48 offset1:49
  ds_read2_b32 v[138:139], v233 offset0:50 offset1:51
  s_waitcnt lgkmcnt(6)
  v_mfma_f32_16x16x32_bf16 v[208:211], v[144:147], v[160:163], v[208:211]
  ds_read_b128 v[180:183], v240 offset:1216
  v_mfma_f32_16x16x32_bf16 v[212:215], v[144:147], v[164:167], v[212:215]
  ds_read2_b32 v[132:133], v232 offset0:176 offset1:177
  ds_read2_b32 v[134:135], v232 offset0:178 offset1:179
  s_add_u32 s13, s82, 0
  buffer_store_dwordx4 v[84:87], v47, s[60:63], s13 offen sc1
  v_mfma_f32_16x16x32_bf16 v[216:219], v[144:147], v[168:171], v[216:219]
  s_waitcnt lgkmcnt(8)
  v_mfma_f32_16x16x32_bf16 v[220:223], v[144:147], v[172:175], v[220:223]
  s_waitcnt lgkmcnt(6)
  v_mfma_f32_16x16x32_bf16 v[204:207], v[140:143], v[160:163], v[204:207]
  v_mfma_f32_16x16x32_bf16 v[208:211], v[140:143], v[164:167], v[208:211]
  v_mfma_f32_16x16x32_bf16 v[212:215], v[140:143], v[168:171], v[212:215]
  buffer_load_dwordx4 a[152:155], v2, s[52:55], s34 offen offset:2048 sc1
  v_mfma_f32_16x16x32_bf16 v[216:219], v[140:143], v[172:175], v[216:219]
  ds_read_b128 v[184:187], v240 offset:704
  s_waitcnt lgkmcnt(6)
  v_mfma_f32_16x16x32_bf16 v[220:223], v[140:143], v[176:179], v[220:223]
  ds_read2_b32 v[128:129], v232 offset0:48 offset1:49
  ds_read2_b32 v[130:131], v232 offset0:50 offset1:51
  s_waitcnt lgkmcnt(6)
  v_mfma_f32_16x16x32_bf16 v[200:203], v[136:139], v[160:163], v[200:203]
  v_mfma_f32_16x16x32_bf16 v[204:207], v[136:139], v[164:167], v[204:207]
  buffer_load_dwordx4 a[156:159], v2, s[52:55], s34 offen offset:3072 sc1
  v_mfma_f32_16x16x32_bf16 v[208:211], v[136:139], v[168:171], v[208:211]
  v_mfma_f32_16x16x32_bf16 v[212:215], v[136:139], v[172:175], v[212:215]
  v_mfma_f32_16x16x32_bf16 v[216:219], v[136:139], v[176:179], v[216:219]
  s_waitcnt lgkmcnt(5)
  v_mfma_f32_16x16x32_bf16 v[220:223], v[136:139], v[180:183], v[220:223]
  s_add_u32 s34, s34, 4096
  buffer_load_dwordx4 a[160:163], v2, s[52:55], s34 offen offset:0 sc1
  s_waitcnt lgkmcnt(3)
  v_mfma_f32_16x16x32_bf16 v[196:199], v[132:135], v[160:163], v[196:199]
  ds_read_b128 v[188:191], v240 offset:192
  v_mfma_f32_16x16x32_bf16 v[200:203], v[132:135], v[164:167], v[200:203]
  ds_read2_b32 v[156:157], v239 offset0:128 offset1:129
  ds_read2_b32 v[158:159], v239 offset0:130 offset1:131
  v_mfma_f32_16x16x32_bf16 v[204:207], v[132:135], v[168:171], v[204:207]
  ds_read2_b32 v[152:153], v239 offset0:0 offset1:1
  ds_read2_b32 v[154:155], v239 offset0:2 offset1:3
  v_mfma_f32_16x16x32_bf16 v[208:211], v[132:135], v[172:175], v[208:211]
  ds_read2_b32 v[148:149], v238 offset0:128 offset1:129
  ds_read2_b32 v[150:151], v238 offset0:130 offset1:131
  v_mfma_f32_16x16x32_bf16 v[212:215], v[132:135], v[176:179], v[212:215]
  ds_read2_b32 v[144:145], v238 offset0:0 offset1:1
  ds_read2_b32 v[146:147], v238 offset0:2 offset1:3
  v_mfma_f32_16x16x32_bf16 v[216:219], v[132:135], v[180:183], v[216:219]
  buffer_load_dwordx4 a[164:167], v2, s[52:55], s34 offen offset:1024 sc1
  s_waitcnt lgkmcnt(11)
  v_mfma_f32_16x16x32_bf16 v[220:223], v[132:135], v[184:187], v[220:223]
  ds_read2_b32 v[140:141], v237 offset0:128 offset1:129
  ds_read2_b32 v[142:143], v237 offset0:130 offset1:131
  s_waitcnt lgkmcnt(11)
  v_mfma_f32_16x16x32_bf16 v[192:195], v[128:131], v[160:163], v[192:195]
  ds_read_b128 v[160:163], v241 offset:3584
  v_mfma_f32_16x16x32_bf16 v[196:199], v[128:131], v[164:167], v[196:199]
  ds_read_b128 v[164:167], v241 offset:3072
  v_mfma_f32_16x16x32_bf16 v[200:203], v[128:131], v[168:171], v[200:203]
  ds_read2_b32 v[136:137], v237 offset0:0 offset1:1
  ds_read2_b32 v[138:139], v237 offset0:2 offset1:3
  v_mfma_f32_16x16x32_bf16 v[204:207], v[128:131], v[172:175], v[204:207]
  ds_read_b128 v[168:171], v241 offset:2560
  buffer_load_dwordx4 a[168:171], v2, s[52:55], s34 offen offset:2048 sc1
  v_mfma_f32_16x16x32_bf16 v[208:211], v[128:131], v[176:179], v[208:211]
  ds_read_b128 v[172:175], v241 offset:2048
  v_mfma_f32_16x16x32_bf16 v[212:215], v[128:131], v[180:183], v[212:215]
  ds_read_b128 v[176:179], v241 offset:1536
  v_mfma_f32_16x16x32_bf16 v[216:219], v[128:131], v[184:187], v[216:219]
  ds_read2_b32 v[132:133], v236 offset0:128 offset1:129
  ds_read2_b32 v[134:135], v236 offset0:130 offset1:131
  s_waitcnt lgkmcnt(15)
  v_mfma_f32_16x16x32_bf16 v[220:223], v[128:131], v[188:191], v[220:223]
  ds_read_b128 v[180:183], v241 offset:1024
  buffer_load_dwordx4 a[172:175], v2, s[52:55], s34 offen offset:3072 sc1
  s_waitcnt vmcnt(6)
  s_add_u32 s14, s84, 4352
  v_mov_b32 v15, s8
  s_mov_b64 exec, 1
  s_cmp_eq_u32 s9, 0
  s_cbranch_scc1 slow_38
  buffer_store_dword v15, off, s[52:55], s14
back_39:
  s_mov_b64 exec, -1
  s_waitcnt lgkmcnt(9)
  v_mfma_f32_16x16x32_bf16 v[116:119], v[156:159], v[160:163], 0
  ds_read_b128 v[184:187], v241 offset:512
  s_waitcnt lgkmcnt(9)
  v_mfma_f32_16x16x32_bf16 v[116:119], v[152:155], v[164:167], v[116:119]
  ds_read2_b32 v[128:129], v236 offset0:0 offset1:1
  ds_read2_b32 v[130:131], v236 offset0:2 offset1:3
  s_waitcnt lgkmcnt(8)
  v_mfma_f32_16x16x32_bf16 v[116:119], v[148:151], v[168:171], v[116:119]
  v_mfma_f32_16x16x32_bf16 v[112:115], v[144:147], v[160:163], 0
  ds_read_b128 v[188:191], v241 offset:0
  s_waitcnt lgkmcnt(8)
  v_mfma_f32_16x16x32_bf16 v[116:119], v[144:147], v[172:175], v[116:119]
  ds_read2_b32 v[156:157], v239 offset0:144 offset1:145
  ds_read2_b32 v[158:159], v239 offset0:146 offset1:147
  v_mfma_f32_16x16x32_bf16 v[112:115], v[140:143], v[164:167], v[112:115]
  ds_read2_b32 v[152:153], v239 offset0:16 offset1:17
  ds_read2_b32 v[154:155], v239 offset0:18 offset1:19
  s_waitcnt lgkmcnt(11)
  v_mfma_f32_16x16x32_bf16 v[116:119], v[140:143], v[176:179], v[116:119]
  ds_read2_b32 v[148:149], v238 offset0:144 offset1:145
  ds_read2_b32 v[150:151], v238 offset0:146 offset1:147
  v_mfma_f32_16x16x32_bf16 v[108:111], v[136:139], v[160:163], 0
  ds_read2_b32 v[144:145], v238 offset0:16 offset1:17
  ds_read2_b32 v[146:147], v238 offset0:18 offset1:19
  s_add_u32 s34, s34, 4096
  buffer_load_dwordx4 a[176:179], v2, s[52:55], s34 offen offset:0 sc1
  s_bitcmp0_b32 s7, 0
  s_cbranch_scc1 skip_40
  v_swap_b32 v192, v208
  v_swap_b32 v193, v209
  v_swap_b32 v194, v210
  v_swap_b32 v195, v211
  v_swap_b32 v196, v212
  v_swap_b32 v197, v213
  v_swap_b32 v198, v214
  v_swap_b32 v199, v215
  v_swap_b32 v200, v216
  v_swap_b32 v201, v217
  v_swap_b32 v202, v218
  v_swap_b32 v203, v219
  v_swap_b32 v204, v220
  v_swap_b32 v205, v221
  v_swap_b32 v206, v222
  v_swap_b32 v207, v223
skip_40:
  v_mfma_f32_16x16x32_bf16 v[112:115], v[136:139], v[168:171], v[112:115]
  buffer_load_dwordx4 a[180:183], v2, s[52:55], s34 offen offset:1024 sc1
  s_waitcnt lgkmcnt(12)
  v_mfma_f32_16x16x32_bf16 v[116:119], v[136:139], v[180:183], v[116:119]
  ds_read2_b32 v[140:141], v237 offset0:144 offset1:145
  ds_read2_b32 v[142:143], v237 offset0:146 offset1:147
  v_mfma_f32_16x16x32_bf16 v[104:107], v[132:135], v[160:163], 0
  ds_read_b128 v[160:163], v241 offset:3648
  v_mfma_f32_16x16x32_bf16 v[108:111], v[132:135], v[164:167], v[108:111]
  ds_read2_b32 v[136:137], v237 offset0:16 offset1:17
  ds_read2_b32 v[138:139], v237 offset0:18 offset1:19
  ds_write_b128 v249, v[208:211] offset:0
  v_mfma_f32_16x16x32_bf16 v[112:115], v[132:135], v[172:175], v[112:115]
  ds_read_b128 v[172:175], v241 offset:2112
  s_waitcnt lgkmcnt(15)
  v_mfma_f32_16x16x32_bf16 v[116:119], v[132:135], v[184:187], v[116:119]
  ds_read_b128 v[180:183], v241 offset:1088
  v_mfma_f32_16x16x32_bf16 v[104:107], v[128:131], v[164:167], v[104:107]
  ds_read_b128 v[164:167], v241 offset:3136
  v_mfma_f32_16x16x32_bf16 v[108:111], v[128:131], v[168:171], v[108:111]
  ds_read2_b32 v[132:133], v236 offset0:144 offset1:145
  ds_read2_b32 v[134:135], v236 offset0:146 offset1:147
  buffer_load_dwordx4 a[184:187], v2, s[52:55], s34 offen offset:2048 sc1
  ds_write_b128 v249, v[212:215] offset:1024
  s_mov_b32 s92, 24576
  buffer_load_dwordx4 v[120:123], v2, s[52:55], s92 offen sc1
  v_mfma_f32_16x16x32_bf16 v[112:115], v[128:131], v[176:179], v[112:115]
  ds_read_b128 v[168:171], v241 offset:2624
  v_mfma_f32_16x16x32_bf16 v[116:119], v[128:131], v[188:191], v[116:119]
  ds_read_b128 v[176:179], v241 offset:1600
  s_waitcnt lgkmcnt(11)
  v_mfma_f32_16x16x32_bf16 v[116:119], v[156:159], v[160:163], v[116:119]
  ds_read_b128 v[184:187], v241 offset:576
  s_waitcnt lgkmcnt(6)
  v_mfma_f32_16x16x32_bf16 v[116:119], v[152:155], v[164:167], v[116:119]
  ds_read2_b32 v[128:129], v236 offset0:16 offset1:17
  ds_read2_b32 v[130:131], v236 offset0:18 offset1:19
  buffer_load_dwordx4 a[188:191], v2, s[52:55], s34 offen offset:3072 sc1
  ds_write_b128 v249, v[216:219] offset:2048
  s_barrier
  s_waitcnt lgkmcnt(5)
  v_mfma_f32_16x16x32_bf16 v[116:119], v[148:151], v[168:171], v[116:119]
  s_add_u32 s34, s34, 4096
  buffer_load_dwordx4 a[192:195], v2, s[52:55], s34 offen offset:0 sc1
  v_mfma_f32_16x16x32_bf16 v[112:115], v[144:147], v[160:163], v[112:115]
  ds_read_b128 v[188:191], v241 offset:64
  v_mfma_f32_16x16x32_bf16 v[116:119], v[144:147], v[172:175], v[116:119]
  ds_write_b128 v249, v[220:223] offset:3072
  v_mfma_f32_16x16x32_bf16 v[112:115], v[140:143], v[164:167], v[112:115]
  s_waitcnt lgkmcnt(6)
  v_mfma_f32_16x16x32_bf16 v[116:119], v[140:143], v[176:179], v[116:119]
  buffer_load_dwordx4 a[196:199], v2, s[52:55], s34 offen offset:1024 sc1
  v_mfma_f32_16x16x32_bf16 v[108:111], v[136:139], v[160:163], v[108:111]
  buffer_load_dwordx2 v[42:43], v244, s[52:55], s49 offen sc1
  v_mfma_f32_16x16x32_bf16 v[112:115], v[136:139], v[168:171], v[112:115]
  v_mfma_f32_16x16x32_bf16 v[116:119], v[136:139], v[180:183], v[116:119]
  v_mfma_f32_16x16x32_bf16 v[104:107], v[132:135], v[160:163], v[104:107]
  v_mfma_f32_16x16x32_bf16 v[108:111], v[132:135], v[164:167], v[108:111]
  v_mfma_f32_16x16x32_bf16 v[112:115], v[132:135], v[172:175], v[112:115]
  s_waitcnt lgkmcnt(5)
  v_mfma_f32_16x16x32_bf16 v[116:119], v[132:135], v[184:187], v[116:119]
  s_waitcnt lgkmcnt(3)
  v_mfma_f32_16x16x32_bf16 v[104:107], v[128:131], v[164:167], v[104:107]
  v_mfma_f32_16x16x32_bf16 v[108:111], v[128:131], v[168:171], v[108:111]
  v_mfma_f32_16x16x32_bf16 v[112:115], v[128:131], v[176:179], v[112:115]
  s_waitcnt lgkmcnt(1)
  v_mfma_f32_16x16x32_bf16 v[116:119], v[128:131], v[188:191], v[116:119]
  s_branch join_37
type_36:
  ds_read2_b32 v[156:157], v235 offset0:176 offset1:177
  ds_read2_b32 v[158:159], v235 offset0:178 offset1:179
  ds_read_b128 v[160:163], v240 offset:3776
  ds_read2_b32 v[152:153], v235 offset0:48 offset1:49
  ds_read2_b32 v[154:155], v235 offset0:50 offset1:51
  ds_read_b128 v[164:167], v240 offset:3264
  ds_read2_b32 v[148:149], v234 offset0:176 offset1:177
  ds_read2_b32 v[150:151], v234 offset0:178 offset1:179
  s_waitcnt lgkmcnt(5)
  v_mfma_f32_16x16x32_bf16 v[220:223], v[156:159], v[160:163], v[220:223]
  ds_read_b128 v[168:171], v240 offset:2752
  s_waitcnt lgkmcnt(4)
  v_mfma_f32_16x16x32_bf16 v[216:219], v[152:155], v[160:163], v[216:219]
  ds_read2_b32 v[144:145], v234 offset0:48 offset1:49
  ds_read2_b32 v[146:147], v234 offset0:50 offset1:51
  s_waitcnt lgkmcnt(5)
  v_mfma_f32_16x16x32_bf16 v[220:223], v[152:155], v[164:167], v[220:223]
  ds_read_b128 v[172:175], v240 offset:2240
  s_waitcnt lgkmcnt(4)
  v_mfma_f32_16x16x32_bf16 v[212:215], v[148:151], v[160:163], v[212:215]
  ds_read2_b32 v[140:141], v233 offset0:176 offset1:177
  ds_read2_b32 v[142:143], v233 offset0:178 offset1:179
  s_add_u32 s13, s81, 0
  buffer_store_dwordx4 v[76:79], v47, s[60:63], s13 offen sc1
  v_mfma_f32_16x16x32_bf16 v[216:219], v[148:151], v[164:167], v[216:219]
  ds_read_b128 v[176:179], v240 offset:1728
  s_waitcnt lgkmcnt(6)
  v_mfma_f32_16x16x32_bf16 v[220:223], v[148:151], v[168:171], v[220:223]
  ds_read2_b32 v[136:137], v233 offset0:48 offset1:49
  ds_read2_b32 v[138:139], v233 offset0:50 offset1:51
  s_waitcnt lgkmcnt(6)
  v_mfma_f32_16x16x32_bf16 v[208:211], v[144:147], v[160:163], v[208:211]
  ds_read_b128 v[180:183], v240 offset:1216
  v_mfma_f32_16x16x32_bf16 v[212:215], v[144:147], v[164:167], v[212:215]
  ds_read2_b32 v[132:133], v232 offset0:176 offset1:177
  ds_read2_b32 v[134:135], v232 offset0:178 offset1:179
  s_add_u32 s13, s82, 0
  buffer_store_dwordx4 v[84:87], v47, s[60:63], s13 offen sc1
  v_mfma_f32_16x16x32_bf16 v[216:219], v[144:147], v[168:171], v[216:219]
  s_waitcnt lgkmcnt(8)
  v_mfma_f32_16x16x32_bf16 v[220:223], v[144:147], v[172:175], v[220:223]
  s_waitcnt lgkmcnt(6)
  v_mfma_f32_16x16x32_bf16 v[204:207], v[140:143], v[160:163], v[204:207]
  v_mfma_f32_16x16x32_bf16 v[208:211], v[140:143], v[164:167], v[208:211]
  v_mfma_f32_16x16x32_bf16 v[212:215], v[140:143], v[168:171], v[212:215]
  buffer_load_dwordx4 a[152:155], v2, s[52:55], s34 offen offset:2048 sc1
  v_mfma_f32_16x16x32_bf16 v[216:219], v[140:143], v[172:175], v[216:219]
  ds_read_b128 v[184:187], v240 offset:704
  s_waitcnt lgkmcnt(6)
  v_mfma_f32_16x16x32_bf16 v[220:223], v[140:143], v[176:179], v[220:223]
  ds_read2_b32 v[128:129], v232 offset0:48 offset1:49
  ds_read2_b32 v[130:131], v232 offset0:50 offset1:51
  s_waitcnt lgkmcnt(6)
  v_mfma_f32_16x16x32_bf16 v[200:203], v[136:139], v[160:163], v[200:203]
  v_mfma_f32_16x16x32_bf16 v[204:207], v[136:139], v[164:167], v[204:207]
  buffer_load_dwordx4 a[156:159], v2, s[52:55], s34 offen offset:3072 sc1
  v_mfma_f32_16x16x32_bf16 v[208:211], v[136:139], v[168:171], v[208:211]
  v_mfma_f32_16x16x32_bf16 v[212:215], v[136:139], v[172:175], v[212:215]
  v_mfma_f32_16x16x32_bf16 v[216:219], v[136:139], v[176:179], v[216:219]
  s_waitcnt lgkmcnt(5)
  v_mfma_f32_16x16x32_bf16 v[220:223], v[136:139], v[180:183], v[220:223]
  s_add_u32 s34, s34, 4096
  buffer_load_dwordx4 a[160:163], v2, s[52:55], s34 offen offset:0 sc1
  s_waitcnt lgkmcnt(3)
  v_mfma_f32_16x16x32_bf16 v[196:199], v[132:135], v[160:163], v[196:199]
  ds_read_b128 v[188:191], v240 offset:192
  v_mfma_f32_16x16x32_bf16 v[200:203], v[132:135], v[164:167], v[200:203]
  ds_read2_b32 v[152:153], v239 offset0:0 offset1:1
  ds_read2_b32 v[154:155], v239 offset0:2 offset1:3
  v_mfma_f32_16x16x32_bf16 v[204:207], v[132:135], v[168:171], v[204:207]
  ds_read2_b32 v[148:149], v238 offset0:128 offset1:129
  ds_read2_b32 v[150:151], v238 offset0:130 offset1:131
  v_mfma_f32_16x16x32_bf16 v[208:211], v[132:135], v[172:175], v[208:211]
  buffer_load_dwordx4 a[164:167], v2, s[52:55], s34 offen offset:1024 sc1
  v_mfma_f32_16x16x32_bf16 v[212:215], v[132:135], v[176:179], v[212:215]
  ds_read2_b32 v[144:145], v238 offset0:0 offset1:1
  ds_read2_b32 v[146:147], v238 offset0:2 offset1:3
  v_mfma_f32_16x16x32_bf16 v[216:219], v[132:135], v[180:183], v[216:219]
  s_waitcnt lgkmcnt(9)
  v_mfma_f32_16x16x32_bf16 v[220:223], v[132:135], v[184:187], v[220:223]
  ds_read2_b32 v[140:141], v237 offset0:128 offset1:129
  ds_read2_b32 v[142:143], v237 offset0:130 offset1:131
  s_waitcnt lgkmcnt(9)
  v_mfma_f32_16x16x32_bf16 v[192:195], v[128:131], v[160:163], v[192:195]
  ds_read_b128 v[160:163], v241 offset:3584
  v_mfma_f32_16x16x32_bf16 v[196:199], v[128:131], v[164:167], v[196:199]
  ds_read_b128 v[164:167], v241 offset:3072
  v_mfma_f32_16x16x32_bf16 v[200:203], v[128:131], v[168:171], v[200:203]
  ds_read_b128 v[168:171], v241 offset:2560
  v_mfma_f32_16x16x32_bf16 v[204:207], v[128:131], v[172:175], v[204:207]
  ds_read2_b32 v[136:137], v237 offset0:0 offset1:1
  ds_read2_b32 v[138:139], v237 offset0:2 offset1:3
  buffer_load_dwordx4 a[168:171], v2, s[52:55], s34 offen offset:2048 sc1
  v_mfma_f32_16x16x32_bf16 v[208:211], v[128:131], v[176:179], v[208:211]
  ds_read_b128 v[172:175], v241 offset:2048
  v_mfma_f32_16x16x32_bf16 v[212:215], v[128:131], v[180:183], v[212:215]
  ds_read_b128 v[176:179], v241 offset:1536
  v_mfma_f32_16x16x32_bf16 v[216:219], v[128:131], v[184:187], v[216:219]
  ds_read2_b32 v[132:133], v236 offset0:128 offset1:129
  ds_read2_b32 v[134:135], v236 offset0:130 offset1:131
  s_waitcnt lgkmcnt(15)
  v_mfma_f32_16x16x32_bf16 v[220:223], v[128:131], v[188:191], v[220:223]
  ds_read_b128 v[180:183], v241 offset:1024
  buffer_load_dwordx4 a[172:175], v2, s[52:55], s34 offen offset:3072 sc1
  s_waitcnt vmcnt(6)
  s_add_u32 s14, s84, 4352
  v_mov_b32 v15, s8
  s_mov_b64 exec, 1
  s_cmp_eq_u32 s9, 0
  s_cbranch_scc1 slow_41
  buffer_store_dword v15, off, s[52:55], s14
back_42:
  s_mov_b64 exec, -1
  s_waitcnt lgkmcnt(9)
  v_mfma_f32_16x16x32_bf16 v[116:119], v[152:155], v[160:163], 0
  ds_read2_b32 v[128:129], v236 offset0:0 offset1:1
  ds_read2_b32 v[130:131], v236 offset0:2 offset1:3
  v_mfma_f32_16x16x32_bf16 v[112:115], v[148:151], v[160:163], 0
  s_waitcnt lgkmcnt(10)
  v_mfma_f32_16x16x32_bf16 v[116:119], v[148:151], v[164:167], v[116:119]
  v_mfma_f32_16x16x32_bf16 v[112:115], v[144:147], v[164:167], v[112:115]
  ds_read_b128 v[184:187], v241 offset:512
  s_waitcnt lgkmcnt(10)
  v_mfma_f32_16x16x32_bf16 v[116:119], v[144:147], v[168:171], v[116:119]
  ds_read2_b32 v[152:153], v239 offset0:16 offset1:17
  ds_read2_b32 v[154:155], v239 offset0:18 offset1:19
  v_mfma_f32_16x16x32_bf16 v[108:111], v[140:143], v[160:163], 0
  ds_read2_b32 v[148:149], v238 offset0:144 offset1:145
  ds_read2_b32 v[150:151], v238 offset0:146 offset1:147
  v_mfma_f32_16x16x32_bf16 v[112:115], v[140:143], v[168:171], v[112:115]
  s_add_u32 s34, s34, 4096
  buffer_load_dwordx4 a[176:179], v2, s[52:55], s34 offen offset:0 sc1
  s_waitcnt lgkmcnt(11)
  v_mfma_f32_16x16x32_bf16 v[116:119], v[140:143], v[172:175], v[116:119]
  ds_read2_b32 v[144:145], v238 offset0:16 offset1:17
  ds_read2_b32 v[146:147], v238 offset0:18 offset1:19
  s_bitcmp0_b32 s7, 0
  s_cbranch_scc1 skip_43
  v_swap_b32 v192, v208
  v_swap_b32 v193, v209
  v_swap_b32 v194, v210
  v_swap_b32 v195, v211
  v_swap_b32 v196, v212
  v_swap_b32 v197, v213
  v_swap_b32 v198, v214
  v_swap_b32 v199, v215
  v_swap_b32 v200, v216
  v_swap_b32 v201, v217
  v_swap_b32 v202, v218
  v_swap_b32 v203, v219
  v_swap_b32 v204, v220
  v_swap_b32 v205, v221
  v_swap_b32 v206, v222
  v_swap_b32 v207, v223
skip_43:
  v_mfma_f32_16x16x32_bf16 v[108:111], v[136:139], v[164:167], v[108:111]
  ds_read_b128 v[164:167], v241 offset:3136
  v_mfma_f32_16x16x32_bf16 v[112:115], v[136:139], v[172:175], v[112:115]
  ds_read2_b32 v[140:141], v237 offset0:144 offset1:145
  ds_read2_b32 v[142:143], v237 offset0:146 offset1:147
  s_waitcnt lgkmcnt(15)
  v_mfma_f32_16x16x32_bf16 v[116:119], v[136:139], v[176:179], v[116:119]
  buffer_load_dwordx4 a[180:183], v2, s[52:55], s34 offen offset:1024 sc1
  s_waitcnt lgkmcnt(13)
  v_mfma_f32_16x16x32_bf16 v[108:111], v[132:135], v[168:171], v[108:111]
  ds_read_b128 v[168:171], v241 offset:2624
  ds_write_b128 v249, v[208:211] offset:0
  v_mfma_f32_16x16x32_bf16 v[112:115], v[132:135], v[176:179], v[112:115]
  ds_read2_b32 v[136:137], v237 offset0:16 offset1:17
  ds_read2_b32 v[138:139], v237 offset0:18 offset1:19
  s_waitcnt lgkmcnt(15)
  v_mfma_f32_16x16x32_bf16 v[116:119], v[132:135], v[180:183], v[116:119]
  buffer_load_dwordx4 a[184:187], v2, s[52:55], s34 offen offset:2048 sc1
  s_waitcnt lgkmcnt(14)
  v_mfma_f32_16x16x32_bf16 v[104:107], v[128:131], v[160:163], 0
  ds_read_b128 v[160:163], v241 offset:3648
  v_mfma_f32_16x16x32_bf16 v[108:111], v[128:131], v[172:175], v[108:111]
  ds_read_b128 v[176:179], v241 offset:1600
  ds_write_b128 v249, v[212:215] offset:1024
  s_mov_b32 s92, 24576
  buffer_load_dwordx4 v[120:123], v2, s[52:55], s92 offen sc1
  v_mfma_f32_16x16x32_bf16 v[112:115], v[128:131], v[180:183], v[112:115]
  ds_read_b128 v[172:175], v241 offset:2112
  s_waitcnt lgkmcnt(15)
  v_mfma_f32_16x16x32_bf16 v[116:119], v[128:131], v[184:187], v[116:119]
  ds_read2_b32 v[132:133], v236 offset0:144 offset1:145
  ds_read2_b32 v[134:135], v236 offset0:146 offset1:147
  s_waitcnt lgkmcnt(5)
  v_mfma_f32_16x16x32_bf16 v[116:119], v[152:155], v[160:163], v[116:119]
  ds_read_b128 v[180:183], v241 offset:1088
  v_mfma_f32_16x16x32_bf16 v[112:115], v[148:151], v[160:163], v[112:115]
  ds_read2_b32 v[128:129], v236 offset0:16 offset1:17
  ds_read2_b32 v[130:131], v236 offset0:18 offset1:19
  buffer_load_dwordx4 a[188:191], v2, s[52:55], s34 offen offset:3072 sc1
  ds_write_b128 v249, v[216:219] offset:2048
  s_barrier
  v_mfma_f32_16x16x32_bf16 v[116:119], v[148:151], v[164:167], v[116:119]
  s_add_u32 s34, s34, 4096
  buffer_load_dwordx4 a[192:195], v2, s[52:55], s34 offen offset:0 sc1
  v_mfma_f32_16x16x32_bf16 v[112:115], v[144:147], v[164:167], v[112:115]
  ds_read_b128 v[184:187], v241 offset:576
  v_mfma_f32_16x16x32_bf16 v[116:119], v[144:147], v[168:171], v[116:119]
  ds_write_b128 v249, v[220:223] offset:3072
  v_mfma_f32_16x16x32_bf16 v[108:111], v[140:143], v[160:163], v[108:111]
  v_mfma_f32_16x16x32_bf16 v[112:115], v[140:143], v[168:171], v[112:115]
  buffer_load_dwordx4 a[196:199], v2, s[52:55], s34 offen offset:1024 sc1
  s_waitcnt lgkmcnt(8)
  v_mfma_f32_16x16x32_bf16 v[116:119], v[140:143], v[172:175], v[116:119]
  buffer_load_dwordx2 v[42:43], v244, s[52:55], s49 offen sc1
  v_mfma_f32_16x16x32_bf16 v[108:111], v[136:139], v[164:167], v[108:111]
  v_mfma_f32_16x16x32_bf16 v[112:115], v[136:139], v[172:175], v[112:115]
  v_mfma_f32_16x16x32_bf16 v[116:119], v[136:139], v[176:179], v[116:119]
  s_waitcnt lgkmcnt(6)
  v_mfma_f32_16x16x32_bf16 v[108:111], v[132:135], v[168:171], v[108:111]
  v_mfma_f32_16x16x32_bf16 v[112:115], v[132:135], v[176:179], v[112:115]
  s_waitcnt lgkmcnt(5)
  v_mfma_f32_16x16x32_bf16 v[116:119], v[132:135], v[180:183], v[116:119]
  s_waitcnt lgkmcnt(3)
  v_mfma_f32_16x16x32_bf16 v[104:107], v[128:131], v[160:163], v[104:107]
  v_mfma_f32_16x16x32_bf16 v[108:111], v[128:131], v[172:175], v[108:111]
  v_mfma_f32_16x16x32_bf16 v[112:115], v[128:131], v[180:183], v[112:115]
  s_waitcnt lgkmcnt(1)
  v_mfma_f32_16x16x32_bf16 v[116:119], v[128:131], v[184:187], v[116:119]
join_37:
  s_nop 3
  ds_write_b128 v252, v[104:107] offset:0
  ds_write_b128 v252, v[108:111] offset:1024
  ds_write_b128 v252, v[112:115] offset:2048
  s_nop 0
  ds_write_b128 v252, v[116:119] offset:3072
  v_dot2_f32_bf16 v192, v89, s31, v192
  v_dot2_f32_bf16 v193, v89, s30, v193
  v_dot2_f32_bf16 v194, v88, s31, v194
  v_dot2_f32_bf16 v195, v88, s30, v195
  v_dot2_f32_bf16 v196, v91, s31, v196
  v_dot2_f32_bf16 v197, v91, s30, v197
  v_dot2_f32_bf16 v198, v90, s31, v198
  v_dot2_f32_bf16 v199, v90, s30, v199
  v_dot2_f32_bf16 v200, v93, s31, v200
  v_dot2_f32_bf16 v201, v93, s30, v201
  v_dot2_f32_bf16 v202, v92, s31, v202
  v_dot2_f32_bf16 v203, v92, s30, v203
  v_dot2_f32_bf16 v204, v95, s31, v204
  v_dot2_f32_bf16 v205, v95, s30, v205
  v_dot2_f32_bf16 v206, v94, s31, v206
  v_dot2_f32_bf16 v207, v94, s30, v207
  s_waitcnt vmcnt(4)
  v_min3_u32 v15, v120, v121, s8
  v_max3_u32 v14, v120, v121, s8
  v_min3_u32 v15, v15, v122, v123
  v_max3_u32 v14, v14, v122, v123
  v_cmp_ne_u32 vcc, v15, v14
  s_cbranch_vccnz again_44
ok_45:
  s_waitcnt vmcnt(0)
  v_xor_b32 v15, s8, v42
  v_xor_b32 v14, s8, v43
  v_or_b32 v15, v15, v14
  v_cmp_ne_u32 vcc, 0, v15
  s_cbranch_vccz ok_47
again_46:
  buffer_load_dwordx2 v[42:43], v244, s[52:55], s49 offen sc1
  s_sub_u32 s10, s10, 1
  s_cmp_gt_i32 s10, 0
  s_waitcnt vmcnt(0)
  v_xor_b32 v15, s8, v42
  v_xor_b32 v14, s8, v43
  v_or_b32 v15, v15, v14
  v_cmp_ne_u32 vcc, 0, v15
  s_cbranch_scc0 out_48
  s_cbranch_vccnz again_46
out_48:
ok_47:
  buffer_load_dwordx4 v[128:131], v2, s[60:63], s16 offen offset:0 sc1
  buffer_load_dwordx4 v[132:135], v2, s[60:63], s16 offen offset:1024 sc1
  buffer_load_dwordx4 v[136:139], v2, s[60:63], s16 offen offset:2048 sc1
  buffer_load_dwordx4 v[140:143], v2, s[60:63], s16 offen offset:3072 sc1
  s_add_u32 s16, s16, 4096
  buffer_load_dwordx4 v[144:147], v2, s[60:63], s16 offen offset:0 sc1
  buffer_load_dwordx4 v[148:151], v2, s[60:63], s16 offen offset:1024 sc1
  buffer_load_dwordx4 v[152:155], v2, s[60:63], s16 offen offset:2048 sc1
  buffer_load_dwordx4 v[156:159], v2, s[60:63], s16 offen offset:3072 sc1
  s_waitcnt lgkmcnt(0)
  s_barrier
  ds_read_b128 v[208:211], v250 offset:0
  ds_read_b128 v[212:215], v250 offset:1024
  ds_read_b128 v[216:219], v250 offset:2048
  ds_read_b128 v[220:223], v250 offset:3072
  ds_read_b128 v[224:227], v251 offset:0
  ds_read_b128 v[228:231], v251 offset:4096
  ds_read_b128 v[232:235], v251 offset:8192
  ds_read_b128 v[236:239], v251 offset:12288
  s_waitcnt vmcnt(7)
  v_mfma_f32_16x16x32_bf16 v[48:51], a[0:3], v[128:131], 0
  s_add_u32 s16, s16, 4096
  buffer_load_dwordx4 v[160:163], v2, s[60:63], s16 offen offset:0 sc1
  s_waitcnt lgkmcnt(0)
  v_mfma_f32_16x16x32_bf16 v[52:55], a[4:7], v[128:131], 0
  v_add_f32 v208, v192, v208
  v_add_f32 v209, v193, v209
  v_mfma_f32_16x16x32_bf16 v[56:59], a[8:11], v[128:131], 0
  v_add_f32 v210, v194, v210
  v_add_f32 v211, v195, v211
  v_mfma_f32_16x16x32_bf16 v[60:63], a[12:15], v[128:131], 0
  v_cvt_pk_bf16_f32 v208, v208, v209
  v_cvt_pk_bf16_f32 v209, v210, v211
  v_mfma_f32_16x16x32_bf16 v[64:67], a[16:19], v[128:131], 0
  buffer_store_dwordx2 v[208:209], v246, s[52:55], s50 offen offset:0 sc1
  s_waitcnt vmcnt(8)
  v_mfma_f32_16x16x32_bf16 v[48:51], a[20:23], v[132:135], v[48:51]
  buffer_load_dwordx4 v[164:167], v2, s[60:63], s16 offen offset:1024 sc1
  v_add_f32 v212, v196, v212
  v_mfma_f32_16x16x32_bf16 v[52:55], a[24:27], v[132:135], v[52:55]
  v_add_f32 v213, v197, v213
  v_add_f32 v214, v198, v214
  v_mfma_f32_16x16x32_bf16 v[56:59], a[28:31], v[132:135], v[56:59]
  v_add_f32_e64 v215, v199, v215
  v_cvt_pk_bf16_f32 v212, v212, v213
  v_mfma_f32_16x16x32_bf16 v[60:63], a[32:35], v[132:135], v[60:63]
  v_cvt_pk_bf16_f32 v213, v214, v215
  buffer_store_dwordx2 v[212:213], v246, s[52:55], s50 offen offset:512 sc1
  v_mfma_f32_16x16x32_bf16 v[64:67], a[36:39], v[132:135], v[64:67]
  v_add_f32 v216, v200, v216
  s_waitcnt vmcnt(9)
  v_mfma_f32_16x16x32_bf16 v[48:51], a[40:43], v[136:139], v[48:51]
  buffer_load_dwordx4 v[168:171], v2, s[60:63], s17 offen offset:0 sc1
  v_add_f32_e64 v217, v201, v217
  v_mfma_f32_16x16x32_bf16 v[52:55], a[44:47], v[136:139], v[52:55]
  v_add_f32 v218, v202, v218
  v_add_f32 v219, v203, v219
  v_mfma_f32_16x16x32_bf16 v[56:59], a[48:51], v[136:139], v[56:59]
  v_cvt_pk_bf16_f32 v216, v216, v217
  v_cvt_pk_bf16_f32 v217, v218, v219
  v_mfma_f32_16x16x32_bf16 v[60:63], a[52:55], v[136:139], v[60:63]
  buffer_store_dwordx2 v[216:217], v246, s[52:55], s50 offen offset:1024 sc1
  v_add_f32_e64 v220, v204, v220
  v_mfma_f32_16x16x32_bf16 v[64:67], a[56:59], v[136:139], v[64:67]
  v_add_f32 v221, v205, v221
  s_waitcnt vmcnt(10)
  v_mfma_f32_16x16x32_bf16 v[48:51], a[60:63], v[140:143], v[48:51]
  buffer_load_dwordx4 v[172:175], v2, s[60:63], s17 offen offset:1024 sc1
  v_add_f32_e64 v222, v206, v222
  v_mfma_f32_16x16x32_bf16 v[52:55], a[64:67], v[140:143], v[52:55]
  v_add_f32_e64 v223, v207, v223
  v_cvt_pk_bf16_f32 v220, v220, v221
  v_mfma_f32_16x16x32_bf16 v[56:59], a[68:71], v[140:143], v[56:59]
  v_cvt_pk_bf16_f32 v221, v222, v223
  buffer_store_dwordx2 v[220:221], v246, s[52:55], s50 offen offset:1536 sc1
  v_mfma_f32_16x16x32_bf16 v[60:63], a[72:75], v[140:143], v[60:63]
  v_dot2_f32_bf16 v224, v97, s45, v224
  v_dot2_f32_bf16 v225, v97, s25, v225
  v_mfma_f32_16x16x32_bf16 v[64:67], a[76:79], v[140:143], v[64:67]
  v_dot2_f32_bf16 v226, v96, s45, v226
  s_waitcnt vmcnt(11)
  v_mfma_f32_16x16x32_bf16 v[48:51], a[80:83], v[144:147], v[48:51]
  buffer_load_dwordx4 v[176:179], v2, s[60:63], s17 offen offset:2048 sc1
  v_dot2_f32_bf16 v227, v96, s25, v227
  v_mfma_f32_16x16x32_bf16 v[52:55], a[84:87], v[144:147], v[52:55]
  v_add_f32 v228, v228, v232
  v_add_f32_e64 v229, v229, v233
  v_mfma_f32_16x16x32_bf16 v[56:59], a[88:91], v[144:147], v[56:59]
  v_add_f32 v230, v230, v234
  v_add_f32 v231, v231, v235
  v_mfma_f32_16x16x32_bf16 v[60:63], a[92:95], v[144:147], v[60:63]
  v_add_f32 v224, v224, v236
  v_add_f32 v225, v225, v237
  v_mfma_f32_16x16x32_bf16 v[64:67], a[96:99], v[144:147], v[64:67]
  v_add_f32 v226, v226, v238
  s_waitcnt vmcnt(11)
  v_mfma_f32_16x16x32_bf16 v[48:51], a[100:103], v[148:151], v[48:51]
  buffer_load_dwordx4 v[180:183], v2, s[60:63], s17 offen offset:3072 sc1
  v_add_f32_e64 v227, v227, v239
  v_mfma_f32_16x16x32_bf16 v[52:55], a[104:107], v[148:151], v[52:55]
  v_add_f32 v224, v224, v228
  v_add_f32 v225, v225, v229
  v_mfma_f32_16x16x32_bf16 v[56:59], a[108:111], v[148:151], v[56:59]
  v_add_f32 v226, v226, v230
  v_add_f32 v227, v227, v231
  v_mfma_f32_16x16x32_bf16 v[60:63], a[112:115], v[148:151], v[60:63]
  v_cvt_pk_bf16_f32 v224, v224, v225
  v_cvt_pk_bf16_f32 v225, v226, v227
  v_mfma_f32_16x16x32_bf16 v[64:67], a[116:119], v[148:151], v[64:67]
  buffer_store_dwordx2 v[224:225], v246, s[52:55], s51 offen sc1
  s_waitcnt vmcnt(12)
  v_mfma_f32_16x16x32_bf16 v[48:51], a[120:123], v[152:155], v[48:51]
  s_add_u32 s17, s17, 4096
  buffer_load_dwordx4 v[184:187], v2, s[60:63], s17 offen offset:0 sc1
  s_barrier
  v_mfma_f32_16x16x32_bf16 v[52:55], a[124:127], v[152:155], v[52:55]
  v_accvgpr_read_b32 v102, a226
  v_accvgpr_read_b32 v103, a227
  v_mfma_f32_16x16x32_bf16 v[56:59], a[128:131], v[152:155], v[56:59]
  v_mul_f32_e64 v102, v102, v103
  v_accvgpr_read_b32 v98, a216
  v_mfma_f32_16x16x32_bf16 v[60:63], a[132:135], v[152:155], v[60:63]
  v_accvgpr_read_b32 v100, a230
  v_accvgpr_read_b32 v99, a217
  v_mfma_f32_16x16x32_bf16 v[64:67], a[136:139], v[152:155], v[64:67]
  v_accvgpr_read_b32 v101, a231
  v_lshlrev_b32 v108, 16, v98
  s_waitcnt vmcnt(12)
  v_mfma_f32_16x16x32_bf16 v[48:51], a[140:143], v[156:159], v[48:51]
  buffer_load_dwordx4 v[188:191], v2, s[60:63], s17 offen offset:1024 sc1
  v_and_b32 v109, 0xffff0000, v98
  v_mfma_f32_16x16x32_bf16 v[52:55], a[144:147], v[156:159], v[52:55]
  v_lshlrev_b32_e64 v110, 16, v99
  v_and_b32 v111, 0xffff0000, v99
  v_mfma_f32_16x16x32_bf16 v[56:59], a[148:151], v[156:159], v[56:59]
  v_lshlrev_b32_e64 v92, 16, v100
  v_and_b32 v93, 0xffff0000, v100
  v_mfma_f32_16x16x32_bf16 v[60:63], a[152:155], v[156:159], v[60:63]
  v_lshlrev_b32_e64 v94, 16, v101
  v_and_b32 v95, 0xffff0000, v101
  v_mfma_f32_16x16x32_bf16 v[64:67], a[156:159], v[156:159], v[64:67]
  v_fma_f32 v88, v108, v103, -v102
  s_waitcnt vmcnt(12)
  v_mfma_f32_16x16x32_bf16 v[48:51], a[160:163], v[160:163], v[48:51]
  buffer_load_dwordx4 v[128:131], v2, s[60:63], s17 offen offset:2048 sc1
  v_fma_f32 v89, v109, v103, -v102
  v_mfma_f32_16x16x32_bf16 v[52:55], a[164:167], v[160:163], v[52:55]
  v_fma_f32 v90, v110, v103, -v102
  v_fma_f32 v91, v111, v103, -v102
  v_mfma_f32_16x16x32_bf16 v[56:59], a[168:171], v[160:163], v[56:59]
  v_fmac_f32 v108, v88, v92
  v_fmac_f32_e64 v109, v89, v93
  v_mfma_f32_16x16x32_bf16 v[60:63], a[172:175], v[160:163], v[60:63]
  v_fmac_f32 v110, v90, v94
  v_fmac_f32 v111, v91, v95
  v_mfma_f32_16x16x32_bf16 v[64:67], a[176:179], v[160:163], v[64:67]
  v_accvgpr_read_b32 v98, a218
  s_waitcnt vmcnt(11)
  v_mfma_f32_16x16x32_bf16 v[48:51], a[180:183], v[164:167], v[48:51]
  buffer_load_dwordx4 v[132:135], v2, s[60:63], s17 offen offset:3072 sc1
  v_accvgpr_read_b32 v100, a232
  v_mfma_f32_16x16x32_bf16 v[52:55], a[184:187], v[164:167], v[52:55]
  v_accvgpr_read_b32 v99, a219
  v_accvgpr_read_b32 v101, a233
  v_mfma_f32_16x16x32_bf16 v[56:59], a[188:191], v[164:167], v[56:59]
  v_lshlrev_b32 v112, 16, v98
  v_and_b32 v113, 0xffff0000, v98
  v_mfma_f32_16x16x32_bf16 v[60:63], a[192:195], v[164:167], v[60:63]
  v_lshlrev_b32_e64 v114, 16, v99
  v_and_b32 v115, 0xffff0000, v99
  v_mfma_f32_16x16x32_bf16 v[64:67], a[196:199], v[164:167], v[64:67]
  v_lshlrev_b32 v92, 16, v100
  s_waitcnt vmcnt(10)
  v_mfma_f32_16x16x32_bf16 v[68:71], a[0:3], v[168:171], 0
  s_add_u32 s17, s17, 4096
  buffer_load_dwordx4 v[136:139], v2, s[60:63], s17 offen offset:0 sc1
  v_and_b32 v93, 0xffff0000, v100
  v_mfma_f32_16x16x32_bf16 v[72:75], a[4:7], v[168:171], 0
  v_lshlrev_b32_e64 v94, 16, v101
  v_and_b32 v95, 0xffff0000, v101
  v_mfma_f32_16x16x32_bf16 v[76:79], a[8:11], v[168:171], 0
  v_fma_f32 v88, v112, v103, -v102
  v_fma_f32 v89, v113, v103, -v102
  v_mfma_f32_16x16x32_bf16 v[80:83], a[12:15], v[168:171], 0
  v_fma_f32 v90, v114, v103, -v102
  v_fma_f32 v91, v115, v103, -v102
  v_mfma_f32_16x16x32_bf16 v[84:87], a[16:19], v[168:171], 0
  v_fmac_f32 v112, v88, v92
  s_waitcnt vmcnt(9)
  v_mfma_f32_16x16x32_bf16 v[68:71], a[20:23], v[172:175], v[68:71]
  ds_write_b128 v44, v[48:51] offset:0
  ds_write_b128 v44, v[52:55] offset:1024
  buffer_load_dwordx4 v[140:143], v2, s[60:63], s17 offen offset:1024 sc1
  v_mfma_f32_16x16x32_bf16 v[72:75], a[24:27], v[172:175], v[72:75]
  v_fmac_f32 v113, v89, v93
  v_fmac_f32 v114, v90, v94
  v_mfma_f32_16x16x32_bf16 v[76:79], a[28:31], v[172:175], v[76:79]
  v_fmac_f32_e64 v115, v91, v95
  v_accvgpr_read_b32 v98, a220
  v_mfma_f32_16x16x32_bf16 v[80:83], a[32:35], v[172:175], v[80:83]
  v_accvgpr_read_b32 v100, a234
  v_accvgpr_read_b32 v99, a221
  v_mfma_f32_16x16x32_bf16 v[84:87], a[36:39], v[172:175], v[84:87]
  v_accvgpr_read_b32 v101, a235
  v_lshlrev_b32 v116, 16, v98
  s_waitcnt vmcnt(8)
  v_mfma_f32_16x16x32_bf16 v[68:71], a[40:43], v[176:179], v[68:71]
  ds_write_b128 v44, v[56:59] offset:2048
  ds_write_b128 v44, v[60:63] offset:3072
  buffer_load_dwordx4 v[144:147], v2, s[60:63], s18 offen offset:0 sc1
  v_mfma_f32_16x16x32_bf16 v[72:75], a[44:47], v[176:179], v[72:75]
  v_and_b32 v117, 0xffff0000, v98
  v_lshlrev_b32_e64 v118, 16, v99
  v_mfma_f32_16x16x32_bf16 v[76:79], a[48:51], v[176:179], v[76:79]
  v_and_b32 v119, 0xffff0000, v99
  v_lshlrev_b32_e64 v92, 16, v100
  v_mfma_f32_16x16x32_bf16 v[80:83], a[52:55], v[176:179], v[80:83]
  v_and_b32 v93, 0xffff0000, v100
  v_lshlrev_b32_e64 v94, 16, v101
  v_mfma_f32_16x16x32_bf16 v[84:87], a[56:59], v[176:179], v[84:87]
  v_and_b32 v95, 0xffff0000, v101
  v_fma_f32 v88, v116, v103, -v102
  s_waitcnt vmcnt(8)
  v_mfma_f32_16x16x32_bf16 v[68:71], a[60:63], v[180:183], v[68:71]
  ds_write_b128 v44, v[64:67] offset:4096
  buffer_load_dwordx4 v[148:151], v2, s[60:63], s18 offen offset:1024 sc1
  v_mfma_f32_16x16x32_bf16 v[72:75], a[64:67], v[180:183], v[72:75]
  v_fma_f32 v89, v117, v103, -v102
  v_fma_f32 v90, v118, v103, -v102
  v_mfma_f32_16x16x32_bf16 v[76:79], a[68:71], v[180:183], v[76:79]
  v_fma_f32 v91, v119, v103, -v102
  v_fmac_f32 v116, v88, v92
  v_mfma_f32_16x16x32_bf16 v[80:83], a[72:75], v[180:183], v[80:83]
  v_fmac_f32 v117, v89, v93
  v_fmac_f32 v118, v90, v94
  v_mfma_f32_16x16x32_bf16 v[84:87], a[76:79], v[180:183], v[84:87]
  v_fmac_f32_e64 v119, v91, v95
  v_accvgpr_read_b32 v98, a222
  s_waitcnt vmcnt(7)
  v_mfma_f32_16x16x32_bf16 v[68:71], a[80:83], v[184:187], v[68:71]
  buffer_load_dwordx4 v[152:155], v2, s[60:63], s18 offen offset:2048 sc1
  v_accvgpr_read_b32 v100, a236
  v_mfma_f32_16x16x32_bf16 v[72:75], a[84:87], v[184:187], v[72:75]
  v_accvgpr_read_b32 v99, a223
  v_accvgpr_read_b32 v101, a237
  v_mfma_f32_16x16x32_bf16 v[76:79], a[88:91], v[184:187], v[76:79]
  v_lshlrev_b32 v120, 16, v98
  v_and_b32 v121, 0xffff0000, v98
  v_mfma_f32_16x16x32_bf16 v[80:83], a[92:95], v[184:187], v[80:83]
  v_lshlrev_b32_e64 v122, 16, v99
  v_and_b32 v123, 0xffff0000, v99
  v_mfma_f32_16x16x32_bf16 v[84:87], a[96:99], v[184:187], v[84:87]
  v_lshlrev_b32 v92, 16, v100
  s_waitcnt vmcnt(7)
  v_mfma_f32_16x16x32_bf16 v[68:71], a[100:103], v[188:191], v[68:71]
  buffer_load_dwordx4 v[156:159], v2, s[60:63], s18 offen offset:3072 sc1
  v_and_b32 v93, 0xffff0000, v100
  v_mfma_f32_16x16x32_bf16 v[72:75], a[104:107], v[188:191], v[72:75]
  v_lshlrev_b32_e64 v94, 16, v101
  v_and_b32 v95, 0xffff0000, v101
  v_mfma_f32_16x16x32_bf16 v[76:79], a[108:111], v[188:191], v[76:79]
  v_fma_f32 v88, v120, v103, -v102
  v_fma_f32 v89, v121, v103, -v102
  v_mfma_f32_16x16x32_bf16 v[80:83], a[112:115], v[188:191], v[80:83]
  v_fma_f32 v90, v122, v103, -v102
  v_fma_f32 v91, v123, v103, -v102
  v_mfma_f32_16x16x32_bf16 v[84:87], a[116:119], v[188:191], v[84:87]
  v_fmac_f32 v120, v88, v92
  s_waitcnt vmcnt(7)
  v_mfma_f32_16x16x32_bf16 v[68:71], a[120:123], v[128:131], v[68:71]
  s_add_u32 s18, s18, 4096
  buffer_load_dwordx4 v[160:163], v2, s[60:63], s18 offen offset:0 sc1
  v_fmac_f32 v121, v89, v93
  v_fmac_f32 v122, v90, v94
  v_mfma_f32_16x16x32_bf16 v[72:75], a[124:127], v[128:131], v[72:75]
  v_fmac_f32_e64 v123, v91, v95
  v_accvgpr_read_b32 v98, a224
  v_accvgpr_read_b32 v100, a238
  v_mfma_f32_16x16x32_bf16 v[76:79], a[128:131], v[128:131], v[76:79]
  v_accvgpr_read_b32 v99, a225
  v_accvgpr_read_b32 v101, a239
  v_mfma_f32_16x16x32_bf16 v[80:83], a[132:135], v[128:131], v[80:83]
  v_lshlrev_b32_e64 v124, 16, v98
  s_mul_i32 s15, s7, 10240
  v_mfma_f32_16x16x32_bf16 v[84:87], a[136:139], v[128:131], v[84:87]
  s_add_u32 s15, s15, 102400
  v_add_u32 v47, s15, v2
  s_waitcnt vmcnt(7)
  v_mfma_f32_16x16x32_bf16 v[68:71], a[140:143], v[132:135], v[68:71]
  buffer_load_dwordx4 v[164:167], v2, s[60:63], s18 offen offset:1024 sc1
  v_and_b32 v125, 0xffff0000, v98
  v_mfma_f32_16x16x32_bf16 v[72:75], a[144:147], v[132:135], v[72:75]
  v_lshlrev_b32_e64 v126, 16, v99
  v_and_b32 v127, 0xffff0000, v99
  v_mfma_f32_16x16x32_bf16 v[76:79], a[148:151], v[132:135], v[76:79]
  v_lshlrev_b32_e64 v92, 16, v100
  v_and_b32 v93, 0xffff0000, v100
  v_mfma_f32_16x16x32_bf16 v[80:83], a[152:155], v[132:135], v[80:83]
  v_lshlrev_b32_e64 v94, 16, v101
  v_and_b32 v95, 0xffff0000, v101
  v_mfma_f32_16x16x32_bf16 v[84:87], a[156:159], v[132:135], v[84:87]
  v_fma_f32 v88, v124, v103, -v102
  s_waitcnt vmcnt(7)
  v_mfma_f32_16x16x32_bf16 v[68:71], a[160:163], v[136:139], v[68:71]
  buffer_load_dwordx4 v[168:171], v2, s[60:63], s18 offen offset:2048 sc1
  v_fma_f32 v89, v125, v103, -v102
  v_mfma_f32_16x16x32_bf16 v[72:75], a[164:167], v[136:139], v[72:75]
  v_fma_f32 v90, v126, v103, -v102
  v_fma_f32 v91, v127, v103, -v102
  v_mfma_f32_16x16x32_bf16 v[76:79], a[168:171], v[136:139], v[76:79]
  v_fmac_f32 v124, v88, v92
  v_fmac_f32_e64 v125, v89, v93
  v_mfma_f32_16x16x32_bf16 v[80:83], a[172:175], v[136:139], v[80:83]
  v_fmac_f32_e64 v126, v90, v94
  v_mfma_f32_16x16x32_bf16 v[84:87], a[176:179], v[136:139], v[84:87]
  v_fmac_f32 v127, v91, v95
  s_waitcnt vmcnt(7)
  v_mfma_f32_16x16x32_bf16 v[68:71], a[180:183], v[140:143], v[68:71]
  buffer_load_dwordx4 v[172:175], v2, s[60:63], s18 offen offset:3072 sc1
  v_mfma_f32_16x16x32_bf16 v[72:75], a[184:187], v[140:143], v[72:75]
  v_mfma_f32_16x16x32_bf16 v[76:79], a[188:191], v[140:143], v[76:79]
  v_mfma_f32_16x16x32_bf16 v[80:83], a[192:195], v[140:143], v[80:83]
  v_mfma_f32_16x16x32_bf16 v[84:87], a[196:199], v[140:143], v[84:87]
  s_waitcnt vmcnt(7)
  v_mfma_f32_16x16x32_bf16 v[48:51], a[0:3], v[144:147], 0
  s_add_u32 s18, s18, 4096
  buffer_load_dwordx4 v[176:179], v2, s[60:63], s18 offen offset:0 sc1
  v_mfma_f32_16x16x32_bf16 v[52:55], a[4:7], v[144:147], 0
  v_mfma_f32_16x16x32_bf16 v[56:59], a[8:11], v[144:147], 0
  v_mfma_f32_16x16x32_bf16 v[60:63], a[12:15], v[144:147], 0
  v_mfma_f32_16x16x32_bf16 v[64:67], a[16:19], v[144:147], 0
  s_waitcnt vmcnt(7)
  v_mfma_f32_16x16x32_bf16 v[48:51], a[20:23], v[148:151], v[48:51]
  ds_write_b128 v45, v[68:71] offset:0
  v_mfma_f32_16x16x32_bf16 v[52:55], a[24:27], v[148:151], v[52:55]
  ds_write_b128 v45, v[72:75] offset:1024
  v_mfma_f32_16x16x32_bf16 v[56:59], a[28:31], v[148:151], v[56:59]
  buffer_load_dwordx4 v[180:183], v2, s[60:63], s18 offen offset:1024 sc1
  v_mfma_f32_16x16x32_bf16 v[60:63], a[32:35], v[148:151], v[60:63]
  v_mfma_f32_16x16x32_bf16 v[64:67], a[36:39], v[148:151], v[64:67]
  s_waitcnt vmcnt(7)
  v_mfma_f32_16x16x32_bf16 v[48:51], a[40:43], v[152:155], v[48:51]
  ds_write_b128 v45, v[76:79] offset:2048
  v_mfma_f32_16x16x32_bf16 v[52:55], a[44:47], v[152:155], v[52:55]
  ds_write_b128 v45, v[80:83] offset:3072
  v_mfma_f32_16x16x32_bf16 v[56:59], a[48:51], v[152:155], v[56:59]
  buffer_load_dwordx4 v[184:187], v2, s[60:63], s19 offen offset:0 sc1
  v_mfma_f32_16x16x32_bf16 v[60:63], a[52:55], v[152:155], v[60:63]
  v_mfma_f32_16x16x32_bf16 v[64:67], a[56:59], v[152:155], v[64:67]
  s_waitcnt vmcnt(7)
  v_mfma_f32_16x16x32_bf16 v[48:51], a[60:63], v[156:159], v[48:51]
  ds_write_b128 v45, v[84:87] offset:4096
  v_mfma_f32_16x16x32_bf16 v[52:55], a[64:67], v[156:159], v[52:55]
  buffer_load_dwordx4 v[188:191], v2, s[60:63], s19 offen offset:1024 sc1
  v_mfma_f32_16x16x32_bf16 v[56:59], a[68:71], v[156:159], v[56:59]
  v_mfma_f32_16x16x32_bf16 v[60:63], a[72:75], v[156:159], v[60:63]
  v_mfma_f32_16x16x32_bf16 v[64:67], a[76:79], v[156:159], v[64:67]
  s_waitcnt vmcnt(7)
  v_mfma_f32_16x16x32_bf16 v[48:51], a[80:83], v[160:163], v[48:51]
  buffer_load_dwordx4 v[128:131], v2, s[60:63], s19 offen offset:2048 sc1
  s_waitcnt lgkmcnt(0)
  s_barrier
  v_mfma_f32_16x16x32_bf16 v[52:55], a[84:87], v[160:163], v[52:55]
  ds_read_b128 v[192:195], v47 offset:0
  ds_read_b128 v[196:199], v47 offset:1024
  v_mfma_f32_16x16x32_bf16 v[56:59], a[88:91], v[160:163], v[56:59]
  ds_read_b128 v[200:203], v47 offset:2048
  ds_read_b128 v[204:207], v47 offset:3072
  v_mfma_f32_16x16x32_bf16 v[60:63], a[92:95], v[160:163], v[60:63]
  ds_read_b128 v[208:211], v47 offset:4096
  ds_read_b128 v[212:215], v47 offset:5120
  v_mfma_f32_16x16x32_bf16 v[64:67], a[96:99], v[160:163], v[64:67]
  ds_read_b128 v[216:219], v47 offset:6144
  ds_read_b128 v[220:223], v47 offset:7168
  s_waitcnt vmcnt(7)
  v_mfma_f32_16x16x32_bf16 v[48:51], a[100:103], v[164:167], v[48:51]
  buffer_load_dwordx4 v[132:135], v2, s[60:63], s19 offen offset:3072 sc1
  ds_read_b128 v[224:227], v47 offset:8192
  v_mfma_f32_16x16x32_bf16 v[52:55], a[104:107], v[164:167], v[52:55]
  ds_read_b128 v[228:231], v47 offset:9216
  s_waitcnt lgkmcnt(5)
  v_mfma_f32_16x16x32_bf16 v[56:59], a[108:111], v[164:167], v[56:59]
  v_add_f32 v108, v108, v192
  v_add_f32_e64 v109, v109, v193
  v_mfma_f32_16x16x32_bf16 v[60:63], a[112:115], v[164:167], v[60:63]
  v_add_f32 v110, v110, v194
  v_add_f32 v111, v111, v195
  v_mfma_f32_16x16x32_bf16 v[64:67], a[116:119], v[164:167], v[64:67]
  v_add_f32 v112, v112, v196
  v_add_f32 v113, v113, v197
  s_waitcnt vmcnt(7)
  v_mfma_f32_16x16x32_bf16 v[48:51], a[120:123], v[168:171], v[48:51]
  s_add_u32 s19, s19, 4096
  buffer_load_dwordx4 v[136:139], v2, s[60:63], s19 offen offset:0 sc1
  v_add_f32 v114, v114, v198
  v_mfma_f32_16x16x32_bf16 v[52:55], a[124:127], v[168:171], v[52:55]
  v_add_f32 v115, v115, v199
  v_add_f32 v116, v116, v200
  v_mfma_f32_16x16x32_bf16 v[56:59], a[128:131], v[168:171], v[56:59]
  v_add_f32 v117, v117, v201
  v_add_f32 v118, v118, v202
  v_mfma_f32_16x16x32_bf16 v[60:63], a[132:135], v[168:171], v[60:63]
  v_add_f32 v119, v119, v203
  v_add_f32 v120, v120, v204
  v_mfma_f32_16x16x32_bf16 v[64:67], a[136:139], v[168:171], v[64:67]
  v_add_f32 v121, v121, v205
  v_add_f32 v122, v122, v206
  s_waitcnt vmcnt(7)
  v_mfma_f32_16x16x32_bf16 v[48:51], a[140:143], v[172:175], v[48:51]
  buffer_load_dwordx4 v[140:143], v2, s[60:63], s19 offen offset:1024 sc1
  s_mul_i32 s93, s6, 327680
  s_lshl_b32 s12, s5, 7
  s_add_u32 s93, s93, s12
  v_mfma_f32_16x16x32_bf16 v[52:55], a[144:147], v[172:175], v[52:55]
  s_lshr_b32 s12, s7, 1
  s_mul_i32 s94, s12, 5120
  s_add_u32 s94, s94, 143360
  s_lshl_b32 s12, s12, 6
  v_mfma_f32_16x16x32_bf16 v[56:59], a[148:151], v[172:175], v[56:59]
  s_add_u32 s93, s93, s12
  s_add_u32 s93, s93, 19922944
  s_mov_b32 s92, s93
  v_add_f32 v123, v123, v207
  v_mfma_f32_16x16x32_bf16 v[60:63], a[152:155], v[172:175], v[60:63]
  v_add_f32 v124, v124, v208
  v_add_f32 v125, v125, v209
  v_add_f32 v126, v126, v210
  v_add_f32 v127, v127, v211
  v_mfma_f32_16x16x32_bf16 v[64:67], a[156:159], v[172:175], v[64:67]
  s_waitcnt lgkmcnt(0)
  v_add_f32 v108, v108, v212
  v_add_f32 v109, v109, v213
  v_add_f32 v110, v110, v214
  s_waitcnt vmcnt(7)
  v_mfma_f32_16x16x32_bf16 v[48:51], a[160:163], v[176:179], v[48:51]
  buffer_load_dwordx4 v[144:147], v2, s[60:63], s19 offen offset:2048 sc1
  s_and_b32 s12, s7, 1
  s_mul_i32 s13, s12, 196608
  s_add_u32 s93, s93, s13
  s_mul_i32 s13, s12, 3072
  v_mfma_f32_16x16x32_bf16 v[52:55], a[164:167], v[176:179], v[52:55]
  s_add_u32 s95, s94, s13
  s_lshl_b32 s12, s12, 3
  s_add_u32 s94, s94, s12
  v_lshrrev_b32_e64 v252, 2, v1
  v_mfma_f32_16x16x32_bf16 v[56:59], a[168:171], v[176:179], v[56:59]
  v_lshlrev_b32 v252, 12, v252
  v_and_b32 v12, 3, v1
  v_lshl_add_u32 v252, v12, 4, v252
  v_add_f32_e64 v111, v111, v215
  v_mfma_f32_16x16x32_bf16 v[60:63], a[172:175], v[176:179], v[60:63]
  v_add_f32 v112, v112, v216
  v_add_f32 v113, v113, v217
  v_add_f32 v114, v114, v218
  v_add_f32 v115, v115, v219
  v_mfma_f32_16x16x32_bf16 v[64:67], a[176:179], v[176:179], v[64:67]
  v_add_f32 v116, v116, v220
  v_add_f32 v117, v117, v221
  v_add_f32 v118, v118, v222
  v_add_f32 v119, v119, v223
  s_waitcnt vmcnt(7)
  v_mfma_f32_16x16x32_bf16 v[48:51], a[180:183], v[180:183], v[48:51]
  buffer_load_dwordx4 v[148:151], v2, s[60:63], s19 offen offset:3072 sc1
  v_add_f32 v120, v120, v224
  v_mfma_f32_16x16x32_bf16 v[52:55], a[184:187], v[180:183], v[52:55]
  v_add_f32 v121, v121, v225
  v_add_f32 v122, v122, v226
  v_mfma_f32_16x16x32_bf16 v[56:59], a[188:191], v[180:183], v[56:59]
  v_add_f32 v123, v123, v227
  v_add_f32 v124, v124, v228
  v_mfma_f32_16x16x32_bf16 v[60:63], a[192:195], v[180:183], v[60:63]
  v_add_f32 v125, v125, v229
  v_add_f32 v126, v126, v230
  v_mfma_f32_16x16x32_bf16 v[64:67], a[196:199], v[180:183], v[64:67]
  v_add_f32 v127, v127, v231
  s_waitcnt vmcnt(7)
  v_mfma_f32_16x16x32_bf16 v[68:71], a[0:3], v[184:187], v[108:111]
  s_add_u32 s19, s19, 4096
  buffer_load_dwordx4 v[152:155], v2, s[60:63], s19 offen offset:0 sc1
  v_mfma_f32_16x16x32_bf16 v[72:75], a[4:7], v[184:187], v[112:115]
  v_mfma_f32_16x16x32_bf16 v[76:79], a[8:11], v[184:187], v[116:119]
  v_mfma_f32_16x16x32_bf16 v[80:83], a[12:15], v[184:187], v[120:123]
  v_mfma_f32_16x16x32_bf16 v[84:87], a[16:19], v[184:187], v[124:127]
  s_waitcnt vmcnt(7)
  v_mfma_f32_16x16x32_bf16 v[68:71], a[20:23], v[188:191], v[68:71]
  ds_write_b128 v46, v[48:51] offset:0
  v_mfma_f32_16x16x32_bf16 v[72:75], a[24:27], v[188:191], v[72:75]
  ds_write_b128 v46, v[52:55] offset:1024
  v_mfma_f32_16x16x32_bf16 v[76:79], a[28:31], v[188:191], v[76:79]
  buffer_load_dwordx4 v[156:159], v2, s[60:63], s19 offen offset:1024 sc1
  v_mfma_f32_16x16x32_bf16 v[80:83], a[32:35], v[188:191], v[80:83]
  v_mfma_f32_16x16x32_bf16 v[84:87], a[36:39], v[188:191], v[84:87]
  s_waitcnt vmcnt(7)
  v_mfma_f32_16x16x32_bf16 v[68:71], a[40:43], v[128:131], v[68:71]
  ds_write_b128 v46, v[56:59] offset:2048
  v_mfma_f32_16x16x32_bf16 v[72:75], a[44:47], v[128:131], v[72:75]
  ds_write_b128 v46, v[60:63] offset:3072
  v_mfma_f32_16x16x32_bf16 v[76:79], a[48:51], v[128:131], v[76:79]
  s_add_u32 m0, s95, 0
  s_nop 0
  buffer_load_dwordx4 v252, s[52:55], s93 offen sc1 lds
  s_add_u32 s93, s93, 65536
  v_mfma_f32_16x16x32_bf16 v[80:83], a[52:55], v[128:131], v[80:83]
  s_add_u32 m0, s95, 1024
  s_nop 0
  buffer_load_dwordx4 v252, s[52:55], s93 offen sc1 lds
  s_add_u32 s93, s93, 65536
  v_mfma_f32_16x16x32_bf16 v[84:87], a[56:59], v[128:131], v[84:87]
  s_add_u32 m0, s95, 2048
  s_bitcmp1_b32 s7, 0
  s_cselect_b32 s93, 1879048192, s93
  s_cselect_b32 m0, 163840, m0
  s_nop 0
  buffer_load_dwordx4 v252, s[52:55], s93 offen sc1 lds
  s_add_u32 s93, s93, 65536
  s_waitcnt vmcnt(9)
  v_mfma_f32_16x16x32_bf16 v[68:71], a[60:63], v[132:135], v[68:71]
  ds_write_b128 v46, v[64:67] offset:4096
  v_mfma_f32_16x16x32_bf16 v[72:75], a[64:67], v[132:135], v[72:75]
  v_add_u32_e64 v253, s94, v2
  v_mfma_f32_16x16x32_bf16 v[76:79], a[68:71], v[132:135], v[76:79]
  v_mfma_f32_16x16x32_bf16 v[80:83], a[72:75], v[132:135], v[80:83]
  v_mfma_f32_16x16x32_bf16 v[84:87], a[76:79], v[132:135], v[84:87]
  s_waitcnt vmcnt(8)
  v_mfma_f32_16x16x32_bf16 v[68:71], a[80:83], v[136:139], v[68:71]
  s_mul_i32 s15, s7, 5120
  v_mfma_f32_16x16x32_bf16 v[72:75], a[84:87], v[136:139], v[72:75]
  v_add_u32 v47, s15, v2
  v_mfma_f32_16x16x32_bf16 v[76:79], a[88:91], v[136:139], v[76:79]
  v_mfma_f32_16x16x32_bf16 v[80:83], a[92:95], v[136:139], v[80:83]
  v_mfma_f32_16x16x32_bf16 v[84:87], a[96:99], v[136:139], v[84:87]
  s_waitcnt vmcnt(7)
  v_mfma_f32_16x16x32_bf16 v[68:71], a[100:103], v[140:143], v[68:71]
  s_waitcnt lgkmcnt(0)
  s_barrier
  ds_read_b128 v[192:195], v47 offset:0
  v_mfma_f32_16x16x32_bf16 v[72:75], a[104:107], v[140:143], v[72:75]
  ds_read_b128 v[196:199], v47 offset:1024
  v_mfma_f32_16x16x32_bf16 v[76:79], a[108:111], v[140:143], v[76:79]
  ds_read_b128 v[200:203], v47 offset:2048
  v_mfma_f32_16x16x32_bf16 v[80:83], a[112:115], v[140:143], v[80:83]
  ds_read_b128 v[204:207], v47 offset:3072
  v_mfma_f32_16x16x32_bf16 v[84:87], a[116:119], v[140:143], v[84:87]
  ds_read_b128 v[208:211], v47 offset:4096
  s_waitcnt vmcnt(6)
  v_mfma_f32_16x16x32_bf16 v[68:71], a[120:123], v[144:147], v[68:71]
  v_mfma_f32_16x16x32_bf16 v[72:75], a[124:127], v[144:147], v[72:75]
  v_mfma_f32_16x16x32_bf16 v[76:79], a[128:131], v[144:147], v[76:79]
  v_mfma_f32_16x16x32_bf16 v[80:83], a[132:135], v[144:147], v[80:83]
  v_mfma_f32_16x16x32_bf16 v[84:87], a[136:139], v[144:147], v[84:87]
  s_waitcnt vmcnt(5)
  v_mfma_f32_16x16x32_bf16 v[68:71], a[140:143], v[148:151], v[68:71]
  v_mfma_f32_16x16x32_bf16 v[72:75], a[144:147], v[148:151], v[72:75]
  v_mfma_f32_16x16x32_bf16 v[76:79], a[148:151], v[148:151], v[76:79]
  v_mfma_f32_16x16x32_bf16 v[80:83], a[152:155], v[148:151], v[80:83]
  v_mfma_f32_16x16x32_bf16 v[84:87], a[156:159], v[148:151], v[84:87]
  s_waitcnt vmcnt(4)
  v_mfma_f32_16x16x32_bf16 v[68:71], a[160:163], v[152:155], v[68:71]
  v_mfma_f32_16x16x32_bf16 v[72:75], a[164:167], v[152:155], v[72:75]
  v_mfma_f32_16x16x32_bf16 v[76:79], a[168:171], v[152:155], v[76:79]
  v_mfma_f32_16x16x32_bf16 v[80:83], a[172:175], v[152:155], v[80:83]
  v_mfma_f32_16x16x32_bf16 v[84:87], a[176:179], v[152:155], v[84:87]
  s_waitcnt vmcnt(3)
  v_mfma_f32_16x16x32_bf16 v[68:71], a[180:183], v[156:159], v[68:71]
  v_mfma_f32_16x16x32_bf16 v[72:75], a[184:187], v[156:159], v[72:75]
  v_mfma_f32_16x16x32_bf16 v[76:79], a[188:191], v[156:159], v[76:79]
  v_mfma_f32_16x16x32_bf16 v[80:83], a[192:195], v[156:159], v[80:83]
  v_mfma_f32_16x16x32_bf16 v[84:87], a[196:199], v[156:159], v[84:87]
  s_lshl_b32 s12, s5, 15
  s_lshl_b32 s13, s7, 9
  s_add_u32 s12, s12, s13
  s_add_u32 s12, s12, 1310720
  s_lshl_b32 s13, s6, 12
  s_add_u32 s13, s13, s12
  s_waitcnt lgkmcnt(0)
  s_waitcnt vmcnt(0)
  s_barrier
  ds_read_b64_tr_b16 v[232:233], v253 offset:0
  ds_read_b64_tr_b16 v[234:235], v253 offset:1024
  ds_read_b64_tr_b16 v[236:237], v253 offset:2048
  ds_read_b64_tr_b16 v[238:239], v253 offset:3072
  ds_read_b64_tr_b16 v[240:241], v253 offset:4096
  v_accvgpr_read_b32 v244, a243
  v_accvgpr_read_b32 v245, a244
  v_pk_add_f32 v[68:69], v[68:69], v[192:193]
  v_pk_add_f32 v[70:71], v[70:71], v[194:195]
  v_pk_add_f32 v[72:73], v[72:73], v[196:197]
  v_pk_add_f32 v[74:75], v[74:75], v[198:199]
  v_pk_add_f32 v[76:77], v[76:77], v[200:201]
  v_pk_add_f32 v[78:79], v[78:79], v[202:203]
  v_pk_add_f32 v[80:81], v[80:81], v[204:205]
  v_pk_add_f32 v[82:83], v[82:83], v[206:207]
  v_pk_add_f32 v[84:85], v[84:85], v[208:209]
  v_pk_add_f32 v[86:87], v[86:87], v[210:211]
  v_pk_add_f32 v[212:213], v[68:69], v[70:71]
  v_pk_mul_f32 v[214:215], v[68:69], v[68:69]
  v_pk_fma_f32 v[214:215], v[70:71], v[70:71], v[214:215]
  v_pk_add_f32 v[212:213], v[212:213], v[72:73]
  v_pk_fma_f32 v[214:215], v[72:73], v[72:73], v[214:215]
  v_pk_add_f32 v[212:213], v[212:213], v[74:75]
  v_pk_fma_f32 v[214:215], v[74:75], v[74:75], v[214:215]
  v_pk_add_f32 v[212:213], v[212:213], v[76:77]
  v_pk_fma_f32 v[214:215], v[76:77], v[76:77], v[214:215]
  v_pk_add_f32 v[212:213], v[212:213], v[78:79]
  v_pk_fma_f32 v[214:215], v[78:79], v[78:79], v[214:215]
  v_pk_add_f32 v[212:213], v[212:213], v[80:81]
  v_pk_fma_f32 v[214:215], v[80:81], v[80:81], v[214:215]
  v_pk_add_f32 v[212:213], v[212:213], v[82:83]
  v_pk_fma_f32 v[214:215], v[82:83], v[82:83], v[214:215]
  v_pk_add_f32 v[212:213], v[212:213], v[84:85]
  v_pk_fma_f32 v[214:215], v[84:85], v[84:85], v[214:215]
  v_pk_add_f32 v[212:213], v[212:213], v[86:87]
  v_pk_fma_f32 v[214:215], v[86:87], v[86:87], v[214:215]
  s_waitcnt lgkmcnt(0)
  v_pk_max_u16 v15, v232, v233
  v_pk_max_u16 v15, v15, v234
  v_pk_max_u16 v15, v15, v235
  v_pk_max_u16 v15, v15, v236
  v_pk_max_u16 v15, v15, v237
  v_pk_max_u16 v15, v15, v238
  v_pk_max_u16 v15, v15, v239
  v_pk_max_u16 v15, v15, v240
  v_pk_max_u16 v15, v15, v241
  v_lshlrev_b32 v14, 16, v15
  v_max_u32 v15, v15, v14
  v_cmp_le_u32 vcc, 0xffff0000, v15
  s_cbranch_vccnz again_49
ok_50:
  v_lshlrev_b32 v88, 16, v232
  v_and_b32 v89, 0xffff0000, v232
  v_lshlrev_b32_e64 v90, 16, v233
  v_and_b32 v91, 0xffff0000, v233
  s_add_u32 m0, s75, 0
  s_add_u32 s14, s74, 0
  buffer_load_dwordx4 v244, s[56:59], s14 offen lds
  buffer_load_dwordx4 v245, s[56:59], s14 offen offset:2048 lds
  v_pk_mul_f32 v[160:161], v[68:69], v[88:89]
  v_pk_mul_f32 v[226:227], v[88:89], v[88:89]
  v_pk_mul_f32 v[218:219], v[160:161], v[68:69]
  v_pk_mul_f32 v[220:221], v[160:161], v[160:161]
  v_pk_mul_f32 v[222:223], v[160:161], v[88:89]
  v_pk_mul_f32 v[162:163], v[70:71], v[90:91]
  v_pk_add_f32 v[224:225], v[88:89], v[90:91]
  v_pk_fma_f32 v[226:227], v[90:91], v[90:91], v[226:227]
  v_pk_add_f32 v[216:217], v[160:161], v[162:163]
  v_pk_fma_f32 v[218:219], v[162:163], v[70:71], v[218:219]
  v_pk_fma_f32 v[220:221], v[162:163], v[162:163], v[220:221]
  v_pk_fma_f32 v[222:223], v[162:163], v[90:91], v[222:223]
  v_lshlrev_b32_e64 v92, 16, v234
  v_and_b32 v93, 0xffff0000, v234
  v_lshlrev_b32_e64 v94, 16, v235
  v_and_b32 v95, 0xffff0000, v235
  v_pk_mul_f32 v[164:165], v[72:73], v[92:93]
  v_pk_add_f32 v[224:225], v[224:225], v[92:93]
  v_pk_fma_f32 v[226:227], v[92:93], v[92:93], v[226:227]
  v_pk_add_f32 v[216:217], v[216:217], v[164:165]
  v_pk_fma_f32 v[218:219], v[164:165], v[72:73], v[218:219]
  v_pk_fma_f32 v[220:221], v[164:165], v[164:165], v[220:221]
  v_pk_fma_f32 v[222:223], v[164:165], v[92:93], v[222:223]
  v_pk_mul_f32 v[166:167], v[74:75], v[94:95]
  v_pk_add_f32 v[224:225], v[224:225], v[94:95]
  v_pk_fma_f32 v[226:227], v[94:95], v[94:95], v[226:227]
  v_pk_add_f32 v[216:217], v[216:217], v[166:167]
  v_pk_fma_f32 v[218:219], v[166:167], v[74:75], v[218:219]
  v_pk_fma_f32 v[220:221], v[166:167], v[166:167], v[220:221]
  v_pk_fma_f32 v[222:223], v[166:167], v[94:95], v[222:223]
  v_lshlrev_b32_e64 v96, 16, v236
  v_and_b32 v97, 0xffff0000, v236
  v_lshlrev_b32_e64 v98, 16, v237
  v_and_b32 v99, 0xffff0000, v237
  s_add_u32 m0, s75, 4096
  s_add_u32 s14, s74, 20480
  buffer_load_dwordx4 v244, s[56:59], s14 offen lds
  buffer_load_dwordx4 v245, s[56:59], s14 offen offset:2048 lds
  v_pk_mul_f32 v[168:169], v[76:77], v[96:97]
  v_pk_add_f32 v[224:225], v[224:225], v[96:97]
  v_pk_fma_f32 v[226:227], v[96:97], v[96:97], v[226:227]
  v_pk_add_f32 v[216:217], v[216:217], v[168:169]
  v_pk_fma_f32 v[218:219], v[168:169], v[76:77], v[218:219]
  v_pk_fma_f32 v[220:221], v[168:169], v[168:169], v[220:221]
  v_pk_fma_f32 v[222:223], v[168:169], v[96:97], v[222:223]
  v_pk_mul_f32 v[170:171], v[78:79], v[98:99]
  v_pk_add_f32 v[224:225], v[224:225], v[98:99]
  v_pk_fma_f32 v[226:227], v[98:99], v[98:99], v[226:227]
  v_pk_add_f32 v[216:217], v[216:217], v[170:171]
  v_pk_fma_f32 v[218:219], v[170:171], v[78:79], v[218:219]
  v_pk_fma_f32 v[220:221], v[170:171], v[170:171], v[220:221]
  v_pk_fma_f32 v[222:223], v[170:171], v[98:99], v[222:223]
  v_lshlrev_b32_e64 v100, 16, v238
  v_and_b32 v101, 0xffff0000, v238
  v_lshlrev_b32_e64 v102, 16, v239
  v_and_b32 v103, 0xffff0000, v239
  v_pk_mul_f32 v[172:173], v[80:81], v[100:101]
  v_pk_add_f32 v[224:225], v[224:225], v[100:101]
  v_pk_fma_f32 v[226:227], v[100:101], v[100:101], v[226:227]
  v_pk_add_f32 v[216:217], v[216:217], v[172:173]
  v_pk_fma_f32 v[218:219], v[172:173], v[80:81], v[218:219]
  v_pk_fma_f32 v[220:221], v[172:173], v[172:173], v[220:221]
  v_pk_fma_f32 v[222:223], v[172:173], v[100:101], v[222:223]
  v_pk_mul_f32 v[174:175], v[82:83], v[102:103]
  v_pk_add_f32 v[224:225], v[224:225], v[102:103]
  v_pk_fma_f32 v[226:227], v[102:103], v[102:103], v[226:227]
  v_pk_add_f32 v[216:217], v[216:217], v[174:175]
  v_pk_fma_f32 v[218:219], v[174:175], v[82:83], v[218:219]
  v_pk_fma_f32 v[220:221], v[174:175], v[174:175], v[220:221]
  v_pk_fma_f32 v[222:223], v[174:175], v[102:103], v[222:223]
  v_lshlrev_b32_e64 v104, 16, v240
  v_and_b32 v105, 0xffff0000, v240
  v_lshlrev_b32_e64 v106, 16, v241
  v_and_b32 v107, 0xffff0000, v241
  s_add_u32 m0, s75, 8192
  s_add_u32 s14, s74, 40960
  buffer_load_dwordx4 v244, s[56:59], s14 offen lds
  v_pk_mul_f32 v[176:177], v[84:85], v[104:105]
  v_pk_add_f32 v[224:225], v[224:225], v[104:105]
  v_pk_fma_f32 v[226:227], v[104:105], v[104:105], v[226:227]
  v_pk_add_f32 v[216:217], v[216:217], v[176:177]
  v_pk_fma_f32 v[218:219], v[176:177], v[84:85], v[218:219]
  v_pk_fma_f32 v[220:221], v[176:177], v[176:177], v[220:221]
  v_pk_fma_f32 v[222:223], v[176:177], v[104:105], v[222:223]
  v_pk_mul_f32 v[178:179], v[86:87], v[106:107]
  v_pk_add_f32 v[224:225], v[224:225], v[106:107]
  v_pk_fma_f32 v[226:227], v[106:107], v[106:107], v[226:227]
  v_pk_add_f32 v[216:217], v[216:217], v[178:179]
  v_pk_fma_f32 v[218:219], v[178:179], v[86:87], v[218:219]
  v_pk_fma_f32 v[220:221], v[178:179], v[178:179], v[220:221]
  v_pk_fma_f32 v[222:223], v[178:179], v[106:107], v[222:223]
  v_add_f32 v212, v212, v213
  v_add_f32 v214, v214, v215
  v_add_f32 v216, v216, v217
  v_add_f32 v218, v218, v219
  v_add_f32 v220, v220, v221
  v_add_f32 v222, v222, v223
  v_add_f32 v224, v224, v225
  v_add_f32 v226, v226, v227
  v_permlane16_swap_b32 v212, v220
  v_permlane16_swap_b32 v214, v222
  v_permlane16_swap_b32 v216, v224
  v_permlane16_swap_b32 v218, v226
  v_add_f32 v228, v212, v220
  v_add_f32 v229, v214, v222
  v_add_f32 v230, v216, v224
  v_add_f32 v231, v218, v226
  v_mov_b32 v212, v228
  v_mov_b32 v213, v229
  v_mov_b32 v214, v230
  v_mov_b32 v215, v231
  v_permlane32_swap_b32 v228, v212
  v_permlane32_swap_b32 v229, v213
  v_permlane32_swap_b32 v230, v214
  v_permlane32_swap_b32 v231, v215
  s_movk_i32 s14, 0xff
  v_add_f32 v228, v228, v212
  v_add_f32 v229, v229, v213
  v_add_f32 v230, v230, v214
  v_add_f32 v231, v231, v215
  s_lshr_b32 s15, s8, 0
  v_mov_b32_e64 v212, s15
  v_bfi_b32 v228, s14, v212, v228
  s_lshr_b32 s15, s8, 8
  v_mov_b32 v213, s15
  v_bfi_b32 v229, s14, v213, v229
  s_lshr_b32 s15, s8, 16
  v_mov_b32 v214, s15
  v_bfi_b32 v230, s14, v214, v230
  s_lshr_b32 s15, s8, 24
  v_mov_b32 v215, s15
  v_bfi_b32 v231, s14, v215, v231
  s_mov_b32 exec_hi, 0
  s_cmp_eq_u32 s9, 0
  s_cbranch_scc1 slow_51
  buffer_store_dwordx4 v[228:231], v2, s[52:55], s13 offen
back_52:
  s_mov_b32 exec_hi, -1
  v_accvgpr_write_b32 a200, v232
  v_accvgpr_write_b32 a201, v233
  v_accvgpr_write_b32 a202, v234
  v_accvgpr_write_b32 a203, v235
  v_accvgpr_write_b32 a204, v236
  v_accvgpr_write_b32 a205, v237
  v_accvgpr_write_b32 a206, v238
  v_accvgpr_write_b32 a207, v239
  v_accvgpr_write_b32 a208, v240
  v_accvgpr_write_b32 a209, v241
  v_lshrrev_b32_e64 v11, 2, v3
  v_mul_u32_u24 v11, 5120, v11
  v_and_b32_e64 v12, 3, v3
  v_lshl_add_u32 v11, v12, 4, v11
  v_lshrrev_b32_e64 v12, 1, v4
  v_lshl_add_u32 v11, v12, 6, v11
  v_and_b32_e64 v12, 1, v4
  v_lshl_add_u32 v47, v12, 3, v11
  s_lshl_b32 s88, s5, 2
  s_add_u32 s88, s88, s7
  s_mul_i32 s88, s88, 20480
  s_mul_i32 s14, s6, 640
  s_add_u32 s88, s88, s14
  s_add_u32 s88, s88, 4194304
  v_accvgpr_read_b32 v190, a230
  v_accvgpr_read_b32 v191, a231
  v_accvgpr_read_b32 v192, a232
  v_accvgpr_read_b32 v193, a233
  v_accvgpr_read_b32 v194, a234
  v_accvgpr_read_b32 v195, a235
  v_accvgpr_read_b32 v196, a236
  v_accvgpr_read_b32 v197, a237
  v_accvgpr_read_b32 v198, a238
  v_accvgpr_read_b32 v199, a239
  v_lshlrev_b32 v108, 16, v190
  v_and_b32 v109, 0xffff0000, v190
  v_lshlrev_b32_e64 v110, 16, v191
  v_and_b32 v111, 0xffff0000, v191
  v_lshlrev_b32_e64 v112, 16, v192
  v_and_b32 v113, 0xffff0000, v192
  v_lshlrev_b32_e64 v114, 16, v193
  v_and_b32 v115, 0xffff0000, v193
  v_lshlrev_b32_e64 v116, 16, v194
  v_and_b32 v117, 0xffff0000, v194
  v_lshlrev_b32_e64 v118, 16, v195
  v_and_b32 v119, 0xffff0000, v195
  v_lshlrev_b32_e64 v120, 16, v196
  v_and_b32 v121, 0xffff0000, v196
  v_lshlrev_b32_e64 v122, 16, v197
  v_and_b32 v123, 0xffff0000, v197
  v_lshlrev_b32_e64 v124, 16, v198
  v_and_b32 v125, 0xffff0000, v198
  v_lshlrev_b32_e64 v126, 16, v199
  v_and_b32 v127, 0xffff0000, v199
  s_lshl_b32 s87, s3, 10
  s_lshr_b32 s13, s7, 1
  s_lshl_b32 s13, s13, 7
  s_add_u32 s87, s87, s13
  s_and_b32 s13, s7, 1
  s_lshl_b32 s13, s13, 3
  s_add_u32 s87, s87, s13
  s_add_u32 s87, s87, 4096
  v_and_b32 v46, 7, v1
  v_lshlrev_b32_e64 v46, 4, v46
  s_add_u32 s34, s76, 4194304
  s_add_u32 s35, s34, 20480
  s_lshl_b32 s44, s5, 5
  s_lshl_b32 s13, s6, 2
  s_add_u32 s44, s44, s13
  s_add_u32 s44, s44, s7
  v_and_b32 v11, 31, v1
  v_lshlrev_b32 v11, 4, v11
  v_lshrrev_b32_e64 v12, 5, v1
  v_lshl_add_u32 v11, v12, 14, v11
  s_mov_b32 s14, 0x0c0c0400
  s_mov_b32 s15, 0x04000c0c
  s_add_u32 s89, s12, 4096
  s_add_u32 s90, s12, 8192
  s_add_u32 s91, s12, 12288
stpoll_53:
  buffer_load_dwordx4 v[128:131], v11, s[52:55], s12 offen sc1
  buffer_load_dwordx4 v[132:135], v11, s[52:55], s89 offen sc1
  buffer_load_dwordx4 v[136:139], v11, s[52:55], s90 offen sc1
  buffer_load_dwordx4 v[140:143], v11, s[52:55], s91 offen sc1
  s_waitcnt vmcnt(0)
  v_perm_b32 v212, v129, v128, s14
  v_perm_b32 v213, v131, v130, s15
  v_perm_b32 v214, v133, v132, s14
  v_perm_b32 v215, v135, v134, s15
  v_perm_b32 v216, v137, v136, s14
  v_perm_b32 v217, v139, v138, s15
  v_perm_b32 v218, v141, v140, s14
  v_perm_b32 v219, v143, v142, s15
  v_or_b32 v212, v212, v213
  v_or_b32 v214, v214, v215
  v_or_b32 v216, v216, v217
  v_or_b32_e64 v218, v218, v219
  v_min3_u32 v13, v212, v214, s8
  v_max3_u32 v14, v212, v214, s8
  v_min3_u32 v13, v13, v216, v218
  v_max3_u32 v14, v14, v216, v218
  v_cmp_ne_u32 vcc, v13, v14
  s_sub_u32 s10, s10, 1
  s_cmp_gt_i32 s10, 0
  s_cbranch_scc0 giveup_55
  s_cbranch_vccnz stpoll_53
giveup_55:
  v_pk_add_f32 v[128:129], v[128:129], v[132:133]
  v_pk_add_f32 v[136:137], v[136:137], v[140:141]
  v_pk_add_f32 v[130:131], v[130:131], v[134:135]
  v_pk_add_f32 v[138:139], v[138:139], v[142:143]
  v_pk_add_f32 v[128:129], v[128:129], v[136:137]
  v_pk_add_f32 v[130:131], v[130:131], v[138:139]
  v_mov_b32 v132, v128
  v_mov_b32 v133, v129
  v_mov_b32 v134, v130
  v_mov_b32 v135, v131
  v_permlane32_swap_b32 v128, v132
  v_permlane32_swap_b32 v129, v133
  v_permlane32_swap_b32 v130, v134
  v_permlane32_swap_b32 v131, v135
  v_add_f32 v212, v128, v132
  v_add_f32 v213, v129, v133
  v_add_f32 v214, v130, v134
  v_add_f32 v215, v131, v135
  v_mov_b32 v216, v212
  v_mov_b32 v217, v213
  v_mov_b32 v218, v214
  v_mov_b32 v219, v215
  v_permlane16_swap_b32 v212, v216
  v_permlane16_swap_b32 v213, v217
  v_permlane16_swap_b32 v214, v218
  v_permlane16_swap_b32 v215, v219
  v_mul_f32 v200, 0x3acccccd, v212
  v_mul_f32 v204, 0x3acccccd, v213
  v_fma_f32 v204, -v200, v200, v204
  v_max_f32 v204, 0, v204
  v_add_f32 v204, 0x3727c5ac, v204
  v_rsq_f32 v202, v204
  s_nop 0
  v_mul_f32_e64 v203, v200, v202
  v_fma_f32 v204, v202, v214, v212
  v_fma_f32 v204, -v203, v218, v204
  v_mul_f32_e64 v205, v202, v216
  v_fma_f32 v205, 2.0, v215, v205
  v_fma_f32 v205, v202, v205, v213
  v_fma_f32 v214, v202, v217, v214
  v_mul_f32_e64 v219, v203, v219
  v_fma_f32 v214, -2.0, v214, v219
  v_fma_f32 v205, v203, v214, v205
  v_mul_f32 v204, 0x3acccccd, v204
  v_mul_f32 v205, 0x3acccccd, v205
  v_fma_f32 v205, -v204, v204, v205
  v_max_f32_e64 v205, 0, v205
  v_add_f32 v205, 0x3727c5ac, v205
  v_rsq_f32 v206, v205
  s_nop 0
  v_mul_f32_e64 v207, v204, v206
  v_pk_fma_f32 v[160:161], v[68:69], v[202:203], v[202:203] op_sel:[0,0,1] op_sel_hi:[1,0,1] neg_lo:[0,0,1] neg_hi:[0,0,1]
  v_pk_fma_f32 v[162:163], v[70:71], v[202:203], v[202:203] op_sel:[0,0,1] op_sel_hi:[1,0,1] neg_lo:[0,0,1] neg_hi:[0,0,1]
  v_pk_fma_f32 v[164:165], v[72:73], v[202:203], v[202:203] op_sel:[0,0,1] op_sel_hi:[1,0,1] neg_lo:[0,0,1] neg_hi:[0,0,1]
  v_pk_fma_f32 v[166:167], v[74:75], v[202:203], v[202:203] op_sel:[0,0,1] op_sel_hi:[1,0,1] neg_lo:[0,0,1] neg_hi:[0,0,1]
  v_pk_fma_f32 v[168:169], v[76:77], v[202:203], v[202:203] op_sel:[0,0,1] op_sel_hi:[1,0,1] neg_lo:[0,0,1] neg_hi:[0,0,1]
  v_pk_fma_f32 v[170:171], v[78:79], v[202:203], v[202:203] op_sel:[0,0,1] op_sel_hi:[1,0,1] neg_lo:[0,0,1] neg_hi:[0,0,1]
  v_pk_fma_f32 v[172:173], v[80:81], v[202:203], v[202:203] op_sel:[0,0,1] op_sel_hi:[1,0,1] neg_lo:[0,0,1] neg_hi:[0,0,1]
  v_pk_fma_f32 v[174:175], v[82:83], v[202:203], v[202:203] op_sel:[0,0,1] op_sel_hi:[1,0,1] neg_lo:[0,0,1] neg_hi:[0,0,1]
  v_pk_fma_f32 v[176:177], v[84:85], v[202:203], v[202:203] op_sel:[0,0,1] op_sel_hi:[1,0,1] neg_lo:[0,0,1] neg_hi:[0,0,1]
  v_pk_fma_f32 v[178:179], v[86:87], v[202:203], v[202:203] op_sel:[0,0,1] op_sel_hi:[1,0,1] neg_lo:[0,0,1] neg_hi:[0,0,1]
  v_pk_fma_f32 v[68:69], v[160:161], v[88:89], v[68:69]
  v_pk_fma_f32 v[70:71], v[162:163], v[90:91], v[70:71]
  v_pk_fma_f32 v[72:73], v[164:165], v[92:93], v[72:73]
  v_pk_fma_f32 v[74:75], v[166:167], v[94:95], v[74:75]
  v_pk_fma_f32 v[76:77], v[168:169], v[96:97], v[76:77]
  v_pk_fma_f32 v[78:79], v[170:171], v[98:99], v[78:79]
  v_pk_fma_f32 v[80:81], v[172:173], v[100:101], v[80:81]
  v_pk_fma_f32 v[82:83], v[174:175], v[102:103], v[82:83]
  v_pk_fma_f32 v[84:85], v[176:177], v[104:105], v[84:85]
  v_pk_fma_f32 v[86:87], v[178:179], v[106:107], v[86:87]
  v_pk_fma_f32 v[160:161], v[68:69], v[206:207], v[206:207] op_sel:[0,0,1] op_sel_hi:[1,0,1] neg_lo:[0,0,1] neg_hi:[0,0,1]
  v_pk_fma_f32 v[162:163], v[70:71], v[206:207], v[206:207] op_sel:[0,0,1] op_sel_hi:[1,0,1] neg_lo:[0,0,1] neg_hi:[0,0,1]
  v_pk_fma_f32 v[164:165], v[72:73], v[206:207], v[206:207] op_sel:[0,0,1] op_sel_hi:[1,0,1] neg_lo:[0,0,1] neg_hi:[0,0,1]
  v_pk_fma_f32 v[166:167], v[74:75], v[206:207], v[206:207] op_sel:[0,0,1] op_sel_hi:[1,0,1] neg_lo:[0,0,1] neg_hi:[0,0,1]
  v_pk_fma_f32 v[168:169], v[76:77], v[206:207], v[206:207] op_sel:[0,0,1] op_sel_hi:[1,0,1] neg_lo:[0,0,1] neg_hi:[0,0,1]
  v_pk_fma_f32 v[170:171], v[78:79], v[206:207], v[206:207] op_sel:[0,0,1] op_sel_hi:[1,0,1] neg_lo:[0,0,1] neg_hi:[0,0,1]
  v_pk_fma_f32 v[172:173], v[80:81], v[206:207], v[206:207] op_sel:[0,0,1] op_sel_hi:[1,0,1] neg_lo:[0,0,1] neg_hi:[0,0,1]
  v_pk_fma_f32 v[174:175], v[82:83], v[206:207], v[206:207] op_sel:[0,0,1] op_sel_hi:[1,0,1] neg_lo:[0,0,1] neg_hi:[0,0,1]
  v_pk_fma_f32 v[176:177], v[84:85], v[206:207], v[206:207] op_sel:[0,0,1] op_sel_hi:[1,0,1] neg_lo:[0,0,1] neg_hi:[0,0,1]
  v_pk_fma_f32 v[178:179], v[86:87], v[206:207], v[206:207] op_sel:[0,0,1] op_sel_hi:[1,0,1] neg_lo:[0,0,1] neg_hi:[0,0,1]
  v_cvt_pk_bf16_f32 v180, v160, v161
  v_cvt_pk_bf16_f32 v181, v162, v163
  v_cvt_pk_bf16_f32 v182, v164, v165
  v_cvt_pk_bf16_f32 v183, v166, v167
  v_cvt_pk_bf16_f32 v184, v168, v169
  v_cvt_pk_bf16_f32 v185, v170, v171
  v_cvt_pk_bf16_f32 v186, v172, v173
  v_cvt_pk_bf16_f32 v187, v174, v175
  v_cvt_pk_bf16_f32 v188, v176, v177
  v_cvt_pk_bf16_f32 v189, v178, v179
  buffer_store_dwordx2 v[180:181], v47, s[52:55], s88 offen offset:0 sc1
  buffer_store_dwordx2 v[182:183], v47, s[52:55], s88 offen offset:128 sc1
  buffer_store_dwordx2 v[184:185], v47, s[52:55], s88 offen offset:256 sc1
  buffer_store_dwordx2 v[186:187], v47, s[52:55], s88 offen offset:384 sc1
  buffer_store_dwordx2 v[188:189], v47, s[52:55], s88 offen offset:512 sc1
  v_pk_fma_f32 v[68:69], v[160:161], v[108:109], v[68:69]
  v_pk_fma_f32 v[70:71], v[162:163], v[110:111], v[70:71]
  v_pk_fma_f32 v[72:73], v[164:165], v[112:113], v[72:73]
  v_pk_fma_f32 v[74:75], v[166:167], v[114:115], v[74:75]
  v_pk_fma_f32 v[76:77], v[168:169], v[116:117], v[76:77]
  v_pk_fma_f32 v[78:79], v[170:171], v[118:119], v[78:79]
  v_pk_fma_f32 v[80:81], v[172:173], v[120:121], v[80:81]
  v_pk_fma_f32 v[82:83], v[174:175], v[122:123], v[82:83]
  v_pk_fma_f32 v[84:85], v[176:177], v[124:125], v[84:85]
  v_pk_fma_f32 v[86:87], v[178:179], v[126:127], v[86:87]
  v_accvgpr_write_b32 a210, v68
  v_accvgpr_write_b32 a211, v69
  v_accvgpr_write_b32 a212, v70
  v_accvgpr_write_b32 a213, v71
  v_accvgpr_write_b32 a214, v72
  v_accvgpr_write_b32 a215, v73
  v_accvgpr_write_b32 a216, v74
  v_accvgpr_write_b32 a217, v75
  v_accvgpr_write_b32 a218, v76
  v_accvgpr_write_b32 a219, v77
  v_accvgpr_write_b32 a220, v78
  v_accvgpr_write_b32 a221, v79
  v_accvgpr_write_b32 a222, v80
  v_accvgpr_write_b32 a223, v81
  v_accvgpr_write_b32 a224, v82
  v_accvgpr_write_b32 a225, v83
  v_accvgpr_write_b32 a226, v84
  v_accvgpr_write_b32 a227, v85
  v_accvgpr_write_b32 a228, v86
  v_accvgpr_write_b32 a229, v87
  s_add_u32 s13, s84, 4096
  s_waitcnt vmcnt(0)
  v_mov_b32 v15, s8
  s_mov_b64 exec, 1
  s_cmp_eq_u32 s9, 0
  s_cbranch_scc1 slow_56
  buffer_store_dword v15, off, s[52:55], s13
back_57:
  s_mov_b64 exec, -1
  s_cmp_lg_u32 s44, 992
  s_cbranch_scc1 skip_58
  v_mov_b32 v15, s8
  s_mov_b64 exec, 1
  buffer_store_dword v15, off, s[52:55], 0 sc1
  s_mov_b64 exec, -1
skip_58:
again_59:
  buffer_load_dwordx2 v[42:43], v46, s[52:55], s87 offen sc1
  s_sub_u32 s10, s10, 1
  s_cmp_gt_i32 s10, 0
  s_waitcnt vmcnt(0)
  v_xor_b32 v15, s8, v42
  v_xor_b32 v14, s8, v43
  v_or_b32 v15, v15, v14
  v_cmp_ne_u32 vcc, 0, v15
  s_cbranch_scc0 out_61
  s_cbranch_vccnz again_59
out_61:
ok_60:
  buffer_load_dwordx4 v[128:131], v0, s[52:55], s34 offen offset:1024 sc1
  buffer_load_dwordx4 v[132:135], v0, s[52:55], s35 offen offset:1024 sc1
  buffer_load_dwordx4 v[136:139], v0, s[52:55], s34 offen offset:1280 sc1
  buffer_load_dwordx4 v[140:143], v0, s[52:55], s35 offen offset:1280 sc1
  buffer_load_dwordx4 v[144:147], v0, s[52:55], s34 offen offset:1536 sc1
  buffer_load_dwordx4 v[148:151], v0, s[52:55], s35 offen offset:1536 sc1
  buffer_load_dwordx4 v[152:155], v0, s[52:55], s34 offen offset:1792 sc1
  buffer_load_dwordx4 v[156:159], v0, s[52:55], s35 offen offset:1792 sc1
  ds_read_b128 v[88:91], v5 offset:20480
  ds_read_b128 v[92:95], v5 offset:22528
  ds_read_b128 v[96:99], v5 offset:24576
  ds_read_b128 v[100:103], v5 offset:26624
  ds_read_b128 v[104:107], v5 offset:28672
  s_waitcnt vmcnt(6)
  s_waitcnt lgkmcnt(4)
  v_mfma_f32_16x16x32_bf16 v[48:51], v[128:131], v[88:91], 0
  ds_read_b128 v[108:111], v6 offset:20480
  v_mfma_f32_16x16x32_bf16 v[52:55], v[132:135], v[88:91], 0
  buffer_load_dwordx4 v[160:163], v0, s[52:55], s34 offen offset:2048 sc1
  s_waitcnt lgkmcnt(4)
  v_mfma_f32_16x16x32_bf16 v[56:59], v[128:131], v[92:95], 0
  ds_read_b128 v[112:115], v6 offset:22528
  v_mfma_f32_16x16x32_bf16 v[60:63], v[132:135], v[92:95], 0
  buffer_load_dwordx4 v[164:167], v0, s[52:55], s35 offen offset:2048 sc1
  s_waitcnt lgkmcnt(4)
  v_mfma_f32_16x16x32_bf16 v[64:67], v[128:131], v[96:99], 0
  ds_read_b128 v[116:119], v6 offset:24576
  v_mfma_f32_16x16x32_bf16 v[68:71], v[132:135], v[96:99], 0
  s_waitcnt lgkmcnt(4)
  v_mfma_f32_16x16x32_bf16 v[72:75], v[128:131], v[100:103], 0
  ds_read_b128 v[120:123], v6 offset:26624
  v_mfma_f32_16x16x32_bf16 v[76:79], v[132:135], v[100:103], 0
  s_waitcnt lgkmcnt(4)
  v_mfma_f32_16x16x32_bf16 v[80:83], v[128:131], v[104:107], 0
  ds_read_b128 v[124:127], v6 offset:28672
  v_mfma_f32_16x16x32_bf16 v[84:87], v[132:135], v[104:107], 0
  s_waitcnt vmcnt(6)
  s_waitcnt lgkmcnt(2)
  v_mfma_f32_16x16x32_bf16 v[48:51], v[136:139], v[108:111], v[48:51]
  ds_read_b128 v[88:91], v5 offset:30720
  v_mfma_f32_16x16x32_bf16 v[52:55], v[140:143], v[108:111], v[52:55]
  buffer_load_dwordx4 v[168:171], v0, s[52:55], s34 offen offset:2304 sc1
  v_mfma_f32_16x16x32_bf16 v[56:59], v[136:139], v[112:115], v[56:59]
  ds_read_b128 v[92:95], v5 offset:32768
  v_mfma_f32_16x16x32_bf16 v[60:63], v[140:143], v[112:115], v[60:63]
  buffer_load_dwordx4 v[172:175], v0, s[52:55], s35 offen offset:2304 sc1
  v_mfma_f32_16x16x32_bf16 v[64:67], v[136:139], v[116:119], v[64:67]
  ds_read_b128 v[96:99], v5 offset:34816
  v_mfma_f32_16x16x32_bf16 v[68:71], v[140:143], v[116:119], v[68:71]
  s_waitcnt lgkmcnt(3)
  v_mfma_f32_16x16x32_bf16 v[72:75], v[136:139], v[120:123], v[72:75]
  ds_read_b128 v[100:103], v5 offset:36864
  v_mfma_f32_16x16x32_bf16 v[76:79], v[140:143], v[120:123], v[76:79]
  v_mfma_f32_16x16x32_bf16 v[80:83], v[136:139], v[124:127], v[80:83]
  ds_read_b128 v[104:107], v5 offset:38912
  v_mfma_f32_16x16x32_bf16 v[84:87], v[140:143], v[124:127], v[84:87]
  s_waitcnt vmcnt(6)
  s_waitcnt lgkmcnt(2)
  v_mfma_f32_16x16x32_bf16 v[48:51], v[144:147], v[88:91], v[48:51]
  ds_read_b128 v[108:111], v6 offset:30720
  v_mfma_f32_16x16x32_bf16 v[52:55], v[148:151], v[88:91], v[52:55]
  buffer_load_dwordx4 v[176:179], v0, s[52:55], s34 offen offset:2560 sc1
  v_mfma_f32_16x16x32_bf16 v[56:59], v[144:147], v[92:95], v[56:59]
  ds_read_b128 v[112:115], v6 offset:32768
  v_mfma_f32_16x16x32_bf16 v[60:63], v[148:151], v[92:95], v[60:63]
  buffer_load_dwordx4 v[180:183], v0, s[52:55], s35 offen offset:2560 sc1
  v_mfma_f32_16x16x32_bf16 v[64:67], v[144:147], v[96:99], v[64:67]
  ds_read_b128 v[116:119], v6 offset:34816
  v_mfma_f32_16x16x32_bf16 v[68:71], v[148:151], v[96:99], v[68:71]
  s_waitcnt lgkmcnt(3)
  v_mfma_f32_16x16x32_bf16 v[72:75], v[144:147], v[100:103], v[72:75]
  ds_read_b128 v[120:123], v6 offset:36864
  v_mfma_f32_16x16x32_bf16 v[76:79], v[148:151], v[100:103], v[76:79]
  v_mfma_f32_16x16x32_bf16 v[80:83], v[144:147], v[104:107], v[80:83]
  ds_read_b128 v[124:127], v6 offset:38912
  v_mfma_f32_16x16x32_bf16 v[84:87], v[148:151], v[104:107], v[84:87]
  s_waitcnt vmcnt(6)
  s_waitcnt lgkmcnt(2)
  v_mfma_f32_16x16x32_bf16 v[48:51], v[152:155], v[108:111], v[48:51]
  ds_read_b128 v[88:91], v5 offset:40960
  v_mfma_f32_16x16x32_bf16 v[52:55], v[156:159], v[108:111], v[52:55]
  buffer_load_dwordx4 v[184:187], v0, s[52:55], s34 offen offset:2816 sc1
  v_mfma_f32_16x16x32_bf16 v[56:59], v[152:155], v[112:115], v[56:59]
  ds_read_b128 v[92:95], v5 offset:43008
  v_mfma_f32_16x16x32_bf16 v[60:63], v[156:159], v[112:115], v[60:63]
  buffer_load_dwordx4 v[188:191], v0, s[52:55], s35 offen offset:2816 sc1
  v_mfma_f32_16x16x32_bf16 v[64:67], v[152:155], v[116:119], v[64:67]
  ds_read_b128 v[96:99], v5 offset:45056
  v_mfma_f32_16x16x32_bf16 v[68:71], v[156:159], v[116:119], v[68:71]
  s_waitcnt lgkmcnt(3)
  v_mfma_f32_16x16x32_bf16 v[72:75], v[152:155], v[120:123], v[72:75]
  ds_read_b128 v[100:103], v5 offset:47104
  v_mfma_f32_16x16x32_bf16 v[76:79], v[156:159], v[120:123], v[76:79]
  v_mfma_f32_16x16x32_bf16 v[80:83], v[152:155], v[124:127], v[80:83]
  ds_read_b128 v[104:107], v5 offset:49152
  v_mfma_f32_16x16x32_bf16 v[84:87], v[156:159], v[124:127], v[84:87]
  s_waitcnt vmcnt(6)
  s_waitcnt lgkmcnt(2)
  v_mfma_f32_16x16x32_bf16 v[48:51], v[160:163], v[88:91], v[48:51]
  ds_read_b128 v[108:111], v6 offset:40960
  v_mfma_f32_16x16x32_bf16 v[52:55], v[164:167], v[88:91], v[52:55]
  buffer_load_dwordx4 v[128:131], v0, s[52:55], s34 offen offset:3072 sc1
  v_mfma_f32_16x16x32_bf16 v[56:59], v[160:163], v[92:95], v[56:59]
  ds_read_b128 v[112:115], v6 offset:43008
  v_mfma_f32_16x16x32_bf16 v[60:63], v[164:167], v[92:95], v[60:63]
  buffer_load_dwordx4 v[132:135], v0, s[52:55], s35 offen offset:3072 sc1
  v_mfma_f32_16x16x32_bf16 v[64:67], v[160:163], v[96:99], v[64:67]
  ds_read_b128 v[116:119], v6 offset:45056
  v_mfma_f32_16x16x32_bf16 v[68:71], v[164:167], v[96:99], v[68:71]
  s_waitcnt lgkmcnt(3)
  v_mfma_f32_16x16x32_bf16 v[72:75], v[160:163], v[100:103], v[72:75]
  ds_read_b128 v[120:123], v6 offset:47104
  v_mfma_f32_16x16x32_bf16 v[76:79], v[164:167], v[100:103], v[76:79]
  v_mfma_f32_16x16x32_bf16 v[80:83], v[160:163], v[104:107], v[80:83]
  ds_read_b128 v[124:127], v6 offset:49152
  v_mfma_f32_16x16x32_bf16 v[84:87], v[164:167], v[104:107], v[84:87]
  s_waitcnt vmcnt(6)
  s_waitcnt lgkmcnt(2)
  v_mfma_f32_16x16x32_bf16 v[48:51], v[168:171], v[108:111], v[48:51]
  ds_read_b128 v[88:91], v7 offset:0
  v_mfma_f32_16x16x32_bf16 v[52:55], v[172:175], v[108:111], v[52:55]
  buffer_load_dwordx4 v[136:139], v0, s[52:55], s34 offen offset:3328 sc1
  v_mfma_f32_16x16x32_bf16 v[56:59], v[168:171], v[112:115], v[56:59]
  ds_read_b128 v[92:95], v7 offset:2048
  v_mfma_f32_16x16x32_bf16 v[60:63], v[172:175], v[112:115], v[60:63]
  buffer_load_dwordx4 v[140:143], v0, s[52:55], s35 offen offset:3328 sc1
  v_mfma_f32_16x16x32_bf16 v[64:67], v[168:171], v[116:119], v[64:67]
  ds_read_b128 v[96:99], v7 offset:4096
  v_mfma_f32_16x16x32_bf16 v[68:71], v[172:175], v[116:119], v[68:71]
  s_waitcnt lgkmcnt(3)
  v_mfma_f32_16x16x32_bf16 v[72:75], v[168:171], v[120:123], v[72:75]
  ds_read_b128 v[100:103], v7 offset:6144
  v_mfma_f32_16x16x32_bf16 v[76:79], v[172:175], v[120:123], v[76:79]
  v_mfma_f32_16x16x32_bf16 v[80:83], v[168:171], v[124:127], v[80:83]
  ds_read_b128 v[104:107], v7 offset:8192
  v_mfma_f32_16x16x32_bf16 v[84:87], v[172:175], v[124:127], v[84:87]
  s_waitcnt vmcnt(6)
  s_waitcnt lgkmcnt(2)
  v_mfma_f32_16x16x32_bf16 v[48:51], v[176:179], v[88:91], v[48:51]
  ds_read_b128 v[108:111], v8 offset:0
  v_mfma_f32_16x16x32_bf16 v[52:55], v[180:183], v[88:91], v[52:55]
  buffer_load_dwordx4 v[144:147], v0, s[52:55], s34 offen offset:3584 sc1
  v_mfma_f32_16x16x32_bf16 v[56:59], v[176:179], v[92:95], v[56:59]
  ds_read_b128 v[112:115], v8 offset:2048
  v_mfma_f32_16x16x32_bf16 v[60:63], v[180:183], v[92:95], v[60:63]
  buffer_load_dwordx4 v[148:151], v0, s[52:55], s35 offen offset:3584 sc1
  v_mfma_f32_16x16x32_bf16 v[64:67], v[176:179], v[96:99], v[64:67]
  ds_read_b128 v[116:119], v8 offset:4096
  v_mfma_f32_16x16x32_bf16 v[68:71], v[180:183], v[96:99], v[68:71]
  s_waitcnt lgkmcnt(3)
  v_mfma_f32_16x16x32_bf16 v[72:75], v[176:179], v[100:103], v[72:75]
  ds_read_b128 v[120:123], v8 offset:6144
  v_mfma_f32_16x16x32_bf16 v[76:79], v[180:183], v[100:103], v[76:79]
  v_mfma_f32_16x16x32_bf16 v[80:83], v[176:179], v[104:107], v[80:83]
  ds_read_b128 v[124:127], v8 offset:8192
  v_mfma_f32_16x16x32_bf16 v[84:87], v[180:183], v[104:107], v[84:87]
  s_waitcnt vmcnt(6)
  s_waitcnt lgkmcnt(2)
  v_mfma_f32_16x16x32_bf16 v[48:51], v[184:187], v[108:111], v[48:51]
  ds_read_b128 v[88:91], v7 offset:10240
  v_mfma_f32_16x16x32_bf16 v[52:55], v[188:191], v[108:111], v[52:55]
  buffer_load_dwordx4 v[152:155], v0, s[52:55], s34 offen offset:3840 sc1
  v_mfma_f32_16x16x32_bf16 v[56:59], v[184:187], v[112:115], v[56:59]
  ds_read_b128 v[92:95], v7 offset:12288
  v_mfma_f32_16x16x32_bf16 v[60:63], v[188:191], v[112:115], v[60:63]
  buffer_load_dwordx4 v[156:159], v0, s[52:55], s35 offen offset:3840 sc1
  v_mfma_f32_16x16x32_bf16 v[64:67], v[184:187], v[116:119], v[64:67]
  ds_read_b128 v[96:99], v7 offset:14336
  v_mfma_f32_16x16x32_bf16 v[68:71], v[188:191], v[116:119], v[68:71]
  s_waitcnt lgkmcnt(3)
  v_mfma_f32_16x16x32_bf16 v[72:75], v[184:187], v[120:123], v[72:75]
  ds_read_b128 v[100:103], v7 offset:16384
  v_mfma_f32_16x16x32_bf16 v[76:79], v[188:191], v[120:123], v[76:79]
  v_mfma_f32_16x16x32_bf16 v[80:83], v[184:187], v[124:127], v[80:83]
  ds_read_b128 v[104:107], v7 offset:18432
  v_mfma_f32_16x16x32_bf16 v[84:87], v[188:191], v[124:127], v[84:87]
  s_waitcnt vmcnt(6)
  s_waitcnt lgkmcnt(2)
  v_mfma_f32_16x16x32_bf16 v[48:51], v[128:131], v[88:91], v[48:51]
  ds_read_b128 v[108:111], v8 offset:10240
  v_mfma_f32_16x16x32_bf16 v[52:55], v[132:135], v[88:91], v[52:55]
  s_add_u32 s34, s34, 4096
  buffer_load_dwordx4 v[160:163], v0, s[52:55], s34 offen offset:0 sc1
  v_mfma_f32_16x16x32_bf16 v[56:59], v[128:131], v[92:95], v[56:59]
  ds_read_b128 v[112:115], v8 offset:12288
  v_mfma_f32_16x16x32_bf16 v[60:63], v[132:135], v[92:95], v[60:63]
  s_add_u32 s35, s35, 4096
  buffer_load_dwordx4 v[164:167], v0, s[52:55], s35 offen offset:0 sc1
  v_mfma_f32_16x16x32_bf16 v[64:67], v[128:131], v[96:99], v[64:67]
  ds_read_b128 v[116:119], v8 offset:14336
  v_mfma_f32_16x16x32_bf16 v[68:71], v[132:135], v[96:99], v[68:71]
  s_waitcnt lgkmcnt(3)
  v_mfma_f32_16x16x32_bf16 v[72:75], v[128:131], v[100:103], v[72:75]
  ds_read_b128 v[120:123], v8 offset:16384
  v_mfma_f32_16x16x32_bf16 v[76:79], v[132:135], v[100:103], v[76:79]
  v_mfma_f32_16x16x32_bf16 v[80:83], v[128:131], v[104:107], v[80:83]
  ds_read_b128 v[124:127], v8 offset:18432
  v_mfma_f32_16x16x32_bf16 v[84:87], v[132:135], v[104:107], v[84:87]
  s_waitcnt vmcnt(6)
  s_waitcnt lgkmcnt(2)
  v_mfma_f32_16x16x32_bf16 v[48:51], v[136:139], v[108:111], v[48:51]
  ds_read_b128 v[88:91], v7 offset:20480
  v_mfma_f32_16x16x32_bf16 v[52:55], v[140:143], v[108:111], v[52:55]
  buffer_load_dwordx4 v[168:171], v0, s[52:55], s34 offen offset:256 sc1
  v_mfma_f32_16x16x32_bf16 v[56:59], v[136:139], v[112:115], v[56:59]
  ds_read_b128 v[92:95], v7 offset:22528
  v_mfma_f32_16x16x32_bf16 v[60:63], v[140:143], v[112:115], v[60:63]
  buffer_load_dwordx4 v[172:175], v0, s[52:55], s35 offen offset:256 sc1
  v_mfma_f32_16x16x32_bf16 v[64:67], v[136:139], v[116:119], v[64:67]
  ds_read_b128 v[96:99], v7 offset:24576
  v_mfma_f32_16x16x32_bf16 v[68:71], v[140:143], v[116:119], v[68:71]
  s_waitcnt lgkmcnt(3)
  v_mfma_f32_16x16x32_bf16 v[72:75], v[136:139], v[120:123], v[72:75]
  ds_read_b128 v[100:103], v7 offset:26624
  v_mfma_f32_16x16x32_bf16 v[76:79], v[140:143], v[120:123], v[76:79]
  v_mfma_f32_16x16x32_bf16 v[80:83], v[136:139], v[124:127], v[80:83]
  ds_read_b128 v[104:107], v7 offset:28672
  v_mfma_f32_16x16x32_bf16 v[84:87], v[140:143], v[124:127], v[84:87]
  s_waitcnt vmcnt(6)
  s_waitcnt lgkmcnt(2)
  v_mfma_f32_16x16x32_bf16 v[48:51], v[144:147], v[88:91], v[48:51]
  ds_read_b128 v[108:111], v8 offset:20480
  v_mfma_f32_16x16x32_bf16 v[52:55], v[148:151], v[88:91], v[52:55]
  buffer_load_dwordx4 v[176:179], v0, s[52:55], s34 offen offset:512 sc1
  v_mfma_f32_16x16x32_bf16 v[56:59], v[144:147], v[92:95], v[56:59]
  ds_read_b128 v[112:115], v8 offset:22528
  v_mfma_f32_16x16x32_bf16 v[60:63], v[148:151], v[92:95], v[60:63]
  buffer_load_dwordx4 v[180:183], v0, s[52:55], s35 offen offset:512 sc1
  v_mfma_f32_16x16x32_bf16 v[64:67], v[144:147], v[96:99], v[64:67]
  ds_read_b128 v[116:119], v8 offset:24576
  v_mfma_f32_16x16x32_bf16 v[68:71], v[148:151], v[96:99], v[68:71]
  s_waitcnt lgkmcnt(3)
  v_mfma_f32_16x16x32_bf16 v[72:75], v[144:147], v[100:103], v[72:75]
  ds_read_b128 v[120:123], v8 offset:26624
  v_mfma_f32_16x16x32_bf16 v[76:79], v[148:151], v[100:103], v[76:79]
  v_mfma_f32_16x16x32_bf16 v[80:83], v[144:147], v[104:107], v[80:83]
  ds_read_b128 v[124:127], v8 offset:28672
  v_mfma_f32_16x16x32_bf16 v[84:87], v[148:151], v[104:107], v[84:87]
  s_waitcnt vmcnt(6)
  s_waitcnt lgkmcnt(2)
  v_mfma_f32_16x16x32_bf16 v[48:51], v[152:155], v[108:111], v[48:51]
  ds_read_b128 v[88:91], v7 offset:30720
  v_mfma_f32_16x16x32_bf16 v[52:55], v[156:159], v[108:111], v[52:55]
  buffer_load_dwordx4 v[184:187], v0, s[52:55], s34 offen offset:768 sc1
  v_mfma_f32_16x16x32_bf16 v[56:59], v[152:155], v[112:115], v[56:59]
  ds_read_b128 v[92:95], v7 offset:32768
  v_mfma_f32_16x16x32_bf16 v[60:63], v[156:159], v[112:115], v[60:63]
  buffer_load_dwordx4 v[188:191], v0, s[52:55], s35 offen offset:768 sc1
  v_mfma_f32_16x16x32_bf16 v[64:67], v[152:155], v[116:119], v[64:67]
  ds_read_b128 v[96:99], v7 offset:34816
  v_mfma_f32_16x16x32_bf16 v[68:71], v[156:159], v[116:119], v[68:71]
  s_waitcnt lgkmcnt(3)
  v_mfma_f32_16x16x32_bf16 v[72:75], v[152:155], v[120:123], v[72:75]
  ds_read_b128 v[100:103], v7 offset:36864
  v_mfma_f32_16x16x32_bf16 v[76:79], v[156:159], v[120:123], v[76:79]
  v_mfma_f32_16x16x32_bf16 v[80:83], v[152:155], v[124:127], v[80:83]
  ds_read_b128 v[104:107], v7 offset:38912
  v_mfma_f32_16x16x32_bf16 v[84:87], v[156:159], v[124:127], v[84:87]
  s_waitcnt vmcnt(6)
  s_waitcnt lgkmcnt(2)
  v_mfma_f32_16x16x32_bf16 v[48:51], v[160:163], v[88:91], v[48:51]
  ds_read_b128 v[108:111], v8 offset:30720
  v_mfma_f32_16x16x32_bf16 v[52:55], v[164:167], v[88:91], v[52:55]
  s_sub_u32 s34, s34, 4096
  buffer_load_dwordx4 v[128:131], v0, s[52:55], s34 offen offset:0 sc1
  v_mfma_f32_16x16x32_bf16 v[56:59], v[160:163], v[92:95], v[56:59]
  ds_read_b128 v[112:115], v8 offset:32768
  v_mfma_f32_16x16x32_bf16 v[60:63], v[164:167], v[92:95], v[60:63]
  s_sub_u32 s35, s35, 4096
  buffer_load_dwordx4 v[132:135], v0, s[52:55], s35 offen offset:0 sc1
  v_mfma_f32_16x16x32_bf16 v[64:67], v[160:163], v[96:99], v[64:67]
  ds_read_b128 v[116:119], v8 offset:34816
  v_mfma_f32_16x16x32_bf16 v[68:71], v[164:167], v[96:99], v[68:71]
  s_waitcnt lgkmcnt(3)
  v_mfma_f32_16x16x32_bf16 v[72:75], v[160:163], v[100:103], v[72:75]
  ds_read_b128 v[120:123], v8 offset:36864
  v_mfma_f32_16x16x32_bf16 v[76:79], v[164:167], v[100:103], v[76:79]
  v_mfma_f32_16x16x32_bf16 v[80:83], v[160:163], v[104:107], v[80:83]
  ds_read_b128 v[124:127], v8 offset:38912
  v_mfma_f32_16x16x32_bf16 v[84:87], v[164:167], v[104:107], v[84:87]
  s_waitcnt vmcnt(6)
  s_waitcnt lgkmcnt(2)
  v_mfma_f32_16x16x32_bf16 v[48:51], v[168:171], v[108:111], v[48:51]
  ds_read_b128 v[88:91], v7 offset:40960
  v_mfma_f32_16x16x32_bf16 v[52:55], v[172:175], v[108:111], v[52:55]
  buffer_load_dwordx4 v[136:139], v0, s[52:55], s34 offen offset:256 sc1
  v_mfma_f32_16x16x32_bf16 v[56:59], v[168:171], v[112:115], v[56:59]
  ds_read_b128 v[92:95], v7 offset:43008
  v_mfma_f32_16x16x32_bf16 v[60:63], v[172:175], v[112:115], v[60:63]
  buffer_load_dwordx4 v[140:143], v0, s[52:55], s35 offen offset:256 sc1
  v_mfma_f32_16x16x32_bf16 v[64:67], v[168:171], v[116:119], v[64:67]
  ds_read_b128 v[96:99], v7 offset:45056
  v_mfma_f32_16x16x32_bf16 v[68:71], v[172:175], v[116:119], v[68:71]
  s_waitcnt lgkmcnt(3)
  v_mfma_f32_16x16x32_bf16 v[72:75], v[168:171], v[120:123], v[72:75]
  ds_read_b128 v[100:103], v7 offset:47104
  v_mfma_f32_16x16x32_bf16 v[76:79], v[172:175], v[120:123], v[76:79]
  v_mfma_f32_16x16x32_bf16 v[80:83], v[168:171], v[124:127], v[80:83]
  ds_read_b128 v[104:107], v7 offset:49152
  v_mfma_f32_16x16x32_bf16 v[84:87], v[172:175], v[124:127], v[84:87]
  s_waitcnt vmcnt(6)
  s_waitcnt lgkmcnt(2)
  v_mfma_f32_16x16x32_bf16 v[48:51], v[176:179], v[88:91], v[48:51]
  ds_read_b128 v[108:111], v8 offset:40960
  v_mfma_f32_16x16x32_bf16 v[52:55], v[180:183], v[88:91], v[52:55]
  buffer_load_dwordx4 v[144:147], v0, s[52:55], s34 offen offset:512 sc1
  v_mfma_f32_16x16x32_bf16 v[56:59], v[176:179], v[92:95], v[56:59]
  ds_read_b128 v[112:115], v8 offset:43008
  v_mfma_f32_16x16x32_bf16 v[60:63], v[180:183], v[92:95], v[60:63]
  buffer_load_dwordx4 v[148:151], v0, s[52:55], s35 offen offset:512 sc1
  v_mfma_f32_16x16x32_bf16 v[64:67], v[176:179], v[96:99], v[64:67]
  ds_read_b128 v[116:119], v8 offset:45056
  v_mfma_f32_16x16x32_bf16 v[68:71], v[180:183], v[96:99], v[68:71]
  s_waitcnt lgkmcnt(3)
  v_mfma_f32_16x16x32_bf16 v[72:75], v[176:179], v[100:103], v[72:75]
  ds_read_b128 v[120:123], v8 offset:47104
  v_mfma_f32_16x16x32_bf16 v[76:79], v[180:183], v[100:103], v[76:79]
  v_mfma_f32_16x16x32_bf16 v[80:83], v[176:179], v[104:107], v[80:83]
  ds_read_b128 v[124:127], v8 offset:49152
  v_mfma_f32_16x16x32_bf16 v[84:87], v[180:183], v[104:107], v[84:87]
  s_waitcnt vmcnt(6)
  s_barrier
  s_waitcnt lgkmcnt(2)
  v_mfma_f32_16x16x32_bf16 v[48:51], v[184:187], v[108:111], v[48:51]
  ds_read_b128 v[88:91], v5 offset:0
  v_mfma_f32_16x16x32_bf16 v[52:55], v[188:191], v[108:111], v[52:55]
  buffer_load_dwordx4 v[152:155], v0, s[52:55], s34 offen offset:768 sc1
  v_mfma_f32_16x16x32_bf16 v[56:59], v[184:187], v[112:115], v[56:59]
  ds_read_b128 v[92:95], v5 offset:2048
  v_mfma_f32_16x16x32_bf16 v[60:63], v[188:191], v[112:115], v[60:63]
  buffer_load_dwordx4 v[156:159], v0, s[52:55], s35 offen offset:768 sc1
  v_mfma_f32_16x16x32_bf16 v[64:67], v[184:187], v[116:119], v[64:67]
  ds_read_b128 v[96:99], v5 offset:4096
  v_mfma_f32_16x16x32_bf16 v[68:71], v[188:191], v[116:119], v[68:71]
  s_waitcnt lgkmcnt(3)
  v_mfma_f32_16x16x32_bf16 v[72:75], v[184:187], v[120:123], v[72:75]
  ds_read_b128 v[100:103], v5 offset:6144
  v_mfma_f32_16x16x32_bf16 v[76:79], v[188:191], v[120:123], v[76:79]
  v_mfma_f32_16x16x32_bf16 v[80:83], v[184:187], v[124:127], v[80:83]
  ds_read_b128 v[104:107], v5 offset:8192
  v_mfma_f32_16x16x32_bf16 v[84:87], v[188:191], v[124:127], v[84:87]
  s_waitcnt vmcnt(6)
  s_waitcnt lgkmcnt(2)
  v_mfma_f32_16x16x32_bf16 v[48:51], v[128:131], v[88:91], v[48:51]
  ds_read_b128 v[108:111], v6 offset:0
  v_mfma_f32_16x16x32_bf16 v[52:55], v[132:135], v[88:91], v[52:55]
  v_mfma_f32_16x16x32_bf16 v[56:59], v[128:131], v[92:95], v[56:59]
  ds_read_b128 v[112:115], v6 offset:2048
  v_mfma_f32_16x16x32_bf16 v[60:63], v[132:135], v[92:95], v[60:63]
  v_mfma_f32_16x16x32_bf16 v[64:67], v[128:131], v[96:99], v[64:67]
  ds_read_b128 v[116:119], v6 offset:4096
  v_mfma_f32_16x16x32_bf16 v[68:71], v[132:135], v[96:99], v[68:71]
  s_waitcnt lgkmcnt(3)
  v_mfma_f32_16x16x32_bf16 v[72:75], v[128:131], v[100:103], v[72:75]
  ds_read_b128 v[120:123], v6 offset:6144
  v_mfma_f32_16x16x32_bf16 v[76:79], v[132:135], v[100:103], v[76:79]
  v_mfma_f32_16x16x32_bf16 v[80:83], v[128:131], v[104:107], v[80:83]
  ds_read_b128 v[124:127], v6 offset:8192
  v_mfma_f32_16x16x32_bf16 v[84:87], v[132:135], v[104:107], v[84:87]
  s_waitcnt vmcnt(4)
  s_waitcnt lgkmcnt(2)
  v_mfma_f32_16x16x32_bf16 v[48:51], v[136:139], v[108:111], v[48:51]
  ds_read_b128 v[88:91], v5 offset:10240
  v_mfma_f32_16x16x32_bf16 v[52:55], v[140:143], v[108:111], v[52:55]
  v_accvgpr_read_b32 v11, a245
  s_and_b32 exec_lo, s96, 0x3fffffff
  s_mov_b32 exec_hi, 0
  buffer_load_dword a250, v11, s[52:55], 0 offen
  s_mov_b64 exec, -1
  v_mfma_f32_16x16x32_bf16 v[56:59], v[136:139], v[112:115], v[56:59]
  ds_read_b128 v[92:95], v5 offset:12288
  v_mfma_f32_16x16x32_bf16 v[60:63], v[140:143], v[112:115], v[60:63]
  v_mfma_f32_16x16x32_bf16 v[64:67], v[136:139], v[116:119], v[64:67]
  ds_read_b128 v[96:99], v5 offset:14336
  v_mfma_f32_16x16x32_bf16 v[68:71], v[140:143], v[116:119], v[68:71]
  s_waitcnt lgkmcnt(3)
  v_mfma_f32_16x16x32_bf16 v[72:75], v[136:139], v[120:123], v[72:75]
  ds_read_b128 v[100:103], v5 offset:16384
  v_mfma_f32_16x16x32_bf16 v[76:79], v[140:143], v[120:123], v[76:79]
  v_mfma_f32_16x16x32_bf16 v[80:83], v[136:139], v[124:127], v[80:83]
  ds_read_b128 v[104:107], v5 offset:18432
  v_mfma_f32_16x16x32_bf16 v[84:87], v[140:143], v[124:127], v[84:87]
  s_waitcnt vmcnt(2)
  s_waitcnt lgkmcnt(2)
  v_mfma_f32_16x16x32_bf16 v[48:51], v[144:147], v[88:91], v[48:51]
  ds_read_b128 v[108:111], v6 offset:10240
  v_mfma_f32_16x16x32_bf16 v[52:55], v[148:151], v[88:91], v[52:55]
  v_mfma_f32_16x16x32_bf16 v[56:59], v[144:147], v[92:95], v[56:59]
  ds_read_b128 v[112:115], v6 offset:12288
  v_mfma_f32_16x16x32_bf16 v[60:63], v[148:151], v[92:95], v[60:63]
  v_mfma_f32_16x16x32_bf16 v[64:67], v[144:147], v[96:99], v[64:67]
  ds_read_b128 v[116:119], v6 offset:14336
  v_mfma_f32_16x16x32_bf16 v[68:71], v[148:151], v[96:99], v[68:71]
  s_waitcnt lgkmcnt(3)
  v_mfma_f32_16x16x32_bf16 v[72:75], v[144:147], v[100:103], v[72:75]
  ds_read_b128 v[120:123], v6 offset:16384
  v_mfma_f32_16x16x32_bf16 v[76:79], v[148:151], v[100:103], v[76:79]
  v_mfma_f32_16x16x32_bf16 v[80:83], v[144:147], v[104:107], v[80:83]
  ds_read_b128 v[124:127], v6 offset:18432
  v_mfma_f32_16x16x32_bf16 v[84:87], v[148:151], v[104:107], v[84:87]
  s_waitcnt vmcnt(0)
  s_waitcnt lgkmcnt(2)
  v_mfma_f32_16x16x32_bf16 v[48:51], v[152:155], v[108:111], v[48:51]
  v_mfma_f32_16x16x32_bf16 v[52:55], v[156:159], v[108:111], v[52:55]
  v_mfma_f32_16x16x32_bf16 v[56:59], v[152:155], v[112:115], v[56:59]
  v_mfma_f32_16x16x32_bf16 v[60:63], v[156:159], v[112:115], v[60:63]
  v_mfma_f32_16x16x32_bf16 v[64:67], v[152:155], v[116:119], v[64:67]
  v_mfma_f32_16x16x32_bf16 v[68:71], v[156:159], v[116:119], v[68:71]
  s_waitcnt lgkmcnt(0)
  v_mfma_f32_16x16x32_bf16 v[72:75], v[152:155], v[120:123], v[72:75]
  v_mfma_f32_16x16x32_bf16 v[76:79], v[156:159], v[120:123], v[76:79]
  v_mfma_f32_16x16x32_bf16 v[80:83], v[152:155], v[124:127], v[80:83]
  v_mfma_f32_16x16x32_bf16 v[84:87], v[156:159], v[124:127], v[84:87]
  v_fmac_f32 v49, v16, v48
  v_fmac_f32 v57, v17, v56
  v_fmac_f32 v65, v18, v64
  s_nop 1
  v_fmac_f32 v73, v19, v72
  s_nop 0
  v_fmac_f32 v81, v20, v80
  v_fmac_f32_dpp v49, v48, v21 quad_perm:[1,0,3,2] row_mask:0xf bank_mask:0xf
  v_fmac_f32_dpp v57, v56, v22 quad_perm:[1,0,3,2] row_mask:0xf bank_mask:0xf
  v_fmac_f32_dpp v65, v64, v23 quad_perm:[1,0,3,2] row_mask:0xf bank_mask:0xf
  v_fmac_f32_dpp v73, v72, v24 quad_perm:[1,0,3,2] row_mask:0xf bank_mask:0xf
  v_fmac_f32_dpp v81, v80, v25 quad_perm:[1,0,3,2] row_mask:0xf bank_mask:0xf
  v_fmac_f32 v50, v16, v49
  v_fmac_f32 v58, v17, v57
  v_fmac_f32 v66, v18, v65
  v_fmac_f32 v74, v19, v73
  v_fmac_f32_e64 v82, v20, v81
  v_fmac_f32_dpp v50, v49, v21 quad_perm:[1,0,3,2] row_mask:0xf bank_mask:0xf
  v_fmac_f32_dpp v58, v57, v22 quad_perm:[1,0,3,2] row_mask:0xf bank_mask:0xf
  v_fmac_f32_dpp v66, v65, v23 quad_perm:[1,0,3,2] row_mask:0xf bank_mask:0xf
  v_fmac_f32_dpp v74, v73, v24 quad_perm:[1,0,3,2] row_mask:0xf bank_mask:0xf
  v_fmac_f32_dpp v82, v81, v25 quad_perm:[1,0,3,2] row_mask:0xf bank_mask:0xf
  v_fmac_f32 v51, v16, v50
  v_fmac_f32 v59, v17, v58
  v_fmac_f32 v67, v18, v66
  v_fmac_f32 v75, v19, v74
  v_fmac_f32_e64 v83, v20, v82
  v_fmac_f32_dpp v51, v50, v21 quad_perm:[1,0,3,2] row_mask:0xf bank_mask:0xf
  v_fmac_f32_dpp v59, v58, v22 quad_perm:[1,0,3,2] row_mask:0xf bank_mask:0xf
  v_fmac_f32_dpp v67, v66, v23 quad_perm:[1,0,3,2] row_mask:0xf bank_mask:0xf
  v_fmac_f32_dpp v75, v74, v24 quad_perm:[1,0,3,2] row_mask:0xf bank_mask:0xf
  v_fmac_f32_dpp v83, v82, v25 quad_perm:[1,0,3,2] row_mask:0xf bank_mask:0xf
  v_fmac_f32 v52, v16, v51
  v_fmac_f32 v60, v17, v59
  v_fmac_f32 v68, v18, v67
  v_fmac_f32 v76, v19, v75
  v_fmac_f32_e64 v84, v20, v83
  v_fmac_f32_dpp v52, v51, v21 quad_perm:[1,0,3,2] row_mask:0xf bank_mask:0xf
  v_fmac_f32_dpp v60, v59, v22 quad_perm:[1,0,3,2] row_mask:0xf bank_mask:0xf
  v_fmac_f32_dpp v68, v67, v23 quad_perm:[1,0,3,2] row_mask:0xf bank_mask:0xf
  v_fmac_f32_dpp v76, v75, v24 quad_perm:[1,0,3,2] row_mask:0xf bank_mask:0xf
  v_fmac_f32_dpp v84, v83, v25 quad_perm:[1,0,3,2] row_mask:0xf bank_mask:0xf
  v_fmac_f32 v53, v16, v52
  v_fmac_f32 v61, v17, v60
  v_fmac_f32 v69, v18, v68
  v_fmac_f32 v77, v19, v76
  v_fmac_f32_e64 v85, v20, v84
  v_fmac_f32_dpp v53, v52, v21 quad_perm:[1,0,3,2] row_mask:0xf bank_mask:0xf
  v_fmac_f32_dpp v61, v60, v22 quad_perm:[1,0,3,2] row_mask:0xf bank_mask:0xf
  v_fmac_f32_dpp v69, v68, v23 quad_perm:[1,0,3,2] row_mask:0xf bank_mask:0xf
  v_fmac_f32_dpp v77, v76, v24 quad_perm:[1,0,3,2] row_mask:0xf bank_mask:0xf
  v_fmac_f32_dpp v85, v84, v25 quad_perm:[1,0,3,2] row_mask:0xf bank_mask:0xf
  v_fmac_f32 v54, v16, v53
  v_fmac_f32 v62, v17, v61
  v_fmac_f32 v70, v18, v69
  v_fmac_f32 v78, v19, v77
  v_fmac_f32_e64 v86, v20, v85
  v_fmac_f32_dpp v54, v53, v21 quad_perm:[1,0,3,2] row_mask:0xf bank_mask:0xf
  v_fmac_f32_dpp v62, v61, v22 quad_perm:[1,0,3,2] row_mask:0xf bank_mask:0xf
  v_fmac_f32_dpp v70, v69, v23 quad_perm:[1,0,3,2] row_mask:0xf bank_mask:0xf
  v_fmac_f32_dpp v78, v77, v24 quad_perm:[1,0,3,2] row_mask:0xf bank_mask:0xf
  v_fmac_f32_dpp v86, v85, v25 quad_perm:[1,0,3,2] row_mask:0xf bank_mask:0xf
  v_fmac_f32 v55, v16, v54
  v_fmac_f32 v63, v17, v62
  v_fmac_f32 v71, v18, v70
  v_fmac_f32 v79, v19, v78
  v_fmac_f32_e64 v87, v20, v86
  v_fmac_f32_dpp v55, v54, v21 quad_perm:[1,0,3,2] row_mask:0xf bank_mask:0xf
  v_fmac_f32_dpp v63, v62, v22 quad_perm:[1,0,3,2] row_mask:0xf bank_mask:0xf
  v_fmac_f32_dpp v71, v70, v23 quad_perm:[1,0,3,2] row_mask:0xf bank_mask:0xf
  v_fmac_f32_dpp v79, v78, v24 quad_perm:[1,0,3,2] row_mask:0xf bank_mask:0xf
  v_fmac_f32_dpp v87, v86, v25 quad_perm:[1,0,3,2] row_mask:0xf bank_mask:0xf
  v_add_u32 v11, 152320, v9
  v_min_u32 v12, 39, v1
  v_mul_u32_u24 v44, 48, v12
  s_lshl_b32 s12, s7, 3
  s_add_u32 s12, s12, 149504
  v_add_u32 v44, s12, v44
  ds_write_b32 v11, v55 offset:0
  ds_write_b32 v11, v63 offset:1152
  ds_write_b32 v11, v71 offset:2304
  ds_write_b32 v11, v79 offset:3456
  ds_write_b32 v11, v87 offset:4608
  v_mul_u32_u24 v46, 144, v12
  v_add_u32 v46, 152320, v46
  s_waitcnt lgkmcnt(0)
  s_barrier
  ds_read_b128 v[90:93], v46 offset:0
  ds_read_b128 v[94:97], v46 offset:16
  ds_read_b128 v[98:101], v46 offset:32
  ds_read_b128 v[102:105], v46 offset:48
  ds_read_b128 v[106:109], v46 offset:64
  ds_read_b128 v[110:113], v46 offset:80
  ds_read_b128 v[114:117], v46 offset:96
  ds_read_b128 v[118:121], v46 offset:112
  s_waitcnt lgkmcnt(7)
  v_pk_fma_f32 v[92:93], v[90:91], v[36:37], v[92:93] op_sel:[1,1,0] op_sel_hi:[0,1,1] neg_lo:[0,1,0]
  v_pk_fma_f32 v[92:93], v[90:91], v[36:37], v[92:93] op_sel:[0,0,0] op_sel_hi:[1,0,1]
  s_waitcnt lgkmcnt(6)
  v_pk_fma_f32 v[94:95], v[92:93], v[36:37], v[94:95] op_sel:[1,1,0] op_sel_hi:[0,1,1] neg_lo:[0,1,0]
  v_pk_fma_f32 v[94:95], v[92:93], v[36:37], v[94:95] op_sel:[0,0,0] op_sel_hi:[1,0,1]
  v_pk_fma_f32 v[96:97], v[94:95], v[36:37], v[96:97] op_sel:[1,1,0] op_sel_hi:[0,1,1] neg_lo:[0,1,0]
  v_pk_fma_f32 v[96:97], v[94:95], v[36:37], v[96:97] op_sel:[0,0,0] op_sel_hi:[1,0,1]
  s_waitcnt lgkmcnt(5)
  v_pk_fma_f32 v[98:99], v[96:97], v[36:37], v[98:99] op_sel:[1,1,0] op_sel_hi:[0,1,1] neg_lo:[0,1,0]
  v_pk_fma_f32 v[98:99], v[96:97], v[36:37], v[98:99] op_sel:[0,0,0] op_sel_hi:[1,0,1]
  v_pk_fma_f32 v[100:101], v[98:99], v[36:37], v[100:101] op_sel:[1,1,0] op_sel_hi:[0,1,1] neg_lo:[0,1,0]
  v_pk_fma_f32 v[100:101], v[98:99], v[36:37], v[100:101] op_sel:[0,0,0] op_sel_hi:[1,0,1]
  s_waitcnt lgkmcnt(4)
  v_pk_fma_f32 v[102:103], v[100:101], v[36:37], v[102:103] op_sel:[1,1,0] op_sel_hi:[0,1,1] neg_lo:[0,1,0]
  v_pk_fma_f32 v[102:103], v[100:101], v[36:37], v[102:103] op_sel:[0,0,0] op_sel_hi:[1,0,1]
  v_pk_fma_f32 v[104:105], v[102:103], v[36:37], v[104:105] op_sel:[1,1,0] op_sel_hi:[0,1,1] neg_lo:[0,1,0]
  v_pk_fma_f32 v[104:105], v[102:103], v[36:37], v[104:105] op_sel:[0,0,0] op_sel_hi:[1,0,1]
  s_waitcnt lgkmcnt(3)
  v_pk_fma_f32 v[106:107], v[104:105], v[36:37], v[106:107] op_sel:[1,1,0] op_sel_hi:[0,1,1] neg_lo:[0,1,0]
  v_pk_fma_f32 v[106:107], v[104:105], v[36:37], v[106:107] op_sel:[0,0,0] op_sel_hi:[1,0,1]
  v_pk_fma_f32 v[108:109], v[106:107], v[36:37], v[108:109] op_sel:[1,1,0] op_sel_hi:[0,1,1] neg_lo:[0,1,0]
  v_pk_fma_f32 v[108:109], v[106:107], v[36:37], v[108:109] op_sel:[0,0,0] op_sel_hi:[1,0,1]
  s_waitcnt lgkmcnt(2)
  v_pk_fma_f32 v[110:111], v[108:109], v[36:37], v[110:111] op_sel:[1,1,0] op_sel_hi:[0,1,1] neg_lo:[0,1,0]
  v_pk_fma_f32 v[110:111], v[108:109], v[36:37], v[110:111] op_sel:[0,0,0] op_sel_hi:[1,0,1]
  v_pk_fma_f32 v[112:113], v[110:111], v[36:37], v[112:113] op_sel:[1,1,0] op_sel_hi:[0,1,1] neg_lo:[0,1,0]
  v_pk_fma_f32 v[112:113], v[110:111], v[36:37], v[112:113] op_sel:[0,0,0] op_sel_hi:[1,0,1]
  s_waitcnt lgkmcnt(1)
  v_pk_fma_f32 v[114:115], v[112:113], v[36:37], v[114:115] op_sel:[1,1,0] op_sel_hi:[0,1,1] neg_lo:[0,1,0]
  v_pk_fma_f32 v[114:115], v[112:113], v[36:37], v[114:115] op_sel:[0,0,0] op_sel_hi:[1,0,1]
  v_pk_fma_f32 v[116:117], v[114:115], v[36:37], v[116:117] op_sel:[1,1,0] op_sel_hi:[0,1,1] neg_lo:[0,1,0]
  v_pk_fma_f32 v[116:117], v[114:115], v[36:37], v[116:117] op_sel:[0,0,0] op_sel_hi:[1,0,1]
  s_waitcnt lgkmcnt(0)
  v_pk_fma_f32 v[118:119], v[116:117], v[36:37], v[118:119] op_sel:[1,1,0] op_sel_hi:[0,1,1] neg_lo:[0,1,0]
  v_pk_fma_f32 v[118:119], v[116:117], v[36:37], v[118:119] op_sel:[0,0,0] op_sel_hi:[1,0,1]
  v_pk_fma_f32 v[120:121], v[118:119], v[36:37], v[120:121] op_sel:[1,1,0] op_sel_hi:[0,1,1] neg_lo:[0,1,0]
  v_pk_fma_f32 v[120:121], v[118:119], v[36:37], v[120:121] op_sel:[0,0,0] op_sel_hi:[1,0,1]
  v_mov_b32 v122, s8
  v_mov_b32 v123, s8
  s_add_u32 s12, s83, 337920
  s_mov_b64 exec, s[96:97]
  buffer_store_dwordx4 v[120:123], v2, s[52:55], s12 offen sc1
  s_mov_b64 exec, -1
  v_subrev_u32 v46, 8576, v46
  v_mov_b32 v88, 0
  v_mov_b32 v89, 0
  s_mov_b32 exec_hi, 0xff
  s_cmp_eq_u32 s7, 1
  s_cbranch_scc1 w1_64
  s_cmp_eq_u32 s7, 2
  s_cbranch_scc1 w2_65
  s_cmp_eq_u32 s7, 3
  s_cbranch_scc1 w3_66
w0_63:
  ds_write_b128 v46, v[88:91] offset:0
  ds_write_b128 v46, v[92:95] offset:16
  s_branch join_62
w1_64:
  ds_write_b128 v46, v[96:99] offset:32
  ds_write_b128 v46, v[100:103] offset:48
  s_branch join_62
w2_65:
  ds_write_b128 v46, v[104:107] offset:64
  ds_write_b128 v46, v[108:111] offset:80
  s_branch join_62
w3_66:
  ds_write_b128 v46, v[112:115] offset:96
  ds_write_b128 v46, v[116:119] offset:112
join_62:
  s_mov_b32 exec_hi, -1
  v_add_u32 v46, 143744, v9
  ds_read_b32 v244, v46 offset:0
  ds_read_b32 v246, v46 offset:1152
  ds_read_b32 v248, v46 offset:2304
  ds_read_b32 v250, v46 offset:3456
  ds_read_b32 v252, v46 offset:4608
  v_and_b32 v43, 1, v3
  v_cvt_f32_u32 v43, v43
  v_fma_f32 v43, 2.0, v43, -1.0
  s_waitcnt lgkmcnt(0)
  s_nop 0
  v_mul_f32_dpp v245, v244, v43 quad_perm:[1,0,3,2] row_mask:0xf bank_mask:0xf
  v_mul_f32_dpp v247, v246, v43 quad_perm:[1,0,3,2] row_mask:0xf bank_mask:0xf
  v_mul_f32_dpp v249, v248, v43 quad_perm:[1,0,3,2] row_mask:0xf bank_mask:0xf
  v_mul_f32_dpp v251, v250, v43 quad_perm:[1,0,3,2] row_mask:0xf bank_mask:0xf
  v_mul_f32_dpp v253, v252, v43 quad_perm:[1,0,3,2] row_mask:0xf bank_mask:0xf
  s_and_b32 vcc_lo, s1, 7
  s_lshl_b32 vcc_lo, vcc_lo, 2
  s_add_u32 vcc_lo, vcc_lo, s7
  s_lshl_b32 vcc_lo, vcc_lo, 11
  v_lshl_add_u32 v15, v3, 7, vcc_lo
  v_min_u32 v15, L_codeend-L_pc-4, v15
  s_mov_b64 exec, 0xffff
  global_load_dword a250, v15, s[98:99]
  s_mov_b64 exec, -1
  s_lshl_b32 s90, s7, 2
  s_sub_u32 s90, 12, s90
  s_mul_i32 s90, s90, 640
  s_add_u32 s90, s90, s83
  s_add_u32 s90, s90, 327680
  v_min_u32 v42, 39, v1
  v_lshlrev_b32 v42, 4, v42
  buffer_load_dwordx3 v[88:90], v42, s[52:55], s90 offen offset:0 sc1
  buffer_load_dwordx3 v[92:94], v42, s[52:55], s90 offen offset:640 sc1
  buffer_load_dwordx3 v[96:98], v42, s[52:55], s90 offen offset:1280 sc1
  buffer_load_dwordx3 v[100:102], v42, s[52:55], s90 offen offset:1920 sc1
  s_mul_i32 s12, s7, 2560
  s_add_u32 s12, s12, 24576
  v_lshlrev_b32_e64 v11, 5, v3
  v_lshl_add_u32 v11, v4, 3, v11
  v_add_u32_e64 v11, s12, v11
  v_lshl_add_u32 v12, v1, 3, s12
  ds_write_b64 v11, a[200:201] offset:0
  ds_write_b64 v11, a[202:203] offset:512
  ds_write_b64 v11, a[204:205] offset:1024
  ds_write_b64 v11, a[206:207] offset:1536
  ds_write_b64 v11, a[208:209] offset:2048
  ds_read_b64 v[232:233], v12 offset:0
  ds_read_b64 v[234:235], v12 offset:512
  ds_read_b64 v[236:237], v12 offset:1024
  ds_read_b64 v[238:239], v12 offset:1536
  ds_read_b64 v[240:241], v12 offset:2048
  v_lshrrev_b32_e64 v11, 1, v3
  v_mul_u32_u24 v12, 80, v11
  v_add_u32 v12, 160640, v12
  v_mul_u32_u24_e64 v11, 48, v11
  v_add_u32 v11, 149504, v11
  ds_read_b128 v[128:131], v12 offset:0
  ds_read_b128 v[132:135], v12 offset:16
  ds_read_b128 v[136:139], v12 offset:32
  ds_read_b128 v[140:143], v12 offset:48
  ds_read_b128 v[144:147], v12 offset:640
  ds_read_b128 v[148:151], v12 offset:656
  ds_read_b128 v[152:155], v12 offset:672
  ds_read_b128 v[156:159], v12 offset:688
  ds_read_b128 v[160:163], v12 offset:1280
  ds_read_b128 v[164:167], v12 offset:1296
  ds_read_b128 v[168:171], v12 offset:1312
  ds_read_b128 v[172:175], v12 offset:1328
  ds_read_b128 v[176:179], v12 offset:1920
  ds_read_b128 v[180:183], v12 offset:1936
  ds_read_b128 v[184:187], v12 offset:1952
  ds_read_b128 v[188:191], v12 offset:1968
  ds_read_b128 v[104:107], v12 offset:2560
  ds_read_b128 v[108:111], v12 offset:2576
  ds_read_b128 v[112:115], v12 offset:2592
  ds_read_b128 v[116:119], v12 offset:2608
  v_accvgpr_read_b32 v254, a240
  v_accvgpr_read_b32 v255, a241
  v_accvgpr_read_b32 v47, a242
  s_waitcnt vmcnt(0)
  v_min3_u32 v14, v90, v94, s8
  v_max3_u32 v15, v90, v94, s8
  v_min3_u32 v14, v14, v98, v102
  v_max3_u32 v15, v15, v98, v102
  v_cmp_ne_u32 vcc, v14, v15
  s_cbranch_vccz ok_68
again_67:
  buffer_load_dwordx3 v[88:90], v42, s[52:55], s90 offen offset:0 sc1
  buffer_load_dwordx3 v[92:94], v42, s[52:55], s90 offen offset:640 sc1
  buffer_load_dwordx3 v[96:98], v42, s[52:55], s90 offen offset:1280 sc1
  buffer_load_dwordx3 v[100:102], v42, s[52:55], s90 offen offset:1920 sc1
  s_sub_u32 s10, s10, 1
  s_cmp_gt_i32 s10, 0
  s_waitcnt vmcnt(0)
  v_min3_u32 v14, v90, v94, s8
  v_max3_u32 v15, v90, v94, s8
  v_min3_u32 v14, v14, v98, v102
  v_max3_u32 v15, v15, v98, v102
  v_cmp_ne_u32 vcc, v14, v15
  s_cbranch_scc0 out_69
  s_cbranch_vccnz again_67
out_69:
ok_68:
  v_pk_fma_f32 v[92:93], v[88:89], v[38:39], v[92:93] op_sel:[1,1,0] op_sel_hi:[0,1,1] neg_lo:[0,1,0]
  v_pk_fma_f32 v[92:93], v[88:89], v[38:39], v[92:93] op_sel:[0,0,0] op_sel_hi:[1,0,1]
  v_pk_fma_f32 v[96:97], v[92:93], v[38:39], v[96:97] op_sel:[1,1,0] op_sel_hi:[0,1,1] neg_lo:[0,1,0]
  v_pk_fma_f32 v[96:97], v[92:93], v[38:39], v[96:97] op_sel:[0,0,0] op_sel_hi:[1,0,1]
  v_pk_fma_f32 v[100:101], v[96:97], v[38:39], v[100:101] op_sel:[1,1,0] op_sel_hi:[0,1,1] neg_lo:[0,1,0]
  v_pk_fma_f32 v[100:101], v[96:97], v[38:39], v[100:101] op_sel:[0,0,0] op_sel_hi:[1,0,1]
  v_pk_mul_f32 v[88:89], v[100:101], v[40:41] op_sel:[1,1] op_sel_hi:[0,1] neg_lo:[0,1]
  v_pk_fma_f32 v[88:89], v[100:101], v[40:41], v[88:89] op_sel:[0,0,0] op_sel_hi:[1,0,1]
  s_mov_b32 exec_hi, 0xff
  ds_write_b64 v44, v[88:89]
  s_mov_b32 exec_hi, -1
  s_waitcnt lgkmcnt(0)
  s_barrier
  ds_read_b128 v[88:91], v11 offset:0
  ds_read_b128 v[92:95], v11 offset:16
  ds_read_b128 v[96:99], v11 offset:384
  ds_read_b128 v[100:103], v11 offset:400
  ds_read_b128 v[224:227], v11 offset:768
  ds_read_b128 v[228:231], v11 offset:784
  s_waitcnt lgkmcnt(4)
  v_pk_add_f32 v[88:89], v[88:89], v[90:91]
  v_pk_add_f32 v[92:93], v[92:93], v[94:95]
  v_pk_add_f32 v[88:89], v[88:89], v[92:93]
  v_pk_fma_f32 v[244:245], v[26:27], v[88:89], v[244:245] op_sel:[0,0,0] op_sel_hi:[1,0,1]
  v_pk_fma_f32 v[244:245], v[26:27], v[88:89], v[244:245] op_sel:[1,1,0] op_sel_hi:[0,1,1] neg_hi:[1,0,0]
  ds_read_b128 v[88:91], v11 offset:1152
  ds_read_b128 v[92:95], v11 offset:1168
  s_waitcnt lgkmcnt(4)
  v_pk_add_f32 v[96:97], v[96:97], v[98:99]
  v_pk_add_f32 v[100:101], v[100:101], v[102:103]
  v_pk_add_f32 v[96:97], v[96:97], v[100:101]
  v_pk_fma_f32 v[246:247], v[28:29], v[96:97], v[246:247] op_sel:[0,0,0] op_sel_hi:[1,0,1]
  v_pk_fma_f32 v[246:247], v[28:29], v[96:97], v[246:247] op_sel:[1,1,0] op_sel_hi:[0,1,1] neg_hi:[1,0,0]
  ds_read_b128 v[96:99], v11 offset:1536
  ds_read_b128 v[100:103], v11 offset:1552
  v_pk_fma_f32 v[48:49], v[128:129], v[244:245], v[48:49] op_sel:[0,0,0] op_sel_hi:[1,0,1]
  v_pk_fma_f32 v[50:51], v[130:131], v[244:245], v[50:51] op_sel:[0,0,0] op_sel_hi:[1,0,1]
  v_pk_fma_f32 v[52:53], v[132:133], v[244:245], v[52:53] op_sel:[0,0,0] op_sel_hi:[1,0,1]
  v_pk_fma_f32 v[54:55], v[134:135], v[244:245], v[54:55] op_sel:[0,0,0] op_sel_hi:[1,0,1]
  v_pk_fma_f32 v[48:49], v[136:137], v[244:245], v[48:49] op_sel:[0,1,0] op_sel_hi:[1,1,1]
  v_pk_fma_f32 v[50:51], v[138:139], v[244:245], v[50:51] op_sel:[0,1,0] op_sel_hi:[1,1,1]
  v_pk_fma_f32 v[52:53], v[140:141], v[244:245], v[52:53] op_sel:[0,1,0] op_sel_hi:[1,1,1]
  v_pk_fma_f32 v[54:55], v[142:143], v[244:245], v[54:55] op_sel:[0,1,0] op_sel_hi:[1,1,1]
  v_cvt_pk_bf16_f32 v120, v48, v49
  v_cvt_pk_bf16_f32 v121, v50, v51
  v_cvt_pk_bf16_f32 v122, v52, v53
  v_cvt_pk_bf16_f32 v123, v54, v55
  ds_write_b128 v254, v[120:123]
  ds_read_b64_tr_b16 v[52:53], v255
  ds_read_b64_tr_b16 v[54:55], v255 offset:640
  s_waitcnt lgkmcnt(7)
  v_pk_add_f32 v[224:225], v[224:225], v[226:227]
  v_pk_add_f32 v[228:229], v[228:229], v[230:231]
  v_pk_add_f32 v[224:225], v[224:225], v[228:229]
  v_pk_fma_f32 v[248:249], v[30:31], v[224:225], v[248:249] op_sel:[0,0,0] op_sel_hi:[1,0,1]
  v_pk_fma_f32 v[248:249], v[30:31], v[224:225], v[248:249] op_sel:[1,1,0] op_sel_hi:[0,1,1] neg_hi:[1,0,0]
  v_pk_fma_f32 v[56:57], v[144:145], v[246:247], v[56:57] op_sel:[0,0,0] op_sel_hi:[1,0,1]
  v_pk_fma_f32 v[58:59], v[146:147], v[246:247], v[58:59] op_sel:[0,0,0] op_sel_hi:[1,0,1]
  v_pk_fma_f32 v[60:61], v[148:149], v[246:247], v[60:61] op_sel:[0,0,0] op_sel_hi:[1,0,1]
  v_pk_fma_f32 v[62:63], v[150:151], v[246:247], v[62:63] op_sel:[0,0,0] op_sel_hi:[1,0,1]
  v_pk_fma_f32 v[56:57], v[152:153], v[246:247], v[56:57] op_sel:[0,1,0] op_sel_hi:[1,1,1]
  v_pk_fma_f32 v[58:59], v[154:155], v[246:247], v[58:59] op_sel:[0,1,0] op_sel_hi:[1,1,1]
  v_pk_fma_f32 v[60:61], v[156:157], v[246:247], v[60:61] op_sel:[0,1,0] op_sel_hi:[1,1,1]
  v_pk_fma_f32 v[62:63], v[158:159], v[246:247], v[62:63] op_sel:[0,1,0] op_sel_hi:[1,1,1]
  v_cvt_pk_bf16_f32 v124, v56, v57
  v_cvt_pk_bf16_f32 v125, v58, v59
  v_cvt_pk_bf16_f32 v126, v60, v61
  v_cvt_pk_bf16_f32 v127, v62, v63
  ds_write_b128 v254, v[124:127]
  ds_read_b64_tr_b16 v[60:61], v255
  ds_read_b64_tr_b16 v[62:63], v255 offset:640
  s_waitcnt lgkmcnt(8)
  v_pk_add_f32 v[88:89], v[88:89], v[90:91]
  v_pk_add_f32 v[92:93], v[92:93], v[94:95]
  v_pk_add_f32 v[88:89], v[88:89], v[92:93]
  v_pk_fma_f32 v[250:251], v[32:33], v[88:89], v[250:251] op_sel:[0,0,0] op_sel_hi:[1,0,1]
  v_pk_fma_f32 v[250:251], v[32:33], v[88:89], v[250:251] op_sel:[1,1,0] op_sel_hi:[0,1,1] neg_hi:[1,0,0]
  s_add_u32 s13, s78, 0
  s_waitcnt lgkmcnt(3)
  s_cmp_eq_u32 s9, 0
  s_cbranch_scc1 slow_70
  buffer_store_dwordx4 v[52:55], v47, s[60:63], s13 offen
back_71:
  v_pk_fma_f32 v[64:65], v[160:161], v[248:249], v[64:65] op_sel:[0,0,0] op_sel_hi:[1,0,1]
  v_pk_fma_f32 v[66:67], v[162:163], v[248:249], v[66:67] op_sel:[0,0,0] op_sel_hi:[1,0,1]
  v_pk_fma_f32 v[68:69], v[164:165], v[248:249], v[68:69] op_sel:[0,0,0] op_sel_hi:[1,0,1]
  v_pk_fma_f32 v[70:71], v[166:167], v[248:249], v[70:71] op_sel:[0,0,0] op_sel_hi:[1,0,1]
  v_pk_fma_f32 v[64:65], v[168:169], v[248:249], v[64:65] op_sel:[0,1,0] op_sel_hi:[1,1,1]
  v_pk_fma_f32 v[66:67], v[170:171], v[248:249], v[66:67] op_sel:[0,1,0] op_sel_hi:[1,1,1]
  v_pk_fma_f32 v[68:69], v[172:173], v[248:249], v[68:69] op_sel:[0,1,0] op_sel_hi:[1,1,1]
  v_pk_fma_f32 v[70:71], v[174:175], v[248:249], v[70:71] op_sel:[0,1,0] op_sel_hi:[1,1,1]
  v_cvt_pk_bf16_f32 v120, v64, v65
  v_cvt_pk_bf16_f32 v121, v66, v67
  v_cvt_pk_bf16_f32 v122, v68, v69
  v_cvt_pk_bf16_f32 v123, v70, v71
  ds_write_b128 v254, v[120:123]
  ds_read_b64_tr_b16 v[68:69], v255
  ds_read_b64_tr_b16 v[70:71], v255 offset:640
  v_pk_add_f32 v[96:97], v[96:97], v[98:99]
  v_pk_add_f32 v[100:101], v[100:101], v[102:103]
  v_pk_add_f32 v[96:97], v[96:97], v[100:101]
  v_pk_fma_f32 v[252:253], v[34:35], v[96:97], v[252:253] op_sel:[0,0,0] op_sel_hi:[1,0,1]
  v_pk_fma_f32 v[252:253], v[34:35], v[96:97], v[252:253] op_sel:[1,1,0] op_sel_hi:[0,1,1] neg_hi:[1,0,0]
  s_add_u32 s13, s79, 0
  s_waitcnt lgkmcnt(3)
  s_cmp_eq_u32 s9, 0
  s_cbranch_scc1 slow_72
  buffer_store_dwordx4 v[60:63], v47, s[60:63], s13 offen
back_73:
  v_pk_fma_f32 v[72:73], v[176:177], v[250:251], v[72:73] op_sel:[0,0,0] op_sel_hi:[1,0,1]
  v_pk_fma_f32 v[74:75], v[178:179], v[250:251], v[74:75] op_sel:[0,0,0] op_sel_hi:[1,0,1]
  v_pk_fma_f32 v[76:77], v[180:181], v[250:251], v[76:77] op_sel:[0,0,0] op_sel_hi:[1,0,1]
  v_pk_fma_f32 v[78:79], v[182:183], v[250:251], v[78:79] op_sel:[0,0,0] op_sel_hi:[1,0,1]
  v_pk_fma_f32 v[72:73], v[184:185], v[250:251], v[72:73] op_sel:[0,1,0] op_sel_hi:[1,1,1]
  v_pk_fma_f32 v[74:75], v[186:187], v[250:251], v[74:75] op_sel:[0,1,0] op_sel_hi:[1,1,1]
  v_pk_fma_f32 v[76:77], v[188:189], v[250:251], v[76:77] op_sel:[0,1,0] op_sel_hi:[1,1,1]
  v_pk_fma_f32 v[78:79], v[190:191], v[250:251], v[78:79] op_sel:[0,1,0] op_sel_hi:[1,1,1]
  v_cvt_pk_bf16_f32 v124, v72, v73
  v_cvt_pk_bf16_f32 v125, v74, v75
  v_cvt_pk_bf16_f32 v126, v76, v77
  v_cvt_pk_bf16_f32 v127, v78, v79
  ds_write_b128 v254, v[124:127]
  ds_read_b64_tr_b16 v[76:77], v255
  ds_read_b64_tr_b16 v[78:79], v255 offset:640
  s_add_u32 s13, s80, 0
  s_waitcnt lgkmcnt(3)
  s_cmp_eq_u32 s9, 0
  s_cbranch_scc1 slow_74
  buffer_store_dwordx4 v[68:71], v47, s[60:63], s13 offen
back_75:
  v_pk_fma_f32 v[80:81], v[104:105], v[252:253], v[80:81] op_sel:[0,0,0] op_sel_hi:[1,0,1]
  v_pk_fma_f32 v[82:83], v[106:107], v[252:253], v[82:83] op_sel:[0,0,0] op_sel_hi:[1,0,1]
  v_pk_fma_f32 v[84:85], v[108:109], v[252:253], v[84:85] op_sel:[0,0,0] op_sel_hi:[1,0,1]
  v_pk_fma_f32 v[86:87], v[110:111], v[252:253], v[86:87] op_sel:[0,0,0] op_sel_hi:[1,0,1]
  v_pk_fma_f32 v[80:81], v[112:113], v[252:253], v[80:81] op_sel:[0,1,0] op_sel_hi:[1,1,1]
  v_pk_fma_f32 v[82:83], v[114:115], v[252:253], v[82:83] op_sel:[0,1,0] op_sel_hi:[1,1,1]
  v_pk_fma_f32 v[84:85], v[116:117], v[252:253], v[84:85] op_sel:[0,1,0] op_sel_hi:[1,1,1]
  v_pk_fma_f32 v[86:87], v[118:119], v[252:253], v[86:87] op_sel:[0,1,0] op_sel_hi:[1,1,1]
  v_cvt_pk_bf16_f32 v120, v80, v81
  v_cvt_pk_bf16_f32 v121, v82, v83
  v_cvt_pk_bf16_f32 v122, v84, v85
  v_cvt_pk_bf16_f32 v123, v86, v87
  ds_write_b128 v254, v[120:123]
  ds_read_b64_tr_b16 v[84:85], v255
  ds_read_b64_tr_b16 v[86:87], v255 offset:640
  s_add_u32 s13, s81, 0
  s_waitcnt lgkmcnt(3)
  s_cmp_eq_u32 s9, 0
  s_cbranch_scc1 slow_76
  buffer_store_dwordx4 v[76:79], v47, s[60:63], s13 offen
back_77:
  s_add_u32 s13, s82, 0
  s_waitcnt lgkmcnt(0)
  s_cmp_eq_u32 s9, 0
  s_cbranch_scc1 slow_78
  buffer_store_dwordx4 v[84:87], v47, s[60:63], s13 offen
back_79:
  s_mul_i32 s13, s5, 163840
  s_mul_i32 s14, s7, 10240
  s_add_u32 s13, s13, s14
  s_add_u32 s13, s13, 0
  s_add_u32 s14, s7, 1
  s_and_b32 s14, s14, 3
  s_mul_i32 s15, s14, 40960
  s_add_u32 s16, s15, s13
  s_mul_i32 s15, s14, 10240
  s_add_u32 s15, s15, 102400
  v_add_u32 v44, s15, v2
  s_add_u32 s14, s7, 2
  s_and_b32 s14, s14, 3
  s_mul_i32 s15, s14, 40960
  s_add_u32 s17, s15, s13
  s_mul_i32 s15, s14, 10240
  s_add_u32 s15, s15, 107520
  v_add_u32 v45, s15, v2
  s_add_u32 s14, s7, 3
  s_and_b32 s14, s14, 3
  s_mul_i32 s15, s14, 40960
  s_add_u32 s18, s15, s13
  s_mul_i32 s15, s14, 5120
  v_add_u32 v46, s15, v2
  s_add_u32 s14, s7, 4
  s_and_b32 s14, s14, 3
  s_mul_i32 s15, s14, 40960
  s_add_u32 s19, s15, s13
  s_lshl_b32 s49, s3, 10
  s_lshl_b32 s13, s7, 6
  s_add_u32 s49, s49, s13
  s_and_b32 s13, s5, 1
  s_lshl_b32 s13, s13, 3
  s_add_u32 s49, s49, s13
  s_add_u32 s49, s49, 4608
  v_and_b32 v244, 3, v1
  v_lshlrev_b32 v244, 4, v244
  s_waitcnt vmcnt(0)
  s_add_u32 s14, s84, 4608
  v_mov_b32 v15, s8
  s_mov_b64 exec, 1
  s_cmp_eq_u32 s9, 0
  s_cbranch_scc1 slow_80
  buffer_store_dword v15, off, s[52:55], s14
back_81:
  s_mov_b64 exec, -1
again_82:
  buffer_load_dwordx2 v[42:43], v244, s[52:55], s49 offen sc1
  s_sub_u32 s10, s10, 1
  s_cmp_gt_i32 s10, 0
  s_waitcnt vmcnt(0)
  v_xor_b32 v15, s8, v42
  v_xor_b32 v14, s8, v43
  v_or_b32 v15, v15, v14
  v_cmp_ne_u32 vcc, 0, v15
  s_cbranch_scc0 out_84
  s_cbranch_vccnz again_82
out_84:
ok_83:
  buffer_load_dwordx4 v[128:131], v2, s[60:63], s16 offen offset:0 sc1
  buffer_load_dwordx4 v[132:135], v2, s[60:63], s16 offen offset:1024 sc1
  buffer_load_dwordx4 v[136:139], v2, s[60:63], s16 offen offset:2048 sc1
  buffer_load_dwordx4 v[140:143], v2, s[60:63], s16 offen offset:3072 sc1
  s_add_u32 s16, s16, 4096
  buffer_load_dwordx4 v[144:147], v2, s[60:63], s16 offen offset:0 sc1
  buffer_load_dwordx4 v[148:151], v2, s[60:63], s16 offen offset:1024 sc1
  buffer_load_dwordx4 v[152:155], v2, s[60:63], s16 offen offset:2048 sc1
  buffer_load_dwordx4 v[156:159], v2, s[60:63], s16 offen offset:3072 sc1
  s_waitcnt vmcnt(7)
  v_mfma_f32_16x16x32_bf16 v[48:51], a[0:3], v[128:131], 0
  s_add_u32 s16, s16, 4096
  buffer_load_dwordx4 v[160:163], v2, s[60:63], s16 offen offset:0 sc1
  v_mfma_f32_16x16x32_bf16 v[52:55], a[4:7], v[128:131], 0
  v_mfma_f32_16x16x32_bf16 v[56:59], a[8:11], v[128:131], 0
  v_mfma_f32_16x16x32_bf16 v[60:63], a[12:15], v[128:131], 0
  v_mfma_f32_16x16x32_bf16 v[64:67], a[16:19], v[128:131], 0
  s_waitcnt vmcnt(7)
  v_mfma_f32_16x16x32_bf16 v[48:51], a[20:23], v[132:135], v[48:51]
  buffer_load_dwordx4 v[164:167], v2, s[60:63], s16 offen offset:1024 sc1
  v_mfma_f32_16x16x32_bf16 v[52:55], a[24:27], v[132:135], v[52:55]
  v_accvgpr_read_b32 v108, a210
  v_mfma_f32_16x16x32_bf16 v[56:59], a[28:31], v[132:135], v[56:59]
  v_accvgpr_read_b32 v109, a211
  v_mfma_f32_16x16x32_bf16 v[60:63], a[32:35], v[132:135], v[60:63]
  v_accvgpr_read_b32 v110, a212
  v_mfma_f32_16x16x32_bf16 v[64:67], a[36:39], v[132:135], v[64:67]
  s_waitcnt vmcnt(7)
  v_mfma_f32_16x16x32_bf16 v[48:51], a[40:43], v[136:139], v[48:51]
  buffer_load_dwordx4 v[168:171], v2, s[60:63], s17 offen offset:0 sc1
  v_mfma_f32_16x16x32_bf16 v[52:55], a[44:47], v[136:139], v[52:55]
  v_accvgpr_read_b32 v111, a213
  v_mfma_f32_16x16x32_bf16 v[56:59], a[48:51], v[136:139], v[56:59]
  v_accvgpr_read_b32 v112, a214
  v_mfma_f32_16x16x32_bf16 v[60:63], a[52:55], v[136:139], v[60:63]
  v_accvgpr_read_b32 v113, a215
  v_mfma_f32_16x16x32_bf16 v[64:67], a[56:59], v[136:139], v[64:67]
  s_waitcnt vmcnt(7)
  v_mfma_f32_16x16x32_bf16 v[48:51], a[60:63], v[140:143], v[48:51]
  buffer_load_dwordx4 v[172:175], v2, s[60:63], s17 offen offset:1024 sc1
  v_mfma_f32_16x16x32_bf16 v[52:55], a[64:67], v[140:143], v[52:55]
  v_accvgpr_read_b32 v114, a216
  v_mfma_f32_16x16x32_bf16 v[56:59], a[68:71], v[140:143], v[56:59]
  v_accvgpr_read_b32 v115, a217
  v_mfma_f32_16x16x32_bf16 v[60:63], a[72:75], v[140:143], v[60:63]
  v_accvgpr_read_b32 v116, a218
  v_mfma_f32_16x16x32_bf16 v[64:67], a[76:79], v[140:143], v[64:67]
  s_waitcnt vmcnt(7)
  v_mfma_f32_16x16x32_bf16 v[48:51], a[80:83], v[144:147], v[48:51]
  buffer_load_dwordx4 v[176:179], v2, s[60:63], s17 offen offset:2048 sc1
  v_mfma_f32_16x16x32_bf16 v[52:55], a[84:87], v[144:147], v[52:55]
  v_accvgpr_read_b32 v117, a219
  v_mfma_f32_16x16x32_bf16 v[56:59], a[88:91], v[144:147], v[56:59]
  v_accvgpr_read_b32 v118, a220
  v_mfma_f32_16x16x32_bf16 v[60:63], a[92:95], v[144:147], v[60:63]
  v_accvgpr_read_b32 v119, a221
  v_mfma_f32_16x16x32_bf16 v[64:67], a[96:99], v[144:147], v[64:67]
  s_waitcnt vmcnt(7)
  v_mfma_f32_16x16x32_bf16 v[48:51], a[100:103], v[148:151], v[48:51]
  buffer_load_dwordx4 v[180:183], v2, s[60:63], s17 offen offset:3072 sc1
  v_mfma_f32_16x16x32_bf16 v[52:55], a[104:107], v[148:151], v[52:55]
  v_accvgpr_read_b32 v120, a222
  v_mfma_f32_16x16x32_bf16 v[56:59], a[108:111], v[148:151], v[56:59]
  v_accvgpr_read_b32 v121, a223
  v_mfma_f32_16x16x32_bf16 v[60:63], a[112:115], v[148:151], v[60:63]
  v_accvgpr_read_b32 v122, a224
  v_mfma_f32_16x16x32_bf16 v[64:67], a[116:119], v[148:151], v[64:67]
  s_waitcnt vmcnt(7)
  v_mfma_f32_16x16x32_bf16 v[48:51], a[120:123], v[152:155], v[48:51]
  s_add_u32 s17, s17, 4096
  buffer_load_dwordx4 v[184:187], v2, s[60:63], s17 offen offset:0 sc1
  v_mfma_f32_16x16x32_bf16 v[52:55], a[124:127], v[152:155], v[52:55]
  v_accvgpr_read_b32 v123, a225
  v_mfma_f32_16x16x32_bf16 v[56:59], a[128:131], v[152:155], v[56:59]
  v_accvgpr_read_b32 v124, a226
  v_mfma_f32_16x16x32_bf16 v[60:63], a[132:135], v[152:155], v[60:63]
  v_accvgpr_read_b32 v125, a227
  v_mfma_f32_16x16x32_bf16 v[64:67], a[136:139], v[152:155], v[64:67]
  s_waitcnt vmcnt(7)
  v_mfma_f32_16x16x32_bf16 v[48:51], a[140:143], v[156:159], v[48:51]
  buffer_load_dwordx4 v[188:191], v2, s[60:63], s17 offen offset:1024 sc1
  v_mfma_f32_16x16x32_bf16 v[52:55], a[144:147], v[156:159], v[52:55]
  v_accvgpr_read_b32 v126, a228
  v_mfma_f32_16x16x32_bf16 v[56:59], a[148:151], v[156:159], v[56:59]
  v_accvgpr_read_b32 v127, a229
  v_mfma_f32_16x16x32_bf16 v[60:63], a[152:155], v[156:159], v[60:63]
  v_lshlrev_b32_e64 v88, 16, v232
  v_mfma_f32_16x16x32_bf16 v[64:67], a[156:159], v[156:159], v[64:67]
  s_waitcnt vmcnt(7)
  v_mfma_f32_16x16x32_bf16 v[48:51], a[160:163], v[160:163], v[48:51]
  buffer_load_dwordx4 v[128:131], v2, s[60:63], s17 offen offset:2048 sc1
  v_mfma_f32_16x16x32_bf16 v[52:55], a[164:167], v[160:163], v[52:55]
  v_and_b32 v89, 0xffff0000, v232
  v_mfma_f32_16x16x32_bf16 v[56:59], a[168:171], v[160:163], v[56:59]
  v_lshlrev_b32 v90, 16, v233
  v_mfma_f32_16x16x32_bf16 v[60:63], a[172:175], v[160:163], v[60:63]
  v_and_b32 v91, 0xffff0000, v233
  v_mfma_f32_16x16x32_bf16 v[64:67], a[176:179], v[160:163], v[64:67]
  s_waitcnt vmcnt(7)
  v_mfma_f32_16x16x32_bf16 v[48:51], a[180:183], v[164:167], v[48:51]
  buffer_load_dwordx4 v[132:135], v2, s[60:63], s17 offen offset:3072 sc1
  v_mfma_f32_16x16x32_bf16 v[52:55], a[184:187], v[164:167], v[52:55]
  v_lshlrev_b32 v92, 16, v234
  v_mfma_f32_16x16x32_bf16 v[56:59], a[188:191], v[164:167], v[56:59]
  v_and_b32 v93, 0xffff0000, v234
  v_mfma_f32_16x16x32_bf16 v[60:63], a[192:195], v[164:167], v[60:63]
  v_lshlrev_b32_e64 v94, 16, v235
  v_mfma_f32_16x16x32_bf16 v[64:67], a[196:199], v[164:167], v[64:67]
  s_waitcnt vmcnt(7)
  v_mfma_f32_16x16x32_bf16 v[68:71], a[0:3], v[168:171], 0
  s_add_u32 s17, s17, 4096
  buffer_load_dwordx4 v[136:139], v2, s[60:63], s17 offen offset:0 sc1
  v_mfma_f32_16x16x32_bf16 v[72:75], a[4:7], v[168:171], 0
  v_and_b32 v95, 0xffff0000, v235
  v_mfma_f32_16x16x32_bf16 v[76:79], a[8:11], v[168:171], 0
  v_lshlrev_b32 v96, 16, v236
  v_mfma_f32_16x16x32_bf16 v[80:83], a[12:15], v[168:171], 0
  v_and_b32 v97, 0xffff0000, v236
  v_mfma_f32_16x16x32_bf16 v[84:87], a[16:19], v[168:171], 0
  s_waitcnt vmcnt(7)
  v_mfma_f32_16x16x32_bf16 v[68:71], a[20:23], v[172:175], v[68:71]
  ds_write_b128 v44, v[48:51] offset:0
  ds_write_b128 v44, v[52:55] offset:1024
  v_mfma_f32_16x16x32_bf16 v[72:75], a[24:27], v[172:175], v[72:75]
  buffer_load_dwordx4 v[140:143], v2, s[60:63], s17 offen offset:1024 sc1
  v_mfma_f32_16x16x32_bf16 v[76:79], a[28:31], v[172:175], v[76:79]
  v_lshlrev_b32 v98, 16, v237
  v_mfma_f32_16x16x32_bf16 v[80:83], a[32:35], v[172:175], v[80:83]
  v_and_b32 v99, 0xffff0000, v237
  v_mfma_f32_16x16x32_bf16 v[84:87], a[36:39], v[172:175], v[84:87]
  v_lshlrev_b32 v100, 16, v238
  s_waitcnt vmcnt(7)
  v_mfma_f32_16x16x32_bf16 v[68:71], a[40:43], v[176:179], v[68:71]
  ds_write_b128 v44, v[56:59] offset:2048
  ds_write_b128 v44, v[60:63] offset:3072
  v_mfma_f32_16x16x32_bf16 v[72:75], a[44:47], v[176:179], v[72:75]
  buffer_load_dwordx4 v[144:147], v2, s[60:63], s18 offen offset:0 sc1
  v_mfma_f32_16x16x32_bf16 v[76:79], a[48:51], v[176:179], v[76:79]
  v_and_b32 v101, 0xffff0000, v238
  v_mfma_f32_16x16x32_bf16 v[80:83], a[52:55], v[176:179], v[80:83]
  v_lshlrev_b32_e64 v102, 16, v239
  v_mfma_f32_16x16x32_bf16 v[84:87], a[56:59], v[176:179], v[84:87]
  v_and_b32 v103, 0xffff0000, v239
  s_waitcnt vmcnt(7)
  v_mfma_f32_16x16x32_bf16 v[68:71], a[60:63], v[180:183], v[68:71]
  ds_write_b128 v44, v[64:67] offset:4096
  v_mfma_f32_16x16x32_bf16 v[72:75], a[64:67], v[180:183], v[72:75]
  buffer_load_dwordx4 v[148:151], v2, s[60:63], s18 offen offset:1024 sc1
  v_mfma_f32_16x16x32_bf16 v[76:79], a[68:71], v[180:183], v[76:79]
  v_lshlrev_b32 v104, 16, v240
  v_mfma_f32_16x16x32_bf16 v[80:83], a[72:75], v[180:183], v[80:83]
  v_and_b32 v105, 0xffff0000, v240
  v_mfma_f32_16x16x32_bf16 v[84:87], a[76:79], v[180:183], v[84:87]
  v_lshlrev_b32 v106, 16, v241
  s_waitcnt vmcnt(7)
  v_mfma_f32_16x16x32_bf16 v[68:71], a[80:83], v[184:187], v[68:71]
  buffer_load_dwordx4 v[152:155], v2, s[60:63], s18 offen offset:2048 sc1
  v_mfma_f32_16x16x32_bf16 v[72:75], a[84:87], v[184:187], v[72:75]
  v_and_b32 v107, 0xffff0000, v241
  v_mfma_f32_16x16x32_bf16 v[76:79], a[88:91], v[184:187], v[76:79]
  v_mfma_f32_16x16x32_bf16 v[80:83], a[92:95], v[184:187], v[80:83]
  v_mfma_f32_16x16x32_bf16 v[84:87], a[96:99], v[184:187], v[84:87]
  s_waitcnt vmcnt(7)
  v_mfma_f32_16x16x32_bf16 v[68:71], a[100:103], v[188:191], v[68:71]
  buffer_load_dwordx4 v[156:159], v2, s[60:63], s18 offen offset:3072 sc1
  v_mfma_f32_16x16x32_bf16 v[72:75], a[104:107], v[188:191], v[72:75]
  v_mfma_f32_16x16x32_bf16 v[76:79], a[108:111], v[188:191], v[76:79]
  v_mfma_f32_16x16x32_bf16 v[80:83], a[112:115], v[188:191], v[80:83]
  v_mfma_f32_16x16x32_bf16 v[84:87], a[116:119], v[188:191], v[84:87]
  s_waitcnt vmcnt(7)
  v_mfma_f32_16x16x32_bf16 v[68:71], a[120:123], v[128:131], v[68:71]
  s_add_u32 s18, s18, 4096
  buffer_load_dwordx4 v[160:163], v2, s[60:63], s18 offen offset:0 sc1
  v_mfma_f32_16x16x32_bf16 v[72:75], a[124:127], v[128:131], v[72:75]
  s_mul_i32 s15, s7, 10240
  v_mfma_f32_16x16x32_bf16 v[76:79], a[128:131], v[128:131], v[76:79]
  s_add_u32 s15, s15, 102400
  v_mfma_f32_16x16x32_bf16 v[80:83], a[132:135], v[128:131], v[80:83]
  v_add_u32_e64 v47, s15, v2
  v_mfma_f32_16x16x32_bf16 v[84:87], a[136:139], v[128:131], v[84:87]
  s_waitcnt vmcnt(7)
  v_mfma_f32_16x16x32_bf16 v[68:71], a[140:143], v[132:135], v[68:71]
  buffer_load_dwordx4 v[164:167], v2, s[60:63], s18 offen offset:1024 sc1
  v_mfma_f32_16x16x32_bf16 v[72:75], a[144:147], v[132:135], v[72:75]
  v_mfma_f32_16x16x32_bf16 v[76:79], a[148:151], v[132:135], v[76:79]
  v_mfma_f32_16x16x32_bf16 v[80:83], a[152:155], v[132:135], v[80:83]
  v_mfma_f32_16x16x32_bf16 v[84:87], a[156:159], v[132:135], v[84:87]
  s_waitcnt vmcnt(7)
  v_mfma_f32_16x16x32_bf16 v[68:71], a[160:163], v[136:139], v[68:71]
  buffer_load_dwordx4 v[168:171], v2, s[60:63], s18 offen offset:2048 sc1
  v_mfma_f32_16x16x32_bf16 v[72:75], a[164:167], v[136:139], v[72:75]
  v_mfma_f32_16x16x32_bf16 v[76:79], a[168:171], v[136:139], v[76:79]
  v_mfma_f32_16x16x32_bf16 v[80:83], a[172:175], v[136:139], v[80:83]
  v_mfma_f32_16x16x32_bf16 v[84:87], a[176:179], v[136:139], v[84:87]
  s_waitcnt vmcnt(7)
  v_mfma_f32_16x16x32_bf16 v[68:71], a[180:183], v[140:143], v[68:71]
  buffer_load_dwordx4 v[172:175], v2, s[60:63], s18 offen offset:3072 sc1
  v_mfma_f32_16x16x32_bf16 v[72:75], a[184:187], v[140:143], v[72:75]
  v_mfma_f32_16x16x32_bf16 v[76:79], a[188:191], v[140:143], v[76:79]
  v_mfma_f32_16x16x32_bf16 v[80:83], a[192:195], v[140:143], v[80:83]
  v_mfma_f32_16x16x32_bf16 v[84:87], a[196:199], v[140:143], v[84:87]
  s_waitcnt vmcnt(7)
  v_mfma_f32_16x16x32_bf16 v[48:51], a[0:3], v[144:147], 0
  s_add_u32 s18, s18, 4096
  buffer_load_dwordx4 v[176:179], v2, s[60:63], s18 offen offset:0 sc1
  v_mfma_f32_16x16x32_bf16 v[52:55], a[4:7], v[144:147], 0
  v_mfma_f32_16x16x32_bf16 v[56:59], a[8:11], v[144:147], 0
  v_mfma_f32_16x16x32_bf16 v[60:63], a[12:15], v[144:147], 0
  v_mfma_f32_16x16x32_bf16 v[64:67], a[16:19], v[144:147], 0
  s_waitcnt vmcnt(7)
  v_mfma_f32_16x16x32_bf16 v[48:51], a[20:23], v[148:151], v[48:51]
  ds_write_b128 v45, v[68:71] offset:0
  v_mfma_f32_16x16x32_bf16 v[52:55], a[24:27], v[148:151], v[52:55]
  ds_write_b128 v45, v[72:75] offset:1024
  v_mfma_f32_16x16x32_bf16 v[56:59], a[28:31], v[148:151], v[56:59]
  buffer_load_dwordx4 v[180:183], v2, s[60:63], s18 offen offset:1024 sc1
  v_mfma_f32_16x16x32_bf16 v[60:63], a[32:35], v[148:151], v[60:63]
  v_mfma_f32_16x16x32_bf16 v[64:67], a[36:39], v[148:151], v[64:67]
  s_waitcnt vmcnt(7)
  v_mfma_f32_16x16x32_bf16 v[48:51], a[40:43], v[152:155], v[48:51]
  ds_write_b128 v45, v[76:79] offset:2048
  v_mfma_f32_16x16x32_bf16 v[52:55], a[44:47], v[152:155], v[52:55]
  ds_write_b128 v45, v[80:83] offset:3072
  v_mfma_f32_16x16x32_bf16 v[56:59], a[48:51], v[152:155], v[56:59]
  buffer_load_dwordx4 v[184:187], v2, s[60:63], s19 offen offset:0 sc1
  v_mfma_f32_16x16x32_bf16 v[60:63], a[52:55], v[152:155], v[60:63]
  v_mfma_f32_16x16x32_bf16 v[64:67], a[56:59], v[152:155], v[64:67]
  s_waitcnt vmcnt(7)
  v_mfma_f32_16x16x32_bf16 v[48:51], a[60:63], v[156:159], v[48:51]
  ds_write_b128 v45, v[84:87] offset:4096
  v_mfma_f32_16x16x32_bf16 v[52:55], a[64:67], v[156:159], v[52:55]
  buffer_load_dwordx4 v[188:191], v2, s[60:63], s19 offen offset:1024 sc1
  v_mfma_f32_16x16x32_bf16 v[56:59], a[68:71], v[156:159], v[56:59]
  v_mfma_f32_16x16x32_bf16 v[60:63], a[72:75], v[156:159], v[60:63]
  v_mfma_f32_16x16x32_bf16 v[64:67], a[76:79], v[156:159], v[64:67]
  s_waitcnt vmcnt(7)
  v_mfma_f32_16x16x32_bf16 v[48:51], a[80:83], v[160:163], v[48:51]
  buffer_load_dwordx4 v[128:131], v2, s[60:63], s19 offen offset:2048 sc1
  s_waitcnt lgkmcnt(0)
  s_barrier
  v_mfma_f32_16x16x32_bf16 v[52:55], a[84:87], v[160:163], v[52:55]
  ds_read_b128 v[192:195], v47 offset:0
  ds_read_b128 v[196:199], v47 offset:1024
  v_mfma_f32_16x16x32_bf16 v[56:59], a[88:91], v[160:163], v[56:59]
  ds_read_b128 v[200:203], v47 offset:2048
  ds_read_b128 v[204:207], v47 offset:3072
  v_mfma_f32_16x16x32_bf16 v[60:63], a[92:95], v[160:163], v[60:63]
  ds_read_b128 v[208:211], v47 offset:4096
  ds_read_b128 v[212:215], v47 offset:5120
  v_mfma_f32_16x16x32_bf16 v[64:67], a[96:99], v[160:163], v[64:67]
  ds_read_b128 v[216:219], v47 offset:6144
  ds_read_b128 v[220:223], v47 offset:7168
  s_waitcnt vmcnt(7)
  v_mfma_f32_16x16x32_bf16 v[48:51], a[100:103], v[164:167], v[48:51]
  buffer_load_dwordx4 v[132:135], v2, s[60:63], s19 offen offset:3072 sc1
  ds_read_b128 v[224:227], v47 offset:8192
  v_mfma_f32_16x16x32_bf16 v[52:55], a[104:107], v[164:167], v[52:55]
  ds_read_b128 v[228:231], v47 offset:9216
  s_waitcnt lgkmcnt(5)
  v_mfma_f32_16x16x32_bf16 v[56:59], a[108:111], v[164:167], v[56:59]
  v_add_f32 v108, v108, v192
  v_add_f32 v109, v109, v193
  v_mfma_f32_16x16x32_bf16 v[60:63], a[112:115], v[164:167], v[60:63]
  v_add_f32 v110, v110, v194
  v_add_f32 v111, v111, v195
  v_mfma_f32_16x16x32_bf16 v[64:67], a[116:119], v[164:167], v[64:67]
  v_add_f32 v112, v112, v196
  v_add_f32 v113, v113, v197
  s_waitcnt vmcnt(7)
  v_mfma_f32_16x16x32_bf16 v[48:51], a[120:123], v[168:171], v[48:51]
  s_add_u32 s19, s19, 4096
  buffer_load_dwordx4 v[136:139], v2, s[60:63], s19 offen offset:0 sc1
  v_add_f32 v114, v114, v198
  v_mfma_f32_16x16x32_bf16 v[52:55], a[124:127], v[168:171], v[52:55]
  v_add_f32 v115, v115, v199
  v_add_f32 v116, v116, v200
  v_mfma_f32_16x16x32_bf16 v[56:59], a[128:131], v[168:171], v[56:59]
  v_add_f32 v117, v117, v201
  v_add_f32 v118, v118, v202
  v_mfma_f32_16x16x32_bf16 v[60:63], a[132:135], v[168:171], v[60:63]
  v_add_f32 v119, v119, v203
  v_add_f32 v120, v120, v204
  v_mfma_f32_16x16x32_bf16 v[64:67], a[136:139], v[168:171], v[64:67]
  v_add_f32 v121, v121, v205
  v_add_f32 v122, v122, v206
  s_waitcnt vmcnt(7)
  v_mfma_f32_16x16x32_bf16 v[48:51], a[140:143], v[172:175], v[48:51]
  buffer_load_dwordx4 v[140:143], v2, s[60:63], s19 offen offset:1024 sc1
  v_add_f32 v123, v123, v207
  v_mfma_f32_16x16x32_bf16 v[52:55], a[144:147], v[172:175], v[52:55]
  v_add_f32 v124, v124, v208
  v_add_f32 v125, v125, v209
  v_mfma_f32_16x16x32_bf16 v[56:59], a[148:151], v[172:175], v[56:59]
  v_add_f32 v126, v126, v210
  v_add_f32 v127, v127, v211
  v_mfma_f32_16x16x32_bf16 v[60:63], a[152:155], v[172:175], v[60:63]
  s_waitcnt lgkmcnt(0)
  v_add_f32 v108, v108, v212
  v_mfma_f32_16x16x32_bf16 v[64:67], a[156:159], v[172:175], v[64:67]
  v_add_f32 v109, v109, v213
  v_add_f32 v110, v110, v214
  s_waitcnt vmcnt(7)
  v_mfma_f32_16x16x32_bf16 v[48:51], a[160:163], v[176:179], v[48:51]
  buffer_load_dwordx4 v[144:147], v2, s[60:63], s19 offen offset:2048 sc1
  v_add_f32 v111, v111, v215
  v_mfma_f32_16x16x32_bf16 v[52:55], a[164:167], v[176:179], v[52:55]
  v_add_f32 v112, v112, v216
  v_add_f32 v113, v113, v217
  v_mfma_f32_16x16x32_bf16 v[56:59], a[168:171], v[176:179], v[56:59]
  v_add_f32 v114, v114, v218
  v_add_f32 v115, v115, v219
  v_mfma_f32_16x16x32_bf16 v[60:63], a[172:175], v[176:179], v[60:63]
  v_add_f32 v116, v116, v220
  v_add_f32 v117, v117, v221
  v_mfma_f32_16x16x32_bf16 v[64:67], a[176:179], v[176:179], v[64:67]
  v_add_f32 v118, v118, v222
  v_add_f32 v119, v119, v223
  s_waitcnt vmcnt(7)
  v_mfma_f32_16x16x32_bf16 v[48:51], a[180:183], v[180:183], v[48:51]
  buffer_load_dwordx4 v[148:151], v2, s[60:63], s19 offen offset:3072 sc1
  v_add_f32 v120, v120, v224
  v_mfma_f32_16x16x32_bf16 v[52:55], a[184:187], v[180:183], v[52:55]
  v_add_f32 v121, v121, v225
  v_add_f32 v122, v122, v226
  v_mfma_f32_16x16x32_bf16 v[56:59], a[188:191], v[180:183], v[56:59]
  v_add_f32 v123, v123, v227
  v_add_f32 v124, v124, v228
  v_mfma_f32_16x16x32_bf16 v[60:63], a[192:195], v[180:183], v[60:63]
  v_add_f32 v125, v125, v229
  v_add_f32 v126, v126, v230
  v_mfma_f32_16x16x32_bf16 v[64:67], a[196:199], v[180:183], v[64:67]
  v_add_f32 v127, v127, v231
  s_waitcnt vmcnt(7)
  v_mfma_f32_16x16x32_bf16 v[68:71], a[0:3], v[184:187], v[108:111]
  s_add_u32 s19, s19, 4096
  buffer_load_dwordx4 v[152:155], v2, s[60:63], s19 offen offset:0 sc1
  v_mfma_f32_16x16x32_bf16 v[72:75], a[4:7], v[184:187], v[112:115]
  v_mfma_f32_16x16x32_bf16 v[76:79], a[8:11], v[184:187], v[116:119]
  v_mfma_f32_16x16x32_bf16 v[80:83], a[12:15], v[184:187], v[120:123]
  v_mfma_f32_16x16x32_bf16 v[84:87], a[16:19], v[184:187], v[124:127]
  s_waitcnt vmcnt(7)
  v_mfma_f32_16x16x32_bf16 v[68:71], a[20:23], v[188:191], v[68:71]
  ds_write_b128 v46, v[48:51] offset:0
  v_mfma_f32_16x16x32_bf16 v[72:75], a[24:27], v[188:191], v[72:75]
  ds_write_b128 v46, v[52:55] offset:1024
  v_mfma_f32_16x16x32_bf16 v[76:79], a[28:31], v[188:191], v[76:79]
  buffer_load_dwordx4 v[156:159], v2, s[60:63], s19 offen offset:1024 sc1
  v_mfma_f32_16x16x32_bf16 v[80:83], a[32:35], v[188:191], v[80:83]
  v_mfma_f32_16x16x32_bf16 v[84:87], a[36:39], v[188:191], v[84:87]
  s_waitcnt vmcnt(7)
  v_mfma_f32_16x16x32_bf16 v[68:71], a[40:43], v[128:131], v[68:71]
  ds_write_b128 v46, v[56:59] offset:2048
  v_mfma_f32_16x16x32_bf16 v[72:75], a[44:47], v[128:131], v[72:75]
  ds_write_b128 v46, v[60:63] offset:3072
  v_mfma_f32_16x16x32_bf16 v[76:79], a[48:51], v[128:131], v[76:79]
  v_mfma_f32_16x16x32_bf16 v[80:83], a[52:55], v[128:131], v[80:83]
  v_mfma_f32_16x16x32_bf16 v[84:87], a[56:59], v[128:131], v[84:87]
  s_waitcnt vmcnt(6)
  v_mfma_f32_16x16x32_bf16 v[68:71], a[60:63], v[132:135], v[68:71]
  ds_write_b128 v46, v[64:67] offset:4096
  v_mfma_f32_16x16x32_bf16 v[72:75], a[64:67], v[132:135], v[72:75]
  v_mfma_f32_16x16x32_bf16 v[76:79], a[68:71], v[132:135], v[76:79]
  v_mfma_f32_16x16x32_bf16 v[80:83], a[72:75], v[132:135], v[80:83]
  v_mfma_f32_16x16x32_bf16 v[84:87], a[76:79], v[132:135], v[84:87]
  s_waitcnt vmcnt(5)
  v_mfma_f32_16x16x32_bf16 v[68:71], a[80:83], v[136:139], v[68:71]
  s_mul_i32 s15, s7, 5120
  v_mfma_f32_16x16x32_bf16 v[72:75], a[84:87], v[136:139], v[72:75]
  v_add_u32_e64 v47, s15, v2
  v_mfma_f32_16x16x32_bf16 v[76:79], a[88:91], v[136:139], v[76:79]
  v_mfma_f32_16x16x32_bf16 v[80:83], a[92:95], v[136:139], v[80:83]
  v_mfma_f32_16x16x32_bf16 v[84:87], a[96:99], v[136:139], v[84:87]
  s_waitcnt vmcnt(4)
  v_mfma_f32_16x16x32_bf16 v[68:71], a[100:103], v[140:143], v[68:71]
  s_waitcnt vmcnt(0)
  s_waitcnt lgkmcnt(0)
  s_barrier
  ds_read_b128 v[192:195], v47 offset:0
  v_mfma_f32_16x16x32_bf16 v[72:75], a[104:107], v[140:143], v[72:75]
  ds_read_b128 v[196:199], v47 offset:1024
  v_mfma_f32_16x16x32_bf16 v[76:79], a[108:111], v[140:143], v[76:79]
  ds_read_b128 v[200:203], v47 offset:2048
  v_mfma_f32_16x16x32_bf16 v[80:83], a[112:115], v[140:143], v[80:83]
  ds_read_b128 v[204:207], v47 offset:3072
  v_mfma_f32_16x16x32_bf16 v[84:87], a[116:119], v[140:143], v[84:87]
  ds_read_b128 v[208:211], v47 offset:4096
  v_mfma_f32_16x16x32_bf16 v[68:71], a[120:123], v[144:147], v[68:71]
  v_mfma_f32_16x16x32_bf16 v[72:75], a[124:127], v[144:147], v[72:75]
  v_mfma_f32_16x16x32_bf16 v[76:79], a[128:131], v[144:147], v[76:79]
  v_mfma_f32_16x16x32_bf16 v[80:83], a[132:135], v[144:147], v[80:83]
  v_mfma_f32_16x16x32_bf16 v[84:87], a[136:139], v[144:147], v[84:87]
  v_mfma_f32_16x16x32_bf16 v[68:71], a[140:143], v[148:151], v[68:71]
  v_mfma_f32_16x16x32_bf16 v[72:75], a[144:147], v[148:151], v[72:75]
  v_mfma_f32_16x16x32_bf16 v[76:79], a[148:151], v[148:151], v[76:79]
  v_mfma_f32_16x16x32_bf16 v[80:83], a[152:155], v[148:151], v[80:83]
  v_mfma_f32_16x16x32_bf16 v[84:87], a[156:159], v[148:151], v[84:87]
  v_mfma_f32_16x16x32_bf16 v[68:71], a[160:163], v[152:155], v[68:71]
  v_mfma_f32_16x16x32_bf16 v[72:75], a[164:167], v[152:155], v[72:75]
  v_mfma_f32_16x16x32_bf16 v[76:79], a[168:171], v[152:155], v[76:79]
  v_mfma_f32_16x16x32_bf16 v[80:83], a[172:175], v[152:155], v[80:83]
  v_mfma_f32_16x16x32_bf16 v[84:87], a[176:179], v[152:155], v[84:87]
  v_mfma_f32_16x16x32_bf16 v[68:71], a[180:183], v[156:159], v[68:71]
  v_mfma_f32_16x16x32_bf16 v[72:75], a[184:187], v[156:159], v[72:75]
  v_mfma_f32_16x16x32_bf16 v[76:79], a[188:191], v[156:159], v[76:79]
  v_mfma_f32_16x16x32_bf16 v[80:83], a[192:195], v[156:159], v[80:83]
  v_mfma_f32_16x16x32_bf16 v[84:87], a[196:199], v[156:159], v[84:87]
  s_lshl_b32 s12, s5, 15
  s_lshl_b32 s13, s7, 8
  s_add_u32 s12, s12, s13
  s_add_u32 s12, s12, 1312768
  s_lshl_b32 s13, s6, 12
  s_add_u32 s13, s13, s12
  s_waitcnt lgkmcnt(0)
  v_pk_add_f32 v[68:69], v[68:69], v[192:193]
  v_pk_add_f32 v[70:71], v[70:71], v[194:195]
  v_pk_add_f32 v[72:73], v[72:73], v[196:197]
  v_pk_add_f32 v[74:75], v[74:75], v[198:199]
  v_pk_add_f32 v[76:77], v[76:77], v[200:201]
  v_pk_add_f32 v[78:79], v[78:79], v[202:203]
  v_pk_add_f32 v[80:81], v[80:81], v[204:205]
  v_pk_add_f32 v[82:83], v[82:83], v[206:207]
  v_pk_add_f32 v[84:85], v[84:85], v[208:209]
  v_pk_add_f32 v[86:87], v[86:87], v[210:211]
  v_pk_add_f32 v[212:213], v[68:69], v[70:71]
  v_pk_mul_f32 v[214:215], v[68:69], v[68:69]
  v_pk_fma_f32 v[214:215], v[70:71], v[70:71], v[214:215]
  v_pk_add_f32 v[212:213], v[212:213], v[72:73]
  v_pk_fma_f32 v[214:215], v[72:73], v[72:73], v[214:215]
  v_pk_add_f32 v[212:213], v[212:213], v[74:75]
  v_pk_fma_f32 v[214:215], v[74:75], v[74:75], v[214:215]
  v_pk_add_f32 v[212:213], v[212:213], v[76:77]
  v_pk_fma_f32 v[214:215], v[76:77], v[76:77], v[214:215]
  v_pk_add_f32 v[212:213], v[212:213], v[78:79]
  v_pk_fma_f32 v[214:215], v[78:79], v[78:79], v[214:215]
  v_pk_add_f32 v[212:213], v[212:213], v[80:81]
  v_pk_fma_f32 v[214:215], v[80:81], v[80:81], v[214:215]
  v_pk_add_f32 v[212:213], v[212:213], v[82:83]
  v_pk_fma_f32 v[214:215], v[82:83], v[82:83], v[214:215]
  v_pk_add_f32 v[212:213], v[212:213], v[84:85]
  v_pk_fma_f32 v[214:215], v[84:85], v[84:85], v[214:215]
  v_pk_add_f32 v[212:213], v[212:213], v[86:87]
  v_pk_fma_f32 v[214:215], v[86:87], v[86:87], v[214:215]
  v_add_f32 v228, v212, v213
  v_add_f32 v229, v214, v215
  v_mov_b32 v230, s8
  v_mov_b32 v231, s8
  v_mov_b32 v212, v228
  v_mov_b32 v213, v229
  s_nop 0
  v_permlane32_swap_b32 v228, v212
  v_permlane32_swap_b32 v229, v213
  v_add_f32 v228, v228, v212
  v_add_f32 v229, v229, v213
  v_mov_b32 v212, v228
  v_mov_b32 v213, v229
  s_nop 0
  v_permlane16_swap_b32 v228, v212
  v_permlane16_swap_b32 v229, v213
  v_add_f32 v228, v228, v212
  v_add_f32 v229, v229, v213
  s_mov_b64 exec, 0xffff
  s_cmp_eq_u32 s9, 0
  s_cbranch_scc1 slow_85
  buffer_store_dwordx4 v[228:231], v2, s[52:55], s13 offen
back_86:
  s_mov_b64 exec, -1
  s_mul_i32 s14, s7, 10240
  s_add_u32 s14, s14, 102400
  v_lshrrev_b32 v12, 1, v3
  v_xor_b32 v12, v12, v4
  v_and_b32 v12, 3, v12
  v_lshlrev_b32_e64 v12, 4, v12
  v_lshl_add_u32 v12, v3, 6, v12
  v_add_u32_e64 v44, s14, v12
  ds_write_b128 v44, v[68:71] offset:0
  ds_write_b128 v44, v[72:75] offset:1024
  ds_write_b128 v44, v[76:79] offset:2048
  ds_write_b128 v44, v[80:83] offset:3072
  ds_write_b128 v44, v[84:87] offset:4096
  v_lshrrev_b32 v12, 3, v1
  v_xor_b32 v12, v12, v1
  v_and_b32 v12, 3, v12
  v_lshlrev_b32 v12, 4, v12
  v_lshrrev_b32_e64 v13, 2, v1
  v_lshl_add_u32 v12, v13, 6, v12
  v_add_u32_e64 v45, s14, v12
  ds_read_b128 v[160:163], v45 offset:0
  ds_read_b128 v[164:167], v45 offset:1024
  ds_read_b128 v[168:171], v45 offset:2048
  ds_read_b128 v[172:175], v45 offset:3072
  ds_read_b128 v[176:179], v45 offset:4096
  v_and_b32 v14, 3, v1
  v_lshlrev_b32 v11, 13, v14
  v_lshl_add_u32 v11, v13, 4, v11
  s_add_u32 s13, s12, 4096
  v_lshrrev_b32_e64 v12, 2, v13
  v_lshl_add_u32 v12, v12, 2, v13
  v_mul_u32_u24 v12, 2560, v12
  v_lshl_add_u32 v46, v14, 4, v12
  s_lshl_b32 s15, s5, 6
  s_lshr_b32 s88, s7, 1
  s_lshl_b32 s88, s88, 5
  s_add_u32 s15, s15, s88
  s_and_b32 s88, s7, 1
  s_lshl_b32 s88, s88, 2
  s_add_u32 s15, s15, s88
  s_mul_i32 s15, s15, 2560
  s_mul_i32 s88, s6, 320
  s_add_u32 s15, s15, s88
again_87:
  buffer_load_dwordx3 v[128:130], v11, s[52:55], s12 offen sc1
  buffer_load_dwordx3 v[132:134], v11, s[52:55], s13 offen sc1
  s_sub_u32 s10, s10, 1
  s_cmp_gt_i32 s10, 0
  s_waitcnt vmcnt(0)
  v_xor_b32 v15, s8, v130
  v_xor_b32 v14, s8, v134
  v_or_b32 v15, v15, v14
  v_cmp_ne_u32 vcc, 0, v15
  s_cbranch_scc0 out_89
  s_cbranch_vccnz again_87
out_89:
ok_88:
  s_waitcnt lgkmcnt(0)
  v_pk_add_f32 v[128:129], v[128:129], v[132:133]
  s_nop 1
  v_add_f32_dpp v128, v128, v128 quad_perm:[1,0,3,2] row_mask:0xf bank_mask:0xf
  v_add_f32_dpp v129, v129, v129 quad_perm:[1,0,3,2] row_mask:0xf bank_mask:0xf
  s_nop 0
  v_add_f32_dpp v128, v128, v128 quad_perm:[2,3,0,1] row_mask:0xf bank_mask:0xf
  v_add_f32_dpp v129, v129, v129 quad_perm:[2,3,0,1] row_mask:0xf bank_mask:0xf
  v_mul_f32 v128, 0x3acccccd, v128
  v_mul_f32 v202, 0x3acccccd, v129
  v_fma_f32 v202, -v128, v128, v202
  v_max_f32_e64 v202, 0, v202
  v_add_f32 v202, 0x3727c5ac, v202
  v_rsq_f32 v200, v202
  s_nop 0
  v_mul_f32_e64 v201, v128, v200
  v_pk_fma_f32 v[132:133], v[160:161], v[200:201], v[200:201] op_sel:[0,0,1] op_sel_hi:[1,0,1] neg_lo:[0,0,1] neg_hi:[0,0,1]
  v_pk_fma_f32 v[134:135], v[162:163], v[200:201], v[200:201] op_sel:[0,0,1] op_sel_hi:[1,0,1] neg_lo:[0,0,1] neg_hi:[0,0,1]
  v_pk_fma_f32 v[160:161], v[132:133], v[88:89], v[160:161]
  v_pk_fma_f32 v[162:163], v[134:135], v[90:91], v[162:163]
  s_cmp_eq_u32 s9, 0
  s_cbranch_scc1 slow_90
  buffer_store_dwordx4 v[160:163], v46, s[60:63], s15 offen offset:0
back_91:
  v_pk_fma_f32 v[136:137], v[164:165], v[200:201], v[200:201] op_sel:[0,0,1] op_sel_hi:[1,0,1] neg_lo:[0,0,1] neg_hi:[0,0,1]
  v_pk_fma_f32 v[138:139], v[166:167], v[200:201], v[200:201] op_sel:[0,0,1] op_sel_hi:[1,0,1] neg_lo:[0,0,1] neg_hi:[0,0,1]
  v_pk_fma_f32 v[164:165], v[136:137], v[92:93], v[164:165]
  v_pk_fma_f32 v[166:167], v[138:139], v[94:95], v[166:167]
  s_cmp_eq_u32 s9, 0
  s_cbranch_scc1 slow_92
  buffer_store_dwordx4 v[164:167], v46, s[60:63], s15 offen offset:64
back_93:
  v_pk_fma_f32 v[132:133], v[168:169], v[200:201], v[200:201] op_sel:[0,0,1] op_sel_hi:[1,0,1] neg_lo:[0,0,1] neg_hi:[0,0,1]
  v_pk_fma_f32 v[134:135], v[170:171], v[200:201], v[200:201] op_sel:[0,0,1] op_sel_hi:[1,0,1] neg_lo:[0,0,1] neg_hi:[0,0,1]
  v_pk_fma_f32 v[168:169], v[132:133], v[96:97], v[168:169]
  v_pk_fma_f32 v[170:171], v[134:135], v[98:99], v[170:171]
  s_cmp_eq_u32 s9, 0
  s_cbranch_scc1 slow_94
  buffer_store_dwordx4 v[168:171], v46, s[60:63], s15 offen offset:128
back_95:
  v_pk_fma_f32 v[136:137], v[172:173], v[200:201], v[200:201] op_sel:[0,0,1] op_sel_hi:[1,0,1] neg_lo:[0,0,1] neg_hi:[0,0,1]
  v_pk_fma_f32 v[138:139], v[174:175], v[200:201], v[200:201] op_sel:[0,0,1] op_sel_hi:[1,0,1] neg_lo:[0,0,1] neg_hi:[0,0,1]
  v_pk_fma_f32 v[172:173], v[136:137], v[100:101], v[172:173]
  v_pk_fma_f32 v[174:175], v[138:139], v[102:103], v[174:175]
  s_cmp_eq_u32 s9, 0
  s_cbranch_scc1 slow_96
  buffer_store_dwordx4 v[172:175], v46, s[60:63], s15 offen offset:192
back_97:
  v_pk_fma_f32 v[132:133], v[176:177], v[200:201], v[200:201] op_sel:[0,0,1] op_sel_hi:[1,0,1] neg_lo:[0,0,1] neg_hi:[0,0,1]
  v_pk_fma_f32 v[134:135], v[178:179], v[200:201], v[200:201] op_sel:[0,0,1] op_sel_hi:[1,0,1] neg_lo:[0,0,1] neg_hi:[0,0,1]
  v_pk_fma_f32 v[176:177], v[132:133], v[104:105], v[176:177]
  v_pk_fma_f32 v[178:179], v[134:135], v[106:107], v[178:179]
  s_cmp_eq_u32 s9, 0
  s_cbranch_scc1 slow_98
  buffer_store_dwordx4 v[176:179], v46, s[60:63], s15 offen offset:256
back_99:
L_end:
  s_endpgm
again_13:
  s_sub_u32 s10, s10, 1
  s_cmp_gt_i32 s10, 0
  s_cbranch_scc0 ok_14
  buffer_load_dword v184, v185, s[52:55], s89 offen sc1
  s_waitcnt vmcnt(0)
  v_xor_b32 v15, s8, v184
  v_cmp_lt_u32 vcc, 15, v15
  s_cbranch_vccz ok_14
  s_and_b32 s13, s10, 3
  s_cbranch_scc1 again_13
  buffer_load_dword v184, v185, s[52:55], s89 offen offset:128 sc1
  s_waitcnt vmcnt(0)
  v_xor_b32 v15, s8, v184
  v_cmp_lt_u32 vcc, 15, v15
  s_cbranch_vccnz again_13
  s_branch ok_14
again_15:
  s_sub_u32 s10, s10, 1
  s_cmp_gt_i32 s10, 0
  s_cbranch_scc0 ok_16
  buffer_load_dword v184, v185, s[52:55], s89 offen sc1
  s_waitcnt vmcnt(0)
  v_xor_b32 v15, s8, v184
  v_cmp_lt_u32 vcc, 15, v15
  s_cbranch_vccz ok_16
  s_and_b32 s13, s10, 3
  s_cbranch_scc1 again_15
  buffer_load_dword v184, v185, s[52:55], s89 offen offset:128 sc1
  s_waitcnt vmcnt(0)
  v_xor_b32 v15, s8, v184
  v_cmp_lt_u32 vcc, 15, v15
  s_cbranch_vccnz again_15
  s_branch ok_16
slow_17:
  buffer_store_dword v15, off, s[52:55], s41 sc1
  s_nop 1
  s_branch back_18
again_19:
  s_sub_u32 s10, s10, 1
  s_cmp_gt_i32 s10, 0
  s_cbranch_scc0 ok_20
  buffer_load_dwordx2 v[188:189], v187, s[52:55], s87 offen sc1
  s_waitcnt vmcnt(0)
  v_xor_b32 v15, s8, v188
  v_xor_b32 v14, s8, v189
  v_or_b32 v15, v15, v14
  v_cmp_ne_u32 vcc, 0, v15
  s_cbranch_vccnz again_19
  s_branch ok_20
again_21:
  s_sub_u32 s10, s10, 1
  s_cmp_gt_i32 s10, 0
  s_cbranch_scc0 ok_22
  buffer_load_dwordx3 v[152:154], v160, s[52:55], s93 offen sc1
  buffer_load_dwordx2 v[156:157], v161, s[52:55], s94 offen sc1
  buffer_load_dwordx2 v[158:159], v162, s[52:55], s94 offen offset:512 sc1
  s_waitcnt vmcnt(0)
  v_min3_u32 v15, v154, v154, s8
  v_max3_u32 v14, v154, v154, s8
  v_min3_u32 v15, v15, v157, v159
  v_max3_u32 v14, v14, v157, v159
  v_cmp_ne_u32 vcc, v15, v14
  s_cbranch_vccnz again_21
  s_branch ok_22
again_23:
  s_sub_u32 s10, s10, 1
  s_cmp_gt_i32 s10, 0
  s_cbranch_scc0 ok_24
  buffer_load_dwordx4 v[220:223], v2, s[52:55], s36 offen sc1
  s_waitcnt vmcnt(0)
  v_min3_u32 v15, v220, v221, s8
  v_max3_u32 v14, v220, v221, s8
  v_min3_u32 v15, v15, v222, v223
  v_max3_u32 v14, v14, v222, v223
  v_cmp_ne_u32 vcc, v15, v14
  s_cbranch_vccnz again_23
  s_branch ok_24
again_25:
  s_sub_u32 s10, s10, 1
  s_cmp_gt_i32 s10, 0
  s_cbranch_scc0 ok_26
  buffer_load_dwordx4 v[188:191], v187, s[52:55], s88 offen sc1
  s_waitcnt vmcnt(0)
  v_min3_u32 v15, v188, v189, s8
  v_max3_u32 v14, v188, v189, s8
  v_min3_u32 v15, v15, v190, v191
  v_max3_u32 v14, v14, v190, v191
  v_cmp_ne_u32 vcc, v15, v14
  s_cbranch_vccnz again_25
  s_branch ok_26
slow_38:
  buffer_store_dword v15, off, s[52:55], s14 sc1
  s_nop 1
  s_branch back_39
slow_41:
  buffer_store_dword v15, off, s[52:55], s14 sc1
  s_nop 1
  s_branch back_42
again_44:
  s_sub_u32 s10, s10, 1
  s_cmp_gt_i32 s10, 0
  s_cbranch_scc0 ok_45
  buffer_load_dwordx4 v[120:123], v2, s[52:55], s92 offen sc1
  s_waitcnt vmcnt(0)
  v_min3_u32 v15, v120, v121, s8
  v_max3_u32 v14, v120, v121, s8
  v_min3_u32 v15, v15, v122, v123
  v_max3_u32 v14, v14, v122, v123
  v_cmp_ne_u32 vcc, v15, v14
  s_cbranch_vccnz again_44
  s_branch ok_45
again_49:
  s_sub_u32 s10, s10, 1
  s_cmp_gt_i32 s10, 0
  s_cbranch_scc0 ok_50
  s_mul_i32 s95, s7, 10240
  s_add_u32 s95, s95, 107520
  s_and_b32 s93, s7, 1
  s_lshl_b32 s93, s93, 3
  s_add_u32 s93, s93, s95
  v_add_u32 v253, s93, v2
  s_add_u32 m0, s95, 0
  s_add_u32 s93, s92, 0
  buffer_load_dwordx4 v252, s[52:55], s93 offen sc1 lds
  s_add_u32 m0, s95, 1024
  s_add_u32 s93, s92, 65536
  buffer_load_dwordx4 v252, s[52:55], s93 offen sc1 lds
  s_add_u32 m0, s95, 2048
  s_add_u32 s93, s92, 131072
  buffer_load_dwordx4 v252, s[52:55], s93 offen sc1 lds
  s_add_u32 m0, s95, 3072
  s_add_u32 s93, s92, 196608
  buffer_load_dwordx4 v252, s[52:55], s93 offen sc1 lds
  s_add_u32 m0, s95, 4096
  s_add_u32 s93, s92, 262144
  buffer_load_dwordx4 v252, s[52:55], s93 offen sc1 lds
  s_waitcnt vmcnt(0)
  ds_read_b64_tr_b16 v[232:233], v253 offset:0
  ds_read_b64_tr_b16 v[234:235], v253 offset:1024
  ds_read_b64_tr_b16 v[236:237], v253 offset:2048
  ds_read_b64_tr_b16 v[238:239], v253 offset:3072
  ds_read_b64_tr_b16 v[240:241], v253 offset:4096
  s_waitcnt lgkmcnt(0)
  v_pk_max_u16 v15, v232, v233
  v_pk_max_u16 v15, v15, v234
  v_pk_max_u16 v15, v15, v235
  v_pk_max_u16 v15, v15, v236
  v_pk_max_u16 v15, v15, v237
  v_pk_max_u16 v15, v15, v238
  v_pk_max_u16 v15, v15, v239
  v_pk_max_u16 v15, v15, v240
  v_pk_max_u16 v15, v15, v241
  v_lshlrev_b32 v14, 16, v15
  v_max_u32 v15, v15, v14
  v_cmp_le_u32 vcc, 0xffff0000, v15
  s_cbranch_vccnz again_49
  s_branch ok_50
slow_51:
  buffer_store_dwordx4 v[228:231], v2, s[52:55], s13 offen sc1
  s_nop 1
  s_branch back_52
slow_56:
  buffer_store_dword v15, off, s[52:55], s13 sc1
  s_nop 1
  s_branch back_57
slow_70:
  buffer_store_dwordx4 v[52:55], v47, s[60:63], s13 offen sc1
  s_nop 1
  s_branch back_71
slow_72:
  buffer_store_dwordx4 v[60:63], v47, s[60:63], s13 offen sc1
  s_nop 1
  s_branch back_73
slow_74:
  buffer_store_dwordx4 v[68:71], v47, s[60:63], s13 offen sc1
  s_nop 1
  s_branch back_75
slow_76:
  buffer_store_dwordx4 v[76:79], v47, s[60:63], s13 offen sc1
  s_nop 1
  s_branch back_77
slow_78:
  buffer_store_dwordx4 v[84:87], v47, s[60:63], s13 offen sc1
  s_nop 1
  s_branch back_79
slow_80:
  buffer_store_dword v15, off, s[52:55], s14 sc1
  s_nop 1
  s_branch back_81
slow_85:
  buffer_store_dwordx4 v[228:231], v2, s[52:55], s13 offen sc1
  s_nop 1
  s_branch back_86
slow_90:
  buffer_store_dwordx4 v[160:163], v46, s[60:63], s15 offen offset:0 sc1
  s_nop 1
  s_branch back_91
slow_92:
  buffer_store_dwordx4 v[164:167], v46, s[60:63], s15 offen offset:64 sc1
  s_nop 1
  s_branch back_93
slow_94:
  buffer_store_dwordx4 v[168:171], v46, s[60:63], s15 offen offset:128 sc1
  s_nop 1
  s_branch back_95
slow_96:
  buffer_store_dwordx4 v[172:175], v46, s[60:63], s15 offen offset:192 sc1
  s_nop 1
  s_branch back_97
slow_98:
  buffer_store_dwordx4 v[176:179], v46, s[60:63], s15 offen offset:256 sc1
  s_nop 1
  s_branch back_99
  s_endpgm
L_codeend:
.section .rodata,"a"
.p2align 6
.amdhsa_kernel interleave_layers__ssm_conv_s5__ssm_conv_h3__prompt_kernel
  .amdhsa_next_free_vgpr 512
  .amdhsa_next_free_sgpr 102
  .amdhsa_accum_offset 256
  .amdhsa_group_segment_fixed_size 0
  .amdhsa_kernarg_size 144
  .amdhsa_user_sgpr_count 2
  .amdhsa_user_sgpr_kernarg_segment_ptr 1
  .amdhsa_system_sgpr_workgroup_id_x 1
.end_amdhsa_kernel
```

```asm
; @launch grid=(256,1,1) block=(256,1,1) lds=163840
.amdgcn_target "amdgcn-amd-amdhsa--gfx950"
.text
.globl interleave_layers__ssm_conv_s5__ssm_conv_h3__prompt_kernel
.p2align 8
.type interleave_layers__ssm_conv_s5__ssm_conv_h3__prompt_kernel,@function
interleave_layers__ssm_conv_s5__ssm_conv_h3__prompt_kernel:
  s_cmp_ge_u32 s2, 256
  s_cbranch_scc1 L_end
  s_load_dwordx16 s[16:31], s[0:1], 0
  s_load_dwordx16 s[32:47], s[0:1], 64
  s_load_dwordx4 s[48:51], s[0:1], 128
  v_and_b32 v1, 63, v0
  v_lshrrev_b32 v11, 6, v0
  v_lshlrev_b32 v2, 4, v1
  v_readfirstlane_b32 s7, v11
  v_and_b32 v3, 15, v1
  v_lshrrev_b32 v4, 4, v1
  s_and_b32 s12, s2, 7
  s_lshr_b32 s13, s2, 3
  s_getpc_b64 s[98:99]
L_pc:
  s_and_b32 s4, s13, 15
  s_lshr_b32 s14, s13, 4
  s_lshl_b32 s3, s12, 1
  s_add_u32 s3, s3, s14
  s_mov_b32 s0, s12
  s_mov_b32 s1, s13
  s_and_b32 vcc_lo, s1, 7
  s_lshl_b32 vcc_lo, vcc_lo, 2
  s_add_u32 vcc_lo, vcc_lo, s7
  s_lshl_b32 vcc_lo, vcc_lo, 11
  v_lshl_add_u32 v15, v3, 7, vcc_lo
  v_min_u32 v15, L_codeend-L_pc-4, v15
  s_mov_b64 exec, 0xffff
  global_load_dword a250, v15, s[98:99]
  s_mov_b64 exec, -1
  v_lshrrev_b32 v11, 3, v1
  v_and_b32_e64 v13, 7, v1
  v_mul_u32_u24 v150, 1280, v11
  v_lshl_add_u32 v150, v13, 4, v150
  s_mul_i32 s12, s1, 81920
  s_lshl_b32 s13, s0, 7
  s_add_u32 s12, s12, s13
  v_add_u32 v169, s12, v150
  s_lshl_b32 s95, s0, 5
  s_add_u32 s95, s95, s1
  s_mul_i32 s12, s95, 10240
  s_add_u32 s12, s12, 1024
  v_add_u32 v170, s12, v150
  s_cmp_eq_u32 s7, 1
  s_cbranch_scc1 w1_3
  s_cmp_eq_u32 s7, 2
  s_cbranch_scc1 w2_4
  s_cmp_eq_u32 s7, 3
  s_cbranch_scc1 w3_5
w0_2:
  s_waitcnt lgkmcnt(0)
  s_mov_b32 s60, s36
  s_and_b32 s61, s37, 0xffff
  s_mov_b32 s62, 2621440
  s_mov_b32 s63, 0x20000
  s_mov_b32 m0, 119840
  s_nop 0
  buffer_load_dwordx4 v169, s[60:63], 0 offen nt lds
  s_mov_b32 m0, 120896
  s_mov_b32 s12, 10240
  buffer_load_dwordx4 v169, s[60:63], s12 offen nt lds
  s_mov_b32 m0, 121952
  s_mov_b32 s12, 20480
  buffer_load_dwordx4 v169, s[60:63], s12 offen nt lds
  s_mov_b32 m0, 123008
  s_mov_b32 s12, 30720
  buffer_load_dwordx4 v169, s[60:63], s12 offen nt lds
  s_mov_b32 m0, 124064
  s_mov_b32 s12, 40960
  buffer_load_dwordx4 v169, s[60:63], s12 offen nt lds
  s_mov_b32 m0, 125120
  s_mov_b32 s12, 51200
  buffer_load_dwordx4 v169, s[60:63], s12 offen nt lds
  s_mov_b32 m0, 126176
  s_mov_b32 s12, 61440
  buffer_load_dwordx4 v169, s[60:63], s12 offen nt lds
  v_subrev_u32 v11, 10240, v169
  s_mov_b32 exec_lo, 0
  s_mov_b32 exec_hi, 0xffffff00
  s_mov_b32 m0, 118784
  s_nop 0
  buffer_load_dwordx4 v11, s[60:63], 0 offen nt lds
  s_mov_b64 exec, -1
  s_mov_b32 s52, s50
  s_and_b32 s53, s51, 0xffff
  s_mov_b32 s54, 41943040
  s_mov_b32 s55, 0x20000
  s_lshl_b32 s12, s3, 4
  s_add_u32 s12, s12, s4
  s_lshl_b32 s12, s12, 12
  s_add_u32 s12, s12, 1310720
  s_sub_u32 s12, s12, 0
  v_mov_b32 v11, s12
  s_lshl_b32 s12, s3, 10
  s_add_u32 s12, s12, 4096
  s_sub_u32 s12, s12, 3072
  v_cmp_lt_u32 vcc, 23, v1
  v_mov_b32 v15, s12
  s_nop 0
  v_cndmask_b32 v11, v11, v15, vcc
  s_lshl_b32 s12, s0, 11
  s_add_u32 s12, s12, 65536
  s_sub_u32 s12, s12, 3840
  v_cmp_lt_u32 vcc, 29, v1
  v_mov_b32 v15, s12
  s_nop 0
  v_cndmask_b32 v11, v11, v15, vcc
  s_lshl_b32 s12, s4, 5
  s_add_u32 s12, s12, s3
  s_mul_i32 s12, s12, 640
  s_add_u32 s12, s12, 337920
  s_sub_u32 s12, s12, 4992
  v_cmp_lt_u32 vcc, 38, v1
  v_mov_b32 v15, s12
  s_nop 0
  v_cndmask_b32 v11, v11, v15, vcc
  s_lshl_b32 s12, s4, 5
  s_add_u32 s12, s12, s3
  s_mul_i32 s12, s12, 640
  s_add_u32 s12, s12, 665600
  s_sub_u32 s12, s12, 5632
  v_cmp_lt_u32 vcc, 43, v1
  v_mov_b32 v15, s12
  s_nop 0
  v_cndmask_b32 v11, v11, v15, vcc
  s_mul_i32 s12, s4, 640
  s_add_u32 s12, s12, 303104
  s_sub_u32 s12, s12, 6272
  v_cmp_lt_u32 vcc, 48, v1
  v_mov_b32 v15, s12
  s_nop 0
  v_cndmask_b32 v11, v11, v15, vcc
  s_lshl_b32 s12, s0, 7
  s_add_u32 s12, s12, 24576
  s_sub_u32 s12, s12, 6912
  v_cmp_lt_u32 vcc, 53, v1
  v_mov_b32 v15, s12
  s_nop 0
  v_cndmask_b32 v11, v11, v15, vcc
  s_lshl_b32 s12, s0, 7
  s_add_u32 s12, s12, 32768
  s_sub_u32 s12, s12, 7040
  v_cmp_lt_u32 vcc, 54, v1
  v_mov_b32 v15, s12
  s_nop 0
  v_cndmask_b32 v11, v11, v15, vcc
  v_lshl_add_u32 v11, v1, 7, v11
  s_mov_b32 exec_hi, 16777215
  buffer_load_dword a250, v11, s[52:55], 0 offen
  s_mov_b32 exec_hi, -1
  s_branch join_1
w1_3:
  s_waitcnt lgkmcnt(0)
  v_min_u32 v11, 39, v1
  s_mul_i32 s12, s4, 80
  v_lshl_add_u32 v14, v11, 1, s12
  global_load_ushort v229, v14, s[18:19]
  global_load_ushort v230, v14, s[20:21]
  global_load_ushort v231, v14, s[30:31]
  s_mov_b32 s64, s38
  s_and_b32 s65, s39, 0xffff
  s_mov_b32 s66, 2621440
  s_mov_b32 s67, 0x20000
  s_mov_b32 m0, 132512
  s_nop 0
  buffer_load_dwordx4 v169, s[64:67], 0 offen nt lds
  s_mov_b32 m0, 133568
  s_mov_b32 s12, 10240
  buffer_load_dwordx4 v169, s[64:67], s12 offen nt lds
  s_mov_b32 m0, 134624
  s_mov_b32 s12, 20480
  buffer_load_dwordx4 v169, s[64:67], s12 offen nt lds
  s_mov_b32 m0, 135680
  s_mov_b32 s12, 30720
  buffer_load_dwordx4 v169, s[64:67], s12 offen nt lds
  s_mov_b32 m0, 136736
  s_mov_b32 s12, 40960
  buffer_load_dwordx4 v169, s[64:67], s12 offen nt lds
  s_mov_b32 m0, 137792
  s_mov_b32 s12, 51200
  buffer_load_dwordx4 v169, s[64:67], s12 offen nt lds
  s_mov_b32 m0, 138848
  s_mov_b32 s12, 61440
  buffer_load_dwordx4 v169, s[64:67], s12 offen nt lds
  s_mov_b32 m0, 139904
  s_mov_b32 s12, 71680
  buffer_load_dwordx4 v169, s[64:67], s12 offen nt lds
  s_branch join_1
w2_4:
  s_waitcnt lgkmcnt(0)
  s_mov_b32 s60, s36
  s_and_b32 s61, s37, 0xffff
  s_mov_b32 s62, 2621440
  s_mov_b32 s63, 0x20000
  s_mov_b32 s64, s38
  s_and_b32 s65, s39, 0xffff
  s_mov_b32 s66, 2621440
  s_mov_b32 s67, 0x20000
  s_mov_b32 m0, 127232
  s_mov_b32 s12, 71680
  buffer_load_dwordx4 v169, s[60:63], s12 offen nt lds
  s_mov_b32 m0, 129344
  s_nop 0
  buffer_load_dwordx4 v170, s[60:63], 0 offen nt lds
  s_mov_b32 m0, 142016
  s_nop 0
  buffer_load_dwordx4 v170, s[64:67], 0 offen nt lds
  s_mov_b32 m0, 131456
  s_mov_b32 s12, 128
  buffer_load_dwordx4 v170, s[60:63], s12 offen nt lds
  s_mov_b32 m0, 144128
  s_mov_b32 s12, 128
  buffer_load_dwordx4 v170, s[64:67], s12 offen nt lds
  v_subrev_u32 v11, 10240, v170
  s_mov_b32 exec_lo, 0
  s_mov_b32 exec_hi, 0xffffff00
  s_mov_b32 m0, 128288
  s_nop 0
  buffer_load_dwordx4 v11, s[60:63], 0 offen nt lds
  s_mov_b64 exec, -1
  v_subrev_u32 v11, 10240, v170
  s_mov_b32 exec_lo, 0
  s_mov_b32 exec_hi, 0xffffff00
  s_mov_b32 m0, 130400
  s_mov_b32 s12, 128
  buffer_load_dwordx4 v11, s[60:63], s12 offen nt lds
  s_mov_b64 exec, -1
  s_mov_b32 s64, s40
  s_and_b32 s65, s41, 0xffff
  s_mov_b32 s66, 5120
  s_mov_b32 s67, 0x20000
  s_mov_b32 m0, 143072
  s_movk_i32 s12, 4096
  buffer_load_dwordx4 v2, s[64:67], s12 offen lds
  s_mov_b32 m0, 140960
  s_lshl_b32 s12, s0, 9
  s_mov_b32 exec_hi, 0
  buffer_load_dwordx4 v2, s[64:67], s12 offen lds
  s_mov_b32 exec_hi, -1
  s_branch join_1
w3_5:
  s_waitcnt lgkmcnt(0)
  s_mov_b32 s68, s16
  s_and_b32 s69, s17, 0xffff
  s_mov_b32 s70, 2621440
  s_mov_b32 s71, 0x20000
  s_lshl_b32 s12, s3, 4
  s_add_u32 s12, s12, s4
  s_mul_i32 s12, s12, 10240
  buffer_load_dwordx4 v[48:51], v150, s[68:71], s12 offen offset:0
  buffer_load_dwordx4 v[52:55], v150, s[68:71], s12 offen offset:128
  buffer_load_dwordx4 v[56:59], v150, s[68:71], s12 offen offset:256
  buffer_load_dwordx4 v[60:63], v150, s[68:71], s12 offen offset:384
  buffer_load_dwordx4 v[64:67], v150, s[68:71], s12 offen offset:512
  buffer_load_dwordx4 v[68:71], v150, s[68:71], s12 offen offset:640
  buffer_load_dwordx4 v[72:75], v150, s[68:71], s12 offen offset:768
  buffer_load_dwordx4 v[76:79], v150, s[68:71], s12 offen offset:896
  buffer_load_dwordx4 v[80:83], v150, s[68:71], s12 offen offset:1024
  buffer_load_dwordx4 v[84:87], v150, s[68:71], s12 offen offset:1152
join_1:
  s_load_dword s8, s[50:51], 0
  s_lshl_b32 s86, s95, 1
  s_lshl_b32 s12, s86, 1
  s_load_dword s72, s[44:45], s12
  s_and_b32 s12, s95, 0xfffffffc
  s_add_u32 s12, s12, 1024
  s_load_dword s73, s[44:45], s12
  s_getreg_b32 s11, hwreg(HW_REG_XCC_ID, 0, 4)
  s_mov_b32 s10, 262144
  s_mov_b32 s2, 0x3f803f80
  v_lshrrev_b32 v11, 3, v1
  v_and_b32 v12, 6, v11
  v_and_b32 v13, 7, v1
  s_movk_i32 s15, 0x78
  v_bfe_u32 v14, s15, v12, 2
  v_xor_b32 v14, v14, v13
  v_mul_u32_u24 v146, 1280, v11
  v_lshl_add_u32 v148, v14, 4, v146
  s_and_b32 s12, s7, 1
  s_lshl_b32 s13, s12, 6
  v_xor_b32_e64 v148, s13, v148
  v_add_u32 v149, 8192, v148
  v_xor_b32 v12, v12, v13
  v_and_b32 v11, 4, v11
  v_mul_u32_u24 v11, 1280, v11
  v_lshl_add_u32 v11, v12, 4, v11
  v_add_u32_e64 v146, v11, v146
  v_add_u32 v147, 19456, v146
  s_lshr_b32 s13, s7, 1
  s_mul_i32 s75, s13, 10240
  s_lshl_b32 s12, s12, 10
  s_add_u32 s75, s75, s12
  s_mul_i32 s74, s4, 51200
  s_lshl_b32 s13, s13, 7
  s_add_u32 s74, s74, s13
  s_lshl_b32 s76, s3, 2
  s_add_u32 s76, s76, s7
  s_mul_i32 s76, s76, 40960
  s_lshl_b32 s77, s7, 11
  s_add_u32 s77, s77, 102400
  s_bitcmp1_b32 s7, 0
  s_cselect_b32 s56, s24, s22
  s_cselect_b32 s57, s25, s23
  s_and_b32 s57, s57, 0xffff
  s_mov_b32 s58, 819200
  s_mov_b32 s59, 0x20000
  s_bitcmp1_b32 s3, 3
  s_cselect_b32 s60, s24, s22
  s_cselect_b32 s61, s25, s23
  s_and_b32 s61, s61, 0xffff
  s_mov_b32 s62, 819200
  s_mov_b32 s63, 0x20000
  s_mov_b32 s68, s16
  s_and_b32 s69, s17, 0xffff
  s_mov_b32 s70, 2621440
  s_mov_b32 s71, 0x20000
  s_mov_b32 s52, s50
  s_and_b32 s53, s51, 0xffff
  s_mov_b32 s54, 41943040
  s_mov_b32 s55, 0x20000
  s_lshr_b32 s24, s95, 1
  s_add_u32 s24, s24, 512
  s_lshr_b32 s14, s4, 3
  s_lshl_b32 s5, s3, 1
  s_add_u32 s5, s5, s14
  s_and_b32 s6, s4, 7
  s_lshl_b32 s84, s3, 10
  s_lshl_b32 s13, s4, 4
  s_add_u32 s84, s84, s13
  s_lshl_b32 s13, s7, 2
  s_add_u32 s84, s84, s13
  s_lshl_b32 s85, s0, 11
  s_add_u32 s85, s85, s13
  s_lshl_b32 s13, s1, 4
  s_add_u32 s85, s85, s13
  s_lshl_b32 s83, s4, 5
  s_add_u32 s83, s83, s3
  s_mul_i32 s83, s83, 640
  s_add_u32 s83, s83, 327680
  s_cmp_eq_u32 s7, 0
  s_cselect_b32 s96, -1, 0
  s_cselect_b32 s97, 0xff, 0
  s_lshl_b32 s12, s76, 1
  s_mul_i32 s13, s4, 5
  s_add_u32 s14, s13, 0
  s_lshr_b32 s15, s14, 2
  s_lshl_b32 s15, s15, 11
  s_and_b32 s14, s14, 3
  s_lshl_b32 s14, s14, 8
  s_add_u32 s14, s14, s15
  s_add_u32 s78, s14, s12
  s_add_u32 s14, s13, 1
  s_lshr_b32 s15, s14, 2
  s_lshl_b32 s15, s15, 11
  s_and_b32 s14, s14, 3
  s_lshl_b32 s14, s14, 8
  s_add_u32 s14, s14, s15
  s_add_u32 s79, s14, s12
  s_add_u32 s14, s13, 2
  s_lshr_b32 s15, s14, 2
  s_lshl_b32 s15, s15, 11
  s_and_b32 s14, s14, 3
  s_lshl_b32 s14, s14, 8
  s_add_u32 s14, s14, s15
  s_add_u32 s80, s14, s12
  s_add_u32 s14, s13, 3
  s_lshr_b32 s15, s14, 2
  s_lshl_b32 s15, s15, 11
  s_and_b32 s14, s14, 3
  s_lshl_b32 s14, s14, 8
  s_add_u32 s14, s14, s15
  s_add_u32 s81, s14, s12
  s_add_u32 s14, s13, 4
  s_lshr_b32 s15, s14, 2
  s_lshl_b32 s15, s15, 11
  s_and_b32 s14, s14, 3
  s_lshl_b32 s14, s14, 8
  s_add_u32 s14, s14, s15
  s_add_u32 s82, s14, s12
  s_mul_i32 s12, s7, 1280
  s_add_u32 s12, s12, 13824
  v_mul_u32_u24 v11, 80, v3
  v_lshl_add_u32 v11, v4, 4, v11
  v_add_u32 v42, s12, v11
  v_bfe_u32 v12, v1, 2, 2
  v_mul_u32_u24 v12, 160, v12
  v_and_b32_e64 v13, 3, v1
  v_lshl_add_u32 v12, v13, 4, v12
  v_lshrrev_b32_e64 v13, 1, v4
  v_mul_u32_u24 v14, 80, v13
  v_lshlrev_b32_e64 v13, 10, v13
  v_add3_u32 v12, v12, v14, s12
  v_and_b32_e64 v14, 1, v4
  v_lshl_add_u32 v43, v14, 3, v12
  v_mul_u32_u24 v14, 40960, v14
  v_lshl_add_u32 v13, v3, 4, v13
  v_add_u32_e64 v44, v13, v14
  v_accvgpr_write_b32 a240, v42
  v_accvgpr_write_b32 a241, v43
  v_accvgpr_write_b32 a242, v44
  v_accvgpr_write_b32 a243, v148
  v_accvgpr_write_b32 a244, v149
  v_lshrrev_b32_e64 v11, 2, v3
  v_mul_u32_u24 v11, 5120, v11
  v_and_b32_e64 v12, 3, v3
  v_lshl_add_u32 v11, v12, 4, v11
  v_lshl_add_u32 v0, v4, 6, v11
  v_and_b32 v11, 1, v3
  v_lshrrev_b32 v12, 1, v3
  v_and_b32 v13, 6, v12
  s_movk_i32 s15, 0x78
  v_bfe_u32 v13, s15, v13, 2
  v_xor_b32_e64 v13, v13, v4
  v_lshl_add_u32 v13, v11, 2, v13
  v_lshlrev_b32_e64 v13, 4, v13
  v_lshl_add_u32 v13, v12, 7, v13
  v_lshl_add_u32 v5, v11, 10, v13
  v_xor_b32_e64 v6, 64, v5
  v_add_u32 v7, 51200, v5
  v_add_u32 v8, 51200, v6
  v_mul_u32_u24 v9, 144, v12
  v_lshl_add_u32 v9, v11, 2, v9
  v_lshl_add_u32 v9, v4, 3, v9
  s_lshl_b32 s12, s7, 5
  v_add_u32 v9, s12, v9
  v_and_b32 v11, 6, v3
  v_xor_b32 v11, v11, v4
  v_lshlrev_b32_e64 v11, 4, v11
  v_lshl_add_u32 v11, v3, 7, v11
  v_add_u32 v144, s77, v11
  v_xor_b32 v145, 64, v144
  v_lshrrev_b32 v11, 3, v1
  v_and_b32 v12, 7, v1
  v_mul_u32_u24 v13, 1056, v12
  v_lshl_add_u32 v13, v11, 3, v13
  s_lshl_b32 s12, s7, 6
  s_add_u32 s12, s12, 118784
  v_add_u32 v172, s12, v13
  s_lshl_b32 s12, s7, 8
  s_add_u32 s12, s12, 140960
  v_lshl_add_u32 v173, v11, 5, s12
  v_sub_u32 v13, 7, v12
  v_lshlrev_b32_e64 v13, 4, v13
  v_lshl_add_u32 v171, v11, 14, v13
  s_mul_i32 s12, s0, 80
  s_lshl_b32 s13, s7, 5
  s_add_u32 s12, s12, s13
  s_lshl_b32 s12, s12, 12
  s_lshl_b32 s13, s1, 7
  s_sub_u32 s12, s12, s13
  s_add_u32 s87, s12, 4198272
  s_add_u32 s41, s85, 65536
  s_movk_i32 s36, 4096
  s_cmp_lg_u32 s7, 2
  s_cbranch_scc1 skip_6
  v_bfe_u32 v13, v1, 4, 1
  v_mul_u32_u24 v13, 2112, v13
  v_and_b32_e64 v14, 15, v1
  v_lshl_add_u32 v13, v14, 3, v13
  v_add_u32 v172, 128288, v13
  v_and_b32 v13, 31, v1
  v_lshlrev_b32 v13, 5, v13
  v_add_u32 v173, 143072, v13
  v_cmp_gt_u32_e64 vcc, 32, v1
  v_mov_b32 v14, 1879048192
  s_lshl_b32 s87, s95, 11
  s_add_u32 s87, s87, 26214400
  v_cndmask_b32 v171, v14, v2, vcc
  s_lshl_b32 s41, s95, 2
  s_add_u32 s41, s41, 32768
  s_movk_i32 s36, 512
skip_6:
  s_lshl_b32 s12, s86, 12
  s_lshl_b32 s13, s7, 10
  s_add_u32 s90, s12, s13
  s_add_u32 s91, s90, 4096
  s_lshl_b32 s92, s24, 12
  s_add_u32 s92, s92, s13
  s_add_u32 s13, s13, 102432
  v_add_u32 v186, s13, v2
  v_lshrrev_b32_e64 v11, 1, v1
  v_mul_u32_u24 v11, 4160, v11
  v_and_b32_e64 v12, 1, v1
  v_lshl_add_u32 v11, v12, 4, v11
  v_add_u32 v163, 102400, v11
  s_waitcnt lgkmcnt(0)
  s_lshr_b32 s8, s8, 4
  s_mul_i32 s8, s8, 0x19660d
  s_add_u32 s8, s8, 0x3c6ef35f
  s_lshl_b32 s8, s8, 4
  s_cmp_eq_u32 s7, 1
  s_cbranch_scc1 w1_8
  s_cmp_eq_u32 s7, 2
  s_cbranch_scc1 w2_9
  s_cmp_eq_u32 s7, 3
  s_cbranch_scc1 w3_10
  s_branch join_7
w1_8:
  s_waitcnt vmcnt(8)
  v_lshlrev_b32 v229, 16, v229
  v_lshlrev_b32 v230, 16, v230
  v_lshlrev_b32 v231, 16, v231
  v_mul_f32 v231, 0x3fb8aa3b, v231
  v_exp_f32 v231, v231
  v_min_u32 v104, 39, v1
  v_mul_u32_u24 v102, 80, v104
  v_mul_u32_u24 v103, 176, v104
  v_cvt_pk_bf16_f32 v231, v231, v231
  v_and_b32 v231, 0xffff0000, v231
  v_mul_f32 v96, v231, v229
  v_mul_f32 v97, v231, v230
  v_mul_f32 v96, 0x3fb8aa3b, v96
  v_mul_f32 v97, 0x3e22f983, v97
  v_mul_f32 v98, 1.0, v96
  v_mul_f32 v99, 1.0, v97
  v_exp_f32 v98, v98
  v_fract_f32 v99, v99
  v_sin_f32 v100, v99
  v_cos_f32 v101, v99
  v_mul_f32 v107, v98, v100
  v_mul_f32_e64 v106, v98, v101
  v_mul_f32 v98, 0x41000000, v96
  v_mul_f32 v99, 0x41000000, v97
  v_exp_f32 v98, v98
  v_fract_f32 v99, v99
  v_sin_f32 v100, v99
  v_cos_f32 v101, v99
  v_mul_f32 v51, v98, v100
  v_mul_f32 v50, v98, v101
  v_mul_f32 v98, v229, v229
  v_fmac_f32 v98, v230, v230
  v_rcp_f32 v98, v98
  v_add_f32 v99, -1.0, v106
  v_add_f32 v98, v98, v98
  v_mul_f32 v100, v99, v229
  v_fmac_f32 v100, v107, v230
  v_mul_f32 v101, v107, v229
  v_fma_f32 v101, -v99, v230, v101
  v_mul_f32 v100, v98, v100
  v_mul_f32 v101, v98, v101
  v_and_b32 v98, 1, v104
  v_lshrrev_b32 v104, 1, v104
  v_lshlrev_b32_e64 v104, 4, v104
  v_lshl_add_u32 v104, v98, 2, v104
  v_add_u32 v104, 159744, v104
  v_add_u32 v102, 160640, v102
  v_add_u32 v103, 145184, v103
  ds_write2_b32 v104, v100, v101 offset0:0 offset1:2
  v_mov_b32 v48, 1.0
  v_mov_b32 v49, 0
  v_mov_b32 v84, 1.0
  v_mov_b32 v85, 0
  v_pk_mul_f32 v[52:53], v[50:51], v[50:51] op_sel:[1,1] op_sel_hi:[0,1] neg_lo:[0,1]
  v_pk_mul_f32 v[108:109], v[106:107], v[106:107] op_sel:[1,1] op_sel_hi:[0,1] neg_lo:[0,1]
  v_pk_fma_f32 v[52:53], v[50:51], v[50:51], v[52:53] op_sel:[0,0,0] op_sel_hi:[1,0,1]
  v_pk_fma_f32 v[108:109], v[106:107], v[106:107], v[108:109] op_sel:[0,0,0] op_sel_hi:[1,0,1]
  v_pk_mul_f32 v[54:55], v[52:53], v[50:51] op_sel:[1,1] op_sel_hi:[0,1] neg_lo:[0,1]
  v_pk_mul_f32 v[110:111], v[108:109], v[106:107] op_sel:[1,1] op_sel_hi:[0,1] neg_lo:[0,1]
  v_pk_fma_f32 v[54:55], v[52:53], v[50:51], v[54:55] op_sel:[0,0,0] op_sel_hi:[1,0,1]
  v_pk_fma_f32 v[110:111], v[108:109], v[106:107], v[110:111] op_sel:[0,0,0] op_sel_hi:[1,0,1]
  ds_write_b128 v103, v[48:51] offset:0
  v_pk_mul_f32 v[56:57], v[54:55], v[50:51] op_sel:[1,1] op_sel_hi:[0,1] neg_lo:[0,1]
  v_pk_mul_f32 v[112:113], v[110:111], v[106:107] op_sel:[1,1] op_sel_hi:[0,1] neg_lo:[0,1]
  v_pk_fma_f32 v[56:57], v[54:55], v[50:51], v[56:57] op_sel:[0,0,0] op_sel_hi:[1,0,1]
  v_pk_fma_f32 v[112:113], v[110:111], v[106:107], v[112:113] op_sel:[0,0,0] op_sel_hi:[1,0,1]
  v_pk_mul_f32 v[58:59], v[56:57], v[50:51] op_sel:[1,1] op_sel_hi:[0,1] neg_lo:[0,1]
  v_pk_mul_f32 v[114:115], v[112:113], v[106:107] op_sel:[1,1] op_sel_hi:[0,1] neg_lo:[0,1]
  v_pk_fma_f32 v[58:59], v[56:57], v[50:51], v[58:59] op_sel:[0,0,0] op_sel_hi:[1,0,1]
  v_pk_fma_f32 v[114:115], v[112:113], v[106:107], v[114:115] op_sel:[0,0,0] op_sel_hi:[1,0,1]
  ds_write_b128 v103, v[52:55] offset:16
  v_pk_mul_f32 v[60:61], v[58:59], v[50:51] op_sel:[1,1] op_sel_hi:[0,1] neg_lo:[0,1]
  v_pk_mul_f32 v[116:117], v[114:115], v[106:107] op_sel:[1,1] op_sel_hi:[0,1] neg_lo:[0,1]
  v_pk_fma_f32 v[60:61], v[58:59], v[50:51], v[60:61] op_sel:[0,0,0] op_sel_hi:[1,0,1]
  v_pk_fma_f32 v[116:117], v[114:115], v[106:107], v[116:117] op_sel:[0,0,0] op_sel_hi:[1,0,1]
  v_pk_mul_f32 v[62:63], v[60:61], v[50:51] op_sel:[1,1] op_sel_hi:[0,1] neg_lo:[0,1]
  v_pk_mul_f32 v[118:119], v[116:117], v[106:107] op_sel:[1,1] op_sel_hi:[0,1] neg_lo:[0,1]
  v_pk_fma_f32 v[62:63], v[60:61], v[50:51], v[62:63] op_sel:[0,0,0] op_sel_hi:[1,0,1]
  v_pk_fma_f32 v[118:119], v[116:117], v[106:107], v[118:119] op_sel:[0,0,0] op_sel_hi:[1,0,1]
  ds_write_b128 v103, v[56:59] offset:32
  v_pk_mul_f32 v[64:65], v[62:63], v[50:51] op_sel:[1,1] op_sel_hi:[0,1] neg_lo:[0,1]
  v_pk_fma_f32 v[64:65], v[62:63], v[50:51], v[64:65] op_sel:[0,0,0] op_sel_hi:[1,0,1]
  ds_write2_b32 v102, v106, v107 offset0:0 offset1:8
  v_pk_mul_f32 v[66:67], v[64:65], v[50:51] op_sel:[1,1] op_sel_hi:[0,1] neg_lo:[0,1]
  v_pk_fma_f32 v[66:67], v[64:65], v[50:51], v[66:67] op_sel:[0,0,0] op_sel_hi:[1,0,1]
  ds_write2_b32 v102, v108, v109 offset0:1 offset1:9
  ds_write_b128 v103, v[60:63] offset:48
  v_pk_mul_f32 v[68:69], v[66:67], v[50:51] op_sel:[1,1] op_sel_hi:[0,1] neg_lo:[0,1]
  v_pk_fma_f32 v[68:69], v[66:67], v[50:51], v[68:69] op_sel:[0,0,0] op_sel_hi:[1,0,1]
  ds_write2_b32 v102, v110, v111 offset0:2 offset1:10
  v_pk_mul_f32 v[70:71], v[68:69], v[50:51] op_sel:[1,1] op_sel_hi:[0,1] neg_lo:[0,1]
  v_pk_fma_f32 v[70:71], v[68:69], v[50:51], v[70:71] op_sel:[0,0,0] op_sel_hi:[1,0,1]
  ds_write2_b32 v102, v112, v113 offset0:3 offset1:11
  ds_write_b128 v103, v[64:67] offset:64
  v_pk_mul_f32 v[72:73], v[70:71], v[50:51] op_sel:[1,1] op_sel_hi:[0,1] neg_lo:[0,1]
  v_pk_fma_f32 v[72:73], v[70:71], v[50:51], v[72:73] op_sel:[0,0,0] op_sel_hi:[1,0,1]
  ds_write2_b32 v102, v114, v115 offset0:4 offset1:12
  v_pk_mul_f32 v[74:75], v[72:73], v[50:51] op_sel:[1,1] op_sel_hi:[0,1] neg_lo:[0,1]
  v_pk_fma_f32 v[74:75], v[72:73], v[50:51], v[74:75] op_sel:[0,0,0] op_sel_hi:[1,0,1]
  ds_write2_b32 v102, v116, v117 offset0:5 offset1:13
  ds_write_b128 v103, v[68:71] offset:80
  v_pk_mul_f32 v[76:77], v[74:75], v[50:51] op_sel:[1,1] op_sel_hi:[0,1] neg_lo:[0,1]
  v_pk_fma_f32 v[76:77], v[74:75], v[50:51], v[76:77] op_sel:[0,0,0] op_sel_hi:[1,0,1]
  ds_write2_b32 v102, v118, v119 offset0:6 offset1:14
  v_pk_mul_f32 v[78:79], v[76:77], v[50:51] op_sel:[1,1] op_sel_hi:[0,1] neg_lo:[0,1]
  v_pk_fma_f32 v[78:79], v[76:77], v[50:51], v[78:79] op_sel:[0,0,0] op_sel_hi:[1,0,1]
  ds_write_b128 v103, v[72:75] offset:96
  v_pk_mul_f32 v[80:81], v[78:79], v[50:51] op_sel:[1,1] op_sel_hi:[0,1] neg_lo:[0,1]
  v_pk_fma_f32 v[80:81], v[78:79], v[50:51], v[80:81] op_sel:[0,0,0] op_sel_hi:[1,0,1]
  ds_write2_b32 v102, v50, v51 offset0:7 offset1:15
  ds_write_b128 v103, v[76:79] offset:112
  v_pk_mul_f32 v[98:99], v[80:81], v[80:81] op_sel:[1,1] op_sel_hi:[0,1] neg_lo:[0,1]
  v_pk_fma_f32 v[98:99], v[80:81], v[80:81], v[98:99] op_sel:[0,0,0] op_sel_hi:[1,0,1]
  v_pk_mul_f32 v[86:87], v[98:99], v[98:99] op_sel:[1,1] op_sel_hi:[0,1] neg_lo:[0,1]
  v_pk_fma_f32 v[86:87], v[98:99], v[98:99], v[86:87] op_sel:[0,0,0] op_sel_hi:[1,0,1]
  v_pk_mul_f32 v[88:89], v[86:87], v[86:87] op_sel:[1,1] op_sel_hi:[0,1] neg_lo:[0,1]
  v_pk_fma_f32 v[88:89], v[86:87], v[86:87], v[88:89] op_sel:[0,0,0] op_sel_hi:[1,0,1]
  v_pk_mul_f32 v[90:91], v[88:89], v[86:87] op_sel:[1,1] op_sel_hi:[0,1] neg_lo:[0,1]
  v_pk_fma_f32 v[90:91], v[88:89], v[86:87], v[90:91] op_sel:[0,0,0] op_sel_hi:[1,0,1]
  ds_write_b64 v103, v[80:81] offset:128
  ds_write_b128 v103, v[84:87] offset:144
  ds_write_b128 v103, v[88:91] offset:160
  s_branch join_7
w2_9:
  v_mov_b32 v88, 0
  s_lshl_b32 s12, s0, 11
  s_lshl_b32 s13, s1, 2
  s_add_u32 s12, s12, s13
  s_add_u32 s12, s12, 66560
  s_or_b32 s13, s8, s11
  v_mov_b32 v15, s13
  s_mov_b64 exec, 1
  buffer_store_dword v15, off, s[52:55], s12
  s_mov_b64 exec, -1
  s_lshl_b32 s12, s0, 11
  s_lshl_b32 s13, s1, 2
  s_add_u32 s12, s12, s13
  s_add_u32 s12, s12, 66560
  s_or_b32 s13, s8, s11
  v_mov_b32 v15, s13
  s_mov_b64 exec, 1
  buffer_store_dword v15, off, s[52:55], s12 offset:128 sc1
  s_mov_b64 exec, -1
  v_mov_b32 v89, 0
  v_mov_b32 v90, s8
  v_mov_b32_e64 v91, s8
  s_add_u32 s12, s83, 327680
  s_mov_b32 exec_hi, 0xff
  buffer_store_dwordx4 v[88:91], v2, s[52:55], s83 offen sc1
  buffer_store_dwordx4 v[88:91], v2, s[52:55], s12 offen sc1
  s_mov_b32 exec_hi, -1
  s_branch join_7
w3_10:
  s_waitcnt vmcnt(0)
  v_dot2_f32_bf16 v88, v48, s2, 0
  v_dot2_f32_bf16 v90, v48, v48, 0
  v_dot2_f32_bf16 v88, v49, s2, v88
  v_dot2_f32_bf16 v90, v49, v49, v90
  v_dot2_f32_bf16 v88, v50, s2, v88
  v_dot2_f32_bf16 v90, v50, v50, v90
  v_dot2_f32_bf16 v88, v51, s2, v88
  v_dot2_f32_bf16 v90, v51, v51, v90
  v_dot2_f32_bf16 v88, v52, s2, v88
  v_dot2_f32_bf16 v90, v52, v52, v90
  v_dot2_f32_bf16 v88, v53, s2, v88
  v_dot2_f32_bf16 v90, v53, v53, v90
  v_dot2_f32_bf16 v88, v54, s2, v88
  v_dot2_f32_bf16 v90, v54, v54, v90
  v_dot2_f32_bf16 v88, v55, s2, v88
  v_dot2_f32_bf16 v90, v55, v55, v90
  v_dot2_f32_bf16 v88, v56, s2, v88
  v_dot2_f32_bf16 v90, v56, v56, v90
  v_dot2_f32_bf16 v88, v57, s2, v88
  v_dot2_f32_bf16 v90, v57, v57, v90
  v_dot2_f32_bf16 v88, v58, s2, v88
  v_dot2_f32_bf16 v90, v58, v58, v90
  v_dot2_f32_bf16 v88, v59, s2, v88
  v_dot2_f32_bf16 v90, v59, v59, v90
  v_dot2_f32_bf16 v88, v60, s2, v88
  v_dot2_f32_bf16 v90, v60, v60, v90
  v_dot2_f32_bf16 v88, v61, s2, v88
  v_dot2_f32_bf16 v90, v61, v61, v90
  v_dot2_f32_bf16 v88, v62, s2, v88
  v_dot2_f32_bf16 v90, v62, v62, v90
  v_dot2_f32_bf16 v88, v63, s2, v88
  v_dot2_f32_bf16 v90, v63, v63, v90
  v_dot2_f32_bf16 v88, v64, s2, v88
  v_dot2_f32_bf16 v90, v64, v64, v90
  v_dot2_f32_bf16 v88, v65, s2, v88
  v_dot2_f32_bf16 v90, v65, v65, v90
  v_dot2_f32_bf16 v88, v66, s2, v88
  v_dot2_f32_bf16 v90, v66, v66, v90
  v_dot2_f32_bf16 v88, v67, s2, v88
  v_dot2_f32_bf16 v90, v67, v67, v90
  v_dot2_f32_bf16 v88, v68, s2, v88
  v_dot2_f32_bf16 v90, v68, v68, v90
  v_dot2_f32_bf16 v88, v69, s2, v88
  v_dot2_f32_bf16 v90, v69, v69, v90
  v_dot2_f32_bf16 v88, v70, s2, v88
  v_dot2_f32_bf16 v90, v70, v70, v90
  v_dot2_f32_bf16 v88, v71, s2, v88
  v_dot2_f32_bf16 v90, v71, v71, v90
  v_dot2_f32_bf16 v88, v72, s2, v88
  v_dot2_f32_bf16 v90, v72, v72, v90
  v_dot2_f32_bf16 v88, v73, s2, v88
  v_dot2_f32_bf16 v90, v73, v73, v90
  v_dot2_f32_bf16 v88, v74, s2, v88
  v_dot2_f32_bf16 v90, v74, v74, v90
  v_dot2_f32_bf16 v88, v75, s2, v88
  v_dot2_f32_bf16 v90, v75, v75, v90
  v_dot2_f32_bf16 v88, v76, s2, v88
  v_dot2_f32_bf16 v90, v76, v76, v90
  v_dot2_f32_bf16 v88, v77, s2, v88
  v_dot2_f32_bf16 v90, v77, v77, v90
  v_dot2_f32_bf16 v88, v78, s2, v88
  v_dot2_f32_bf16 v90, v78, v78, v90
  v_dot2_f32_bf16 v88, v79, s2, v88
  v_dot2_f32_bf16 v90, v79, v79, v90
  v_dot2_f32_bf16 v88, v80, s2, v88
  v_dot2_f32_bf16 v90, v80, v80, v90
  v_dot2_f32_bf16 v88, v81, s2, v88
  v_dot2_f32_bf16 v90, v81, v81, v90
  v_dot2_f32_bf16 v88, v82, s2, v88
  v_dot2_f32_bf16 v90, v82, v82, v90
  v_dot2_f32_bf16 v88, v83, s2, v88
  v_dot2_f32_bf16 v90, v83, v83, v90
  v_dot2_f32_bf16 v88, v84, s2, v88
  v_dot2_f32_bf16 v90, v84, v84, v90
  v_dot2_f32_bf16 v88, v85, s2, v88
  v_dot2_f32_bf16 v90, v85, v85, v90
  v_dot2_f32_bf16 v88, v86, s2, v88
  v_dot2_f32_bf16 v90, v86, v86, v90
  v_dot2_f32_bf16 v88, v87, s2, v88
  v_dot2_f32_bf16 v90, v87, v87, v90
  s_nop 1
  v_add_f32_dpp v88, v88, v88 quad_perm:[1,0,3,2] row_mask:0xf bank_mask:0xf
  v_add_f32_dpp v90, v90, v90 quad_perm:[1,0,3,2] row_mask:0xf bank_mask:0xf
  s_nop 0
  v_add_f32_dpp v88, v88, v88 quad_perm:[2,3,0,1] row_mask:0xf bank_mask:0xf
  v_add_f32_dpp v90, v90, v90 quad_perm:[2,3,0,1] row_mask:0xf bank_mask:0xf
  s_nop 0
  v_add_f32_dpp v88, v88, v88 row_half_mirror row_mask:0xf bank_mask:0xf
  v_add_f32_dpp v90, v90, v90 row_half_mirror row_mask:0xf bank_mask:0xf
  v_mul_f32 v88, 0x3acccccd, v88
  v_mul_f32 v90, 0x3acccccd, v90
  v_fma_f32 v90, -v88, v88, v90
  v_max_f32_e64 v90, 0, v90
  v_cvt_pk_bf16_f32 v88, v88, v88
  v_and_b32 v88, 0xffff0000, v88
  v_cvt_pk_bf16_f32 v90, v90, v90
  v_and_b32 v90, 0xffff0000, v90
  v_add_f32 v90, 0x3727c5ac, v90
  v_cvt_pk_bf16_f32 v90, v90, v90
  v_and_b32 v90, 0xffff0000, v90
  v_sqrt_f32 v90, v90
  s_nop 0
  v_cvt_pk_bf16_f32 v90, v90, v90
  v_and_b32 v90, 0xffff0000, v90
  v_rcp_f32 v89, v90
  v_mov_b32 v90, s8
  v_mov_b32 v91, s8
  v_lshlrev_b32 v11, 1, v1
  s_lshl_b32 s12, s3, 4
  s_add_u32 s12, s12, s4
  s_lshl_b32 s12, s12, 7
  s_add_u32 s12, s12, 262144
  s_mov_b32 exec_lo, 0x01010101
  s_mov_b32 exec_hi, 0x01010101
  buffer_store_dwordx4 v[88:91], v11, s[52:55], s12 offen sc1
  s_mov_b64 exec, -1
join_7:
  s_lshl_b32 s93, s3, 11
  s_lshl_b32 s12, s7, 9
  s_add_u32 s93, s93, s12
  s_add_u32 s93, s93, 262144
  v_and_b32 v160, 7, v3
  v_lshlrev_b32_e64 v160, 4, v160
  v_lshl_add_u32 v160, v4, 7, v160
  s_mul_i32 s94, s4, 640
  s_add_u32 s94, s94, 303104
  v_lshlrev_b32 v161, 3, v1
  v_lshlrev_b32 v162, 3, v3
  v_and_b32 v187, 31, v1
  v_lshlrev_b32 v187, 4, v187
  s_lshl_b32 s88, s6, 11
  s_add_u32 s88, s88, 66048
  v_and_b32 v185, 31, v1
  v_lshlrev_b32 v185, 2, v185
  s_lshl_b32 s89, s0, 11
  s_add_u32 s89, s89, 66560
  v_add_u32 v11, 1, v3
  v_and_b32 v12, 1, v11
  v_mul_u32_u24 v12, 4160, v12
  v_lshrrev_b32_e64 v11, 1, v11
  v_lshl_add_u32 v12, v11, 2, v12
  v_lshl_add_u32 v12, v4, 4, v12
  v_sub_u32 v11, 15, v3
  v_lshlrev_b32 v11, 5, v11
  v_lshl_add_u32 v11, v4, 4, v11
  s_lshr_b32 s12, s7, 1
  s_and_b32 s13, s7, 1
  s_lshl_b32 s13, s13, 8
  s_mul_i32 s14, s12, 8320
  s_add_u32 s14, s14, s13
  s_add_u32 s14, s14, 102400
  v_add_u32_e64 v232, s14, v12
  s_mul_i32 s14, s12, 4608
  s_add_u32 s14, s14, s13
  v_add_u32 v240, s14, v11
  s_lshl_b32 s13, s7, 7
  s_add_u32 s14, s13, 119040
  v_add_u32 v236, s14, v12
  s_add_u32 s14, s13, 9216
  v_add_u32_e64 v241, s14, v11
  s_mul_i32 s13, s5, 163840
  s_mul_i32 s14, s7, 10240
  s_add_u32 s13, s13, s14
  s_add_u32 s13, s13, 0
  s_add_u32 s14, s7, 1
  s_and_b32 s14, s14, 3
  s_mul_i32 s15, s14, 40960
  s_add_u32 s16, s15, s13
  s_mul_i32 s15, s14, 10240
  s_add_u32 s15, s15, 102400
  v_add_u32 v44, s15, v2
  s_add_u32 s14, s7, 2
  s_and_b32 s14, s14, 3
  s_mul_i32 s15, s14, 40960
  s_add_u32 s17, s15, s13
  s_mul_i32 s15, s14, 10240
  s_add_u32 s15, s15, 107520
  v_add_u32 v45, s15, v2
  s_add_u32 s14, s7, 3
  s_and_b32 s14, s14, 3
  s_mul_i32 s15, s14, 40960
  s_add_u32 s18, s15, s13
  s_mul_i32 s15, s14, 5120
  v_add_u32 v46, s15, v2
  s_add_u32 s14, s7, 4
  s_and_b32 s14, s14, 3
  s_mul_i32 s15, s14, 40960
  s_add_u32 s19, s15, s13
  s_lshl_b32 s49, s3, 10
  s_lshl_b32 s13, s7, 6
  s_add_u32 s49, s49, s13
  s_and_b32 s13, s5, 1
  s_lshl_b32 s13, s13, 3
  s_add_u32 s49, s49, s13
  s_add_u32 s49, s49, 4352
  v_and_b32 v244, 3, v1
  v_lshlrev_b32 v244, 4, v244
  s_lshr_b32 s13, s7, 1
  s_add_u32 s12, s86, s13
  s_bitcmp1_b32 s12, 0
  s_cselect_b32 s14, 16, 0
  s_lshr_b32 s72, s72, s14
  s_and_b32 s30, s72, 0xffff
  s_lshl_b32 s31, s72, 16
  s_bitcmp1_b32 s24, 0
  s_cselect_b32 s14, 16, 0
  s_lshr_b32 s73, s73, s14
  s_and_b32 s25, s73, 0xffff
  s_lshl_b32 s45, s73, 16
  s_lshl_b32 s50, s12, 12
  s_and_b32 s12, s7, 1
  s_lshl_b32 s12, s12, 11
  s_add_u32 s50, s50, s12
  s_add_u32 s50, s50, 19922944
  s_mul_i32 s13, s13, 4608
  s_sub_u32 s13, s13, s12
  s_add_u32 s13, s13, 2552
  v_lshlrev_b32_e64 v246, 5, v3
  v_lshl_add_u32 v246, v4, 3, v246
  v_sub_u32 v247, s13, v246
  s_bitcmp1_b32 s1, 0
  s_movk_i32 s12, 0x7421
  s_cselect_b32 s12, 0x6530, s12
  s_lshl_b32 s13, s7, 2
  s_lshr_b32 s12, s12, s13
  s_and_b32 s12, s12, 7
  s_lshl_b32 s12, s12, 9
  s_lshl_b32 s51, s24, 12
  s_add_u32 s51, s51, s12
  s_add_u32 s51, s51, 19922944
  s_sub_u32 s12, 13304, s12
  v_sub_u32 v248, s12, v246
  s_lshl_b32 s12, s7, 12
  s_add_u32 s13, s12, 102400
  v_add_u32 v252, s13, v2
  s_add_u32 s13, s12, 127360
  v_add_u32_e64 v249, s13, v2
  s_xor_b32 s13, s12, 4096
  s_add_u32 s13, s13, 127360
  v_add_u32 v250, s13, v2
  s_lshl_b32 s13, s7, 10
  s_add_u32 s13, s13, 102400
  v_add_u32_e64 v251, s13, v2
  v_accvgpr_write_b32 a200, v232
  v_accvgpr_write_b32 a201, v236
  v_accvgpr_write_b32 a202, v240
  v_accvgpr_write_b32 a203, v241
  v_accvgpr_write_b32 a204, v246
  v_accvgpr_write_b32 a205, v247
  v_accvgpr_write_b32 a206, v248
  v_accvgpr_write_b32 a207, v249
  v_accvgpr_write_b32 a208, v250
  v_accvgpr_write_b32 a209, v251
  v_accvgpr_write_b32 a210, v252
  v_accvgpr_write_b32 a211, v44
  v_accvgpr_write_b32 a212, v45
  v_accvgpr_write_b32 a213, v46
  v_accvgpr_write_b32 a214, v244
  s_lshl_b32 s12, s5, 6
  s_lshr_b32 s13, s7, 1
  s_lshl_b32 s13, s13, 5
  s_add_u32 s12, s12, s13
  s_and_b32 s13, s7, 1
  s_lshl_b32 s13, s13, 2
  s_add_u32 s12, s12, s13
  s_mul_i32 s20, s12, 1280
  s_mul_i32 s13, s6, 160
  s_add_u32 s20, s20, s13
  s_lshl_b32 s48, s7, 12
  s_add_u32 s48, s48, 127360
  v_add_u32 v11, 0, v1
  v_mul_u32_u24 v12, 205, v11
  v_lshrrev_b32 v12, 11, v12
  v_lshrrev_b32 v13, 2, v12
  v_mul_u32_u24 v12, 1120, v12
  v_mul_u32_u24 v13, 5120, v13
  v_lshlrev_b32_e64 v11, 4, v11
  v_add3_u32 v224, v11, v12, v13
  v_add_u32_e64 v11, 64, v1
  v_mul_u32_u24 v12, 205, v11
  v_lshrrev_b32 v12, 11, v12
  v_lshrrev_b32 v13, 2, v12
  v_mul_u32_u24 v12, 1120, v12
  v_mul_u32_u24 v13, 5120, v13
  v_lshlrev_b32_e64 v11, 4, v11
  v_add3_u32 v225, v11, v12, v13
  v_add_u32 v11, 128, v1
  v_mul_u32_u24 v12, 205, v11
  v_lshrrev_b32 v12, 11, v12
  v_lshrrev_b32 v13, 2, v12
  v_mul_u32_u24 v12, 1120, v12
  v_mul_u32_u24 v13, 5120, v13
  v_lshlrev_b32_e64 v11, 4, v11
  v_add3_u32 v226, v11, v12, v13
  s_and_b32 s12, s5, 1
  s_lshl_b32 s12, s12, 2
  s_add_u32 s12, s12, s7
  s_lshr_b32 s13, s12, 1
  s_lshl_b32 s13, s13, 8
  s_and_b32 s12, s12, 1
  s_lshl_b32 s12, s12, 5
  s_add_u32 s12, s12, s13
  s_add_u32 s12, s12, 158720
  v_lshrrev_b32 v12, 2, v3
  v_lshlrev_b32 v12, 6, v12
  v_and_b32_e64 v13, 3, v3
  v_lshl_add_u32 v12, v13, 3, v12
  v_add_u32 v227, s12, v12
  v_and_b32 v13, 7, v3
  v_lshlrev_b32_e64 v13, 3, v13
  v_lshl_add_u32 v13, v4, 6, v13
  s_lshl_b32 s12, s7, 8
  s_add_u32 s12, s12, 158720
  v_add_u32 v228, s12, v13
  v_lshl_add_u32 v243, v4, 3, s48
  v_mul_u32_u24 v242, 160, v3
  v_lshl_add_u32 v242, v4, 3, v242
  v_add_u32 v242, s48, v242
  s_lshl_b32 s12, s3, 4
  s_add_u32 s12, s12, s4
  s_lshl_b32 s12, s12, 12
  s_add_u32 s12, s12, 1310720
  s_sub_u32 s12, s12, 0
  v_mov_b32 v11, s12
  s_lshl_b32 s12, s3, 10
  s_add_u32 s12, s12, 4096
  s_sub_u32 s12, s12, 3072
  v_cmp_lt_u32 vcc, 23, v1
  v_mov_b32 v15, s12
  s_nop 0
  v_cndmask_b32 v11, v11, v15, vcc
  v_lshl_add_u32 v11, v1, 7, v11
  v_accvgpr_write_b32 a245, v11
  s_add_u32 m0, s75, 0
  s_add_u32 s14, s74, 0
  buffer_load_dwordx4 v148, s[56:59], s14 offen lds
  buffer_load_dwordx4 v149, s[56:59], s14 offen offset:2048 lds
  s_add_u32 m0, s75, 4096
  s_add_u32 s14, s74, 20480
  buffer_load_dwordx4 v148, s[56:59], s14 offen lds
  buffer_load_dwordx4 v149, s[56:59], s14 offen offset:2048 lds
  s_add_u32 m0, s75, 8192
  s_add_u32 s14, s74, 40960
  buffer_load_dwordx4 v148, s[56:59], s14 offen lds
  s_add_u32 m0, s77, 0
  s_add_u32 s15, s76, 0
  buffer_load_dwordx4 v146, s[68:71], s15 offen lds
  buffer_load_dwordx4 v147, s[68:71], s15 offen offset:1024 lds
  s_add_u32 m0, s77, 8192
  s_add_u32 s15, s76, 5120
  buffer_load_dwordx4 v146, s[68:71], s15 offen lds
  buffer_load_dwordx4 v147, s[68:71], s15 offen offset:1024 lds
  v_mul_u32_u24 v11, 171, v1
  v_lshrrev_b32 v11, 11, v11
  v_mul_u32_u24 v12, 12, v11
  v_sub_u32 v12, v1, v12
  s_mul_i32 s12, s4, 5
  v_min_u32 v13, 4, v11
  v_add_u32 v13, s12, v13
  s_mul_i32 s13, s7, 12
  v_add_u32 v12, s13, v12
  v_cmp_gt_u32 vcc, 40, v12
  v_cmp_gt_u32 s[14:15], 5, v11
  s_lshr_b32 s13, s1, 4
  s_mul_i32 s13, s13, 40
  v_min_u32 v12, 39, v12
  s_and_b64 vcc, vcc, s[14:15]
  v_add_u32_e64 v12, s13, v12
  s_mul_i32 s14, s0, 102400
  v_mul_u32_u24 v14, 1280, v12
  v_lshl_add_u32 v14, v13, 4, v14
  v_add_u32_e64 v14, s14, v14
  global_load_dwordx4 v[176:179], v14, s[26:27]
  global_load_dwordx4 v[180:183], v14, s[28:29]
  v_lshrrev_b32_e64 v14, 2, v13
  v_mul_u32_u24 v14, 10240, v14
  v_and_b32_e64 v13, 3, v13
  v_lshl_add_u32 v14, v13, 8, v14
  v_lshrrev_b32_e64 v13, 4, v12
  v_lshl_add_u32 v14, v13, 10, v14
  v_and_b32_e64 v12, 15, v12
  v_lshl_add_u32 v14, v12, 4, v14
  v_mov_b32 v13, 1879048192
  v_cndmask_b32 v174, v13, v14, vcc
  v_min_u32 v11, 4, v11
  v_lshlrev_b32_e64 v11, 6, v11
  v_add_u32 v175, 159744, v11
  s_waitcnt vmcnt(11)
  s_waitcnt lgkmcnt(0)
  s_barrier
  buffer_load_dword v184, v185, s[52:55], s89 offen sc1
  v_lshrrev_b32 v11, 1, v3
  v_mul_u32_u24 v12, 176, v11
  v_mul_u32_u24 v11, 80, v11
  v_and_b32_e64 v13, 1, v3
  v_lshl_add_u32 v12, v13, 2, v12
  v_lshl_add_u32 v12, v4, 3, v12
  s_lshl_b32 s12, s7, 5
  s_add_u32 s12, s12, 145184
  v_add_u32 v12, s12, v12
  v_add_u32 v11, 160640, v11
  v_cvt_f32_u32 v151, v13
  v_min_u32 v13, 39, v1
  v_mul_u32_u24 v13, 176, v13
  v_fma_f32 v151, 2.0, v151, -1.0
  v_add_u32 v13, 145184, v13
  s_lshl_b32 s12, s7, 3
  ds_read_b32 v16, v11 offset:0
  ds_read_b32 v21, v11 offset:32
  ds_read_b32 v26, v12 offset:0
  ds_read_b32 v17, v11 offset:640
  ds_read_b32 v22, v11 offset:672
  ds_read_b32 v28, v12 offset:1408
  ds_read_b32 v18, v11 offset:1280
  ds_read_b32 v23, v11 offset:1312
  ds_read_b32 v30, v12 offset:2816
  ds_read_b32 v19, v11 offset:1920
  ds_read_b32 v24, v11 offset:1952
  ds_read_b32 v32, v12 offset:4224
  ds_read_b32 v20, v11 offset:2560
  ds_read_b32 v25, v11 offset:2592
  ds_read_b32 v34, v12 offset:5632
  ds_read_b64 v[36:37], v13 offset:8
  ds_read_b64 v[38:39], v13 offset:128
  v_add_u32 v13, s12, v13
  ds_read_b64 v[40:41], v13 offset:144
  s_cmp_eq_u32 s7, 3
  s_cbranch_scc1 w3_11
  ds_read_b128 v[88:91], v173
  ds_read_b128 v[92:95], v173 offset:16
  ds_read_b64 v[48:49], v172 offset:640
  ds_read_b64 v[50:51], v172 offset:768
  ds_read_b64 v[52:53], v172 offset:896
  ds_read_b64 v[54:55], v172 offset:1056
  ds_read_b64 v[56:57], v172 offset:1184
  ds_read_b64 v[58:59], v172 offset:1312
  ds_read_b64 v[60:61], v172 offset:1440
  ds_read_b64 v[62:63], v172 offset:1568
  ds_read_b64 v[64:65], v172 offset:1696
  ds_read_b64 v[66:67], v172 offset:1824
  ds_read_b64 v[68:69], v172 offset:1952
  ds_read_b64 v[70:71], v172 offset:13728
  ds_read_b64 v[72:73], v172 offset:13856
  ds_read_b64 v[74:75], v172 offset:13984
  ds_read_b64 v[76:77], v172 offset:14112
  ds_read_b64 v[78:79], v172 offset:14240
  ds_read_b64 v[80:81], v172 offset:14368
  ds_read_b64 v[82:83], v172 offset:14496
  ds_read_b64 v[84:85], v172 offset:14624
  s_waitcnt lgkmcnt(15)
  v_lshlrev_b32 v96, 16, v88
  v_and_b32 v100, 0xffff0000, v88
  v_lshlrev_b32_e64 v104, 16, v89
  v_and_b32 v108, 0xffff0000, v89
  v_lshlrev_b32_e64 v97, 16, v90
  v_and_b32 v101, 0xffff0000, v90
  v_lshlrev_b32_e64 v105, 16, v91
  v_and_b32 v109, 0xffff0000, v91
  v_lshlrev_b32_e64 v98, 16, v92
  v_and_b32 v102, 0xffff0000, v92
  v_lshlrev_b32_e64 v106, 16, v93
  v_and_b32 v110, 0xffff0000, v93
  v_lshlrev_b32_e64 v99, 16, v94
  v_and_b32 v103, 0xffff0000, v94
  v_lshlrev_b32_e64 v107, 16, v95
  v_and_b32 v111, 0xffff0000, v95
  s_waitcnt lgkmcnt(8)
  v_lshlrev_b32 v216, 16, v48
  v_and_b32 v217, 0xffff0000, v48
  v_pk_mul_f32 v[112:113], v[216:217], v[108:109]
  v_lshlrev_b32_e64 v218, 16, v50
  v_and_b32 v219, 0xffff0000, v50
  v_pk_mul_f32 v[114:115], v[218:219], v[108:109]
  v_lshlrev_b32_e64 v216, 16, v52
  v_and_b32 v217, 0xffff0000, v52
  v_pk_fma_f32 v[112:113], v[218:219], v[104:105], v[112:113]
  v_pk_mul_f32 v[116:117], v[216:217], v[108:109]
  v_lshlrev_b32_e64 v218, 16, v54
  v_and_b32 v219, 0xffff0000, v54
  v_pk_fma_f32 v[114:115], v[216:217], v[104:105], v[114:115]
  v_pk_fma_f32 v[112:113], v[216:217], v[100:101], v[112:113]
  v_pk_mul_f32 v[118:119], v[218:219], v[108:109]
  v_lshlrev_b32_e64 v216, 16, v56
  v_and_b32 v217, 0xffff0000, v56
  v_pk_fma_f32 v[116:117], v[218:219], v[104:105], v[116:117]
  v_pk_fma_f32 v[114:115], v[218:219], v[100:101], v[114:115]
  v_pk_fma_f32 v[112:113], v[218:219], v[96:97], v[112:113]
  v_pk_mul_f32 v[120:121], v[216:217], v[108:109]
  v_lshlrev_b32_e64 v218, 16, v58
  v_and_b32 v219, 0xffff0000, v58
  v_pk_fma_f32 v[118:119], v[216:217], v[104:105], v[118:119]
  v_pk_fma_f32 v[116:117], v[216:217], v[100:101], v[116:117]
  v_pk_fma_f32 v[114:115], v[216:217], v[96:97], v[114:115]
  v_pk_mul_f32 v[122:123], v[218:219], v[108:109]
  v_lshlrev_b32_e64 v216, 16, v60
  v_and_b32 v217, 0xffff0000, v60
  v_pk_fma_f32 v[120:121], v[218:219], v[104:105], v[120:121]
  v_pk_fma_f32 v[118:119], v[218:219], v[100:101], v[118:119]
  v_pk_fma_f32 v[116:117], v[218:219], v[96:97], v[116:117]
  v_pk_mul_f32 v[124:125], v[216:217], v[108:109]
  v_lshlrev_b32_e64 v218, 16, v62
  v_and_b32 v219, 0xffff0000, v62
  v_pk_fma_f32 v[122:123], v[216:217], v[104:105], v[122:123]
  v_pk_fma_f32 v[120:121], v[216:217], v[100:101], v[120:121]
  v_pk_fma_f32 v[118:119], v[216:217], v[96:97], v[118:119]
  v_pk_mul_f32 v[126:127], v[218:219], v[108:109]
  v_lshlrev_b32_e64 v216, 16, v64
  v_and_b32 v217, 0xffff0000, v64
  v_pk_fma_f32 v[124:125], v[218:219], v[104:105], v[124:125]
  v_pk_fma_f32 v[122:123], v[218:219], v[100:101], v[122:123]
  v_pk_fma_f32 v[120:121], v[218:219], v[96:97], v[120:121]
  v_pk_fma_f32 v[126:127], v[216:217], v[104:105], v[126:127]
  v_lshlrev_b32_e64 v218, 16, v66
  v_and_b32 v219, 0xffff0000, v66
  v_pk_fma_f32 v[124:125], v[216:217], v[100:101], v[124:125]
  v_pk_fma_f32 v[122:123], v[216:217], v[96:97], v[122:123]
  v_pk_fma_f32 v[126:127], v[218:219], v[100:101], v[126:127]
  v_lshlrev_b32_e64 v216, 16, v68
  v_and_b32 v217, 0xffff0000, v68
  v_pk_fma_f32 v[124:125], v[218:219], v[96:97], v[124:125]
  v_pk_fma_f32 v[126:127], v[216:217], v[96:97], v[126:127]
  s_waitcnt lgkmcnt(0)
  v_lshlrev_b32 v220, 16, v70
  v_and_b32 v221, 0xffff0000, v70
  v_lshlrev_b32_e64 v222, 16, v72
  v_and_b32 v223, 0xffff0000, v72
  v_pk_mul_f32 v[112:113], v[112:113], v[220:221]
  v_lshlrev_b32_e64 v220, 16, v74
  v_and_b32 v221, 0xffff0000, v74
  v_pk_mul_f32 v[114:115], v[114:115], v[222:223]
  v_lshlrev_b32_e64 v222, 16, v76
  v_and_b32 v223, 0xffff0000, v76
  v_pk_mul_f32 v[116:117], v[116:117], v[220:221]
  v_lshlrev_b32_e64 v220, 16, v78
  v_and_b32 v221, 0xffff0000, v78
  v_pk_mul_f32 v[118:119], v[118:119], v[222:223]
  v_lshlrev_b32_e64 v222, 16, v80
  v_and_b32 v223, 0xffff0000, v80
  v_pk_mul_f32 v[120:121], v[120:121], v[220:221]
  v_lshlrev_b32_e64 v220, 16, v82
  v_and_b32 v221, 0xffff0000, v82
  v_pk_mul_f32 v[122:123], v[122:123], v[222:223]
  v_lshlrev_b32_e64 v222, 16, v84
  v_and_b32 v223, 0xffff0000, v84
  v_pk_mul_f32 v[124:125], v[124:125], v[220:221]
  v_pk_mul_f32 v[126:127], v[126:127], v[222:223]
  v_cvt_pk_bf16_f32 v232, v126, v124
  v_cvt_pk_bf16_f32 v233, v122, v120
  v_cvt_pk_bf16_f32 v234, v118, v116
  v_cvt_pk_bf16_f32 v235, v114, v112
  v_cvt_pk_bf16_f32 v236, v127, v125
  v_cvt_pk_bf16_f32 v237, v123, v121
  v_cvt_pk_bf16_f32 v238, v119, v117
  v_cvt_pk_bf16_f32 v239, v115, v113
  v_lshlrev_b32_e64 v216, 16, v49
  v_and_b32 v217, 0xffff0000, v49
  v_pk_mul_f32 v[112:113], v[216:217], v[110:111]
  v_lshlrev_b32_e64 v218, 16, v51
  v_and_b32 v219, 0xffff0000, v51
  v_pk_mul_f32 v[114:115], v[218:219], v[110:111]
  v_lshlrev_b32_e64 v216, 16, v53
  v_and_b32 v217, 0xffff0000, v53
  v_pk_fma_f32 v[112:113], v[218:219], v[106:107], v[112:113]
  v_pk_mul_f32 v[116:117], v[216:217], v[110:111]
  v_lshlrev_b32_e64 v218, 16, v55
  v_and_b32 v219, 0xffff0000, v55
  v_pk_fma_f32 v[114:115], v[216:217], v[106:107], v[114:115]
  v_pk_fma_f32 v[112:113], v[216:217], v[102:103], v[112:113]
  v_pk_mul_f32 v[118:119], v[218:219], v[110:111]
  v_lshlrev_b32_e64 v216, 16, v57
  v_and_b32 v217, 0xffff0000, v57
  v_pk_fma_f32 v[116:117], v[218:219], v[106:107], v[116:117]
  v_pk_fma_f32 v[114:115], v[218:219], v[102:103], v[114:115]
  v_pk_fma_f32 v[112:113], v[218:219], v[98:99], v[112:113]
  v_pk_mul_f32 v[120:121], v[216:217], v[110:111]
  v_lshlrev_b32_e64 v218, 16, v59
  v_and_b32 v219, 0xffff0000, v59
  v_pk_fma_f32 v[118:119], v[216:217], v[106:107], v[118:119]
  v_pk_fma_f32 v[116:117], v[216:217], v[102:103], v[116:117]
  v_pk_fma_f32 v[114:115], v[216:217], v[98:99], v[114:115]
  v_pk_mul_f32 v[122:123], v[218:219], v[110:111]
  v_lshlrev_b32_e64 v216, 16, v61
  v_and_b32 v217, 0xffff0000, v61
  v_pk_fma_f32 v[120:121], v[218:219], v[106:107], v[120:121]
  v_pk_fma_f32 v[118:119], v[218:219], v[102:103], v[118:119]
  v_pk_fma_f32 v[116:117], v[218:219], v[98:99], v[116:117]
  v_pk_mul_f32 v[124:125], v[216:217], v[110:111]
  v_lshlrev_b32_e64 v218, 16, v63
  v_and_b32 v219, 0xffff0000, v63
  v_pk_fma_f32 v[122:123], v[216:217], v[106:107], v[122:123]
  v_pk_fma_f32 v[120:121], v[216:217], v[102:103], v[120:121]
  v_pk_fma_f32 v[118:119], v[216:217], v[98:99], v[118:119]
  v_pk_mul_f32 v[126:127], v[218:219], v[110:111]
  v_lshlrev_b32_e64 v216, 16, v65
  v_and_b32 v217, 0xffff0000, v65
  v_pk_fma_f32 v[124:125], v[218:219], v[106:107], v[124:125]
  v_pk_fma_f32 v[122:123], v[218:219], v[102:103], v[122:123]
  v_pk_fma_f32 v[120:121], v[218:219], v[98:99], v[120:121]
  v_pk_fma_f32 v[126:127], v[216:217], v[106:107], v[126:127]
  v_lshlrev_b32_e64 v218, 16, v67
  v_and_b32 v219, 0xffff0000, v67
  v_pk_fma_f32 v[124:125], v[216:217], v[102:103], v[124:125]
  v_pk_fma_f32 v[122:123], v[216:217], v[98:99], v[122:123]
  v_pk_fma_f32 v[126:127], v[218:219], v[102:103], v[126:127]
  v_lshlrev_b32_e64 v216, 16, v69
  v_and_b32 v217, 0xffff0000, v69
  v_pk_fma_f32 v[124:125], v[218:219], v[98:99], v[124:125]
  v_pk_fma_f32 v[126:127], v[216:217], v[98:99], v[126:127]
  v_lshlrev_b32_e64 v220, 16, v71
  v_and_b32 v221, 0xffff0000, v71
  v_lshlrev_b32_e64 v222, 16, v73
  v_and_b32 v223, 0xffff0000, v73
  v_pk_mul_f32 v[112:113], v[112:113], v[220:221]
  v_lshlrev_b32_e64 v220, 16, v75
  v_and_b32 v221, 0xffff0000, v75
  v_pk_mul_f32 v[114:115], v[114:115], v[222:223]
  v_lshlrev_b32_e64 v222, 16, v77
  v_and_b32 v223, 0xffff0000, v77
  v_pk_mul_f32 v[116:117], v[116:117], v[220:221]
  v_lshlrev_b32_e64 v220, 16, v79
  v_and_b32 v221, 0xffff0000, v79
  v_pk_mul_f32 v[118:119], v[118:119], v[222:223]
  v_lshlrev_b32_e64 v222, 16, v81
  v_and_b32 v223, 0xffff0000, v81
  v_pk_mul_f32 v[120:121], v[120:121], v[220:221]
  v_lshlrev_b32_e64 v220, 16, v83
  v_and_b32 v221, 0xffff0000, v83
  v_pk_mul_f32 v[122:123], v[122:123], v[222:223]
  v_lshlrev_b32_e64 v222, 16, v85
  v_and_b32 v223, 0xffff0000, v85
  v_pk_mul_f32 v[124:125], v[124:125], v[220:221]
  v_pk_mul_f32 v[126:127], v[126:127], v[222:223]
  v_cvt_pk_bf16_f32 v88, v126, v124
  v_cvt_pk_bf16_f32 v89, v122, v120
  v_cvt_pk_bf16_f32 v90, v118, v116
  v_cvt_pk_bf16_f32 v91, v114, v112
  v_cvt_pk_bf16_f32 v92, v127, v125
  v_cvt_pk_bf16_f32 v93, v123, v121
  v_cvt_pk_bf16_f32 v94, v119, v117
  v_cvt_pk_bf16_f32 v95, v115, v113
  s_waitcnt vmcnt(0)
  v_xor_b32 v15, s8, v184
  v_cmp_lt_u32 vcc, 15, v15
  s_cbranch_vccnz again_13
ok_14:
  s_or_b32 s13, s8, s11
  v_cmp_ne_u32 vcc, s13, v184
  s_cmp_eq_u64 vcc, 0
  s_cselect_b32 s9, 1, 0
  s_cmp_eq_u32 s7, 2
  s_cselect_b32 s40, 0, s9
  buffer_store_dwordx4 v[232:235], v171, s[52:55], s87 offen sc1
  s_add_u32 s87, s87, s36
  buffer_store_dwordx4 v[236:239], v171, s[52:55], s87 offen sc1
  s_add_u32 s87, s87, s36
  buffer_store_dwordx4 v[88:91], v171, s[52:55], s87 offen sc1
  s_add_u32 s87, s87, s36
  buffer_store_dwordx4 v[92:95], v171, s[52:55], s87 offen sc1
  s_branch join_12
w3_11:
  s_lshl_b32 s12, s4, 3
  s_and_b32 s13, s3, 7
  s_add_u32 s12, s12, s13
  s_mul_i32 s12, s12, 6400
  s_mov_b32 exec_hi, 0xff
  buffer_load_dwordx4 v[48:51], v150, s[60:63], s12 offen offset:0
  buffer_load_dwordx4 v[52:55], v150, s[60:63], s12 offen offset:128
  buffer_load_dwordx4 v[56:59], v150, s[60:63], s12 offen offset:256
  buffer_load_dwordx4 v[60:63], v150, s[60:63], s12 offen offset:384
  buffer_load_dwordx4 v[64:67], v150, s[60:63], s12 offen offset:512
  buffer_load_dwordx4 v[68:71], v150, s[60:63], s12 offen offset:640
  buffer_load_dwordx4 v[72:75], v150, s[60:63], s12 offen offset:768
  buffer_load_dwordx4 v[76:79], v150, s[60:63], s12 offen offset:896
  buffer_load_dwordx4 v[80:83], v150, s[60:63], s12 offen offset:1024
  buffer_load_dwordx4 v[84:87], v150, s[60:63], s12 offen offset:1152
  s_mov_b32 exec_hi, -1
  s_mov_b32 s64, s22
  s_and_b32 s65, s23, 0xffff
  s_mov_b32 s66, 819200
  s_mov_b32 s67, 0x20000
  v_xor_b32 v11, 64, v148
  v_xor_b32_e64 v12, 64, v149
  s_mul_i32 s15, s4, 51200
  s_add_u32 s14, s15, 256
  s_mov_b32 m0, 20480
  s_nop 0
  buffer_load_dwordx4 v11, s[64:67], s14 offen lds
  buffer_load_dwordx4 v12, s[64:67], s14 offen offset:2048 lds
  s_mov_b32 m0, 21504
  s_nop 0
  buffer_load_dwordx4 v148, s[56:59], s14 offen lds
  buffer_load_dwordx4 v149, s[56:59], s14 offen offset:2048 lds
  s_add_u32 s14, s15, 20736
  s_mov_b32 m0, 24576
  s_nop 0
  buffer_load_dwordx4 v11, s[64:67], s14 offen lds
  buffer_load_dwordx4 v12, s[64:67], s14 offen offset:2048 lds
  s_mov_b32 m0, 25600
  s_nop 0
  buffer_load_dwordx4 v148, s[56:59], s14 offen lds
  buffer_load_dwordx4 v149, s[56:59], s14 offen offset:2048 lds
  s_add_u32 s14, s15, 41216
  s_mov_b32 m0, 28672
  s_nop 0
  buffer_load_dwordx4 v11, s[64:67], s14 offen lds
  s_mov_b32 m0, 29696
  s_nop 0
  buffer_load_dwordx4 v148, s[56:59], s14 offen lds
  s_add_u32 s14, s15, 384
  s_mov_b32 m0, 30720
  s_nop 0
  buffer_load_dwordx4 v11, s[64:67], s14 offen lds
  buffer_load_dwordx4 v12, s[64:67], s14 offen offset:2048 lds
  s_mov_b32 m0, 31744
  s_nop 0
  buffer_load_dwordx4 v148, s[56:59], s14 offen lds
  buffer_load_dwordx4 v149, s[56:59], s14 offen offset:2048 lds
  s_add_u32 s14, s15, 20864
  s_mov_b32 m0, 34816
  s_nop 0
  buffer_load_dwordx4 v11, s[64:67], s14 offen lds
  buffer_load_dwordx4 v12, s[64:67], s14 offen offset:2048 lds
  s_mov_b32 m0, 35840
  s_nop 0
  buffer_load_dwordx4 v148, s[56:59], s14 offen lds
  buffer_load_dwordx4 v149, s[56:59], s14 offen offset:2048 lds
  s_add_u32 s14, s15, 41344
  s_mov_b32 m0, 38912
  s_nop 0
  buffer_load_dwordx4 v11, s[64:67], s14 offen lds
  s_mov_b32 m0, 39936
  s_nop 0
  buffer_load_dwordx4 v148, s[56:59], s14 offen lds
  s_mov_b32 s64, s22
  s_and_b32 s65, s23, 0xffff
  s_mov_b32 s66, 819200
  s_mov_b32 s67, 0x20000
  v_xor_b32 v11, 64, v148
  v_xor_b32_e64 v12, 64, v149
  s_mul_i32 s15, s4, 51200
  s_add_u32 s14, s15, 512
  s_mov_b32 m0, 40960
  s_nop 0
  buffer_load_dwordx4 v11, s[64:67], s14 offen lds
  buffer_load_dwordx4 v12, s[64:67], s14 offen offset:2048 lds
  s_mov_b32 m0, 41984
  s_nop 0
  buffer_load_dwordx4 v148, s[56:59], s14 offen lds
  buffer_load_dwordx4 v149, s[56:59], s14 offen offset:2048 lds
  s_add_u32 s14, s15, 20992
  s_mov_b32 m0, 45056
  s_nop 0
  buffer_load_dwordx4 v11, s[64:67], s14 offen lds
  buffer_load_dwordx4 v12, s[64:67], s14 offen offset:2048 lds
  s_mov_b32 m0, 46080
  s_nop 0
  buffer_load_dwordx4 v148, s[56:59], s14 offen lds
  buffer_load_dwordx4 v149, s[56:59], s14 offen offset:2048 lds
  s_add_u32 s14, s15, 41472
  s_mov_b32 m0, 49152
  s_nop 0
  buffer_load_dwordx4 v11, s[64:67], s14 offen lds
  s_mov_b32 m0, 50176
  s_nop 0
  buffer_load_dwordx4 v148, s[56:59], s14 offen lds
  s_add_u32 s14, s15, 640
  s_mov_b32 m0, 51200
  s_nop 0
  buffer_load_dwordx4 v11, s[64:67], s14 offen lds
  buffer_load_dwordx4 v12, s[64:67], s14 offen offset:2048 lds
  s_mov_b32 m0, 52224
  s_nop 0
  buffer_load_dwordx4 v148, s[56:59], s14 offen lds
  buffer_load_dwordx4 v149, s[56:59], s14 offen offset:2048 lds
  s_add_u32 s14, s15, 21120
  s_mov_b32 m0, 55296
  s_nop 0
  buffer_load_dwordx4 v11, s[64:67], s14 offen lds
  buffer_load_dwordx4 v12, s[64:67], s14 offen offset:2048 lds
  s_mov_b32 m0, 56320
  s_nop 0
  buffer_load_dwordx4 v148, s[56:59], s14 offen lds
  buffer_load_dwordx4 v149, s[56:59], s14 offen offset:2048 lds
  s_add_u32 s14, s15, 41600
  s_mov_b32 m0, 59392
  s_nop 0
  buffer_load_dwordx4 v11, s[64:67], s14 offen lds
  s_mov_b32 m0, 60416
  s_nop 0
  buffer_load_dwordx4 v148, s[56:59], s14 offen lds
  s_waitcnt vmcnt(50)
  v_xor_b32 v15, s8, v184
  v_cmp_lt_u32 vcc, 15, v15
  s_cbranch_vccnz again_15
ok_16:
  s_or_b32 s13, s8, s11
  v_cmp_ne_u32 vcc, s13, v184
  s_cmp_eq_u64 vcc, 0
  s_cselect_b32 s9, 1, 0
  s_cmp_eq_u32 s7, 2
  s_cselect_b32 s40, 0, s9
  s_waitcnt vmcnt(40)
  v_dot2_f32_bf16 v88, v48, s2, 0
  v_dot2_f32_bf16 v89, v49, s2, 0
  v_dot2_f32_bf16 v88, v50, s2, v88
  v_dot2_f32_bf16 v89, v51, s2, v89
  v_dot2_f32_bf16 v88, v52, s2, v88
  v_dot2_f32_bf16 v89, v53, s2, v89
  v_dot2_f32_bf16 v88, v54, s2, v88
  v_dot2_f32_bf16 v89, v55, s2, v89
  v_dot2_f32_bf16 v88, v56, s2, v88
  v_dot2_f32_bf16 v89, v57, s2, v89
  v_dot2_f32_bf16 v88, v58, s2, v88
  v_dot2_f32_bf16 v89, v59, s2, v89
  v_dot2_f32_bf16 v88, v60, s2, v88
  v_dot2_f32_bf16 v89, v61, s2, v89
  v_dot2_f32_bf16 v88, v62, s2, v88
  v_dot2_f32_bf16 v89, v63, s2, v89
  v_dot2_f32_bf16 v88, v64, s2, v88
  v_dot2_f32_bf16 v89, v65, s2, v89
  v_dot2_f32_bf16 v88, v66, s2, v88
  v_dot2_f32_bf16 v89, v67, s2, v89
  v_dot2_f32_bf16 v88, v68, s2, v88
  v_dot2_f32_bf16 v89, v69, s2, v89
  v_dot2_f32_bf16 v88, v70, s2, v88
  v_dot2_f32_bf16 v89, v71, s2, v89
  v_dot2_f32_bf16 v88, v72, s2, v88
  v_dot2_f32_bf16 v89, v73, s2, v89
  v_dot2_f32_bf16 v88, v74, s2, v88
  v_dot2_f32_bf16 v89, v75, s2, v89
  v_dot2_f32_bf16 v88, v76, s2, v88
  v_dot2_f32_bf16 v89, v77, s2, v89
  v_dot2_f32_bf16 v88, v78, s2, v88
  v_dot2_f32_bf16 v89, v79, s2, v89
  v_dot2_f32_bf16 v88, v80, s2, v88
  v_dot2_f32_bf16 v89, v81, s2, v89
  v_dot2_f32_bf16 v88, v82, s2, v88
  v_dot2_f32_bf16 v89, v83, s2, v89
  v_dot2_f32_bf16 v88, v84, s2, v88
  v_dot2_f32_bf16 v89, v85, s2, v89
  v_dot2_f32_bf16 v88, v86, s2, v88
  v_dot2_f32_bf16 v89, v87, s2, v89
  s_nop 2
  v_add_f32 v88, v88, v89
  s_nop 1
  v_add_f32_dpp v88, v88, v88 quad_perm:[1,0,3,2] row_mask:0xf bank_mask:0xf
  s_nop 1
  v_add_f32_dpp v88, v88, v88 quad_perm:[2,3,0,1] row_mask:0xf bank_mask:0xf
  s_nop 1
  v_add_f32_dpp v88, v88, v88 row_half_mirror row_mask:0xf bank_mask:0xf
  v_mov_b32 v89, s8
  v_lshlrev_b32 v11, 1, v1
  s_lshl_b32 s12, s4, 3
  s_and_b32 s13, s3, 7
  s_add_u32 s12, s12, s13
  s_mul_i32 s12, s12, 80
  s_and_b32 s13, s3, 8
  s_add_u32 s12, s12, s13
  s_add_u32 s12, s12, 303104
  s_mov_b32 exec_lo, 0x01010101
  s_mov_b32 exec_hi, 1
  buffer_store_dwordx2 v[88:89], v11, s[52:55], s12 offen sc1
  s_mov_b64 exec, -1
join_12:
  s_waitcnt lgkmcnt(0)
  v_mul_f32_e64 v21, v151, v21
  v_mul_f32_dpp v27, v26, v151 quad_perm:[1,0,3,2] row_mask:0xf bank_mask:0xf
  v_mul_f32_e64 v22, v151, v22
  v_mul_f32_dpp v29, v28, v151 quad_perm:[1,0,3,2] row_mask:0xf bank_mask:0xf
  v_mul_f32_e64 v23, v151, v23
  v_mul_f32_dpp v31, v30, v151 quad_perm:[1,0,3,2] row_mask:0xf bank_mask:0xf
  v_mul_f32_e64 v24, v151, v24
  v_mul_f32_dpp v33, v32, v151 quad_perm:[1,0,3,2] row_mask:0xf bank_mask:0xf
  v_mul_f32_e64 v25, v151, v25
  v_mul_f32_dpp v35, v34, v151 quad_perm:[1,0,3,2] row_mask:0xf bank_mask:0xf
  s_waitcnt vmcnt(7)
  s_barrier
  ds_read_b128 v[128:131], v144 offset:0
  ds_read_b128 v[132:135], v144 offset:8192
  ds_read_b128 v[88:91], v5 offset:0
  ds_read_b128 v[92:95], v5 offset:2048
  ds_read_b128 v[96:99], v5 offset:4096
  ds_read_b128 v[100:103], v5 offset:6144
  ds_read_b128 v[104:107], v5 offset:8192
  s_add_u32 m0, s77, 16384
  s_add_u32 s15, s76, 128
  buffer_load_dwordx4 v146, s[68:71], s15 offen lds
  buffer_load_dwordx4 v147, s[68:71], s15 offen offset:1024 lds
  s_add_u32 m0, s77, 24576
  s_add_u32 s15, s76, 5248
  buffer_load_dwordx4 v146, s[68:71], s15 offen lds
  buffer_load_dwordx4 v147, s[68:71], s15 offen offset:1024 lds
  s_waitcnt lgkmcnt(4)
  v_mfma_f32_16x16x32_bf16 v[48:51], v[128:131], v[88:91], 0
  ds_read_b128 v[136:139], v145 offset:0
  ds_read_b128 v[140:143], v145 offset:8192
  ds_read_b128 v[108:111], v6 offset:0
  ds_read_b128 v[192:195], v175 offset:0
  ds_read_b128 v[196:199], v175 offset:16
  v_mfma_f32_16x16x32_bf16 v[52:55], v[132:135], v[88:91], 0
  ds_read_b128 v[200:203], v175 offset:32
  ds_read_b128 v[204:207], v175 offset:48
  s_waitcnt lgkmcnt(10)
  v_mfma_f32_16x16x32_bf16 v[56:59], v[128:131], v[92:95], 0
  ds_read_b128 v[112:115], v6 offset:2048
  s_waitcnt vmcnt(9)
  s_waitcnt lgkmcnt(1)
  v_lshlrev_b32_e64 v152, 16, v176
  v_mfma_f32_16x16x32_bf16 v[60:63], v[132:135], v[92:95], 0
  v_and_b32 v153, 0xffff0000, v176
  v_lshlrev_b32_e64 v154, 16, v180
  v_mfma_f32_16x16x32_bf16 v[64:67], v[128:131], v[96:99], 0
  ds_read_b128 v[116:119], v6 offset:4096
  v_and_b32 v155, 0xffff0000, v180
  v_pk_mul_f32 v[156:157], v[152:153], v[192:193]
  v_mfma_f32_16x16x32_bf16 v[68:71], v[132:135], v[96:99], 0
  v_pk_mul_f32 v[158:159], v[152:153], v[194:195] neg_lo:[0,1] neg_hi:[0,1]
  v_pk_fma_f32 v[156:157], v[154:155], v[194:195], v[156:157] neg_lo:[0,1,0] neg_hi:[0,1,0]
  v_mfma_f32_16x16x32_bf16 v[72:75], v[128:131], v[100:103], 0
  ds_read_b128 v[120:123], v6 offset:6144
  v_pk_fma_f32 v[158:159], v[154:155], v[192:193], v[158:159] neg_lo:[0,1,0] neg_hi:[0,1,0]
  v_cvt_pk_bf16_f32 v176, v156, v157
  v_mfma_f32_16x16x32_bf16 v[76:79], v[132:135], v[100:103], 0
  s_add_u32 m0, s77, 32768
  s_add_u32 s15, s76, 256
  buffer_load_dwordx4 v146, s[68:71], s15 offen lds
  buffer_load_dwordx4 v147, s[68:71], s15 offen offset:1024 lds
  s_add_u32 m0, s77, 40960
  s_add_u32 s15, s76, 5376
  buffer_load_dwordx4 v146, s[68:71], s15 offen lds
  buffer_load_dwordx4 v147, s[68:71], s15 offen offset:1024 lds
  v_mfma_f32_16x16x32_bf16 v[80:83], v[128:131], v[104:107], 0
  ds_read_b128 v[124:127], v6 offset:8192
  s_add_u32 m0, s75, 61440
  s_add_u32 s14, s74, 768
  buffer_load_dwordx4 v148, s[56:59], s14 offen lds
  buffer_load_dwordx4 v149, s[56:59], s14 offen offset:2048 lds
  v_mfma_f32_16x16x32_bf16 v[84:87], v[132:135], v[104:107], 0
  s_add_u32 m0, s75, 65536
  s_add_u32 s14, s74, 21248
  buffer_load_dwordx4 v148, s[56:59], s14 offen lds
  buffer_load_dwordx4 v149, s[56:59], s14 offen offset:2048 lds
  s_waitcnt vmcnt(8)
  s_waitcnt lgkmcnt(2)
  v_mfma_f32_16x16x32_bf16 v[48:51], v[136:139], v[108:111], v[48:51]
  ds_read_b128 v[128:131], v144 offset:16384
  ds_read_b128 v[132:135], v144 offset:24576
  ds_read_b128 v[88:91], v5 offset:10240
  v_cvt_pk_bf16_f32 v180, v158, v159
  v_lshlrev_b32_e64 v152, 16, v177
  v_mfma_f32_16x16x32_bf16 v[52:55], v[140:143], v[108:111], v[52:55]
  v_and_b32 v153, 0xffff0000, v177
  v_lshlrev_b32_e64 v154, 16, v181
  v_mfma_f32_16x16x32_bf16 v[56:59], v[136:139], v[112:115], v[56:59]
  ds_read_b128 v[92:95], v5 offset:12288
  v_and_b32 v155, 0xffff0000, v181
  v_pk_mul_f32 v[156:157], v[152:153], v[196:197]
  v_mfma_f32_16x16x32_bf16 v[60:63], v[140:143], v[112:115], v[60:63]
  v_pk_mul_f32 v[158:159], v[152:153], v[198:199] neg_lo:[0,1] neg_hi:[0,1]
  v_pk_fma_f32 v[156:157], v[154:155], v[198:199], v[156:157] neg_lo:[0,1,0] neg_hi:[0,1,0]
  v_mfma_f32_16x16x32_bf16 v[64:67], v[136:139], v[116:119], v[64:67]
  ds_read_b128 v[96:99], v5 offset:14336
  v_pk_fma_f32 v[158:159], v[154:155], v[196:197], v[158:159] neg_lo:[0,1,0] neg_hi:[0,1,0]
  v_cvt_pk_bf16_f32 v177, v156, v157
  v_mfma_f32_16x16x32_bf16 v[68:71], v[140:143], v[116:119], v[68:71]
  v_cvt_pk_bf16_f32 v181, v158, v159
  v_lshlrev_b32 v152, 16, v178
  s_waitcnt lgkmcnt(5)
  v_mfma_f32_16x16x32_bf16 v[72:75], v[136:139], v[120:123], v[72:75]
  ds_read_b128 v[100:103], v5 offset:16384
  v_and_b32 v153, 0xffff0000, v178
  v_lshlrev_b32_e64 v154, 16, v182
  v_mfma_f32_16x16x32_bf16 v[76:79], v[140:143], v[120:123], v[76:79]
  s_add_u32 m0, s77, 49152
  s_add_u32 s15, s76, 384
  buffer_load_dwordx4 v146, s[68:71], s15 offen lds
  buffer_load_dwordx4 v147, s[68:71], s15 offen offset:1024 lds
  v_mfma_f32_16x16x32_bf16 v[80:83], v[136:139], v[124:127], v[80:83]
  ds_read_b128 v[104:107], v5 offset:18432
  s_add_u32 m0, s77, 0
  s_add_u32 s15, s76, 5504
  buffer_load_dwordx4 v146, s[68:71], s15 offen lds
  buffer_load_dwordx4 v147, s[68:71], s15 offen offset:1024 lds
  v_mfma_f32_16x16x32_bf16 v[84:87], v[140:143], v[124:127], v[84:87]
  s_add_u32 m0, s75, 69632
  s_add_u32 s14, s74, 41728
  buffer_load_dwordx4 v148, s[56:59], s14 offen lds
  s_waitcnt lgkmcnt(2)
  v_mfma_f32_16x16x32_bf16 v[48:51], v[128:131], v[88:91], v[48:51]
  ds_read_b128 v[136:139], v145 offset:16384
  ds_read_b128 v[140:143], v145 offset:24576
  ds_read_b128 v[108:111], v6 offset:10240
  v_and_b32 v155, 0xffff0000, v182
  v_pk_mul_f32 v[156:157], v[152:153], v[200:201]
  v_mfma_f32_16x16x32_bf16 v[52:55], v[132:135], v[88:91], v[52:55]
  v_pk_mul_f32 v[158:159], v[152:153], v[202:203] neg_lo:[0,1] neg_hi:[0,1]
  v_pk_fma_f32 v[156:157], v[154:155], v[202:203], v[156:157] neg_lo:[0,1,0] neg_hi:[0,1,0]
  v_mfma_f32_16x16x32_bf16 v[56:59], v[128:131], v[92:95], v[56:59]
  ds_read_b128 v[112:115], v6 offset:12288
  v_pk_fma_f32 v[158:159], v[154:155], v[200:201], v[158:159] neg_lo:[0,1,0] neg_hi:[0,1,0]
  v_cvt_pk_bf16_f32 v178, v156, v157
  v_mfma_f32_16x16x32_bf16 v[60:63], v[132:135], v[92:95], v[60:63]
  v_cvt_pk_bf16_f32 v182, v158, v159
  v_lshlrev_b32_e64 v152, 16, v179
  v_mfma_f32_16x16x32_bf16 v[64:67], v[128:131], v[96:99], v[64:67]
  ds_read_b128 v[116:119], v6 offset:14336
  v_and_b32 v153, 0xffff0000, v179
  v_lshlrev_b32_e64 v154, 16, v183
  v_mfma_f32_16x16x32_bf16 v[68:71], v[132:135], v[96:99], v[68:71]
  v_and_b32 v155, 0xffff0000, v183
  v_pk_mul_f32 v[156:157], v[152:153], v[204:205]
  s_waitcnt lgkmcnt(5)
  v_mfma_f32_16x16x32_bf16 v[72:75], v[128:131], v[100:103], v[72:75]
  ds_read_b128 v[120:123], v6 offset:16384
  v_pk_mul_f32 v[158:159], v[152:153], v[206:207] neg_lo:[0,1] neg_hi:[0,1]
  v_pk_fma_f32 v[156:157], v[154:155], v[206:207], v[156:157] neg_lo:[0,1,0] neg_hi:[0,1,0]
  v_mfma_f32_16x16x32_bf16 v[76:79], v[132:135], v[100:103], v[76:79]
  s_add_u32 m0, s77, 8192
  s_add_u32 s15, s76, 512
  buffer_load_dwordx4 v146, s[68:71], s15 offen lds
  buffer_load_dwordx4 v147, s[68:71], s15 offen offset:1024 lds
  v_mfma_f32_16x16x32_bf16 v[80:83], v[128:131], v[104:107], v[80:83]
  ds_read_b128 v[124:127], v6 offset:18432
  s_add_u32 m0, s75, 81920
  s_add_u32 s14, s74, 1024
  buffer_load_dwordx4 v148, s[56:59], s14 offen lds
  buffer_load_dwordx4 v149, s[56:59], s14 offen offset:2048 lds
  v_mfma_f32_16x16x32_bf16 v[84:87], v[132:135], v[104:107], v[84:87]
  s_add_u32 m0, s75, 86016
  s_add_u32 s14, s74, 21504
  buffer_load_dwordx4 v148, s[56:59], s14 offen lds
  buffer_load_dwordx4 v149, s[56:59], s14 offen offset:2048 lds
  s_waitcnt vmcnt(15)
  s_barrier
  s_waitcnt lgkmcnt(2)
  v_mfma_f32_16x16x32_bf16 v[48:51], v[136:139], v[108:111], v[48:51]
  ds_read_b128 v[128:131], v144 offset:32768
  ds_read_b128 v[132:135], v144 offset:40960
  ds_read_b128 v[88:91], v5 offset:20480
  v_pk_fma_f32 v[158:159], v[154:155], v[204:205], v[158:159] neg_lo:[0,1,0] neg_hi:[0,1,0]
  v_mfma_f32_16x16x32_bf16 v[52:55], v[140:143], v[108:111], v[52:55]
  v_cvt_pk_bf16_f32 v179, v156, v157
  v_mfma_f32_16x16x32_bf16 v[56:59], v[136:139], v[112:115], v[56:59]
  ds_read_b128 v[92:95], v5 offset:22528
  v_cvt_pk_bf16_f32 v183, v158, v159
  v_mfma_f32_16x16x32_bf16 v[60:63], v[140:143], v[112:115], v[60:63]
  s_mul_i32 s12, s0, 204800
  s_add_u32 s12, s12, 23068672
  s_add_u32 s13, s12, 5120
  buffer_store_dwordx4 v[176:179], v174, s[52:55], s12 offen sc1
  buffer_store_dwordx4 v[180:183], v174, s[52:55], s13 offen sc1
  v_mfma_f32_16x16x32_bf16 v[64:67], v[136:139], v[116:119], v[64:67]
  ds_read_b128 v[96:99], v5 offset:24576
  s_add_u32 m0, s77, 16384
  s_add_u32 s15, s76, 5632
  buffer_load_dwordx4 v146, s[68:71], s15 offen lds
  buffer_load_dwordx4 v147, s[68:71], s15 offen offset:1024 lds
  v_mfma_f32_16x16x32_bf16 v[68:71], v[140:143], v[116:119], v[68:71]
  s_add_u32 m0, s75, 90112
  s_add_u32 s14, s74, 41984
  buffer_load_dwordx4 v148, s[56:59], s14 offen lds
  s_waitcnt lgkmcnt(5)
  v_mfma_f32_16x16x32_bf16 v[72:75], v[136:139], v[120:123], v[72:75]
  ds_read_b128 v[100:103], v5 offset:26624
  v_mfma_f32_16x16x32_bf16 v[76:79], v[140:143], v[120:123], v[76:79]
  v_mfma_f32_16x16x32_bf16 v[80:83], v[136:139], v[124:127], v[80:83]
  ds_read_b128 v[104:107], v5 offset:28672
  v_mfma_f32_16x16x32_bf16 v[84:87], v[140:143], v[124:127], v[84:87]
  s_waitcnt lgkmcnt(2)
  v_mfma_f32_16x16x32_bf16 v[48:51], v[128:131], v[88:91], v[48:51]
  ds_read_b128 v[136:139], v145 offset:32768
  ds_read_b128 v[140:143], v145 offset:40960
  ds_read_b128 v[108:111], v6 offset:20480
  s_add_u32 m0, s77, 24576
  s_add_u32 s15, s76, 640
  buffer_load_dwordx4 v146, s[68:71], s15 offen lds
  buffer_load_dwordx4 v147, s[68:71], s15 offen offset:1024 lds
  v_mfma_f32_16x16x32_bf16 v[52:55], v[132:135], v[88:91], v[52:55]
  v_mfma_f32_16x16x32_bf16 v[56:59], v[128:131], v[92:95], v[56:59]
  ds_read_b128 v[112:115], v6 offset:22528
  v_mfma_f32_16x16x32_bf16 v[60:63], v[132:135], v[92:95], v[60:63]
  v_mfma_f32_16x16x32_bf16 v[64:67], v[128:131], v[96:99], v[64:67]
  ds_read_b128 v[116:119], v6 offset:24576
  v_mfma_f32_16x16x32_bf16 v[68:71], v[132:135], v[96:99], v[68:71]
  s_waitcnt lgkmcnt(5)
  v_mfma_f32_16x16x32_bf16 v[72:75], v[128:131], v[100:103], v[72:75]
  ds_read_b128 v[120:123], v6 offset:26624
  v_mfma_f32_16x16x32_bf16 v[76:79], v[132:135], v[100:103], v[76:79]
  v_mfma_f32_16x16x32_bf16 v[80:83], v[128:131], v[104:107], v[80:83]
  ds_read_b128 v[124:127], v6 offset:28672
  v_mfma_f32_16x16x32_bf16 v[84:87], v[132:135], v[104:107], v[84:87]
  s_waitcnt vmcnt(14)
  s_waitcnt lgkmcnt(2)
  v_mfma_f32_16x16x32_bf16 v[48:51], v[136:139], v[108:111], v[48:51]
  ds_read_b128 v[128:131], v144 offset:49152
  ds_read_b128 v[132:135], v144 offset:0
  ds_read_b128 v[88:91], v5 offset:30720
  s_add_u32 m0, s77, 32768
  s_add_u32 s15, s76, 5760
  buffer_load_dwordx4 v146, s[68:71], s15 offen lds
  buffer_load_dwordx4 v147, s[68:71], s15 offen offset:1024 lds
  v_mfma_f32_16x16x32_bf16 v[52:55], v[140:143], v[108:111], v[52:55]
  v_mov_b32 v15, s8
  s_mov_b64 exec, 1
  s_cmp_eq_u32 s40, 0
  s_cbranch_scc1 slow_17
  buffer_store_dword v15, off, s[52:55], s41
back_18:
  s_mov_b64 exec, -1
  v_mfma_f32_16x16x32_bf16 v[56:59], v[136:139], v[112:115], v[56:59]
  ds_read_b128 v[92:95], v5 offset:32768
  v_mfma_f32_16x16x32_bf16 v[60:63], v[140:143], v[112:115], v[60:63]
  v_mfma_f32_16x16x32_bf16 v[64:67], v[136:139], v[116:119], v[64:67]
  ds_read_b128 v[96:99], v5 offset:34816
  v_mfma_f32_16x16x32_bf16 v[68:71], v[140:143], v[116:119], v[68:71]
  s_waitcnt lgkmcnt(5)
  v_mfma_f32_16x16x32_bf16 v[72:75], v[136:139], v[120:123], v[72:75]
  ds_read_b128 v[100:103], v5 offset:36864
  v_mfma_f32_16x16x32_bf16 v[76:79], v[140:143], v[120:123], v[76:79]
  v_mfma_f32_16x16x32_bf16 v[80:83], v[136:139], v[124:127], v[80:83]
  ds_read_b128 v[104:107], v5 offset:38912
  v_mfma_f32_16x16x32_bf16 v[84:87], v[140:143], v[124:127], v[84:87]
  s_waitcnt lgkmcnt(2)
  v_mfma_f32_16x16x32_bf16 v[48:51], v[128:131], v[88:91], v[48:51]
  ds_read_b128 v[136:139], v145 offset:49152
  ds_read_b128 v[140:143], v145 offset:0
  ds_read_b128 v[108:111], v6 offset:30720
  s_add_u32 m0, s77, 40960
  s_add_u32 s15, s76, 768
  buffer_load_dwordx4 v146, s[68:71], s15 offen lds
  buffer_load_dwordx4 v147, s[68:71], s15 offen offset:1024 lds
  v_mfma_f32_16x16x32_bf16 v[52:55], v[132:135], v[88:91], v[52:55]
  v_mfma_f32_16x16x32_bf16 v[56:59], v[128:131], v[92:95], v[56:59]
  ds_read_b128 v[112:115], v6 offset:32768
  v_mfma_f32_16x16x32_bf16 v[60:63], v[132:135], v[92:95], v[60:63]
  v_mfma_f32_16x16x32_bf16 v[64:67], v[128:131], v[96:99], v[64:67]
  ds_read_b128 v[116:119], v6 offset:34816
  v_mfma_f32_16x16x32_bf16 v[68:71], v[132:135], v[96:99], v[68:71]
  s_waitcnt lgkmcnt(5)
  v_mfma_f32_16x16x32_bf16 v[72:75], v[128:131], v[100:103], v[72:75]
  ds_read_b128 v[120:123], v6 offset:36864
  v_mfma_f32_16x16x32_bf16 v[76:79], v[132:135], v[100:103], v[76:79]
  v_mfma_f32_16x16x32_bf16 v[80:83], v[128:131], v[104:107], v[80:83]
  ds_read_b128 v[124:127], v6 offset:38912
  v_mfma_f32_16x16x32_bf16 v[84:87], v[132:135], v[104:107], v[84:87]
  s_waitcnt vmcnt(8)
  s_barrier
  s_waitcnt lgkmcnt(2)
  v_mfma_f32_16x16x32_bf16 v[48:51], v[136:139], v[108:111], v[48:51]
  ds_read_b128 v[128:131], v144 offset:8192
  ds_read_b128 v[132:135], v144 offset:16384
  ds_read_b128 v[88:91], v5 offset:40960
  s_add_u32 m0, s77, 49152
  s_add_u32 s15, s76, 5888
  buffer_load_dwordx4 v146, s[68:71], s15 offen lds
  buffer_load_dwordx4 v147, s[68:71], s15 offen offset:1024 lds
  v_mfma_f32_16x16x32_bf16 v[52:55], v[140:143], v[108:111], v[52:55]
  s_add_u32 s12, s85, 66048
  v_mov_b32 v15, s8
  s_mov_b64 exec, 1
  buffer_store_dword v15, off, s[52:55], s12 sc1
  s_mov_b64 exec, -1
  v_mfma_f32_16x16x32_bf16 v[56:59], v[136:139], v[112:115], v[56:59]
  ds_read_b128 v[92:95], v5 offset:43008
  v_mfma_f32_16x16x32_bf16 v[60:63], v[140:143], v[112:115], v[60:63]
  v_mfma_f32_16x16x32_bf16 v[64:67], v[136:139], v[116:119], v[64:67]
  ds_read_b128 v[96:99], v5 offset:45056
  v_mfma_f32_16x16x32_bf16 v[68:71], v[140:143], v[116:119], v[68:71]
  s_waitcnt lgkmcnt(5)
  v_mfma_f32_16x16x32_bf16 v[72:75], v[136:139], v[120:123], v[72:75]
  ds_read_b128 v[100:103], v5 offset:47104
  v_mfma_f32_16x16x32_bf16 v[76:79], v[140:143], v[120:123], v[76:79]
  v_mfma_f32_16x16x32_bf16 v[80:83], v[136:139], v[124:127], v[80:83]
  ds_read_b128 v[104:107], v5 offset:49152
  v_mfma_f32_16x16x32_bf16 v[84:87], v[140:143], v[124:127], v[84:87]
  s_waitcnt lgkmcnt(2)
  v_mfma_f32_16x16x32_bf16 v[48:51], v[128:131], v[88:91], v[48:51]
  ds_read_b128 v[136:139], v145 offset:8192
  ds_read_b128 v[140:143], v145 offset:16384
  ds_read_b128 v[108:111], v6 offset:40960
  s_add_u32 m0, s77, 0
  s_add_u32 s15, s76, 896
  buffer_load_dwordx4 v146, s[68:71], s15 offen lds
  buffer_load_dwordx4 v147, s[68:71], s15 offen offset:1024 lds
  v_mfma_f32_16x16x32_bf16 v[52:55], v[132:135], v[88:91], v[52:55]
  v_lshrrev_b32_e64 v11, 5, v1
  v_mfma_f32_16x16x32_bf16 v[56:59], v[128:131], v[92:95], v[56:59]
  ds_read_b128 v[112:115], v6 offset:43008
  v_mul_u32_u24 v11, 4096, v11
  v_mfma_f32_16x16x32_bf16 v[60:63], v[132:135], v[92:95], v[60:63]
  v_add_u32_e64 v11, v11, v2
  v_mfma_f32_16x16x32_bf16 v[64:67], v[128:131], v[96:99], v[64:67]
  ds_read_b128 v[116:119], v6 offset:45056
  v_mov_b32_e64 v216, 0
  v_mfma_f32_16x16x32_bf16 v[68:71], v[132:135], v[96:99], v[68:71]
  v_mov_b32 v217, 0
  s_waitcnt lgkmcnt(5)
  v_mfma_f32_16x16x32_bf16 v[72:75], v[128:131], v[100:103], v[72:75]
  ds_read_b128 v[120:123], v6 offset:47104
  v_mov_b32_e64 v218, 0
  v_mfma_f32_16x16x32_bf16 v[76:79], v[132:135], v[100:103], v[76:79]
  v_mov_b32_e64 v219, 0
  v_mfma_f32_16x16x32_bf16 v[80:83], v[128:131], v[104:107], v[80:83]
  ds_read_b128 v[124:127], v6 offset:49152
  ds_write_b128 v11, v[216:219] offset:4096
  v_mfma_f32_16x16x32_bf16 v[84:87], v[132:135], v[104:107], v[84:87]
  ds_write_b128 v11, v[216:219] offset:8704
  s_waitcnt vmcnt(8)
  s_waitcnt lgkmcnt(4)
  v_mfma_f32_16x16x32_bf16 v[48:51], v[136:139], v[108:111], v[48:51]
  ds_read_b128 v[128:131], v144 offset:24576
  ds_read_b128 v[132:135], v144 offset:32768
  ds_read_b128 v[88:91], v7 offset:0
  s_add_u32 m0, s77, 8192
  s_add_u32 s15, s76, 6016
  buffer_load_dwordx4 v146, s[68:71], s15 offen lds
  buffer_load_dwordx4 v147, s[68:71], s15 offen offset:1024 lds
  v_mfma_f32_16x16x32_bf16 v[52:55], v[140:143], v[108:111], v[52:55]
  v_mfma_f32_16x16x32_bf16 v[56:59], v[136:139], v[112:115], v[56:59]
  ds_read_b128 v[92:95], v7 offset:2048
  v_mfma_f32_16x16x32_bf16 v[60:63], v[140:143], v[112:115], v[60:63]
  v_mfma_f32_16x16x32_bf16 v[64:67], v[136:139], v[116:119], v[64:67]
  ds_read_b128 v[96:99], v7 offset:4096
  v_mfma_f32_16x16x32_bf16 v[68:71], v[140:143], v[116:119], v[68:71]
  s_waitcnt lgkmcnt(7)
  v_mfma_f32_16x16x32_bf16 v[72:75], v[136:139], v[120:123], v[72:75]
  ds_read_b128 v[100:103], v7 offset:6144
  v_mfma_f32_16x16x32_bf16 v[76:79], v[140:143], v[120:123], v[76:79]
  v_mfma_f32_16x16x32_bf16 v[80:83], v[136:139], v[124:127], v[80:83]
  ds_read_b128 v[104:107], v7 offset:8192
  v_mfma_f32_16x16x32_bf16 v[84:87], v[140:143], v[124:127], v[84:87]
  s_waitcnt lgkmcnt(2)
  v_mfma_f32_16x16x32_bf16 v[48:51], v[128:131], v[88:91], v[48:51]
  ds_read_b128 v[136:139], v145 offset:24576
  ds_read_b128 v[140:143], v145 offset:32768
  ds_read_b128 v[108:111], v8 offset:0
  s_add_u32 m0, s77, 16384
  s_add_u32 s15, s76, 1024
  buffer_load_dwordx4 v146, s[68:71], s15 offen lds
  buffer_load_dwordx4 v147, s[68:71], s15 offen offset:1024 lds
  v_mfma_f32_16x16x32_bf16 v[52:55], v[132:135], v[88:91], v[52:55]
  s_and_b32 s87, s85, 0x3800
  s_add_u32 s87, s87, 65536
  buffer_load_dwordx2 v[188:189], v187, s[52:55], s87 offen sc1
  v_mfma_f32_16x16x32_bf16 v[56:59], v[128:131], v[92:95], v[56:59]
  ds_read_b128 v[112:115], v8 offset:2048
  v_mfma_f32_16x16x32_bf16 v[60:63], v[132:135], v[92:95], v[60:63]
  v_mfma_f32_16x16x32_bf16 v[64:67], v[128:131], v[96:99], v[64:67]
  ds_read_b128 v[116:119], v8 offset:4096
  v_mfma_f32_16x16x32_bf16 v[68:71], v[132:135], v[96:99], v[68:71]
  s_waitcnt lgkmcnt(5)
  v_mfma_f32_16x16x32_bf16 v[72:75], v[128:131], v[100:103], v[72:75]
  ds_read_b128 v[120:123], v8 offset:6144
  v_mfma_f32_16x16x32_bf16 v[76:79], v[132:135], v[100:103], v[76:79]
  v_mfma_f32_16x16x32_bf16 v[80:83], v[128:131], v[104:107], v[80:83]
  ds_read_b128 v[124:127], v8 offset:8192
  v_mfma_f32_16x16x32_bf16 v[84:87], v[132:135], v[104:107], v[84:87]
  s_waitcnt vmcnt(8)
  s_barrier
  s_waitcnt lgkmcnt(2)
  v_mfma_f32_16x16x32_bf16 v[48:51], v[136:139], v[108:111], v[48:51]
  ds_read_b128 v[128:131], v144 offset:40960
  ds_read_b128 v[132:135], v144 offset:49152
  ds_read_b128 v[88:91], v7 offset:10240
  s_add_u32 m0, s77, 24576
  s_add_u32 s15, s76, 6144
  buffer_load_dwordx4 v146, s[68:71], s15 offen lds
  buffer_load_dwordx4 v147, s[68:71], s15 offen offset:1024 lds
  v_mfma_f32_16x16x32_bf16 v[52:55], v[140:143], v[108:111], v[52:55]
  v_mfma_f32_16x16x32_bf16 v[56:59], v[136:139], v[112:115], v[56:59]
  ds_read_b128 v[92:95], v7 offset:12288
  v_mfma_f32_16x16x32_bf16 v[60:63], v[140:143], v[112:115], v[60:63]
  v_mfma_f32_16x16x32_bf16 v[64:67], v[136:139], v[116:119], v[64:67]
  ds_read_b128 v[96:99], v7 offset:14336
  v_mfma_f32_16x16x32_bf16 v[68:71], v[140:143], v[116:119], v[68:71]
  s_waitcnt lgkmcnt(5)
  v_mfma_f32_16x16x32_bf16 v[72:75], v[136:139], v[120:123], v[72:75]
  ds_read_b128 v[100:103], v7 offset:16384
  v_mfma_f32_16x16x32_bf16 v[76:79], v[140:143], v[120:123], v[76:79]
  v_mfma_f32_16x16x32_bf16 v[80:83], v[136:139], v[124:127], v[80:83]
  ds_read_b128 v[104:107], v7 offset:18432
  v_mfma_f32_16x16x32_bf16 v[84:87], v[140:143], v[124:127], v[84:87]
  s_waitcnt lgkmcnt(2)
  v_mfma_f32_16x16x32_bf16 v[48:51], v[128:131], v[88:91], v[48:51]
  ds_read_b128 v[136:139], v145 offset:40960
  ds_read_b128 v[140:143], v145 offset:49152
  ds_read_b128 v[108:111], v8 offset:10240
  s_add_u32 m0, s77, 32768
  s_add_u32 s15, s76, 1152
  buffer_load_dwordx4 v146, s[68:71], s15 offen lds
  buffer_load_dwordx4 v147, s[68:71], s15 offen offset:1024 lds
  v_mfma_f32_16x16x32_bf16 v[52:55], v[132:135], v[88:91], v[52:55]
  s_waitcnt vmcnt(4)
  v_xor_b32 v15, s8, v188
  v_xor_b32 v14, s8, v189
  v_or_b32 v15, v15, v14
  v_cmp_ne_u32 vcc, 0, v15
  s_cbranch_vccnz again_19
ok_20:
  s_lshl_b32 s12, s0, 16
  s_add_u32 s12, s12, s90
  s_add_u32 s12, s12, 4194304
  s_lshl_b32 m0, s7, 10
  s_nop 0
  buffer_load_dwordx4 v2, s[52:55], s12 offen sc1 lds
  s_lshl_b32 s12, s0, 16
  s_add_u32 s12, s12, s91
  s_add_u32 s12, s12, 4194304
  s_lshl_b32 m0, s7, 10
  s_add_u32 m0, m0, 4608
  s_nop 0
  buffer_load_dwordx4 v2, s[52:55], s12 offen sc1 lds
  v_mfma_f32_16x16x32_bf16 v[56:59], v[128:131], v[92:95], v[56:59]
  ds_read_b128 v[112:115], v8 offset:12288
  v_mfma_f32_16x16x32_bf16 v[60:63], v[132:135], v[92:95], v[60:63]
  v_mfma_f32_16x16x32_bf16 v[64:67], v[128:131], v[96:99], v[64:67]
  ds_read_b128 v[116:119], v8 offset:14336
  v_mfma_f32_16x16x32_bf16 v[68:71], v[132:135], v[96:99], v[68:71]
  s_waitcnt lgkmcnt(5)
  v_mfma_f32_16x16x32_bf16 v[72:75], v[128:131], v[100:103], v[72:75]
  ds_read_b128 v[120:123], v8 offset:16384
  v_mfma_f32_16x16x32_bf16 v[76:79], v[132:135], v[100:103], v[76:79]
  v_mfma_f32_16x16x32_bf16 v[80:83], v[128:131], v[104:107], v[80:83]
  ds_read_b128 v[124:127], v8 offset:18432
  v_mfma_f32_16x16x32_bf16 v[84:87], v[132:135], v[104:107], v[84:87]
  s_waitcnt lgkmcnt(2)
  v_mfma_f32_16x16x32_bf16 v[48:51], v[136:139], v[108:111], v[48:51]
  ds_read_b128 v[128:131], v144 offset:0
  ds_read_b128 v[132:135], v144 offset:8192
  ds_read_b128 v[88:91], v7 offset:20480
  s_add_u32 m0, s77, 40960
  s_add_u32 s15, s76, 6272
  buffer_load_dwordx4 v146, s[68:71], s15 offen lds
  buffer_load_dwordx4 v147, s[68:71], s15 offen offset:1024 lds
  v_mfma_f32_16x16x32_bf16 v[52:55], v[140:143], v[108:111], v[52:55]
  buffer_load_dwordx3 v[152:154], v160, s[52:55], s93 offen sc1
  v_mfma_f32_16x16x32_bf16 v[56:59], v[136:139], v[112:115], v[56:59]
  ds_read_b128 v[92:95], v7 offset:22528
  buffer_load_dwordx2 v[156:157], v161, s[52:55], s94 offen sc1
  v_mfma_f32_16x16x32_bf16 v[60:63], v[140:143], v[112:115], v[60:63]
  buffer_load_dwordx2 v[158:159], v162, s[52:55], s94 offen offset:512 sc1
  v_mfma_f32_16x16x32_bf16 v[64:67], v[136:139], v[116:119], v[64:67]
  ds_read_b128 v[96:99], v7 offset:24576
  s_mov_b32 s36, 32768
  buffer_load_dwordx4 v[220:223], v2, s[52:55], s36 offen sc1
  v_mfma_f32_16x16x32_bf16 v[68:71], v[140:143], v[116:119], v[68:71]
  s_waitcnt lgkmcnt(5)
  v_mfma_f32_16x16x32_bf16 v[72:75], v[136:139], v[120:123], v[72:75]
  ds_read_b128 v[100:103], v7 offset:26624
  v_mfma_f32_16x16x32_bf16 v[76:79], v[140:143], v[120:123], v[76:79]
  v_mfma_f32_16x16x32_bf16 v[80:83], v[136:139], v[124:127], v[80:83]
  ds_read_b128 v[104:107], v7 offset:28672
  v_mfma_f32_16x16x32_bf16 v[84:87], v[140:143], v[124:127], v[84:87]
  s_waitcnt lgkmcnt(2)
  v_mfma_f32_16x16x32_bf16 v[48:51], v[128:131], v[88:91], v[48:51]
  ds_read_b128 v[136:139], v145 offset:0
  ds_read_b128 v[140:143], v145 offset:8192
  ds_read_b128 v[108:111], v8 offset:20480
  s_mov_b32 s64, s42
  s_and_b32 s65, s43, 0xffff
  s_mov_b32 s66, 2621440
  s_mov_b32 s67, 0x20000
  v_mfma_f32_16x16x32_bf16 v[52:55], v[132:135], v[88:91], v[52:55]
  buffer_load_dwordx4 v[192:195], v2, s[64:67], s90 offen nt
  v_mfma_f32_16x16x32_bf16 v[56:59], v[128:131], v[92:95], v[56:59]
  ds_read_b128 v[112:115], v8 offset:22528
  buffer_load_dwordx4 v[204:207], v2, s[64:67], s90 offen offset:4 nt
  v_mfma_f32_16x16x32_bf16 v[60:63], v[132:135], v[92:95], v[60:63]
  buffer_load_dwordx4 v[188:191], v187, s[52:55], s88 offen sc1
  v_mfma_f32_16x16x32_bf16 v[64:67], v[128:131], v[96:99], v[64:67]
  ds_read_b128 v[116:119], v8 offset:24576
  v_mfma_f32_16x16x32_bf16 v[68:71], v[132:135], v[96:99], v[68:71]
  s_waitcnt lgkmcnt(5)
  v_mfma_f32_16x16x32_bf16 v[72:75], v[128:131], v[100:103], v[72:75]
  ds_read_b128 v[120:123], v8 offset:26624
  v_mfma_f32_16x16x32_bf16 v[76:79], v[132:135], v[100:103], v[76:79]
  v_mfma_f32_16x16x32_bf16 v[80:83], v[128:131], v[104:107], v[80:83]
  ds_read_b128 v[124:127], v8 offset:28672
  v_mfma_f32_16x16x32_bf16 v[84:87], v[132:135], v[104:107], v[84:87]
  s_waitcnt vmcnt(13)
  s_barrier
  s_waitcnt lgkmcnt(2)
  v_mfma_f32_16x16x32_bf16 v[48:51], v[136:139], v[108:111], v[48:51]
  ds_read_b128 v[128:131], v144 offset:16384
  ds_read_b128 v[132:135], v144 offset:24576
  ds_read_b128 v[88:91], v7 offset:30720
  buffer_load_dwordx4 v[196:199], v2, s[64:67], s91 offen nt
  v_mfma_f32_16x16x32_bf16 v[52:55], v[140:143], v[108:111], v[52:55]
  buffer_load_dwordx4 v[208:211], v2, s[64:67], s91 offen offset:4 nt
  v_mfma_f32_16x16x32_bf16 v[56:59], v[136:139], v[112:115], v[56:59]
  ds_read_b128 v[92:95], v7 offset:32768
  buffer_load_dwordx4 v[200:203], v2, s[64:67], s92 offen nt
  v_mfma_f32_16x16x32_bf16 v[60:63], v[140:143], v[112:115], v[60:63]
  v_mfma_f32_16x16x32_bf16 v[64:67], v[136:139], v[116:119], v[64:67]
  ds_read_b128 v[96:99], v7 offset:34816
  v_mfma_f32_16x16x32_bf16 v[68:71], v[140:143], v[116:119], v[68:71]
  s_waitcnt lgkmcnt(5)
  v_mfma_f32_16x16x32_bf16 v[72:75], v[136:139], v[120:123], v[72:75]
  ds_read_b128 v[100:103], v7 offset:36864
  v_mfma_f32_16x16x32_bf16 v[76:79], v[140:143], v[120:123], v[76:79]
  v_mfma_f32_16x16x32_bf16 v[80:83], v[136:139], v[124:127], v[80:83]
  ds_read_b128 v[104:107], v7 offset:38912
  v_mfma_f32_16x16x32_bf16 v[84:87], v[140:143], v[124:127], v[84:87]
  s_waitcnt lgkmcnt(2)
  v_mfma_f32_16x16x32_bf16 v[48:51], v[128:131], v[88:91], v[48:51]
  ds_read_b128 v[136:139], v145 offset:16384
  ds_read_b128 v[140:143], v145 offset:24576
  ds_read_b128 v[108:111], v8 offset:30720
  buffer_load_dwordx4 v[212:215], v2, s[64:67], s92 offen offset:4 nt
  v_mfma_f32_16x16x32_bf16 v[52:55], v[132:135], v[88:91], v[52:55]
  v_mfma_f32_16x16x32_bf16 v[56:59], v[128:131], v[92:95], v[56:59]
  ds_read_b128 v[112:115], v8 offset:32768
  v_mfma_f32_16x16x32_bf16 v[60:63], v[132:135], v[92:95], v[60:63]
  v_mfma_f32_16x16x32_bf16 v[64:67], v[128:131], v[96:99], v[64:67]
  ds_read_b128 v[116:119], v8 offset:34816
  v_mfma_f32_16x16x32_bf16 v[68:71], v[132:135], v[96:99], v[68:71]
  s_waitcnt lgkmcnt(5)
  v_mfma_f32_16x16x32_bf16 v[72:75], v[128:131], v[100:103], v[72:75]
  ds_read_b128 v[120:123], v8 offset:36864
  v_mfma_f32_16x16x32_bf16 v[76:79], v[132:135], v[100:103], v[76:79]
  v_mfma_f32_16x16x32_bf16 v[80:83], v[128:131], v[104:107], v[80:83]
  ds_read_b128 v[124:127], v8 offset:38912
  v_mfma_f32_16x16x32_bf16 v[84:87], v[132:135], v[104:107], v[84:87]
  s_waitcnt vmcnt(11)
  s_waitcnt lgkmcnt(2)
  v_mfma_f32_16x16x32_bf16 v[48:51], v[136:139], v[108:111], v[48:51]
  ds_read_b128 v[128:131], v144 offset:32768
  ds_read_b128 v[132:135], v144 offset:40960
  ds_read_b128 v[88:91], v7 offset:40960
  s_waitcnt vmcnt(8)
  v_min3_u32 v15, v154, v154, s8
  v_max3_u32 v14, v154, v154, s8
  v_min3_u32 v15, v15, v157, v159
  v_max3_u32 v14, v14, v157, v159
  v_cmp_ne_u32 vcc, v15, v14
  s_cbranch_vccnz again_21
ok_22:
  v_mfma_f32_16x16x32_bf16 v[52:55], v[140:143], v[108:111], v[52:55]
  s_waitcnt vmcnt(7)
  v_min3_u32 v15, v220, v221, s8
  v_max3_u32 v14, v220, v221, s8
  v_min3_u32 v15, v15, v222, v223
  v_max3_u32 v14, v14, v222, v223
  v_cmp_ne_u32 vcc, v15, v14
  s_cbranch_vccnz again_23
ok_24:
  s_lshl_b32 s13, s7, 6
  s_sub_u32 s12, 255, s13
  v_sub_u32 v11, s12, v1
  v_lshlrev_b32 v11, 11, v11
  s_and_b32 s12, s24, 3
  s_lshl_b32 s12, s12, 9
  s_bfe_u32 s14, s24, 0x50002
  s_lshl_b32 s14, s14, 4
  s_add_u32 s12, s12, s14
  s_add_u32 s12, s12, 26214400
  s_lshl_b32 s13, s13, 4
  s_add_u32 m0, s13, 9216
  s_nop 0
  buffer_load_dwordx4 v11, s[52:55], s12 offen sc1 lds
  v_mfma_f32_16x16x32_bf16 v[56:59], v[136:139], v[112:115], v[56:59]
  ds_read_b128 v[92:95], v7 offset:43008
  s_waitcnt vmcnt(5)
  v_min3_u32 v15, v188, v189, s8
  v_max3_u32 v14, v188, v189, s8
  v_min3_u32 v15, v15, v190, v191
  v_max3_u32 v14, v14, v190, v191
  v_cmp_ne_u32 vcc, v15, v14
  s_cbranch_vccnz again_25
ok_26:
  s_mul_i32 s34, s6, 200
  s_mul_i32 s12, s7, 50
  s_add_u32 s34, s34, s12
  s_lshl_b32 s34, s34, 10
  s_add_u32 s34, s34, 23068672
  v_mfma_f32_16x16x32_bf16 v[60:63], v[140:143], v[112:115], v[60:63]
  buffer_load_dwordx4 a[0:3], v2, s[52:55], s34 offen offset:0 sc1
  v_mfma_f32_16x16x32_bf16 v[64:67], v[136:139], v[116:119], v[64:67]
  ds_read_b128 v[96:99], v7 offset:45056
  buffer_load_dwordx4 a[4:7], v2, s[52:55], s34 offen offset:1024 sc1
  v_mfma_f32_16x16x32_bf16 v[68:71], v[140:143], v[116:119], v[68:71]
  buffer_load_dwordx4 a[8:11], v2, s[52:55], s34 offen offset:2048 sc1
  s_waitcnt lgkmcnt(5)
  v_mfma_f32_16x16x32_bf16 v[72:75], v[136:139], v[120:123], v[72:75]
  ds_read_b128 v[100:103], v7 offset:47104
  v_mfma_f32_16x16x32_bf16 v[76:79], v[140:143], v[120:123], v[76:79]
  v_mfma_f32_16x16x32_bf16 v[80:83], v[136:139], v[124:127], v[80:83]
  ds_read_b128 v[104:107], v7 offset:49152
  v_mfma_f32_16x16x32_bf16 v[84:87], v[140:143], v[124:127], v[84:87]
  s_waitcnt lgkmcnt(2)
  v_mfma_f32_16x16x32_bf16 v[48:51], v[128:131], v[88:91], v[48:51]
  ds_read_b128 v[136:139], v145 offset:32768
  ds_read_b128 v[140:143], v145 offset:40960
  ds_read_b128 v[108:111], v8 offset:40960
  buffer_load_dwordx4 a[12:15], v2, s[52:55], s34 offen offset:3072 sc1
  v_mfma_f32_16x16x32_bf16 v[52:55], v[132:135], v[88:91], v[52:55]
  s_add_u32 s34, s34, 4096
  buffer_load_dwordx4 a[16:19], v2, s[52:55], s34 offen offset:0 sc1
  v_mfma_f32_16x16x32_bf16 v[56:59], v[128:131], v[92:95], v[56:59]
  ds_read_b128 v[112:115], v8 offset:43008
  buffer_load_dwordx4 a[20:23], v2, s[52:55], s34 offen offset:1024 sc1
  v_mfma_f32_16x16x32_bf16 v[60:63], v[132:135], v[92:95], v[60:63]
  v_mfma_f32_16x16x32_bf16 v[64:67], v[128:131], v[96:99], v[64:67]
  ds_read_b128 v[116:119], v8 offset:45056
  v_mfma_f32_16x16x32_bf16 v[68:71], v[132:135], v[96:99], v[68:71]
  s_waitcnt lgkmcnt(5)
  v_mfma_f32_16x16x32_bf16 v[72:75], v[128:131], v[100:103], v[72:75]
  ds_read_b128 v[120:123], v8 offset:47104
  v_mfma_f32_16x16x32_bf16 v[76:79], v[132:135], v[100:103], v[76:79]
  v_mfma_f32_16x16x32_bf16 v[80:83], v[128:131], v[104:107], v[80:83]
  ds_read_b128 v[124:127], v8 offset:49152
  v_mfma_f32_16x16x32_bf16 v[84:87], v[132:135], v[104:107], v[84:87]
  s_waitcnt lgkmcnt(2)
  s_barrier
  v_mfma_f32_16x16x32_bf16 v[48:51], v[136:139], v[108:111], v[48:51]
  buffer_load_dwordx4 a[24:27], v2, s[52:55], s34 offen offset:2048 sc1
  buffer_load_dwordx4 a[28:31], v2, s[52:55], s34 offen offset:3072 sc1
  v_mov_b32_e64 v246, v156
  v_mfma_f32_16x16x32_bf16 v[52:55], v[140:143], v[108:111], v[52:55]
  v_mov_b32 v247, v156
  v_mov_b32 v250, v158
  s_nop 0
  v_permlane16_swap_b32 v246, v247
  v_mfma_f32_16x16x32_bf16 v[56:59], v[136:139], v[112:115], v[56:59]
  v_mov_b32 v248, v246
  v_mov_b32 v249, v247
  s_nop 0
  v_permlane32_swap_b32 v246, v248
  v_mfma_f32_16x16x32_bf16 v[60:63], v[140:143], v[112:115], v[60:63]
  v_permlane32_swap_b32 v247, v249
  v_mov_b32_dpp v88, v152 row_newbcast:0 row_mask:0xf bank_mask:0xf
  v_mov_b32_dpp v96, v153 row_newbcast:0 row_mask:0xf bank_mask:0xf
  v_mfma_f32_16x16x32_bf16 v[64:67], v[136:139], v[116:119], v[64:67]
  v_mov_b32_dpp v89, v152 row_newbcast:1 row_mask:0xf bank_mask:0xf
  v_mov_b32_dpp v97, v153 row_newbcast:1 row_mask:0xf bank_mask:0xf
  v_mov_b32_dpp v90, v152 row_newbcast:2 row_mask:0xf bank_mask:0xf
  v_mfma_f32_16x16x32_bf16 v[68:71], v[140:143], v[116:119], v[68:71]
  v_mov_b32_dpp v98, v153 row_newbcast:2 row_mask:0xf bank_mask:0xf
  v_mov_b32_dpp v91, v152 row_newbcast:3 row_mask:0xf bank_mask:0xf
  v_mov_b32_dpp v99, v153 row_newbcast:3 row_mask:0xf bank_mask:0xf
  s_waitcnt lgkmcnt(0)
  v_mfma_f32_16x16x32_bf16 v[72:75], v[136:139], v[120:123], v[72:75]
  v_mov_b32_dpp v92, v152 row_newbcast:4 row_mask:0xf bank_mask:0xf
  v_mov_b32_dpp v100, v153 row_newbcast:4 row_mask:0xf bank_mask:0xf
  v_mfma_f32_16x16x32_bf16 v[76:79], v[140:143], v[120:123], v[76:79]
  v_mov_b32_dpp v93, v152 row_newbcast:5 row_mask:0xf bank_mask:0xf
  v_mov_b32_dpp v101, v153 row_newbcast:5 row_mask:0xf bank_mask:0xf
  v_mfma_f32_16x16x32_bf16 v[80:83], v[136:139], v[124:127], v[80:83]
  v_mov_b32_dpp v94, v152 row_newbcast:6 row_mask:0xf bank_mask:0xf
  v_mov_b32_dpp v102, v153 row_newbcast:6 row_mask:0xf bank_mask:0xf
  v_mfma_f32_16x16x32_bf16 v[84:87], v[140:143], v[124:127], v[84:87]
  v_mov_b32_dpp v95, v152 row_newbcast:7 row_mask:0xf bank_mask:0xf
  v_mov_b32_dpp v103, v153 row_newbcast:7 row_mask:0xf bank_mask:0xf
  v_pk_fma_f32 v[48:49], v[88:89], v[246:247], v[48:49] op_sel_hi:[1,0,1] neg_lo:[1,0,0] neg_hi:[1,0,0]
  v_pk_fma_f32 v[50:51], v[90:91], v[246:247], v[50:51] op_sel_hi:[1,0,1] neg_lo:[1,0,0] neg_hi:[1,0,0]
  v_pk_fma_f32 v[52:53], v[92:93], v[246:247], v[52:53] op_sel_hi:[1,0,1] neg_lo:[1,0,0] neg_hi:[1,0,0]
  v_pk_fma_f32 v[54:55], v[94:95], v[246:247], v[54:55] op_sel_hi:[1,0,1] neg_lo:[1,0,0] neg_hi:[1,0,0]
  v_pk_fma_f32 v[56:57], v[88:89], v[246:247], v[56:57] op_sel:[0,1,0] op_sel_hi:[1,1,1] neg_lo:[1,0,0] neg_hi:[1,0,0]
  v_pk_fma_f32 v[58:59], v[90:91], v[246:247], v[58:59] op_sel:[0,1,0] op_sel_hi:[1,1,1] neg_lo:[1,0,0] neg_hi:[1,0,0]
  v_pk_fma_f32 v[60:61], v[92:93], v[246:247], v[60:61] op_sel:[0,1,0] op_sel_hi:[1,1,1] neg_lo:[1,0,0] neg_hi:[1,0,0]
  v_pk_fma_f32 v[62:63], v[94:95], v[246:247], v[62:63] op_sel:[0,1,0] op_sel_hi:[1,1,1] neg_lo:[1,0,0] neg_hi:[1,0,0]
  v_pk_fma_f32 v[64:65], v[88:89], v[248:249], v[64:65] op_sel_hi:[1,0,1] neg_lo:[1,0,0] neg_hi:[1,0,0]
  v_pk_fma_f32 v[66:67], v[90:91], v[248:249], v[66:67] op_sel_hi:[1,0,1] neg_lo:[1,0,0] neg_hi:[1,0,0]
  v_pk_fma_f32 v[68:69], v[92:93], v[248:249], v[68:69] op_sel_hi:[1,0,1] neg_lo:[1,0,0] neg_hi:[1,0,0]
  v_pk_fma_f32 v[70:71], v[94:95], v[248:249], v[70:71] op_sel_hi:[1,0,1] neg_lo:[1,0,0] neg_hi:[1,0,0]
  v_pk_fma_f32 v[72:73], v[88:89], v[248:249], v[72:73] op_sel:[0,1,0] op_sel_hi:[1,1,1] neg_lo:[1,0,0] neg_hi:[1,0,0]
  v_pk_fma_f32 v[74:75], v[90:91], v[248:249], v[74:75] op_sel:[0,1,0] op_sel_hi:[1,1,1] neg_lo:[1,0,0] neg_hi:[1,0,0]
  v_pk_fma_f32 v[76:77], v[92:93], v[248:249], v[76:77] op_sel:[0,1,0] op_sel_hi:[1,1,1] neg_lo:[1,0,0] neg_hi:[1,0,0]
  v_pk_fma_f32 v[78:79], v[94:95], v[248:249], v[78:79] op_sel:[0,1,0] op_sel_hi:[1,1,1] neg_lo:[1,0,0] neg_hi:[1,0,0]
  v_pk_fma_f32 v[80:81], v[88:89], v[250:251], v[80:81] op_sel_hi:[1,0,1] neg_lo:[1,0,0] neg_hi:[1,0,0]
  v_pk_fma_f32 v[82:83], v[90:91], v[250:251], v[82:83] op_sel_hi:[1,0,1] neg_lo:[1,0,0] neg_hi:[1,0,0]
  v_pk_fma_f32 v[84:85], v[92:93], v[250:251], v[84:85] op_sel_hi:[1,0,1] neg_lo:[1,0,0] neg_hi:[1,0,0]
  v_pk_fma_f32 v[86:87], v[94:95], v[250:251], v[86:87] op_sel_hi:[1,0,1] neg_lo:[1,0,0] neg_hi:[1,0,0]
  v_pk_mul_f32 v[48:49], v[48:49], v[96:97]
  v_pk_mul_f32 v[50:51], v[50:51], v[98:99]
  v_pk_mul_f32 v[52:53], v[52:53], v[100:101]
  v_pk_mul_f32 v[54:55], v[54:55], v[102:103]
  v_pk_mul_f32 v[56:57], v[56:57], v[96:97]
  v_pk_mul_f32 v[58:59], v[58:59], v[98:99]
  v_pk_mul_f32 v[60:61], v[60:61], v[100:101]
  v_pk_mul_f32 v[62:63], v[62:63], v[102:103]
  v_pk_mul_f32 v[64:65], v[64:65], v[96:97]
  v_pk_mul_f32 v[66:67], v[66:67], v[98:99]
  v_pk_mul_f32 v[68:69], v[68:69], v[100:101]
  v_pk_mul_f32 v[70:71], v[70:71], v[102:103]
  v_pk_mul_f32 v[72:73], v[72:73], v[96:97]
  v_pk_mul_f32 v[74:75], v[74:75], v[98:99]
  v_pk_mul_f32 v[76:77], v[76:77], v[100:101]
  v_pk_mul_f32 v[78:79], v[78:79], v[102:103]
  v_pk_mul_f32 v[80:81], v[80:81], v[96:97]
  v_pk_mul_f32 v[82:83], v[82:83], v[98:99]
  v_pk_mul_f32 v[84:85], v[84:85], v[100:101]
  v_pk_mul_f32 v[86:87], v[86:87], v[102:103]
  s_waitcnt vmcnt(9)
  ds_write_b128 v186, v[192:195] offset:0
  s_add_u32 s34, s34, 4096
  buffer_load_dwordx4 a[32:35], v2, s[52:55], s34 offen offset:0 sc1
  v_fmac_f32 v49, v16, v48
  v_fmac_f32 v57, v17, v56
  v_fmac_f32 v65, v18, v64
  v_fmac_f32 v73, v19, v72
  v_fmac_f32 v81, v20, v80
  v_fmac_f32_dpp v49, v48, v21 quad_perm:[1,0,3,2] row_mask:0xf bank_mask:0xf
  v_fmac_f32_dpp v57, v56, v22 quad_perm:[1,0,3,2] row_mask:0xf bank_mask:0xf
  v_fmac_f32_dpp v65, v64, v23 quad_perm:[1,0,3,2] row_mask:0xf bank_mask:0xf
  v_fmac_f32_dpp v73, v72, v24 quad_perm:[1,0,3,2] row_mask:0xf bank_mask:0xf
  v_fmac_f32_dpp v81, v80, v25 quad_perm:[1,0,3,2] row_mask:0xf bank_mask:0xf
  v_alignbit_b32 v204, v204, v192, 16
  v_alignbit_b32 v205, v205, v193, 16
  v_alignbit_b32 v206, v206, v194, 16
  v_alignbit_b32 v207, v207, v195, 16
  ds_write_b128 v186, v[204:207] offset:4160
  ds_write_b128 v186, v[196:199] offset:8320
  buffer_load_dwordx4 a[36:39], v2, s[52:55], s34 offen offset:1024 sc1
  v_fmac_f32 v50, v16, v49
  v_fmac_f32 v58, v17, v57
  v_fmac_f32 v66, v18, v65
  v_fmac_f32 v74, v19, v73
  v_fmac_f32_e64 v82, v20, v81
  v_fmac_f32_dpp v50, v49, v21 quad_perm:[1,0,3,2] row_mask:0xf bank_mask:0xf
  v_fmac_f32_dpp v58, v57, v22 quad_perm:[1,0,3,2] row_mask:0xf bank_mask:0xf
  v_fmac_f32_dpp v66, v65, v23 quad_perm:[1,0,3,2] row_mask:0xf bank_mask:0xf
  v_fmac_f32_dpp v74, v73, v24 quad_perm:[1,0,3,2] row_mask:0xf bank_mask:0xf
  v_fmac_f32_dpp v82, v81, v25 quad_perm:[1,0,3,2] row_mask:0xf bank_mask:0xf
  v_alignbit_b32 v208, v208, v196, 16
  v_alignbit_b32 v209, v209, v197, 16
  v_alignbit_b32 v210, v210, v198, 16
  v_alignbit_b32 v211, v211, v199, 16
  ds_write_b128 v186, v[208:211] offset:12480
  ds_write_b128 v186, v[200:203] offset:16640
  buffer_load_dwordx4 a[40:43], v2, s[52:55], s34 offen offset:2048 sc1
  v_fmac_f32 v51, v16, v50
  v_fmac_f32 v59, v17, v58
  v_fmac_f32 v67, v18, v66
  v_fmac_f32 v75, v19, v74
  v_fmac_f32_e64 v83, v20, v82
  v_fmac_f32_dpp v51, v50, v21 quad_perm:[1,0,3,2] row_mask:0xf bank_mask:0xf
  v_fmac_f32_dpp v59, v58, v22 quad_perm:[1,0,3,2] row_mask:0xf bank_mask:0xf
  v_fmac_f32_dpp v67, v66, v23 quad_perm:[1,0,3,2] row_mask:0xf bank_mask:0xf
  v_fmac_f32_dpp v75, v74, v24 quad_perm:[1,0,3,2] row_mask:0xf bank_mask:0xf
  v_fmac_f32_dpp v83, v82, v25 quad_perm:[1,0,3,2] row_mask:0xf bank_mask:0xf
  v_alignbit_b32 v212, v212, v200, 16
  v_alignbit_b32 v213, v213, v201, 16
  v_alignbit_b32 v214, v214, v202, 16
  v_alignbit_b32 v215, v215, v203, 16
  ds_write_b128 v186, v[212:215] offset:20800
  buffer_load_dwordx4 a[44:47], v2, s[52:55], s34 offen offset:3072 sc1
  v_fmac_f32 v52, v16, v51
  v_fmac_f32 v60, v17, v59
  v_fmac_f32 v68, v18, v67
  v_fmac_f32 v76, v19, v75
  v_fmac_f32_e64 v84, v20, v83
  v_fmac_f32_dpp v52, v51, v21 quad_perm:[1,0,3,2] row_mask:0xf bank_mask:0xf
  v_fmac_f32_dpp v60, v59, v22 quad_perm:[1,0,3,2] row_mask:0xf bank_mask:0xf
  v_fmac_f32_dpp v68, v67, v23 quad_perm:[1,0,3,2] row_mask:0xf bank_mask:0xf
  v_fmac_f32_dpp v76, v75, v24 quad_perm:[1,0,3,2] row_mask:0xf bank_mask:0xf
  v_fmac_f32_dpp v84, v83, v25 quad_perm:[1,0,3,2] row_mask:0xf bank_mask:0xf
  s_cmp_lg_u32 s7, 0
  s_cbranch_scc1 skip_27
  v_mov_b32 v216, 0
  v_mov_b32 v217, 0
  v_mov_b32 v218, 0
  v_mov_b32 v219, 0
  s_mov_b64 exec, 0xfff
  ds_write_b128 v163, v[216:219]
  s_mov_b64 exec, 1
  ds_write_b16 v163, v192 offset:4190
  ds_write_b16 v163, v196 offset:12510
  ds_write_b16 v163, v200 offset:20830
  s_mov_b64 exec, -1
skip_27:
  s_add_u32 s34, s34, 4096
  buffer_load_dwordx4 a[48:51], v2, s[52:55], s34 offen offset:0 sc1
  v_fmac_f32 v53, v16, v52
  v_fmac_f32 v61, v17, v60
  v_fmac_f32 v69, v18, v68
  v_fmac_f32 v77, v19, v76
  v_fmac_f32_e64 v85, v20, v84
  v_fmac_f32_dpp v53, v52, v21 quad_perm:[1,0,3,2] row_mask:0xf bank_mask:0xf
  v_fmac_f32_dpp v61, v60, v22 quad_perm:[1,0,3,2] row_mask:0xf bank_mask:0xf
  v_fmac_f32_dpp v69, v68, v23 quad_perm:[1,0,3,2] row_mask:0xf bank_mask:0xf
  v_fmac_f32_dpp v77, v76, v24 quad_perm:[1,0,3,2] row_mask:0xf bank_mask:0xf
  v_fmac_f32_dpp v85, v84, v25 quad_perm:[1,0,3,2] row_mask:0xf bank_mask:0xf
  ds_write_b64 v228, v[152:153]
  buffer_load_dwordx4 a[52:55], v2, s[52:55], s34 offen offset:1024 sc1
  v_fmac_f32 v54, v16, v53
  v_fmac_f32 v62, v17, v61
  v_fmac_f32 v70, v18, v69
  v_fmac_f32 v78, v19, v77
  v_fmac_f32_e64 v86, v20, v85
  v_fmac_f32_dpp v54, v53, v21 quad_perm:[1,0,3,2] row_mask:0xf bank_mask:0xf
  v_fmac_f32_dpp v62, v61, v22 quad_perm:[1,0,3,2] row_mask:0xf bank_mask:0xf
  v_fmac_f32_dpp v70, v69, v23 quad_perm:[1,0,3,2] row_mask:0xf bank_mask:0xf
  v_fmac_f32_dpp v78, v77, v24 quad_perm:[1,0,3,2] row_mask:0xf bank_mask:0xf
  v_fmac_f32_dpp v86, v85, v25 quad_perm:[1,0,3,2] row_mask:0xf bank_mask:0xf
  buffer_load_dwordx4 a[56:59], v2, s[52:55], s34 offen offset:2048 sc1
  v_fmac_f32 v55, v16, v54
  v_fmac_f32 v63, v17, v62
  v_fmac_f32 v71, v18, v70
  v_fmac_f32 v79, v19, v78
  v_fmac_f32_e64 v87, v20, v86
  v_fmac_f32_dpp v55, v54, v21 quad_perm:[1,0,3,2] row_mask:0xf bank_mask:0xf
  v_fmac_f32_dpp v63, v62, v22 quad_perm:[1,0,3,2] row_mask:0xf bank_mask:0xf
  v_fmac_f32_dpp v71, v70, v23 quad_perm:[1,0,3,2] row_mask:0xf bank_mask:0xf
  v_fmac_f32_dpp v79, v78, v24 quad_perm:[1,0,3,2] row_mask:0xf bank_mask:0xf
  v_fmac_f32_dpp v87, v86, v25 quad_perm:[1,0,3,2] row_mask:0xf bank_mask:0xf
  v_add_u32 v11, 152320, v9
  v_min_u32 v12, 39, v1
  v_mul_u32_u24 v44, 48, v12
  s_lshl_b32 s12, s7, 3
  s_add_u32 s12, s12, 149504
  v_add_u32 v44, s12, v44
  ds_write_b32 v11, v55 offset:0
  ds_write_b32 v11, v63 offset:1152
  ds_write_b32 v11, v71 offset:2304
  ds_write_b32 v11, v79 offset:3456
  ds_write_b32 v11, v87 offset:4608
  v_mul_u32_u24 v46, 144, v12
  v_add_u32 v46, 152320, v46
  s_waitcnt lgkmcnt(0)
  s_barrier
  ds_read_b128 v[90:93], v46 offset:0
  ds_read_b128 v[94:97], v46 offset:16
  ds_read_b128 v[98:101], v46 offset:32
  ds_read_b128 v[102:105], v46 offset:48
  ds_read_b128 v[106:109], v46 offset:64
  ds_read_b128 v[110:113], v46 offset:80
  ds_read_b128 v[114:117], v46 offset:96
  ds_read_b128 v[118:121], v46 offset:112
  s_waitcnt lgkmcnt(7)
  v_pk_fma_f32 v[92:93], v[90:91], v[36:37], v[92:93] op_sel:[1,1,0] op_sel_hi:[0,1,1] neg_lo:[0,1,0]
  v_pk_fma_f32 v[92:93], v[90:91], v[36:37], v[92:93] op_sel:[0,0,0] op_sel_hi:[1,0,1]
  buffer_load_dwordx4 a[60:63], v2, s[52:55], s34 offen offset:3072 sc1
  s_waitcnt lgkmcnt(6)
  v_pk_fma_f32 v[94:95], v[92:93], v[36:37], v[94:95] op_sel:[1,1,0] op_sel_hi:[0,1,1] neg_lo:[0,1,0]
  v_pk_fma_f32 v[94:95], v[92:93], v[36:37], v[94:95] op_sel:[0,0,0] op_sel_hi:[1,0,1]
  v_pk_fma_f32 v[96:97], v[94:95], v[36:37], v[96:97] op_sel:[1,1,0] op_sel_hi:[0,1,1] neg_lo:[0,1,0]
  v_pk_fma_f32 v[96:97], v[94:95], v[36:37], v[96:97] op_sel:[0,0,0] op_sel_hi:[1,0,1]
  s_waitcnt lgkmcnt(5)
  s_add_u32 s34, s34, 4096
  buffer_load_dwordx4 a[64:67], v2, s[52:55], s34 offen offset:0 sc1
  v_pk_fma_f32 v[98:99], v[96:97], v[36:37], v[98:99] op_sel:[1,1,0] op_sel_hi:[0,1,1] neg_lo:[0,1,0]
  v_pk_fma_f32 v[98:99], v[96:97], v[36:37], v[98:99] op_sel:[0,0,0] op_sel_hi:[1,0,1]
  v_pk_fma_f32 v[100:101], v[98:99], v[36:37], v[100:101] op_sel:[1,1,0] op_sel_hi:[0,1,1] neg_lo:[0,1,0]
  v_pk_fma_f32 v[100:101], v[98:99], v[36:37], v[100:101] op_sel:[0,0,0] op_sel_hi:[1,0,1]
  s_waitcnt lgkmcnt(4)
  v_pk_fma_f32 v[102:103], v[100:101], v[36:37], v[102:103] op_sel:[1,1,0] op_sel_hi:[0,1,1] neg_lo:[0,1,0]
  buffer_load_dwordx4 a[68:71], v2, s[52:55], s34 offen offset:1024 sc1
  v_pk_fma_f32 v[102:103], v[100:101], v[36:37], v[102:103] op_sel:[0,0,0] op_sel_hi:[1,0,1]
  v_pk_fma_f32 v[104:105], v[102:103], v[36:37], v[104:105] op_sel:[1,1,0] op_sel_hi:[0,1,1] neg_lo:[0,1,0]
  v_pk_fma_f32 v[104:105], v[102:103], v[36:37], v[104:105] op_sel:[0,0,0] op_sel_hi:[1,0,1]
  s_waitcnt lgkmcnt(3)
  v_pk_fma_f32 v[106:107], v[104:105], v[36:37], v[106:107] op_sel:[1,1,0] op_sel_hi:[0,1,1] neg_lo:[0,1,0]
  v_pk_fma_f32 v[106:107], v[104:105], v[36:37], v[106:107] op_sel:[0,0,0] op_sel_hi:[1,0,1]
  buffer_load_dwordx4 a[72:75], v2, s[52:55], s34 offen offset:2048 sc1
  v_pk_fma_f32 v[108:109], v[106:107], v[36:37], v[108:109] op_sel:[1,1,0] op_sel_hi:[0,1,1] neg_lo:[0,1,0]
  v_pk_fma_f32 v[108:109], v[106:107], v[36:37], v[108:109] op_sel:[0,0,0] op_sel_hi:[1,0,1]
  s_waitcnt lgkmcnt(2)
  v_pk_fma_f32 v[110:111], v[108:109], v[36:37], v[110:111] op_sel:[1,1,0] op_sel_hi:[0,1,1] neg_lo:[0,1,0]
  v_pk_fma_f32 v[110:111], v[108:109], v[36:37], v[110:111] op_sel:[0,0,0] op_sel_hi:[1,0,1]
  v_pk_fma_f32 v[112:113], v[110:111], v[36:37], v[112:113] op_sel:[1,1,0] op_sel_hi:[0,1,1] neg_lo:[0,1,0]
  buffer_load_dwordx4 a[76:79], v2, s[52:55], s34 offen offset:3072 sc1
  v_pk_fma_f32 v[112:113], v[110:111], v[36:37], v[112:113] op_sel:[0,0,0] op_sel_hi:[1,0,1]
  s_waitcnt lgkmcnt(1)
  v_pk_fma_f32 v[114:115], v[112:113], v[36:37], v[114:115] op_sel:[1,1,0] op_sel_hi:[0,1,1] neg_lo:[0,1,0]
  v_pk_fma_f32 v[114:115], v[112:113], v[36:37], v[114:115] op_sel:[0,0,0] op_sel_hi:[1,0,1]
  v_pk_fma_f32 v[116:117], v[114:115], v[36:37], v[116:117] op_sel:[1,1,0] op_sel_hi:[0,1,1] neg_lo:[0,1,0]
  v_pk_fma_f32 v[116:117], v[114:115], v[36:37], v[116:117] op_sel:[0,0,0] op_sel_hi:[1,0,1]
  s_waitcnt lgkmcnt(0)
  v_pk_fma_f32 v[118:119], v[116:117], v[36:37], v[118:119] op_sel:[1,1,0] op_sel_hi:[0,1,1] neg_lo:[0,1,0]
  v_pk_fma_f32 v[118:119], v[116:117], v[36:37], v[118:119] op_sel:[0,0,0] op_sel_hi:[1,0,1]
  v_pk_fma_f32 v[120:121], v[118:119], v[36:37], v[120:121] op_sel:[1,1,0] op_sel_hi:[0,1,1] neg_lo:[0,1,0]
  v_pk_fma_f32 v[120:121], v[118:119], v[36:37], v[120:121] op_sel:[0,0,0] op_sel_hi:[1,0,1]
  v_mov_b32 v122, s8
  v_mov_b32 v123, s8
  s_add_u32 s12, s83, 10240
  s_mov_b64 exec, s[96:97]
  buffer_store_dwordx4 v[120:123], v2, s[52:55], s12 offen sc1
  s_mov_b64 exec, -1
  v_accvgpr_read_b32 v232, a200
  v_accvgpr_read_b32 v236, a201
  v_accvgpr_read_b32 v240, a202
  v_accvgpr_read_b32 v241, a203
  v_add_u32 v233, 1024, v232
  v_add_u32 v234, 2048, v232
  v_add_u32 v235, 3072, v232
  v_add_u32 v237, 1024, v236
  v_add_u32 v238, 2048, v236
  v_add_u32 v239, 3072, v236
  ds_read2_b32 v[156:157], v235 offset0:128 offset1:129
  ds_read2_b32 v[158:159], v235 offset0:130 offset1:131
  ds_read_b128 v[160:163], v240 offset:3584
  ds_read2_b32 v[152:153], v235 offset0:0 offset1:1
  ds_read2_b32 v[154:155], v235 offset0:2 offset1:3
  ds_read_b128 v[164:167], v240 offset:3072
  ds_read2_b32 v[148:149], v234 offset0:128 offset1:129
  ds_read2_b32 v[150:151], v234 offset0:130 offset1:131
  s_waitcnt lgkmcnt(5)
  v_mfma_f32_16x16x32_bf16 v[220:223], v[156:159], v[160:163], 0
  ds_read_b128 v[168:171], v240 offset:2560
  s_waitcnt lgkmcnt(4)
  v_mfma_f32_16x16x32_bf16 v[216:219], v[152:155], v[160:163], 0
  ds_read2_b32 v[144:145], v234 offset0:0 offset1:1
  ds_read2_b32 v[146:147], v234 offset0:2 offset1:3
  s_waitcnt lgkmcnt(5)
  v_mfma_f32_16x16x32_bf16 v[220:223], v[152:155], v[164:167], v[220:223]
  ds_read_b128 v[172:175], v240 offset:2048
  s_waitcnt lgkmcnt(4)
  v_mfma_f32_16x16x32_bf16 v[212:215], v[148:151], v[160:163], 0
  ds_read2_b32 v[140:141], v233 offset0:128 offset1:129
  ds_read2_b32 v[142:143], v233 offset0:130 offset1:131
  v_subrev_u32 v46, 8576, v46
  v_mov_b32 v88, 0
  v_mov_b32 v89, 0
  s_mov_b32 exec_hi, 0xff
  s_cmp_eq_u32 s7, 1
  s_cbranch_scc1 w1_30
  s_cmp_eq_u32 s7, 2
  s_cbranch_scc1 w2_31
  s_cmp_eq_u32 s7, 3
  s_cbranch_scc1 w3_32
w0_29:
  ds_write_b128 v46, v[88:91] offset:0
  ds_write_b128 v46, v[92:95] offset:16
  s_branch join_28
w1_30:
  ds_write_b128 v46, v[96:99] offset:32
  ds_write_b128 v46, v[100:103] offset:48
  s_branch join_28
w2_31:
  ds_write_b128 v46, v[104:107] offset:64
  ds_write_b128 v46, v[108:111] offset:80
  s_branch join_28
w3_32:
  ds_write_b128 v46, v[112:115] offset:96
  ds_write_b128 v46, v[116:119] offset:112
join_28:
  s_mov_b32 exec_hi, -1
  v_add_u32 v46, 143744, v9
  ds_read_b32 v244, v46 offset:0
  s_add_u32 s34, s34, 4096
  buffer_load_dwordx4 a[80:83], v2, s[52:55], s34 offen offset:0 sc1
  s_add_u32 m0, s48, 0
  s_nop 0
  buffer_load_dwordx4 v224, s[68:71], s20 offen lds
  ds_read_b64 a[226:227], v227
  v_mfma_f32_16x16x32_bf16 v[216:219], v[148:151], v[164:167], v[216:219]
  ds_read_b128 v[176:179], v240 offset:1536
  s_waitcnt lgkmcnt(10)
  v_mfma_f32_16x16x32_bf16 v[220:223], v[148:151], v[168:171], v[220:223]
  ds_read2_b32 v[136:137], v233 offset0:0 offset1:1
  ds_read2_b32 v[138:139], v233 offset0:2 offset1:3
  s_waitcnt lgkmcnt(10)
  v_mfma_f32_16x16x32_bf16 v[208:211], v[144:147], v[160:163], 0
  ds_read_b128 v[180:183], v240 offset:1024
  v_mfma_f32_16x16x32_bf16 v[212:215], v[144:147], v[164:167], v[212:215]
  ds_read2_b32 v[132:133], v232 offset0:128 offset1:129
  ds_read2_b32 v[134:135], v232 offset0:130 offset1:131
  ds_read_b32 v246, v46 offset:1152
  ds_read_b32 v248, v46 offset:2304
  ds_read_b32 v250, v46 offset:3456
  s_add_u32 m0, s48, 1024
  s_nop 0
  buffer_load_dwordx4 v225, s[68:71], s20 offen lds
  s_mov_b32 s60, s46
  s_and_b32 s61, s47, 0xffff
  s_mov_b32 s62, 5242880
  s_mov_b32 s63, 0x20000
  v_mfma_f32_16x16x32_bf16 v[216:219], v[144:147], v[168:171], v[216:219]
  ds_read_b32 v252, v46 offset:4608
  v_and_b32 v43, 1, v3
  s_waitcnt lgkmcnt(15)
  v_mfma_f32_16x16x32_bf16 v[220:223], v[144:147], v[172:175], v[220:223]
  v_cvt_f32_u32 v43, v43
  s_waitcnt lgkmcnt(14)
  v_mfma_f32_16x16x32_bf16 v[204:207], v[140:143], v[160:163], 0
  buffer_load_dwordx4 a[84:87], v2, s[52:55], s34 offen offset:1024 sc1
  v_mfma_f32_16x16x32_bf16 v[208:211], v[140:143], v[164:167], v[208:211]
  s_add_u32 m0, s48, 2048
  s_mov_b32 exec_hi, 0
  buffer_load_dwordx4 v226, s[68:71], s20 offen lds
  s_mov_b32 exec_hi, -1
  v_mfma_f32_16x16x32_bf16 v[212:215], v[140:143], v[168:171], v[212:215]
  v_fma_f32 v43, 2.0, v43, -1.0
  s_waitcnt lgkmcnt(0)
  s_nop 0
  v_mul_f32_dpp v245, v244, v43 quad_perm:[1,0,3,2] row_mask:0xf bank_mask:0xf
  v_mfma_f32_16x16x32_bf16 v[216:219], v[140:143], v[172:175], v[216:219]
  ds_read_b128 v[184:187], v240 offset:512
  v_mfma_f32_16x16x32_bf16 v[220:223], v[140:143], v[176:179], v[220:223]
  ds_read2_b32 v[128:129], v232 offset0:0 offset1:1
  ds_read2_b32 v[130:131], v232 offset0:2 offset1:3
  v_mfma_f32_16x16x32_bf16 v[200:203], v[136:139], v[160:163], 0
  s_mov_b32 s64, s32
  s_and_b32 s65, s33, 0xffff
  s_mov_b32 s66, 1280
  s_mov_b32 s67, 0x20000
  s_add_u32 m0, s48, 2560
  s_mul_i32 s12, s6, 160
  s_mov_b64 exec, 0x3ff
  buffer_load_dwordx4 v2, s[64:67], s12 offen lds
  s_mov_b64 exec, -1
  v_mov_b32 v228, -1
  v_mov_b32 v229, -1
  v_mov_b32 v230, -1
  v_mov_b32 v231, -1
  v_lshlrev_b32_e64 v11, 3, v1
  buffer_store_dwordx2 v[228:229], v11, s[52:55], s51 offen sc1
  v_mfma_f32_16x16x32_bf16 v[204:207], v[136:139], v[164:167], v[204:207]
  v_mul_f32_dpp v247, v246, v43 quad_perm:[1,0,3,2] row_mask:0xf bank_mask:0xf
  v_mul_f32_dpp v249, v248, v43 quad_perm:[1,0,3,2] row_mask:0xf bank_mask:0xf
  v_mfma_f32_16x16x32_bf16 v[208:211], v[136:139], v[168:171], v[208:211]
  v_mul_f32_dpp v251, v250, v43 quad_perm:[1,0,3,2] row_mask:0xf bank_mask:0xf
  v_mfma_f32_16x16x32_bf16 v[212:215], v[136:139], v[172:175], v[212:215]
  buffer_load_dwordx4 a[88:91], v2, s[52:55], s34 offen offset:2048 sc1
  v_mfma_f32_16x16x32_bf16 v[216:219], v[136:139], v[176:179], v[216:219]
  buffer_store_dwordx4 v[228:231], v2, s[52:55], s50 offen offset:0 sc1
  v_mfma_f32_16x16x32_bf16 v[220:223], v[136:139], v[180:183], v[220:223]
  v_mul_f32_dpp v253, v252, v43 quad_perm:[1,0,3,2] row_mask:0xf bank_mask:0xf
  v_mfma_f32_16x16x32_bf16 v[196:199], v[132:135], v[160:163], 0
  ds_read_b128 v[188:191], v240 offset:0
  v_mfma_f32_16x16x32_bf16 v[200:203], v[132:135], v[164:167], v[200:203]
  ds_read2_b32 v[156:157], v235 offset0:144 offset1:145
  ds_read2_b32 v[158:159], v235 offset0:146 offset1:147
  v_mfma_f32_16x16x32_bf16 v[204:207], v[132:135], v[168:171], v[204:207]
  ds_read2_b32 v[152:153], v235 offset0:16 offset1:17
  ds_read2_b32 v[154:155], v235 offset0:18 offset1:19
  buffer_store_dwordx4 v[228:231], v2, s[52:55], s50 offen offset:1024 sc1
  v_mfma_f32_16x16x32_bf16 v[208:211], v[132:135], v[172:175], v[208:211]
  buffer_load_dwordx4 a[92:95], v2, s[52:55], s34 offen offset:3072 sc1
  v_mfma_f32_16x16x32_bf16 v[212:215], v[132:135], v[176:179], v[212:215]
  ds_read2_b32 v[148:149], v234 offset0:144 offset1:145
  ds_read2_b32 v[150:151], v234 offset0:146 offset1:147
  v_mfma_f32_16x16x32_bf16 v[216:219], v[132:135], v[180:183], v[216:219]
  s_waitcnt lgkmcnt(9)
  v_mfma_f32_16x16x32_bf16 v[220:223], v[132:135], v[184:187], v[220:223]
  s_waitcnt lgkmcnt(7)
  v_mfma_f32_16x16x32_bf16 v[192:195], v[128:131], v[160:163], 0
  ds_read_b128 v[160:163], v240 offset:3648
  v_mfma_f32_16x16x32_bf16 v[196:199], v[128:131], v[164:167], v[196:199]
  ds_read2_b32 v[144:145], v234 offset0:16 offset1:17
  ds_read2_b32 v[146:147], v234 offset0:18 offset1:19
  v_mfma_f32_16x16x32_bf16 v[200:203], v[128:131], v[168:171], v[200:203]
  ds_read_b128 v[164:167], v240 offset:3136
  v_mfma_f32_16x16x32_bf16 v[204:207], v[128:131], v[172:175], v[204:207]
  ds_read_b128 v[168:171], v240 offset:2624
  v_mfma_f32_16x16x32_bf16 v[208:211], v[128:131], v[176:179], v[208:211]
  ds_read_b128 v[172:175], v240 offset:2112
  v_mfma_f32_16x16x32_bf16 v[212:215], v[128:131], v[180:183], v[212:215]
  ds_read2_b32 v[140:141], v233 offset0:144 offset1:145
  ds_read2_b32 v[142:143], v233 offset0:146 offset1:147
  v_mfma_f32_16x16x32_bf16 v[216:219], v[128:131], v[184:187], v[216:219]
  s_add_u32 s34, s34, 4096
  buffer_load_dwordx4 a[96:99], v2, s[52:55], s34 offen offset:0 sc1
  s_waitcnt lgkmcnt(14)
  v_mfma_f32_16x16x32_bf16 v[220:223], v[128:131], v[188:191], v[220:223]
  s_waitcnt lgkmcnt(7)
  v_mfma_f32_16x16x32_bf16 v[220:223], v[156:159], v[160:163], v[220:223]
  ds_read_b128 v[176:179], v240 offset:1600
  v_mfma_f32_16x16x32_bf16 v[216:219], v[152:155], v[160:163], v[216:219]
  ds_read2_b32 v[136:137], v233 offset0:16 offset1:17
  ds_read2_b32 v[138:139], v233 offset0:18 offset1:19
  s_waitcnt lgkmcnt(7)
  v_mfma_f32_16x16x32_bf16 v[220:223], v[152:155], v[164:167], v[220:223]
  v_mfma_f32_16x16x32_bf16 v[212:215], v[148:151], v[160:163], v[212:215]
  v_mfma_f32_16x16x32_bf16 v[216:219], v[148:151], v[164:167], v[216:219]
  buffer_load_dwordx4 a[100:103], v2, s[52:55], s34 offen offset:1024 sc1
  s_waitcnt lgkmcnt(6)
  v_mfma_f32_16x16x32_bf16 v[220:223], v[148:151], v[168:171], v[220:223]
  s_and_b32 vcc_lo, s1, 7
  s_lshl_b32 vcc_lo, vcc_lo, 2
  s_add_u32 vcc_lo, vcc_lo, s7
  s_lshl_b32 vcc_lo, vcc_lo, 11
  v_lshl_add_u32 v15, v3, 7, vcc_lo
  v_min_u32 v15, L_codeend-L_pc-4, v15
  s_mov_b64 exec, 0xffff
  global_load_dword a250, v15, s[98:99]
  s_mov_b64 exec, -1
  v_mfma_f32_16x16x32_bf16 v[208:211], v[144:147], v[160:163], v[208:211]
  ds_read_b128 v[180:183], v240 offset:1088
  v_mfma_f32_16x16x32_bf16 v[212:215], v[144:147], v[164:167], v[212:215]
  ds_read2_b32 v[132:133], v232 offset0:144 offset1:145
  ds_read2_b32 v[134:135], v232 offset0:146 offset1:147
  v_mfma_f32_16x16x32_bf16 v[216:219], v[144:147], v[168:171], v[216:219]
  s_waitcnt lgkmcnt(8)
  v_mfma_f32_16x16x32_bf16 v[220:223], v[144:147], v[172:175], v[220:223]
  s_waitcnt lgkmcnt(6)
  v_mfma_f32_16x16x32_bf16 v[204:207], v[140:143], v[160:163], v[204:207]
  v_mfma_f32_16x16x32_bf16 v[208:211], v[140:143], v[164:167], v[208:211]
  v_mfma_f32_16x16x32_bf16 v[212:215], v[140:143], v[168:171], v[212:215]
  buffer_load_dwordx4 a[104:107], v2, s[52:55], s34 offen offset:2048 sc1
  v_mfma_f32_16x16x32_bf16 v[216:219], v[140:143], v[172:175], v[216:219]
  ds_read_b128 v[184:187], v240 offset:576
  s_waitcnt lgkmcnt(6)
  v_mfma_f32_16x16x32_bf16 v[220:223], v[140:143], v[176:179], v[220:223]
  ds_read2_b32 v[128:129], v232 offset0:16 offset1:17
  ds_read2_b32 v[130:131], v232 offset0:18 offset1:19
  s_waitcnt lgkmcnt(6)
  v_mfma_f32_16x16x32_bf16 v[200:203], v[136:139], v[160:163], v[200:203]
  v_accvgpr_read_b32 v11, a245
  s_and_b32 exec_lo, s96, 0x3fffffff
  s_mov_b32 exec_hi, 0
  buffer_load_dword a250, v11, s[52:55], 0 offen
  s_mov_b64 exec, -1
  v_mfma_f32_16x16x32_bf16 v[204:207], v[136:139], v[164:167], v[204:207]
  v_mfma_f32_16x16x32_bf16 v[208:211], v[136:139], v[168:171], v[208:211]
  v_mfma_f32_16x16x32_bf16 v[212:215], v[136:139], v[172:175], v[212:215]
  v_mfma_f32_16x16x32_bf16 v[216:219], v[136:139], v[176:179], v[216:219]
  s_waitcnt lgkmcnt(5)
  v_mfma_f32_16x16x32_bf16 v[220:223], v[136:139], v[180:183], v[220:223]
  buffer_load_dwordx4 a[108:111], v2, s[52:55], s34 offen offset:3072 sc1
  s_waitcnt lgkmcnt(3)
  v_mfma_f32_16x16x32_bf16 v[196:199], v[132:135], v[160:163], v[196:199]
  ds_read_b128 v[188:191], v240 offset:64
  v_mfma_f32_16x16x32_bf16 v[200:203], v[132:135], v[164:167], v[200:203]
  ds_read2_b32 v[156:157], v235 offset0:160 offset1:161
  ds_read2_b32 v[158:159], v235 offset0:162 offset1:163
  v_mfma_f32_16x16x32_bf16 v[204:207], v[132:135], v[168:171], v[204:207]
  ds_read2_b32 v[152:153], v235 offset0:32 offset1:33
  ds_read2_b32 v[154:155], v235 offset0:34 offset1:35
  s_waitcnt vmcnt(9)
  ds_read_b64 a[216:217], v242 offset:0
  v_mfma_f32_16x16x32_bf16 v[208:211], v[132:135], v[172:175], v[208:211]
  ds_read_b64 a[218:219], v242 offset:32
  v_mfma_f32_16x16x32_bf16 v[212:215], v[132:135], v[176:179], v[212:215]
  ds_read2_b32 v[148:149], v234 offset0:160 offset1:161
  ds_read2_b32 v[150:151], v234 offset0:162 offset1:163
  v_mfma_f32_16x16x32_bf16 v[216:219], v[132:135], v[180:183], v[216:219]
  ds_read_b64 a[220:221], v242 offset:64
  s_waitcnt lgkmcnt(12)
  v_mfma_f32_16x16x32_bf16 v[220:223], v[132:135], v[184:187], v[220:223]
  s_waitcnt lgkmcnt(10)
  v_mfma_f32_16x16x32_bf16 v[192:195], v[128:131], v[160:163], v[192:195]
  ds_read_b128 v[160:163], v240 offset:3712
  v_mfma_f32_16x16x32_bf16 v[196:199], v[128:131], v[164:167], v[196:199]
  ds_read2_b32 v[144:145], v234 offset0:32 offset1:33
  ds_read2_b32 v[146:147], v234 offset0:34 offset1:35
  v_mfma_f32_16x16x32_bf16 v[200:203], v[128:131], v[168:171], v[200:203]
  ds_read_b128 v[164:167], v240 offset:3200
  v_mfma_f32_16x16x32_bf16 v[204:207], v[128:131], v[172:175], v[204:207]
  ds_read_b128 v[168:171], v240 offset:2688
  s_add_u32 s34, s34, 4096
  buffer_load_dwordx4 a[112:115], v2, s[52:55], s34 offen offset:0 sc1
  ds_read_b64 a[222:223], v242 offset:96
  ds_read_b64 a[224:225], v242 offset:128
  v_mfma_f32_16x16x32_bf16 v[208:211], v[128:131], v[176:179], v[208:211]
  ds_read_b128 v[172:175], v240 offset:2176
  v_mfma_f32_16x16x32_bf16 v[212:215], v[128:131], v[180:183], v[212:215]
  ds_read2_b32 v[140:141], v233 offset0:160 offset1:161
  ds_read2_b32 v[142:143], v233 offset0:162 offset1:163
  v_mfma_f32_16x16x32_bf16 v[216:219], v[128:131], v[184:187], v[216:219]
  ds_read_b64 a[230:231], v243 offset:2560
  s_waitcnt lgkmcnt(15)
  v_mfma_f32_16x16x32_bf16 v[220:223], v[128:131], v[188:191], v[220:223]
  ds_read_b64 a[232:233], v243 offset:2592
  s_waitcnt lgkmcnt(11)
  v_mfma_f32_16x16x32_bf16 v[220:223], v[156:159], v[160:163], v[220:223]
  ds_read_b128 v[176:179], v240 offset:1664
  v_mfma_f32_16x16x32_bf16 v[216:219], v[152:155], v[160:163], v[216:219]
  ds_read2_b32 v[136:137], v233 offset0:32 offset1:33
  ds_read2_b32 v[138:139], v233 offset0:34 offset1:35
  s_waitcnt lgkmcnt(11)
  v_mfma_f32_16x16x32_bf16 v[220:223], v[152:155], v[164:167], v[220:223]
  buffer_load_dwordx4 a[116:119], v2, s[52:55], s34 offen offset:1024 sc1
  ds_read_b64 a[234:235], v243 offset:2624
  v_mfma_f32_16x16x32_bf16 v[212:215], v[148:151], v[160:163], v[212:215]
  ds_read_b64 a[236:237], v243 offset:2656
  v_mfma_f32_16x16x32_bf16 v[216:219], v[148:151], v[164:167], v[216:219]
  ds_read_b64 a[238:239], v243 offset:2688
  s_lshl_b32 s90, s7, 2
  s_waitcnt lgkmcnt(13)
  v_mfma_f32_16x16x32_bf16 v[220:223], v[148:151], v[168:171], v[220:223]
  s_sub_u32 s90, 12, s90
  v_mfma_f32_16x16x32_bf16 v[208:211], v[144:147], v[160:163], v[208:211]
  ds_read_b128 v[180:183], v240 offset:1152
  v_mfma_f32_16x16x32_bf16 v[212:215], v[144:147], v[164:167], v[212:215]
  ds_read2_b32 v[132:133], v232 offset0:160 offset1:161
  ds_read2_b32 v[134:135], v232 offset0:162 offset1:163
  s_mul_i32 s90, s90, 640
  s_add_u32 s90, s90, s83
  v_mfma_f32_16x16x32_bf16 v[216:219], v[144:147], v[168:171], v[216:219]
  s_add_u32 s90, s90, 0
  s_waitcnt lgkmcnt(13)
  v_mfma_f32_16x16x32_bf16 v[220:223], v[144:147], v[172:175], v[220:223]
  v_min_u32 v42, 39, v1
  s_waitcnt lgkmcnt(11)
  v_mfma_f32_16x16x32_bf16 v[204:207], v[140:143], v[160:163], v[204:207]
  v_lshlrev_b32 v42, 4, v42
  v_mfma_f32_16x16x32_bf16 v[208:211], v[140:143], v[164:167], v[208:211]
  v_mfma_f32_16x16x32_bf16 v[212:215], v[140:143], v[168:171], v[212:215]
  buffer_load_dwordx3 v[88:90], v42, s[52:55], s90 offen offset:0 sc1
  v_mfma_f32_16x16x32_bf16 v[216:219], v[140:143], v[172:175], v[216:219]
  ds_read_b128 v[184:187], v240 offset:640
  s_waitcnt lgkmcnt(9)
  v_mfma_f32_16x16x32_bf16 v[220:223], v[140:143], v[176:179], v[220:223]
  ds_read2_b32 v[128:129], v232 offset0:32 offset1:33
  ds_read2_b32 v[130:131], v232 offset0:34 offset1:35
  s_waitcnt lgkmcnt(9)
  v_mfma_f32_16x16x32_bf16 v[200:203], v[136:139], v[160:163], v[200:203]
  buffer_load_dwordx3 v[92:94], v42, s[52:55], s90 offen offset:640 sc1
  v_mfma_f32_16x16x32_bf16 v[204:207], v[136:139], v[164:167], v[204:207]
  buffer_load_dwordx3 v[96:98], v42, s[52:55], s90 offen offset:1280 sc1
  v_mfma_f32_16x16x32_bf16 v[208:211], v[136:139], v[168:171], v[208:211]
  buffer_load_dwordx3 v[100:102], v42, s[52:55], s90 offen offset:1920 sc1
  v_mfma_f32_16x16x32_bf16 v[212:215], v[136:139], v[172:175], v[212:215]
  v_mfma_f32_16x16x32_bf16 v[216:219], v[136:139], v[176:179], v[216:219]
  s_waitcnt lgkmcnt(5)
  v_mfma_f32_16x16x32_bf16 v[220:223], v[136:139], v[180:183], v[220:223]
  s_waitcnt lgkmcnt(3)
  v_mfma_f32_16x16x32_bf16 v[196:199], v[132:135], v[160:163], v[196:199]
  ds_read_b128 v[188:191], v240 offset:128
  v_mfma_f32_16x16x32_bf16 v[200:203], v[132:135], v[164:167], v[200:203]
  v_mfma_f32_16x16x32_bf16 v[204:207], v[132:135], v[168:171], v[204:207]
  v_mfma_f32_16x16x32_bf16 v[208:211], v[132:135], v[172:175], v[208:211]
  v_mfma_f32_16x16x32_bf16 v[212:215], v[132:135], v[176:179], v[212:215]
  v_mfma_f32_16x16x32_bf16 v[216:219], v[132:135], v[180:183], v[216:219]
  s_waitcnt lgkmcnt(3)
  v_mfma_f32_16x16x32_bf16 v[220:223], v[132:135], v[184:187], v[220:223]
  s_waitcnt lgkmcnt(1)
  v_mfma_f32_16x16x32_bf16 v[192:195], v[128:131], v[160:163], v[192:195]
  v_mfma_f32_16x16x32_bf16 v[196:199], v[128:131], v[164:167], v[196:199]
  v_mfma_f32_16x16x32_bf16 v[200:203], v[128:131], v[168:171], v[200:203]
  v_mfma_f32_16x16x32_bf16 v[204:207], v[128:131], v[172:175], v[204:207]
  v_mfma_f32_16x16x32_bf16 v[208:211], v[128:131], v[176:179], v[208:211]
  v_mfma_f32_16x16x32_bf16 v[212:215], v[128:131], v[180:183], v[212:215]
  v_mfma_f32_16x16x32_bf16 v[216:219], v[128:131], v[184:187], v[216:219]
  s_waitcnt lgkmcnt(0)
  v_mfma_f32_16x16x32_bf16 v[220:223], v[128:131], v[188:191], v[220:223]
  v_lshrrev_b32 v11, 1, v3
  v_mul_u32_u24 v12, 80, v11
  v_add_u32 v12, 160640, v12
  v_mul_u32_u24_e64 v11, 48, v11
  v_add_u32 v11, 149504, v11
  ds_read_b128 v[128:131], v12 offset:0
  ds_read_b128 v[132:135], v12 offset:16
  ds_read_b128 v[136:139], v12 offset:32
  ds_read_b128 v[140:143], v12 offset:48
  ds_read_b128 v[144:147], v12 offset:640
  ds_read_b128 v[148:151], v12 offset:656
  ds_read_b128 v[152:155], v12 offset:672
  ds_read_b128 v[156:159], v12 offset:688
  v_accvgpr_read_b32 v254, a240
  v_accvgpr_read_b32 v255, a241
  v_accvgpr_read_b32 v47, a242
  s_waitcnt vmcnt(0)
  v_min3_u32 v14, v90, v94, s8
  v_max3_u32 v15, v90, v94, s8
  v_min3_u32 v14, v14, v98, v102
  v_max3_u32 v15, v15, v98, v102
  v_cmp_ne_u32 vcc, v14, v15
  s_cbranch_vccz ok_34
again_33:
  buffer_load_dwordx3 v[88:90], v42, s[52:55], s90 offen offset:0 sc1
  buffer_load_dwordx3 v[92:94], v42, s[52:55], s90 offen offset:640 sc1
  buffer_load_dwordx3 v[96:98], v42, s[52:55], s90 offen offset:1280 sc1
  buffer_load_dwordx3 v[100:102], v42, s[52:55], s90 offen offset:1920 sc1
  s_sub_u32 s10, s10, 1
  s_cmp_gt_i32 s10, 0
  s_waitcnt vmcnt(0)
  v_min3_u32 v14, v90, v94, s8
  v_max3_u32 v15, v90, v94, s8
  v_min3_u32 v14, v14, v98, v102
  v_max3_u32 v15, v15, v98, v102
  v_cmp_ne_u32 vcc, v14, v15
  s_cbranch_scc0 out_35
  s_cbranch_vccnz again_33
out_35:
ok_34:
  v_pk_fma_f32 v[92:93], v[88:89], v[38:39], v[92:93] op_sel:[1,1,0] op_sel_hi:[0,1,1] neg_lo:[0,1,0]
  v_pk_fma_f32 v[92:93], v[88:89], v[38:39], v[92:93] op_sel:[0,0,0] op_sel_hi:[1,0,1]
  v_pk_fma_f32 v[96:97], v[92:93], v[38:39], v[96:97] op_sel:[1,1,0] op_sel_hi:[0,1,1] neg_lo:[0,1,0]
  v_pk_fma_f32 v[96:97], v[92:93], v[38:39], v[96:97] op_sel:[0,0,0] op_sel_hi:[1,0,1]
  v_pk_fma_f32 v[100:101], v[96:97], v[38:39], v[100:101] op_sel:[1,1,0] op_sel_hi:[0,1,1] neg_lo:[0,1,0]
  v_pk_fma_f32 v[100:101], v[96:97], v[38:39], v[100:101] op_sel:[0,0,0] op_sel_hi:[1,0,1]
  v_pk_mul_f32 v[88:89], v[100:101], v[40:41] op_sel:[1,1] op_sel_hi:[0,1] neg_lo:[0,1]
  v_pk_fma_f32 v[88:89], v[100:101], v[40:41], v[88:89] op_sel:[0,0,0] op_sel_hi:[1,0,1]
  buffer_load_dwordx4 a[120:123], v2, s[52:55], s34 offen offset:2048 sc1
  s_mov_b32 exec_hi, 0xff
  ds_write_b64 v44, v[88:89]
  s_mov_b32 exec_hi, -1
  s_waitcnt lgkmcnt(0)
  s_barrier
  ds_read_b128 v[88:91], v11 offset:0
  ds_read_b128 v[92:95], v11 offset:16
  ds_read_b128 v[96:99], v11 offset:384
  ds_read_b128 v[100:103], v11 offset:400
  ds_read_b128 v[224:227], v11 offset:768
  ds_read_b128 v[228:231], v11 offset:784
  ds_read_b128 v[160:163], v12 offset:1280
  ds_read_b128 v[164:167], v12 offset:1296
  ds_read_b128 v[168:171], v12 offset:1312
  ds_read_b128 v[172:175], v12 offset:1328
  buffer_load_dwordx4 a[124:127], v2, s[52:55], s34 offen offset:3072 sc1
  s_waitcnt lgkmcnt(8)
  v_pk_add_f32 v[88:89], v[88:89], v[90:91]
  v_pk_add_f32 v[92:93], v[92:93], v[94:95]
  v_pk_add_f32 v[88:89], v[88:89], v[92:93]
  v_pk_fma_f32 v[244:245], v[26:27], v[88:89], v[244:245] op_sel:[0,0,0] op_sel_hi:[1,0,1]
  v_pk_fma_f32 v[244:245], v[26:27], v[88:89], v[244:245] op_sel:[1,1,0] op_sel_hi:[0,1,1] neg_hi:[1,0,0]
  ds_read_b128 v[88:91], v11 offset:1152
  ds_read_b128 v[92:95], v11 offset:1168
  s_waitcnt lgkmcnt(8)
  v_pk_add_f32 v[96:97], v[96:97], v[98:99]
  v_pk_add_f32 v[100:101], v[100:101], v[102:103]
  v_pk_add_f32 v[96:97], v[96:97], v[100:101]
  v_pk_fma_f32 v[246:247], v[28:29], v[96:97], v[246:247] op_sel:[0,0,0] op_sel_hi:[1,0,1]
  v_pk_fma_f32 v[246:247], v[28:29], v[96:97], v[246:247] op_sel:[1,1,0] op_sel_hi:[0,1,1] neg_hi:[1,0,0]
  ds_read_b128 v[96:99], v11 offset:1536
  ds_read_b128 v[100:103], v11 offset:1552
  ds_read_b128 v[176:179], v12 offset:1920
  ds_read_b128 v[180:183], v12 offset:1936
  ds_read_b128 v[184:187], v12 offset:1952
  ds_read_b128 v[188:191], v12 offset:1968
  v_pk_fma_f32 v[48:49], v[128:129], v[244:245], v[48:49] op_sel:[0,0,0] op_sel_hi:[1,0,1]
  v_pk_fma_f32 v[50:51], v[130:131], v[244:245], v[50:51] op_sel:[0,0,0] op_sel_hi:[1,0,1]
  v_pk_fma_f32 v[52:53], v[132:133], v[244:245], v[52:53] op_sel:[0,0,0] op_sel_hi:[1,0,1]
  v_pk_fma_f32 v[54:55], v[134:135], v[244:245], v[54:55] op_sel:[0,0,0] op_sel_hi:[1,0,1]
  s_add_u32 s34, s34, 4096
  buffer_load_dwordx4 a[128:131], v2, s[52:55], s34 offen offset:0 sc1
  v_pk_fma_f32 v[48:49], v[136:137], v[244:245], v[48:49] op_sel:[0,1,0] op_sel_hi:[1,1,1]
  v_pk_fma_f32 v[50:51], v[138:139], v[244:245], v[50:51] op_sel:[0,1,0] op_sel_hi:[1,1,1]
  v_pk_fma_f32 v[52:53], v[140:141], v[244:245], v[52:53] op_sel:[0,1,0] op_sel_hi:[1,1,1]
  v_pk_fma_f32 v[54:55], v[142:143], v[244:245], v[54:55] op_sel:[0,1,0] op_sel_hi:[1,1,1]
  v_cvt_pk_bf16_f32 v120, v48, v49
  v_cvt_pk_bf16_f32 v121, v50, v51
  v_cvt_pk_bf16_f32 v122, v52, v53
  v_cvt_pk_bf16_f32 v123, v54, v55
  ds_write_b128 v254, v[120:123]
  buffer_load_dwordx4 a[132:135], v2, s[52:55], s34 offen offset:1024 sc1
  ds_read_b64_tr_b16 v[52:53], v255
  ds_read_b64_tr_b16 v[54:55], v255 offset:640
  s_waitcnt lgkmcnt(15)
  v_pk_add_f32 v[224:225], v[224:225], v[226:227]
  v_pk_add_f32 v[228:229], v[228:229], v[230:231]
  v_pk_add_f32 v[224:225], v[224:225], v[228:229]
  v_pk_fma_f32 v[248:249], v[30:31], v[224:225], v[248:249] op_sel:[0,0,0] op_sel_hi:[1,0,1]
  v_pk_fma_f32 v[248:249], v[30:31], v[224:225], v[248:249] op_sel:[1,1,0] op_sel_hi:[0,1,1] neg_hi:[1,0,0]
  s_lshl_b32 s12, s86, 1
  s_add_u32 s12, s12, 24576
  v_mov_b32 v15, s8
  s_and_b32 exec_lo, s96, 1
  s_mov_b32 exec_hi, 0
  buffer_store_dword v15, off, s[52:55], s12 sc1
  s_mov_b64 exec, -1
  ds_read_b128 v[104:107], v12 offset:2560
  ds_read_b128 v[108:111], v12 offset:2576
  ds_read_b128 v[112:115], v12 offset:2592
  ds_read_b128 v[116:119], v12 offset:2608
  v_pk_fma_f32 v[56:57], v[144:145], v[246:247], v[56:57] op_sel:[0,0,0] op_sel_hi:[1,0,1]
  v_pk_fma_f32 v[58:59], v[146:147], v[246:247], v[58:59] op_sel:[0,0,0] op_sel_hi:[1,0,1]
  v_pk_fma_f32 v[60:61], v[148:149], v[246:247], v[60:61] op_sel:[0,0,0] op_sel_hi:[1,0,1]
  v_pk_fma_f32 v[62:63], v[150:151], v[246:247], v[62:63] op_sel:[0,0,0] op_sel_hi:[1,0,1]
  buffer_load_dwordx4 a[136:139], v2, s[52:55], s34 offen offset:2048 sc1
  v_pk_fma_f32 v[56:57], v[152:153], v[246:247], v[56:57] op_sel:[0,1,0] op_sel_hi:[1,1,1]
  v_pk_fma_f32 v[58:59], v[154:155], v[246:247], v[58:59] op_sel:[0,1,0] op_sel_hi:[1,1,1]
  v_pk_fma_f32 v[60:61], v[156:157], v[246:247], v[60:61] op_sel:[0,1,0] op_sel_hi:[1,1,1]
  v_pk_fma_f32 v[62:63], v[158:159], v[246:247], v[62:63] op_sel:[0,1,0] op_sel_hi:[1,1,1]
  v_cvt_pk_bf16_f32 v124, v56, v57
  v_cvt_pk_bf16_f32 v125, v58, v59
  v_cvt_pk_bf16_f32 v126, v60, v61
  v_cvt_pk_bf16_f32 v127, v62, v63
  ds_write_b128 v254, v[124:127]
  buffer_load_dwordx4 a[140:143], v2, s[52:55], s34 offen offset:3072 sc1
  ds_read_b64_tr_b16 v[60:61], v255
  ds_read_b64_tr_b16 v[62:63], v255 offset:640
  s_waitcnt lgkmcnt(15)
  v_pk_add_f32 v[88:89], v[88:89], v[90:91]
  v_pk_add_f32 v[92:93], v[92:93], v[94:95]
  v_pk_add_f32 v[88:89], v[88:89], v[92:93]
  v_pk_fma_f32 v[250:251], v[32:33], v[88:89], v[250:251] op_sel:[0,0,0] op_sel_hi:[1,0,1]
  v_pk_fma_f32 v[250:251], v[32:33], v[88:89], v[250:251] op_sel:[1,1,0] op_sel_hi:[0,1,1] neg_hi:[1,0,0]
  s_add_u32 s13, s78, 0
  s_waitcnt lgkmcnt(7)
  buffer_store_dwordx4 v[52:55], v47, s[60:63], s13 offen sc1
  v_pk_fma_f32 v[64:65], v[160:161], v[248:249], v[64:65] op_sel:[0,0,0] op_sel_hi:[1,0,1]
  v_pk_fma_f32 v[66:67], v[162:163], v[248:249], v[66:67] op_sel:[0,0,0] op_sel_hi:[1,0,1]
  v_pk_fma_f32 v[68:69], v[164:165], v[248:249], v[68:69] op_sel:[0,0,0] op_sel_hi:[1,0,1]
  v_pk_fma_f32 v[70:71], v[166:167], v[248:249], v[70:71] op_sel:[0,0,0] op_sel_hi:[1,0,1]
  s_add_u32 s34, s34, 4096
  buffer_load_dwordx4 a[144:147], v2, s[52:55], s34 offen offset:0 sc1
  v_pk_fma_f32 v[64:65], v[168:169], v[248:249], v[64:65] op_sel:[0,1,0] op_sel_hi:[1,1,1]
  v_pk_fma_f32 v[66:67], v[170:171], v[248:249], v[66:67] op_sel:[0,1,0] op_sel_hi:[1,1,1]
  v_pk_fma_f32 v[68:69], v[172:173], v[248:249], v[68:69] op_sel:[0,1,0] op_sel_hi:[1,1,1]
  v_pk_fma_f32 v[70:71], v[174:175], v[248:249], v[70:71] op_sel:[0,1,0] op_sel_hi:[1,1,1]
  v_cvt_pk_bf16_f32 v120, v64, v65
  v_cvt_pk_bf16_f32 v121, v66, v67
  v_cvt_pk_bf16_f32 v122, v68, v69
  v_cvt_pk_bf16_f32 v123, v70, v71
  ds_write_b128 v254, v[120:123]
  buffer_load_dwordx4 a[148:151], v2, s[52:55], s34 offen offset:1024 sc1
  ds_read_b64_tr_b16 v[68:69], v255
  ds_read_b64_tr_b16 v[70:71], v255 offset:640
  v_pk_add_f32 v[96:97], v[96:97], v[98:99]
  v_pk_add_f32 v[100:101], v[100:101], v[102:103]
  v_pk_add_f32 v[96:97], v[96:97], v[100:101]
  v_pk_fma_f32 v[252:253], v[34:35], v[96:97], v[252:253] op_sel:[0,0,0] op_sel_hi:[1,0,1]
  v_pk_fma_f32 v[252:253], v[34:35], v[96:97], v[252:253] op_sel:[1,1,0] op_sel_hi:[0,1,1] neg_hi:[1,0,0]
  s_add_u32 s13, s79, 0
  s_waitcnt lgkmcnt(3)
  buffer_store_dwordx4 v[60:63], v47, s[60:63], s13 offen sc1
  v_pk_fma_f32 v[72:73], v[176:177], v[250:251], v[72:73] op_sel:[0,0,0] op_sel_hi:[1,0,1]
  v_pk_fma_f32 v[74:75], v[178:179], v[250:251], v[74:75] op_sel:[0,0,0] op_sel_hi:[1,0,1]
  v_pk_fma_f32 v[76:77], v[180:181], v[250:251], v[76:77] op_sel:[0,0,0] op_sel_hi:[1,0,1]
  v_pk_fma_f32 v[78:79], v[182:183], v[250:251], v[78:79] op_sel:[0,0,0] op_sel_hi:[1,0,1]
  v_pk_fma_f32 v[72:73], v[184:185], v[250:251], v[72:73] op_sel:[0,1,0] op_sel_hi:[1,1,1]
  v_pk_fma_f32 v[74:75], v[186:187], v[250:251], v[74:75] op_sel:[0,1,0] op_sel_hi:[1,1,1]
  v_pk_fma_f32 v[76:77], v[188:189], v[250:251], v[76:77] op_sel:[0,1,0] op_sel_hi:[1,1,1]
  v_pk_fma_f32 v[78:79], v[190:191], v[250:251], v[78:79] op_sel:[0,1,0] op_sel_hi:[1,1,1]
  v_cvt_pk_bf16_f32 v124, v72, v73
  v_cvt_pk_bf16_f32 v125, v74, v75
  v_cvt_pk_bf16_f32 v126, v76, v77
  v_cvt_pk_bf16_f32 v127, v78, v79
  ds_write_b128 v254, v[124:127]
  ds_read_b64_tr_b16 v[76:77], v255
  ds_read_b64_tr_b16 v[78:79], v255 offset:640
  s_add_u32 s13, s80, 0
  s_waitcnt lgkmcnt(3)
  buffer_store_dwordx4 v[68:71], v47, s[60:63], s13 offen sc1
  v_pk_fma_f32 v[80:81], v[104:105], v[252:253], v[80:81] op_sel:[0,0,0] op_sel_hi:[1,0,1]
  v_pk_fma_f32 v[82:83], v[106:107], v[252:253], v[82:83] op_sel:[0,0,0] op_sel_hi:[1,0,1]
  v_pk_fma_f32 v[84:85], v[108:109], v[252:253], v[84:85] op_sel:[0,0,0] op_sel_hi:[1,0,1]
  v_pk_fma_f32 v[86:87], v[110:111], v[252:253], v[86:87] op_sel:[0,0,0] op_sel_hi:[1,0,1]
  v_pk_fma_f32 v[80:81], v[112:113], v[252:253], v[80:81] op_sel:[0,1,0] op_sel_hi:[1,1,1]
  v_pk_fma_f32 v[82:83], v[114:115], v[252:253], v[82:83] op_sel:[0,1,0] op_sel_hi:[1,1,1]
  v_pk_fma_f32 v[84:85], v[116:117], v[252:253], v[84:85] op_sel:[0,1,0] op_sel_hi:[1,1,1]
  v_pk_fma_f32 v[86:87], v[118:119], v[252:253], v[86:87] op_sel:[0,1,0] op_sel_hi:[1,1,1]
  v_cvt_pk_bf16_f32 v120, v80, v81
  v_cvt_pk_bf16_f32 v121, v82, v83
  v_cvt_pk_bf16_f32 v122, v84, v85
  v_cvt_pk_bf16_f32 v123, v86, v87
  ds_write_b128 v254, v[120:123]
  ds_read_b64_tr_b16 v[84:85], v255
  ds_read_b64_tr_b16 v[86:87], v255 offset:640
  v_accvgpr_read_b32 v246, a204
  v_accvgpr_read_b32 v247, a205
  v_accvgpr_read_b32 v248, a206
  v_accvgpr_read_b32 v249, a207
  v_accvgpr_read_b32 v250, a208
  v_accvgpr_read_b32 v251, a209
  v_accvgpr_read_b32 v252, a210
  v_accvgpr_read_b32 v44, a211
  v_accvgpr_read_b32 v45, a212
  v_accvgpr_read_b32 v46, a213
  v_accvgpr_read_b32 v244, a214
  ds_read_b64 v[88:89], v247 offset:1536
  ds_read_b64 v[90:91], v247 offset:1024
  ds_read_b64 v[92:93], v247 offset:512
  ds_read_b64 v[94:95], v247 offset:0
  ds_read_b64 v[96:97], v248
  s_waitcnt lgkmcnt(5)
  s_bitcmp1_b32 s1, 0
  s_cbranch_scc1 type_36
  ds_read2_b32 v[156:157], v235 offset0:176 offset1:177
  ds_read2_b32 v[158:159], v235 offset0:178 offset1:179
  ds_read_b128 v[160:163], v240 offset:3776
  ds_read2_b32 v[152:153], v235 offset0:48 offset1:49
  ds_read2_b32 v[154:155], v235 offset0:50 offset1:51
  ds_read_b128 v[164:167], v240 offset:3264
  ds_read2_b32 v[148:149], v234 offset0:176 offset1:177
  ds_read2_b32 v[150:151], v234 offset0:178 offset1:179
  s_waitcnt lgkmcnt(5)
  v_mfma_f32_16x16x32_bf16 v[220:223], v[156:159], v[160:163], v[220:223]
  ds_read_b128 v[168:171], v240 offset:2752
  s_waitcnt lgkmcnt(4)
  v_mfma_f32_16x16x32_bf16 v[216:219], v[152:155], v[160:163], v[216:219]
  ds_read2_b32 v[144:145], v234 offset0:48 offset1:49
  ds_read2_b32 v[146:147], v234 offset0:50 offset1:51
  s_waitcnt lgkmcnt(5)
  v_mfma_f32_16x16x32_bf16 v[220:223], v[152:155], v[164:167], v[220:223]
  ds_read_b128 v[172:175], v240 offset:2240
  s_waitcnt lgkmcnt(4)
  v_mfma_f32_16x16x32_bf16 v[212:215], v[148:151], v[160:163], v[212:215]
  ds_read2_b32 v[140:141], v233 offset0:176 offset1:177
  ds_read2_b32 v[142:143], v233 offset0:178 offset1:179
  s_add_u32 s13, s81, 0
  buffer_store_dwordx4 v[76:79], v47, s[60:63], s13 offen sc1
  v_mfma_f32_16x16x32_bf16 v[216:219], v[148:151], v[164:167], v[216:219]
  ds_read_b128 v[176:179], v240 offset:1728
  s_waitcnt lgkmcnt(6)
  v_mfma_f32_16x16x32_bf16 v[220:223], v[148:151], v[168:171], v[220:223]
  ds_read2_b32 v[136:137], v233 offset0:48 offset1:49
  ds_read2_b32 v[138:139], v233 offset0:50 offset1:51
  s_waitcnt lgkmcnt(6)
  v_mfma_f32_16x16x32_bf16 v[208:211], v[144:147], v[160:163], v[208:211]
  ds_read_b128 v[180:183], v240 offset:1216
  v_mfma_f32_16x16x32_bf16 v[212:215], v[144:147], v[164:167], v[212:215]
  ds_read2_b32 v[132:133], v232 offset0:176 offset1:177
  ds_read2_b32 v[134:135], v232 offset0:178 offset1:179
  s_add_u32 s13, s82, 0
  buffer_store_dwordx4 v[84:87], v47, s[60:63], s13 offen sc1
  v_mfma_f32_16x16x32_bf16 v[216:219], v[144:147], v[168:171], v[216:219]
  s_waitcnt lgkmcnt(8)
  v_mfma_f32_16x16x32_bf16 v[220:223], v[144:147], v[172:175], v[220:223]
  s_waitcnt lgkmcnt(6)
  v_mfma_f32_16x16x32_bf16 v[204:207], v[140:143], v[160:163], v[204:207]
  v_mfma_f32_16x16x32_bf16 v[208:211], v[140:143], v[164:167], v[208:211]
  v_mfma_f32_16x16x32_bf16 v[212:215], v[140:143], v[168:171], v[212:215]
  buffer_load_dwordx4 a[152:155], v2, s[52:55], s34 offen offset:2048 sc1
  v_mfma_f32_16x16x32_bf16 v[216:219], v[140:143], v[172:175], v[216:219]
  ds_read_b128 v[184:187], v240 offset:704
  s_waitcnt lgkmcnt(6)
  v_mfma_f32_16x16x32_bf16 v[220:223], v[140:143], v[176:179], v[220:223]
  ds_read2_b32 v[128:129], v232 offset0:48 offset1:49
  ds_read2_b32 v[130:131], v232 offset0:50 offset1:51
  s_waitcnt lgkmcnt(6)
  v_mfma_f32_16x16x32_bf16 v[200:203], v[136:139], v[160:163], v[200:203]
  v_mfma_f32_16x16x32_bf16 v[204:207], v[136:139], v[164:167], v[204:207]
  buffer_load_dwordx4 a[156:159], v2, s[52:55], s34 offen offset:3072 sc1
  v_mfma_f32_16x16x32_bf16 v[208:211], v[136:139], v[168:171], v[208:211]
  v_mfma_f32_16x16x32_bf16 v[212:215], v[136:139], v[172:175], v[212:215]
  v_mfma_f32_16x16x32_bf16 v[216:219], v[136:139], v[176:179], v[216:219]
  s_waitcnt lgkmcnt(5)
  v_mfma_f32_16x16x32_bf16 v[220:223], v[136:139], v[180:183], v[220:223]
  s_add_u32 s34, s34, 4096
  buffer_load_dwordx4 a[160:163], v2, s[52:55], s34 offen offset:0 sc1
  s_waitcnt lgkmcnt(3)
  v_mfma_f32_16x16x32_bf16 v[196:199], v[132:135], v[160:163], v[196:199]
  ds_read_b128 v[188:191], v240 offset:192
  v_mfma_f32_16x16x32_bf16 v[200:203], v[132:135], v[164:167], v[200:203]
  ds_read2_b32 v[156:157], v239 offset0:128 offset1:129
  ds_read2_b32 v[158:159], v239 offset0:130 offset1:131
  v_mfma_f32_16x16x32_bf16 v[204:207], v[132:135], v[168:171], v[204:207]
  ds_read2_b32 v[152:153], v239 offset0:0 offset1:1
  ds_read2_b32 v[154:155], v239 offset0:2 offset1:3
  v_mfma_f32_16x16x32_bf16 v[208:211], v[132:135], v[172:175], v[208:211]
  ds_read2_b32 v[148:149], v238 offset0:128 offset1:129
  ds_read2_b32 v[150:151], v238 offset0:130 offset1:131
  v_mfma_f32_16x16x32_bf16 v[212:215], v[132:135], v[176:179], v[212:215]
  ds_read2_b32 v[144:145], v238 offset0:0 offset1:1
  ds_read2_b32 v[146:147], v238 offset0:2 offset1:3
  v_mfma_f32_16x16x32_bf16 v[216:219], v[132:135], v[180:183], v[216:219]
  buffer_load_dwordx4 a[164:167], v2, s[52:55], s34 offen offset:1024 sc1
  s_waitcnt lgkmcnt(11)
  v_mfma_f32_16x16x32_bf16 v[220:223], v[132:135], v[184:187], v[220:223]
  ds_read2_b32 v[140:141], v237 offset0:128 offset1:129
  ds_read2_b32 v[142:143], v237 offset0:130 offset1:131
  s_waitcnt lgkmcnt(11)
  v_mfma_f32_16x16x32_bf16 v[192:195], v[128:131], v[160:163], v[192:195]
  ds_read_b128 v[160:163], v241 offset:3584
  v_mfma_f32_16x16x32_bf16 v[196:199], v[128:131], v[164:167], v[196:199]
  ds_read_b128 v[164:167], v241 offset:3072
  v_mfma_f32_16x16x32_bf16 v[200:203], v[128:131], v[168:171], v[200:203]
  ds_read2_b32 v[136:137], v237 offset0:0 offset1:1
  ds_read2_b32 v[138:139], v237 offset0:2 offset1:3
  v_mfma_f32_16x16x32_bf16 v[204:207], v[128:131], v[172:175], v[204:207]
  ds_read_b128 v[168:171], v241 offset:2560
  buffer_load_dwordx4 a[168:171], v2, s[52:55], s34 offen offset:2048 sc1
  v_mfma_f32_16x16x32_bf16 v[208:211], v[128:131], v[176:179], v[208:211]
  ds_read_b128 v[172:175], v241 offset:2048
  v_mfma_f32_16x16x32_bf16 v[212:215], v[128:131], v[180:183], v[212:215]
  ds_read_b128 v[176:179], v241 offset:1536
  v_mfma_f32_16x16x32_bf16 v[216:219], v[128:131], v[184:187], v[216:219]
  ds_read2_b32 v[132:133], v236 offset0:128 offset1:129
  ds_read2_b32 v[134:135], v236 offset0:130 offset1:131
  s_waitcnt lgkmcnt(15)
  v_mfma_f32_16x16x32_bf16 v[220:223], v[128:131], v[188:191], v[220:223]
  ds_read_b128 v[180:183], v241 offset:1024
  buffer_load_dwordx4 a[172:175], v2, s[52:55], s34 offen offset:3072 sc1
  s_waitcnt vmcnt(6)
  s_add_u32 s14, s84, 4352
  v_mov_b32 v15, s8
  s_mov_b64 exec, 1
  s_cmp_eq_u32 s9, 0
  s_cbranch_scc1 slow_38
  buffer_store_dword v15, off, s[52:55], s14
back_39:
  s_mov_b64 exec, -1
  s_waitcnt lgkmcnt(9)
  v_mfma_f32_16x16x32_bf16 v[116:119], v[156:159], v[160:163], 0
  ds_read_b128 v[184:187], v241 offset:512
  s_waitcnt lgkmcnt(9)
  v_mfma_f32_16x16x32_bf16 v[116:119], v[152:155], v[164:167], v[116:119]
  ds_read2_b32 v[128:129], v236 offset0:0 offset1:1
  ds_read2_b32 v[130:131], v236 offset0:2 offset1:3
  s_waitcnt lgkmcnt(8)
  v_mfma_f32_16x16x32_bf16 v[116:119], v[148:151], v[168:171], v[116:119]
  v_mfma_f32_16x16x32_bf16 v[112:115], v[144:147], v[160:163], 0
  ds_read_b128 v[188:191], v241 offset:0
  s_waitcnt lgkmcnt(8)
  v_mfma_f32_16x16x32_bf16 v[116:119], v[144:147], v[172:175], v[116:119]
  ds_read2_b32 v[156:157], v239 offset0:144 offset1:145
  ds_read2_b32 v[158:159], v239 offset0:146 offset1:147
  v_mfma_f32_16x16x32_bf16 v[112:115], v[140:143], v[164:167], v[112:115]
  ds_read2_b32 v[152:153], v239 offset0:16 offset1:17
  ds_read2_b32 v[154:155], v239 offset0:18 offset1:19
  s_waitcnt lgkmcnt(11)
  v_mfma_f32_16x16x32_bf16 v[116:119], v[140:143], v[176:179], v[116:119]
  ds_read2_b32 v[148:149], v238 offset0:144 offset1:145
  ds_read2_b32 v[150:151], v238 offset0:146 offset1:147
  v_mfma_f32_16x16x32_bf16 v[108:111], v[136:139], v[160:163], 0
  ds_read2_b32 v[144:145], v238 offset0:16 offset1:17
  ds_read2_b32 v[146:147], v238 offset0:18 offset1:19
  s_add_u32 s34, s34, 4096
  buffer_load_dwordx4 a[176:179], v2, s[52:55], s34 offen offset:0 sc1
  s_bitcmp0_b32 s7, 0
  s_cbranch_scc1 skip_40
  v_swap_b32 v192, v208
  v_swap_b32 v193, v209
  v_swap_b32 v194, v210
  v_swap_b32 v195, v211
  v_swap_b32 v196, v212
  v_swap_b32 v197, v213
  v_swap_b32 v198, v214
  v_swap_b32 v199, v215
  v_swap_b32 v200, v216
  v_swap_b32 v201, v217
  v_swap_b32 v202, v218
  v_swap_b32 v203, v219
  v_swap_b32 v204, v220
  v_swap_b32 v205, v221
  v_swap_b32 v206, v222
  v_swap_b32 v207, v223
skip_40:
  v_mfma_f32_16x16x32_bf16 v[112:115], v[136:139], v[168:171], v[112:115]
  buffer_load_dwordx4 a[180:183], v2, s[52:55], s34 offen offset:1024 sc1
  s_waitcnt lgkmcnt(12)
  v_mfma_f32_16x16x32_bf16 v[116:119], v[136:139], v[180:183], v[116:119]
  ds_read2_b32 v[140:141], v237 offset0:144 offset1:145
  ds_read2_b32 v[142:143], v237 offset0:146 offset1:147
  v_mfma_f32_16x16x32_bf16 v[104:107], v[132:135], v[160:163], 0
  ds_read_b128 v[160:163], v241 offset:3648
  v_mfma_f32_16x16x32_bf16 v[108:111], v[132:135], v[164:167], v[108:111]
  ds_read2_b32 v[136:137], v237 offset0:16 offset1:17
  ds_read2_b32 v[138:139], v237 offset0:18 offset1:19
  ds_write_b128 v249, v[208:211] offset:0
  v_mfma_f32_16x16x32_bf16 v[112:115], v[132:135], v[172:175], v[112:115]
  ds_read_b128 v[172:175], v241 offset:2112
  s_waitcnt lgkmcnt(15)
  v_mfma_f32_16x16x32_bf16 v[116:119], v[132:135], v[184:187], v[116:119]
  ds_read_b128 v[180:183], v241 offset:1088
  v_mfma_f32_16x16x32_bf16 v[104:107], v[128:131], v[164:167], v[104:107]
  ds_read_b128 v[164:167], v241 offset:3136
  v_mfma_f32_16x16x32_bf16 v[108:111], v[128:131], v[168:171], v[108:111]
  ds_read2_b32 v[132:133], v236 offset0:144 offset1:145
  ds_read2_b32 v[134:135], v236 offset0:146 offset1:147
  buffer_load_dwordx4 a[184:187], v2, s[52:55], s34 offen offset:2048 sc1
  ds_write_b128 v249, v[212:215] offset:1024
  s_mov_b32 s92, 24576
  buffer_load_dwordx4 v[120:123], v2, s[52:55], s92 offen sc1
  v_mfma_f32_16x16x32_bf16 v[112:115], v[128:131], v[176:179], v[112:115]
  ds_read_b128 v[168:171], v241 offset:2624
  v_mfma_f32_16x16x32_bf16 v[116:119], v[128:131], v[188:191], v[116:119]
  ds_read_b128 v[176:179], v241 offset:1600
  s_waitcnt lgkmcnt(11)
  v_mfma_f32_16x16x32_bf16 v[116:119], v[156:159], v[160:163], v[116:119]
  ds_read_b128 v[184:187], v241 offset:576
  s_waitcnt lgkmcnt(6)
  v_mfma_f32_16x16x32_bf16 v[116:119], v[152:155], v[164:167], v[116:119]
  ds_read2_b32 v[128:129], v236 offset0:16 offset1:17
  ds_read2_b32 v[130:131], v236 offset0:18 offset1:19
  buffer_load_dwordx4 a[188:191], v2, s[52:55], s34 offen offset:3072 sc1
  ds_write_b128 v249, v[216:219] offset:2048
  s_barrier
  s_waitcnt lgkmcnt(5)
  v_mfma_f32_16x16x32_bf16 v[116:119], v[148:151], v[168:171], v[116:119]
  s_add_u32 s34, s34, 4096
  buffer_load_dwordx4 a[192:195], v2, s[52:55], s34 offen offset:0 sc1
  v_mfma_f32_16x16x32_bf16 v[112:115], v[144:147], v[160:163], v[112:115]
  ds_read_b128 v[188:191], v241 offset:64
  v_mfma_f32_16x16x32_bf16 v[116:119], v[144:147], v[172:175], v[116:119]
  ds_write_b128 v249, v[220:223] offset:3072
  v_mfma_f32_16x16x32_bf16 v[112:115], v[140:143], v[164:167], v[112:115]
  s_waitcnt lgkmcnt(6)
  v_mfma_f32_16x16x32_bf16 v[116:119], v[140:143], v[176:179], v[116:119]
  buffer_load_dwordx4 a[196:199], v2, s[52:55], s34 offen offset:1024 sc1
  v_mfma_f32_16x16x32_bf16 v[108:111], v[136:139], v[160:163], v[108:111]
  buffer_load_dwordx2 v[42:43], v244, s[52:55], s49 offen sc1
  v_mfma_f32_16x16x32_bf16 v[112:115], v[136:139], v[168:171], v[112:115]
  v_mfma_f32_16x16x32_bf16 v[116:119], v[136:139], v[180:183], v[116:119]
  v_mfma_f32_16x16x32_bf16 v[104:107], v[132:135], v[160:163], v[104:107]
  v_mfma_f32_16x16x32_bf16 v[108:111], v[132:135], v[164:167], v[108:111]
  v_mfma_f32_16x16x32_bf16 v[112:115], v[132:135], v[172:175], v[112:115]
  s_waitcnt lgkmcnt(5)
  v_mfma_f32_16x16x32_bf16 v[116:119], v[132:135], v[184:187], v[116:119]
  s_waitcnt lgkmcnt(3)
  v_mfma_f32_16x16x32_bf16 v[104:107], v[128:131], v[164:167], v[104:107]
  v_mfma_f32_16x16x32_bf16 v[108:111], v[128:131], v[168:171], v[108:111]
  v_mfma_f32_16x16x32_bf16 v[112:115], v[128:131], v[176:179], v[112:115]
  s_waitcnt lgkmcnt(1)
  v_mfma_f32_16x16x32_bf16 v[116:119], v[128:131], v[188:191], v[116:119]
  s_branch join_37
type_36:
  ds_read2_b32 v[156:157], v235 offset0:176 offset1:177
  ds_read2_b32 v[158:159], v235 offset0:178 offset1:179
  ds_read_b128 v[160:163], v240 offset:3776
  ds_read2_b32 v[152:153], v235 offset0:48 offset1:49
  ds_read2_b32 v[154:155], v235 offset0:50 offset1:51
  ds_read_b128 v[164:167], v240 offset:3264
  ds_read2_b32 v[148:149], v234 offset0:176 offset1:177
  ds_read2_b32 v[150:151], v234 offset0:178 offset1:179
  s_waitcnt lgkmcnt(5)
  v_mfma_f32_16x16x32_bf16 v[220:223], v[156:159], v[160:163], v[220:223]
  ds_read_b128 v[168:171], v240 offset:2752
  s_waitcnt lgkmcnt(4)
  v_mfma_f32_16x16x32_bf16 v[216:219], v[152:155], v[160:163], v[216:219]
  ds_read2_b32 v[144:145], v234 offset0:48 offset1:49
  ds_read2_b32 v[146:147], v234 offset0:50 offset1:51
  s_waitcnt lgkmcnt(5)
  v_mfma_f32_16x16x32_bf16 v[220:223], v[152:155], v[164:167], v[220:223]
  ds_read_b128 v[172:175], v240 offset:2240
  s_waitcnt lgkmcnt(4)
  v_mfma_f32_16x16x32_bf16 v[212:215], v[148:151], v[160:163], v[212:215]
  ds_read2_b32 v[140:141], v233 offset0:176 offset1:177
  ds_read2_b32 v[142:143], v233 offset0:178 offset1:179
  s_add_u32 s13, s81, 0
  buffer_store_dwordx4 v[76:79], v47, s[60:63], s13 offen sc1
  v_mfma_f32_16x16x32_bf16 v[216:219], v[148:151], v[164:167], v[216:219]
  ds_read_b128 v[176:179], v240 offset:1728
  s_waitcnt lgkmcnt(6)
  v_mfma_f32_16x16x32_bf16 v[220:223], v[148:151], v[168:171], v[220:223]
  ds_read2_b32 v[136:137], v233 offset0:48 offset1:49
  ds_read2_b32 v[138:139], v233 offset0:50 offset1:51
  s_waitcnt lgkmcnt(6)
  v_mfma_f32_16x16x32_bf16 v[208:211], v[144:147], v[160:163], v[208:211]
  ds_read_b128 v[180:183], v240 offset:1216
  v_mfma_f32_16x16x32_bf16 v[212:215], v[144:147], v[164:167], v[212:215]
  ds_read2_b32 v[132:133], v232 offset0:176 offset1:177
  ds_read2_b32 v[134:135], v232 offset0:178 offset1:179
  s_add_u32 s13, s82, 0
  buffer_store_dwordx4 v[84:87], v47, s[60:63], s13 offen sc1
  v_mfma_f32_16x16x32_bf16 v[216:219], v[144:147], v[168:171], v[216:219]
  s_waitcnt lgkmcnt(8)
  v_mfma_f32_16x16x32_bf16 v[220:223], v[144:147], v[172:175], v[220:223]
  s_waitcnt lgkmcnt(6)
  v_mfma_f32_16x16x32_bf16 v[204:207], v[140:143], v[160:163], v[204:207]
  v_mfma_f32_16x16x32_bf16 v[208:211], v[140:143], v[164:167], v[208:211]
  v_mfma_f32_16x16x32_bf16 v[212:215], v[140:143], v[168:171], v[212:215]
  buffer_load_dwordx4 a[152:155], v2, s[52:55], s34 offen offset:2048 sc1
  v_mfma_f32_16x16x32_bf16 v[216:219], v[140:143], v[172:175], v[216:219]
  ds_read_b128 v[184:187], v240 offset:704
  s_waitcnt lgkmcnt(6)
  v_mfma_f32_16x16x32_bf16 v[220:223], v[140:143], v[176:179], v[220:223]
  ds_read2_b32 v[128:129], v232 offset0:48 offset1:49
  ds_read2_b32 v[130:131], v232 offset0:50 offset1:51
  s_waitcnt lgkmcnt(6)
  v_mfma_f32_16x16x32_bf16 v[200:203], v[136:139], v[160:163], v[200:203]
  v_mfma_f32_16x16x32_bf16 v[204:207], v[136:139], v[164:167], v[204:207]
  buffer_load_dwordx4 a[156:159], v2, s[52:55], s34 offen offset:3072 sc1
  v_mfma_f32_16x16x32_bf16 v[208:211], v[136:139], v[168:171], v[208:211]
  v_mfma_f32_16x16x32_bf16 v[212:215], v[136:139], v[172:175], v[212:215]
  v_mfma_f32_16x16x32_bf16 v[216:219], v[136:139], v[176:179], v[216:219]
  s_waitcnt lgkmcnt(5)
  v_mfma_f32_16x16x32_bf16 v[220:223], v[136:139], v[180:183], v[220:223]
  s_add_u32 s34, s34, 4096
  buffer_load_dwordx4 a[160:163], v2, s[52:55], s34 offen offset:0 sc1
  s_waitcnt lgkmcnt(3)
  v_mfma_f32_16x16x32_bf16 v[196:199], v[132:135], v[160:163], v[196:199]
  ds_read_b128 v[188:191], v240 offset:192
  v_mfma_f32_16x16x32_bf16 v[200:203], v[132:135], v[164:167], v[200:203]
  ds_read2_b32 v[152:153], v239 offset0:0 offset1:1
  ds_read2_b32 v[154:155], v239 offset0:2 offset1:3
  v_mfma_f32_16x16x32_bf16 v[204:207], v[132:135], v[168:171], v[204:207]
  ds_read2_b32 v[148:149], v238 offset0:128 offset1:129
  ds_read2_b32 v[150:151], v238 offset0:130 offset1:131
  v_mfma_f32_16x16x32_bf16 v[208:211], v[132:135], v[172:175], v[208:211]
  buffer_load_dwordx4 a[164:167], v2, s[52:55], s34 offen offset:1024 sc1
  v_mfma_f32_16x16x32_bf16 v[212:215], v[132:135], v[176:179], v[212:215]
  ds_read2_b32 v[144:145], v238 offset0:0 offset1:1
  ds_read2_b32 v[146:147], v238 offset0:2 offset1:3
  v_mfma_f32_16x16x32_bf16 v[216:219], v[132:135], v[180:183], v[216:219]
  s_waitcnt lgkmcnt(9)
  v_mfma_f32_16x16x32_bf16 v[220:223], v[132:135], v[184:187], v[220:223]
  ds_read2_b32 v[140:141], v237 offset0:128 offset1:129
  ds_read2_b32 v[142:143], v237 offset0:130 offset1:131
  s_waitcnt lgkmcnt(9)
  v_mfma_f32_16x16x32_bf16 v[192:195], v[128:131], v[160:163], v[192:195]
  ds_read_b128 v[160:163], v241 offset:3584
  v_mfma_f32_16x16x32_bf16 v[196:199], v[128:131], v[164:167], v[196:199]
  ds_read_b128 v[164:167], v241 offset:3072
  v_mfma_f32_16x16x32_bf16 v[200:203], v[128:131], v[168:171], v[200:203]
  ds_read_b128 v[168:171], v241 offset:2560
  v_mfma_f32_16x16x32_bf16 v[204:207], v[128:131], v[172:175], v[204:207]
  ds_read2_b32 v[136:137], v237 offset0:0 offset1:1
  ds_read2_b32 v[138:139], v237 offset0:2 offset1:3
  buffer_load_dwordx4 a[168:171], v2, s[52:55], s34 offen offset:2048 sc1
  v_mfma_f32_16x16x32_bf16 v[208:211], v[128:131], v[176:179], v[208:211]
  ds_read_b128 v[172:175], v241 offset:2048
  v_mfma_f32_16x16x32_bf16 v[212:215], v[128:131], v[180:183], v[212:215]
  ds_read_b128 v[176:179], v241 offset:1536
  v_mfma_f32_16x16x32_bf16 v[216:219], v[128:131], v[184:187], v[216:219]
  ds_read2_b32 v[132:133], v236 offset0:128 offset1:129
  ds_read2_b32 v[134:135], v236 offset0:130 offset1:131
  s_waitcnt lgkmcnt(15)
  v_mfma_f32_16x16x32_bf16 v[220:223], v[128:131], v[188:191], v[220:223]
  ds_read_b128 v[180:183], v241 offset:1024
  buffer_load_dwordx4 a[172:175], v2, s[52:55], s34 offen offset:3072 sc1
  s_waitcnt vmcnt(6)
  s_add_u32 s14, s84, 4352
  v_mov_b32 v15, s8
  s_mov_b64 exec, 1
  s_cmp_eq_u32 s9, 0
  s_cbranch_scc1 slow_41
  buffer_store_dword v15, off, s[52:55], s14
back_42:
  s_mov_b64 exec, -1
  s_waitcnt lgkmcnt(9)
  v_mfma_f32_16x16x32_bf16 v[116:119], v[152:155], v[160:163], 0
  ds_read2_b32 v[128:129], v236 offset0:0 offset1:1
  ds_read2_b32 v[130:131], v236 offset0:2 offset1:3
  v_mfma_f32_16x16x32_bf16 v[112:115], v[148:151], v[160:163], 0
  s_waitcnt lgkmcnt(10)
  v_mfma_f32_16x16x32_bf16 v[116:119], v[148:151], v[164:167], v[116:119]
  v_mfma_f32_16x16x32_bf16 v[112:115], v[144:147], v[164:167], v[112:115]
  ds_read_b128 v[184:187], v241 offset:512
  s_waitcnt lgkmcnt(10)
  v_mfma_f32_16x16x32_bf16 v[116:119], v[144:147], v[168:171], v[116:119]
  ds_read2_b32 v[152:153], v239 offset0:16 offset1:17
  ds_read2_b32 v[154:155], v239 offset0:18 offset1:19
  v_mfma_f32_16x16x32_bf16 v[108:111], v[140:143], v[160:163], 0
  ds_read2_b32 v[148:149], v238 offset0:144 offset1:145
  ds_read2_b32 v[150:151], v238 offset0:146 offset1:147
  v_mfma_f32_16x16x32_bf16 v[112:115], v[140:143], v[168:171], v[112:115]
  s_add_u32 s34, s34, 4096
  buffer_load_dwordx4 a[176:179], v2, s[52:55], s34 offen offset:0 sc1
  s_waitcnt lgkmcnt(11)
  v_mfma_f32_16x16x32_bf16 v[116:119], v[140:143], v[172:175], v[116:119]
  ds_read2_b32 v[144:145], v238 offset0:16 offset1:17
  ds_read2_b32 v[146:147], v238 offset0:18 offset1:19
  s_bitcmp0_b32 s7, 0
  s_cbranch_scc1 skip_43
  v_swap_b32 v192, v208
  v_swap_b32 v193, v209
  v_swap_b32 v194, v210
  v_swap_b32 v195, v211
  v_swap_b32 v196, v212
  v_swap_b32 v197, v213
  v_swap_b32 v198, v214
  v_swap_b32 v199, v215
  v_swap_b32 v200, v216
  v_swap_b32 v201, v217
  v_swap_b32 v202, v218
  v_swap_b32 v203, v219
  v_swap_b32 v204, v220
  v_swap_b32 v205, v221
  v_swap_b32 v206, v222
  v_swap_b32 v207, v223
skip_43:
  v_mfma_f32_16x16x32_bf16 v[108:111], v[136:139], v[164:167], v[108:111]
  ds_read_b128 v[164:167], v241 offset:3136
  v_mfma_f32_16x16x32_bf16 v[112:115], v[136:139], v[172:175], v[112:115]
  ds_read2_b32 v[140:141], v237 offset0:144 offset1:145
  ds_read2_b32 v[142:143], v237 offset0:146 offset1:147
  s_waitcnt lgkmcnt(15)
  v_mfma_f32_16x16x32_bf16 v[116:119], v[136:139], v[176:179], v[116:119]
  buffer_load_dwordx4 a[180:183], v2, s[52:55], s34 offen offset:1024 sc1
  s_waitcnt lgkmcnt(13)
  v_mfma_f32_16x16x32_bf16 v[108:111], v[132:135], v[168:171], v[108:111]
  ds_read_b128 v[168:171], v241 offset:2624
  ds_write_b128 v249, v[208:211] offset:0
  v_mfma_f32_16x16x32_bf16 v[112:115], v[132:135], v[176:179], v[112:115]
  ds_read2_b32 v[136:137], v237 offset0:16 offset1:17
  ds_read2_b32 v[138:139], v237 offset0:18 offset1:19
  s_waitcnt lgkmcnt(15)
  v_mfma_f32_16x16x32_bf16 v[116:119], v[132:135], v[180:183], v[116:119]
  buffer_load_dwordx4 a[184:187], v2, s[52:55], s34 offen offset:2048 sc1
  s_waitcnt lgkmcnt(14)
  v_mfma_f32_16x16x32_bf16 v[104:107], v[128:131], v[160:163], 0
  ds_read_b128 v[160:163], v241 offset:3648
  v_mfma_f32_16x16x32_bf16 v[108:111], v[128:131], v[172:175], v[108:111]
  ds_read_b128 v[176:179], v241 offset:1600
  ds_write_b128 v249, v[212:215] offset:1024
  s_mov_b32 s92, 24576
  buffer_load_dwordx4 v[120:123], v2, s[52:55], s92 offen sc1
  v_mfma_f32_16x16x32_bf16 v[112:115], v[128:131], v[180:183], v[112:115]
  ds_read_b128 v[172:175], v241 offset:2112
  s_waitcnt lgkmcnt(15)
  v_mfma_f32_16x16x32_bf16 v[116:119], v[128:131], v[184:187], v[116:119]
  ds_read2_b32 v[132:133], v236 offset0:144 offset1:145
  ds_read2_b32 v[134:135], v236 offset0:146 offset1:147
  s_waitcnt lgkmcnt(5)
  v_mfma_f32_16x16x32_bf16 v[116:119], v[152:155], v[160:163], v[116:119]
  ds_read_b128 v[180:183], v241 offset:1088
  v_mfma_f32_16x16x32_bf16 v[112:115], v[148:151], v[160:163], v[112:115]
  ds_read2_b32 v[128:129], v236 offset0:16 offset1:17
  ds_read2_b32 v[130:131], v236 offset0:18 offset1:19
  buffer_load_dwordx4 a[188:191], v2, s[52:55], s34 offen offset:3072 sc1
  ds_write_b128 v249, v[216:219] offset:2048
  s_barrier
  v_mfma_f32_16x16x32_bf16 v[116:119], v[148:151], v[164:167], v[116:119]
  s_add_u32 s34, s34, 4096
  buffer_load_dwordx4 a[192:195], v2, s[52:55], s34 offen offset:0 sc1
  v_mfma_f32_16x16x32_bf16 v[112:115], v[144:147], v[164:167], v[112:115]
  ds_read_b128 v[184:187], v241 offset:576
  v_mfma_f32_16x16x32_bf16 v[116:119], v[144:147], v[168:171], v[116:119]
  ds_write_b128 v249, v[220:223] offset:3072
  v_mfma_f32_16x16x32_bf16 v[108:111], v[140:143], v[160:163], v[108:111]
  v_mfma_f32_16x16x32_bf16 v[112:115], v[140:143], v[168:171], v[112:115]
  buffer_load_dwordx4 a[196:199], v2, s[52:55], s34 offen offset:1024 sc1
  s_waitcnt lgkmcnt(8)
  v_mfma_f32_16x16x32_bf16 v[116:119], v[140:143], v[172:175], v[116:119]
  buffer_load_dwordx2 v[42:43], v244, s[52:55], s49 offen sc1
  v_mfma_f32_16x16x32_bf16 v[108:111], v[136:139], v[164:167], v[108:111]
  v_mfma_f32_16x16x32_bf16 v[112:115], v[136:139], v[172:175], v[112:115]
  v_mfma_f32_16x16x32_bf16 v[116:119], v[136:139], v[176:179], v[116:119]
  s_waitcnt lgkmcnt(6)
  v_mfma_f32_16x16x32_bf16 v[108:111], v[132:135], v[168:171], v[108:111]
  v_mfma_f32_16x16x32_bf16 v[112:115], v[132:135], v[176:179], v[112:115]
  s_waitcnt lgkmcnt(5)
  v_mfma_f32_16x16x32_bf16 v[116:119], v[132:135], v[180:183], v[116:119]
  s_waitcnt lgkmcnt(3)
  v_mfma_f32_16x16x32_bf16 v[104:107], v[128:131], v[160:163], v[104:107]
  v_mfma_f32_16x16x32_bf16 v[108:111], v[128:131], v[172:175], v[108:111]
  v_mfma_f32_16x16x32_bf16 v[112:115], v[128:131], v[180:183], v[112:115]
  s_waitcnt lgkmcnt(1)
  v_mfma_f32_16x16x32_bf16 v[116:119], v[128:131], v[184:187], v[116:119]
join_37:
  s_nop 3
  ds_write_b128 v252, v[104:107] offset:0
  ds_write_b128 v252, v[108:111] offset:1024
  ds_write_b128 v252, v[112:115] offset:2048
  s_nop 0
  ds_write_b128 v252, v[116:119] offset:3072
  v_dot2_f32_bf16 v192, v89, s31, v192
  v_dot2_f32_bf16 v193, v89, s30, v193
  v_dot2_f32_bf16 v194, v88, s31, v194
  v_dot2_f32_bf16 v195, v88, s30, v195
  v_dot2_f32_bf16 v196, v91, s31, v196
  v_dot2_f32_bf16 v197, v91, s30, v197
  v_dot2_f32_bf16 v198, v90, s31, v198
  v_dot2_f32_bf16 v199, v90, s30, v199
  v_dot2_f32_bf16 v200, v93, s31, v200
  v_dot2_f32_bf16 v201, v93, s30, v201
  v_dot2_f32_bf16 v202, v92, s31, v202
  v_dot2_f32_bf16 v203, v92, s30, v203
  v_dot2_f32_bf16 v204, v95, s31, v204
  v_dot2_f32_bf16 v205, v95, s30, v205
  v_dot2_f32_bf16 v206, v94, s31, v206
  v_dot2_f32_bf16 v207, v94, s30, v207
  s_waitcnt vmcnt(4)
  v_min3_u32 v15, v120, v121, s8
  v_max3_u32 v14, v120, v121, s8
  v_min3_u32 v15, v15, v122, v123
  v_max3_u32 v14, v14, v122, v123
  v_cmp_ne_u32 vcc, v15, v14
  s_cbranch_vccnz again_44
ok_45:
  s_waitcnt vmcnt(0)
  v_xor_b32 v15, s8, v42
  v_xor_b32 v14, s8, v43
  v_or_b32 v15, v15, v14
  v_cmp_ne_u32 vcc, 0, v15
  s_cbranch_vccz ok_47
again_46:
  buffer_load_dwordx2 v[42:43], v244, s[52:55], s49 offen sc1
  s_sub_u32 s10, s10, 1
  s_cmp_gt_i32 s10, 0
  s_waitcnt vmcnt(0)
  v_xor_b32 v15, s8, v42
  v_xor_b32 v14, s8, v43
  v_or_b32 v15, v15, v14
  v_cmp_ne_u32 vcc, 0, v15
  s_cbranch_scc0 out_48
  s_cbranch_vccnz again_46
out_48:
ok_47:
  buffer_load_dwordx4 v[128:131], v2, s[60:63], s16 offen offset:0 sc1
  buffer_load_dwordx4 v[132:135], v2, s[60:63], s16 offen offset:1024 sc1
  buffer_load_dwordx4 v[136:139], v2, s[60:63], s16 offen offset:2048 sc1
  buffer_load_dwordx4 v[140:143], v2, s[60:63], s16 offen offset:3072 sc1
  s_add_u32 s16, s16, 4096
  buffer_load_dwordx4 v[144:147], v2, s[60:63], s16 offen offset:0 sc1
  buffer_load_dwordx4 v[148:151], v2, s[60:63], s16 offen offset:1024 sc1
  buffer_load_dwordx4 v[152:155], v2, s[60:63], s16 offen offset:2048 sc1
  buffer_load_dwordx4 v[156:159], v2, s[60:63], s16 offen offset:3072 sc1
  s_waitcnt lgkmcnt(0)
  s_barrier
  ds_read_b128 v[208:211], v250 offset:0
  ds_read_b128 v[212:215], v250 offset:1024
  ds_read_b128 v[216:219], v250 offset:2048
  ds_read_b128 v[220:223], v250 offset:3072
  ds_read_b128 v[224:227], v251 offset:0
  ds_read_b128 v[228:231], v251 offset:4096
  ds_read_b128 v[232:235], v251 offset:8192
  ds_read_b128 v[236:239], v251 offset:12288
  s_waitcnt vmcnt(7)
  v_mfma_f32_16x16x32_bf16 v[48:51], a[0:3], v[128:131], 0
  s_add_u32 s16, s16, 4096
  buffer_load_dwordx4 v[160:163], v2, s[60:63], s16 offen offset:0 sc1
  s_waitcnt lgkmcnt(0)
  v_mfma_f32_16x16x32_bf16 v[52:55], a[4:7], v[128:131], 0
  v_add_f32 v208, v192, v208
  v_add_f32 v209, v193, v209
  v_mfma_f32_16x16x32_bf16 v[56:59], a[8:11], v[128:131], 0
  v_add_f32 v210, v194, v210
  v_add_f32 v211, v195, v211
  v_mfma_f32_16x16x32_bf16 v[60:63], a[12:15], v[128:131], 0
  v_cvt_pk_bf16_f32 v208, v208, v209
  v_cvt_pk_bf16_f32 v209, v210, v211
  v_mfma_f32_16x16x32_bf16 v[64:67], a[16:19], v[128:131], 0
  buffer_store_dwordx2 v[208:209], v246, s[52:55], s50 offen offset:0 sc1
  s_waitcnt vmcnt(8)
  v_mfma_f32_16x16x32_bf16 v[48:51], a[20:23], v[132:135], v[48:51]
  buffer_load_dwordx4 v[164:167], v2, s[60:63], s16 offen offset:1024 sc1
  v_add_f32 v212, v196, v212
  v_mfma_f32_16x16x32_bf16 v[52:55], a[24:27], v[132:135], v[52:55]
  v_add_f32 v213, v197, v213
  v_add_f32 v214, v198, v214
  v_mfma_f32_16x16x32_bf16 v[56:59], a[28:31], v[132:135], v[56:59]
  v_add_f32_e64 v215, v199, v215
  v_cvt_pk_bf16_f32 v212, v212, v213
  v_mfma_f32_16x16x32_bf16 v[60:63], a[32:35], v[132:135], v[60:63]
  v_cvt_pk_bf16_f32 v213, v214, v215
  buffer_store_dwordx2 v[212:213], v246, s[52:55], s50 offen offset:512 sc1
  v_mfma_f32_16x16x32_bf16 v[64:67], a[36:39], v[132:135], v[64:67]
  v_add_f32 v216, v200, v216
  s_waitcnt vmcnt(9)
  v_mfma_f32_16x16x32_bf16 v[48:51], a[40:43], v[136:139], v[48:51]
  buffer_load_dwordx4 v[168:171], v2, s[60:63], s17 offen offset:0 sc1
  v_add_f32_e64 v217, v201, v217
  v_mfma_f32_16x16x32_bf16 v[52:55], a[44:47], v[136:139], v[52:55]
  v_add_f32 v218, v202, v218
  v_add_f32 v219, v203, v219
  v_mfma_f32_16x16x32_bf16 v[56:59], a[48:51], v[136:139], v[56:59]
  v_cvt_pk_bf16_f32 v216, v216, v217
  v_cvt_pk_bf16_f32 v217, v218, v219
  v_mfma_f32_16x16x32_bf16 v[60:63], a[52:55], v[136:139], v[60:63]
  buffer_store_dwordx2 v[216:217], v246, s[52:55], s50 offen offset:1024 sc1
  v_add_f32_e64 v220, v204, v220
  v_mfma_f32_16x16x32_bf16 v[64:67], a[56:59], v[136:139], v[64:67]
  v_add_f32 v221, v205, v221
  s_waitcnt vmcnt(10)
  v_mfma_f32_16x16x32_bf16 v[48:51], a[60:63], v[140:143], v[48:51]
  buffer_load_dwordx4 v[172:175], v2, s[60:63], s17 offen offset:1024 sc1
  v_add_f32_e64 v222, v206, v222
  v_mfma_f32_16x16x32_bf16 v[52:55], a[64:67], v[140:143], v[52:55]
  v_add_f32_e64 v223, v207, v223
  v_cvt_pk_bf16_f32 v220, v220, v221
  v_mfma_f32_16x16x32_bf16 v[56:59], a[68:71], v[140:143], v[56:59]
  v_cvt_pk_bf16_f32 v221, v222, v223
  buffer_store_dwordx2 v[220:221], v246, s[52:55], s50 offen offset:1536 sc1
  v_mfma_f32_16x16x32_bf16 v[60:63], a[72:75], v[140:143], v[60:63]
  v_dot2_f32_bf16 v224, v97, s45, v224
  v_dot2_f32_bf16 v225, v97, s25, v225
  v_mfma_f32_16x16x32_bf16 v[64:67], a[76:79], v[140:143], v[64:67]
  v_dot2_f32_bf16 v226, v96, s45, v226
  s_waitcnt vmcnt(11)
  v_mfma_f32_16x16x32_bf16 v[48:51], a[80:83], v[144:147], v[48:51]
  buffer_load_dwordx4 v[176:179], v2, s[60:63], s17 offen offset:2048 sc1
  v_dot2_f32_bf16 v227, v96, s25, v227
  v_mfma_f32_16x16x32_bf16 v[52:55], a[84:87], v[144:147], v[52:55]
  v_add_f32 v228, v228, v232
  v_add_f32_e64 v229, v229, v233
  v_mfma_f32_16x16x32_bf16 v[56:59], a[88:91], v[144:147], v[56:59]
  v_add_f32 v230, v230, v234
  v_add_f32 v231, v231, v235
  v_mfma_f32_16x16x32_bf16 v[60:63], a[92:95], v[144:147], v[60:63]
  v_add_f32 v224, v224, v236
  v_add_f32 v225, v225, v237
  v_mfma_f32_16x16x32_bf16 v[64:67], a[96:99], v[144:147], v[64:67]
  v_add_f32 v226, v226, v238
  s_waitcnt vmcnt(11)
  v_mfma_f32_16x16x32_bf16 v[48:51], a[100:103], v[148:151], v[48:51]
  buffer_load_dwordx4 v[180:183], v2, s[60:63], s17 offen offset:3072 sc1
  v_add_f32_e64 v227, v227, v239
  v_mfma_f32_16x16x32_bf16 v[52:55], a[104:107], v[148:151], v[52:55]
  v_add_f32 v224, v224, v228
  v_add_f32 v225, v225, v229
  v_mfma_f32_16x16x32_bf16 v[56:59], a[108:111], v[148:151], v[56:59]
  v_add_f32 v226, v226, v230
  v_add_f32 v227, v227, v231
  v_mfma_f32_16x16x32_bf16 v[60:63], a[112:115], v[148:151], v[60:63]
  v_cvt_pk_bf16_f32 v224, v224, v225
  v_cvt_pk_bf16_f32 v225, v226, v227
  v_mfma_f32_16x16x32_bf16 v[64:67], a[116:119], v[148:151], v[64:67]
  buffer_store_dwordx2 v[224:225], v246, s[52:55], s51 offen sc1
  s_waitcnt vmcnt(12)
  v_mfma_f32_16x16x32_bf16 v[48:51], a[120:123], v[152:155], v[48:51]
  s_add_u32 s17, s17, 4096
  buffer_load_dwordx4 v[184:187], v2, s[60:63], s17 offen offset:0 sc1
  s_barrier
  v_mfma_f32_16x16x32_bf16 v[52:55], a[124:127], v[152:155], v[52:55]
  v_accvgpr_read_b32 v102, a226
  v_accvgpr_read_b32 v103, a227
  v_mfma_f32_16x16x32_bf16 v[56:59], a[128:131], v[152:155], v[56:59]
  v_mul_f32_e64 v102, v102, v103
  v_accvgpr_read_b32 v98, a216
  v_mfma_f32_16x16x32_bf16 v[60:63], a[132:135], v[152:155], v[60:63]
  v_accvgpr_read_b32 v100, a230
  v_accvgpr_read_b32 v99, a217
  v_mfma_f32_16x16x32_bf16 v[64:67], a[136:139], v[152:155], v[64:67]
  v_accvgpr_read_b32 v101, a231
  v_lshlrev_b32 v108, 16, v98
  s_waitcnt vmcnt(12)
  v_mfma_f32_16x16x32_bf16 v[48:51], a[140:143], v[156:159], v[48:51]
  buffer_load_dwordx4 v[188:191], v2, s[60:63], s17 offen offset:1024 sc1
  v_and_b32 v109, 0xffff0000, v98
  v_mfma_f32_16x16x32_bf16 v[52:55], a[144:147], v[156:159], v[52:55]
  v_lshlrev_b32_e64 v110, 16, v99
  v_and_b32 v111, 0xffff0000, v99
  v_mfma_f32_16x16x32_bf16 v[56:59], a[148:151], v[156:159], v[56:59]
  v_lshlrev_b32_e64 v92, 16, v100
  v_and_b32 v93, 0xffff0000, v100
  v_mfma_f32_16x16x32_bf16 v[60:63], a[152:155], v[156:159], v[60:63]
  v_lshlrev_b32_e64 v94, 16, v101
  v_and_b32 v95, 0xffff0000, v101
  v_mfma_f32_16x16x32_bf16 v[64:67], a[156:159], v[156:159], v[64:67]
  v_fma_f32 v88, v108, v103, -v102
  s_waitcnt vmcnt(12)
  v_mfma_f32_16x16x32_bf16 v[48:51], a[160:163], v[160:163], v[48:51]
  buffer_load_dwordx4 v[128:131], v2, s[60:63], s17 offen offset:2048 sc1
  v_fma_f32 v89, v109, v103, -v102
  v_mfma_f32_16x16x32_bf16 v[52:55], a[164:167], v[160:163], v[52:55]
  v_fma_f32 v90, v110, v103, -v102
  v_fma_f32 v91, v111, v103, -v102
  v_mfma_f32_16x16x32_bf16 v[56:59], a[168:171], v[160:163], v[56:59]
  v_fmac_f32 v108, v88, v92
  v_fmac_f32_e64 v109, v89, v93
  v_mfma_f32_16x16x32_bf16 v[60:63], a[172:175], v[160:163], v[60:63]
  v_fmac_f32 v110, v90, v94
  v_fmac_f32 v111, v91, v95
  v_mfma_f32_16x16x32_bf16 v[64:67], a[176:179], v[160:163], v[64:67]
  v_accvgpr_read_b32 v98, a218
  s_waitcnt vmcnt(11)
  v_mfma_f32_16x16x32_bf16 v[48:51], a[180:183], v[164:167], v[48:51]
  buffer_load_dwordx4 v[132:135], v2, s[60:63], s17 offen offset:3072 sc1
  v_accvgpr_read_b32 v100, a232
  v_mfma_f32_16x16x32_bf16 v[52:55], a[184:187], v[164:167], v[52:55]
  v_accvgpr_read_b32 v99, a219
  v_accvgpr_read_b32 v101, a233
  v_mfma_f32_16x16x32_bf16 v[56:59], a[188:191], v[164:167], v[56:59]
  v_lshlrev_b32 v112, 16, v98
  v_and_b32 v113, 0xffff0000, v98
  v_mfma_f32_16x16x32_bf16 v[60:63], a[192:195], v[164:167], v[60:63]
  v_lshlrev_b32_e64 v114, 16, v99
  v_and_b32 v115, 0xffff0000, v99
  v_mfma_f32_16x16x32_bf16 v[64:67], a[196:199], v[164:167], v[64:67]
  v_lshlrev_b32 v92, 16, v100
  s_waitcnt vmcnt(10)
  v_mfma_f32_16x16x32_bf16 v[68:71], a[0:3], v[168:171], 0
  s_add_u32 s17, s17, 4096
  buffer_load_dwordx4 v[136:139], v2, s[60:63], s17 offen offset:0 sc1
  v_and_b32 v93, 0xffff0000, v100
  v_mfma_f32_16x16x32_bf16 v[72:75], a[4:7], v[168:171], 0
  v_lshlrev_b32_e64 v94, 16, v101
  v_and_b32 v95, 0xffff0000, v101
  v_mfma_f32_16x16x32_bf16 v[76:79], a[8:11], v[168:171], 0
  v_fma_f32 v88, v112, v103, -v102
  v_fma_f32 v89, v113, v103, -v102
  v_mfma_f32_16x16x32_bf16 v[80:83], a[12:15], v[168:171], 0
  v_fma_f32 v90, v114, v103, -v102
  v_fma_f32 v91, v115, v103, -v102
  v_mfma_f32_16x16x32_bf16 v[84:87], a[16:19], v[168:171], 0
  v_fmac_f32 v112, v88, v92
  s_waitcnt vmcnt(9)
  v_mfma_f32_16x16x32_bf16 v[68:71], a[20:23], v[172:175], v[68:71]
  ds_write_b128 v44, v[48:51] offset:0
  ds_write_b128 v44, v[52:55] offset:1024
  buffer_load_dwordx4 v[140:143], v2, s[60:63], s17 offen offset:1024 sc1
  v_mfma_f32_16x16x32_bf16 v[72:75], a[24:27], v[172:175], v[72:75]
  v_fmac_f32 v113, v89, v93
  v_fmac_f32 v114, v90, v94
  v_mfma_f32_16x16x32_bf16 v[76:79], a[28:31], v[172:175], v[76:79]
  v_fmac_f32_e64 v115, v91, v95
  v_accvgpr_read_b32 v98, a220
  v_mfma_f32_16x16x32_bf16 v[80:83], a[32:35], v[172:175], v[80:83]
  v_accvgpr_read_b32 v100, a234
  v_accvgpr_read_b32 v99, a221
  v_mfma_f32_16x16x32_bf16 v[84:87], a[36:39], v[172:175], v[84:87]
  v_accvgpr_read_b32 v101, a235
  v_lshlrev_b32 v116, 16, v98
  s_waitcnt vmcnt(8)
  v_mfma_f32_16x16x32_bf16 v[68:71], a[40:43], v[176:179], v[68:71]
  ds_write_b128 v44, v[56:59] offset:2048
  ds_write_b128 v44, v[60:63] offset:3072
  buffer_load_dwordx4 v[144:147], v2, s[60:63], s18 offen offset:0 sc1
  v_mfma_f32_16x16x32_bf16 v[72:75], a[44:47], v[176:179], v[72:75]
  v_and_b32 v117, 0xffff0000, v98
  v_lshlrev_b32_e64 v118, 16, v99
  v_mfma_f32_16x16x32_bf16 v[76:79], a[48:51], v[176:179], v[76:79]
  v_and_b32 v119, 0xffff0000, v99
  v_lshlrev_b32_e64 v92, 16, v100
  v_mfma_f32_16x16x32_bf16 v[80:83], a[52:55], v[176:179], v[80:83]
  v_and_b32 v93, 0xffff0000, v100
  v_lshlrev_b32_e64 v94, 16, v101
  v_mfma_f32_16x16x32_bf16 v[84:87], a[56:59], v[176:179], v[84:87]
  v_and_b32 v95, 0xffff0000, v101
  v_fma_f32 v88, v116, v103, -v102
  s_waitcnt vmcnt(8)
  v_mfma_f32_16x16x32_bf16 v[68:71], a[60:63], v[180:183], v[68:71]
  ds_write_b128 v44, v[64:67] offset:4096
  buffer_load_dwordx4 v[148:151], v2, s[60:63], s18 offen offset:1024 sc1
  v_mfma_f32_16x16x32_bf16 v[72:75], a[64:67], v[180:183], v[72:75]
  v_fma_f32 v89, v117, v103, -v102
  v_fma_f32 v90, v118, v103, -v102
  v_mfma_f32_16x16x32_bf16 v[76:79], a[68:71], v[180:183], v[76:79]
  v_fma_f32 v91, v119, v103, -v102
  v_fmac_f32 v116, v88, v92
  v_mfma_f32_16x16x32_bf16 v[80:83], a[72:75], v[180:183], v[80:83]
  v_fmac_f32 v117, v89, v93
  v_fmac_f32 v118, v90, v94
  v_mfma_f32_16x16x32_bf16 v[84:87], a[76:79], v[180:183], v[84:87]
  v_fmac_f32_e64 v119, v91, v95
  v_accvgpr_read_b32 v98, a222
  s_waitcnt vmcnt(7)
  v_mfma_f32_16x16x32_bf16 v[68:71], a[80:83], v[184:187], v[68:71]
  buffer_load_dwordx4 v[152:155], v2, s[60:63], s18 offen offset:2048 sc1
  v_accvgpr_read_b32 v100, a236
  v_mfma_f32_16x16x32_bf16 v[72:75], a[84:87], v[184:187], v[72:75]
  v_accvgpr_read_b32 v99, a223
  v_accvgpr_read_b32 v101, a237
  v_mfma_f32_16x16x32_bf16 v[76:79], a[88:91], v[184:187], v[76:79]
  v_lshlrev_b32 v120, 16, v98
  v_and_b32 v121, 0xffff0000, v98
  v_mfma_f32_16x16x32_bf16 v[80:83], a[92:95], v[184:187], v[80:83]
  v_lshlrev_b32_e64 v122, 16, v99
  v_and_b32 v123, 0xffff0000, v99
  v_mfma_f32_16x16x32_bf16 v[84:87], a[96:99], v[184:187], v[84:87]
  v_lshlrev_b32 v92, 16, v100
  s_waitcnt vmcnt(7)
  v_mfma_f32_16x16x32_bf16 v[68:71], a[100:103], v[188:191], v[68:71]
  buffer_load_dwordx4 v[156:159], v2, s[60:63], s18 offen offset:3072 sc1
  v_and_b32 v93, 0xffff0000, v100
  v_mfma_f32_16x16x32_bf16 v[72:75], a[104:107], v[188:191], v[72:75]
  v_lshlrev_b32_e64 v94, 16, v101
  v_and_b32 v95, 0xffff0000, v101
  v_mfma_f32_16x16x32_bf16 v[76:79], a[108:111], v[188:191], v[76:79]
  v_fma_f32 v88, v120, v103, -v102
  v_fma_f32 v89, v121, v103, -v102
  v_mfma_f32_16x16x32_bf16 v[80:83], a[112:115], v[188:191], v[80:83]
  v_fma_f32 v90, v122, v103, -v102
  v_fma_f32 v91, v123, v103, -v102
  v_mfma_f32_16x16x32_bf16 v[84:87], a[116:119], v[188:191], v[84:87]
  v_fmac_f32 v120, v88, v92
  s_waitcnt vmcnt(7)
  v_mfma_f32_16x16x32_bf16 v[68:71], a[120:123], v[128:131], v[68:71]
  s_add_u32 s18, s18, 4096
  buffer_load_dwordx4 v[160:163], v2, s[60:63], s18 offen offset:0 sc1
  v_fmac_f32 v121, v89, v93
  v_fmac_f32 v122, v90, v94
  v_mfma_f32_16x16x32_bf16 v[72:75], a[124:127], v[128:131], v[72:75]
  v_fmac_f32_e64 v123, v91, v95
  v_accvgpr_read_b32 v98, a224
  v_accvgpr_read_b32 v100, a238
  v_mfma_f32_16x16x32_bf16 v[76:79], a[128:131], v[128:131], v[76:79]
  v_accvgpr_read_b32 v99, a225
  v_accvgpr_read_b32 v101, a239
  v_mfma_f32_16x16x32_bf16 v[80:83], a[132:135], v[128:131], v[80:83]
  v_lshlrev_b32_e64 v124, 16, v98
  s_mul_i32 s15, s7, 10240
  v_mfma_f32_16x16x32_bf16 v[84:87], a[136:139], v[128:131], v[84:87]
  s_add_u32 s15, s15, 102400
  v_add_u32 v47, s15, v2
  s_waitcnt vmcnt(7)
  v_mfma_f32_16x16x32_bf16 v[68:71], a[140:143], v[132:135], v[68:71]
  buffer_load_dwordx4 v[164:167], v2, s[60:63], s18 offen offset:1024 sc1
  v_and_b32 v125, 0xffff0000, v98
  v_mfma_f32_16x16x32_bf16 v[72:75], a[144:147], v[132:135], v[72:75]
  v_lshlrev_b32_e64 v126, 16, v99
  v_and_b32 v127, 0xffff0000, v99
  v_mfma_f32_16x16x32_bf16 v[76:79], a[148:151], v[132:135], v[76:79]
  v_lshlrev_b32_e64 v92, 16, v100
  v_and_b32 v93, 0xffff0000, v100
  v_mfma_f32_16x16x32_bf16 v[80:83], a[152:155], v[132:135], v[80:83]
  v_lshlrev_b32_e64 v94, 16, v101
  v_and_b32 v95, 0xffff0000, v101
  v_mfma_f32_16x16x32_bf16 v[84:87], a[156:159], v[132:135], v[84:87]
  v_fma_f32 v88, v124, v103, -v102
  s_waitcnt vmcnt(7)
  v_mfma_f32_16x16x32_bf16 v[68:71], a[160:163], v[136:139], v[68:71]
  buffer_load_dwordx4 v[168:171], v2, s[60:63], s18 offen offset:2048 sc1
  v_fma_f32 v89, v125, v103, -v102
  v_mfma_f32_16x16x32_bf16 v[72:75], a[164:167], v[136:139], v[72:75]
  v_fma_f32 v90, v126, v103, -v102
  v_fma_f32 v91, v127, v103, -v102
  v_mfma_f32_16x16x32_bf16 v[76:79], a[168:171], v[136:139], v[76:79]
  v_fmac_f32 v124, v88, v92
  v_fmac_f32_e64 v125, v89, v93
  v_mfma_f32_16x16x32_bf16 v[80:83], a[172:175], v[136:139], v[80:83]
  v_fmac_f32_e64 v126, v90, v94
  v_mfma_f32_16x16x32_bf16 v[84:87], a[176:179], v[136:139], v[84:87]
  v_fmac_f32 v127, v91, v95
  s_waitcnt vmcnt(7)
  v_mfma_f32_16x16x32_bf16 v[68:71], a[180:183], v[140:143], v[68:71]
  buffer_load_dwordx4 v[172:175], v2, s[60:63], s18 offen offset:3072 sc1
  v_mfma_f32_16x16x32_bf16 v[72:75], a[184:187], v[140:143], v[72:75]
  v_mfma_f32_16x16x32_bf16 v[76:79], a[188:191], v[140:143], v[76:79]
  v_mfma_f32_16x16x32_bf16 v[80:83], a[192:195], v[140:143], v[80:83]
  v_mfma_f32_16x16x32_bf16 v[84:87], a[196:199], v[140:143], v[84:87]
  s_waitcnt vmcnt(7)
  v_mfma_f32_16x16x32_bf16 v[48:51], a[0:3], v[144:147], 0
  s_add_u32 s18, s18, 4096
  buffer_load_dwordx4 v[176:179], v2, s[60:63], s18 offen offset:0 sc1
  v_mfma_f32_16x16x32_bf16 v[52:55], a[4:7], v[144:147], 0
  v_mfma_f32_16x16x32_bf16 v[56:59], a[8:11], v[144:147], 0
  v_mfma_f32_16x16x32_bf16 v[60:63], a[12:15], v[144:147], 0
  v_mfma_f32_16x16x32_bf16 v[64:67], a[16:19], v[144:147], 0
  s_waitcnt vmcnt(7)
  v_mfma_f32_16x16x32_bf16 v[48:51], a[20:23], v[148:151], v[48:51]
  ds_write_b128 v45, v[68:71] offset:0
  v_mfma_f32_16x16x32_bf16 v[52:55], a[24:27], v[148:151], v[52:55]
  ds_write_b128 v45, v[72:75] offset:1024
  v_mfma_f32_16x16x32_bf16 v[56:59], a[28:31], v[148:151], v[56:59]
  buffer_load_dwordx4 v[180:183], v2, s[60:63], s18 offen offset:1024 sc1
  v_mfma_f32_16x16x32_bf16 v[60:63], a[32:35], v[148:151], v[60:63]
  v_mfma_f32_16x16x32_bf16 v[64:67], a[36:39], v[148:151], v[64:67]
  s_waitcnt vmcnt(7)
  v_mfma_f32_16x16x32_bf16 v[48:51], a[40:43], v[152:155], v[48:51]
  ds_write_b128 v45, v[76:79] offset:2048
  v_mfma_f32_16x16x32_bf16 v[52:55], a[44:47], v[152:155], v[52:55]
  ds_write_b128 v45, v[80:83] offset:3072
  v_mfma_f32_16x16x32_bf16 v[56:59], a[48:51], v[152:155], v[56:59]
  buffer_load_dwordx4 v[184:187], v2, s[60:63], s19 offen offset:0 sc1
  v_mfma_f32_16x16x32_bf16 v[60:63], a[52:55], v[152:155], v[60:63]
  v_mfma_f32_16x16x32_bf16 v[64:67], a[56:59], v[152:155], v[64:67]
  s_waitcnt vmcnt(7)
  v_mfma_f32_16x16x32_bf16 v[48:51], a[60:63], v[156:159], v[48:51]
  ds_write_b128 v45, v[84:87] offset:4096
  v_mfma_f32_16x16x32_bf16 v[52:55], a[64:67], v[156:159], v[52:55]
  buffer_load_dwordx4 v[188:191], v2, s[60:63], s19 offen offset:1024 sc1
  v_mfma_f32_16x16x32_bf16 v[56:59], a[68:71], v[156:159], v[56:59]
  v_mfma_f32_16x16x32_bf16 v[60:63], a[72:75], v[156:159], v[60:63]
  v_mfma_f32_16x16x32_bf16 v[64:67], a[76:79], v[156:159], v[64:67]
  s_waitcnt vmcnt(7)
  v_mfma_f32_16x16x32_bf16 v[48:51], a[80:83], v[160:163], v[48:51]
  buffer_load_dwordx4 v[128:131], v2, s[60:63], s19 offen offset:2048 sc1
  s_waitcnt lgkmcnt(0)
  s_barrier
  v_mfma_f32_16x16x32_bf16 v[52:55], a[84:87], v[160:163], v[52:55]
  ds_read_b128 v[192:195], v47 offset:0
  ds_read_b128 v[196:199], v47 offset:1024
  v_mfma_f32_16x16x32_bf16 v[56:59], a[88:91], v[160:163], v[56:59]
  ds_read_b128 v[200:203], v47 offset:2048
  ds_read_b128 v[204:207], v47 offset:3072
  v_mfma_f32_16x16x32_bf16 v[60:63], a[92:95], v[160:163], v[60:63]
  ds_read_b128 v[208:211], v47 offset:4096
  ds_read_b128 v[212:215], v47 offset:5120
  v_mfma_f32_16x16x32_bf16 v[64:67], a[96:99], v[160:163], v[64:67]
  ds_read_b128 v[216:219], v47 offset:6144
  ds_read_b128 v[220:223], v47 offset:7168
  s_waitcnt vmcnt(7)
  v_mfma_f32_16x16x32_bf16 v[48:51], a[100:103], v[164:167], v[48:51]
  buffer_load_dwordx4 v[132:135], v2, s[60:63], s19 offen offset:3072 sc1
  ds_read_b128 v[224:227], v47 offset:8192
  v_mfma_f32_16x16x32_bf16 v[52:55], a[104:107], v[164:167], v[52:55]
  ds_read_b128 v[228:231], v47 offset:9216
  s_waitcnt lgkmcnt(5)
  v_mfma_f32_16x16x32_bf16 v[56:59], a[108:111], v[164:167], v[56:59]
  v_add_f32 v108, v108, v192
  v_add_f32_e64 v109, v109, v193
  v_mfma_f32_16x16x32_bf16 v[60:63], a[112:115], v[164:167], v[60:63]
  v_add_f32 v110, v110, v194
  v_add_f32 v111, v111, v195
  v_mfma_f32_16x16x32_bf16 v[64:67], a[116:119], v[164:167], v[64:67]
  v_add_f32 v112, v112, v196
  v_add_f32 v113, v113, v197
  s_waitcnt vmcnt(7)
  v_mfma_f32_16x16x32_bf16 v[48:51], a[120:123], v[168:171], v[48:51]
  s_add_u32 s19, s19, 4096
  buffer_load_dwordx4 v[136:139], v2, s[60:63], s19 offen offset:0 sc1
  v_add_f32 v114, v114, v198
  v_mfma_f32_16x16x32_bf16 v[52:55], a[124:127], v[168:171], v[52:55]
  v_add_f32 v115, v115, v199
  v_add_f32 v116, v116, v200
  v_mfma_f32_16x16x32_bf16 v[56:59], a[128:131], v[168:171], v[56:59]
  v_add_f32 v117, v117, v201
  v_add_f32 v118, v118, v202
  v_mfma_f32_16x16x32_bf16 v[60:63], a[132:135], v[168:171], v[60:63]
  v_add_f32 v119, v119, v203
  v_add_f32 v120, v120, v204
  v_mfma_f32_16x16x32_bf16 v[64:67], a[136:139], v[168:171], v[64:67]
  v_add_f32 v121, v121, v205
  v_add_f32 v122, v122, v206
  s_waitcnt vmcnt(7)
  v_mfma_f32_16x16x32_bf16 v[48:51], a[140:143], v[172:175], v[48:51]
  buffer_load_dwordx4 v[140:143], v2, s[60:63], s19 offen offset:1024 sc1
  s_mul_i32 s93, s6, 327680
  s_lshl_b32 s12, s5, 7
  s_add_u32 s93, s93, s12
  v_mfma_f32_16x16x32_bf16 v[52:55], a[144:147], v[172:175], v[52:55]
  s_lshr_b32 s12, s7, 1
  s_mul_i32 s94, s12, 5120
  s_add_u32 s94, s94, 143360
  s_lshl_b32 s12, s12, 6
  v_mfma_f32_16x16x32_bf16 v[56:59], a[148:151], v[172:175], v[56:59]
  s_add_u32 s93, s93, s12
  s_add_u32 s93, s93, 19922944
  s_mov_b32 s92, s93
  v_add_f32 v123, v123, v207
  v_mfma_f32_16x16x32_bf16 v[60:63], a[152:155], v[172:175], v[60:63]
  v_add_f32 v124, v124, v208
  v_add_f32 v125, v125, v209
  v_add_f32 v126, v126, v210
  v_add_f32 v127, v127, v211
  v_mfma_f32_16x16x32_bf16 v[64:67], a[156:159], v[172:175], v[64:67]
  s_waitcnt lgkmcnt(0)
  v_add_f32 v108, v108, v212
  v_add_f32 v109, v109, v213
  v_add_f32 v110, v110, v214
  s_waitcnt vmcnt(7)
  v_mfma_f32_16x16x32_bf16 v[48:51], a[160:163], v[176:179], v[48:51]
  buffer_load_dwordx4 v[144:147], v2, s[60:63], s19 offen offset:2048 sc1
  s_and_b32 s12, s7, 1
  s_mul_i32 s13, s12, 196608
  s_add_u32 s93, s93, s13
  s_mul_i32 s13, s12, 3072
  v_mfma_f32_16x16x32_bf16 v[52:55], a[164:167], v[176:179], v[52:55]
  s_add_u32 s95, s94, s13
  s_lshl_b32 s12, s12, 3
  s_add_u32 s94, s94, s12
  v_lshrrev_b32_e64 v252, 2, v1
  v_mfma_f32_16x16x32_bf16 v[56:59], a[168:171], v[176:179], v[56:59]
  v_lshlrev_b32 v252, 12, v252
  v_and_b32 v12, 3, v1
  v_lshl_add_u32 v252, v12, 4, v252
  v_add_f32_e64 v111, v111, v215
  v_mfma_f32_16x16x32_bf16 v[60:63], a[172:175], v[176:179], v[60:63]
  v_add_f32 v112, v112, v216
  v_add_f32 v113, v113, v217
  v_add_f32 v114, v114, v218
  v_add_f32 v115, v115, v219
  v_mfma_f32_16x16x32_bf16 v[64:67], a[176:179], v[176:179], v[64:67]
  v_add_f32 v116, v116, v220
  v_add_f32 v117, v117, v221
  v_add_f32 v118, v118, v222
  v_add_f32 v119, v119, v223
  s_waitcnt vmcnt(7)
  v_mfma_f32_16x16x32_bf16 v[48:51], a[180:183], v[180:183], v[48:51]
  buffer_load_dwordx4 v[148:151], v2, s[60:63], s19 offen offset:3072 sc1
  v_add_f32 v120, v120, v224
  v_mfma_f32_16x16x32_bf16 v[52:55], a[184:187], v[180:183], v[52:55]
  v_add_f32 v121, v121, v225
  v_add_f32 v122, v122, v226
  v_mfma_f32_16x16x32_bf16 v[56:59], a[188:191], v[180:183], v[56:59]
  v_add_f32 v123, v123, v227
  v_add_f32 v124, v124, v228
  v_mfma_f32_16x16x32_bf16 v[60:63], a[192:195], v[180:183], v[60:63]
  v_add_f32 v125, v125, v229
  v_add_f32 v126, v126, v230
  v_mfma_f32_16x16x32_bf16 v[64:67], a[196:199], v[180:183], v[64:67]
  v_add_f32 v127, v127, v231
  s_waitcnt vmcnt(7)
  v_mfma_f32_16x16x32_bf16 v[68:71], a[0:3], v[184:187], v[108:111]
  s_add_u32 s19, s19, 4096
  buffer_load_dwordx4 v[152:155], v2, s[60:63], s19 offen offset:0 sc1
  v_mfma_f32_16x16x32_bf16 v[72:75], a[4:7], v[184:187], v[112:115]
  v_mfma_f32_16x16x32_bf16 v[76:79], a[8:11], v[184:187], v[116:119]
  v_mfma_f32_16x16x32_bf16 v[80:83], a[12:15], v[184:187], v[120:123]
  v_mfma_f32_16x16x32_bf16 v[84:87], a[16:19], v[184:187], v[124:127]
  s_waitcnt vmcnt(7)
  v_mfma_f32_16x16x32_bf16 v[68:71], a[20:23], v[188:191], v[68:71]
  ds_write_b128 v46, v[48:51] offset:0
  v_mfma_f32_16x16x32_bf16 v[72:75], a[24:27], v[188:191], v[72:75]
  ds_write_b128 v46, v[52:55] offset:1024
  v_mfma_f32_16x16x32_bf16 v[76:79], a[28:31], v[188:191], v[76:79]
  buffer_load_dwordx4 v[156:159], v2, s[60:63], s19 offen offset:1024 sc1
  v_mfma_f32_16x16x32_bf16 v[80:83], a[32:35], v[188:191], v[80:83]
  v_mfma_f32_16x16x32_bf16 v[84:87], a[36:39], v[188:191], v[84:87]
  s_waitcnt vmcnt(7)
  v_mfma_f32_16x16x32_bf16 v[68:71], a[40:43], v[128:131], v[68:71]
  ds_write_b128 v46, v[56:59] offset:2048
  v_mfma_f32_16x16x32_bf16 v[72:75], a[44:47], v[128:131], v[72:75]
  ds_write_b128 v46, v[60:63] offset:3072
  v_mfma_f32_16x16x32_bf16 v[76:79], a[48:51], v[128:131], v[76:79]
  s_add_u32 m0, s95, 0
  s_nop 0
  buffer_load_dwordx4 v252, s[52:55], s93 offen sc1 lds
  s_add_u32 s93, s93, 65536
  v_mfma_f32_16x16x32_bf16 v[80:83], a[52:55], v[128:131], v[80:83]
  s_add_u32 m0, s95, 1024
  s_nop 0
  buffer_load_dwordx4 v252, s[52:55], s93 offen sc1 lds
  s_add_u32 s93, s93, 65536
  v_mfma_f32_16x16x32_bf16 v[84:87], a[56:59], v[128:131], v[84:87]
  s_add_u32 m0, s95, 2048
  s_bitcmp1_b32 s7, 0
  s_cselect_b32 s93, 1879048192, s93
  s_cselect_b32 m0, 163840, m0
  s_nop 0
  buffer_load_dwordx4 v252, s[52:55], s93 offen sc1 lds
  s_add_u32 s93, s93, 65536
  s_waitcnt vmcnt(9)
  v_mfma_f32_16x16x32_bf16 v[68:71], a[60:63], v[132:135], v[68:71]
  ds_write_b128 v46, v[64:67] offset:4096
  v_mfma_f32_16x16x32_bf16 v[72:75], a[64:67], v[132:135], v[72:75]
  v_add_u32_e64 v253, s94, v2
  v_mfma_f32_16x16x32_bf16 v[76:79], a[68:71], v[132:135], v[76:79]
  v_mfma_f32_16x16x32_bf16 v[80:83], a[72:75], v[132:135], v[80:83]
  v_mfma_f32_16x16x32_bf16 v[84:87], a[76:79], v[132:135], v[84:87]
  s_waitcnt vmcnt(8)
  v_mfma_f32_16x16x32_bf16 v[68:71], a[80:83], v[136:139], v[68:71]
  s_mul_i32 s15, s7, 5120
  v_mfma_f32_16x16x32_bf16 v[72:75], a[84:87], v[136:139], v[72:75]
  v_add_u32 v47, s15, v2
  v_mfma_f32_16x16x32_bf16 v[76:79], a[88:91], v[136:139], v[76:79]
  v_mfma_f32_16x16x32_bf16 v[80:83], a[92:95], v[136:139], v[80:83]
  v_mfma_f32_16x16x32_bf16 v[84:87], a[96:99], v[136:139], v[84:87]
  s_waitcnt vmcnt(7)
  v_mfma_f32_16x16x32_bf16 v[68:71], a[100:103], v[140:143], v[68:71]
  s_waitcnt lgkmcnt(0)
  s_barrier
  ds_read_b128 v[192:195], v47 offset:0
  v_mfma_f32_16x16x32_bf16 v[72:75], a[104:107], v[140:143], v[72:75]
  ds_read_b128 v[196:199], v47 offset:1024
  v_mfma_f32_16x16x32_bf16 v[76:79], a[108:111], v[140:143], v[76:79]
  ds_read_b128 v[200:203], v47 offset:2048
  v_mfma_f32_16x16x32_bf16 v[80:83], a[112:115], v[140:143], v[80:83]
  ds_read_b128 v[204:207], v47 offset:3072
  v_mfma_f32_16x16x32_bf16 v[84:87], a[116:119], v[140:143], v[84:87]
  ds_read_b128 v[208:211], v47 offset:4096
  s_waitcnt vmcnt(6)
  v_mfma_f32_16x16x32_bf16 v[68:71], a[120:123], v[144:147], v[68:71]
  v_mfma_f32_16x16x32_bf16 v[72:75], a[124:127], v[144:147], v[72:75]
  v_mfma_f32_16x16x32_bf16 v[76:79], a[128:131], v[144:147], v[76:79]
  v_mfma_f32_16x16x32_bf16 v[80:83], a[132:135], v[144:147], v[80:83]
  v_mfma_f32_16x16x32_bf16 v[84:87], a[136:139], v[144:147], v[84:87]
  s_waitcnt vmcnt(5)
  v_mfma_f32_16x16x32_bf16 v[68:71], a[140:143], v[148:151], v[68:71]
  v_mfma_f32_16x16x32_bf16 v[72:75], a[144:147], v[148:151], v[72:75]
  v_mfma_f32_16x16x32_bf16 v[76:79], a[148:151], v[148:151], v[76:79]
  v_mfma_f32_16x16x32_bf16 v[80:83], a[152:155], v[148:151], v[80:83]
  v_mfma_f32_16x16x32_bf16 v[84:87], a[156:159], v[148:151], v[84:87]
  s_waitcnt vmcnt(4)
  v_mfma_f32_16x16x32_bf16 v[68:71], a[160:163], v[152:155], v[68:71]
  v_mfma_f32_16x16x32_bf16 v[72:75], a[164:167], v[152:155], v[72:75]
  v_mfma_f32_16x16x32_bf16 v[76:79], a[168:171], v[152:155], v[76:79]
  v_mfma_f32_16x16x32_bf16 v[80:83], a[172:175], v[152:155], v[80:83]
  v_mfma_f32_16x16x32_bf16 v[84:87], a[176:179], v[152:155], v[84:87]
  s_waitcnt vmcnt(3)
  v_mfma_f32_16x16x32_bf16 v[68:71], a[180:183], v[156:159], v[68:71]
  v_mfma_f32_16x16x32_bf16 v[72:75], a[184:187], v[156:159], v[72:75]
  v_mfma_f32_16x16x32_bf16 v[76:79], a[188:191], v[156:159], v[76:79]
  v_mfma_f32_16x16x32_bf16 v[80:83], a[192:195], v[156:159], v[80:83]
  v_mfma_f32_16x16x32_bf16 v[84:87], a[196:199], v[156:159], v[84:87]
  s_lshl_b32 s12, s5, 15
  s_lshl_b32 s13, s7, 9
  s_add_u32 s12, s12, s13
  s_add_u32 s12, s12, 1310720
  s_lshl_b32 s13, s6, 12
  s_add_u32 s13, s13, s12
  s_waitcnt lgkmcnt(0)
  s_waitcnt vmcnt(0)
  s_barrier
  ds_read_b64_tr_b16 v[232:233], v253 offset:0
  ds_read_b64_tr_b16 v[234:235], v253 offset:1024
  ds_read_b64_tr_b16 v[236:237], v253 offset:2048
  ds_read_b64_tr_b16 v[238:239], v253 offset:3072
  ds_read_b64_tr_b16 v[240:241], v253 offset:4096
  v_accvgpr_read_b32 v244, a243
  v_accvgpr_read_b32 v245, a244
  v_pk_add_f32 v[68:69], v[68:69], v[192:193]
  v_pk_add_f32 v[70:71], v[70:71], v[194:195]
  v_pk_add_f32 v[72:73], v[72:73], v[196:197]
  v_pk_add_f32 v[74:75], v[74:75], v[198:199]
  v_pk_add_f32 v[76:77], v[76:77], v[200:201]
  v_pk_add_f32 v[78:79], v[78:79], v[202:203]
  v_pk_add_f32 v[80:81], v[80:81], v[204:205]
  v_pk_add_f32 v[82:83], v[82:83], v[206:207]
  v_pk_add_f32 v[84:85], v[84:85], v[208:209]
  v_pk_add_f32 v[86:87], v[86:87], v[210:211]
  v_pk_add_f32 v[212:213], v[68:69], v[70:71]
  v_pk_mul_f32 v[214:215], v[68:69], v[68:69]
  v_pk_fma_f32 v[214:215], v[70:71], v[70:71], v[214:215]
  v_pk_add_f32 v[212:213], v[212:213], v[72:73]
  v_pk_fma_f32 v[214:215], v[72:73], v[72:73], v[214:215]
  v_pk_add_f32 v[212:213], v[212:213], v[74:75]
  v_pk_fma_f32 v[214:215], v[74:75], v[74:75], v[214:215]
  v_pk_add_f32 v[212:213], v[212:213], v[76:77]
  v_pk_fma_f32 v[214:215], v[76:77], v[76:77], v[214:215]
  v_pk_add_f32 v[212:213], v[212:213], v[78:79]
  v_pk_fma_f32 v[214:215], v[78:79], v[78:79], v[214:215]
  v_pk_add_f32 v[212:213], v[212:213], v[80:81]
  v_pk_fma_f32 v[214:215], v[80:81], v[80:81], v[214:215]
  v_pk_add_f32 v[212:213], v[212:213], v[82:83]
  v_pk_fma_f32 v[214:215], v[82:83], v[82:83], v[214:215]
  v_pk_add_f32 v[212:213], v[212:213], v[84:85]
  v_pk_fma_f32 v[214:215], v[84:85], v[84:85], v[214:215]
  v_pk_add_f32 v[212:213], v[212:213], v[86:87]
  v_pk_fma_f32 v[214:215], v[86:87], v[86:87], v[214:215]
  s_waitcnt lgkmcnt(0)
  v_pk_max_u16 v15, v232, v233
  v_pk_max_u16 v15, v15, v234
  v_pk_max_u16 v15, v15, v235
  v_pk_max_u16 v15, v15, v236
  v_pk_max_u16 v15, v15, v237
  v_pk_max_u16 v15, v15, v238
  v_pk_max_u16 v15, v15, v239
  v_pk_max_u16 v15, v15, v240
  v_pk_max_u16 v15, v15, v241
  v_lshlrev_b32 v14, 16, v15
  v_max_u32 v15, v15, v14
  v_cmp_le_u32 vcc, 0xffff0000, v15
  s_cbranch_vccnz again_49
ok_50:
  v_lshlrev_b32 v88, 16, v232
  v_and_b32 v89, 0xffff0000, v232
  v_lshlrev_b32_e64 v90, 16, v233
  v_and_b32 v91, 0xffff0000, v233
  s_add_u32 m0, s75, 0
  s_add_u32 s14, s74, 0
  buffer_load_dwordx4 v244, s[56:59], s14 offen lds
  buffer_load_dwordx4 v245, s[56:59], s14 offen offset:2048 lds
  v_pk_mul_f32 v[160:161], v[68:69], v[88:89]
  v_pk_mul_f32 v[226:227], v[88:89], v[88:89]
  v_pk_mul_f32 v[218:219], v[160:161], v[68:69]
  v_pk_mul_f32 v[220:221], v[160:161], v[160:161]
  v_pk_mul_f32 v[222:223], v[160:161], v[88:89]
  v_pk_mul_f32 v[162:163], v[70:71], v[90:91]
  v_pk_add_f32 v[224:225], v[88:89], v[90:91]
  v_pk_fma_f32 v[226:227], v[90:91], v[90:91], v[226:227]
  v_pk_add_f32 v[216:217], v[160:161], v[162:163]
  v_pk_fma_f32 v[218:219], v[162:163], v[70:71], v[218:219]
  v_pk_fma_f32 v[220:221], v[162:163], v[162:163], v[220:221]
  v_pk_fma_f32 v[222:223], v[162:163], v[90:91], v[222:223]
  v_lshlrev_b32_e64 v92, 16, v234
  v_and_b32 v93, 0xffff0000, v234
  v_lshlrev_b32_e64 v94, 16, v235
  v_and_b32 v95, 0xffff0000, v235
  v_pk_mul_f32 v[164:165], v[72:73], v[92:93]
  v_pk_add_f32 v[224:225], v[224:225], v[92:93]
  v_pk_fma_f32 v[226:227], v[92:93], v[92:93], v[226:227]
  v_pk_add_f32 v[216:217], v[216:217], v[164:165]
  v_pk_fma_f32 v[218:219], v[164:165], v[72:73], v[218:219]
  v_pk_fma_f32 v[220:221], v[164:165], v[164:165], v[220:221]
  v_pk_fma_f32 v[222:223], v[164:165], v[92:93], v[222:223]
  v_pk_mul_f32 v[166:167], v[74:75], v[94:95]
  v_pk_add_f32 v[224:225], v[224:225], v[94:95]
  v_pk_fma_f32 v[226:227], v[94:95], v[94:95], v[226:227]
  v_pk_add_f32 v[216:217], v[216:217], v[166:167]
  v_pk_fma_f32 v[218:219], v[166:167], v[74:75], v[218:219]
  v_pk_fma_f32 v[220:221], v[166:167], v[166:167], v[220:221]
  v_pk_fma_f32 v[222:223], v[166:167], v[94:95], v[222:223]
  v_lshlrev_b32_e64 v96, 16, v236
  v_and_b32 v97, 0xffff0000, v236
  v_lshlrev_b32_e64 v98, 16, v237
  v_and_b32 v99, 0xffff0000, v237
  s_add_u32 m0, s75, 4096
  s_add_u32 s14, s74, 20480
  buffer_load_dwordx4 v244, s[56:59], s14 offen lds
  buffer_load_dwordx4 v245, s[56:59], s14 offen offset:2048 lds
  v_pk_mul_f32 v[168:169], v[76:77], v[96:97]
  v_pk_add_f32 v[224:225], v[224:225], v[96:97]
  v_pk_fma_f32 v[226:227], v[96:97], v[96:97], v[226:227]
  v_pk_add_f32 v[216:217], v[216:217], v[168:169]
  v_pk_fma_f32 v[218:219], v[168:169], v[76:77], v[218:219]
  v_pk_fma_f32 v[220:221], v[168:169], v[168:169], v[220:221]
  v_pk_fma_f32 v[222:223], v[168:169], v[96:97], v[222:223]
  v_pk_mul_f32 v[170:171], v[78:79], v[98:99]
  v_pk_add_f32 v[224:225], v[224:225], v[98:99]
  v_pk_fma_f32 v[226:227], v[98:99], v[98:99], v[226:227]
  v_pk_add_f32 v[216:217], v[216:217], v[170:171]
  v_pk_fma_f32 v[218:219], v[170:171], v[78:79], v[218:219]
  v_pk_fma_f32 v[220:221], v[170:171], v[170:171], v[220:221]
  v_pk_fma_f32 v[222:223], v[170:171], v[98:99], v[222:223]
  v_lshlrev_b32_e64 v100, 16, v238
  v_and_b32 v101, 0xffff0000, v238
  v_lshlrev_b32_e64 v102, 16, v239
  v_and_b32 v103, 0xffff0000, v239
  v_pk_mul_f32 v[172:173], v[80:81], v[100:101]
  v_pk_add_f32 v[224:225], v[224:225], v[100:101]
  v_pk_fma_f32 v[226:227], v[100:101], v[100:101], v[226:227]
  v_pk_add_f32 v[216:217], v[216:217], v[172:173]
  v_pk_fma_f32 v[218:219], v[172:173], v[80:81], v[218:219]
  v_pk_fma_f32 v[220:221], v[172:173], v[172:173], v[220:221]
  v_pk_fma_f32 v[222:223], v[172:173], v[100:101], v[222:223]
  v_pk_mul_f32 v[174:175], v[82:83], v[102:103]
  v_pk_add_f32 v[224:225], v[224:225], v[102:103]
  v_pk_fma_f32 v[226:227], v[102:103], v[102:103], v[226:227]
  v_pk_add_f32 v[216:217], v[216:217], v[174:175]
  v_pk_fma_f32 v[218:219], v[174:175], v[82:83], v[218:219]
  v_pk_fma_f32 v[220:221], v[174:175], v[174:175], v[220:221]
  v_pk_fma_f32 v[222:223], v[174:175], v[102:103], v[222:223]
  v_lshlrev_b32_e64 v104, 16, v240
  v_and_b32 v105, 0xffff0000, v240
  v_lshlrev_b32_e64 v106, 16, v241
  v_and_b32 v107, 0xffff0000, v241
  s_add_u32 m0, s75, 8192
  s_add_u32 s14, s74, 40960
  buffer_load_dwordx4 v244, s[56:59], s14 offen lds
  v_pk_mul_f32 v[176:177], v[84:85], v[104:105]
  v_pk_add_f32 v[224:225], v[224:225], v[104:105]
  v_pk_fma_f32 v[226:227], v[104:105], v[104:105], v[226:227]
  v_pk_add_f32 v[216:217], v[216:217], v[176:177]
  v_pk_fma_f32 v[218:219], v[176:177], v[84:85], v[218:219]
  v_pk_fma_f32 v[220:221], v[176:177], v[176:177], v[220:221]
  v_pk_fma_f32 v[222:223], v[176:177], v[104:105], v[222:223]
  v_pk_mul_f32 v[178:179], v[86:87], v[106:107]
  v_pk_add_f32 v[224:225], v[224:225], v[106:107]
  v_pk_fma_f32 v[226:227], v[106:107], v[106:107], v[226:227]
  v_pk_add_f32 v[216:217], v[216:217], v[178:179]
  v_pk_fma_f32 v[218:219], v[178:179], v[86:87], v[218:219]
  v_pk_fma_f32 v[220:221], v[178:179], v[178:179], v[220:221]
  v_pk_fma_f32 v[222:223], v[178:179], v[106:107], v[222:223]
  v_add_f32 v212, v212, v213
  v_add_f32 v214, v214, v215
  v_add_f32 v216, v216, v217
  v_add_f32 v218, v218, v219
  v_add_f32 v220, v220, v221
  v_add_f32 v222, v222, v223
  v_add_f32 v224, v224, v225
  v_add_f32 v226, v226, v227
  v_permlane16_swap_b32 v212, v220
  v_permlane16_swap_b32 v214, v222
  v_permlane16_swap_b32 v216, v224
  v_permlane16_swap_b32 v218, v226
  v_add_f32 v228, v212, v220
  v_add_f32 v229, v214, v222
  v_add_f32 v230, v216, v224
  v_add_f32 v231, v218, v226
  v_mov_b32 v212, v228
  v_mov_b32 v213, v229
  v_mov_b32 v214, v230
  v_mov_b32 v215, v231
  v_permlane32_swap_b32 v228, v212
  v_permlane32_swap_b32 v229, v213
  v_permlane32_swap_b32 v230, v214
  v_permlane32_swap_b32 v231, v215
  s_movk_i32 s14, 0xff
  v_add_f32 v228, v228, v212
  v_add_f32 v229, v229, v213
  v_add_f32 v230, v230, v214
  v_add_f32 v231, v231, v215
  s_lshr_b32 s15, s8, 0
  v_mov_b32_e64 v212, s15
  v_bfi_b32 v228, s14, v212, v228
  s_lshr_b32 s15, s8, 8
  v_mov_b32 v213, s15
  v_bfi_b32 v229, s14, v213, v229
  s_lshr_b32 s15, s8, 16
  v_mov_b32 v214, s15
  v_bfi_b32 v230, s14, v214, v230
  s_lshr_b32 s15, s8, 24
  v_mov_b32 v215, s15
  v_bfi_b32 v231, s14, v215, v231
  s_mov_b32 exec_hi, 0
  s_cmp_eq_u32 s9, 0
  s_cbranch_scc1 slow_51
  buffer_store_dwordx4 v[228:231], v2, s[52:55], s13 offen
back_52:
  s_mov_b32 exec_hi, -1
  v_accvgpr_write_b32 a200, v232
  v_accvgpr_write_b32 a201, v233
  v_accvgpr_write_b32 a202, v234
  v_accvgpr_write_b32 a203, v235
  v_accvgpr_write_b32 a204, v236
  v_accvgpr_write_b32 a205, v237
  v_accvgpr_write_b32 a206, v238
  v_accvgpr_write_b32 a207, v239
  v_accvgpr_write_b32 a208, v240
  v_accvgpr_write_b32 a209, v241
  v_lshrrev_b32_e64 v11, 2, v3
  v_mul_u32_u24 v11, 5120, v11
  v_and_b32_e64 v12, 3, v3
  v_lshl_add_u32 v11, v12, 4, v11
  v_lshrrev_b32_e64 v12, 1, v4
  v_lshl_add_u32 v11, v12, 6, v11
  v_and_b32_e64 v12, 1, v4
  v_lshl_add_u32 v47, v12, 3, v11
  s_lshl_b32 s88, s5, 2
  s_add_u32 s88, s88, s7
  s_mul_i32 s88, s88, 20480
  s_mul_i32 s14, s6, 640
  s_add_u32 s88, s88, s14
  s_add_u32 s88, s88, 4194304
  v_accvgpr_read_b32 v190, a230
  v_accvgpr_read_b32 v191, a231
  v_accvgpr_read_b32 v192, a232
  v_accvgpr_read_b32 v193, a233
  v_accvgpr_read_b32 v194, a234
  v_accvgpr_read_b32 v195, a235
  v_accvgpr_read_b32 v196, a236
  v_accvgpr_read_b32 v197, a237
  v_accvgpr_read_b32 v198, a238
  v_accvgpr_read_b32 v199, a239
  v_lshlrev_b32 v108, 16, v190
  v_and_b32 v109, 0xffff0000, v190
  v_lshlrev_b32_e64 v110, 16, v191
  v_and_b32 v111, 0xffff0000, v191
  v_lshlrev_b32_e64 v112, 16, v192
  v_and_b32 v113, 0xffff0000, v192
  v_lshlrev_b32_e64 v114, 16, v193
  v_and_b32 v115, 0xffff0000, v193
  v_lshlrev_b32_e64 v116, 16, v194
  v_and_b32 v117, 0xffff0000, v194
  v_lshlrev_b32_e64 v118, 16, v195
  v_and_b32 v119, 0xffff0000, v195
  v_lshlrev_b32_e64 v120, 16, v196
  v_and_b32 v121, 0xffff0000, v196
  v_lshlrev_b32_e64 v122, 16, v197
  v_and_b32 v123, 0xffff0000, v197
  v_lshlrev_b32_e64 v124, 16, v198
  v_and_b32 v125, 0xffff0000, v198
  v_lshlrev_b32_e64 v126, 16, v199
  v_and_b32 v127, 0xffff0000, v199
  s_lshl_b32 s87, s3, 10
  s_lshr_b32 s13, s7, 1
  s_lshl_b32 s13, s13, 7
  s_add_u32 s87, s87, s13
  s_and_b32 s13, s7, 1
  s_lshl_b32 s13, s13, 3
  s_add_u32 s87, s87, s13
  s_add_u32 s87, s87, 4096
  v_and_b32 v46, 7, v1
  v_lshlrev_b32_e64 v46, 4, v46
  s_add_u32 s34, s76, 4194304
  s_add_u32 s35, s34, 20480
  s_lshl_b32 s44, s5, 5
  s_lshl_b32 s13, s6, 2
  s_add_u32 s44, s44, s13
  s_add_u32 s44, s44, s7
  v_and_b32 v11, 31, v1
  v_lshlrev_b32 v11, 4, v11
  v_lshrrev_b32_e64 v12, 5, v1
  v_lshl_add_u32 v11, v12, 14, v11
  s_mov_b32 s14, 0x0c0c0400
  s_mov_b32 s15, 0x04000c0c
  s_add_u32 s89, s12, 4096
  s_add_u32 s90, s12, 8192
  s_add_u32 s91, s12, 12288
stpoll_53:
  buffer_load_dwordx4 v[128:131], v11, s[52:55], s12 offen sc1
  buffer_load_dwordx4 v[132:135], v11, s[52:55], s89 offen sc1
  buffer_load_dwordx4 v[136:139], v11, s[52:55], s90 offen sc1
  buffer_load_dwordx4 v[140:143], v11, s[52:55], s91 offen sc1
  s_waitcnt vmcnt(0)
  v_perm_b32 v212, v129, v128, s14
  v_perm_b32 v213, v131, v130, s15
  v_perm_b32 v214, v133, v132, s14
  v_perm_b32 v215, v135, v134, s15
  v_perm_b32 v216, v137, v136, s14
  v_perm_b32 v217, v139, v138, s15
  v_perm_b32 v218, v141, v140, s14
  v_perm_b32 v219, v143, v142, s15
  v_or_b32 v212, v212, v213
  v_or_b32 v214, v214, v215
  v_or_b32 v216, v216, v217
  v_or_b32_e64 v218, v218, v219
  v_min3_u32 v13, v212, v214, s8
  v_max3_u32 v14, v212, v214, s8
  v_min3_u32 v13, v13, v216, v218
  v_max3_u32 v14, v14, v216, v218
  v_cmp_ne_u32 vcc, v13, v14
  s_sub_u32 s10, s10, 1
  s_cmp_gt_i32 s10, 0
  s_cbranch_scc0 giveup_55
  s_cbranch_vccnz stpoll_53
giveup_55:
  v_pk_add_f32 v[128:129], v[128:129], v[132:133]
  v_pk_add_f32 v[136:137], v[136:137], v[140:141]
  v_pk_add_f32 v[130:131], v[130:131], v[134:135]
  v_pk_add_f32 v[138:139], v[138:139], v[142:143]
  v_pk_add_f32 v[128:129], v[128:129], v[136:137]
  v_pk_add_f32 v[130:131], v[130:131], v[138:139]
  v_mov_b32 v132, v128
  v_mov_b32 v133, v129
  v_mov_b32 v134, v130
  v_mov_b32 v135, v131
  v_permlane32_swap_b32 v128, v132
  v_permlane32_swap_b32 v129, v133
  v_permlane32_swap_b32 v130, v134
  v_permlane32_swap_b32 v131, v135
  v_add_f32 v212, v128, v132
  v_add_f32 v213, v129, v133
  v_add_f32 v214, v130, v134
  v_add_f32 v215, v131, v135
  v_mov_b32 v216, v212
  v_mov_b32 v217, v213
  v_mov_b32 v218, v214
  v_mov_b32 v219, v215
  v_permlane16_swap_b32 v212, v216
  v_permlane16_swap_b32 v213, v217
  v_permlane16_swap_b32 v214, v218
  v_permlane16_swap_b32 v215, v219
  v_mul_f32 v200, 0x3acccccd, v212
  v_mul_f32 v204, 0x3acccccd, v213
  v_fma_f32 v204, -v200, v200, v204
  v_max_f32 v204, 0, v204
  v_add_f32 v204, 0x3727c5ac, v204
  v_rsq_f32 v202, v204
  s_nop 0
  v_mul_f32_e64 v203, v200, v202
  v_fma_f32 v204, v202, v214, v212
  v_fma_f32 v204, -v203, v218, v204
  v_mul_f32_e64 v205, v202, v216
  v_fma_f32 v205, 2.0, v215, v205
  v_fma_f32 v205, v202, v205, v213
  v_fma_f32 v214, v202, v217, v214
  v_mul_f32_e64 v219, v203, v219
  v_fma_f32 v214, -2.0, v214, v219
  v_fma_f32 v205, v203, v214, v205
  v_mul_f32 v204, 0x3acccccd, v204
  v_mul_f32 v205, 0x3acccccd, v205
  v_fma_f32 v205, -v204, v204, v205
  v_max_f32_e64 v205, 0, v205
  v_add_f32 v205, 0x3727c5ac, v205
  v_rsq_f32 v206, v205
  s_nop 0
  v_mul_f32_e64 v207, v204, v206
  v_pk_fma_f32 v[160:161], v[68:69], v[202:203], v[202:203] op_sel:[0,0,1] op_sel_hi:[1,0,1] neg_lo:[0,0,1] neg_hi:[0,0,1]
  v_pk_fma_f32 v[162:163], v[70:71], v[202:203], v[202:203] op_sel:[0,0,1] op_sel_hi:[1,0,1] neg_lo:[0,0,1] neg_hi:[0,0,1]
  v_pk_fma_f32 v[164:165], v[72:73], v[202:203], v[202:203] op_sel:[0,0,1] op_sel_hi:[1,0,1] neg_lo:[0,0,1] neg_hi:[0,0,1]
  v_pk_fma_f32 v[166:167], v[74:75], v[202:203], v[202:203] op_sel:[0,0,1] op_sel_hi:[1,0,1] neg_lo:[0,0,1] neg_hi:[0,0,1]
  v_pk_fma_f32 v[168:169], v[76:77], v[202:203], v[202:203] op_sel:[0,0,1] op_sel_hi:[1,0,1] neg_lo:[0,0,1] neg_hi:[0,0,1]
  v_pk_fma_f32 v[170:171], v[78:79], v[202:203], v[202:203] op_sel:[0,0,1] op_sel_hi:[1,0,1] neg_lo:[0,0,1] neg_hi:[0,0,1]
  v_pk_fma_f32 v[172:173], v[80:81], v[202:203], v[202:203] op_sel:[0,0,1] op_sel_hi:[1,0,1] neg_lo:[0,0,1] neg_hi:[0,0,1]
  v_pk_fma_f32 v[174:175], v[82:83], v[202:203], v[202:203] op_sel:[0,0,1] op_sel_hi:[1,0,1] neg_lo:[0,0,1] neg_hi:[0,0,1]
  v_pk_fma_f32 v[176:177], v[84:85], v[202:203], v[202:203] op_sel:[0,0,1] op_sel_hi:[1,0,1] neg_lo:[0,0,1] neg_hi:[0,0,1]
  v_pk_fma_f32 v[178:179], v[86:87], v[202:203], v[202:203] op_sel:[0,0,1] op_sel_hi:[1,0,1] neg_lo:[0,0,1] neg_hi:[0,0,1]
  v_pk_fma_f32 v[68:69], v[160:161], v[88:89], v[68:69]
  v_pk_fma_f32 v[70:71], v[162:163], v[90:91], v[70:71]
  v_pk_fma_f32 v[72:73], v[164:165], v[92:93], v[72:73]
  v_pk_fma_f32 v[74:75], v[166:167], v[94:95], v[74:75]
  v_pk_fma_f32 v[76:77], v[168:169], v[96:97], v[76:77]
  v_pk_fma_f32 v[78:79], v[170:171], v[98:99], v[78:79]
  v_pk_fma_f32 v[80:81], v[172:173], v[100:101], v[80:81]
  v_pk_fma_f32 v[82:83], v[174:175], v[102:103], v[82:83]
  v_pk_fma_f32 v[84:85], v[176:177], v[104:105], v[84:85]
  v_pk_fma_f32 v[86:87], v[178:179], v[106:107], v[86:87]
  v_pk_fma_f32 v[160:161], v[68:69], v[206:207], v[206:207] op_sel:[0,0,1] op_sel_hi:[1,0,1] neg_lo:[0,0,1] neg_hi:[0,0,1]
  v_pk_fma_f32 v[162:163], v[70:71], v[206:207], v[206:207] op_sel:[0,0,1] op_sel_hi:[1,0,1] neg_lo:[0,0,1] neg_hi:[0,0,1]
  v_pk_fma_f32 v[164:165], v[72:73], v[206:207], v[206:207] op_sel:[0,0,1] op_sel_hi:[1,0,1] neg_lo:[0,0,1] neg_hi:[0,0,1]
  v_pk_fma_f32 v[166:167], v[74:75], v[206:207], v[206:207] op_sel:[0,0,1] op_sel_hi:[1,0,1] neg_lo:[0,0,1] neg_hi:[0,0,1]
  v_pk_fma_f32 v[168:169], v[76:77], v[206:207], v[206:207] op_sel:[0,0,1] op_sel_hi:[1,0,1] neg_lo:[0,0,1] neg_hi:[0,0,1]
  v_pk_fma_f32 v[170:171], v[78:79], v[206:207], v[206:207] op_sel:[0,0,1] op_sel_hi:[1,0,1] neg_lo:[0,0,1] neg_hi:[0,0,1]
  v_pk_fma_f32 v[172:173], v[80:81], v[206:207], v[206:207] op_sel:[0,0,1] op_sel_hi:[1,0,1] neg_lo:[0,0,1] neg_hi:[0,0,1]
  v_pk_fma_f32 v[174:175], v[82:83], v[206:207], v[206:207] op_sel:[0,0,1] op_sel_hi:[1,0,1] neg_lo:[0,0,1] neg_hi:[0,0,1]
  v_pk_fma_f32 v[176:177], v[84:85], v[206:207], v[206:207] op_sel:[0,0,1] op_sel_hi:[1,0,1] neg_lo:[0,0,1] neg_hi:[0,0,1]
  v_pk_fma_f32 v[178:179], v[86:87], v[206:207], v[206:207] op_sel:[0,0,1] op_sel_hi:[1,0,1] neg_lo:[0,0,1] neg_hi:[0,0,1]
  v_cvt_pk_bf16_f32 v180, v160, v161
  v_cvt_pk_bf16_f32 v181, v162, v163
  v_cvt_pk_bf16_f32 v182, v164, v165
  v_cvt_pk_bf16_f32 v183, v166, v167
  v_cvt_pk_bf16_f32 v184, v168, v169
  v_cvt_pk_bf16_f32 v185, v170, v171
  v_cvt_pk_bf16_f32 v186, v172, v173
  v_cvt_pk_bf16_f32 v187, v174, v175
  v_cvt_pk_bf16_f32 v188, v176, v177
  v_cvt_pk_bf16_f32 v189, v178, v179
  buffer_store_dwordx2 v[180:181], v47, s[52:55], s88 offen offset:0 sc1
  buffer_store_dwordx2 v[182:183], v47, s[52:55], s88 offen offset:128 sc1
  buffer_store_dwordx2 v[184:185], v47, s[52:55], s88 offen offset:256 sc1
  buffer_store_dwordx2 v[186:187], v47, s[52:55], s88 offen offset:384 sc1
  buffer_store_dwordx2 v[188:189], v47, s[52:55], s88 offen offset:512 sc1
  v_pk_fma_f32 v[68:69], v[160:161], v[108:109], v[68:69]
  v_pk_fma_f32 v[70:71], v[162:163], v[110:111], v[70:71]
  v_pk_fma_f32 v[72:73], v[164:165], v[112:113], v[72:73]
  v_pk_fma_f32 v[74:75], v[166:167], v[114:115], v[74:75]
  v_pk_fma_f32 v[76:77], v[168:169], v[116:117], v[76:77]
  v_pk_fma_f32 v[78:79], v[170:171], v[118:119], v[78:79]
  v_pk_fma_f32 v[80:81], v[172:173], v[120:121], v[80:81]
  v_pk_fma_f32 v[82:83], v[174:175], v[122:123], v[82:83]
  v_pk_fma_f32 v[84:85], v[176:177], v[124:125], v[84:85]
  v_pk_fma_f32 v[86:87], v[178:179], v[126:127], v[86:87]
  v_accvgpr_write_b32 a210, v68
  v_accvgpr_write_b32 a211, v69
  v_accvgpr_write_b32 a212, v70
  v_accvgpr_write_b32 a213, v71
  v_accvgpr_write_b32 a214, v72
  v_accvgpr_write_b32 a215, v73
  v_accvgpr_write_b32 a216, v74
  v_accvgpr_write_b32 a217, v75
  v_accvgpr_write_b32 a218, v76
  v_accvgpr_write_b32 a219, v77
  v_accvgpr_write_b32 a220, v78
  v_accvgpr_write_b32 a221, v79
  v_accvgpr_write_b32 a222, v80
  v_accvgpr_write_b32 a223, v81
  v_accvgpr_write_b32 a224, v82
  v_accvgpr_write_b32 a225, v83
  v_accvgpr_write_b32 a226, v84
  v_accvgpr_write_b32 a227, v85
  v_accvgpr_write_b32 a228, v86
  v_accvgpr_write_b32 a229, v87
  s_add_u32 s13, s84, 4096
  s_waitcnt vmcnt(0)
  v_mov_b32 v15, s8
  s_mov_b64 exec, 1
  s_cmp_eq_u32 s9, 0
  s_cbranch_scc1 slow_56
  buffer_store_dword v15, off, s[52:55], s13
back_57:
  s_mov_b64 exec, -1
  s_cmp_lg_u32 s44, 992
  s_cbranch_scc1 skip_58
  v_mov_b32 v15, s8
  s_mov_b64 exec, 1
  buffer_store_dword v15, off, s[52:55], 0 sc1
  s_mov_b64 exec, -1
skip_58:
again_59:
  buffer_load_dwordx2 v[42:43], v46, s[52:55], s87 offen sc1
  s_sub_u32 s10, s10, 1
  s_cmp_gt_i32 s10, 0
  s_waitcnt vmcnt(0)
  v_xor_b32 v15, s8, v42
  v_xor_b32 v14, s8, v43
  v_or_b32 v15, v15, v14
  v_cmp_ne_u32 vcc, 0, v15
  s_cbranch_scc0 out_61
  s_cbranch_vccnz again_59
out_61:
ok_60:
  buffer_load_dwordx4 v[128:131], v0, s[52:55], s34 offen offset:1024 sc1
  buffer_load_dwordx4 v[132:135], v0, s[52:55], s35 offen offset:1024 sc1
  buffer_load_dwordx4 v[136:139], v0, s[52:55], s34 offen offset:1280 sc1
  buffer_load_dwordx4 v[140:143], v0, s[52:55], s35 offen offset:1280 sc1
  buffer_load_dwordx4 v[144:147], v0, s[52:55], s34 offen offset:1536 sc1
  buffer_load_dwordx4 v[148:151], v0, s[52:55], s35 offen offset:1536 sc1
  buffer_load_dwordx4 v[152:155], v0, s[52:55], s34 offen offset:1792 sc1
  buffer_load_dwordx4 v[156:159], v0, s[52:55], s35 offen offset:1792 sc1
  ds_read_b128 v[88:91], v5 offset:20480
  ds_read_b128 v[92:95], v5 offset:22528
  ds_read_b128 v[96:99], v5 offset:24576
  ds_read_b128 v[100:103], v5 offset:26624
  ds_read_b128 v[104:107], v5 offset:28672
  s_waitcnt vmcnt(6)
  s_waitcnt lgkmcnt(4)
  v_mfma_f32_16x16x32_bf16 v[48:51], v[128:131], v[88:91], 0
  ds_read_b128 v[108:111], v6 offset:20480
  v_mfma_f32_16x16x32_bf16 v[52:55], v[132:135], v[88:91], 0
  buffer_load_dwordx4 v[160:163], v0, s[52:55], s34 offen offset:2048 sc1
  s_waitcnt lgkmcnt(4)
  v_mfma_f32_16x16x32_bf16 v[56:59], v[128:131], v[92:95], 0
  ds_read_b128 v[112:115], v6 offset:22528
  v_mfma_f32_16x16x32_bf16 v[60:63], v[132:135], v[92:95], 0
  buffer_load_dwordx4 v[164:167], v0, s[52:55], s35 offen offset:2048 sc1
  s_waitcnt lgkmcnt(4)
  v_mfma_f32_16x16x32_bf16 v[64:67], v[128:131], v[96:99], 0
  ds_read_b128 v[116:119], v6 offset:24576
  v_mfma_f32_16x16x32_bf16 v[68:71], v[132:135], v[96:99], 0
  s_waitcnt lgkmcnt(4)
  v_mfma_f32_16x16x32_bf16 v[72:75], v[128:131], v[100:103], 0
  ds_read_b128 v[120:123], v6 offset:26624
  v_mfma_f32_16x16x32_bf16 v[76:79], v[132:135], v[100:103], 0
  s_waitcnt lgkmcnt(4)
  v_mfma_f32_16x16x32_bf16 v[80:83], v[128:131], v[104:107], 0
  ds_read_b128 v[124:127], v6 offset:28672
  v_mfma_f32_16x16x32_bf16 v[84:87], v[132:135], v[104:107], 0
  s_waitcnt vmcnt(6)
  s_waitcnt lgkmcnt(2)
  v_mfma_f32_16x16x32_bf16 v[48:51], v[136:139], v[108:111], v[48:51]
  ds_read_b128 v[88:91], v5 offset:30720
  v_mfma_f32_16x16x32_bf16 v[52:55], v[140:143], v[108:111], v[52:55]
  buffer_load_dwordx4 v[168:171], v0, s[52:55], s34 offen offset:2304 sc1
  v_mfma_f32_16x16x32_bf16 v[56:59], v[136:139], v[112:115], v[56:59]
  ds_read_b128 v[92:95], v5 offset:32768
  v_mfma_f32_16x16x32_bf16 v[60:63], v[140:143], v[112:115], v[60:63]
  buffer_load_dwordx4 v[172:175], v0, s[52:55], s35 offen offset:2304 sc1
  v_mfma_f32_16x16x32_bf16 v[64:67], v[136:139], v[116:119], v[64:67]
  ds_read_b128 v[96:99], v5 offset:34816
  v_mfma_f32_16x16x32_bf16 v[68:71], v[140:143], v[116:119], v[68:71]
  s_waitcnt lgkmcnt(3)
  v_mfma_f32_16x16x32_bf16 v[72:75], v[136:139], v[120:123], v[72:75]
  ds_read_b128 v[100:103], v5 offset:36864
  v_mfma_f32_16x16x32_bf16 v[76:79], v[140:143], v[120:123], v[76:79]
  v_mfma_f32_16x16x32_bf16 v[80:83], v[136:139], v[124:127], v[80:83]
  ds_read_b128 v[104:107], v5 offset:38912
  v_mfma_f32_16x16x32_bf16 v[84:87], v[140:143], v[124:127], v[84:87]
  s_waitcnt vmcnt(6)
  s_waitcnt lgkmcnt(2)
  v_mfma_f32_16x16x32_bf16 v[48:51], v[144:147], v[88:91], v[48:51]
  ds_read_b128 v[108:111], v6 offset:30720
  v_mfma_f32_16x16x32_bf16 v[52:55], v[148:151], v[88:91], v[52:55]
  buffer_load_dwordx4 v[176:179], v0, s[52:55], s34 offen offset:2560 sc1
  v_mfma_f32_16x16x32_bf16 v[56:59], v[144:147], v[92:95], v[56:59]
  ds_read_b128 v[112:115], v6 offset:32768
  v_mfma_f32_16x16x32_bf16 v[60:63], v[148:151], v[92:95], v[60:63]
  buffer_load_dwordx4 v[180:183], v0, s[52:55], s35 offen offset:2560 sc1
  v_mfma_f32_16x16x32_bf16 v[64:67], v[144:147], v[96:99], v[64:67]
  ds_read_b128 v[116:119], v6 offset:34816
  v_mfma_f32_16x16x32_bf16 v[68:71], v[148:151], v[96:99], v[68:71]
  s_waitcnt lgkmcnt(3)
  v_mfma_f32_16x16x32_bf16 v[72:75], v[144:147], v[100:103], v[72:75]
  ds_read_b128 v[120:123], v6 offset:36864
  v_mfma_f32_16x16x32_bf16 v[76:79], v[148:151], v[100:103], v[76:79]
  v_mfma_f32_16x16x32_bf16 v[80:83], v[144:147], v[104:107], v[80:83]
  ds_read_b128 v[124:127], v6 offset:38912
  v_mfma_f32_16x16x32_bf16 v[84:87], v[148:151], v[104:107], v[84:87]
  s_waitcnt vmcnt(6)
  s_waitcnt lgkmcnt(2)
  v_mfma_f32_16x16x32_bf16 v[48:51], v[152:155], v[108:111], v[48:51]
  ds_read_b128 v[88:91], v5 offset:40960
  v_mfma_f32_16x16x32_bf16 v[52:55], v[156:159], v[108:111], v[52:55]
  buffer_load_dwordx4 v[184:187], v0, s[52:55], s34 offen offset:2816 sc1
  v_mfma_f32_16x16x32_bf16 v[56:59], v[152:155], v[112:115], v[56:59]
  ds_read_b128 v[92:95], v5 offset:43008
  v_mfma_f32_16x16x32_bf16 v[60:63], v[156:159], v[112:115], v[60:63]
  buffer_load_dwordx4 v[188:191], v0, s[52:55], s35 offen offset:2816 sc1
  v_mfma_f32_16x16x32_bf16 v[64:67], v[152:155], v[116:119], v[64:67]
  ds_read_b128 v[96:99], v5 offset:45056
  v_mfma_f32_16x16x32_bf16 v[68:71], v[156:159], v[116:119], v[68:71]
  s_waitcnt lgkmcnt(3)
  v_mfma_f32_16x16x32_bf16 v[72:75], v[152:155], v[120:123], v[72:75]
  ds_read_b128 v[100:103], v5 offset:47104
  v_mfma_f32_16x16x32_bf16 v[76:79], v[156:159], v[120:123], v[76:79]
  v_mfma_f32_16x16x32_bf16 v[80:83], v[152:155], v[124:127], v[80:83]
  ds_read_b128 v[104:107], v5 offset:49152
  v_mfma_f32_16x16x32_bf16 v[84:87], v[156:159], v[124:127], v[84:87]
  s_waitcnt vmcnt(6)
  s_waitcnt lgkmcnt(2)
  v_mfma_f32_16x16x32_bf16 v[48:51], v[160:163], v[88:91], v[48:51]
  ds_read_b128 v[108:111], v6 offset:40960
  v_mfma_f32_16x16x32_bf16 v[52:55], v[164:167], v[88:91], v[52:55]
  buffer_load_dwordx4 v[128:131], v0, s[52:55], s34 offen offset:3072 sc1
  v_mfma_f32_16x16x32_bf16 v[56:59], v[160:163], v[92:95], v[56:59]
  ds_read_b128 v[112:115], v6 offset:43008
  v_mfma_f32_16x16x32_bf16 v[60:63], v[164:167], v[92:95], v[60:63]
  buffer_load_dwordx4 v[132:135], v0, s[52:55], s35 offen offset:3072 sc1
  v_mfma_f32_16x16x32_bf16 v[64:67], v[160:163], v[96:99], v[64:67]
  ds_read_b128 v[116:119], v6 offset:45056
  v_mfma_f32_16x16x32_bf16 v[68:71], v[164:167], v[96:99], v[68:71]
  s_waitcnt lgkmcnt(3)
  v_mfma_f32_16x16x32_bf16 v[72:75], v[160:163], v[100:103], v[72:75]
  ds_read_b128 v[120:123], v6 offset:47104
  v_mfma_f32_16x16x32_bf16 v[76:79], v[164:167], v[100:103], v[76:79]
  v_mfma_f32_16x16x32_bf16 v[80:83], v[160:163], v[104:107], v[80:83]
  ds_read_b128 v[124:127], v6 offset:49152
  v_mfma_f32_16x16x32_bf16 v[84:87], v[164:167], v[104:107], v[84:87]
  s_waitcnt vmcnt(6)
  s_waitcnt lgkmcnt(2)
  v_mfma_f32_16x16x32_bf16 v[48:51], v[168:171], v[108:111], v[48:51]
  ds_read_b128 v[88:91], v7 offset:0
  v_mfma_f32_16x16x32_bf16 v[52:55], v[172:175], v[108:111], v[52:55]
  buffer_load_dwordx4 v[136:139], v0, s[52:55], s34 offen offset:3328 sc1
  v_mfma_f32_16x16x32_bf16 v[56:59], v[168:171], v[112:115], v[56:59]
  ds_read_b128 v[92:95], v7 offset:2048
  v_mfma_f32_16x16x32_bf16 v[60:63], v[172:175], v[112:115], v[60:63]
  buffer_load_dwordx4 v[140:143], v0, s[52:55], s35 offen offset:3328 sc1
  v_mfma_f32_16x16x32_bf16 v[64:67], v[168:171], v[116:119], v[64:67]
  ds_read_b128 v[96:99], v7 offset:4096
  v_mfma_f32_16x16x32_bf16 v[68:71], v[172:175], v[116:119], v[68:71]
  s_waitcnt lgkmcnt(3)
  v_mfma_f32_16x16x32_bf16 v[72:75], v[168:171], v[120:123], v[72:75]
  ds_read_b128 v[100:103], v7 offset:6144
  v_mfma_f32_16x16x32_bf16 v[76:79], v[172:175], v[120:123], v[76:79]
  v_mfma_f32_16x16x32_bf16 v[80:83], v[168:171], v[124:127], v[80:83]
  ds_read_b128 v[104:107], v7 offset:8192
  v_mfma_f32_16x16x32_bf16 v[84:87], v[172:175], v[124:127], v[84:87]
  s_waitcnt vmcnt(6)
  s_waitcnt lgkmcnt(2)
  v_mfma_f32_16x16x32_bf16 v[48:51], v[176:179], v[88:91], v[48:51]
  ds_read_b128 v[108:111], v8 offset:0
  v_mfma_f32_16x16x32_bf16 v[52:55], v[180:183], v[88:91], v[52:55]
  buffer_load_dwordx4 v[144:147], v0, s[52:55], s34 offen offset:3584 sc1
  v_mfma_f32_16x16x32_bf16 v[56:59], v[176:179], v[92:95], v[56:59]
  ds_read_b128 v[112:115], v8 offset:2048
  v_mfma_f32_16x16x32_bf16 v[60:63], v[180:183], v[92:95], v[60:63]
  buffer_load_dwordx4 v[148:151], v0, s[52:55], s35 offen offset:3584 sc1
  v_mfma_f32_16x16x32_bf16 v[64:67], v[176:179], v[96:99], v[64:67]
  ds_read_b128 v[116:119], v8 offset:4096
  v_mfma_f32_16x16x32_bf16 v[68:71], v[180:183], v[96:99], v[68:71]
  s_waitcnt lgkmcnt(3)
  v_mfma_f32_16x16x32_bf16 v[72:75], v[176:179], v[100:103], v[72:75]
  ds_read_b128 v[120:123], v8 offset:6144
  v_mfma_f32_16x16x32_bf16 v[76:79], v[180:183], v[100:103], v[76:79]
  v_mfma_f32_16x16x32_bf16 v[80:83], v[176:179], v[104:107], v[80:83]
  ds_read_b128 v[124:127], v8 offset:8192
  v_mfma_f32_16x16x32_bf16 v[84:87], v[180:183], v[104:107], v[84:87]
  s_waitcnt vmcnt(6)
  s_waitcnt lgkmcnt(2)
  v_mfma_f32_16x16x32_bf16 v[48:51], v[184:187], v[108:111], v[48:51]
  ds_read_b128 v[88:91], v7 offset:10240
  v_mfma_f32_16x16x32_bf16 v[52:55], v[188:191], v[108:111], v[52:55]
  buffer_load_dwordx4 v[152:155], v0, s[52:55], s34 offen offset:3840 sc1
  v_mfma_f32_16x16x32_bf16 v[56:59], v[184:187], v[112:115], v[56:59]
  ds_read_b128 v[92:95], v7 offset:12288
  v_mfma_f32_16x16x32_bf16 v[60:63], v[188:191], v[112:115], v[60:63]
  buffer_load_dwordx4 v[156:159], v0, s[52:55], s35 offen offset:3840 sc1
  v_mfma_f32_16x16x32_bf16 v[64:67], v[184:187], v[116:119], v[64:67]
  ds_read_b128 v[96:99], v7 offset:14336
  v_mfma_f32_16x16x32_bf16 v[68:71], v[188:191], v[116:119], v[68:71]
  s_waitcnt lgkmcnt(3)
  v_mfma_f32_16x16x32_bf16 v[72:75], v[184:187], v[120:123], v[72:75]
  ds_read_b128 v[100:103], v7 offset:16384
  v_mfma_f32_16x16x32_bf16 v[76:79], v[188:191], v[120:123], v[76:79]
  v_mfma_f32_16x16x32_bf16 v[80:83], v[184:187], v[124:127], v[80:83]
  ds_read_b128 v[104:107], v7 offset:18432
  v_mfma_f32_16x16x32_bf16 v[84:87], v[188:191], v[124:127], v[84:87]
  s_waitcnt vmcnt(6)
  s_waitcnt lgkmcnt(2)
  v_mfma_f32_16x16x32_bf16 v[48:51], v[128:131], v[88:91], v[48:51]
  ds_read_b128 v[108:111], v8 offset:10240
  v_mfma_f32_16x16x32_bf16 v[52:55], v[132:135], v[88:91], v[52:55]
  s_add_u32 s34, s34, 4096
  buffer_load_dwordx4 v[160:163], v0, s[52:55], s34 offen offset:0 sc1
  v_mfma_f32_16x16x32_bf16 v[56:59], v[128:131], v[92:95], v[56:59]
  ds_read_b128 v[112:115], v8 offset:12288
  v_mfma_f32_16x16x32_bf16 v[60:63], v[132:135], v[92:95], v[60:63]
  s_add_u32 s35, s35, 4096
  buffer_load_dwordx4 v[164:167], v0, s[52:55], s35 offen offset:0 sc1
  v_mfma_f32_16x16x32_bf16 v[64:67], v[128:131], v[96:99], v[64:67]
  ds_read_b128 v[116:119], v8 offset:14336
  v_mfma_f32_16x16x32_bf16 v[68:71], v[132:135], v[96:99], v[68:71]
  s_waitcnt lgkmcnt(3)
  v_mfma_f32_16x16x32_bf16 v[72:75], v[128:131], v[100:103], v[72:75]
  ds_read_b128 v[120:123], v8 offset:16384
  v_mfma_f32_16x16x32_bf16 v[76:79], v[132:135], v[100:103], v[76:79]
  v_mfma_f32_16x16x32_bf16 v[80:83], v[128:131], v[104:107], v[80:83]
  ds_read_b128 v[124:127], v8 offset:18432
  v_mfma_f32_16x16x32_bf16 v[84:87], v[132:135], v[104:107], v[84:87]
  s_waitcnt vmcnt(6)
  s_waitcnt lgkmcnt(2)
  v_mfma_f32_16x16x32_bf16 v[48:51], v[136:139], v[108:111], v[48:51]
  ds_read_b128 v[88:91], v7 offset:20480
  v_mfma_f32_16x16x32_bf16 v[52:55], v[140:143], v[108:111], v[52:55]
  buffer_load_dwordx4 v[168:171], v0, s[52:55], s34 offen offset:256 sc1
  v_mfma_f32_16x16x32_bf16 v[56:59], v[136:139], v[112:115], v[56:59]
  ds_read_b128 v[92:95], v7 offset:22528
  v_mfma_f32_16x16x32_bf16 v[60:63], v[140:143], v[112:115], v[60:63]
  buffer_load_dwordx4 v[172:175], v0, s[52:55], s35 offen offset:256 sc1
  v_mfma_f32_16x16x32_bf16 v[64:67], v[136:139], v[116:119], v[64:67]
  ds_read_b128 v[96:99], v7 offset:24576
  v_mfma_f32_16x16x32_bf16 v[68:71], v[140:143], v[116:119], v[68:71]
  s_waitcnt lgkmcnt(3)
  v_mfma_f32_16x16x32_bf16 v[72:75], v[136:139], v[120:123], v[72:75]
  ds_read_b128 v[100:103], v7 offset:26624
  v_mfma_f32_16x16x32_bf16 v[76:79], v[140:143], v[120:123], v[76:79]
  v_mfma_f32_16x16x32_bf16 v[80:83], v[136:139], v[124:127], v[80:83]
  ds_read_b128 v[104:107], v7 offset:28672
  v_mfma_f32_16x16x32_bf16 v[84:87], v[140:143], v[124:127], v[84:87]
  s_waitcnt vmcnt(6)
  s_waitcnt lgkmcnt(2)
  v_mfma_f32_16x16x32_bf16 v[48:51], v[144:147], v[88:91], v[48:51]
  ds_read_b128 v[108:111], v8 offset:20480
  v_mfma_f32_16x16x32_bf16 v[52:55], v[148:151], v[88:91], v[52:55]
  buffer_load_dwordx4 v[176:179], v0, s[52:55], s34 offen offset:512 sc1
  v_mfma_f32_16x16x32_bf16 v[56:59], v[144:147], v[92:95], v[56:59]
  ds_read_b128 v[112:115], v8 offset:22528
  v_mfma_f32_16x16x32_bf16 v[60:63], v[148:151], v[92:95], v[60:63]
  buffer_load_dwordx4 v[180:183], v0, s[52:55], s35 offen offset:512 sc1
  v_mfma_f32_16x16x32_bf16 v[64:67], v[144:147], v[96:99], v[64:67]
  ds_read_b128 v[116:119], v8 offset:24576
  v_mfma_f32_16x16x32_bf16 v[68:71], v[148:151], v[96:99], v[68:71]
  s_waitcnt lgkmcnt(3)
  v_mfma_f32_16x16x32_bf16 v[72:75], v[144:147], v[100:103], v[72:75]
  ds_read_b128 v[120:123], v8 offset:26624
  v_mfma_f32_16x16x32_bf16 v[76:79], v[148:151], v[100:103], v[76:79]
  v_mfma_f32_16x16x32_bf16 v[80:83], v[144:147], v[104:107], v[80:83]
  ds_read_b128 v[124:127], v8 offset:28672
  v_mfma_f32_16x16x32_bf16 v[84:87], v[148:151], v[104:107], v[84:87]
  s_waitcnt vmcnt(6)
  s_waitcnt lgkmcnt(2)
  v_mfma_f32_16x16x32_bf16 v[48:51], v[152:155], v[108:111], v[48:51]
  ds_read_b128 v[88:91], v7 offset:30720
  v_mfma_f32_16x16x32_bf16 v[52:55], v[156:159], v[108:111], v[52:55]
  buffer_load_dwordx4 v[184:187], v0, s[52:55], s34 offen offset:768 sc1
  v_mfma_f32_16x16x32_bf16 v[56:59], v[152:155], v[112:115], v[56:59]
  ds_read_b128 v[92:95], v7 offset:32768
  v_mfma_f32_16x16x32_bf16 v[60:63], v[156:159], v[112:115], v[60:63]
  buffer_load_dwordx4 v[188:191], v0, s[52:55], s35 offen offset:768 sc1
  v_mfma_f32_16x16x32_bf16 v[64:67], v[152:155], v[116:119], v[64:67]
  ds_read_b128 v[96:99], v7 offset:34816
  v_mfma_f32_16x16x32_bf16 v[68:71], v[156:159], v[116:119], v[68:71]
  s_waitcnt lgkmcnt(3)
  v_mfma_f32_16x16x32_bf16 v[72:75], v[152:155], v[120:123], v[72:75]
  ds_read_b128 v[100:103], v7 offset:36864
  v_mfma_f32_16x16x32_bf16 v[76:79], v[156:159], v[120:123], v[76:79]
  v_mfma_f32_16x16x32_bf16 v[80:83], v[152:155], v[124:127], v[80:83]
  ds_read_b128 v[104:107], v7 offset:38912
  v_mfma_f32_16x16x32_bf16 v[84:87], v[156:159], v[124:127], v[84:87]
  s_waitcnt vmcnt(6)
  s_waitcnt lgkmcnt(2)
  v_mfma_f32_16x16x32_bf16 v[48:51], v[160:163], v[88:91], v[48:51]
  ds_read_b128 v[108:111], v8 offset:30720
  v_mfma_f32_16x16x32_bf16 v[52:55], v[164:167], v[88:91], v[52:55]
  s_sub_u32 s34, s34, 4096
  buffer_load_dwordx4 v[128:131], v0, s[52:55], s34 offen offset:0 sc1
  v_mfma_f32_16x16x32_bf16 v[56:59], v[160:163], v[92:95], v[56:59]
  ds_read_b128 v[112:115], v8 offset:32768
  v_mfma_f32_16x16x32_bf16 v[60:63], v[164:167], v[92:95], v[60:63]
  s_sub_u32 s35, s35, 4096
  buffer_load_dwordx4 v[132:135], v0, s[52:55], s35 offen offset:0 sc1
  v_mfma_f32_16x16x32_bf16 v[64:67], v[160:163], v[96:99], v[64:67]
  ds_read_b128 v[116:119], v8 offset:34816
  v_mfma_f32_16x16x32_bf16 v[68:71], v[164:167], v[96:99], v[68:71]
  s_waitcnt lgkmcnt(3)
  v_mfma_f32_16x16x32_bf16 v[72:75], v[160:163], v[100:103], v[72:75]
  ds_read_b128 v[120:123], v8 offset:36864
  v_mfma_f32_16x16x32_bf16 v[76:79], v[164:167], v[100:103], v[76:79]
  v_mfma_f32_16x16x32_bf16 v[80:83], v[160:163], v[104:107], v[80:83]
  ds_read_b128 v[124:127], v8 offset:38912
  v_mfma_f32_16x16x32_bf16 v[84:87], v[164:167], v[104:107], v[84:87]
  s_waitcnt vmcnt(6)
  s_waitcnt lgkmcnt(2)
  v_mfma_f32_16x16x32_bf16 v[48:51], v[168:171], v[108:111], v[48:51]
  ds_read_b128 v[88:91], v7 offset:40960
  v_mfma_f32_16x16x32_bf16 v[52:55], v[172:175], v[108:111], v[52:55]
  buffer_load_dwordx4 v[136:139], v0, s[52:55], s34 offen offset:256 sc1
  v_mfma_f32_16x16x32_bf16 v[56:59], v[168:171], v[112:115], v[56:59]
  ds_read_b128 v[92:95], v7 offset:43008
  v_mfma_f32_16x16x32_bf16 v[60:63], v[172:175], v[112:115], v[60:63]
  buffer_load_dwordx4 v[140:143], v0, s[52:55], s35 offen offset:256 sc1
  v_mfma_f32_16x16x32_bf16 v[64:67], v[168:171], v[116:119], v[64:67]
  ds_read_b128 v[96:99], v7 offset:45056
  v_mfma_f32_16x16x32_bf16 v[68:71], v[172:175], v[116:119], v[68:71]
  s_waitcnt lgkmcnt(3)
  v_mfma_f32_16x16x32_bf16 v[72:75], v[168:171], v[120:123], v[72:75]
  ds_read_b128 v[100:103], v7 offset:47104
  v_mfma_f32_16x16x32_bf16 v[76:79], v[172:175], v[120:123], v[76:79]
  v_mfma_f32_16x16x32_bf16 v[80:83], v[168:171], v[124:127], v[80:83]
  ds_read_b128 v[104:107], v7 offset:49152
  v_mfma_f32_16x16x32_bf16 v[84:87], v[172:175], v[124:127], v[84:87]
  s_waitcnt vmcnt(6)
  s_waitcnt lgkmcnt(2)
  v_mfma_f32_16x16x32_bf16 v[48:51], v[176:179], v[88:91], v[48:51]
  ds_read_b128 v[108:111], v8 offset:40960
  v_mfma_f32_16x16x32_bf16 v[52:55], v[180:183], v[88:91], v[52:55]
  buffer_load_dwordx4 v[144:147], v0, s[52:55], s34 offen offset:512 sc1
  v_mfma_f32_16x16x32_bf16 v[56:59], v[176:179], v[92:95], v[56:59]
  ds_read_b128 v[112:115], v8 offset:43008
  v_mfma_f32_16x16x32_bf16 v[60:63], v[180:183], v[92:95], v[60:63]
  buffer_load_dwordx4 v[148:151], v0, s[52:55], s35 offen offset:512 sc1
  v_mfma_f32_16x16x32_bf16 v[64:67], v[176:179], v[96:99], v[64:67]
  ds_read_b128 v[116:119], v8 offset:45056
  v_mfma_f32_16x16x32_bf16 v[68:71], v[180:183], v[96:99], v[68:71]
  s_waitcnt lgkmcnt(3)
  v_mfma_f32_16x16x32_bf16 v[72:75], v[176:179], v[100:103], v[72:75]
  ds_read_b128 v[120:123], v8 offset:47104
  v_mfma_f32_16x16x32_bf16 v[76:79], v[180:183], v[100:103], v[76:79]
  v_mfma_f32_16x16x32_bf16 v[80:83], v[176:179], v[104:107], v[80:83]
  ds_read_b128 v[124:127], v8 offset:49152
  v_mfma_f32_16x16x32_bf16 v[84:87], v[180:183], v[104:107], v[84:87]
  s_waitcnt vmcnt(6)
  s_barrier
  s_waitcnt lgkmcnt(2)
  v_mfma_f32_16x16x32_bf16 v[48:51], v[184:187], v[108:111], v[48:51]
  ds_read_b128 v[88:91], v5 offset:0
  v_mfma_f32_16x16x32_bf16 v[52:55], v[188:191], v[108:111], v[52:55]
  buffer_load_dwordx4 v[152:155], v0, s[52:55], s34 offen offset:768 sc1
  v_mfma_f32_16x16x32_bf16 v[56:59], v[184:187], v[112:115], v[56:59]
  ds_read_b128 v[92:95], v5 offset:2048
  v_mfma_f32_16x16x32_bf16 v[60:63], v[188:191], v[112:115], v[60:63]
  buffer_load_dwordx4 v[156:159], v0, s[52:55], s35 offen offset:768 sc1
  v_mfma_f32_16x16x32_bf16 v[64:67], v[184:187], v[116:119], v[64:67]
  ds_read_b128 v[96:99], v5 offset:4096
  v_mfma_f32_16x16x32_bf16 v[68:71], v[188:191], v[116:119], v[68:71]
  s_waitcnt lgkmcnt(3)
  v_mfma_f32_16x16x32_bf16 v[72:75], v[184:187], v[120:123], v[72:75]
  ds_read_b128 v[100:103], v5 offset:6144
  v_mfma_f32_16x16x32_bf16 v[76:79], v[188:191], v[120:123], v[76:79]
  v_mfma_f32_16x16x32_bf16 v[80:83], v[184:187], v[124:127], v[80:83]
  ds_read_b128 v[104:107], v5 offset:8192
  v_mfma_f32_16x16x32_bf16 v[84:87], v[188:191], v[124:127], v[84:87]
  s_waitcnt vmcnt(6)
  s_waitcnt lgkmcnt(2)
  v_mfma_f32_16x16x32_bf16 v[48:51], v[128:131], v[88:91], v[48:51]
  ds_read_b128 v[108:111], v6 offset:0
  v_mfma_f32_16x16x32_bf16 v[52:55], v[132:135], v[88:91], v[52:55]
  v_mfma_f32_16x16x32_bf16 v[56:59], v[128:131], v[92:95], v[56:59]
  ds_read_b128 v[112:115], v6 offset:2048
  v_mfma_f32_16x16x32_bf16 v[60:63], v[132:135], v[92:95], v[60:63]
  v_mfma_f32_16x16x32_bf16 v[64:67], v[128:131], v[96:99], v[64:67]
  ds_read_b128 v[116:119], v6 offset:4096
  v_mfma_f32_16x16x32_bf16 v[68:71], v[132:135], v[96:99], v[68:71]
  s_waitcnt lgkmcnt(3)
  v_mfma_f32_16x16x32_bf16 v[72:75], v[128:131], v[100:103], v[72:75]
  ds_read_b128 v[120:123], v6 offset:6144
  v_mfma_f32_16x16x32_bf16 v[76:79], v[132:135], v[100:103], v[76:79]
  v_mfma_f32_16x16x32_bf16 v[80:83], v[128:131], v[104:107], v[80:83]
  ds_read_b128 v[124:127], v6 offset:8192
  v_mfma_f32_16x16x32_bf16 v[84:87], v[132:135], v[104:107], v[84:87]
  s_waitcnt vmcnt(4)
  s_waitcnt lgkmcnt(2)
  v_mfma_f32_16x16x32_bf16 v[48:51], v[136:139], v[108:111], v[48:51]
  ds_read_b128 v[88:91], v5 offset:10240
  v_mfma_f32_16x16x32_bf16 v[52:55], v[140:143], v[108:111], v[52:55]
  v_accvgpr_read_b32 v11, a245
  s_and_b32 exec_lo, s96, 0x3fffffff
  s_mov_b32 exec_hi, 0
  buffer_load_dword a250, v11, s[52:55], 0 offen
  s_mov_b64 exec, -1
  v_mfma_f32_16x16x32_bf16 v[56:59], v[136:139], v[112:115], v[56:59]
  ds_read_b128 v[92:95], v5 offset:12288
  v_mfma_f32_16x16x32_bf16 v[60:63], v[140:143], v[112:115], v[60:63]
  v_mfma_f32_16x16x32_bf16 v[64:67], v[136:139], v[116:119], v[64:67]
  ds_read_b128 v[96:99], v5 offset:14336
  v_mfma_f32_16x16x32_bf16 v[68:71], v[140:143], v[116:119], v[68:71]
  s_waitcnt lgkmcnt(3)
  v_mfma_f32_16x16x32_bf16 v[72:75], v[136:139], v[120:123], v[72:75]
  ds_read_b128 v[100:103], v5 offset:16384
  v_mfma_f32_16x16x32_bf16 v[76:79], v[140:143], v[120:123], v[76:79]
  v_mfma_f32_16x16x32_bf16 v[80:83], v[136:139], v[124:127], v[80:83]
  ds_read_b128 v[104:107], v5 offset:18432
  v_mfma_f32_16x16x32_bf16 v[84:87], v[140:143], v[124:127], v[84:87]
  s_waitcnt vmcnt(2)
  s_waitcnt lgkmcnt(2)
  v_mfma_f32_16x16x32_bf16 v[48:51], v[144:147], v[88:91], v[48:51]
  ds_read_b128 v[108:111], v6 offset:10240
  v_mfma_f32_16x16x32_bf16 v[52:55], v[148:151], v[88:91], v[52:55]
  v_mfma_f32_16x16x32_bf16 v[56:59], v[144:147], v[92:95], v[56:59]
  ds_read_b128 v[112:115], v6 offset:12288
  v_mfma_f32_16x16x32_bf16 v[60:63], v[148:151], v[92:95], v[60:63]
  v_mfma_f32_16x16x32_bf16 v[64:67], v[144:147], v[96:99], v[64:67]
  ds_read_b128 v[116:119], v6 offset:14336
  v_mfma_f32_16x16x32_bf16 v[68:71], v[148:151], v[96:99], v[68:71]
  s_waitcnt lgkmcnt(3)
  v_mfma_f32_16x16x32_bf16 v[72:75], v[144:147], v[100:103], v[72:75]
  ds_read_b128 v[120:123], v6 offset:16384
  v_mfma_f32_16x16x32_bf16 v[76:79], v[148:151], v[100:103], v[76:79]
  v_mfma_f32_16x16x32_bf16 v[80:83], v[144:147], v[104:107], v[80:83]
  ds_read_b128 v[124:127], v6 offset:18432
  v_mfma_f32_16x16x32_bf16 v[84:87], v[148:151], v[104:107], v[84:87]
  s_waitcnt vmcnt(0)
  s_waitcnt lgkmcnt(2)
  v_mfma_f32_16x16x32_bf16 v[48:51], v[152:155], v[108:111], v[48:51]
  v_mfma_f32_16x16x32_bf16 v[52:55], v[156:159], v[108:111], v[52:55]
  v_mfma_f32_16x16x32_bf16 v[56:59], v[152:155], v[112:115], v[56:59]
  v_mfma_f32_16x16x32_bf16 v[60:63], v[156:159], v[112:115], v[60:63]
  v_mfma_f32_16x16x32_bf16 v[64:67], v[152:155], v[116:119], v[64:67]
  v_mfma_f32_16x16x32_bf16 v[68:71], v[156:159], v[116:119], v[68:71]
  s_waitcnt lgkmcnt(0)
  v_mfma_f32_16x16x32_bf16 v[72:75], v[152:155], v[120:123], v[72:75]
  v_mfma_f32_16x16x32_bf16 v[76:79], v[156:159], v[120:123], v[76:79]
  v_mfma_f32_16x16x32_bf16 v[80:83], v[152:155], v[124:127], v[80:83]
  v_mfma_f32_16x16x32_bf16 v[84:87], v[156:159], v[124:127], v[84:87]
  v_fmac_f32 v49, v16, v48
  v_fmac_f32 v57, v17, v56
  v_fmac_f32 v65, v18, v64
  s_nop 1
  v_fmac_f32 v73, v19, v72
  s_nop 0
  v_fmac_f32 v81, v20, v80
  v_fmac_f32_dpp v49, v48, v21 quad_perm:[1,0,3,2] row_mask:0xf bank_mask:0xf
  v_fmac_f32_dpp v57, v56, v22 quad_perm:[1,0,3,2] row_mask:0xf bank_mask:0xf
  v_fmac_f32_dpp v65, v64, v23 quad_perm:[1,0,3,2] row_mask:0xf bank_mask:0xf
  v_fmac_f32_dpp v73, v72, v24 quad_perm:[1,0,3,2] row_mask:0xf bank_mask:0xf
  v_fmac_f32_dpp v81, v80, v25 quad_perm:[1,0,3,2] row_mask:0xf bank_mask:0xf
  v_fmac_f32 v50, v16, v49
  v_fmac_f32 v58, v17, v57
  v_fmac_f32 v66, v18, v65
  v_fmac_f32 v74, v19, v73
  v_fmac_f32_e64 v82, v20, v81
  v_fmac_f32_dpp v50, v49, v21 quad_perm:[1,0,3,2] row_mask:0xf bank_mask:0xf
  v_fmac_f32_dpp v58, v57, v22 quad_perm:[1,0,3,2] row_mask:0xf bank_mask:0xf
  v_fmac_f32_dpp v66, v65, v23 quad_perm:[1,0,3,2] row_mask:0xf bank_mask:0xf
  v_fmac_f32_dpp v74, v73, v24 quad_perm:[1,0,3,2] row_mask:0xf bank_mask:0xf
  v_fmac_f32_dpp v82, v81, v25 quad_perm:[1,0,3,2] row_mask:0xf bank_mask:0xf
  v_fmac_f32 v51, v16, v50
  v_fmac_f32 v59, v17, v58
  v_fmac_f32 v67, v18, v66
  v_fmac_f32 v75, v19, v74
  v_fmac_f32_e64 v83, v20, v82
  v_fmac_f32_dpp v51, v50, v21 quad_perm:[1,0,3,2] row_mask:0xf bank_mask:0xf
  v_fmac_f32_dpp v59, v58, v22 quad_perm:[1,0,3,2] row_mask:0xf bank_mask:0xf
  v_fmac_f32_dpp v67, v66, v23 quad_perm:[1,0,3,2] row_mask:0xf bank_mask:0xf
  v_fmac_f32_dpp v75, v74, v24 quad_perm:[1,0,3,2] row_mask:0xf bank_mask:0xf
  v_fmac_f32_dpp v83, v82, v25 quad_perm:[1,0,3,2] row_mask:0xf bank_mask:0xf
  v_fmac_f32 v52, v16, v51
  v_fmac_f32 v60, v17, v59
  v_fmac_f32 v68, v18, v67
  v_fmac_f32 v76, v19, v75
  v_fmac_f32_e64 v84, v20, v83
  v_fmac_f32_dpp v52, v51, v21 quad_perm:[1,0,3,2] row_mask:0xf bank_mask:0xf
  v_fmac_f32_dpp v60, v59, v22 quad_perm:[1,0,3,2] row_mask:0xf bank_mask:0xf
  v_fmac_f32_dpp v68, v67, v23 quad_perm:[1,0,3,2] row_mask:0xf bank_mask:0xf
  v_fmac_f32_dpp v76, v75, v24 quad_perm:[1,0,3,2] row_mask:0xf bank_mask:0xf
  v_fmac_f32_dpp v84, v83, v25 quad_perm:[1,0,3,2] row_mask:0xf bank_mask:0xf
  v_fmac_f32 v53, v16, v52
  v_fmac_f32 v61, v17, v60
  v_fmac_f32 v69, v18, v68
  v_fmac_f32 v77, v19, v76
  v_fmac_f32_e64 v85, v20, v84
  v_fmac_f32_dpp v53, v52, v21 quad_perm:[1,0,3,2] row_mask:0xf bank_mask:0xf
  v_fmac_f32_dpp v61, v60, v22 quad_perm:[1,0,3,2] row_mask:0xf bank_mask:0xf
  v_fmac_f32_dpp v69, v68, v23 quad_perm:[1,0,3,2] row_mask:0xf bank_mask:0xf
  v_fmac_f32_dpp v77, v76, v24 quad_perm:[1,0,3,2] row_mask:0xf bank_mask:0xf
  v_fmac_f32_dpp v85, v84, v25 quad_perm:[1,0,3,2] row_mask:0xf bank_mask:0xf
  v_fmac_f32 v54, v16, v53
  v_fmac_f32 v62, v17, v61
  v_fmac_f32 v70, v18, v69
  v_fmac_f32 v78, v19, v77
  v_fmac_f32_e64 v86, v20, v85
  v_fmac_f32_dpp v54, v53, v21 quad_perm:[1,0,3,2] row_mask:0xf bank_mask:0xf
  v_fmac_f32_dpp v62, v61, v22 quad_perm:[1,0,3,2] row_mask:0xf bank_mask:0xf
  v_fmac_f32_dpp v70, v69, v23 quad_perm:[1,0,3,2] row_mask:0xf bank_mask:0xf
  v_fmac_f32_dpp v78, v77, v24 quad_perm:[1,0,3,2] row_mask:0xf bank_mask:0xf
  v_fmac_f32_dpp v86, v85, v25 quad_perm:[1,0,3,2] row_mask:0xf bank_mask:0xf
  v_fmac_f32 v55, v16, v54
  v_fmac_f32 v63, v17, v62
  v_fmac_f32 v71, v18, v70
  v_fmac_f32 v79, v19, v78
  v_fmac_f32_e64 v87, v20, v86
  v_fmac_f32_dpp v55, v54, v21 quad_perm:[1,0,3,2] row_mask:0xf bank_mask:0xf
  v_fmac_f32_dpp v63, v62, v22 quad_perm:[1,0,3,2] row_mask:0xf bank_mask:0xf
  v_fmac_f32_dpp v71, v70, v23 quad_perm:[1,0,3,2] row_mask:0xf bank_mask:0xf
  v_fmac_f32_dpp v79, v78, v24 quad_perm:[1,0,3,2] row_mask:0xf bank_mask:0xf
  v_fmac_f32_dpp v87, v86, v25 quad_perm:[1,0,3,2] row_mask:0xf bank_mask:0xf
  v_add_u32 v11, 152320, v9
  v_min_u32 v12, 39, v1
  v_mul_u32_u24 v44, 48, v12
  s_lshl_b32 s12, s7, 3
  s_add_u32 s12, s12, 149504
  v_add_u32 v44, s12, v44
  ds_write_b32 v11, v55 offset:0
  ds_write_b32 v11, v63 offset:1152
  ds_write_b32 v11, v71 offset:2304
  ds_write_b32 v11, v79 offset:3456
  ds_write_b32 v11, v87 offset:4608
  v_mul_u32_u24 v46, 144, v12
  v_add_u32 v46, 152320, v46
  s_waitcnt lgkmcnt(0)
  s_barrier
  ds_read_b128 v[90:93], v46 offset:0
  ds_read_b128 v[94:97], v46 offset:16
  ds_read_b128 v[98:101], v46 offset:32
  ds_read_b128 v[102:105], v46 offset:48
  ds_read_b128 v[106:109], v46 offset:64
  ds_read_b128 v[110:113], v46 offset:80
  ds_read_b128 v[114:117], v46 offset:96
  ds_read_b128 v[118:121], v46 offset:112
  s_waitcnt lgkmcnt(7)
  v_pk_fma_f32 v[92:93], v[90:91], v[36:37], v[92:93] op_sel:[1,1,0] op_sel_hi:[0,1,1] neg_lo:[0,1,0]
  v_pk_fma_f32 v[92:93], v[90:91], v[36:37], v[92:93] op_sel:[0,0,0] op_sel_hi:[1,0,1]
  s_waitcnt lgkmcnt(6)
  v_pk_fma_f32 v[94:95], v[92:93], v[36:37], v[94:95] op_sel:[1,1,0] op_sel_hi:[0,1,1] neg_lo:[0,1,0]
  v_pk_fma_f32 v[94:95], v[92:93], v[36:37], v[94:95] op_sel:[0,0,0] op_sel_hi:[1,0,1]
  v_pk_fma_f32 v[96:97], v[94:95], v[36:37], v[96:97] op_sel:[1,1,0] op_sel_hi:[0,1,1] neg_lo:[0,1,0]
  v_pk_fma_f32 v[96:97], v[94:95], v[36:37], v[96:97] op_sel:[0,0,0] op_sel_hi:[1,0,1]
  s_waitcnt lgkmcnt(5)
  v_pk_fma_f32 v[98:99], v[96:97], v[36:37], v[98:99] op_sel:[1,1,0] op_sel_hi:[0,1,1] neg_lo:[0,1,0]
  v_pk_fma_f32 v[98:99], v[96:97], v[36:37], v[98:99] op_sel:[0,0,0] op_sel_hi:[1,0,1]
  v_pk_fma_f32 v[100:101], v[98:99], v[36:37], v[100:101] op_sel:[1,1,0] op_sel_hi:[0,1,1] neg_lo:[0,1,0]
  v_pk_fma_f32 v[100:101], v[98:99], v[36:37], v[100:101] op_sel:[0,0,0] op_sel_hi:[1,0,1]
  s_waitcnt lgkmcnt(4)
  v_pk_fma_f32 v[102:103], v[100:101], v[36:37], v[102:103] op_sel:[1,1,0] op_sel_hi:[0,1,1] neg_lo:[0,1,0]
  v_pk_fma_f32 v[102:103], v[100:101], v[36:37], v[102:103] op_sel:[0,0,0] op_sel_hi:[1,0,1]
  v_pk_fma_f32 v[104:105], v[102:103], v[36:37], v[104:105] op_sel:[1,1,0] op_sel_hi:[0,1,1] neg_lo:[0,1,0]
  v_pk_fma_f32 v[104:105], v[102:103], v[36:37], v[104:105] op_sel:[0,0,0] op_sel_hi:[1,0,1]
  s_waitcnt lgkmcnt(3)
  v_pk_fma_f32 v[106:107], v[104:105], v[36:37], v[106:107] op_sel:[1,1,0] op_sel_hi:[0,1,1] neg_lo:[0,1,0]
  v_pk_fma_f32 v[106:107], v[104:105], v[36:37], v[106:107] op_sel:[0,0,0] op_sel_hi:[1,0,1]
  v_pk_fma_f32 v[108:109], v[106:107], v[36:37], v[108:109] op_sel:[1,1,0] op_sel_hi:[0,1,1] neg_lo:[0,1,0]
  v_pk_fma_f32 v[108:109], v[106:107], v[36:37], v[108:109] op_sel:[0,0,0] op_sel_hi:[1,0,1]
  s_waitcnt lgkmcnt(2)
  v_pk_fma_f32 v[110:111], v[108:109], v[36:37], v[110:111] op_sel:[1,1,0] op_sel_hi:[0,1,1] neg_lo:[0,1,0]
  v_pk_fma_f32 v[110:111], v[108:109], v[36:37], v[110:111] op_sel:[0,0,0] op_sel_hi:[1,0,1]
  v_pk_fma_f32 v[112:113], v[110:111], v[36:37], v[112:113] op_sel:[1,1,0] op_sel_hi:[0,1,1] neg_lo:[0,1,0]
  v_pk_fma_f32 v[112:113], v[110:111], v[36:37], v[112:113] op_sel:[0,0,0] op_sel_hi:[1,0,1]
  s_waitcnt lgkmcnt(1)
  v_pk_fma_f32 v[114:115], v[112:113], v[36:37], v[114:115] op_sel:[1,1,0] op_sel_hi:[0,1,1] neg_lo:[0,1,0]
  v_pk_fma_f32 v[114:115], v[112:113], v[36:37], v[114:115] op_sel:[0,0,0] op_sel_hi:[1,0,1]
  v_pk_fma_f32 v[116:117], v[114:115], v[36:37], v[116:117] op_sel:[1,1,0] op_sel_hi:[0,1,1] neg_lo:[0,1,0]
  v_pk_fma_f32 v[116:117], v[114:115], v[36:37], v[116:117] op_sel:[0,0,0] op_sel_hi:[1,0,1]
  s_waitcnt lgkmcnt(0)
  v_pk_fma_f32 v[118:119], v[116:117], v[36:37], v[118:119] op_sel:[1,1,0] op_sel_hi:[0,1,1] neg_lo:[0,1,0]
  v_pk_fma_f32 v[118:119], v[116:117], v[36:37], v[118:119] op_sel:[0,0,0] op_sel_hi:[1,0,1]
  v_pk_fma_f32 v[120:121], v[118:119], v[36:37], v[120:121] op_sel:[1,1,0] op_sel_hi:[0,1,1] neg_lo:[0,1,0]
  v_pk_fma_f32 v[120:121], v[118:119], v[36:37], v[120:121] op_sel:[0,0,0] op_sel_hi:[1,0,1]
  v_mov_b32 v122, s8
  v_mov_b32 v123, s8
  s_add_u32 s12, s83, 337920
  s_mov_b64 exec, s[96:97]
  buffer_store_dwordx4 v[120:123], v2, s[52:55], s12 offen sc1
  s_mov_b64 exec, -1
  v_subrev_u32 v46, 8576, v46
  v_mov_b32 v88, 0
  v_mov_b32 v89, 0
  s_mov_b32 exec_hi, 0xff
  s_cmp_eq_u32 s7, 1
  s_cbranch_scc1 w1_64
  s_cmp_eq_u32 s7, 2
  s_cbranch_scc1 w2_65
  s_cmp_eq_u32 s7, 3
  s_cbranch_scc1 w3_66
w0_63:
  ds_write_b128 v46, v[88:91] offset:0
  ds_write_b128 v46, v[92:95] offset:16
  s_branch join_62
w1_64:
  ds_write_b128 v46, v[96:99] offset:32
  ds_write_b128 v46, v[100:103] offset:48
  s_branch join_62
w2_65:
  ds_write_b128 v46, v[104:107] offset:64
  ds_write_b128 v46, v[108:111] offset:80
  s_branch join_62
w3_66:
  ds_write_b128 v46, v[112:115] offset:96
  ds_write_b128 v46, v[116:119] offset:112
join_62:
  s_mov_b32 exec_hi, -1
  v_add_u32 v46, 143744, v9
  ds_read_b32 v244, v46 offset:0
  ds_read_b32 v246, v46 offset:1152
  ds_read_b32 v248, v46 offset:2304
  ds_read_b32 v250, v46 offset:3456
  ds_read_b32 v252, v46 offset:4608
  v_and_b32 v43, 1, v3
  v_cvt_f32_u32 v43, v43
  v_fma_f32 v43, 2.0, v43, -1.0
  s_waitcnt lgkmcnt(0)
  s_nop 0
  v_mul_f32_dpp v245, v244, v43 quad_perm:[1,0,3,2] row_mask:0xf bank_mask:0xf
  v_mul_f32_dpp v247, v246, v43 quad_perm:[1,0,3,2] row_mask:0xf bank_mask:0xf
  v_mul_f32_dpp v249, v248, v43 quad_perm:[1,0,3,2] row_mask:0xf bank_mask:0xf
  v_mul_f32_dpp v251, v250, v43 quad_perm:[1,0,3,2] row_mask:0xf bank_mask:0xf
  v_mul_f32_dpp v253, v252, v43 quad_perm:[1,0,3,2] row_mask:0xf bank_mask:0xf
  s_and_b32 vcc_lo, s1, 7
  s_lshl_b32 vcc_lo, vcc_lo, 2
  s_add_u32 vcc_lo, vcc_lo, s7
  s_lshl_b32 vcc_lo, vcc_lo, 11
  v_lshl_add_u32 v15, v3, 7, vcc_lo
  v_min_u32 v15, L_codeend-L_pc-4, v15
  s_mov_b64 exec, 0xffff
  global_load_dword a250, v15, s[98:99]
  s_mov_b64 exec, -1
  s_lshl_b32 s90, s7, 2
  s_sub_u32 s90, 12, s90
  s_mul_i32 s90, s90, 640
  s_add_u32 s90, s90, s83
  s_add_u32 s90, s90, 327680
  v_min_u32 v42, 39, v1
  v_lshlrev_b32 v42, 4, v42
  buffer_load_dwordx3 v[88:90], v42, s[52:55], s90 offen offset:0 sc1
  buffer_load_dwordx3 v[92:94], v42, s[52:55], s90 offen offset:640 sc1
  buffer_load_dwordx3 v[96:98], v42, s[52:55], s90 offen offset:1280 sc1
  buffer_load_dwordx3 v[100:102], v42, s[52:55], s90 offen offset:1920 sc1
  s_mul_i32 s12, s7, 2560
  s_add_u32 s12, s12, 24576
  v_lshlrev_b32_e64 v11, 5, v3
  v_lshl_add_u32 v11, v4, 3, v11
  v_add_u32_e64 v11, s12, v11
  v_lshl_add_u32 v12, v1, 3, s12
  ds_write_b64 v11, a[200:201] offset:0
  ds_write_b64 v11, a[202:203] offset:512
  ds_write_b64 v11, a[204:205] offset:1024
  ds_write_b64 v11, a[206:207] offset:1536
  ds_write_b64 v11, a[208:209] offset:2048
  ds_read_b64 v[232:233], v12 offset:0
  ds_read_b64 v[234:235], v12 offset:512
  ds_read_b64 v[236:237], v12 offset:1024
  ds_read_b64 v[238:239], v12 offset:1536
  ds_read_b64 v[240:241], v12 offset:2048
  v_lshrrev_b32_e64 v11, 1, v3
  v_mul_u32_u24 v12, 80, v11
  v_add_u32 v12, 160640, v12
  v_mul_u32_u24_e64 v11, 48, v11
  v_add_u32 v11, 149504, v11
  ds_read_b128 v[128:131], v12 offset:0
  ds_read_b128 v[132:135], v12 offset:16
  ds_read_b128 v[136:139], v12 offset:32
  ds_read_b128 v[140:143], v12 offset:48
  ds_read_b128 v[144:147], v12 offset:640
  ds_read_b128 v[148:151], v12 offset:656
  ds_read_b128 v[152:155], v12 offset:672
  ds_read_b128 v[156:159], v12 offset:688
  ds_read_b128 v[160:163], v12 offset:1280
  ds_read_b128 v[164:167], v12 offset:1296
  ds_read_b128 v[168:171], v12 offset:1312
  ds_read_b128 v[172:175], v12 offset:1328
  ds_read_b128 v[176:179], v12 offset:1920
  ds_read_b128 v[180:183], v12 offset:1936
  ds_read_b128 v[184:187], v12 offset:1952
  ds_read_b128 v[188:191], v12 offset:1968
  ds_read_b128 v[104:107], v12 offset:2560
  ds_read_b128 v[108:111], v12 offset:2576
  ds_read_b128 v[112:115], v12 offset:2592
  ds_read_b128 v[116:119], v12 offset:2608
  v_accvgpr_read_b32 v254, a240
  v_accvgpr_read_b32 v255, a241
  v_accvgpr_read_b32 v47, a242
  s_waitcnt vmcnt(0)
  v_min3_u32 v14, v90, v94, s8
  v_max3_u32 v15, v90, v94, s8
  v_min3_u32 v14, v14, v98, v102
  v_max3_u32 v15, v15, v98, v102
  v_cmp_ne_u32 vcc, v14, v15
  s_cbranch_vccz ok_68
again_67:
  buffer_load_dwordx3 v[88:90], v42, s[52:55], s90 offen offset:0 sc1
  buffer_load_dwordx3 v[92:94], v42, s[52:55], s90 offen offset:640 sc1
  buffer_load_dwordx3 v[96:98], v42, s[52:55], s90 offen offset:1280 sc1
  buffer_load_dwordx3 v[100:102], v42, s[52:55], s90 offen offset:1920 sc1
  s_sub_u32 s10, s10, 1
  s_cmp_gt_i32 s10, 0
  s_waitcnt vmcnt(0)
  v_min3_u32 v14, v90, v94, s8
  v_max3_u32 v15, v90, v94, s8
  v_min3_u32 v14, v14, v98, v102
  v_max3_u32 v15, v15, v98, v102
  v_cmp_ne_u32 vcc, v14, v15
  s_cbranch_scc0 out_69
  s_cbranch_vccnz again_67
out_69:
ok_68:
  v_pk_fma_f32 v[92:93], v[88:89], v[38:39], v[92:93] op_sel:[1,1,0] op_sel_hi:[0,1,1] neg_lo:[0,1,0]
  v_pk_fma_f32 v[92:93], v[88:89], v[38:39], v[92:93] op_sel:[0,0,0] op_sel_hi:[1,0,1]
  v_pk_fma_f32 v[96:97], v[92:93], v[38:39], v[96:97] op_sel:[1,1,0] op_sel_hi:[0,1,1] neg_lo:[0,1,0]
  v_pk_fma_f32 v[96:97], v[92:93], v[38:39], v[96:97] op_sel:[0,0,0] op_sel_hi:[1,0,1]
  v_pk_fma_f32 v[100:101], v[96:97], v[38:39], v[100:101] op_sel:[1,1,0] op_sel_hi:[0,1,1] neg_lo:[0,1,0]
  v_pk_fma_f32 v[100:101], v[96:97], v[38:39], v[100:101] op_sel:[0,0,0] op_sel_hi:[1,0,1]
  v_pk_mul_f32 v[88:89], v[100:101], v[40:41] op_sel:[1,1] op_sel_hi:[0,1] neg_lo:[0,1]
  v_pk_fma_f32 v[88:89], v[100:101], v[40:41], v[88:89] op_sel:[0,0,0] op_sel_hi:[1,0,1]
  s_mov_b32 exec_hi, 0xff
  ds_write_b64 v44, v[88:89]
  s_mov_b32 exec_hi, -1
  s_waitcnt lgkmcnt(0)
  s_barrier
  ds_read_b128 v[88:91], v11 offset:0
  ds_read_b128 v[92:95], v11 offset:16
  ds_read_b128 v[96:99], v11 offset:384
  ds_read_b128 v[100:103], v11 offset:400
  ds_read_b128 v[224:227], v11 offset:768
  ds_read_b128 v[228:231], v11 offset:784
  s_waitcnt lgkmcnt(4)
  v_pk_add_f32 v[88:89], v[88:89], v[90:91]
  v_pk_add_f32 v[92:93], v[92:93], v[94:95]
  v_pk_add_f32 v[88:89], v[88:89], v[92:93]
  v_pk_fma_f32 v[244:245], v[26:27], v[88:89], v[244:245] op_sel:[0,0,0] op_sel_hi:[1,0,1]
  v_pk_fma_f32 v[244:245], v[26:27], v[88:89], v[244:245] op_sel:[1,1,0] op_sel_hi:[0,1,1] neg_hi:[1,0,0]
  ds_read_b128 v[88:91], v11 offset:1152
  ds_read_b128 v[92:95], v11 offset:1168
  s_waitcnt lgkmcnt(4)
  v_pk_add_f32 v[96:97], v[96:97], v[98:99]
  v_pk_add_f32 v[100:101], v[100:101], v[102:103]
  v_pk_add_f32 v[96:97], v[96:97], v[100:101]
  v_pk_fma_f32 v[246:247], v[28:29], v[96:97], v[246:247] op_sel:[0,0,0] op_sel_hi:[1,0,1]
  v_pk_fma_f32 v[246:247], v[28:29], v[96:97], v[246:247] op_sel:[1,1,0] op_sel_hi:[0,1,1] neg_hi:[1,0,0]
  ds_read_b128 v[96:99], v11 offset:1536
  ds_read_b128 v[100:103], v11 offset:1552
  v_pk_fma_f32 v[48:49], v[128:129], v[244:245], v[48:49] op_sel:[0,0,0] op_sel_hi:[1,0,1]
  v_pk_fma_f32 v[50:51], v[130:131], v[244:245], v[50:51] op_sel:[0,0,0] op_sel_hi:[1,0,1]
  v_pk_fma_f32 v[52:53], v[132:133], v[244:245], v[52:53] op_sel:[0,0,0] op_sel_hi:[1,0,1]
  v_pk_fma_f32 v[54:55], v[134:135], v[244:245], v[54:55] op_sel:[0,0,0] op_sel_hi:[1,0,1]
  v_pk_fma_f32 v[48:49], v[136:137], v[244:245], v[48:49] op_sel:[0,1,0] op_sel_hi:[1,1,1]
  v_pk_fma_f32 v[50:51], v[138:139], v[244:245], v[50:51] op_sel:[0,1,0] op_sel_hi:[1,1,1]
  v_pk_fma_f32 v[52:53], v[140:141], v[244:245], v[52:53] op_sel:[0,1,0] op_sel_hi:[1,1,1]
  v_pk_fma_f32 v[54:55], v[142:143], v[244:245], v[54:55] op_sel:[0,1,0] op_sel_hi:[1,1,1]
  v_cvt_pk_bf16_f32 v120, v48, v49
  v_cvt_pk_bf16_f32 v121, v50, v51
  v_cvt_pk_bf16_f32 v122, v52, v53
  v_cvt_pk_bf16_f32 v123, v54, v55
  ds_write_b128 v254, v[120:123]
  ds_read_b64_tr_b16 v[52:53], v255
  ds_read_b64_tr_b16 v[54:55], v255 offset:640
  s_waitcnt lgkmcnt(7)
  v_pk_add_f32 v[224:225], v[224:225], v[226:227]
  v_pk_add_f32 v[228:229], v[228:229], v[230:231]
  v_pk_add_f32 v[224:225], v[224:225], v[228:229]
  v_pk_fma_f32 v[248:249], v[30:31], v[224:225], v[248:249] op_sel:[0,0,0] op_sel_hi:[1,0,1]
  v_pk_fma_f32 v[248:249], v[30:31], v[224:225], v[248:249] op_sel:[1,1,0] op_sel_hi:[0,1,1] neg_hi:[1,0,0]
  v_pk_fma_f32 v[56:57], v[144:145], v[246:247], v[56:57] op_sel:[0,0,0] op_sel_hi:[1,0,1]
  v_pk_fma_f32 v[58:59], v[146:147], v[246:247], v[58:59] op_sel:[0,0,0] op_sel_hi:[1,0,1]
  v_pk_fma_f32 v[60:61], v[148:149], v[246:247], v[60:61] op_sel:[0,0,0] op_sel_hi:[1,0,1]
  v_pk_fma_f32 v[62:63], v[150:151], v[246:247], v[62:63] op_sel:[0,0,0] op_sel_hi:[1,0,1]
  v_pk_fma_f32 v[56:57], v[152:153], v[246:247], v[56:57] op_sel:[0,1,0] op_sel_hi:[1,1,1]
  v_pk_fma_f32 v[58:59], v[154:155], v[246:247], v[58:59] op_sel:[0,1,0] op_sel_hi:[1,1,1]
  v_pk_fma_f32 v[60:61], v[156:157], v[246:247], v[60:61] op_sel:[0,1,0] op_sel_hi:[1,1,1]
  v_pk_fma_f32 v[62:63], v[158:159], v[246:247], v[62:63] op_sel:[0,1,0] op_sel_hi:[1,1,1]
  v_cvt_pk_bf16_f32 v124, v56, v57
  v_cvt_pk_bf16_f32 v125, v58, v59
  v_cvt_pk_bf16_f32 v126, v60, v61
  v_cvt_pk_bf16_f32 v127, v62, v63
  ds_write_b128 v254, v[124:127]
  ds_read_b64_tr_b16 v[60:61], v255
  ds_read_b64_tr_b16 v[62:63], v255 offset:640
  s_waitcnt lgkmcnt(8)
  v_pk_add_f32 v[88:89], v[88:89], v[90:91]
  v_pk_add_f32 v[92:93], v[92:93], v[94:95]
  v_pk_add_f32 v[88:89], v[88:89], v[92:93]
  v_pk_fma_f32 v[250:251], v[32:33], v[88:89], v[250:251] op_sel:[0,0,0] op_sel_hi:[1,0,1]
  v_pk_fma_f32 v[250:251], v[32:33], v[88:89], v[250:251] op_sel:[1,1,0] op_sel_hi:[0,1,1] neg_hi:[1,0,0]
  s_add_u32 s13, s78, 0
  s_waitcnt lgkmcnt(3)
  s_cmp_eq_u32 s9, 0
  s_cbranch_scc1 slow_70
  buffer_store_dwordx4 v[52:55], v47, s[60:63], s13 offen
back_71:
  v_pk_fma_f32 v[64:65], v[160:161], v[248:249], v[64:65] op_sel:[0,0,0] op_sel_hi:[1,0,1]
  v_pk_fma_f32 v[66:67], v[162:163], v[248:249], v[66:67] op_sel:[0,0,0] op_sel_hi:[1,0,1]
  v_pk_fma_f32 v[68:69], v[164:165], v[248:249], v[68:69] op_sel:[0,0,0] op_sel_hi:[1,0,1]
  v_pk_fma_f32 v[70:71], v[166:167], v[248:249], v[70:71] op_sel:[0,0,0] op_sel_hi:[1,0,1]
  v_pk_fma_f32 v[64:65], v[168:169], v[248:249], v[64:65] op_sel:[0,1,0] op_sel_hi:[1,1,1]
  v_pk_fma_f32 v[66:67], v[170:171], v[248:249], v[66:67] op_sel:[0,1,0] op_sel_hi:[1,1,1]
  v_pk_fma_f32 v[68:69], v[172:173], v[248:249], v[68:69] op_sel:[0,1,0] op_sel_hi:[1,1,1]
  v_pk_fma_f32 v[70:71], v[174:175], v[248:249], v[70:71] op_sel:[0,1,0] op_sel_hi:[1,1,1]
  v_cvt_pk_bf16_f32 v120, v64, v65
  v_cvt_pk_bf16_f32 v121, v66, v67
  v_cvt_pk_bf16_f32 v122, v68, v69
  v_cvt_pk_bf16_f32 v123, v70, v71
  ds_write_b128 v254, v[120:123]
  ds_read_b64_tr_b16 v[68:69], v255
  ds_read_b64_tr_b16 v[70:71], v255 offset:640
  v_pk_add_f32 v[96:97], v[96:97], v[98:99]
  v_pk_add_f32 v[100:101], v[100:101], v[102:103]
  v_pk_add_f32 v[96:97], v[96:97], v[100:101]
  v_pk_fma_f32 v[252:253], v[34:35], v[96:97], v[252:253] op_sel:[0,0,0] op_sel_hi:[1,0,1]
  v_pk_fma_f32 v[252:253], v[34:35], v[96:97], v[252:253] op_sel:[1,1,0] op_sel_hi:[0,1,1] neg_hi:[1,0,0]
  s_add_u32 s13, s79, 0
  s_waitcnt lgkmcnt(3)
  s_cmp_eq_u32 s9, 0
  s_cbranch_scc1 slow_72
  buffer_store_dwordx4 v[60:63], v47, s[60:63], s13 offen
back_73:
  v_pk_fma_f32 v[72:73], v[176:177], v[250:251], v[72:73] op_sel:[0,0,0] op_sel_hi:[1,0,1]
  v_pk_fma_f32 v[74:75], v[178:179], v[250:251], v[74:75] op_sel:[0,0,0] op_sel_hi:[1,0,1]
  v_pk_fma_f32 v[76:77], v[180:181], v[250:251], v[76:77] op_sel:[0,0,0] op_sel_hi:[1,0,1]
  v_pk_fma_f32 v[78:79], v[182:183], v[250:251], v[78:79] op_sel:[0,0,0] op_sel_hi:[1,0,1]
  v_pk_fma_f32 v[72:73], v[184:185], v[250:251], v[72:73] op_sel:[0,1,0] op_sel_hi:[1,1,1]
  v_pk_fma_f32 v[74:75], v[186:187], v[250:251], v[74:75] op_sel:[0,1,0] op_sel_hi:[1,1,1]
  v_pk_fma_f32 v[76:77], v[188:189], v[250:251], v[76:77] op_sel:[0,1,0] op_sel_hi:[1,1,1]
  v_pk_fma_f32 v[78:79], v[190:191], v[250:251], v[78:79] op_sel:[0,1,0] op_sel_hi:[1,1,1]
  v_cvt_pk_bf16_f32 v124, v72, v73
  v_cvt_pk_bf16_f32 v125, v74, v75
  v_cvt_pk_bf16_f32 v126, v76, v77
  v_cvt_pk_bf16_f32 v127, v78, v79
  ds_write_b128 v254, v[124:127]
  ds_read_b64_tr_b16 v[76:77], v255
  ds_read_b64_tr_b16 v[78:79], v255 offset:640
  s_add_u32 s13, s80, 0
  s_waitcnt lgkmcnt(3)
  s_cmp_eq_u32 s9, 0
  s_cbranch_scc1 slow_74
  buffer_store_dwordx4 v[68:71], v47, s[60:63], s13 offen
back_75:
  v_pk_fma_f32 v[80:81], v[104:105], v[252:253], v[80:81] op_sel:[0,0,0] op_sel_hi:[1,0,1]
  v_pk_fma_f32 v[82:83], v[106:107], v[252:253], v[82:83] op_sel:[0,0,0] op_sel_hi:[1,0,1]
  v_pk_fma_f32 v[84:85], v[108:109], v[252:253], v[84:85] op_sel:[0,0,0] op_sel_hi:[1,0,1]
  v_pk_fma_f32 v[86:87], v[110:111], v[252:253], v[86:87] op_sel:[0,0,0] op_sel_hi:[1,0,1]
  v_pk_fma_f32 v[80:81], v[112:113], v[252:253], v[80:81] op_sel:[0,1,0] op_sel_hi:[1,1,1]
  v_pk_fma_f32 v[82:83], v[114:115], v[252:253], v[82:83] op_sel:[0,1,0] op_sel_hi:[1,1,1]
  v_pk_fma_f32 v[84:85], v[116:117], v[252:253], v[84:85] op_sel:[0,1,0] op_sel_hi:[1,1,1]
  v_pk_fma_f32 v[86:87], v[118:119], v[252:253], v[86:87] op_sel:[0,1,0] op_sel_hi:[1,1,1]
  v_cvt_pk_bf16_f32 v120, v80, v81
  v_cvt_pk_bf16_f32 v121, v82, v83
  v_cvt_pk_bf16_f32 v122, v84, v85
  v_cvt_pk_bf16_f32 v123, v86, v87
  ds_write_b128 v254, v[120:123]
  ds_read_b64_tr_b16 v[84:85], v255
  ds_read_b64_tr_b16 v[86:87], v255 offset:640
  s_add_u32 s13, s81, 0
  s_waitcnt lgkmcnt(3)
  s_cmp_eq_u32 s9, 0
  s_cbranch_scc1 slow_76
  buffer_store_dwordx4 v[76:79], v47, s[60:63], s13 offen
back_77:
  s_add_u32 s13, s82, 0
  s_waitcnt lgkmcnt(0)
  s_cmp_eq_u32 s9, 0
  s_cbranch_scc1 slow_78
  buffer_store_dwordx4 v[84:87], v47, s[60:63], s13 offen
back_79:
  s_mul_i32 s13, s5, 163840
  s_mul_i32 s14, s7, 10240
  s_add_u32 s13, s13, s14
  s_add_u32 s13, s13, 0
  s_add_u32 s14, s7, 1
  s_and_b32 s14, s14, 3
  s_mul_i32 s15, s14, 40960
  s_add_u32 s16, s15, s13
  s_mul_i32 s15, s14, 10240
  s_add_u32 s15, s15, 102400
  v_add_u32 v44, s15, v2
  s_add_u32 s14, s7, 2
  s_and_b32 s14, s14, 3
  s_mul_i32 s15, s14, 40960
  s_add_u32 s17, s15, s13
  s_mul_i32 s15, s14, 10240
  s_add_u32 s15, s15, 107520
  v_add_u32 v45, s15, v2
  s_add_u32 s14, s7, 3
  s_and_b32 s14, s14, 3
  s_mul_i32 s15, s14, 40960
  s_add_u32 s18, s15, s13
  s_mul_i32 s15, s14, 5120
  v_add_u32 v46, s15, v2
  s_add_u32 s14, s7, 4
  s_and_b32 s14, s14, 3
  s_mul_i32 s15, s14, 40960
  s_add_u32 s19, s15, s13
  s_lshl_b32 s49, s3, 10
  s_lshl_b32 s13, s7, 6
  s_add_u32 s49, s49, s13
  s_and_b32 s13, s5, 1
  s_lshl_b32 s13, s13, 3
  s_add_u32 s49, s49, s13
  s_add_u32 s49, s49, 4608
  v_and_b32 v244, 3, v1
  v_lshlrev_b32 v244, 4, v244
  s_waitcnt vmcnt(0)
  s_add_u32 s14, s84, 4608
  v_mov_b32 v15, s8
  s_mov_b64 exec, 1
  s_cmp_eq_u32 s9, 0
  s_cbranch_scc1 slow_80
  buffer_store_dword v15, off, s[52:55], s14
back_81:
  s_mov_b64 exec, -1
again_82:
  buffer_load_dwordx2 v[42:43], v244, s[52:55], s49 offen sc1
  s_sub_u32 s10, s10, 1
  s_cmp_gt_i32 s10, 0
  s_waitcnt vmcnt(0)
  v_xor_b32 v15, s8, v42
  v_xor_b32 v14, s8, v43
  v_or_b32 v15, v15, v14
  v_cmp_ne_u32 vcc, 0, v15
  s_cbranch_scc0 out_84
  s_cbranch_vccnz again_82
out_84:
ok_83:
  buffer_load_dwordx4 v[128:131], v2, s[60:63], s16 offen offset:0 sc1
  buffer_load_dwordx4 v[132:135], v2, s[60:63], s16 offen offset:1024 sc1
  buffer_load_dwordx4 v[136:139], v2, s[60:63], s16 offen offset:2048 sc1
  buffer_load_dwordx4 v[140:143], v2, s[60:63], s16 offen offset:3072 sc1
  s_add_u32 s16, s16, 4096
  buffer_load_dwordx4 v[144:147], v2, s[60:63], s16 offen offset:0 sc1
  buffer_load_dwordx4 v[148:151], v2, s[60:63], s16 offen offset:1024 sc1
  buffer_load_dwordx4 v[152:155], v2, s[60:63], s16 offen offset:2048 sc1
  buffer_load_dwordx4 v[156:159], v2, s[60:63], s16 offen offset:3072 sc1
  s_waitcnt vmcnt(7)
  v_mfma_f32_16x16x32_bf16 v[48:51], a[0:3], v[128:131], 0
  s_add_u32 s16, s16, 4096
  buffer_load_dwordx4 v[160:163], v2, s[60:63], s16 offen offset:0 sc1
  v_mfma_f32_16x16x32_bf16 v[52:55], a[4:7], v[128:131], 0
  v_mfma_f32_16x16x32_bf16 v[56:59], a[8:11], v[128:131], 0
  v_mfma_f32_16x16x32_bf16 v[60:63], a[12:15], v[128:131], 0
  v_mfma_f32_16x16x32_bf16 v[64:67], a[16:19], v[128:131], 0
  s_waitcnt vmcnt(7)
  v_mfma_f32_16x16x32_bf16 v[48:51], a[20:23], v[132:135], v[48:51]
  buffer_load_dwordx4 v[164:167], v2, s[60:63], s16 offen offset:1024 sc1
  v_mfma_f32_16x16x32_bf16 v[52:55], a[24:27], v[132:135], v[52:55]
  v_accvgpr_read_b32 v108, a210
  v_mfma_f32_16x16x32_bf16 v[56:59], a[28:31], v[132:135], v[56:59]
  v_accvgpr_read_b32 v109, a211
  v_mfma_f32_16x16x32_bf16 v[60:63], a[32:35], v[132:135], v[60:63]
  v_accvgpr_read_b32 v110, a212
  v_mfma_f32_16x16x32_bf16 v[64:67], a[36:39], v[132:135], v[64:67]
  s_waitcnt vmcnt(7)
  v_mfma_f32_16x16x32_bf16 v[48:51], a[40:43], v[136:139], v[48:51]
  buffer_load_dwordx4 v[168:171], v2, s[60:63], s17 offen offset:0 sc1
  v_mfma_f32_16x16x32_bf16 v[52:55], a[44:47], v[136:139], v[52:55]
  v_accvgpr_read_b32 v111, a213
  v_mfma_f32_16x16x32_bf16 v[56:59], a[48:51], v[136:139], v[56:59]
  v_accvgpr_read_b32 v112, a214
  v_mfma_f32_16x16x32_bf16 v[60:63], a[52:55], v[136:139], v[60:63]
  v_accvgpr_read_b32 v113, a215
  v_mfma_f32_16x16x32_bf16 v[64:67], a[56:59], v[136:139], v[64:67]
  s_waitcnt vmcnt(7)
  v_mfma_f32_16x16x32_bf16 v[48:51], a[60:63], v[140:143], v[48:51]
  buffer_load_dwordx4 v[172:175], v2, s[60:63], s17 offen offset:1024 sc1
  v_mfma_f32_16x16x32_bf16 v[52:55], a[64:67], v[140:143], v[52:55]
  v_accvgpr_read_b32 v114, a216
  v_mfma_f32_16x16x32_bf16 v[56:59], a[68:71], v[140:143], v[56:59]
  v_accvgpr_read_b32 v115, a217
  v_mfma_f32_16x16x32_bf16 v[60:63], a[72:75], v[140:143], v[60:63]
  v_accvgpr_read_b32 v116, a218
  v_mfma_f32_16x16x32_bf16 v[64:67], a[76:79], v[140:143], v[64:67]
  s_waitcnt vmcnt(7)
  v_mfma_f32_16x16x32_bf16 v[48:51], a[80:83], v[144:147], v[48:51]
  buffer_load_dwordx4 v[176:179], v2, s[60:63], s17 offen offset:2048 sc1
  v_mfma_f32_16x16x32_bf16 v[52:55], a[84:87], v[144:147], v[52:55]
  v_accvgpr_read_b32 v117, a219
  v_mfma_f32_16x16x32_bf16 v[56:59], a[88:91], v[144:147], v[56:59]
  v_accvgpr_read_b32 v118, a220
  v_mfma_f32_16x16x32_bf16 v[60:63], a[92:95], v[144:147], v[60:63]
  v_accvgpr_read_b32 v119, a221
  v_mfma_f32_16x16x32_bf16 v[64:67], a[96:99], v[144:147], v[64:67]
  s_waitcnt vmcnt(7)
  v_mfma_f32_16x16x32_bf16 v[48:51], a[100:103], v[148:151], v[48:51]
  buffer_load_dwordx4 v[180:183], v2, s[60:63], s17 offen offset:3072 sc1
  v_mfma_f32_16x16x32_bf16 v[52:55], a[104:107], v[148:151], v[52:55]
  v_accvgpr_read_b32 v120, a222
  v_mfma_f32_16x16x32_bf16 v[56:59], a[108:111], v[148:151], v[56:59]
  v_accvgpr_read_b32 v121, a223
  v_mfma_f32_16x16x32_bf16 v[60:63], a[112:115], v[148:151], v[60:63]
  v_accvgpr_read_b32 v122, a224
  v_mfma_f32_16x16x32_bf16 v[64:67], a[116:119], v[148:151], v[64:67]
  s_waitcnt vmcnt(7)
  v_mfma_f32_16x16x32_bf16 v[48:51], a[120:123], v[152:155], v[48:51]
  s_add_u32 s17, s17, 4096
  buffer_load_dwordx4 v[184:187], v2, s[60:63], s17 offen offset:0 sc1
  v_mfma_f32_16x16x32_bf16 v[52:55], a[124:127], v[152:155], v[52:55]
  v_accvgpr_read_b32 v123, a225
  v_mfma_f32_16x16x32_bf16 v[56:59], a[128:131], v[152:155], v[56:59]
  v_accvgpr_read_b32 v124, a226
  v_mfma_f32_16x16x32_bf16 v[60:63], a[132:135], v[152:155], v[60:63]
  v_accvgpr_read_b32 v125, a227
  v_mfma_f32_16x16x32_bf16 v[64:67], a[136:139], v[152:155], v[64:67]
  s_waitcnt vmcnt(7)
  v_mfma_f32_16x16x32_bf16 v[48:51], a[140:143], v[156:159], v[48:51]
  buffer_load_dwordx4 v[188:191], v2, s[60:63], s17 offen offset:1024 sc1
  v_mfma_f32_16x16x32_bf16 v[52:55], a[144:147], v[156:159], v[52:55]
  v_accvgpr_read_b32 v126, a228
  v_mfma_f32_16x16x32_bf16 v[56:59], a[148:151], v[156:159], v[56:59]
  v_accvgpr_read_b32 v127, a229
  v_mfma_f32_16x16x32_bf16 v[60:63], a[152:155], v[156:159], v[60:63]
  v_lshlrev_b32_e64 v88, 16, v232
  v_mfma_f32_16x16x32_bf16 v[64:67], a[156:159], v[156:159], v[64:67]
  s_waitcnt vmcnt(7)
  v_mfma_f32_16x16x32_bf16 v[48:51], a[160:163], v[160:163], v[48:51]
  buffer_load_dwordx4 v[128:131], v2, s[60:63], s17 offen offset:2048 sc1
  v_mfma_f32_16x16x32_bf16 v[52:55], a[164:167], v[160:163], v[52:55]
  v_and_b32 v89, 0xffff0000, v232
  v_mfma_f32_16x16x32_bf16 v[56:59], a[168:171], v[160:163], v[56:59]
  v_lshlrev_b32 v90, 16, v233
  v_mfma_f32_16x16x32_bf16 v[60:63], a[172:175], v[160:163], v[60:63]
  v_and_b32 v91, 0xffff0000, v233
  v_mfma_f32_16x16x32_bf16 v[64:67], a[176:179], v[160:163], v[64:67]
  s_waitcnt vmcnt(7)
  v_mfma_f32_16x16x32_bf16 v[48:51], a[180:183], v[164:167], v[48:51]
  buffer_load_dwordx4 v[132:135], v2, s[60:63], s17 offen offset:3072 sc1
  v_mfma_f32_16x16x32_bf16 v[52:55], a[184:187], v[164:167], v[52:55]
  v_lshlrev_b32 v92, 16, v234
  v_mfma_f32_16x16x32_bf16 v[56:59], a[188:191], v[164:167], v[56:59]
  v_and_b32 v93, 0xffff0000, v234
  v_mfma_f32_16x16x32_bf16 v[60:63], a[192:195], v[164:167], v[60:63]
  v_lshlrev_b32_e64 v94, 16, v235
  v_mfma_f32_16x16x32_bf16 v[64:67], a[196:199], v[164:167], v[64:67]
  s_waitcnt vmcnt(7)
  v_mfma_f32_16x16x32_bf16 v[68:71], a[0:3], v[168:171], 0
  s_add_u32 s17, s17, 4096
  buffer_load_dwordx4 v[136:139], v2, s[60:63], s17 offen offset:0 sc1
  v_mfma_f32_16x16x32_bf16 v[72:75], a[4:7], v[168:171], 0
  v_and_b32 v95, 0xffff0000, v235
  v_mfma_f32_16x16x32_bf16 v[76:79], a[8:11], v[168:171], 0
  v_lshlrev_b32 v96, 16, v236
  v_mfma_f32_16x16x32_bf16 v[80:83], a[12:15], v[168:171], 0
  v_and_b32 v97, 0xffff0000, v236
  v_mfma_f32_16x16x32_bf16 v[84:87], a[16:19], v[168:171], 0
  s_waitcnt vmcnt(7)
  v_mfma_f32_16x16x32_bf16 v[68:71], a[20:23], v[172:175], v[68:71]
  ds_write_b128 v44, v[48:51] offset:0
  ds_write_b128 v44, v[52:55] offset:1024
  v_mfma_f32_16x16x32_bf16 v[72:75], a[24:27], v[172:175], v[72:75]
  buffer_load_dwordx4 v[140:143], v2, s[60:63], s17 offen offset:1024 sc1
  v_mfma_f32_16x16x32_bf16 v[76:79], a[28:31], v[172:175], v[76:79]
  v_lshlrev_b32 v98, 16, v237
  v_mfma_f32_16x16x32_bf16 v[80:83], a[32:35], v[172:175], v[80:83]
  v_and_b32 v99, 0xffff0000, v237
  v_mfma_f32_16x16x32_bf16 v[84:87], a[36:39], v[172:175], v[84:87]
  v_lshlrev_b32 v100, 16, v238
  s_waitcnt vmcnt(7)
  v_mfma_f32_16x16x32_bf16 v[68:71], a[40:43], v[176:179], v[68:71]
  ds_write_b128 v44, v[56:59] offset:2048
  ds_write_b128 v44, v[60:63] offset:3072
  v_mfma_f32_16x16x32_bf16 v[72:75], a[44:47], v[176:179], v[72:75]
  buffer_load_dwordx4 v[144:147], v2, s[60:63], s18 offen offset:0 sc1
  v_mfma_f32_16x16x32_bf16 v[76:79], a[48:51], v[176:179], v[76:79]
  v_and_b32 v101, 0xffff0000, v238
  v_mfma_f32_16x16x32_bf16 v[80:83], a[52:55], v[176:179], v[80:83]
  v_lshlrev_b32_e64 v102, 16, v239
  v_mfma_f32_16x16x32_bf16 v[84:87], a[56:59], v[176:179], v[84:87]
  v_and_b32 v103, 0xffff0000, v239
  s_waitcnt vmcnt(7)
  v_mfma_f32_16x16x32_bf16 v[68:71], a[60:63], v[180:183], v[68:71]
  ds_write_b128 v44, v[64:67] offset:4096
  v_mfma_f32_16x16x32_bf16 v[72:75], a[64:67], v[180:183], v[72:75]
  buffer_load_dwordx4 v[148:151], v2, s[60:63], s18 offen offset:1024 sc1
  v_mfma_f32_16x16x32_bf16 v[76:79], a[68:71], v[180:183], v[76:79]
  v_lshlrev_b32 v104, 16, v240
  v_mfma_f32_16x16x32_bf16 v[80:83], a[72:75], v[180:183], v[80:83]
  v_and_b32 v105, 0xffff0000, v240
  v_mfma_f32_16x16x32_bf16 v[84:87], a[76:79], v[180:183], v[84:87]
  v_lshlrev_b32 v106, 16, v241
  s_waitcnt vmcnt(7)
  v_mfma_f32_16x16x32_bf16 v[68:71], a[80:83], v[184:187], v[68:71]
  buffer_load_dwordx4 v[152:155], v2, s[60:63], s18 offen offset:2048 sc1
  v_mfma_f32_16x16x32_bf16 v[72:75], a[84:87], v[184:187], v[72:75]
  v_and_b32 v107, 0xffff0000, v241
  v_mfma_f32_16x16x32_bf16 v[76:79], a[88:91], v[184:187], v[76:79]
  v_mfma_f32_16x16x32_bf16 v[80:83], a[92:95], v[184:187], v[80:83]
  v_mfma_f32_16x16x32_bf16 v[84:87], a[96:99], v[184:187], v[84:87]
  s_waitcnt vmcnt(7)
  v_mfma_f32_16x16x32_bf16 v[68:71], a[100:103], v[188:191], v[68:71]
  buffer_load_dwordx4 v[156:159], v2, s[60:63], s18 offen offset:3072 sc1
  v_mfma_f32_16x16x32_bf16 v[72:75], a[104:107], v[188:191], v[72:75]
  v_mfma_f32_16x16x32_bf16 v[76:79], a[108:111], v[188:191], v[76:79]
  v_mfma_f32_16x16x32_bf16 v[80:83], a[112:115], v[188:191], v[80:83]
  v_mfma_f32_16x16x32_bf16 v[84:87], a[116:119], v[188:191], v[84:87]
  s_waitcnt vmcnt(7)
  v_mfma_f32_16x16x32_bf16 v[68:71], a[120:123], v[128:131], v[68:71]
  s_add_u32 s18, s18, 4096
  buffer_load_dwordx4 v[160:163], v2, s[60:63], s18 offen offset:0 sc1
  v_mfma_f32_16x16x32_bf16 v[72:75], a[124:127], v[128:131], v[72:75]
  s_mul_i32 s15, s7, 10240
  v_mfma_f32_16x16x32_bf16 v[76:79], a[128:131], v[128:131], v[76:79]
  s_add_u32 s15, s15, 102400
  v_mfma_f32_16x16x32_bf16 v[80:83], a[132:135], v[128:131], v[80:83]
  v_add_u32_e64 v47, s15, v2
  v_mfma_f32_16x16x32_bf16 v[84:87], a[136:139], v[128:131], v[84:87]
  s_waitcnt vmcnt(7)
  v_mfma_f32_16x16x32_bf16 v[68:71], a[140:143], v[132:135], v[68:71]
  buffer_load_dwordx4 v[164:167], v2, s[60:63], s18 offen offset:1024 sc1
  v_mfma_f32_16x16x32_bf16 v[72:75], a[144:147], v[132:135], v[72:75]
  v_mfma_f32_16x16x32_bf16 v[76:79], a[148:151], v[132:135], v[76:79]
  v_mfma_f32_16x16x32_bf16 v[80:83], a[152:155], v[132:135], v[80:83]
  v_mfma_f32_16x16x32_bf16 v[84:87], a[156:159], v[132:135], v[84:87]
  s_waitcnt vmcnt(7)
  v_mfma_f32_16x16x32_bf16 v[68:71], a[160:163], v[136:139], v[68:71]
  buffer_load_dwordx4 v[168:171], v2, s[60:63], s18 offen offset:2048 sc1
  v_mfma_f32_16x16x32_bf16 v[72:75], a[164:167], v[136:139], v[72:75]
  v_mfma_f32_16x16x32_bf16 v[76:79], a[168:171], v[136:139], v[76:79]
  v_mfma_f32_16x16x32_bf16 v[80:83], a[172:175], v[136:139], v[80:83]
  v_mfma_f32_16x16x32_bf16 v[84:87], a[176:179], v[136:139], v[84:87]
  s_waitcnt vmcnt(7)
  v_mfma_f32_16x16x32_bf16 v[68:71], a[180:183], v[140:143], v[68:71]
  buffer_load_dwordx4 v[172:175], v2, s[60:63], s18 offen offset:3072 sc1
  v_mfma_f32_16x16x32_bf16 v[72:75], a[184:187], v[140:143], v[72:75]
  v_mfma_f32_16x16x32_bf16 v[76:79], a[188:191], v[140:143], v[76:79]
  v_mfma_f32_16x16x32_bf16 v[80:83], a[192:195], v[140:143], v[80:83]
  v_mfma_f32_16x16x32_bf16 v[84:87], a[196:199], v[140:143], v[84:87]
  s_waitcnt vmcnt(7)
  v_mfma_f32_16x16x32_bf16 v[48:51], a[0:3], v[144:147], 0
  s_add_u32 s18, s18, 4096
  buffer_load_dwordx4 v[176:179], v2, s[60:63], s18 offen offset:0 sc1
  v_mfma_f32_16x16x32_bf16 v[52:55], a[4:7], v[144:147], 0
  v_mfma_f32_16x16x32_bf16 v[56:59], a[8:11], v[144:147], 0
  v_mfma_f32_16x16x32_bf16 v[60:63], a[12:15], v[144:147], 0
  v_mfma_f32_16x16x32_bf16 v[64:67], a[16:19], v[144:147], 0
  s_waitcnt vmcnt(7)
  v_mfma_f32_16x16x32_bf16 v[48:51], a[20:23], v[148:151], v[48:51]
  ds_write_b128 v45, v[68:71] offset:0
  v_mfma_f32_16x16x32_bf16 v[52:55], a[24:27], v[148:151], v[52:55]
  ds_write_b128 v45, v[72:75] offset:1024
  v_mfma_f32_16x16x32_bf16 v[56:59], a[28:31], v[148:151], v[56:59]
  buffer_load_dwordx4 v[180:183], v2, s[60:63], s18 offen offset:1024 sc1
  v_mfma_f32_16x16x32_bf16 v[60:63], a[32:35], v[148:151], v[60:63]
  v_mfma_f32_16x16x32_bf16 v[64:67], a[36:39], v[148:151], v[64:67]
  s_waitcnt vmcnt(7)
  v_mfma_f32_16x16x32_bf16 v[48:51], a[40:43], v[152:155], v[48:51]
  ds_write_b128 v45, v[76:79] offset:2048
  v_mfma_f32_16x16x32_bf16 v[52:55], a[44:47], v[152:155], v[52:55]
  ds_write_b128 v45, v[80:83] offset:3072
  v_mfma_f32_16x16x32_bf16 v[56:59], a[48:51], v[152:155], v[56:59]
  buffer_load_dwordx4 v[184:187], v2, s[60:63], s19 offen offset:0 sc1
  v_mfma_f32_16x16x32_bf16 v[60:63], a[52:55], v[152:155], v[60:63]
  v_mfma_f32_16x16x32_bf16 v[64:67], a[56:59], v[152:155], v[64:67]
  s_waitcnt vmcnt(7)
  v_mfma_f32_16x16x32_bf16 v[48:51], a[60:63], v[156:159], v[48:51]
  ds_write_b128 v45, v[84:87] offset:4096
  v_mfma_f32_16x16x32_bf16 v[52:55], a[64:67], v[156:159], v[52:55]
  buffer_load_dwordx4 v[188:191], v2, s[60:63], s19 offen offset:1024 sc1
  v_mfma_f32_16x16x32_bf16 v[56:59], a[68:71], v[156:159], v[56:59]
  v_mfma_f32_16x16x32_bf16 v[60:63], a[72:75], v[156:159], v[60:63]
  v_mfma_f32_16x16x32_bf16 v[64:67], a[76:79], v[156:159], v[64:67]
  s_waitcnt vmcnt(7)
  v_mfma_f32_16x16x32_bf16 v[48:51], a[80:83], v[160:163], v[48:51]
  buffer_load_dwordx4 v[128:131], v2, s[60:63], s19 offen offset:2048 sc1
  s_waitcnt lgkmcnt(0)
  s_barrier
  v_mfma_f32_16x16x32_bf16 v[52:55], a[84:87], v[160:163], v[52:55]
  ds_read_b128 v[192:195], v47 offset:0
  ds_read_b128 v[196:199], v47 offset:1024
  v_mfma_f32_16x16x32_bf16 v[56:59], a[88:91], v[160:163], v[56:59]
  ds_read_b128 v[200:203], v47 offset:2048
  ds_read_b128 v[204:207], v47 offset:3072
  v_mfma_f32_16x16x32_bf16 v[60:63], a[92:95], v[160:163], v[60:63]
  ds_read_b128 v[208:211], v47 offset:4096
  ds_read_b128 v[212:215], v47 offset:5120
  v_mfma_f32_16x16x32_bf16 v[64:67], a[96:99], v[160:163], v[64:67]
  ds_read_b128 v[216:219], v47 offset:6144
  ds_read_b128 v[220:223], v47 offset:7168
  s_waitcnt vmcnt(7)
  v_mfma_f32_16x16x32_bf16 v[48:51], a[100:103], v[164:167], v[48:51]
  buffer_load_dwordx4 v[132:135], v2, s[60:63], s19 offen offset:3072 sc1
  ds_read_b128 v[224:227], v47 offset:8192
  v_mfma_f32_16x16x32_bf16 v[52:55], a[104:107], v[164:167], v[52:55]
  ds_read_b128 v[228:231], v47 offset:9216
  s_waitcnt lgkmcnt(5)
  v_mfma_f32_16x16x32_bf16 v[56:59], a[108:111], v[164:167], v[56:59]
  v_add_f32 v108, v108, v192
  v_add_f32 v109, v109, v193
  v_mfma_f32_16x16x32_bf16 v[60:63], a[112:115], v[164:167], v[60:63]
  v_add_f32 v110, v110, v194
  v_add_f32 v111, v111, v195
  v_mfma_f32_16x16x32_bf16 v[64:67], a[116:119], v[164:167], v[64:67]
  v_add_f32 v112, v112, v196
  v_add_f32 v113, v113, v197
  s_waitcnt vmcnt(7)
  v_mfma_f32_16x16x32_bf16 v[48:51], a[120:123], v[168:171], v[48:51]
  s_add_u32 s19, s19, 4096
  buffer_load_dwordx4 v[136:139], v2, s[60:63], s19 offen offset:0 sc1
  v_add_f32 v114, v114, v198
  v_mfma_f32_16x16x32_bf16 v[52:55], a[124:127], v[168:171], v[52:55]
  v_add_f32 v115, v115, v199
  v_add_f32 v116, v116, v200
  v_mfma_f32_16x16x32_bf16 v[56:59], a[128:131], v[168:171], v[56:59]
  v_add_f32 v117, v117, v201
  v_add_f32 v118, v118, v202
  v_mfma_f32_16x16x32_bf16 v[60:63], a[132:135], v[168:171], v[60:63]
  v_add_f32 v119, v119, v203
  v_add_f32 v120, v120, v204
  v_mfma_f32_16x16x32_bf16 v[64:67], a[136:139], v[168:171], v[64:67]
  v_add_f32 v121, v121, v205
  v_add_f32 v122, v122, v206
  s_waitcnt vmcnt(7)
  v_mfma_f32_16x16x32_bf16 v[48:51], a[140:143], v[172:175], v[48:51]
  buffer_load_dwordx4 v[140:143], v2, s[60:63], s19 offen offset:1024 sc1
  v_add_f32 v123, v123, v207
  v_mfma_f32_16x16x32_bf16 v[52:55], a[144:147], v[172:175], v[52:55]
  v_add_f32 v124, v124, v208
  v_add_f32 v125, v125, v209
  v_mfma_f32_16x16x32_bf16 v[56:59], a[148:151], v[172:175], v[56:59]
  v_add_f32 v126, v126, v210
  v_add_f32 v127, v127, v211
  v_mfma_f32_16x16x32_bf16 v[60:63], a[152:155], v[172:175], v[60:63]
  s_waitcnt lgkmcnt(0)
  v_add_f32 v108, v108, v212
  v_mfma_f32_16x16x32_bf16 v[64:67], a[156:159], v[172:175], v[64:67]
  v_add_f32 v109, v109, v213
  v_add_f32 v110, v110, v214
  s_waitcnt vmcnt(7)
  v_mfma_f32_16x16x32_bf16 v[48:51], a[160:163], v[176:179], v[48:51]
  buffer_load_dwordx4 v[144:147], v2, s[60:63], s19 offen offset:2048 sc1
  v_add_f32 v111, v111, v215
  v_mfma_f32_16x16x32_bf16 v[52:55], a[164:167], v[176:179], v[52:55]
  v_add_f32 v112, v112, v216
  v_add_f32 v113, v113, v217
  v_mfma_f32_16x16x32_bf16 v[56:59], a[168:171], v[176:179], v[56:59]
  v_add_f32 v114, v114, v218
  v_add_f32 v115, v115, v219
  v_mfma_f32_16x16x32_bf16 v[60:63], a[172:175], v[176:179], v[60:63]
  v_add_f32 v116, v116, v220
  v_add_f32 v117, v117, v221
  v_mfma_f32_16x16x32_bf16 v[64:67], a[176:179], v[176:179], v[64:67]
  v_add_f32 v118, v118, v222
  v_add_f32 v119, v119, v223
  s_waitcnt vmcnt(7)
  v_mfma_f32_16x16x32_bf16 v[48:51], a[180:183], v[180:183], v[48:51]
  buffer_load_dwordx4 v[148:151], v2, s[60:63], s19 offen offset:3072 sc1
  v_add_f32 v120, v120, v224
  v_mfma_f32_16x16x32_bf16 v[52:55], a[184:187], v[180:183], v[52:55]
  v_add_f32 v121, v121, v225
  v_add_f32 v122, v122, v226
  v_mfma_f32_16x16x32_bf16 v[56:59], a[188:191], v[180:183], v[56:59]
  v_add_f32 v123, v123, v227
  v_add_f32 v124, v124, v228
  v_mfma_f32_16x16x32_bf16 v[60:63], a[192:195], v[180:183], v[60:63]
  v_add_f32 v125, v125, v229
  v_add_f32 v126, v126, v230
  v_mfma_f32_16x16x32_bf16 v[64:67], a[196:199], v[180:183], v[64:67]
  v_add_f32 v127, v127, v231
  s_waitcnt vmcnt(7)
  v_mfma_f32_16x16x32_bf16 v[68:71], a[0:3], v[184:187], v[108:111]
  s_add_u32 s19, s19, 4096
  buffer_load_dwordx4 v[152:155], v2, s[60:63], s19 offen offset:0 sc1
  v_mfma_f32_16x16x32_bf16 v[72:75], a[4:7], v[184:187], v[112:115]
  v_mfma_f32_16x16x32_bf16 v[76:79], a[8:11], v[184:187], v[116:119]
  v_mfma_f32_16x16x32_bf16 v[80:83], a[12:15], v[184:187], v[120:123]
  v_mfma_f32_16x16x32_bf16 v[84:87], a[16:19], v[184:187], v[124:127]
  s_waitcnt vmcnt(7)
  v_mfma_f32_16x16x32_bf16 v[68:71], a[20:23], v[188:191], v[68:71]
  ds_write_b128 v46, v[48:51] offset:0
  v_mfma_f32_16x16x32_bf16 v[72:75], a[24:27], v[188:191], v[72:75]
  ds_write_b128 v46, v[52:55] offset:1024
  v_mfma_f32_16x16x32_bf16 v[76:79], a[28:31], v[188:191], v[76:79]
  buffer_load_dwordx4 v[156:159], v2, s[60:63], s19 offen offset:1024 sc1
  v_mfma_f32_16x16x32_bf16 v[80:83], a[32:35], v[188:191], v[80:83]
  v_mfma_f32_16x16x32_bf16 v[84:87], a[36:39], v[188:191], v[84:87]
  s_waitcnt vmcnt(7)
  v_mfma_f32_16x16x32_bf16 v[68:71], a[40:43], v[128:131], v[68:71]
  ds_write_b128 v46, v[56:59] offset:2048
  v_mfma_f32_16x16x32_bf16 v[72:75], a[44:47], v[128:131], v[72:75]
  ds_write_b128 v46, v[60:63] offset:3072
  v_mfma_f32_16x16x32_bf16 v[76:79], a[48:51], v[128:131], v[76:79]
  v_mfma_f32_16x16x32_bf16 v[80:83], a[52:55], v[128:131], v[80:83]
  v_mfma_f32_16x16x32_bf16 v[84:87], a[56:59], v[128:131], v[84:87]
  s_waitcnt vmcnt(6)
  v_mfma_f32_16x16x32_bf16 v[68:71], a[60:63], v[132:135], v[68:71]
  ds_write_b128 v46, v[64:67] offset:4096
  v_mfma_f32_16x16x32_bf16 v[72:75], a[64:67], v[132:135], v[72:75]
  v_mfma_f32_16x16x32_bf16 v[76:79], a[68:71], v[132:135], v[76:79]
  v_mfma_f32_16x16x32_bf16 v[80:83], a[72:75], v[132:135], v[80:83]
  v_mfma_f32_16x16x32_bf16 v[84:87], a[76:79], v[132:135], v[84:87]
  s_waitcnt vmcnt(5)
  v_mfma_f32_16x16x32_bf16 v[68:71], a[80:83], v[136:139], v[68:71]
  s_mul_i32 s15, s7, 5120
  v_mfma_f32_16x16x32_bf16 v[72:75], a[84:87], v[136:139], v[72:75]
  v_add_u32_e64 v47, s15, v2
  v_mfma_f32_16x16x32_bf16 v[76:79], a[88:91], v[136:139], v[76:79]
  v_mfma_f32_16x16x32_bf16 v[80:83], a[92:95], v[136:139], v[80:83]
  v_mfma_f32_16x16x32_bf16 v[84:87], a[96:99], v[136:139], v[84:87]
  s_waitcnt vmcnt(4)
  v_mfma_f32_16x16x32_bf16 v[68:71], a[100:103], v[140:143], v[68:71]
  s_waitcnt vmcnt(0)
  s_waitcnt lgkmcnt(0)
  s_barrier
  ds_read_b128 v[192:195], v47 offset:0
  v_mfma_f32_16x16x32_bf16 v[72:75], a[104:107], v[140:143], v[72:75]
  ds_read_b128 v[196:199], v47 offset:1024
  v_mfma_f32_16x16x32_bf16 v[76:79], a[108:111], v[140:143], v[76:79]
  ds_read_b128 v[200:203], v47 offset:2048
  v_mfma_f32_16x16x32_bf16 v[80:83], a[112:115], v[140:143], v[80:83]
  ds_read_b128 v[204:207], v47 offset:3072
  v_mfma_f32_16x16x32_bf16 v[84:87], a[116:119], v[140:143], v[84:87]
  ds_read_b128 v[208:211], v47 offset:4096
  v_mfma_f32_16x16x32_bf16 v[68:71], a[120:123], v[144:147], v[68:71]
  v_mfma_f32_16x16x32_bf16 v[72:75], a[124:127], v[144:147], v[72:75]
  v_mfma_f32_16x16x32_bf16 v[76:79], a[128:131], v[144:147], v[76:79]
  v_mfma_f32_16x16x32_bf16 v[80:83], a[132:135], v[144:147], v[80:83]
  v_mfma_f32_16x16x32_bf16 v[84:87], a[136:139], v[144:147], v[84:87]
  v_mfma_f32_16x16x32_bf16 v[68:71], a[140:143], v[148:151], v[68:71]
  v_mfma_f32_16x16x32_bf16 v[72:75], a[144:147], v[148:151], v[72:75]
  v_mfma_f32_16x16x32_bf16 v[76:79], a[148:151], v[148:151], v[76:79]
  v_mfma_f32_16x16x32_bf16 v[80:83], a[152:155], v[148:151], v[80:83]
  v_mfma_f32_16x16x32_bf16 v[84:87], a[156:159], v[148:151], v[84:87]
  v_mfma_f32_16x16x32_bf16 v[68:71], a[160:163], v[152:155], v[68:71]
  v_mfma_f32_16x16x32_bf16 v[72:75], a[164:167], v[152:155], v[72:75]
  v_mfma_f32_16x16x32_bf16 v[76:79], a[168:171], v[152:155], v[76:79]
  v_mfma_f32_16x16x32_bf16 v[80:83], a[172:175], v[152:155], v[80:83]
  v_mfma_f32_16x16x32_bf16 v[84:87], a[176:179], v[152:155], v[84:87]
  v_mfma_f32_16x16x32_bf16 v[68:71], a[180:183], v[156:159], v[68:71]
  v_mfma_f32_16x16x32_bf16 v[72:75], a[184:187], v[156:159], v[72:75]
  v_mfma_f32_16x16x32_bf16 v[76:79], a[188:191], v[156:159], v[76:79]
  v_mfma_f32_16x16x32_bf16 v[80:83], a[192:195], v[156:159], v[80:83]
  v_mfma_f32_16x16x32_bf16 v[84:87], a[196:199], v[156:159], v[84:87]
  s_lshl_b32 s12, s5, 15
  s_lshl_b32 s13, s7, 8
  s_add_u32 s12, s12, s13
  s_add_u32 s12, s12, 1312768
  s_lshl_b32 s13, s6, 12
  s_add_u32 s13, s13, s12
  s_waitcnt lgkmcnt(0)
  v_pk_add_f32 v[68:69], v[68:69], v[192:193]
  v_pk_add_f32 v[70:71], v[70:71], v[194:195]
  v_pk_add_f32 v[72:73], v[72:73], v[196:197]
  v_pk_add_f32 v[74:75], v[74:75], v[198:199]
  v_pk_add_f32 v[76:77], v[76:77], v[200:201]
  v_pk_add_f32 v[78:79], v[78:79], v[202:203]
  v_pk_add_f32 v[80:81], v[80:81], v[204:205]
  v_pk_add_f32 v[82:83], v[82:83], v[206:207]
  v_pk_add_f32 v[84:85], v[84:85], v[208:209]
  v_pk_add_f32 v[86:87], v[86:87], v[210:211]
  v_pk_add_f32 v[212:213], v[68:69], v[70:71]
  v_pk_mul_f32 v[214:215], v[68:69], v[68:69]
  v_pk_fma_f32 v[214:215], v[70:71], v[70:71], v[214:215]
  v_pk_add_f32 v[212:213], v[212:213], v[72:73]
  v_pk_fma_f32 v[214:215], v[72:73], v[72:73], v[214:215]
  v_pk_add_f32 v[212:213], v[212:213], v[74:75]
  v_pk_fma_f32 v[214:215], v[74:75], v[74:75], v[214:215]
  v_pk_add_f32 v[212:213], v[212:213], v[76:77]
  v_pk_fma_f32 v[214:215], v[76:77], v[76:77], v[214:215]
  v_pk_add_f32 v[212:213], v[212:213], v[78:79]
  v_pk_fma_f32 v[214:215], v[78:79], v[78:79], v[214:215]
  v_pk_add_f32 v[212:213], v[212:213], v[80:81]
  v_pk_fma_f32 v[214:215], v[80:81], v[80:81], v[214:215]
  v_pk_add_f32 v[212:213], v[212:213], v[82:83]
  v_pk_fma_f32 v[214:215], v[82:83], v[82:83], v[214:215]
  v_pk_add_f32 v[212:213], v[212:213], v[84:85]
  v_pk_fma_f32 v[214:215], v[84:85], v[84:85], v[214:215]
  v_pk_add_f32 v[212:213], v[212:213], v[86:87]
  v_pk_fma_f32 v[214:215], v[86:87], v[86:87], v[214:215]
  v_add_f32 v228, v212, v213
  v_add_f32 v229, v214, v215
  v_mov_b32 v230, s8
  v_mov_b32 v231, s8
  v_mov_b32 v212, v228
  v_mov_b32 v213, v229
  s_nop 0
  v_permlane32_swap_b32 v228, v212
  v_permlane32_swap_b32 v229, v213
  v_add_f32 v228, v228, v212
  v_add_f32 v229, v229, v213
  v_mov_b32 v212, v228
  v_mov_b32 v213, v229
  s_nop 0
  v_permlane16_swap_b32 v228, v212
  v_permlane16_swap_b32 v229, v213
  v_add_f32 v228, v228, v212
  v_add_f32 v229, v229, v213
  s_mov_b64 exec, 0xffff
  s_cmp_eq_u32 s9, 0
  s_cbranch_scc1 slow_85
  buffer_store_dwordx4 v[228:231], v2, s[52:55], s13 offen
back_86:
  s_mov_b64 exec, -1
  s_mul_i32 s14, s7, 10240
  s_add_u32 s14, s14, 102400
  v_lshrrev_b32 v12, 1, v3
  v_xor_b32 v12, v12, v4
  v_and_b32 v12, 3, v12
  v_lshlrev_b32_e64 v12, 4, v12
  v_lshl_add_u32 v12, v3, 6, v12
  v_add_u32_e64 v44, s14, v12
  ds_write_b128 v44, v[68:71] offset:0
  ds_write_b128 v44, v[72:75] offset:1024
  ds_write_b128 v44, v[76:79] offset:2048
  ds_write_b128 v44, v[80:83] offset:3072
  ds_write_b128 v44, v[84:87] offset:4096
  v_lshrrev_b32 v12, 3, v1
  v_xor_b32 v12, v12, v1
  v_and_b32 v12, 3, v12
  v_lshlrev_b32 v12, 4, v12
  v_lshrrev_b32_e64 v13, 2, v1
  v_lshl_add_u32 v12, v13, 6, v12
  v_add_u32_e64 v45, s14, v12
  ds_read_b128 v[160:163], v45 offset:0
  ds_read_b128 v[164:167], v45 offset:1024
  ds_read_b128 v[168:171], v45 offset:2048
  ds_read_b128 v[172:175], v45 offset:3072
  ds_read_b128 v[176:179], v45 offset:4096
  v_and_b32 v14, 3, v1
  v_lshlrev_b32 v11, 13, v14
  v_lshl_add_u32 v11, v13, 4, v11
  s_add_u32 s13, s12, 4096
  v_lshrrev_b32_e64 v12, 2, v13
  v_lshl_add_u32 v12, v12, 2, v13
  v_mul_u32_u24 v12, 2560, v12
  v_lshl_add_u32 v46, v14, 4, v12
  s_lshl_b32 s15, s5, 6
  s_lshr_b32 s88, s7, 1
  s_lshl_b32 s88, s88, 5
  s_add_u32 s15, s15, s88
  s_and_b32 s88, s7, 1
  s_lshl_b32 s88, s88, 2
  s_add_u32 s15, s15, s88
  s_mul_i32 s15, s15, 2560
  s_mul_i32 s88, s6, 320
  s_add_u32 s15, s15, s88
again_87:
  buffer_load_dwordx3 v[128:130], v11, s[52:55], s12 offen sc1
  buffer_load_dwordx3 v[132:134], v11, s[52:55], s13 offen sc1
  s_sub_u32 s10, s10, 1
  s_cmp_gt_i32 s10, 0
  s_waitcnt vmcnt(0)
  v_xor_b32 v15, s8, v130
  v_xor_b32 v14, s8, v134
  v_or_b32 v15, v15, v14
  v_cmp_ne_u32 vcc, 0, v15
  s_cbranch_scc0 out_89
  s_cbranch_vccnz again_87
out_89:
ok_88:
  s_waitcnt lgkmcnt(0)
  v_pk_add_f32 v[128:129], v[128:129], v[132:133]
  s_nop 1
  v_add_f32_dpp v128, v128, v128 quad_perm:[1,0,3,2] row_mask:0xf bank_mask:0xf
  v_add_f32_dpp v129, v129, v129 quad_perm:[1,0,3,2] row_mask:0xf bank_mask:0xf
  s_nop 0
  v_add_f32_dpp v128, v128, v128 quad_perm:[2,3,0,1] row_mask:0xf bank_mask:0xf
  v_add_f32_dpp v129, v129, v129 quad_perm:[2,3,0,1] row_mask:0xf bank_mask:0xf
  v_mul_f32 v128, 0x3acccccd, v128
  v_mul_f32 v202, 0x3acccccd, v129
  v_fma_f32 v202, -v128, v128, v202
  v_max_f32_e64 v202, 0, v202
  v_add_f32 v202, 0x3727c5ac, v202
  v_rsq_f32 v200, v202
  s_nop 0
  v_mul_f32_e64 v201, v128, v200
  v_pk_fma_f32 v[132:133], v[160:161], v[200:201], v[200:201] op_sel:[0,0,1] op_sel_hi:[1,0,1] neg_lo:[0,0,1] neg_hi:[0,0,1]
  v_pk_fma_f32 v[134:135], v[162:163], v[200:201], v[200:201] op_sel:[0,0,1] op_sel_hi:[1,0,1] neg_lo:[0,0,1] neg_hi:[0,0,1]
  v_pk_fma_f32 v[160:161], v[132:133], v[88:89], v[160:161]
  v_pk_fma_f32 v[162:163], v[134:135], v[90:91], v[162:163]
  s_cmp_eq_u32 s9, 0
  s_cbranch_scc1 slow_90
  buffer_store_dwordx4 v[160:163], v46, s[60:63], s15 offen offset:0
back_91:
  v_pk_fma_f32 v[136:137], v[164:165], v[200:201], v[200:201] op_sel:[0,0,1] op_sel_hi:[1,0,1] neg_lo:[0,0,1] neg_hi:[0,0,1]
  v_pk_fma_f32 v[138:139], v[166:167], v[200:201], v[200:201] op_sel:[0,0,1] op_sel_hi:[1,0,1] neg_lo:[0,0,1] neg_hi:[0,0,1]
  v_pk_fma_f32 v[164:165], v[136:137], v[92:93], v[164:165]
  v_pk_fma_f32 v[166:167], v[138:139], v[94:95], v[166:167]
  s_cmp_eq_u32 s9, 0
  s_cbranch_scc1 slow_92
  buffer_store_dwordx4 v[164:167], v46, s[60:63], s15 offen offset:64
back_93:
  v_pk_fma_f32 v[132:133], v[168:169], v[200:201], v[200:201] op_sel:[0,0,1] op_sel_hi:[1,0,1] neg_lo:[0,0,1] neg_hi:[0,0,1]
  v_pk_fma_f32 v[134:135], v[170:171], v[200:201], v[200:201] op_sel:[0,0,1] op_sel_hi:[1,0,1] neg_lo:[0,0,1] neg_hi:[0,0,1]
  v_pk_fma_f32 v[168:169], v[132:133], v[96:97], v[168:169]
  v_pk_fma_f32 v[170:171], v[134:135], v[98:99], v[170:171]
  s_cmp_eq_u32 s9, 0
  s_cbranch_scc1 slow_94
  buffer_store_dwordx4 v[168:171], v46, s[60:63], s15 offen offset:128
back_95:
  v_pk_fma_f32 v[136:137], v[172:173], v[200:201], v[200:201] op_sel:[0,0,1] op_sel_hi:[1,0,1] neg_lo:[0,0,1] neg_hi:[0,0,1]
  v_pk_fma_f32 v[138:139], v[174:175], v[200:201], v[200:201] op_sel:[0,0,1] op_sel_hi:[1,0,1] neg_lo:[0,0,1] neg_hi:[0,0,1]
  v_pk_fma_f32 v[172:173], v[136:137], v[100:101], v[172:173]
  v_pk_fma_f32 v[174:175], v[138:139], v[102:103], v[174:175]
  s_cmp_eq_u32 s9, 0
  s_cbranch_scc1 slow_96
  buffer_store_dwordx4 v[172:175], v46, s[60:63], s15 offen offset:192
back_97:
  v_pk_fma_f32 v[132:133], v[176:177], v[200:201], v[200:201] op_sel:[0,0,1] op_sel_hi:[1,0,1] neg_lo:[0,0,1] neg_hi:[0,0,1]
  v_pk_fma_f32 v[134:135], v[178:179], v[200:201], v[200:201] op_sel:[0,0,1] op_sel_hi:[1,0,1] neg_lo:[0,0,1] neg_hi:[0,0,1]
  v_pk_fma_f32 v[176:177], v[132:133], v[104:105], v[176:177]
  v_pk_fma_f32 v[178:179], v[134:135], v[106:107], v[178:179]
  s_cmp_eq_u32 s9, 0
  s_cbranch_scc1 slow_98
  buffer_store_dwordx4 v[176:179], v46, s[60:63], s15 offen offset:256
back_99:
L_end:
  s_endpgm
again_13:
  s_sub_u32 s10, s10, 1
  s_cmp_gt_i32 s10, 0
  s_cbranch_scc0 ok_14
  buffer_load_dword v184, v185, s[52:55], s89 offen sc1
  s_waitcnt vmcnt(0)
  v_xor_b32 v15, s8, v184
  v_cmp_lt_u32 vcc, 15, v15
  s_cbranch_vccz ok_14
  s_and_b32 s13, s10, 3
  s_cbranch_scc1 again_13
  buffer_load_dword v184, v185, s[52:55], s89 offen offset:128 sc1
  s_waitcnt vmcnt(0)
  v_xor_b32 v15, s8, v184
  v_cmp_lt_u32 vcc, 15, v15
  s_cbranch_vccnz again_13
  s_branch ok_14
again_15:
  s_sub_u32 s10, s10, 1
  s_cmp_gt_i32 s10, 0
  s_cbranch_scc0 ok_16
  buffer_load_dword v184, v185, s[52:55], s89 offen sc1
  s_waitcnt vmcnt(0)
  v_xor_b32 v15, s8, v184
  v_cmp_lt_u32 vcc, 15, v15
  s_cbranch_vccz ok_16
  s_and_b32 s13, s10, 3
  s_cbranch_scc1 again_15
  buffer_load_dword v184, v185, s[52:55], s89 offen offset:128 sc1
  s_waitcnt vmcnt(0)
  v_xor_b32 v15, s8, v184
  v_cmp_lt_u32 vcc, 15, v15
  s_cbranch_vccnz again_15
  s_branch ok_16
slow_17:
  buffer_store_dword v15, off, s[52:55], s41 sc1
  s_nop 1
  s_branch back_18
again_19:
  s_sub_u32 s10, s10, 1
  s_cmp_gt_i32 s10, 0
  s_cbranch_scc0 ok_20
  buffer_load_dwordx2 v[188:189], v187, s[52:55], s87 offen sc1
  s_waitcnt vmcnt(0)
  v_xor_b32 v15, s8, v188
  v_xor_b32 v14, s8, v189
  v_or_b32 v15, v15, v14
  v_cmp_ne_u32 vcc, 0, v15
  s_cbranch_vccnz again_19
  s_branch ok_20
again_21:
  s_sub_u32 s10, s10, 1
  s_cmp_gt_i32 s10, 0
  s_cbranch_scc0 ok_22
  buffer_load_dwordx3 v[152:154], v160, s[52:55], s93 offen sc1
  buffer_load_dwordx2 v[156:157], v161, s[52:55], s94 offen sc1
  buffer_load_dwordx2 v[158:159], v162, s[52:55], s94 offen offset:512 sc1
  s_waitcnt vmcnt(0)
  v_min3_u32 v15, v154, v154, s8
  v_max3_u32 v14, v154, v154, s8
  v_min3_u32 v15, v15, v157, v159
  v_max3_u32 v14, v14, v157, v159
  v_cmp_ne_u32 vcc, v15, v14
  s_cbranch_vccnz again_21
  s_branch ok_22
again_23:
  s_sub_u32 s10, s10, 1
  s_cmp_gt_i32 s10, 0
  s_cbranch_scc0 ok_24
  buffer_load_dwordx4 v[220:223], v2, s[52:55], s36 offen sc1
  s_waitcnt vmcnt(0)
  v_min3_u32 v15, v220, v221, s8
  v_max3_u32 v14, v220, v221, s8
  v_min3_u32 v15, v15, v222, v223
  v_max3_u32 v14, v14, v222, v223
  v_cmp_ne_u32 vcc, v15, v14
  s_cbranch_vccnz again_23
  s_branch ok_24
again_25:
  s_sub_u32 s10, s10, 1
  s_cmp_gt_i32 s10, 0
  s_cbranch_scc0 ok_26
  buffer_load_dwordx4 v[188:191], v187, s[52:55], s88 offen sc1
  s_waitcnt vmcnt(0)
  v_min3_u32 v15, v188, v189, s8
  v_max3_u32 v14, v188, v189, s8
  v_min3_u32 v15, v15, v190, v191
  v_max3_u32 v14, v14, v190, v191
  v_cmp_ne_u32 vcc, v15, v14
  s_cbranch_vccnz again_25
  s_branch ok_26
slow_38:
  buffer_store_dword v15, off, s[52:55], s14 sc1
  s_nop 1
  s_branch back_39
slow_41:
  buffer_store_dword v15, off, s[52:55], s14 sc1
  s_nop 1
  s_branch back_42
again_44:
  s_sub_u32 s10, s10, 1
  s_cmp_gt_i32 s10, 0
  s_cbranch_scc0 ok_45
  buffer_load_dwordx4 v[120:123], v2, s[52:55], s92 offen sc1
  s_waitcnt vmcnt(0)
  v_min3_u32 v15, v120, v121, s8
  v_max3_u32 v14, v120, v121, s8
  v_min3_u32 v15, v15, v122, v123
  v_max3_u32 v14, v14, v122, v123
  v_cmp_ne_u32 vcc, v15, v14
  s_cbranch_vccnz again_44
  s_branch ok_45
again_49:
  s_sub_u32 s10, s10, 1
  s_cmp_gt_i32 s10, 0
  s_cbranch_scc0 ok_50
  s_mul_i32 s95, s7, 10240
  s_add_u32 s95, s95, 107520
  s_and_b32 s93, s7, 1
  s_lshl_b32 s93, s93, 3
  s_add_u32 s93, s93, s95
  v_add_u32 v253, s93, v2
  s_add_u32 m0, s95, 0
  s_add_u32 s93, s92, 0
  buffer_load_dwordx4 v252, s[52:55], s93 offen sc1 lds
  s_add_u32 m0, s95, 1024
  s_add_u32 s93, s92, 65536
  buffer_load_dwordx4 v252, s[52:55], s93 offen sc1 lds
  s_add_u32 m0, s95, 2048
  s_add_u32 s93, s92, 131072
  buffer_load_dwordx4 v252, s[52:55], s93 offen sc1 lds
  s_add_u32 m0, s95, 3072
  s_add_u32 s93, s92, 196608
  buffer_load_dwordx4 v252, s[52:55], s93 offen sc1 lds
  s_add_u32 m0, s95, 4096
  s_add_u32 s93, s92, 262144
  buffer_load_dwordx4 v252, s[52:55], s93 offen sc1 lds
  s_waitcnt vmcnt(0)
  ds_read_b64_tr_b16 v[232:233], v253 offset:0
  ds_read_b64_tr_b16 v[234:235], v253 offset:1024
  ds_read_b64_tr_b16 v[236:237], v253 offset:2048
  ds_read_b64_tr_b16 v[238:239], v253 offset:3072
  ds_read_b64_tr_b16 v[240:241], v253 offset:4096
  s_waitcnt lgkmcnt(0)
  v_pk_max_u16 v15, v232, v233
  v_pk_max_u16 v15, v15, v234
  v_pk_max_u16 v15, v15, v235
  v_pk_max_u16 v15, v15, v236
  v_pk_max_u16 v15, v15, v237
  v_pk_max_u16 v15, v15, v238
  v_pk_max_u16 v15, v15, v239
  v_pk_max_u16 v15, v15, v240
  v_pk_max_u16 v15, v15, v241
  v_lshlrev_b32 v14, 16, v15
  v_max_u32 v15, v15, v14
  v_cmp_le_u32 vcc, 0xffff0000, v15
  s_cbranch_vccnz again_49
  s_branch ok_50
slow_51:
  buffer_store_dwordx4 v[228:231], v2, s[52:55], s13 offen sc1
  s_nop 1
  s_branch back_52
slow_56:
  buffer_store_dword v15, off, s[52:55], s13 sc1
  s_nop 1
  s_branch back_57
slow_70:
  buffer_store_dwordx4 v[52:55], v47, s[60:63], s13 offen sc1
  s_nop 1
  s_branch back_71
slow_72:
  buffer_store_dwordx4 v[60:63], v47, s[60:63], s13 offen sc1
  s_nop 1
  s_branch back_73
slow_74:
  buffer_store_dwordx4 v[68:71], v47, s[60:63], s13 offen sc1
  s_nop 1
  s_branch back_75
slow_76:
  buffer_store_dwordx4 v[76:79], v47, s[60:63], s13 offen sc1
  s_nop 1
  s_branch back_77
slow_78:
  buffer_store_dwordx4 v[84:87], v47, s[60:63], s13 offen sc1
  s_nop 1
  s_branch back_79
slow_80:
  buffer_store_dword v15, off, s[52:55], s14 sc1
  s_nop 1
  s_branch back_81
slow_85:
  buffer_store_dwordx4 v[228:231], v2, s[52:55], s13 offen sc1
  s_nop 1
  s_branch back_86
slow_90:
  buffer_store_dwordx4 v[160:163], v46, s[60:63], s15 offen offset:0 sc1
  s_nop 1
  s_branch back_91
slow_92:
  buffer_store_dwordx4 v[164:167], v46, s[60:63], s15 offen offset:64 sc1
  s_nop 1
  s_branch back_93
slow_94:
  buffer_store_dwordx4 v[168:171], v46, s[60:63], s15 offen offset:128 sc1
  s_nop 1
  s_branch back_95
slow_96:
  buffer_store_dwordx4 v[172:175], v46, s[60:63], s15 offen offset:192 sc1
  s_nop 1
  s_branch back_97
slow_98:
  buffer_store_dwordx4 v[176:179], v46, s[60:63], s15 offen offset:256 sc1
  s_nop 1
  s_branch back_99
  s_endpgm
L_codeend:
.section .rodata,"a"
.p2align 6
.amdhsa_kernel interleave_layers__ssm_conv_s5__ssm_conv_h3__prompt_kernel
  .amdhsa_next_free_vgpr 512
  .amdhsa_next_free_sgpr 102
  .amdhsa_accum_offset 256
  .amdhsa_group_segment_fixed_size 0
  .amdhsa_kernarg_size 144
  .amdhsa_user_sgpr_count 2
  .amdhsa_user_sgpr_kernarg_segment_ptr 1
  .amdhsa_system_sgpr_workgroup_id_x 1
.end_amdhsa_kernel
```

```asm
; @launch grid=(256,1,1) block=(256,1,1) lds=163840
.amdgcn_target "amdgcn-amd-amdhsa--gfx950"
.text
.globl interleave_layers__ssm_conv_s5__ssm_conv_h3__prompt_kernel
.p2align 8
.type interleave_layers__ssm_conv_s5__ssm_conv_h3__prompt_kernel,@function
interleave_layers__ssm_conv_s5__ssm_conv_h3__prompt_kernel:
  s_cmp_ge_u32 s2, 256
  s_cbranch_scc1 L_end
  s_load_dwordx16 s[16:31], s[0:1], 0
  s_load_dwordx16 s[32:47], s[0:1], 64
  s_load_dwordx4 s[48:51], s[0:1], 128
  v_and_b32 v1, 63, v0
  v_lshrrev_b32 v11, 6, v0
  v_lshlrev_b32 v2, 4, v1
  v_readfirstlane_b32 s7, v11
  v_and_b32 v3, 15, v1
  v_lshrrev_b32 v4, 4, v1
  s_and_b32 s12, s2, 7
  s_lshr_b32 s13, s2, 3
  s_getpc_b64 s[98:99]
L_pc:
  s_and_b32 s4, s13, 15
  s_lshr_b32 s14, s13, 4
  s_lshl_b32 s3, s12, 1
  s_add_u32 s3, s3, s14
  s_mov_b32 s0, s12
  s_mov_b32 s1, s13
  s_and_b32 vcc_lo, s1, 7
  s_lshl_b32 vcc_lo, vcc_lo, 2
  s_add_u32 vcc_lo, vcc_lo, s7
  s_lshl_b32 vcc_lo, vcc_lo, 11
  v_lshl_add_u32 v15, v3, 7, vcc_lo
  v_min_u32 v15, L_codeend-L_pc-4, v15
  s_mov_b64 exec, 0xffff
  global_load_dword a250, v15, s[98:99]
  s_mov_b64 exec, -1
  v_lshrrev_b32 v11, 3, v1
  v_and_b32_e64 v13, 7, v1
  v_mul_u32_u24 v150, 1280, v11
  v_lshl_add_u32 v150, v13, 4, v150
  s_mul_i32 s12, s1, 81920
  s_lshl_b32 s13, s0, 7
  s_add_u32 s12, s12, s13
  v_add_u32 v169, s12, v150
  s_lshl_b32 s95, s0, 5
  s_add_u32 s95, s95, s1
  s_mul_i32 s12, s95, 10240
  s_add_u32 s12, s12, 1024
  v_add_u32 v170, s12, v150
  s_cmp_eq_u32 s7, 1
  s_cbranch_scc1 w1_3
  s_cmp_eq_u32 s7, 2
  s_cbranch_scc1 w2_4
  s_cmp_eq_u32 s7, 3
  s_cbranch_scc1 w3_5
w0_2:
  s_waitcnt lgkmcnt(0)
  s_mov_b32 s60, s36
  s_and_b32 s61, s37, 0xffff
  s_mov_b32 s62, 2621440
  s_mov_b32 s63, 0x20000
  s_mov_b32 m0, 119840
  s_nop 0
  buffer_load_dwordx4 v169, s[60:63], 0 offen nt lds
  s_mov_b32 m0, 120896
  s_mov_b32 s12, 10240
  buffer_load_dwordx4 v169, s[60:63], s12 offen nt lds
  s_mov_b32 m0, 121952
  s_mov_b32 s12, 20480
  buffer_load_dwordx4 v169, s[60:63], s12 offen nt lds
  s_mov_b32 m0, 123008
  s_mov_b32 s12, 30720
  buffer_load_dwordx4 v169, s[60:63], s12 offen nt lds
  s_mov_b32 m0, 124064
  s_mov_b32 s12, 40960
  buffer_load_dwordx4 v169, s[60:63], s12 offen nt lds
  s_mov_b32 m0, 125120
  s_mov_b32 s12, 51200
  buffer_load_dwordx4 v169, s[60:63], s12 offen nt lds
  s_mov_b32 m0, 126176
  s_mov_b32 s12, 61440
  buffer_load_dwordx4 v169, s[60:63], s12 offen nt lds
  v_subrev_u32 v11, 10240, v169
  s_mov_b32 exec_lo, 0
  s_mov_b32 exec_hi, 0xffffff00
  s_mov_b32 m0, 118784
  s_nop 0
  buffer_load_dwordx4 v11, s[60:63], 0 offen nt lds
  s_mov_b64 exec, -1
  s_mov_b32 s52, s50
  s_and_b32 s53, s51, 0xffff
  s_mov_b32 s54, 41943040
  s_mov_b32 s55, 0x20000
  s_lshl_b32 s12, s3, 4
  s_add_u32 s12, s12, s4
  s_lshl_b32 s12, s12, 12
  s_add_u32 s12, s12, 1310720
  s_sub_u32 s12, s12, 0
  v_mov_b32 v11, s12
  s_lshl_b32 s12, s3, 10
  s_add_u32 s12, s12, 4096
  s_sub_u32 s12, s12, 3072
  v_cmp_lt_u32 vcc, 23, v1
  v_mov_b32 v15, s12
  s_nop 0
  v_cndmask_b32 v11, v11, v15, vcc
  s_lshl_b32 s12, s0, 11
  s_add_u32 s12, s12, 65536
  s_sub_u32 s12, s12, 3840
  v_cmp_lt_u32 vcc, 29, v1
  v_mov_b32 v15, s12
  s_nop 0
  v_cndmask_b32 v11, v11, v15, vcc
  s_lshl_b32 s12, s4, 5
  s_add_u32 s12, s12, s3
  s_mul_i32 s12, s12, 640
  s_add_u32 s12, s12, 337920
  s_sub_u32 s12, s12, 4992
  v_cmp_lt_u32 vcc, 38, v1
  v_mov_b32 v15, s12
  s_nop 0
  v_cndmask_b32 v11, v11, v15, vcc
  s_lshl_b32 s12, s4, 5
  s_add_u32 s12, s12, s3
  s_mul_i32 s12, s12, 640
  s_add_u32 s12, s12, 665600
  s_sub_u32 s12, s12, 5632
  v_cmp_lt_u32 vcc, 43, v1
  v_mov_b32 v15, s12
  s_nop 0
  v_cndmask_b32 v11, v11, v15, vcc
  s_mul_i32 s12, s4, 640
  s_add_u32 s12, s12, 303104
  s_sub_u32 s12, s12, 6272
  v_cmp_lt_u32 vcc, 48, v1
  v_mov_b32 v15, s12
  s_nop 0
  v_cndmask_b32 v11, v11, v15, vcc
  s_lshl_b32 s12, s0, 7
  s_add_u32 s12, s12, 24576
  s_sub_u32 s12, s12, 6912
  v_cmp_lt_u32 vcc, 53, v1
  v_mov_b32 v15, s12
  s_nop 0
  v_cndmask_b32 v11, v11, v15, vcc
  s_lshl_b32 s12, s0, 7
  s_add_u32 s12, s12, 32768
  s_sub_u32 s12, s12, 7040
  v_cmp_lt_u32 vcc, 54, v1
  v_mov_b32 v15, s12
  s_nop 0
  v_cndmask_b32 v11, v11, v15, vcc
  v_lshl_add_u32 v11, v1, 7, v11
  s_mov_b32 exec_hi, 16777215
  buffer_load_dword a250, v11, s[52:55], 0 offen
  s_mov_b32 exec_hi, -1
  s_branch join_1
w1_3:
  s_waitcnt lgkmcnt(0)
  v_min_u32 v11, 39, v1
  s_mul_i32 s12, s4, 80
  v_lshl_add_u32 v14, v11, 1, s12
  global_load_ushort v229, v14, s[18:19]
  global_load_ushort v230, v14, s[20:21]
  global_load_ushort v231, v14, s[30:31]
  s_mov_b32 s64, s38
  s_and_b32 s65, s39, 0xffff
  s_mov_b32 s66, 2621440
  s_mov_b32 s67, 0x20000
  s_mov_b32 m0, 132512
  s_nop 0
  buffer_load_dwordx4 v169, s[64:67], 0 offen nt lds
  s_mov_b32 m0, 133568
  s_mov_b32 s12, 10240
  buffer_load_dwordx4 v169, s[64:67], s12 offen nt lds
  s_mov_b32 m0, 134624
  s_mov_b32 s12, 20480
  buffer_load_dwordx4 v169, s[64:67], s12 offen nt lds
  s_mov_b32 m0, 135680
  s_mov_b32 s12, 30720
  buffer_load_dwordx4 v169, s[64:67], s12 offen nt lds
  s_mov_b32 m0, 136736
  s_mov_b32 s12, 40960
  buffer_load_dwordx4 v169, s[64:67], s12 offen nt lds
  s_mov_b32 m0, 137792
  s_mov_b32 s12, 51200
  buffer_load_dwordx4 v169, s[64:67], s12 offen nt lds
  s_mov_b32 m0, 138848
  s_mov_b32 s12, 61440
  buffer_load_dwordx4 v169, s[64:67], s12 offen nt lds
  s_mov_b32 m0, 139904
  s_mov_b32 s12, 71680
  buffer_load_dwordx4 v169, s[64:67], s12 offen nt lds
  s_branch join_1
w2_4:
  s_waitcnt lgkmcnt(0)
  s_mov_b32 s60, s36
  s_and_b32 s61, s37, 0xffff
  s_mov_b32 s62, 2621440
  s_mov_b32 s63, 0x20000
  s_mov_b32 s64, s38
  s_and_b32 s65, s39, 0xffff
  s_mov_b32 s66, 2621440
  s_mov_b32 s67, 0x20000
  s_mov_b32 m0, 127232
  s_mov_b32 s12, 71680
  buffer_load_dwordx4 v169, s[60:63], s12 offen nt lds
  s_mov_b32 m0, 129344
  s_nop 0
  buffer_load_dwordx4 v170, s[60:63], 0 offen nt lds
  s_mov_b32 m0, 142016
  s_nop 0
  buffer_load_dwordx4 v170, s[64:67], 0 offen nt lds
  s_mov_b32 m0, 131456
  s_mov_b32 s12, 128
  buffer_load_dwordx4 v170, s[60:63], s12 offen nt lds
  s_mov_b32 m0, 144128
  s_mov_b32 s12, 128
  buffer_load_dwordx4 v170, s[64:67], s12 offen nt lds
  v_subrev_u32 v11, 10240, v170
  s_mov_b32 exec_lo, 0
  s_mov_b32 exec_hi, 0xffffff00
  s_mov_b32 m0, 128288
  s_nop 0
  buffer_load_dwordx4 v11, s[60:63], 0 offen nt lds
  s_mov_b64 exec, -1
  v_subrev_u32 v11, 10240, v170
  s_mov_b32 exec_lo, 0
  s_mov_b32 exec_hi, 0xffffff00
  s_mov_b32 m0, 130400
  s_mov_b32 s12, 128
  buffer_load_dwordx4 v11, s[60:63], s12 offen nt lds
  s_mov_b64 exec, -1
  s_mov_b32 s64, s40
  s_and_b32 s65, s41, 0xffff
  s_mov_b32 s66, 5120
  s_mov_b32 s67, 0x20000
  s_mov_b32 m0, 143072
  s_movk_i32 s12, 4096
  buffer_load_dwordx4 v2, s[64:67], s12 offen lds
  s_mov_b32 m0, 140960
  s_lshl_b32 s12, s0, 9
  s_mov_b32 exec_hi, 0
  buffer_load_dwordx4 v2, s[64:67], s12 offen lds
  s_mov_b32 exec_hi, -1
  s_branch join_1
w3_5:
  s_waitcnt lgkmcnt(0)
  s_mov_b32 s68, s16
  s_and_b32 s69, s17, 0xffff
  s_mov_b32 s70, 2621440
  s_mov_b32 s71, 0x20000
  s_lshl_b32 s12, s3, 4
  s_add_u32 s12, s12, s4
  s_mul_i32 s12, s12, 10240
  buffer_load_dwordx4 v[48:51], v150, s[68:71], s12 offen offset:0
  buffer_load_dwordx4 v[52:55], v150, s[68:71], s12 offen offset:128
  buffer_load_dwordx4 v[56:59], v150, s[68:71], s12 offen offset:256
  buffer_load_dwordx4 v[60:63], v150, s[68:71], s12 offen offset:384
  buffer_load_dwordx4 v[64:67], v150, s[68:71], s12 offen offset:512
  buffer_load_dwordx4 v[68:71], v150, s[68:71], s12 offen offset:640
  buffer_load_dwordx4 v[72:75], v150, s[68:71], s12 offen offset:768
  buffer_load_dwordx4 v[76:79], v150, s[68:71], s12 offen offset:896
  buffer_load_dwordx4 v[80:83], v150, s[68:71], s12 offen offset:1024
  buffer_load_dwordx4 v[84:87], v150, s[68:71], s12 offen offset:1152
join_1:
  s_load_dword s8, s[50:51], 0
  s_lshl_b32 s86, s95, 1
  s_lshl_b32 s12, s86, 1
  s_load_dword s72, s[44:45], s12
  s_and_b32 s12, s95, 0xfffffffc
  s_add_u32 s12, s12, 1024
  s_load_dword s73, s[44:45], s12
  s_getreg_b32 s11, hwreg(HW_REG_XCC_ID, 0, 4)
  s_mov_b32 s10, 262144
  s_mov_b32 s2, 0x3f803f80
  v_lshrrev_b32 v11, 3, v1
  v_and_b32 v12, 6, v11
  v_and_b32 v13, 7, v1
  s_movk_i32 s15, 0x78
  v_bfe_u32 v14, s15, v12, 2
  v_xor_b32 v14, v14, v13
  v_mul_u32_u24 v146, 1280, v11
  v_lshl_add_u32 v148, v14, 4, v146
  s_and_b32 s12, s7, 1
  s_lshl_b32 s13, s12, 6
  v_xor_b32_e64 v148, s13, v148
  v_add_u32 v149, 8192, v148
  v_xor_b32 v12, v12, v13
  v_and_b32 v11, 4, v11
  v_mul_u32_u24 v11, 1280, v11
  v_lshl_add_u32 v11, v12, 4, v11
  v_add_u32_e64 v146, v11, v146
  v_add_u32 v147, 19456, v146
  s_lshr_b32 s13, s7, 1
  s_mul_i32 s75, s13, 10240
  s_lshl_b32 s12, s12, 10
  s_add_u32 s75, s75, s12
  s_mul_i32 s74, s4, 51200
  s_lshl_b32 s13, s13, 7
  s_add_u32 s74, s74, s13
  s_lshl_b32 s76, s3, 2
  s_add_u32 s76, s76, s7
  s_mul_i32 s76, s76, 40960
  s_lshl_b32 s77, s7, 11
  s_add_u32 s77, s77, 102400
  s_bitcmp1_b32 s7, 0
  s_cselect_b32 s56, s24, s22
  s_cselect_b32 s57, s25, s23
  s_and_b32 s57, s57, 0xffff
  s_mov_b32 s58, 819200
  s_mov_b32 s59, 0x20000
  s_bitcmp1_b32 s3, 3
  s_cselect_b32 s60, s24, s22
  s_cselect_b32 s61, s25, s23
  s_and_b32 s61, s61, 0xffff
  s_mov_b32 s62, 819200
  s_mov_b32 s63, 0x20000
  s_mov_b32 s68, s16
  s_and_b32 s69, s17, 0xffff
  s_mov_b32 s70, 2621440
  s_mov_b32 s71, 0x20000
  s_mov_b32 s52, s50
  s_and_b32 s53, s51, 0xffff
  s_mov_b32 s54, 41943040
  s_mov_b32 s55, 0x20000
  s_lshr_b32 s24, s95, 1
  s_add_u32 s24, s24, 512
  s_lshr_b32 s14, s4, 3
  s_lshl_b32 s5, s3, 1
  s_add_u32 s5, s5, s14
  s_and_b32 s6, s4, 7
  s_lshl_b32 s84, s3, 10
  s_lshl_b32 s13, s4, 4
  s_add_u32 s84, s84, s13
  s_lshl_b32 s13, s7, 2
  s_add_u32 s84, s84, s13
  s_lshl_b32 s85, s0, 11
  s_add_u32 s85, s85, s13
  s_lshl_b32 s13, s1, 4
  s_add_u32 s85, s85, s13
  s_lshl_b32 s83, s4, 5
  s_add_u32 s83, s83, s3
  s_mul_i32 s83, s83, 640
  s_add_u32 s83, s83, 327680
  s_cmp_eq_u32 s7, 0
  s_cselect_b32 s96, -1, 0
  s_cselect_b32 s97, 0xff, 0
  s_lshl_b32 s12, s76, 1
  s_mul_i32 s13, s4, 5
  s_add_u32 s14, s13, 0
  s_lshr_b32 s15, s14, 2
  s_lshl_b32 s15, s15, 11
  s_and_b32 s14, s14, 3
  s_lshl_b32 s14, s14, 8
  s_add_u32 s14, s14, s15
  s_add_u32 s78, s14, s12
  s_add_u32 s14, s13, 1
  s_lshr_b32 s15, s14, 2
  s_lshl_b32 s15, s15, 11
  s_and_b32 s14, s14, 3
  s_lshl_b32 s14, s14, 8
  s_add_u32 s14, s14, s15
  s_add_u32 s79, s14, s12
  s_add_u32 s14, s13, 2
  s_lshr_b32 s15, s14, 2
  s_lshl_b32 s15, s15, 11
  s_and_b32 s14, s14, 3
  s_lshl_b32 s14, s14, 8
  s_add_u32 s14, s14, s15
  s_add_u32 s80, s14, s12
  s_add_u32 s14, s13, 3
  s_lshr_b32 s15, s14, 2
  s_lshl_b32 s15, s15, 11
  s_and_b32 s14, s14, 3
  s_lshl_b32 s14, s14, 8
  s_add_u32 s14, s14, s15
  s_add_u32 s81, s14, s12
  s_add_u32 s14, s13, 4
  s_lshr_b32 s15, s14, 2
  s_lshl_b32 s15, s15, 11
  s_and_b32 s14, s14, 3
  s_lshl_b32 s14, s14, 8
  s_add_u32 s14, s14, s15
  s_add_u32 s82, s14, s12
  s_mul_i32 s12, s7, 1280
  s_add_u32 s12, s12, 13824
  v_mul_u32_u24 v11, 80, v3
  v_lshl_add_u32 v11, v4, 4, v11
  v_add_u32 v42, s12, v11
  v_bfe_u32 v12, v1, 2, 2
  v_mul_u32_u24 v12, 160, v12
  v_and_b32_e64 v13, 3, v1
  v_lshl_add_u32 v12, v13, 4, v12
  v_lshrrev_b32_e64 v13, 1, v4
  v_mul_u32_u24 v14, 80, v13
  v_lshlrev_b32_e64 v13, 10, v13
  v_add3_u32 v12, v12, v14, s12
  v_and_b32_e64 v14, 1, v4
  v_lshl_add_u32 v43, v14, 3, v12
  v_mul_u32_u24 v14, 40960, v14
  v_lshl_add_u32 v13, v3, 4, v13
  v_add_u32_e64 v44, v13, v14
  v_accvgpr_write_b32 a240, v42
  v_accvgpr_write_b32 a241, v43
  v_accvgpr_write_b32 a242, v44
  v_accvgpr_write_b32 a243, v148
  v_accvgpr_write_b32 a244, v149
  v_lshrrev_b32_e64 v11, 2, v3
  v_mul_u32_u24 v11, 5120, v11
  v_and_b32_e64 v12, 3, v3
  v_lshl_add_u32 v11, v12, 4, v11
  v_lshl_add_u32 v0, v4, 6, v11
  v_and_b32 v11, 1, v3
  v_lshrrev_b32 v12, 1, v3
  v_and_b32 v13, 6, v12
  s_movk_i32 s15, 0x78
  v_bfe_u32 v13, s15, v13, 2
  v_xor_b32_e64 v13, v13, v4
  v_lshl_add_u32 v13, v11, 2, v13
  v_lshlrev_b32_e64 v13, 4, v13
  v_lshl_add_u32 v13, v12, 7, v13
  v_lshl_add_u32 v5, v11, 10, v13
  v_xor_b32_e64 v6, 64, v5
  v_add_u32 v7, 51200, v5
  v_add_u32 v8, 51200, v6
  v_mul_u32_u24 v9, 144, v12
  v_lshl_add_u32 v9, v11, 2, v9
  v_lshl_add_u32 v9, v4, 3, v9
  s_lshl_b32 s12, s7, 5
  v_add_u32 v9, s12, v9
  v_and_b32 v11, 6, v3
  v_xor_b32 v11, v11, v4
  v_lshlrev_b32_e64 v11, 4, v11
  v_lshl_add_u32 v11, v3, 7, v11
  v_add_u32 v144, s77, v11
  v_xor_b32 v145, 64, v144
  v_lshrrev_b32 v11, 3, v1
  v_and_b32 v12, 7, v1
  v_mul_u32_u24 v13, 1056, v12
  v_lshl_add_u32 v13, v11, 3, v13
  s_lshl_b32 s12, s7, 6
  s_add_u32 s12, s12, 118784
  v_add_u32 v172, s12, v13
  s_lshl_b32 s12, s7, 8
  s_add_u32 s12, s12, 140960
  v_lshl_add_u32 v173, v11, 5, s12
  v_sub_u32 v13, 7, v12
  v_lshlrev_b32_e64 v13, 4, v13
  v_lshl_add_u32 v171, v11, 14, v13
  s_mul_i32 s12, s0, 80
  s_lshl_b32 s13, s7, 5
  s_add_u32 s12, s12, s13
  s_lshl_b32 s12, s12, 12
  s_lshl_b32 s13, s1, 7
  s_sub_u32 s12, s12, s13
  s_add_u32 s87, s12, 4198272
  s_add_u32 s41, s85, 65536
  s_movk_i32 s36, 4096
  s_cmp_lg_u32 s7, 2
  s_cbranch_scc1 skip_6
  v_bfe_u32 v13, v1, 4, 1
  v_mul_u32_u24 v13, 2112, v13
  v_and_b32_e64 v14, 15, v1
  v_lshl_add_u32 v13, v14, 3, v13
  v_add_u32 v172, 128288, v13
  v_and_b32 v13, 31, v1
  v_lshlrev_b32 v13, 5, v13
  v_add_u32 v173, 143072, v13
  v_cmp_gt_u32_e64 vcc, 32, v1
  v_mov_b32 v14, 1879048192
  s_lshl_b32 s87, s95, 11
  s_add_u32 s87, s87, 26214400
  v_cndmask_b32 v171, v14, v2, vcc
  s_lshl_b32 s41, s95, 2
  s_add_u32 s41, s41, 32768
  s_movk_i32 s36, 512
skip_6:
  s_lshl_b32 s12, s86, 12
  s_lshl_b32 s13, s7, 10
  s_add_u32 s90, s12, s13
  s_add_u32 s91, s90, 4096
  s_lshl_b32 s92, s24, 12
  s_add_u32 s92, s92, s13
  s_add_u32 s13, s13, 102432
  v_add_u32 v186, s13, v2
  v_lshrrev_b32_e64 v11, 1, v1
  v_mul_u32_u24 v11, 4160, v11
  v_and_b32_e64 v12, 1, v1
  v_lshl_add_u32 v11, v12, 4, v11
  v_add_u32 v163, 102400, v11
  s_waitcnt lgkmcnt(0)
  s_lshr_b32 s8, s8, 4
  s_mul_i32 s8, s8, 0x19660d
  s_add_u32 s8, s8, 0x3c6ef35f
  s_lshl_b32 s8, s8, 4
  s_cmp_eq_u32 s7, 1
  s_cbranch_scc1 w1_8
  s_cmp_eq_u32 s7, 2
  s_cbranch_scc1 w2_9
  s_cmp_eq_u32 s7, 3
  s_cbranch_scc1 w3_10
  s_branch join_7
w1_8:
  s_waitcnt vmcnt(8)
  v_lshlrev_b32 v229, 16, v229
  v_lshlrev_b32 v230, 16, v230
  v_lshlrev_b32 v231, 16, v231
  v_mul_f32 v231, 0x3fb8aa3b, v231
  v_exp_f32 v231, v231
  v_min_u32 v104, 39, v1
  v_mul_u32_u24 v102, 80, v104
  v_mul_u32_u24 v103, 176, v104
  v_cvt_pk_bf16_f32 v231, v231, v231
  v_and_b32 v231, 0xffff0000, v231
  v_mul_f32 v96, v231, v229
  v_mul_f32 v97, v231, v230
  v_mul_f32 v96, 0x3fb8aa3b, v96
  v_mul_f32 v97, 0x3e22f983, v97
  v_mul_f32 v98, 1.0, v96
  v_mul_f32 v99, 1.0, v97
  v_exp_f32 v98, v98
  v_fract_f32 v99, v99
  v_sin_f32 v100, v99
  v_cos_f32 v101, v99
  v_mul_f32 v107, v98, v100
  v_mul_f32_e64 v106, v98, v101
  v_mul_f32 v98, 0x41000000, v96
  v_mul_f32 v99, 0x41000000, v97
  v_exp_f32 v98, v98
  v_fract_f32 v99, v99
  v_sin_f32 v100, v99
  v_cos_f32 v101, v99
  v_mul_f32 v51, v98, v100
  v_mul_f32 v50, v98, v101
  v_mul_f32 v98, v229, v229
  v_fmac_f32 v98, v230, v230
  v_rcp_f32 v98, v98
  v_add_f32 v99, -1.0, v106
  v_add_f32 v98, v98, v98
  v_mul_f32 v100, v99, v229
  v_fmac_f32 v100, v107, v230
  v_mul_f32 v101, v107, v229
  v_fma_f32 v101, -v99, v230, v101
  v_mul_f32 v100, v98, v100
  v_mul_f32 v101, v98, v101
  v_and_b32 v98, 1, v104
  v_lshrrev_b32 v104, 1, v104
  v_lshlrev_b32_e64 v104, 4, v104
  v_lshl_add_u32 v104, v98, 2, v104
  v_add_u32 v104, 159744, v104
  v_add_u32 v102, 160640, v102
  v_add_u32 v103, 145184, v103
  ds_write2_b32 v104, v100, v101 offset0:0 offset1:2
  v_mov_b32 v48, 1.0
  v_mov_b32 v49, 0
  v_mov_b32 v84, 1.0
  v_mov_b32 v85, 0
  v_pk_mul_f32 v[52:53], v[50:51], v[50:51] op_sel:[1,1] op_sel_hi:[0,1] neg_lo:[0,1]
  v_pk_mul_f32 v[108:109], v[106:107], v[106:107] op_sel:[1,1] op_sel_hi:[0,1] neg_lo:[0,1]
  v_pk_fma_f32 v[52:53], v[50:51], v[50:51], v[52:53] op_sel:[0,0,0] op_sel_hi:[1,0,1]
  v_pk_fma_f32 v[108:109], v[106:107], v[106:107], v[108:109] op_sel:[0,0,0] op_sel_hi:[1,0,1]
  v_pk_mul_f32 v[54:55], v[52:53], v[50:51] op_sel:[1,1] op_sel_hi:[0,1] neg_lo:[0,1]
  v_pk_mul_f32 v[110:111], v[108:109], v[106:107] op_sel:[1,1] op_sel_hi:[0,1] neg_lo:[0,1]
  v_pk_fma_f32 v[54:55], v[52:53], v[50:51], v[54:55] op_sel:[0,0,0] op_sel_hi:[1,0,1]
  v_pk_fma_f32 v[110:111], v[108:109], v[106:107], v[110:111] op_sel:[0,0,0] op_sel_hi:[1,0,1]
  ds_write_b128 v103, v[48:51] offset:0
  v_pk_mul_f32 v[56:57], v[54:55], v[50:51] op_sel:[1,1] op_sel_hi:[0,1] neg_lo:[0,1]
  v_pk_mul_f32 v[112:113], v[110:111], v[106:107] op_sel:[1,1] op_sel_hi:[0,1] neg_lo:[0,1]
  v_pk_fma_f32 v[56:57], v[54:55], v[50:51], v[56:57] op_sel:[0,0,0] op_sel_hi:[1,0,1]
  v_pk_fma_f32 v[112:113], v[110:111], v[106:107], v[112:113] op_sel:[0,0,0] op_sel_hi:[1,0,1]
  v_pk_mul_f32 v[58:59], v[56:57], v[50:51] op_sel:[1,1] op_sel_hi:[0,1] neg_lo:[0,1]
  v_pk_mul_f32 v[114:115], v[112:113], v[106:107] op_sel:[1,1] op_sel_hi:[0,1] neg_lo:[0,1]
  v_pk_fma_f32 v[58:59], v[56:57], v[50:51], v[58:59] op_sel:[0,0,0] op_sel_hi:[1,0,1]
  v_pk_fma_f32 v[114:115], v[112:113], v[106:107], v[114:115] op_sel:[0,0,0] op_sel_hi:[1,0,1]
  ds_write_b128 v103, v[52:55] offset:16
  v_pk_mul_f32 v[60:61], v[58:59], v[50:51] op_sel:[1,1] op_sel_hi:[0,1] neg_lo:[0,1]
  v_pk_mul_f32 v[116:117], v[114:115], v[106:107] op_sel:[1,1] op_sel_hi:[0,1] neg_lo:[0,1]
  v_pk_fma_f32 v[60:61], v[58:59], v[50:51], v[60:61] op_sel:[0,0,0] op_sel_hi:[1,0,1]
  v_pk_fma_f32 v[116:117], v[114:115], v[106:107], v[116:117] op_sel:[0,0,0] op_sel_hi:[1,0,1]
  v_pk_mul_f32 v[62:63], v[60:61], v[50:51] op_sel:[1,1] op_sel_hi:[0,1] neg_lo:[0,1]
  v_pk_mul_f32 v[118:119], v[116:117], v[106:107] op_sel:[1,1] op_sel_hi:[0,1] neg_lo:[0,1]
  v_pk_fma_f32 v[62:63], v[60:61], v[50:51], v[62:63] op_sel:[0,0,0] op_sel_hi:[1,0,1]
  v_pk_fma_f32 v[118:119], v[116:117], v[106:107], v[118:119] op_sel:[0,0,0] op_sel_hi:[1,0,1]
  ds_write_b128 v103, v[56:59] offset:32
  v_pk_mul_f32 v[64:65], v[62:63], v[50:51] op_sel:[1,1] op_sel_hi:[0,1] neg_lo:[0,1]
  v_pk_fma_f32 v[64:65], v[62:63], v[50:51], v[64:65] op_sel:[0,0,0] op_sel_hi:[1,0,1]
  ds_write2_b32 v102, v106, v107 offset0:0 offset1:8
  v_pk_mul_f32 v[66:67], v[64:65], v[50:51] op_sel:[1,1] op_sel_hi:[0,1] neg_lo:[0,1]
  v_pk_fma_f32 v[66:67], v[64:65], v[50:51], v[66:67] op_sel:[0,0,0] op_sel_hi:[1,0,1]
  ds_write2_b32 v102, v108, v109 offset0:1 offset1:9
  ds_write_b128 v103, v[60:63] offset:48
  v_pk_mul_f32 v[68:69], v[66:67], v[50:51] op_sel:[1,1] op_sel_hi:[0,1] neg_lo:[0,1]
  v_pk_fma_f32 v[68:69], v[66:67], v[50:51], v[68:69] op_sel:[0,0,0] op_sel_hi:[1,0,1]
  ds_write2_b32 v102, v110, v111 offset0:2 offset1:10
  v_pk_mul_f32 v[70:71], v[68:69], v[50:51] op_sel:[1,1] op_sel_hi:[0,1] neg_lo:[0,1]
  v_pk_fma_f32 v[70:71], v[68:69], v[50:51], v[70:71] op_sel:[0,0,0] op_sel_hi:[1,0,1]
  ds_write2_b32 v102, v112, v113 offset0:3 offset1:11
  ds_write_b128 v103, v[64:67] offset:64
  v_pk_mul_f32 v[72:73], v[70:71], v[50:51] op_sel:[1,1] op_sel_hi:[0,1] neg_lo:[0,1]
  v_pk_fma_f32 v[72:73], v[70:71], v[50:51], v[72:73] op_sel:[0,0,0] op_sel_hi:[1,0,1]
  ds_write2_b32 v102, v114, v115 offset0:4 offset1:12
  v_pk_mul_f32 v[74:75], v[72:73], v[50:51] op_sel:[1,1] op_sel_hi:[0,1] neg_lo:[0,1]
  v_pk_fma_f32 v[74:75], v[72:73], v[50:51], v[74:75] op_sel:[0,0,0] op_sel_hi:[1,0,1]
  ds_write2_b32 v102, v116, v117 offset0:5 offset1:13
  ds_write_b128 v103, v[68:71] offset:80
  v_pk_mul_f32 v[76:77], v[74:75], v[50:51] op_sel:[1,1] op_sel_hi:[0,1] neg_lo:[0,1]
  v_pk_fma_f32 v[76:77], v[74:75], v[50:51], v[76:77] op_sel:[0,0,0] op_sel_hi:[1,0,1]
  ds_write2_b32 v102, v118, v119 offset0:6 offset1:14
  v_pk_mul_f32 v[78:79], v[76:77], v[50:51] op_sel:[1,1] op_sel_hi:[0,1] neg_lo:[0,1]
  v_pk_fma_f32 v[78:79], v[76:77], v[50:51], v[78:79] op_sel:[0,0,0] op_sel_hi:[1,0,1]
  ds_write_b128 v103, v[72:75] offset:96
  v_pk_mul_f32 v[80:81], v[78:79], v[50:51] op_sel:[1,1] op_sel_hi:[0,1] neg_lo:[0,1]
  v_pk_fma_f32 v[80:81], v[78:79], v[50:51], v[80:81] op_sel:[0,0,0] op_sel_hi:[1,0,1]
  ds_write2_b32 v102, v50, v51 offset0:7 offset1:15
  ds_write_b128 v103, v[76:79] offset:112
  v_pk_mul_f32 v[98:99], v[80:81], v[80:81] op_sel:[1,1] op_sel_hi:[0,1] neg_lo:[0,1]
  v_pk_fma_f32 v[98:99], v[80:81], v[80:81], v[98:99] op_sel:[0,0,0] op_sel_hi:[1,0,1]
  v_pk_mul_f32 v[86:87], v[98:99], v[98:99] op_sel:[1,1] op_sel_hi:[0,1] neg_lo:[0,1]
  v_pk_fma_f32 v[86:87], v[98:99], v[98:99], v[86:87] op_sel:[0,0,0] op_sel_hi:[1,0,1]
  v_pk_mul_f32 v[88:89], v[86:87], v[86:87] op_sel:[1,1] op_sel_hi:[0,1] neg_lo:[0,1]
  v_pk_fma_f32 v[88:89], v[86:87], v[86:87], v[88:89] op_sel:[0,0,0] op_sel_hi:[1,0,1]
  v_pk_mul_f32 v[90:91], v[88:89], v[86:87] op_sel:[1,1] op_sel_hi:[0,1] neg_lo:[0,1]
  v_pk_fma_f32 v[90:91], v[88:89], v[86:87], v[90:91] op_sel:[0,0,0] op_sel_hi:[1,0,1]
  ds_write_b64 v103, v[80:81] offset:128
  ds_write_b128 v103, v[84:87] offset:144
  ds_write_b128 v103, v[88:91] offset:160
  s_branch join_7
w2_9:
  v_mov_b32 v88, 0
  s_lshl_b32 s12, s0, 11
  s_lshl_b32 s13, s1, 2
  s_add_u32 s12, s12, s13
  s_add_u32 s12, s12, 66560
  s_or_b32 s13, s8, s11
  v_mov_b32 v15, s13
  s_mov_b64 exec, 1
  buffer_store_dword v15, off, s[52:55], s12
  s_mov_b64 exec, -1
  s_lshl_b32 s12, s0, 11
  s_lshl_b32 s13, s1, 2
  s_add_u32 s12, s12, s13
  s_add_u32 s12, s12, 66560
  s_or_b32 s13, s8, s11
  v_mov_b32 v15, s13
  s_mov_b64 exec, 1
  buffer_store_dword v15, off, s[52:55], s12 offset:128 sc1
  s_mov_b64 exec, -1
  v_mov_b32 v89, 0
  v_mov_b32 v90, s8
  v_mov_b32_e64 v91, s8
  s_add_u32 s12, s83, 327680
  s_mov_b32 exec_hi, 0xff
  buffer_store_dwordx4 v[88:91], v2, s[52:55], s83 offen sc1
  buffer_store_dwordx4 v[88:91], v2, s[52:55], s12 offen sc1
  s_mov_b32 exec_hi, -1
  s_branch join_7
w3_10:
  s_waitcnt vmcnt(0)
  v_dot2_f32_bf16 v88, v48, s2, 0
  v_dot2_f32_bf16 v90, v48, v48, 0
  v_dot2_f32_bf16 v88, v49, s2, v88
  v_dot2_f32_bf16 v90, v49, v49, v90
  v_dot2_f32_bf16 v88, v50, s2, v88
  v_dot2_f32_bf16 v90, v50, v50, v90
  v_dot2_f32_bf16 v88, v51, s2, v88
  v_dot2_f32_bf16 v90, v51, v51, v90
  v_dot2_f32_bf16 v88, v52, s2, v88
  v_dot2_f32_bf16 v90, v52, v52, v90
  v_dot2_f32_bf16 v88, v53, s2, v88
  v_dot2_f32_bf16 v90, v53, v53, v90
  v_dot2_f32_bf16 v88, v54, s2, v88
  v_dot2_f32_bf16 v90, v54, v54, v90
  v_dot2_f32_bf16 v88, v55, s2, v88
  v_dot2_f32_bf16 v90, v55, v55, v90
  v_dot2_f32_bf16 v88, v56, s2, v88
  v_dot2_f32_bf16 v90, v56, v56, v90
  v_dot2_f32_bf16 v88, v57, s2, v88
  v_dot2_f32_bf16 v90, v57, v57, v90
  v_dot2_f32_bf16 v88, v58, s2, v88
  v_dot2_f32_bf16 v90, v58, v58, v90
  v_dot2_f32_bf16 v88, v59, s2, v88
  v_dot2_f32_bf16 v90, v59, v59, v90
  v_dot2_f32_bf16 v88, v60, s2, v88
  v_dot2_f32_bf16 v90, v60, v60, v90
  v_dot2_f32_bf16 v88, v61, s2, v88
  v_dot2_f32_bf16 v90, v61, v61, v90
  v_dot2_f32_bf16 v88, v62, s2, v88
  v_dot2_f32_bf16 v90, v62, v62, v90
  v_dot2_f32_bf16 v88, v63, s2, v88
  v_dot2_f32_bf16 v90, v63, v63, v90
  v_dot2_f32_bf16 v88, v64, s2, v88
  v_dot2_f32_bf16 v90, v64, v64, v90
  v_dot2_f32_bf16 v88, v65, s2, v88
  v_dot2_f32_bf16 v90, v65, v65, v90
  v_dot2_f32_bf16 v88, v66, s2, v88
  v_dot2_f32_bf16 v90, v66, v66, v90
  v_dot2_f32_bf16 v88, v67, s2, v88
  v_dot2_f32_bf16 v90, v67, v67, v90
  v_dot2_f32_bf16 v88, v68, s2, v88
  v_dot2_f32_bf16 v90, v68, v68, v90
  v_dot2_f32_bf16 v88, v69, s2, v88
  v_dot2_f32_bf16 v90, v69, v69, v90
  v_dot2_f32_bf16 v88, v70, s2, v88
  v_dot2_f32_bf16 v90, v70, v70, v90
  v_dot2_f32_bf16 v88, v71, s2, v88
  v_dot2_f32_bf16 v90, v71, v71, v90
  v_dot2_f32_bf16 v88, v72, s2, v88
  v_dot2_f32_bf16 v90, v72, v72, v90
  v_dot2_f32_bf16 v88, v73, s2, v88
  v_dot2_f32_bf16 v90, v73, v73, v90
  v_dot2_f32_bf16 v88, v74, s2, v88
  v_dot2_f32_bf16 v90, v74, v74, v90
  v_dot2_f32_bf16 v88, v75, s2, v88
  v_dot2_f32_bf16 v90, v75, v75, v90
  v_dot2_f32_bf16 v88, v76, s2, v88
  v_dot2_f32_bf16 v90, v76, v76, v90
  v_dot2_f32_bf16 v88, v77, s2, v88
  v_dot2_f32_bf16 v90, v77, v77, v90
  v_dot2_f32_bf16 v88, v78, s2, v88
  v_dot2_f32_bf16 v90, v78, v78, v90
  v_dot2_f32_bf16 v88, v79, s2, v88
  v_dot2_f32_bf16 v90, v79, v79, v90
  v_dot2_f32_bf16 v88, v80, s2, v88
  v_dot2_f32_bf16 v90, v80, v80, v90
  v_dot2_f32_bf16 v88, v81, s2, v88
  v_dot2_f32_bf16 v90, v81, v81, v90
  v_dot2_f32_bf16 v88, v82, s2, v88
  v_dot2_f32_bf16 v90, v82, v82, v90
  v_dot2_f32_bf16 v88, v83, s2, v88
  v_dot2_f32_bf16 v90, v83, v83, v90
  v_dot2_f32_bf16 v88, v84, s2, v88
  v_dot2_f32_bf16 v90, v84, v84, v90
  v_dot2_f32_bf16 v88, v85, s2, v88
  v_dot2_f32_bf16 v90, v85, v85, v90
  v_dot2_f32_bf16 v88, v86, s2, v88
  v_dot2_f32_bf16 v90, v86, v86, v90
  v_dot2_f32_bf16 v88, v87, s2, v88
  v_dot2_f32_bf16 v90, v87, v87, v90
  s_nop 1
  v_add_f32_dpp v88, v88, v88 quad_perm:[1,0,3,2] row_mask:0xf bank_mask:0xf
  v_add_f32_dpp v90, v90, v90 quad_perm:[1,0,3,2] row_mask:0xf bank_mask:0xf
  s_nop 0
  v_add_f32_dpp v88, v88, v88 quad_perm:[2,3,0,1] row_mask:0xf bank_mask:0xf
  v_add_f32_dpp v90, v90, v90 quad_perm:[2,3,0,1] row_mask:0xf bank_mask:0xf
  s_nop 0
  v_add_f32_dpp v88, v88, v88 row_half_mirror row_mask:0xf bank_mask:0xf
  v_add_f32_dpp v90, v90, v90 row_half_mirror row_mask:0xf bank_mask:0xf
  v_mul_f32 v88, 0x3acccccd, v88
  v_mul_f32 v90, 0x3acccccd, v90
  v_fma_f32 v90, -v88, v88, v90
  v_max_f32_e64 v90, 0, v90
  v_cvt_pk_bf16_f32 v88, v88, v88
  v_and_b32 v88, 0xffff0000, v88
  v_cvt_pk_bf16_f32 v90, v90, v90
  v_and_b32 v90, 0xffff0000, v90
  v_add_f32 v90, 0x3727c5ac, v90
  v_cvt_pk_bf16_f32 v90, v90, v90
  v_and_b32 v90, 0xffff0000, v90
  v_sqrt_f32 v90, v90
  s_nop 0
  v_cvt_pk_bf16_f32 v90, v90, v90
  v_and_b32 v90, 0xffff0000, v90
  v_rcp_f32 v89, v90
  v_mov_b32 v90, s8
  v_mov_b32 v91, s8
  v_lshlrev_b32 v11, 1, v1
  s_lshl_b32 s12, s3, 4
  s_add_u32 s12, s12, s4
  s_lshl_b32 s12, s12, 7
  s_add_u32 s12, s12, 262144
  s_mov_b32 exec_lo, 0x01010101
  s_mov_b32 exec_hi, 0x01010101
  buffer_store_dwordx4 v[88:91], v11, s[52:55], s12 offen sc1
  s_mov_b64 exec, -1
join_7:
  s_lshl_b32 s93, s3, 11
  s_lshl_b32 s12, s7, 9
  s_add_u32 s93, s93, s12
  s_add_u32 s93, s93, 262144
  v_and_b32 v160, 7, v3
  v_lshlrev_b32_e64 v160, 4, v160
  v_lshl_add_u32 v160, v4, 7, v160
  s_mul_i32 s94, s4, 640
  s_add_u32 s94, s94, 303104
  v_lshlrev_b32 v161, 3, v1
  v_lshlrev_b32 v162, 3, v3
  v_and_b32 v187, 31, v1
  v_lshlrev_b32 v187, 4, v187
  s_lshl_b32 s88, s6, 11
  s_add_u32 s88, s88, 66048
  v_and_b32 v185, 31, v1
  v_lshlrev_b32 v185, 2, v185
  s_lshl_b32 s89, s0, 11
  s_add_u32 s89, s89, 66560
  v_add_u32 v11, 1, v3
  v_and_b32 v12, 1, v11
  v_mul_u32_u24 v12, 4160, v12
  v_lshrrev_b32_e64 v11, 1, v11
  v_lshl_add_u32 v12, v11, 2, v12
  v_lshl_add_u32 v12, v4, 4, v12
  v_sub_u32 v11, 15, v3
  v_lshlrev_b32 v11, 5, v11
  v_lshl_add_u32 v11, v4, 4, v11
  s_lshr_b32 s12, s7, 1
  s_and_b32 s13, s7, 1
  s_lshl_b32 s13, s13, 8
  s_mul_i32 s14, s12, 8320
  s_add_u32 s14, s14, s13
  s_add_u32 s14, s14, 102400
  v_add_u32_e64 v232, s14, v12
  s_mul_i32 s14, s12, 4608
  s_add_u32 s14, s14, s13
  v_add_u32 v240, s14, v11
  s_lshl_b32 s13, s7, 7
  s_add_u32 s14, s13, 119040
  v_add_u32 v236, s14, v12
  s_add_u32 s14, s13, 9216
  v_add_u32_e64 v241, s14, v11
  s_mul_i32 s13, s5, 163840
  s_mul_i32 s14, s7, 10240
  s_add_u32 s13, s13, s14
  s_add_u32 s13, s13, 0
  s_add_u32 s14, s7, 1
  s_and_b32 s14, s14, 3
  s_mul_i32 s15, s14, 40960
  s_add_u32 s16, s15, s13
  s_mul_i32 s15, s14, 10240
  s_add_u32 s15, s15, 102400
  v_add_u32 v44, s15, v2
  s_add_u32 s14, s7, 2
  s_and_b32 s14, s14, 3
  s_mul_i32 s15, s14, 40960
  s_add_u32 s17, s15, s13
  s_mul_i32 s15, s14, 10240
  s_add_u32 s15, s15, 107520
  v_add_u32 v45, s15, v2
  s_add_u32 s14, s7, 3
  s_and_b32 s14, s14, 3
  s_mul_i32 s15, s14, 40960
  s_add_u32 s18, s15, s13
  s_mul_i32 s15, s14, 5120
  v_add_u32 v46, s15, v2
  s_add_u32 s14, s7, 4
  s_and_b32 s14, s14, 3
  s_mul_i32 s15, s14, 40960
  s_add_u32 s19, s15, s13
  s_lshl_b32 s49, s3, 10
  s_lshl_b32 s13, s7, 6
  s_add_u32 s49, s49, s13
  s_and_b32 s13, s5, 1
  s_lshl_b32 s13, s13, 3
  s_add_u32 s49, s49, s13
  s_add_u32 s49, s49, 4352
  v_and_b32 v244, 3, v1
  v_lshlrev_b32 v244, 4, v244
  s_lshr_b32 s13, s7, 1
  s_add_u32 s12, s86, s13
  s_bitcmp1_b32 s12, 0
  s_cselect_b32 s14, 16, 0
  s_lshr_b32 s72, s72, s14
  s_and_b32 s30, s72, 0xffff
  s_lshl_b32 s31, s72, 16
  s_bitcmp1_b32 s24, 0
  s_cselect_b32 s14, 16, 0
  s_lshr_b32 s73, s73, s14
  s_and_b32 s25, s73, 0xffff
  s_lshl_b32 s45, s73, 16
  s_lshl_b32 s50, s12, 12
  s_and_b32 s12, s7, 1
  s_lshl_b32 s12, s12, 11
  s_add_u32 s50, s50, s12
  s_add_u32 s50, s50, 19922944
  s_mul_i32 s13, s13, 4608
  s_sub_u32 s13, s13, s12
  s_add_u32 s13, s13, 2552
  v_lshlrev_b32_e64 v246, 5, v3
  v_lshl_add_u32 v246, v4, 3, v246
  v_sub_u32 v247, s13, v246
  s_bitcmp1_b32 s1, 0
  s_movk_i32 s12, 0x7421
  s_cselect_b32 s12, 0x6530, s12
  s_lshl_b32 s13, s7, 2
  s_lshr_b32 s12, s12, s13
  s_and_b32 s12, s12, 7
  s_lshl_b32 s12, s12, 9
  s_lshl_b32 s51, s24, 12
  s_add_u32 s51, s51, s12
  s_add_u32 s51, s51, 19922944
  s_sub_u32 s12, 13304, s12
  v_sub_u32 v248, s12, v246
  s_lshl_b32 s12, s7, 12
  s_add_u32 s13, s12, 102400
  v_add_u32 v252, s13, v2
  s_add_u32 s13, s12, 127360
  v_add_u32_e64 v249, s13, v2
  s_xor_b32 s13, s12, 4096
  s_add_u32 s13, s13, 127360
  v_add_u32 v250, s13, v2
  s_lshl_b32 s13, s7, 10
  s_add_u32 s13, s13, 102400
  v_add_u32_e64 v251, s13, v2
  v_accvgpr_write_b32 a200, v232
  v_accvgpr_write_b32 a201, v236
  v_accvgpr_write_b32 a202, v240
  v_accvgpr_write_b32 a203, v241
  v_accvgpr_write_b32 a204, v246
  v_accvgpr_write_b32 a205, v247
  v_accvgpr_write_b32 a206, v248
  v_accvgpr_write_b32 a207, v249
  v_accvgpr_write_b32 a208, v250
  v_accvgpr_write_b32 a209, v251
  v_accvgpr_write_b32 a210, v252
  v_accvgpr_write_b32 a211, v44
  v_accvgpr_write_b32 a212, v45
  v_accvgpr_write_b32 a213, v46
  v_accvgpr_write_b32 a214, v244
  s_lshl_b32 s12, s5, 6
  s_lshr_b32 s13, s7, 1
  s_lshl_b32 s13, s13, 5
  s_add_u32 s12, s12, s13
  s_and_b32 s13, s7, 1
  s_lshl_b32 s13, s13, 2
  s_add_u32 s12, s12, s13
  s_mul_i32 s20, s12, 1280
  s_mul_i32 s13, s6, 160
  s_add_u32 s20, s20, s13
  s_lshl_b32 s48, s7, 12
  s_add_u32 s48, s48, 127360
  v_add_u32 v11, 0, v1
  v_mul_u32_u24 v12, 205, v11
  v_lshrrev_b32 v12, 11, v12
  v_lshrrev_b32 v13, 2, v12
  v_mul_u32_u24 v12, 1120, v12
  v_mul_u32_u24 v13, 5120, v13
  v_lshlrev_b32_e64 v11, 4, v11
  v_add3_u32 v224, v11, v12, v13
  v_add_u32_e64 v11, 64, v1
  v_mul_u32_u24 v12, 205, v11
  v_lshrrev_b32 v12, 11, v12
  v_lshrrev_b32 v13, 2, v12
  v_mul_u32_u24 v12, 1120, v12
  v_mul_u32_u24 v13, 5120, v13
  v_lshlrev_b32_e64 v11, 4, v11
  v_add3_u32 v225, v11, v12, v13
  v_add_u32 v11, 128, v1
  v_mul_u32_u24 v12, 205, v11
  v_lshrrev_b32 v12, 11, v12
  v_lshrrev_b32 v13, 2, v12
  v_mul_u32_u24 v12, 1120, v12
  v_mul_u32_u24 v13, 5120, v13
  v_lshlrev_b32_e64 v11, 4, v11
  v_add3_u32 v226, v11, v12, v13
  s_and_b32 s12, s5, 1
  s_lshl_b32 s12, s12, 2
  s_add_u32 s12, s12, s7
  s_lshr_b32 s13, s12, 1
  s_lshl_b32 s13, s13, 8
  s_and_b32 s12, s12, 1
  s_lshl_b32 s12, s12, 5
  s_add_u32 s12, s12, s13
  s_add_u32 s12, s12, 158720
  v_lshrrev_b32 v12, 2, v3
  v_lshlrev_b32 v12, 6, v12
  v_and_b32_e64 v13, 3, v3
  v_lshl_add_u32 v12, v13, 3, v12
  v_add_u32 v227, s12, v12
  v_and_b32 v13, 7, v3
  v_lshlrev_b32_e64 v13, 3, v13
  v_lshl_add_u32 v13, v4, 6, v13
  s_lshl_b32 s12, s7, 8
  s_add_u32 s12, s12, 158720
  v_add_u32 v228, s12, v13
  v_lshl_add_u32 v243, v4, 3, s48
  v_mul_u32_u24 v242, 160, v3
  v_lshl_add_u32 v242, v4, 3, v242
  v_add_u32 v242, s48, v242
  s_lshl_b32 s12, s3, 4
  s_add_u32 s12, s12, s4
  s_lshl_b32 s12, s12, 12
  s_add_u32 s12, s12, 1310720
  s_sub_u32 s12, s12, 0
  v_mov_b32 v11, s12
  s_lshl_b32 s12, s3, 10
  s_add_u32 s12, s12, 4096
  s_sub_u32 s12, s12, 3072
  v_cmp_lt_u32 vcc, 23, v1
  v_mov_b32 v15, s12
  s_nop 0
  v_cndmask_b32 v11, v11, v15, vcc
  v_lshl_add_u32 v11, v1, 7, v11
  v_accvgpr_write_b32 a245, v11
  s_add_u32 m0, s75, 0
  s_add_u32 s14, s74, 0
  buffer_load_dwordx4 v148, s[56:59], s14 offen lds
  buffer_load_dwordx4 v149, s[56:59], s14 offen offset:2048 lds
  s_add_u32 m0, s75, 4096
  s_add_u32 s14, s74, 20480
  buffer_load_dwordx4 v148, s[56:59], s14 offen lds
  buffer_load_dwordx4 v149, s[56:59], s14 offen offset:2048 lds
  s_add_u32 m0, s75, 8192
  s_add_u32 s14, s74, 40960
  buffer_load_dwordx4 v148, s[56:59], s14 offen lds
  s_add_u32 m0, s77, 0
  s_add_u32 s15, s76, 0
  buffer_load_dwordx4 v146, s[68:71], s15 offen lds
  buffer_load_dwordx4 v147, s[68:71], s15 offen offset:1024 lds
  s_add_u32 m0, s77, 8192
  s_add_u32 s15, s76, 5120
  buffer_load_dwordx4 v146, s[68:71], s15 offen lds
  buffer_load_dwordx4 v147, s[68:71], s15 offen offset:1024 lds
  v_mul_u32_u24 v11, 171, v1
  v_lshrrev_b32 v11, 11, v11
  v_mul_u32_u24 v12, 12, v11
  v_sub_u32 v12, v1, v12
  s_mul_i32 s12, s4, 5
  v_min_u32 v13, 4, v11
  v_add_u32 v13, s12, v13
  s_mul_i32 s13, s7, 12
  v_add_u32 v12, s13, v12
  v_cmp_gt_u32 vcc, 40, v12
  v_cmp_gt_u32 s[14:15], 5, v11
  s_lshr_b32 s13, s1, 4
  s_mul_i32 s13, s13, 40
  v_min_u32 v12, 39, v12
  s_and_b64 vcc, vcc, s[14:15]
  v_add_u32_e64 v12, s13, v12
  s_mul_i32 s14, s0, 102400
  v_mul_u32_u24 v14, 1280, v12
  v_lshl_add_u32 v14, v13, 4, v14
  v_add_u32_e64 v14, s14, v14
  global_load_dwordx4 v[176:179], v14, s[26:27]
  global_load_dwordx4 v[180:183], v14, s[28:29]
  v_lshrrev_b32_e64 v14, 2, v13
  v_mul_u32_u24 v14, 10240, v14
  v_and_b32_e64 v13, 3, v13
  v_lshl_add_u32 v14, v13, 8, v14
  v_lshrrev_b32_e64 v13, 4, v12
  v_lshl_add_u32 v14, v13, 10, v14
  v_and_b32_e64 v12, 15, v12
  v_lshl_add_u32 v14, v12, 4, v14
  v_mov_b32 v13, 1879048192
  v_cndmask_b32 v174, v13, v14, vcc
  v_min_u32 v11, 4, v11
  v_lshlrev_b32_e64 v11, 6, v11
  v_add_u32 v175, 159744, v11
  s_waitcnt vmcnt(11)
  s_waitcnt lgkmcnt(0)
  s_barrier
  buffer_load_dword v184, v185, s[52:55], s89 offen sc1
  v_lshrrev_b32 v11, 1, v3
  v_mul_u32_u24 v12, 176, v11
  v_mul_u32_u24 v11, 80, v11
  v_and_b32_e64 v13, 1, v3
  v_lshl_add_u32 v12, v13, 2, v12
  v_lshl_add_u32 v12, v4, 3, v12
  s_lshl_b32 s12, s7, 5
  s_add_u32 s12, s12, 145184
  v_add_u32 v12, s12, v12
  v_add_u32 v11, 160640, v11
  v_cvt_f32_u32 v151, v13
  v_min_u32 v13, 39, v1
  v_mul_u32_u24 v13, 176, v13
  v_fma_f32 v151, 2.0, v151, -1.0
  v_add_u32 v13, 145184, v13
  s_lshl_b32 s12, s7, 3
  ds_read_b32 v16, v11 offset:0
  ds_read_b32 v21, v11 offset:32
  ds_read_b32 v26, v12 offset:0
  ds_read_b32 v17, v11 offset:640
  ds_read_b32 v22, v11 offset:672
  ds_read_b32 v28, v12 offset:1408
  ds_read_b32 v18, v11 offset:1280
  ds_read_b32 v23, v11 offset:1312
  ds_read_b32 v30, v12 offset:2816
  ds_read_b32 v19, v11 offset:1920
  ds_read_b32 v24, v11 offset:1952
  ds_read_b32 v32, v12 offset:4224
  ds_read_b32 v20, v11 offset:2560
  ds_read_b32 v25, v11 offset:2592
  ds_read_b32 v34, v12 offset:5632
  ds_read_b64 v[36:37], v13 offset:8
  ds_read_b64 v[38:39], v13 offset:128
  v_add_u32 v13, s12, v13
  ds_read_b64 v[40:41], v13 offset:144
  s_cmp_eq_u32 s7, 3
  s_cbranch_scc1 w3_11
  ds_read_b128 v[88:91], v173
  ds_read_b128 v[92:95], v173 offset:16
  ds_read_b64 v[48:49], v172 offset:640
  ds_read_b64 v[50:51], v172 offset:768
  ds_read_b64 v[52:53], v172 offset:896
  ds_read_b64 v[54:55], v172 offset:1056
  ds_read_b64 v[56:57], v172 offset:1184
  ds_read_b64 v[58:59], v172 offset:1312
  ds_read_b64 v[60:61], v172 offset:1440
  ds_read_b64 v[62:63], v172 offset:1568
  ds_read_b64 v[64:65], v172 offset:1696
  ds_read_b64 v[66:67], v172 offset:1824
  ds_read_b64 v[68:69], v172 offset:1952
  ds_read_b64 v[70:71], v172 offset:13728
  ds_read_b64 v[72:73], v172 offset:13856
  ds_read_b64 v[74:75], v172 offset:13984
  ds_read_b64 v[76:77], v172 offset:14112
  ds_read_b64 v[78:79], v172 offset:14240
  ds_read_b64 v[80:81], v172 offset:14368
  ds_read_b64 v[82:83], v172 offset:14496
  ds_read_b64 v[84:85], v172 offset:14624
  s_waitcnt lgkmcnt(15)
  v_lshlrev_b32 v96, 16, v88
  v_and_b32 v100, 0xffff0000, v88
  v_lshlrev_b32_e64 v104, 16, v89
  v_and_b32 v108, 0xffff0000, v89
  v_lshlrev_b32_e64 v97, 16, v90
  v_and_b32 v101, 0xffff0000, v90
  v_lshlrev_b32_e64 v105, 16, v91
  v_and_b32 v109, 0xffff0000, v91
  v_lshlrev_b32_e64 v98, 16, v92
  v_and_b32 v102, 0xffff0000, v92
  v_lshlrev_b32_e64 v106, 16, v93
  v_and_b32 v110, 0xffff0000, v93
  v_lshlrev_b32_e64 v99, 16, v94
  v_and_b32 v103, 0xffff0000, v94
  v_lshlrev_b32_e64 v107, 16, v95
  v_and_b32 v111, 0xffff0000, v95
  s_waitcnt lgkmcnt(8)
  v_lshlrev_b32 v216, 16, v48
  v_and_b32 v217, 0xffff0000, v48
  v_pk_mul_f32 v[112:113], v[216:217], v[108:109]
  v_lshlrev_b32_e64 v218, 16, v50
  v_and_b32 v219, 0xffff0000, v50
  v_pk_mul_f32 v[114:115], v[218:219], v[108:109]
  v_lshlrev_b32_e64 v216, 16, v52
  v_and_b32 v217, 0xffff0000, v52
  v_pk_fma_f32 v[112:113], v[218:219], v[104:105], v[112:113]
  v_pk_mul_f32 v[116:117], v[216:217], v[108:109]
  v_lshlrev_b32_e64 v218, 16, v54
  v_and_b32 v219, 0xffff0000, v54
  v_pk_fma_f32 v[114:115], v[216:217], v[104:105], v[114:115]
  v_pk_fma_f32 v[112:113], v[216:217], v[100:101], v[112:113]
  v_pk_mul_f32 v[118:119], v[218:219], v[108:109]
  v_lshlrev_b32_e64 v216, 16, v56
  v_and_b32 v217, 0xffff0000, v56
  v_pk_fma_f32 v[116:117], v[218:219], v[104:105], v[116:117]
  v_pk_fma_f32 v[114:115], v[218:219], v[100:101], v[114:115]
  v_pk_fma_f32 v[112:113], v[218:219], v[96:97], v[112:113]
  v_pk_mul_f32 v[120:121], v[216:217], v[108:109]
  v_lshlrev_b32_e64 v218, 16, v58
  v_and_b32 v219, 0xffff0000, v58
  v_pk_fma_f32 v[118:119], v[216:217], v[104:105], v[118:119]
  v_pk_fma_f32 v[116:117], v[216:217], v[100:101], v[116:117]
  v_pk_fma_f32 v[114:115], v[216:217], v[96:97], v[114:115]
  v_pk_mul_f32 v[122:123], v[218:219], v[108:109]
  v_lshlrev_b32_e64 v216, 16, v60
  v_and_b32 v217, 0xffff0000, v60
  v_pk_fma_f32 v[120:121], v[218:219], v[104:105], v[120:121]
  v_pk_fma_f32 v[118:119], v[218:219], v[100:101], v[118:119]
  v_pk_fma_f32 v[116:117], v[218:219], v[96:97], v[116:117]
  v_pk_mul_f32 v[124:125], v[216:217], v[108:109]
  v_lshlrev_b32_e64 v218, 16, v62
  v_and_b32 v219, 0xffff0000, v62
  v_pk_fma_f32 v[122:123], v[216:217], v[104:105], v[122:123]
  v_pk_fma_f32 v[120:121], v[216:217], v[100:101], v[120:121]
  v_pk_fma_f32 v[118:119], v[216:217], v[96:97], v[118:119]
  v_pk_mul_f32 v[126:127], v[218:219], v[108:109]
  v_lshlrev_b32_e64 v216, 16, v64
  v_and_b32 v217, 0xffff0000, v64
  v_pk_fma_f32 v[124:125], v[218:219], v[104:105], v[124:125]
  v_pk_fma_f32 v[122:123], v[218:219], v[100:101], v[122:123]
  v_pk_fma_f32 v[120:121], v[218:219], v[96:97], v[120:121]
  v_pk_fma_f32 v[126:127], v[216:217], v[104:105], v[126:127]
  v_lshlrev_b32_e64 v218, 16, v66
  v_and_b32 v219, 0xffff0000, v66
  v_pk_fma_f32 v[124:125], v[216:217], v[100:101], v[124:125]
  v_pk_fma_f32 v[122:123], v[216:217], v[96:97], v[122:123]
  v_pk_fma_f32 v[126:127], v[218:219], v[100:101], v[126:127]
  v_lshlrev_b32_e64 v216, 16, v68
  v_and_b32 v217, 0xffff0000, v68
  v_pk_fma_f32 v[124:125], v[218:219], v[96:97], v[124:125]
  v_pk_fma_f32 v[126:127], v[216:217], v[96:97], v[126:127]
  s_waitcnt lgkmcnt(0)
  v_lshlrev_b32 v220, 16, v70
  v_and_b32 v221, 0xffff0000, v70
  v_lshlrev_b32_e64 v222, 16, v72
  v_and_b32 v223, 0xffff0000, v72
  v_pk_mul_f32 v[112:113], v[112:113], v[220:221]
  v_lshlrev_b32_e64 v220, 16, v74
  v_and_b32 v221, 0xffff0000, v74
  v_pk_mul_f32 v[114:115], v[114:115], v[222:223]
  v_lshlrev_b32_e64 v222, 16, v76
  v_and_b32 v223, 0xffff0000, v76
  v_pk_mul_f32 v[116:117], v[116:117], v[220:221]
  v_lshlrev_b32_e64 v220, 16, v78
  v_and_b32 v221, 0xffff0000, v78
  v_pk_mul_f32 v[118:119], v[118:119], v[222:223]
  v_lshlrev_b32_e64 v222, 16, v80
  v_and_b32 v223, 0xffff0000, v80
  v_pk_mul_f32 v[120:121], v[120:121], v[220:221]
  v_lshlrev_b32_e64 v220, 16, v82
  v_and_b32 v221, 0xffff0000, v82
  v_pk_mul_f32 v[122:123], v[122:123], v[222:223]
  v_lshlrev_b32_e64 v222, 16, v84
  v_and_b32 v223, 0xffff0000, v84
  v_pk_mul_f32 v[124:125], v[124:125], v[220:221]
  v_pk_mul_f32 v[126:127], v[126:127], v[222:223]
  v_cvt_pk_bf16_f32 v232, v126, v124
  v_cvt_pk_bf16_f32 v233, v122, v120
  v_cvt_pk_bf16_f32 v234, v118, v116
  v_cvt_pk_bf16_f32 v235, v114, v112
  v_cvt_pk_bf16_f32 v236, v127, v125
  v_cvt_pk_bf16_f32 v237, v123, v121
  v_cvt_pk_bf16_f32 v238, v119, v117
  v_cvt_pk_bf16_f32 v239, v115, v113
  v_lshlrev_b32_e64 v216, 16, v49
  v_and_b32 v217, 0xffff0000, v49
  v_pk_mul_f32 v[112:113], v[216:217], v[110:111]
  v_lshlrev_b32_e64 v218, 16, v51
  v_and_b32 v219, 0xffff0000, v51
  v_pk_mul_f32 v[114:115], v[218:219], v[110:111]
  v_lshlrev_b32_e64 v216, 16, v53
  v_and_b32 v217, 0xffff0000, v53
  v_pk_fma_f32 v[112:113], v[218:219], v[106:107], v[112:113]
  v_pk_mul_f32 v[116:117], v[216:217], v[110:111]
  v_lshlrev_b32_e64 v218, 16, v55
  v_and_b32 v219, 0xffff0000, v55
  v_pk_fma_f32 v[114:115], v[216:217], v[106:107], v[114:115]
  v_pk_fma_f32 v[112:113], v[216:217], v[102:103], v[112:113]
  v_pk_mul_f32 v[118:119], v[218:219], v[110:111]
  v_lshlrev_b32_e64 v216, 16, v57
  v_and_b32 v217, 0xffff0000, v57
  v_pk_fma_f32 v[116:117], v[218:219], v[106:107], v[116:117]
  v_pk_fma_f32 v[114:115], v[218:219], v[102:103], v[114:115]
  v_pk_fma_f32 v[112:113], v[218:219], v[98:99], v[112:113]
  v_pk_mul_f32 v[120:121], v[216:217], v[110:111]
  v_lshlrev_b32_e64 v218, 16, v59
  v_and_b32 v219, 0xffff0000, v59
  v_pk_fma_f32 v[118:119], v[216:217], v[106:107], v[118:119]
  v_pk_fma_f32 v[116:117], v[216:217], v[102:103], v[116:117]
  v_pk_fma_f32 v[114:115], v[216:217], v[98:99], v[114:115]
  v_pk_mul_f32 v[122:123], v[218:219], v[110:111]
  v_lshlrev_b32_e64 v216, 16, v61
  v_and_b32 v217, 0xffff0000, v61
  v_pk_fma_f32 v[120:121], v[218:219], v[106:107], v[120:121]
  v_pk_fma_f32 v[118:119], v[218:219], v[102:103], v[118:119]
  v_pk_fma_f32 v[116:117], v[218:219], v[98:99], v[116:117]
  v_pk_mul_f32 v[124:125], v[216:217], v[110:111]
  v_lshlrev_b32_e64 v218, 16, v63
  v_and_b32 v219, 0xffff0000, v63
  v_pk_fma_f32 v[122:123], v[216:217], v[106:107], v[122:123]
  v_pk_fma_f32 v[120:121], v[216:217], v[102:103], v[120:121]
  v_pk_fma_f32 v[118:119], v[216:217], v[98:99], v[118:119]
  v_pk_mul_f32 v[126:127], v[218:219], v[110:111]
  v_lshlrev_b32_e64 v216, 16, v65
  v_and_b32 v217, 0xffff0000, v65
  v_pk_fma_f32 v[124:125], v[218:219], v[106:107], v[124:125]
  v_pk_fma_f32 v[122:123], v[218:219], v[102:103], v[122:123]
  v_pk_fma_f32 v[120:121], v[218:219], v[98:99], v[120:121]
  v_pk_fma_f32 v[126:127], v[216:217], v[106:107], v[126:127]
  v_lshlrev_b32_e64 v218, 16, v67
  v_and_b32 v219, 0xffff0000, v67
  v_pk_fma_f32 v[124:125], v[216:217], v[102:103], v[124:125]
  v_pk_fma_f32 v[122:123], v[216:217], v[98:99], v[122:123]
  v_pk_fma_f32 v[126:127], v[218:219], v[102:103], v[126:127]
  v_lshlrev_b32_e64 v216, 16, v69
  v_and_b32 v217, 0xffff0000, v69
  v_pk_fma_f32 v[124:125], v[218:219], v[98:99], v[124:125]
  v_pk_fma_f32 v[126:127], v[216:217], v[98:99], v[126:127]
  v_lshlrev_b32_e64 v220, 16, v71
  v_and_b32 v221, 0xffff0000, v71
  v_lshlrev_b32_e64 v222, 16, v73
  v_and_b32 v223, 0xffff0000, v73
  v_pk_mul_f32 v[112:113], v[112:113], v[220:221]
  v_lshlrev_b32_e64 v220, 16, v75
  v_and_b32 v221, 0xffff0000, v75
  v_pk_mul_f32 v[114:115], v[114:115], v[222:223]
  v_lshlrev_b32_e64 v222, 16, v77
  v_and_b32 v223, 0xffff0000, v77
  v_pk_mul_f32 v[116:117], v[116:117], v[220:221]
  v_lshlrev_b32_e64 v220, 16, v79
  v_and_b32 v221, 0xffff0000, v79
  v_pk_mul_f32 v[118:119], v[118:119], v[222:223]
  v_lshlrev_b32_e64 v222, 16, v81
  v_and_b32 v223, 0xffff0000, v81
  v_pk_mul_f32 v[120:121], v[120:121], v[220:221]
  v_lshlrev_b32_e64 v220, 16, v83
  v_and_b32 v221, 0xffff0000, v83
  v_pk_mul_f32 v[122:123], v[122:123], v[222:223]
  v_lshlrev_b32_e64 v222, 16, v85
  v_and_b32 v223, 0xffff0000, v85
  v_pk_mul_f32 v[124:125], v[124:125], v[220:221]
  v_pk_mul_f32 v[126:127], v[126:127], v[222:223]
  v_cvt_pk_bf16_f32 v88, v126, v124
  v_cvt_pk_bf16_f32 v89, v122, v120
  v_cvt_pk_bf16_f32 v90, v118, v116
  v_cvt_pk_bf16_f32 v91, v114, v112
  v_cvt_pk_bf16_f32 v92, v127, v125
  v_cvt_pk_bf16_f32 v93, v123, v121
  v_cvt_pk_bf16_f32 v94, v119, v117
  v_cvt_pk_bf16_f32 v95, v115, v113
  s_waitcnt vmcnt(0)
  v_xor_b32 v15, s8, v184
  v_cmp_lt_u32 vcc, 15, v15
  s_cbranch_vccnz again_13
ok_14:
  s_or_b32 s13, s8, s11
  v_cmp_ne_u32 vcc, s13, v184
  s_cmp_eq_u64 vcc, 0
  s_cselect_b32 s9, 1, 0
  s_cmp_eq_u32 s7, 2
  s_cselect_b32 s40, 0, s9
  buffer_store_dwordx4 v[232:235], v171, s[52:55], s87 offen sc1
  s_add_u32 s87, s87, s36
  buffer_store_dwordx4 v[236:239], v171, s[52:55], s87 offen sc1
  s_add_u32 s87, s87, s36
  buffer_store_dwordx4 v[88:91], v171, s[52:55], s87 offen sc1
  s_add_u32 s87, s87, s36
  buffer_store_dwordx4 v[92:95], v171, s[52:55], s87 offen sc1
  s_branch join_12
w3_11:
  s_lshl_b32 s12, s4, 3
  s_and_b32 s13, s3, 7
  s_add_u32 s12, s12, s13
  s_mul_i32 s12, s12, 6400
  s_mov_b32 exec_hi, 0xff
  buffer_load_dwordx4 v[48:51], v150, s[60:63], s12 offen offset:0
  buffer_load_dwordx4 v[52:55], v150, s[60:63], s12 offen offset:128
  buffer_load_dwordx4 v[56:59], v150, s[60:63], s12 offen offset:256
  buffer_load_dwordx4 v[60:63], v150, s[60:63], s12 offen offset:384
  buffer_load_dwordx4 v[64:67], v150, s[60:63], s12 offen offset:512
  buffer_load_dwordx4 v[68:71], v150, s[60:63], s12 offen offset:640
  buffer_load_dwordx4 v[72:75], v150, s[60:63], s12 offen offset:768
  buffer_load_dwordx4 v[76:79], v150, s[60:63], s12 offen offset:896
  buffer_load_dwordx4 v[80:83], v150, s[60:63], s12 offen offset:1024
  buffer_load_dwordx4 v[84:87], v150, s[60:63], s12 offen offset:1152
  s_mov_b32 exec_hi, -1
  s_mov_b32 s64, s22
  s_and_b32 s65, s23, 0xffff
  s_mov_b32 s66, 819200
  s_mov_b32 s67, 0x20000
  v_xor_b32 v11, 64, v148
  v_xor_b32_e64 v12, 64, v149
  s_mul_i32 s15, s4, 51200
  s_add_u32 s14, s15, 256
  s_mov_b32 m0, 20480
  s_nop 0
  buffer_load_dwordx4 v11, s[64:67], s14 offen lds
  buffer_load_dwordx4 v12, s[64:67], s14 offen offset:2048 lds
  s_mov_b32 m0, 21504
  s_nop 0
  buffer_load_dwordx4 v148, s[56:59], s14 offen lds
  buffer_load_dwordx4 v149, s[56:59], s14 offen offset:2048 lds
  s_add_u32 s14, s15, 20736
  s_mov_b32 m0, 24576
  s_nop 0
  buffer_load_dwordx4 v11, s[64:67], s14 offen lds
  buffer_load_dwordx4 v12, s[64:67], s14 offen offset:2048 lds
  s_mov_b32 m0, 25600
  s_nop 0
  buffer_load_dwordx4 v148, s[56:59], s14 offen lds
  buffer_load_dwordx4 v149, s[56:59], s14 offen offset:2048 lds
  s_add_u32 s14, s15, 41216
  s_mov_b32 m0, 28672
  s_nop 0
  buffer_load_dwordx4 v11, s[64:67], s14 offen lds
  s_mov_b32 m0, 29696
  s_nop 0
  buffer_load_dwordx4 v148, s[56:59], s14 offen lds
  s_add_u32 s14, s15, 384
  s_mov_b32 m0, 30720
  s_nop 0
  buffer_load_dwordx4 v11, s[64:67], s14 offen lds
  buffer_load_dwordx4 v12, s[64:67], s14 offen offset:2048 lds
  s_mov_b32 m0, 31744
  s_nop 0
  buffer_load_dwordx4 v148, s[56:59], s14 offen lds
  buffer_load_dwordx4 v149, s[56:59], s14 offen offset:2048 lds
  s_add_u32 s14, s15, 20864
  s_mov_b32 m0, 34816
  s_nop 0
  buffer_load_dwordx4 v11, s[64:67], s14 offen lds
  buffer_load_dwordx4 v12, s[64:67], s14 offen offset:2048 lds
  s_mov_b32 m0, 35840
  s_nop 0
  buffer_load_dwordx4 v148, s[56:59], s14 offen lds
  buffer_load_dwordx4 v149, s[56:59], s14 offen offset:2048 lds
  s_add_u32 s14, s15, 41344
  s_mov_b32 m0, 38912
  s_nop 0
  buffer_load_dwordx4 v11, s[64:67], s14 offen lds
  s_mov_b32 m0, 39936
  s_nop 0
  buffer_load_dwordx4 v148, s[56:59], s14 offen lds
  s_mov_b32 s64, s22
  s_and_b32 s65, s23, 0xffff
  s_mov_b32 s66, 819200
  s_mov_b32 s67, 0x20000
  v_xor_b32 v11, 64, v148
  v_xor_b32_e64 v12, 64, v149
  s_mul_i32 s15, s4, 51200
  s_add_u32 s14, s15, 512
  s_mov_b32 m0, 40960
  s_nop 0
  buffer_load_dwordx4 v11, s[64:67], s14 offen lds
  buffer_load_dwordx4 v12, s[64:67], s14 offen offset:2048 lds
  s_mov_b32 m0, 41984
  s_nop 0
  buffer_load_dwordx4 v148, s[56:59], s14 offen lds
  buffer_load_dwordx4 v149, s[56:59], s14 offen offset:2048 lds
  s_add_u32 s14, s15, 20992
  s_mov_b32 m0, 45056
  s_nop 0
  buffer_load_dwordx4 v11, s[64:67], s14 offen lds
  buffer_load_dwordx4 v12, s[64:67], s14 offen offset:2048 lds
  s_mov_b32 m0, 46080
  s_nop 0
  buffer_load_dwordx4 v148, s[56:59], s14 offen lds
  buffer_load_dwordx4 v149, s[56:59], s14 offen offset:2048 lds
  s_add_u32 s14, s15, 41472
  s_mov_b32 m0, 49152
  s_nop 0
  buffer_load_dwordx4 v11, s[64:67], s14 offen lds
  s_mov_b32 m0, 50176
  s_nop 0
  buffer_load_dwordx4 v148, s[56:59], s14 offen lds
  s_add_u32 s14, s15, 640
  s_mov_b32 m0, 51200
  s_nop 0
  buffer_load_dwordx4 v11, s[64:67], s14 offen lds
  buffer_load_dwordx4 v12, s[64:67], s14 offen offset:2048 lds
  s_mov_b32 m0, 52224
  s_nop 0
  buffer_load_dwordx4 v148, s[56:59], s14 offen lds
  buffer_load_dwordx4 v149, s[56:59], s14 offen offset:2048 lds
  s_add_u32 s14, s15, 21120
  s_mov_b32 m0, 55296
  s_nop 0
  buffer_load_dwordx4 v11, s[64:67], s14 offen lds
  buffer_load_dwordx4 v12, s[64:67], s14 offen offset:2048 lds
  s_mov_b32 m0, 56320
  s_nop 0
  buffer_load_dwordx4 v148, s[56:59], s14 offen lds
  buffer_load_dwordx4 v149, s[56:59], s14 offen offset:2048 lds
  s_add_u32 s14, s15, 41600
  s_mov_b32 m0, 59392
  s_nop 0
  buffer_load_dwordx4 v11, s[64:67], s14 offen lds
  s_mov_b32 m0, 60416
  s_nop 0
  buffer_load_dwordx4 v148, s[56:59], s14 offen lds
  s_waitcnt vmcnt(50)
  v_xor_b32 v15, s8, v184
  v_cmp_lt_u32 vcc, 15, v15
  s_cbranch_vccnz again_15
ok_16:
  s_or_b32 s13, s8, s11
  v_cmp_ne_u32 vcc, s13, v184
  s_cmp_eq_u64 vcc, 0
  s_cselect_b32 s9, 1, 0
  s_cmp_eq_u32 s7, 2
  s_cselect_b32 s40, 0, s9
  s_waitcnt vmcnt(40)
  v_dot2_f32_bf16 v88, v48, s2, 0
  v_dot2_f32_bf16 v89, v49, s2, 0
  v_dot2_f32_bf16 v88, v50, s2, v88
  v_dot2_f32_bf16 v89, v51, s2, v89
  v_dot2_f32_bf16 v88, v52, s2, v88
  v_dot2_f32_bf16 v89, v53, s2, v89
  v_dot2_f32_bf16 v88, v54, s2, v88
  v_dot2_f32_bf16 v89, v55, s2, v89
  v_dot2_f32_bf16 v88, v56, s2, v88
  v_dot2_f32_bf16 v89, v57, s2, v89
  v_dot2_f32_bf16 v88, v58, s2, v88
  v_dot2_f32_bf16 v89, v59, s2, v89
  v_dot2_f32_bf16 v88, v60, s2, v88
  v_dot2_f32_bf16 v89, v61, s2, v89
  v_dot2_f32_bf16 v88, v62, s2, v88
  v_dot2_f32_bf16 v89, v63, s2, v89
  v_dot2_f32_bf16 v88, v64, s2, v88
  v_dot2_f32_bf16 v89, v65, s2, v89
  v_dot2_f32_bf16 v88, v66, s2, v88
  v_dot2_f32_bf16 v89, v67, s2, v89
  v_dot2_f32_bf16 v88, v68, s2, v88
  v_dot2_f32_bf16 v89, v69, s2, v89
  v_dot2_f32_bf16 v88, v70, s2, v88
  v_dot2_f32_bf16 v89, v71, s2, v89
  v_dot2_f32_bf16 v88, v72, s2, v88
  v_dot2_f32_bf16 v89, v73, s2, v89
  v_dot2_f32_bf16 v88, v74, s2, v88
  v_dot2_f32_bf16 v89, v75, s2, v89
  v_dot2_f32_bf16 v88, v76, s2, v88
  v_dot2_f32_bf16 v89, v77, s2, v89
  v_dot2_f32_bf16 v88, v78, s2, v88
  v_dot2_f32_bf16 v89, v79, s2, v89
  v_dot2_f32_bf16 v88, v80, s2, v88
  v_dot2_f32_bf16 v89, v81, s2, v89
  v_dot2_f32_bf16 v88, v82, s2, v88
  v_dot2_f32_bf16 v89, v83, s2, v89
  v_dot2_f32_bf16 v88, v84, s2, v88
  v_dot2_f32_bf16 v89, v85, s2, v89
  v_dot2_f32_bf16 v88, v86, s2, v88
  v_dot2_f32_bf16 v89, v87, s2, v89
  s_nop 2
  v_add_f32 v88, v88, v89
  s_nop 1
  v_add_f32_dpp v88, v88, v88 quad_perm:[1,0,3,2] row_mask:0xf bank_mask:0xf
  s_nop 1
  v_add_f32_dpp v88, v88, v88 quad_perm:[2,3,0,1] row_mask:0xf bank_mask:0xf
  s_nop 1
  v_add_f32_dpp v88, v88, v88 row_half_mirror row_mask:0xf bank_mask:0xf
  v_mov_b32 v89, s8
  v_lshlrev_b32 v11, 1, v1
  s_lshl_b32 s12, s4, 3
  s_and_b32 s13, s3, 7
  s_add_u32 s12, s12, s13
  s_mul_i32 s12, s12, 80
  s_and_b32 s13, s3, 8
  s_add_u32 s12, s12, s13
  s_add_u32 s12, s12, 303104
  s_mov_b32 exec_lo, 0x01010101
  s_mov_b32 exec_hi, 1
  buffer_store_dwordx2 v[88:89], v11, s[52:55], s12 offen sc1
  s_mov_b64 exec, -1
join_12:
  s_waitcnt lgkmcnt(0)
  v_mul_f32_e64 v21, v151, v21
  v_mul_f32_dpp v27, v26, v151 quad_perm:[1,0,3,2] row_mask:0xf bank_mask:0xf
  v_mul_f32_e64 v22, v151, v22
  v_mul_f32_dpp v29, v28, v151 quad_perm:[1,0,3,2] row_mask:0xf bank_mask:0xf
  v_mul_f32_e64 v23, v151, v23
  v_mul_f32_dpp v31, v30, v151 quad_perm:[1,0,3,2] row_mask:0xf bank_mask:0xf
  v_mul_f32_e64 v24, v151, v24
  v_mul_f32_dpp v33, v32, v151 quad_perm:[1,0,3,2] row_mask:0xf bank_mask:0xf
  v_mul_f32_e64 v25, v151, v25
  v_mul_f32_dpp v35, v34, v151 quad_perm:[1,0,3,2] row_mask:0xf bank_mask:0xf
  s_waitcnt vmcnt(7)
  s_barrier
  ds_read_b128 v[128:131], v144 offset:0
  ds_read_b128 v[132:135], v144 offset:8192
  ds_read_b128 v[88:91], v5 offset:0
  ds_read_b128 v[92:95], v5 offset:2048
  ds_read_b128 v[96:99], v5 offset:4096
  ds_read_b128 v[100:103], v5 offset:6144
  ds_read_b128 v[104:107], v5 offset:8192
  s_add_u32 m0, s77, 16384
  s_add_u32 s15, s76, 128
  buffer_load_dwordx4 v146, s[68:71], s15 offen lds
  buffer_load_dwordx4 v147, s[68:71], s15 offen offset:1024 lds
  s_add_u32 m0, s77, 24576
  s_add_u32 s15, s76, 5248
  buffer_load_dwordx4 v146, s[68:71], s15 offen lds
  buffer_load_dwordx4 v147, s[68:71], s15 offen offset:1024 lds
  s_waitcnt lgkmcnt(4)
  v_mfma_f32_16x16x32_bf16 v[48:51], v[128:131], v[88:91], 0
  ds_read_b128 v[136:139], v145 offset:0
  ds_read_b128 v[140:143], v145 offset:8192
  ds_read_b128 v[108:111], v6 offset:0
  ds_read_b128 v[192:195], v175 offset:0
  ds_read_b128 v[196:199], v175 offset:16
  v_mfma_f32_16x16x32_bf16 v[52:55], v[132:135], v[88:91], 0
  ds_read_b128 v[200:203], v175 offset:32
  ds_read_b128 v[204:207], v175 offset:48
  s_waitcnt lgkmcnt(10)
  v_mfma_f32_16x16x32_bf16 v[56:59], v[128:131], v[92:95], 0
  ds_read_b128 v[112:115], v6 offset:2048
  s_waitcnt vmcnt(9)
  s_waitcnt lgkmcnt(1)
  v_lshlrev_b32_e64 v152, 16, v176
  v_mfma_f32_16x16x32_bf16 v[60:63], v[132:135], v[92:95], 0
  v_and_b32 v153, 0xffff0000, v176
  v_lshlrev_b32_e64 v154, 16, v180
  v_mfma_f32_16x16x32_bf16 v[64:67], v[128:131], v[96:99], 0
  ds_read_b128 v[116:119], v6 offset:4096
  v_and_b32 v155, 0xffff0000, v180
  v_pk_mul_f32 v[156:157], v[152:153], v[192:193]
  v_mfma_f32_16x16x32_bf16 v[68:71], v[132:135], v[96:99], 0
  v_pk_mul_f32 v[158:159], v[152:153], v[194:195] neg_lo:[0,1] neg_hi:[0,1]
  v_pk_fma_f32 v[156:157], v[154:155], v[194:195], v[156:157] neg_lo:[0,1,0] neg_hi:[0,1,0]
  v_mfma_f32_16x16x32_bf16 v[72:75], v[128:131], v[100:103], 0
  ds_read_b128 v[120:123], v6 offset:6144
  v_pk_fma_f32 v[158:159], v[154:155], v[192:193], v[158:159] neg_lo:[0,1,0] neg_hi:[0,1,0]
  v_cvt_pk_bf16_f32 v176, v156, v157
  v_mfma_f32_16x16x32_bf16 v[76:79], v[132:135], v[100:103], 0
  s_add_u32 m0, s77, 32768
  s_add_u32 s15, s76, 256
  buffer_load_dwordx4 v146, s[68:71], s15 offen lds
  buffer_load_dwordx4 v147, s[68:71], s15 offen offset:1024 lds
  s_add_u32 m0, s77, 40960
  s_add_u32 s15, s76, 5376
  buffer_load_dwordx4 v146, s[68:71], s15 offen lds
  buffer_load_dwordx4 v147, s[68:71], s15 offen offset:1024 lds
  v_mfma_f32_16x16x32_bf16 v[80:83], v[128:131], v[104:107], 0
  ds_read_b128 v[124:127], v6 offset:8192
  s_add_u32 m0, s75, 61440
  s_add_u32 s14, s74, 768
  buffer_load_dwordx4 v148, s[56:59], s14 offen lds
  buffer_load_dwordx4 v149, s[56:59], s14 offen offset:2048 lds
  v_mfma_f32_16x16x32_bf16 v[84:87], v[132:135], v[104:107], 0
  s_add_u32 m0, s75, 65536
  s_add_u32 s14, s74, 21248
  buffer_load_dwordx4 v148, s[56:59], s14 offen lds
  buffer_load_dwordx4 v149, s[56:59], s14 offen offset:2048 lds
  s_waitcnt vmcnt(8)
  s_waitcnt lgkmcnt(2)
  v_mfma_f32_16x16x32_bf16 v[48:51], v[136:139], v[108:111], v[48:51]
  ds_read_b128 v[128:131], v144 offset:16384
  ds_read_b128 v[132:135], v144 offset:24576
  ds_read_b128 v[88:91], v5 offset:10240
  v_cvt_pk_bf16_f32 v180, v158, v159
  v_lshlrev_b32_e64 v152, 16, v177
  v_mfma_f32_16x16x32_bf16 v[52:55], v[140:143], v[108:111], v[52:55]
  v_and_b32 v153, 0xffff0000, v177
  v_lshlrev_b32_e64 v154, 16, v181
  v_mfma_f32_16x16x32_bf16 v[56:59], v[136:139], v[112:115], v[56:59]
  ds_read_b128 v[92:95], v5 offset:12288
  v_and_b32 v155, 0xffff0000, v181
  v_pk_mul_f32 v[156:157], v[152:153], v[196:197]
  v_mfma_f32_16x16x32_bf16 v[60:63], v[140:143], v[112:115], v[60:63]
  v_pk_mul_f32 v[158:159], v[152:153], v[198:199] neg_lo:[0,1] neg_hi:[0,1]
  v_pk_fma_f32 v[156:157], v[154:155], v[198:199], v[156:157] neg_lo:[0,1,0] neg_hi:[0,1,0]
  v_mfma_f32_16x16x32_bf16 v[64:67], v[136:139], v[116:119], v[64:67]
  ds_read_b128 v[96:99], v5 offset:14336
  v_pk_fma_f32 v[158:159], v[154:155], v[196:197], v[158:159] neg_lo:[0,1,0] neg_hi:[0,1,0]
  v_cvt_pk_bf16_f32 v177, v156, v157
  v_mfma_f32_16x16x32_bf16 v[68:71], v[140:143], v[116:119], v[68:71]
  v_cvt_pk_bf16_f32 v181, v158, v159
  v_lshlrev_b32 v152, 16, v178
  s_waitcnt lgkmcnt(5)
  v_mfma_f32_16x16x32_bf16 v[72:75], v[136:139], v[120:123], v[72:75]
  ds_read_b128 v[100:103], v5 offset:16384
  v_and_b32 v153, 0xffff0000, v178
  v_lshlrev_b32_e64 v154, 16, v182
  v_mfma_f32_16x16x32_bf16 v[76:79], v[140:143], v[120:123], v[76:79]
  s_add_u32 m0, s77, 49152
  s_add_u32 s15, s76, 384
  buffer_load_dwordx4 v146, s[68:71], s15 offen lds
  buffer_load_dwordx4 v147, s[68:71], s15 offen offset:1024 lds
  v_mfma_f32_16x16x32_bf16 v[80:83], v[136:139], v[124:127], v[80:83]
  ds_read_b128 v[104:107], v5 offset:18432
  s_add_u32 m0, s77, 0
  s_add_u32 s15, s76, 5504
  buffer_load_dwordx4 v146, s[68:71], s15 offen lds
  buffer_load_dwordx4 v147, s[68:71], s15 offen offset:1024 lds
  v_mfma_f32_16x16x32_bf16 v[84:87], v[140:143], v[124:127], v[84:87]
  s_add_u32 m0, s75, 69632
  s_add_u32 s14, s74, 41728
  buffer_load_dwordx4 v148, s[56:59], s14 offen lds
  s_waitcnt lgkmcnt(2)
  v_mfma_f32_16x16x32_bf16 v[48:51], v[128:131], v[88:91], v[48:51]
  ds_read_b128 v[136:139], v145 offset:16384
  ds_read_b128 v[140:143], v145 offset:24576
  ds_read_b128 v[108:111], v6 offset:10240
  v_and_b32 v155, 0xffff0000, v182
  v_pk_mul_f32 v[156:157], v[152:153], v[200:201]
  v_mfma_f32_16x16x32_bf16 v[52:55], v[132:135], v[88:91], v[52:55]
  v_pk_mul_f32 v[158:159], v[152:153], v[202:203] neg_lo:[0,1] neg_hi:[0,1]
  v_pk_fma_f32 v[156:157], v[154:155], v[202:203], v[156:157] neg_lo:[0,1,0] neg_hi:[0,1,0]
  v_mfma_f32_16x16x32_bf16 v[56:59], v[128:131], v[92:95], v[56:59]
  ds_read_b128 v[112:115], v6 offset:12288
  v_pk_fma_f32 v[158:159], v[154:155], v[200:201], v[158:159] neg_lo:[0,1,0] neg_hi:[0,1,0]
  v_cvt_pk_bf16_f32 v178, v156, v157
  v_mfma_f32_16x16x32_bf16 v[60:63], v[132:135], v[92:95], v[60:63]
  v_cvt_pk_bf16_f32 v182, v158, v159
  v_lshlrev_b32_e64 v152, 16, v179
  v_mfma_f32_16x16x32_bf16 v[64:67], v[128:131], v[96:99], v[64:67]
  ds_read_b128 v[116:119], v6 offset:14336
  v_and_b32 v153, 0xffff0000, v179
  v_lshlrev_b32_e64 v154, 16, v183
  v_mfma_f32_16x16x32_bf16 v[68:71], v[132:135], v[96:99], v[68:71]
  v_and_b32 v155, 0xffff0000, v183
  v_pk_mul_f32 v[156:157], v[152:153], v[204:205]
  s_waitcnt lgkmcnt(5)
  v_mfma_f32_16x16x32_bf16 v[72:75], v[128:131], v[100:103], v[72:75]
  ds_read_b128 v[120:123], v6 offset:16384
  v_pk_mul_f32 v[158:159], v[152:153], v[206:207] neg_lo:[0,1] neg_hi:[0,1]
  v_pk_fma_f32 v[156:157], v[154:155], v[206:207], v[156:157] neg_lo:[0,1,0] neg_hi:[0,1,0]
  v_mfma_f32_16x16x32_bf16 v[76:79], v[132:135], v[100:103], v[76:79]
  s_add_u32 m0, s77, 8192
  s_add_u32 s15, s76, 512
  buffer_load_dwordx4 v146, s[68:71], s15 offen lds
  buffer_load_dwordx4 v147, s[68:71], s15 offen offset:1024 lds
  v_mfma_f32_16x16x32_bf16 v[80:83], v[128:131], v[104:107], v[80:83]
  ds_read_b128 v[124:127], v6 offset:18432
  s_add_u32 m0, s75, 81920
  s_add_u32 s14, s74, 1024
  buffer_load_dwordx4 v148, s[56:59], s14 offen lds
  buffer_load_dwordx4 v149, s[56:59], s14 offen offset:2048 lds
  v_mfma_f32_16x16x32_bf16 v[84:87], v[132:135], v[104:107], v[84:87]
  s_add_u32 m0, s75, 86016
  s_add_u32 s14, s74, 21504
  buffer_load_dwordx4 v148, s[56:59], s14 offen lds
  buffer_load_dwordx4 v149, s[56:59], s14 offen offset:2048 lds
  s_waitcnt vmcnt(15)
  s_barrier
  s_waitcnt lgkmcnt(2)
  v_mfma_f32_16x16x32_bf16 v[48:51], v[136:139], v[108:111], v[48:51]
  ds_read_b128 v[128:131], v144 offset:32768
  ds_read_b128 v[132:135], v144 offset:40960
  ds_read_b128 v[88:91], v5 offset:20480
  v_pk_fma_f32 v[158:159], v[154:155], v[204:205], v[158:159] neg_lo:[0,1,0] neg_hi:[0,1,0]
  v_mfma_f32_16x16x32_bf16 v[52:55], v[140:143], v[108:111], v[52:55]
  v_cvt_pk_bf16_f32 v179, v156, v157
  v_mfma_f32_16x16x32_bf16 v[56:59], v[136:139], v[112:115], v[56:59]
  ds_read_b128 v[92:95], v5 offset:22528
  v_cvt_pk_bf16_f32 v183, v158, v159
  v_mfma_f32_16x16x32_bf16 v[60:63], v[140:143], v[112:115], v[60:63]
  s_mul_i32 s12, s0, 204800
  s_add_u32 s12, s12, 23068672
  s_add_u32 s13, s12, 5120
  buffer_store_dwordx4 v[176:179], v174, s[52:55], s12 offen sc1
  buffer_store_dwordx4 v[180:183], v174, s[52:55], s13 offen sc1
  v_mfma_f32_16x16x32_bf16 v[64:67], v[136:139], v[116:119], v[64:67]
  ds_read_b128 v[96:99], v5 offset:24576
  s_add_u32 m0, s77, 16384
  s_add_u32 s15, s76, 5632
  buffer_load_dwordx4 v146, s[68:71], s15 offen lds
  buffer_load_dwordx4 v147, s[68:71], s15 offen offset:1024 lds
  v_mfma_f32_16x16x32_bf16 v[68:71], v[140:143], v[116:119], v[68:71]
  s_add_u32 m0, s75, 90112
  s_add_u32 s14, s74, 41984
  buffer_load_dwordx4 v148, s[56:59], s14 offen lds
  s_waitcnt lgkmcnt(5)
  v_mfma_f32_16x16x32_bf16 v[72:75], v[136:139], v[120:123], v[72:75]
  ds_read_b128 v[100:103], v5 offset:26624
  v_mfma_f32_16x16x32_bf16 v[76:79], v[140:143], v[120:123], v[76:79]
  v_mfma_f32_16x16x32_bf16 v[80:83], v[136:139], v[124:127], v[80:83]
  ds_read_b128 v[104:107], v5 offset:28672
  v_mfma_f32_16x16x32_bf16 v[84:87], v[140:143], v[124:127], v[84:87]
  s_waitcnt lgkmcnt(2)
  v_mfma_f32_16x16x32_bf16 v[48:51], v[128:131], v[88:91], v[48:51]
  ds_read_b128 v[136:139], v145 offset:32768
  ds_read_b128 v[140:143], v145 offset:40960
  ds_read_b128 v[108:111], v6 offset:20480
  s_add_u32 m0, s77, 24576
  s_add_u32 s15, s76, 640
  buffer_load_dwordx4 v146, s[68:71], s15 offen lds
  buffer_load_dwordx4 v147, s[68:71], s15 offen offset:1024 lds
  v_mfma_f32_16x16x32_bf16 v[52:55], v[132:135], v[88:91], v[52:55]
  v_mfma_f32_16x16x32_bf16 v[56:59], v[128:131], v[92:95], v[56:59]
  ds_read_b128 v[112:115], v6 offset:22528
  v_mfma_f32_16x16x32_bf16 v[60:63], v[132:135], v[92:95], v[60:63]
  v_mfma_f32_16x16x32_bf16 v[64:67], v[128:131], v[96:99], v[64:67]
  ds_read_b128 v[116:119], v6 offset:24576
  v_mfma_f32_16x16x32_bf16 v[68:71], v[132:135], v[96:99], v[68:71]
  s_waitcnt lgkmcnt(5)
  v_mfma_f32_16x16x32_bf16 v[72:75], v[128:131], v[100:103], v[72:75]
  ds_read_b128 v[120:123], v6 offset:26624
  v_mfma_f32_16x16x32_bf16 v[76:79], v[132:135], v[100:103], v[76:79]
  v_mfma_f32_16x16x32_bf16 v[80:83], v[128:131], v[104:107], v[80:83]
  ds_read_b128 v[124:127], v6 offset:28672
  v_mfma_f32_16x16x32_bf16 v[84:87], v[132:135], v[104:107], v[84:87]
  s_waitcnt vmcnt(14)
  s_waitcnt lgkmcnt(2)
  v_mfma_f32_16x16x32_bf16 v[48:51], v[136:139], v[108:111], v[48:51]
  ds_read_b128 v[128:131], v144 offset:49152
  ds_read_b128 v[132:135], v144 offset:0
  ds_read_b128 v[88:91], v5 offset:30720
  s_add_u32 m0, s77, 32768
  s_add_u32 s15, s76, 5760
  buffer_load_dwordx4 v146, s[68:71], s15 offen lds
  buffer_load_dwordx4 v147, s[68:71], s15 offen offset:1024 lds
  v_mfma_f32_16x16x32_bf16 v[52:55], v[140:143], v[108:111], v[52:55]
  v_mov_b32 v15, s8
  s_mov_b64 exec, 1
  s_cmp_eq_u32 s40, 0
  s_cbranch_scc1 slow_17
  buffer_store_dword v15, off, s[52:55], s41
back_18:
  s_mov_b64 exec, -1
  v_mfma_f32_16x16x32_bf16 v[56:59], v[136:139], v[112:115], v[56:59]
  ds_read_b128 v[92:95], v5 offset:32768
  v_mfma_f32_16x16x32_bf16 v[60:63], v[140:143], v[112:115], v[60:63]
  v_mfma_f32_16x16x32_bf16 v[64:67], v[136:139], v[116:119], v[64:67]
  ds_read_b128 v[96:99], v5 offset:34816
  v_mfma_f32_16x16x32_bf16 v[68:71], v[140:143], v[116:119], v[68:71]
  s_waitcnt lgkmcnt(5)
  v_mfma_f32_16x16x32_bf16 v[72:75], v[136:139], v[120:123], v[72:75]
  ds_read_b128 v[100:103], v5 offset:36864
  v_mfma_f32_16x16x32_bf16 v[76:79], v[140:143], v[120:123], v[76:79]
  v_mfma_f32_16x16x32_bf16 v[80:83], v[136:139], v[124:127], v[80:83]
  ds_read_b128 v[104:107], v5 offset:38912
  v_mfma_f32_16x16x32_bf16 v[84:87], v[140:143], v[124:127], v[84:87]
  s_waitcnt lgkmcnt(2)
  v_mfma_f32_16x16x32_bf16 v[48:51], v[128:131], v[88:91], v[48:51]
  ds_read_b128 v[136:139], v145 offset:49152
  ds_read_b128 v[140:143], v145 offset:0
  ds_read_b128 v[108:111], v6 offset:30720
  s_add_u32 m0, s77, 40960
  s_add_u32 s15, s76, 768
  buffer_load_dwordx4 v146, s[68:71], s15 offen lds
  buffer_load_dwordx4 v147, s[68:71], s15 offen offset:1024 lds
  v_mfma_f32_16x16x32_bf16 v[52:55], v[132:135], v[88:91], v[52:55]
  v_mfma_f32_16x16x32_bf16 v[56:59], v[128:131], v[92:95], v[56:59]
  ds_read_b128 v[112:115], v6 offset:32768
  v_mfma_f32_16x16x32_bf16 v[60:63], v[132:135], v[92:95], v[60:63]
  v_mfma_f32_16x16x32_bf16 v[64:67], v[128:131], v[96:99], v[64:67]
  ds_read_b128 v[116:119], v6 offset:34816
  v_mfma_f32_16x16x32_bf16 v[68:71], v[132:135], v[96:99], v[68:71]
  s_waitcnt lgkmcnt(5)
  v_mfma_f32_16x16x32_bf16 v[72:75], v[128:131], v[100:103], v[72:75]
  ds_read_b128 v[120:123], v6 offset:36864
  v_mfma_f32_16x16x32_bf16 v[76:79], v[132:135], v[100:103], v[76:79]
  v_mfma_f32_16x16x32_bf16 v[80:83], v[128:131], v[104:107], v[80:83]
  ds_read_b128 v[124:127], v6 offset:38912
  v_mfma_f32_16x16x32_bf16 v[84:87], v[132:135], v[104:107], v[84:87]
  s_waitcnt vmcnt(8)
  s_barrier
  s_waitcnt lgkmcnt(2)
  v_mfma_f32_16x16x32_bf16 v[48:51], v[136:139], v[108:111], v[48:51]
  ds_read_b128 v[128:131], v144 offset:8192
  ds_read_b128 v[132:135], v144 offset:16384
  ds_read_b128 v[88:91], v5 offset:40960
  s_add_u32 m0, s77, 49152
  s_add_u32 s15, s76, 5888
  buffer_load_dwordx4 v146, s[68:71], s15 offen lds
  buffer_load_dwordx4 v147, s[68:71], s15 offen offset:1024 lds
  v_mfma_f32_16x16x32_bf16 v[52:55], v[140:143], v[108:111], v[52:55]
  s_add_u32 s12, s85, 66048
  v_mov_b32 v15, s8
  s_mov_b64 exec, 1
  buffer_store_dword v15, off, s[52:55], s12 sc1
  s_mov_b64 exec, -1
  v_mfma_f32_16x16x32_bf16 v[56:59], v[136:139], v[112:115], v[56:59]
  ds_read_b128 v[92:95], v5 offset:43008
  v_mfma_f32_16x16x32_bf16 v[60:63], v[140:143], v[112:115], v[60:63]
  v_mfma_f32_16x16x32_bf16 v[64:67], v[136:139], v[116:119], v[64:67]
  ds_read_b128 v[96:99], v5 offset:45056
  v_mfma_f32_16x16x32_bf16 v[68:71], v[140:143], v[116:119], v[68:71]
  s_waitcnt lgkmcnt(5)
  v_mfma_f32_16x16x32_bf16 v[72:75], v[136:139], v[120:123], v[72:75]
  ds_read_b128 v[100:103], v5 offset:47104
  v_mfma_f32_16x16x32_bf16 v[76:79], v[140:143], v[120:123], v[76:79]
  v_mfma_f32_16x16x32_bf16 v[80:83], v[136:139], v[124:127], v[80:83]
  ds_read_b128 v[104:107], v5 offset:49152
  v_mfma_f32_16x16x32_bf16 v[84:87], v[140:143], v[124:127], v[84:87]
  s_waitcnt lgkmcnt(2)
  v_mfma_f32_16x16x32_bf16 v[48:51], v[128:131], v[88:91], v[48:51]
  ds_read_b128 v[136:139], v145 offset:8192
  ds_read_b128 v[140:143], v145 offset:16384
  ds_read_b128 v[108:111], v6 offset:40960
  s_add_u32 m0, s77, 0
  s_add_u32 s15, s76, 896
  buffer_load_dwordx4 v146, s[68:71], s15 offen lds
  buffer_load_dwordx4 v147, s[68:71], s15 offen offset:1024 lds
  v_mfma_f32_16x16x32_bf16 v[52:55], v[132:135], v[88:91], v[52:55]
  v_lshrrev_b32_e64 v11, 5, v1
  v_mfma_f32_16x16x32_bf16 v[56:59], v[128:131], v[92:95], v[56:59]
  ds_read_b128 v[112:115], v6 offset:43008
  v_mul_u32_u24 v11, 4096, v11
  v_mfma_f32_16x16x32_bf16 v[60:63], v[132:135], v[92:95], v[60:63]
  v_add_u32_e64 v11, v11, v2
  v_mfma_f32_16x16x32_bf16 v[64:67], v[128:131], v[96:99], v[64:67]
  ds_read_b128 v[116:119], v6 offset:45056
  v_mov_b32_e64 v216, 0
  v_mfma_f32_16x16x32_bf16 v[68:71], v[132:135], v[96:99], v[68:71]
  v_mov_b32 v217, 0
  s_waitcnt lgkmcnt(5)
  v_mfma_f32_16x16x32_bf16 v[72:75], v[128:131], v[100:103], v[72:75]
  ds_read_b128 v[120:123], v6 offset:47104
  v_mov_b32_e64 v218, 0
  v_mfma_f32_16x16x32_bf16 v[76:79], v[132:135], v[100:103], v[76:79]
  v_mov_b32_e64 v219, 0
  v_mfma_f32_16x16x32_bf16 v[80:83], v[128:131], v[104:107], v[80:83]
  ds_read_b128 v[124:127], v6 offset:49152
  ds_write_b128 v11, v[216:219] offset:4096
  v_mfma_f32_16x16x32_bf16 v[84:87], v[132:135], v[104:107], v[84:87]
  ds_write_b128 v11, v[216:219] offset:8704
  s_waitcnt vmcnt(8)
  s_waitcnt lgkmcnt(4)
  v_mfma_f32_16x16x32_bf16 v[48:51], v[136:139], v[108:111], v[48:51]
  ds_read_b128 v[128:131], v144 offset:24576
  ds_read_b128 v[132:135], v144 offset:32768
  ds_read_b128 v[88:91], v7 offset:0
  s_add_u32 m0, s77, 8192
  s_add_u32 s15, s76, 6016
  buffer_load_dwordx4 v146, s[68:71], s15 offen lds
  buffer_load_dwordx4 v147, s[68:71], s15 offen offset:1024 lds
  v_mfma_f32_16x16x32_bf16 v[52:55], v[140:143], v[108:111], v[52:55]
  v_mfma_f32_16x16x32_bf16 v[56:59], v[136:139], v[112:115], v[56:59]
  ds_read_b128 v[92:95], v7 offset:2048
  v_mfma_f32_16x16x32_bf16 v[60:63], v[140:143], v[112:115], v[60:63]
  v_mfma_f32_16x16x32_bf16 v[64:67], v[136:139], v[116:119], v[64:67]
  ds_read_b128 v[96:99], v7 offset:4096
  v_mfma_f32_16x16x32_bf16 v[68:71], v[140:143], v[116:119], v[68:71]
  s_waitcnt lgkmcnt(7)
  v_mfma_f32_16x16x32_bf16 v[72:75], v[136:139], v[120:123], v[72:75]
  ds_read_b128 v[100:103], v7 offset:6144
  v_mfma_f32_16x16x32_bf16 v[76:79], v[140:143], v[120:123], v[76:79]
  v_mfma_f32_16x16x32_bf16 v[80:83], v[136:139], v[124:127], v[80:83]
  ds_read_b128 v[104:107], v7 offset:8192
  v_mfma_f32_16x16x32_bf16 v[84:87], v[140:143], v[124:127], v[84:87]
  s_waitcnt lgkmcnt(2)
  v_mfma_f32_16x16x32_bf16 v[48:51], v[128:131], v[88:91], v[48:51]
  ds_read_b128 v[136:139], v145 offset:24576
  ds_read_b128 v[140:143], v145 offset:32768
  ds_read_b128 v[108:111], v8 offset:0
  s_add_u32 m0, s77, 16384
  s_add_u32 s15, s76, 1024
  buffer_load_dwordx4 v146, s[68:71], s15 offen lds
  buffer_load_dwordx4 v147, s[68:71], s15 offen offset:1024 lds
  v_mfma_f32_16x16x32_bf16 v[52:55], v[132:135], v[88:91], v[52:55]
  s_and_b32 s87, s85, 0x3800
  s_add_u32 s87, s87, 65536
  buffer_load_dwordx2 v[188:189], v187, s[52:55], s87 offen sc1
  v_mfma_f32_16x16x32_bf16 v[56:59], v[128:131], v[92:95], v[56:59]
  ds_read_b128 v[112:115], v8 offset:2048
  v_mfma_f32_16x16x32_bf16 v[60:63], v[132:135], v[92:95], v[60:63]
  v_mfma_f32_16x16x32_bf16 v[64:67], v[128:131], v[96:99], v[64:67]
  ds_read_b128 v[116:119], v8 offset:4096
  v_mfma_f32_16x16x32_bf16 v[68:71], v[132:135], v[96:99], v[68:71]
  s_waitcnt lgkmcnt(5)
  v_mfma_f32_16x16x32_bf16 v[72:75], v[128:131], v[100:103], v[72:75]
  ds_read_b128 v[120:123], v8 offset:6144
  v_mfma_f32_16x16x32_bf16 v[76:79], v[132:135], v[100:103], v[76:79]
  v_mfma_f32_16x16x32_bf16 v[80:83], v[128:131], v[104:107], v[80:83]
  ds_read_b128 v[124:127], v8 offset:8192
  v_mfma_f32_16x16x32_bf16 v[84:87], v[132:135], v[104:107], v[84:87]
  s_waitcnt vmcnt(8)
  s_barrier
  s_waitcnt lgkmcnt(2)
  v_mfma_f32_16x16x32_bf16 v[48:51], v[136:139], v[108:111], v[48:51]
  ds_read_b128 v[128:131], v144 offset:40960
  ds_read_b128 v[132:135], v144 offset:49152
  ds_read_b128 v[88:91], v7 offset:10240
  s_add_u32 m0, s77, 24576
  s_add_u32 s15, s76, 6144
  buffer_load_dwordx4 v146, s[68:71], s15 offen lds
  buffer_load_dwordx4 v147, s[68:71], s15 offen offset:1024 lds
  v_mfma_f32_16x16x32_bf16 v[52:55], v[140:143], v[108:111], v[52:55]
  v_mfma_f32_16x16x32_bf16 v[56:59], v[136:139], v[112:115], v[56:59]
  ds_read_b128 v[92:95], v7 offset:12288
  v_mfma_f32_16x16x32_bf16 v[60:63], v[140:143], v[112:115], v[60:63]
  v_mfma_f32_16x16x32_bf16 v[64:67], v[136:139], v[116:119], v[64:67]
  ds_read_b128 v[96:99], v7 offset:14336
  v_mfma_f32_16x16x32_bf16 v[68:71], v[140:143], v[116:119], v[68:71]
  s_waitcnt lgkmcnt(5)
  v_mfma_f32_16x16x32_bf16 v[72:75], v[136:139], v[120:123], v[72:75]
  ds_read_b128 v[100:103], v7 offset:16384
  v_mfma_f32_16x16x32_bf16 v[76:79], v[140:143], v[120:123], v[76:79]
  v_mfma_f32_16x16x32_bf16 v[80:83], v[136:139], v[124:127], v[80:83]
  ds_read_b128 v[104:107], v7 offset:18432
  v_mfma_f32_16x16x32_bf16 v[84:87], v[140:143], v[124:127], v[84:87]
  s_waitcnt lgkmcnt(2)
  v_mfma_f32_16x16x32_bf16 v[48:51], v[128:131], v[88:91], v[48:51]
  ds_read_b128 v[136:139], v145 offset:40960
  ds_read_b128 v[140:143], v145 offset:49152
  ds_read_b128 v[108:111], v8 offset:10240
  s_add_u32 m0, s77, 32768
  s_add_u32 s15, s76, 1152
  buffer_load_dwordx4 v146, s[68:71], s15 offen lds
  buffer_load_dwordx4 v147, s[68:71], s15 offen offset:1024 lds
  v_mfma_f32_16x16x32_bf16 v[52:55], v[132:135], v[88:91], v[52:55]
  s_waitcnt vmcnt(4)
  v_xor_b32 v15, s8, v188
  v_xor_b32 v14, s8, v189
  v_or_b32 v15, v15, v14
  v_cmp_ne_u32 vcc, 0, v15
  s_cbranch_vccnz again_19
ok_20:
  s_lshl_b32 s12, s0, 16
  s_add_u32 s12, s12, s90
  s_add_u32 s12, s12, 4194304
  s_lshl_b32 m0, s7, 10
  s_nop 0
  buffer_load_dwordx4 v2, s[52:55], s12 offen sc1 lds
  s_lshl_b32 s12, s0, 16
  s_add_u32 s12, s12, s91
  s_add_u32 s12, s12, 4194304
  s_lshl_b32 m0, s7, 10
  s_add_u32 m0, m0, 4608
  s_nop 0
  buffer_load_dwordx4 v2, s[52:55], s12 offen sc1 lds
  v_mfma_f32_16x16x32_bf16 v[56:59], v[128:131], v[92:95], v[56:59]
  ds_read_b128 v[112:115], v8 offset:12288
  v_mfma_f32_16x16x32_bf16 v[60:63], v[132:135], v[92:95], v[60:63]
  v_mfma_f32_16x16x32_bf16 v[64:67], v[128:131], v[96:99], v[64:67]
  ds_read_b128 v[116:119], v8 offset:14336
  v_mfma_f32_16x16x32_bf16 v[68:71], v[132:135], v[96:99], v[68:71]
  s_waitcnt lgkmcnt(5)
  v_mfma_f32_16x16x32_bf16 v[72:75], v[128:131], v[100:103], v[72:75]
  ds_read_b128 v[120:123], v8 offset:16384
  v_mfma_f32_16x16x32_bf16 v[76:79], v[132:135], v[100:103], v[76:79]
  v_mfma_f32_16x16x32_bf16 v[80:83], v[128:131], v[104:107], v[80:83]
  ds_read_b128 v[124:127], v8 offset:18432
  v_mfma_f32_16x16x32_bf16 v[84:87], v[132:135], v[104:107], v[84:87]
  s_waitcnt lgkmcnt(2)
  v_mfma_f32_16x16x32_bf16 v[48:51], v[136:139], v[108:111], v[48:51]
  ds_read_b128 v[128:131], v144 offset:0
  ds_read_b128 v[132:135], v144 offset:8192
  ds_read_b128 v[88:91], v7 offset:20480
  s_add_u32 m0, s77, 40960
  s_add_u32 s15, s76, 6272
  buffer_load_dwordx4 v146, s[68:71], s15 offen lds
  buffer_load_dwordx4 v147, s[68:71], s15 offen offset:1024 lds
  v_mfma_f32_16x16x32_bf16 v[52:55], v[140:143], v[108:111], v[52:55]
  buffer_load_dwordx3 v[152:154], v160, s[52:55], s93 offen sc1
  v_mfma_f32_16x16x32_bf16 v[56:59], v[136:139], v[112:115], v[56:59]
  ds_read_b128 v[92:95], v7 offset:22528
  buffer_load_dwordx2 v[156:157], v161, s[52:55], s94 offen sc1
  v_mfma_f32_16x16x32_bf16 v[60:63], v[140:143], v[112:115], v[60:63]
  buffer_load_dwordx2 v[158:159], v162, s[52:55], s94 offen offset:512 sc1
  v_mfma_f32_16x16x32_bf16 v[64:67], v[136:139], v[116:119], v[64:67]
  ds_read_b128 v[96:99], v7 offset:24576
  s_mov_b32 s36, 32768
  buffer_load_dwordx4 v[220:223], v2, s[52:55], s36 offen sc1
  v_mfma_f32_16x16x32_bf16 v[68:71], v[140:143], v[116:119], v[68:71]
  s_waitcnt lgkmcnt(5)
  v_mfma_f32_16x16x32_bf16 v[72:75], v[136:139], v[120:123], v[72:75]
  ds_read_b128 v[100:103], v7 offset:26624
  v_mfma_f32_16x16x32_bf16 v[76:79], v[140:143], v[120:123], v[76:79]
  v_mfma_f32_16x16x32_bf16 v[80:83], v[136:139], v[124:127], v[80:83]
  ds_read_b128 v[104:107], v7 offset:28672
  v_mfma_f32_16x16x32_bf16 v[84:87], v[140:143], v[124:127], v[84:87]
  s_waitcnt lgkmcnt(2)
  v_mfma_f32_16x16x32_bf16 v[48:51], v[128:131], v[88:91], v[48:51]
  ds_read_b128 v[136:139], v145 offset:0
  ds_read_b128 v[140:143], v145 offset:8192
  ds_read_b128 v[108:111], v8 offset:20480
  s_mov_b32 s64, s42
  s_and_b32 s65, s43, 0xffff
  s_mov_b32 s66, 2621440
  s_mov_b32 s67, 0x20000
  v_mfma_f32_16x16x32_bf16 v[52:55], v[132:135], v[88:91], v[52:55]
  buffer_load_dwordx4 v[192:195], v2, s[64:67], s90 offen nt
  v_mfma_f32_16x16x32_bf16 v[56:59], v[128:131], v[92:95], v[56:59]
  ds_read_b128 v[112:115], v8 offset:22528
  buffer_load_dwordx4 v[204:207], v2, s[64:67], s90 offen offset:4 nt
  v_mfma_f32_16x16x32_bf16 v[60:63], v[132:135], v[92:95], v[60:63]
  buffer_load_dwordx4 v[188:191], v187, s[52:55], s88 offen sc1
  v_mfma_f32_16x16x32_bf16 v[64:67], v[128:131], v[96:99], v[64:67]
  ds_read_b128 v[116:119], v8 offset:24576
  v_mfma_f32_16x16x32_bf16 v[68:71], v[132:135], v[96:99], v[68:71]
  s_waitcnt lgkmcnt(5)
  v_mfma_f32_16x16x32_bf16 v[72:75], v[128:131], v[100:103], v[72:75]
  ds_read_b128 v[120:123], v8 offset:26624
  v_mfma_f32_16x16x32_bf16 v[76:79], v[132:135], v[100:103], v[76:79]
  v_mfma_f32_16x16x32_bf16 v[80:83], v[128:131], v[104:107], v[80:83]
  ds_read_b128 v[124:127], v8 offset:28672
  v_mfma_f32_16x16x32_bf16 v[84:87], v[132:135], v[104:107], v[84:87]
  s_waitcnt vmcnt(13)
  s_barrier
  s_waitcnt lgkmcnt(2)
  v_mfma_f32_16x16x32_bf16 v[48:51], v[136:139], v[108:111], v[48:51]
  ds_read_b128 v[128:131], v144 offset:16384
  ds_read_b128 v[132:135], v144 offset:24576
  ds_read_b128 v[88:91], v7 offset:30720
  buffer_load_dwordx4 v[196:199], v2, s[64:67], s91 offen nt
  v_mfma_f32_16x16x32_bf16 v[52:55], v[140:143], v[108:111], v[52:55]
  buffer_load_dwordx4 v[208:211], v2, s[64:67], s91 offen offset:4 nt
  v_mfma_f32_16x16x32_bf16 v[56:59], v[136:139], v[112:115], v[56:59]
  ds_read_b128 v[92:95], v7 offset:32768
  buffer_load_dwordx4 v[200:203], v2, s[64:67], s92 offen nt
  v_mfma_f32_16x16x32_bf16 v[60:63], v[140:143], v[112:115], v[60:63]
  v_mfma_f32_16x16x32_bf16 v[64:67], v[136:139], v[116:119], v[64:67]
  ds_read_b128 v[96:99], v7 offset:34816
  v_mfma_f32_16x16x32_bf16 v[68:71], v[140:143], v[116:119], v[68:71]
  s_waitcnt lgkmcnt(5)
  v_mfma_f32_16x16x32_bf16 v[72:75], v[136:139], v[120:123], v[72:75]
  ds_read_b128 v[100:103], v7 offset:36864
  v_mfma_f32_16x16x32_bf16 v[76:79], v[140:143], v[120:123], v[76:79]
  v_mfma_f32_16x16x32_bf16 v[80:83], v[136:139], v[124:127], v[80:83]
  ds_read_b128 v[104:107], v7 offset:38912
  v_mfma_f32_16x16x32_bf16 v[84:87], v[140:143], v[124:127], v[84:87]
  s_waitcnt lgkmcnt(2)
  v_mfma_f32_16x16x32_bf16 v[48:51], v[128:131], v[88:91], v[48:51]
  ds_read_b128 v[136:139], v145 offset:16384
  ds_read_b128 v[140:143], v145 offset:24576
  ds_read_b128 v[108:111], v8 offset:30720
  buffer_load_dwordx4 v[212:215], v2, s[64:67], s92 offen offset:4 nt
  v_mfma_f32_16x16x32_bf16 v[52:55], v[132:135], v[88:91], v[52:55]
  v_mfma_f32_16x16x32_bf16 v[56:59], v[128:131], v[92:95], v[56:59]
  ds_read_b128 v[112:115], v8 offset:32768
  v_mfma_f32_16x16x32_bf16 v[60:63], v[132:135], v[92:95], v[60:63]
  v_mfma_f32_16x16x32_bf16 v[64:67], v[128:131], v[96:99], v[64:67]
  ds_read_b128 v[116:119], v8 offset:34816
  v_mfma_f32_16x16x32_bf16 v[68:71], v[132:135], v[96:99], v[68:71]
  s_waitcnt lgkmcnt(5)
  v_mfma_f32_16x16x32_bf16 v[72:75], v[128:131], v[100:103], v[72:75]
  ds_read_b128 v[120:123], v8 offset:36864
  v_mfma_f32_16x16x32_bf16 v[76:79], v[132:135], v[100:103], v[76:79]
  v_mfma_f32_16x16x32_bf16 v[80:83], v[128:131], v[104:107], v[80:83]
  ds_read_b128 v[124:127], v8 offset:38912
  v_mfma_f32_16x16x32_bf16 v[84:87], v[132:135], v[104:107], v[84:87]
  s_waitcnt vmcnt(11)
  s_waitcnt lgkmcnt(2)
  v_mfma_f32_16x16x32_bf16 v[48:51], v[136:139], v[108:111], v[48:51]
  ds_read_b128 v[128:131], v144 offset:32768
  ds_read_b128 v[132:135], v144 offset:40960
  ds_read_b128 v[88:91], v7 offset:40960
  s_waitcnt vmcnt(8)
  v_min3_u32 v15, v154, v154, s8
  v_max3_u32 v14, v154, v154, s8
  v_min3_u32 v15, v15, v157, v159
  v_max3_u32 v14, v14, v157, v159
  v_cmp_ne_u32 vcc, v15, v14
  s_cbranch_vccnz again_21
ok_22:
  v_mfma_f32_16x16x32_bf16 v[52:55], v[140:143], v[108:111], v[52:55]
  s_waitcnt vmcnt(7)
  v_min3_u32 v15, v220, v221, s8
  v_max3_u32 v14, v220, v221, s8
  v_min3_u32 v15, v15, v222, v223
  v_max3_u32 v14, v14, v222, v223
  v_cmp_ne_u32 vcc, v15, v14
  s_cbranch_vccnz again_23
ok_24:
  s_lshl_b32 s13, s7, 6
  s_sub_u32 s12, 255, s13
  v_sub_u32 v11, s12, v1
  v_lshlrev_b32 v11, 11, v11
  s_and_b32 s12, s24, 3
  s_lshl_b32 s12, s12, 9
  s_bfe_u32 s14, s24, 0x50002
  s_lshl_b32 s14, s14, 4
  s_add_u32 s12, s12, s14
  s_add_u32 s12, s12, 26214400
  s_lshl_b32 s13, s13, 4
  s_add_u32 m0, s13, 9216
  s_nop 0
  buffer_load_dwordx4 v11, s[52:55], s12 offen sc1 lds
  v_mfma_f32_16x16x32_bf16 v[56:59], v[136:139], v[112:115], v[56:59]
  ds_read_b128 v[92:95], v7 offset:43008
  s_waitcnt vmcnt(5)
  v_min3_u32 v15, v188, v189, s8
  v_max3_u32 v14, v188, v189, s8
  v_min3_u32 v15, v15, v190, v191
  v_max3_u32 v14, v14, v190, v191
  v_cmp_ne_u32 vcc, v15, v14
  s_cbranch_vccnz again_25
ok_26:
  s_mul_i32 s34, s6, 200
  s_mul_i32 s12, s7, 50
  s_add_u32 s34, s34, s12
  s_lshl_b32 s34, s34, 10
  s_add_u32 s34, s34, 23068672
  v_mfma_f32_16x16x32_bf16 v[60:63], v[140:143], v[112:115], v[60:63]
  buffer_load_dwordx4 a[0:3], v2, s[52:55], s34 offen offset:0 sc1
  v_mfma_f32_16x16x32_bf16 v[64:67], v[136:139], v[116:119], v[64:67]
  ds_read_b128 v[96:99], v7 offset:45056
  buffer_load_dwordx4 a[4:7], v2, s[52:55], s34 offen offset:1024 sc1
  v_mfma_f32_16x16x32_bf16 v[68:71], v[140:143], v[116:119], v[68:71]
  buffer_load_dwordx4 a[8:11], v2, s[52:55], s34 offen offset:2048 sc1
  s_waitcnt lgkmcnt(5)
  v_mfma_f32_16x16x32_bf16 v[72:75], v[136:139], v[120:123], v[72:75]
  ds_read_b128 v[100:103], v7 offset:47104
  v_mfma_f32_16x16x32_bf16 v[76:79], v[140:143], v[120:123], v[76:79]
  v_mfma_f32_16x16x32_bf16 v[80:83], v[136:139], v[124:127], v[80:83]
  ds_read_b128 v[104:107], v7 offset:49152
  v_mfma_f32_16x16x32_bf16 v[84:87], v[140:143], v[124:127], v[84:87]
  s_waitcnt lgkmcnt(2)
  v_mfma_f32_16x16x32_bf16 v[48:51], v[128:131], v[88:91], v[48:51]
  ds_read_b128 v[136:139], v145 offset:32768
  ds_read_b128 v[140:143], v145 offset:40960
  ds_read_b128 v[108:111], v8 offset:40960
  buffer_load_dwordx4 a[12:15], v2, s[52:55], s34 offen offset:3072 sc1
  v_mfma_f32_16x16x32_bf16 v[52:55], v[132:135], v[88:91], v[52:55]
  s_add_u32 s34, s34, 4096
  buffer_load_dwordx4 a[16:19], v2, s[52:55], s34 offen offset:0 sc1
  v_mfma_f32_16x16x32_bf16 v[56:59], v[128:131], v[92:95], v[56:59]
  ds_read_b128 v[112:115], v8 offset:43008
  buffer_load_dwordx4 a[20:23], v2, s[52:55], s34 offen offset:1024 sc1
  v_mfma_f32_16x16x32_bf16 v[60:63], v[132:135], v[92:95], v[60:63]
  v_mfma_f32_16x16x32_bf16 v[64:67], v[128:131], v[96:99], v[64:67]
  ds_read_b128 v[116:119], v8 offset:45056
  v_mfma_f32_16x16x32_bf16 v[68:71], v[132:135], v[96:99], v[68:71]
  s_waitcnt lgkmcnt(5)
  v_mfma_f32_16x16x32_bf16 v[72:75], v[128:131], v[100:103], v[72:75]
  ds_read_b128 v[120:123], v8 offset:47104
  v_mfma_f32_16x16x32_bf16 v[76:79], v[132:135], v[100:103], v[76:79]
  v_mfma_f32_16x16x32_bf16 v[80:83], v[128:131], v[104:107], v[80:83]
  ds_read_b128 v[124:127], v8 offset:49152
  v_mfma_f32_16x16x32_bf16 v[84:87], v[132:135], v[104:107], v[84:87]
  s_waitcnt lgkmcnt(2)
  s_barrier
  v_mfma_f32_16x16x32_bf16 v[48:51], v[136:139], v[108:111], v[48:51]
  buffer_load_dwordx4 a[24:27], v2, s[52:55], s34 offen offset:2048 sc1
  buffer_load_dwordx4 a[28:31], v2, s[52:55], s34 offen offset:3072 sc1
  v_mov_b32_e64 v246, v156
  v_mfma_f32_16x16x32_bf16 v[52:55], v[140:143], v[108:111], v[52:55]
  v_mov_b32 v247, v156
  v_mov_b32 v250, v158
  s_nop 0
  v_permlane16_swap_b32 v246, v247
  v_mfma_f32_16x16x32_bf16 v[56:59], v[136:139], v[112:115], v[56:59]
  v_mov_b32 v248, v246
  v_mov_b32 v249, v247
  s_nop 0
  v_permlane32_swap_b32 v246, v248
  v_mfma_f32_16x16x32_bf16 v[60:63], v[140:143], v[112:115], v[60:63]
  v_permlane32_swap_b32 v247, v249
  v_mov_b32_dpp v88, v152 row_newbcast:0 row_mask:0xf bank_mask:0xf
  v_mov_b32_dpp v96, v153 row_newbcast:0 row_mask:0xf bank_mask:0xf
  v_mfma_f32_16x16x32_bf16 v[64:67], v[136:139], v[116:119], v[64:67]
  v_mov_b32_dpp v89, v152 row_newbcast:1 row_mask:0xf bank_mask:0xf
  v_mov_b32_dpp v97, v153 row_newbcast:1 row_mask:0xf bank_mask:0xf
  v_mov_b32_dpp v90, v152 row_newbcast:2 row_mask:0xf bank_mask:0xf
  v_mfma_f32_16x16x32_bf16 v[68:71], v[140:143], v[116:119], v[68:71]
  v_mov_b32_dpp v98, v153 row_newbcast:2 row_mask:0xf bank_mask:0xf
  v_mov_b32_dpp v91, v152 row_newbcast:3 row_mask:0xf bank_mask:0xf
  v_mov_b32_dpp v99, v153 row_newbcast:3 row_mask:0xf bank_mask:0xf
  s_waitcnt lgkmcnt(0)
  v_mfma_f32_16x16x32_bf16 v[72:75], v[136:139], v[120:123], v[72:75]
  v_mov_b32_dpp v92, v152 row_newbcast:4 row_mask:0xf bank_mask:0xf
  v_mov_b32_dpp v100, v153 row_newbcast:4 row_mask:0xf bank_mask:0xf
  v_mfma_f32_16x16x32_bf16 v[76:79], v[140:143], v[120:123], v[76:79]
  v_mov_b32_dpp v93, v152 row_newbcast:5 row_mask:0xf bank_mask:0xf
  v_mov_b32_dpp v101, v153 row_newbcast:5 row_mask:0xf bank_mask:0xf
  v_mfma_f32_16x16x32_bf16 v[80:83], v[136:139], v[124:127], v[80:83]
  v_mov_b32_dpp v94, v152 row_newbcast:6 row_mask:0xf bank_mask:0xf
  v_mov_b32_dpp v102, v153 row_newbcast:6 row_mask:0xf bank_mask:0xf
  v_mfma_f32_16x16x32_bf16 v[84:87], v[140:143], v[124:127], v[84:87]
  v_mov_b32_dpp v95, v152 row_newbcast:7 row_mask:0xf bank_mask:0xf
  v_mov_b32_dpp v103, v153 row_newbcast:7 row_mask:0xf bank_mask:0xf
  v_pk_fma_f32 v[48:49], v[88:89], v[246:247], v[48:49] op_sel_hi:[1,0,1] neg_lo:[1,0,0] neg_hi:[1,0,0]
  v_pk_fma_f32 v[50:51], v[90:91], v[246:247], v[50:51] op_sel_hi:[1,0,1] neg_lo:[1,0,0] neg_hi:[1,0,0]
  v_pk_fma_f32 v[52:53], v[92:93], v[246:247], v[52:53] op_sel_hi:[1,0,1] neg_lo:[1,0,0] neg_hi:[1,0,0]
  v_pk_fma_f32 v[54:55], v[94:95], v[246:247], v[54:55] op_sel_hi:[1,0,1] neg_lo:[1,0,0] neg_hi:[1,0,0]
  v_pk_fma_f32 v[56:57], v[88:89], v[246:247], v[56:57] op_sel:[0,1,0] op_sel_hi:[1,1,1] neg_lo:[1,0,0] neg_hi:[1,0,0]
  v_pk_fma_f32 v[58:59], v[90:91], v[246:247], v[58:59] op_sel:[0,1,0] op_sel_hi:[1,1,1] neg_lo:[1,0,0] neg_hi:[1,0,0]
  v_pk_fma_f32 v[60:61], v[92:93], v[246:247], v[60:61] op_sel:[0,1,0] op_sel_hi:[1,1,1] neg_lo:[1,0,0] neg_hi:[1,0,0]
  v_pk_fma_f32 v[62:63], v[94:95], v[246:247], v[62:63] op_sel:[0,1,0] op_sel_hi:[1,1,1] neg_lo:[1,0,0] neg_hi:[1,0,0]
  v_pk_fma_f32 v[64:65], v[88:89], v[248:249], v[64:65] op_sel_hi:[1,0,1] neg_lo:[1,0,0] neg_hi:[1,0,0]
  v_pk_fma_f32 v[66:67], v[90:91], v[248:249], v[66:67] op_sel_hi:[1,0,1] neg_lo:[1,0,0] neg_hi:[1,0,0]
  v_pk_fma_f32 v[68:69], v[92:93], v[248:249], v[68:69] op_sel_hi:[1,0,1] neg_lo:[1,0,0] neg_hi:[1,0,0]
  v_pk_fma_f32 v[70:71], v[94:95], v[248:249], v[70:71] op_sel_hi:[1,0,1] neg_lo:[1,0,0] neg_hi:[1,0,0]
  v_pk_fma_f32 v[72:73], v[88:89], v[248:249], v[72:73] op_sel:[0,1,0] op_sel_hi:[1,1,1] neg_lo:[1,0,0] neg_hi:[1,0,0]
  v_pk_fma_f32 v[74:75], v[90:91], v[248:249], v[74:75] op_sel:[0,1,0] op_sel_hi:[1,1,1] neg_lo:[1,0,0] neg_hi:[1,0,0]
  v_pk_fma_f32 v[76:77], v[92:93], v[248:249], v[76:77] op_sel:[0,1,0] op_sel_hi:[1,1,1] neg_lo:[1,0,0] neg_hi:[1,0,0]
  v_pk_fma_f32 v[78:79], v[94:95], v[248:249], v[78:79] op_sel:[0,1,0] op_sel_hi:[1,1,1] neg_lo:[1,0,0] neg_hi:[1,0,0]
  v_pk_fma_f32 v[80:81], v[88:89], v[250:251], v[80:81] op_sel_hi:[1,0,1] neg_lo:[1,0,0] neg_hi:[1,0,0]
  v_pk_fma_f32 v[82:83], v[90:91], v[250:251], v[82:83] op_sel_hi:[1,0,1] neg_lo:[1,0,0] neg_hi:[1,0,0]
  v_pk_fma_f32 v[84:85], v[92:93], v[250:251], v[84:85] op_sel_hi:[1,0,1] neg_lo:[1,0,0] neg_hi:[1,0,0]
  v_pk_fma_f32 v[86:87], v[94:95], v[250:251], v[86:87] op_sel_hi:[1,0,1] neg_lo:[1,0,0] neg_hi:[1,0,0]
  v_pk_mul_f32 v[48:49], v[48:49], v[96:97]
  v_pk_mul_f32 v[50:51], v[50:51], v[98:99]
  v_pk_mul_f32 v[52:53], v[52:53], v[100:101]
  v_pk_mul_f32 v[54:55], v[54:55], v[102:103]
  v_pk_mul_f32 v[56:57], v[56:57], v[96:97]
  v_pk_mul_f32 v[58:59], v[58:59], v[98:99]
  v_pk_mul_f32 v[60:61], v[60:61], v[100:101]
  v_pk_mul_f32 v[62:63], v[62:63], v[102:103]
  v_pk_mul_f32 v[64:65], v[64:65], v[96:97]
  v_pk_mul_f32 v[66:67], v[66:67], v[98:99]
  v_pk_mul_f32 v[68:69], v[68:69], v[100:101]
  v_pk_mul_f32 v[70:71], v[70:71], v[102:103]
  v_pk_mul_f32 v[72:73], v[72:73], v[96:97]
  v_pk_mul_f32 v[74:75], v[74:75], v[98:99]
  v_pk_mul_f32 v[76:77], v[76:77], v[100:101]
  v_pk_mul_f32 v[78:79], v[78:79], v[102:103]
  v_pk_mul_f32 v[80:81], v[80:81], v[96:97]
  v_pk_mul_f32 v[82:83], v[82:83], v[98:99]
  v_pk_mul_f32 v[84:85], v[84:85], v[100:101]
  v_pk_mul_f32 v[86:87], v[86:87], v[102:103]
  s_waitcnt vmcnt(9)
  ds_write_b128 v186, v[192:195] offset:0
  s_add_u32 s34, s34, 4096
  buffer_load_dwordx4 a[32:35], v2, s[52:55], s34 offen offset:0 sc1
  v_fmac_f32 v49, v16, v48
  v_fmac_f32 v57, v17, v56
  v_fmac_f32 v65, v18, v64
  v_fmac_f32 v73, v19, v72
  v_fmac_f32 v81, v20, v80
  v_fmac_f32_dpp v49, v48, v21 quad_perm:[1,0,3,2] row_mask:0xf bank_mask:0xf
  v_fmac_f32_dpp v57, v56, v22 quad_perm:[1,0,3,2] row_mask:0xf bank_mask:0xf
  v_fmac_f32_dpp v65, v64, v23 quad_perm:[1,0,3,2] row_mask:0xf bank_mask:0xf
  v_fmac_f32_dpp v73, v72, v24 quad_perm:[1,0,3,2] row_mask:0xf bank_mask:0xf
  v_fmac_f32_dpp v81, v80, v25 quad_perm:[1,0,3,2] row_mask:0xf bank_mask:0xf
  v_alignbit_b32 v204, v204, v192, 16
  v_alignbit_b32 v205, v205, v193, 16
  v_alignbit_b32 v206, v206, v194, 16
  v_alignbit_b32 v207, v207, v195, 16
  ds_write_b128 v186, v[204:207] offset:4160
  ds_write_b128 v186, v[196:199] offset:8320
  buffer_load_dwordx4 a[36:39], v2, s[52:55], s34 offen offset:1024 sc1
  v_fmac_f32 v50, v16, v49
  v_fmac_f32 v58, v17, v57
  v_fmac_f32 v66, v18, v65
  v_fmac_f32 v74, v19, v73
  v_fmac_f32_e64 v82, v20, v81
  v_fmac_f32_dpp v50, v49, v21 quad_perm:[1,0,3,2] row_mask:0xf bank_mask:0xf
  v_fmac_f32_dpp v58, v57, v22 quad_perm:[1,0,3,2] row_mask:0xf bank_mask:0xf
  v_fmac_f32_dpp v66, v65, v23 quad_perm:[1,0,3,2] row_mask:0xf bank_mask:0xf
  v_fmac_f32_dpp v74, v73, v24 quad_perm:[1,0,3,2] row_mask:0xf bank_mask:0xf
  v_fmac_f32_dpp v82, v81, v25 quad_perm:[1,0,3,2] row_mask:0xf bank_mask:0xf
  v_alignbit_b32 v208, v208, v196, 16
  v_alignbit_b32 v209, v209, v197, 16
  v_alignbit_b32 v210, v210, v198, 16
  v_alignbit_b32 v211, v211, v199, 16
  ds_write_b128 v186, v[208:211] offset:12480
  ds_write_b128 v186, v[200:203] offset:16640
  buffer_load_dwordx4 a[40:43], v2, s[52:55], s34 offen offset:2048 sc1
  v_fmac_f32 v51, v16, v50
  v_fmac_f32 v59, v17, v58
  v_fmac_f32 v67, v18, v66
  v_fmac_f32 v75, v19, v74
  v_fmac_f32_e64 v83, v20, v82
  v_fmac_f32_dpp v51, v50, v21 quad_perm:[1,0,3,2] row_mask:0xf bank_mask:0xf
  v_fmac_f32_dpp v59, v58, v22 quad_perm:[1,0,3,2] row_mask:0xf bank_mask:0xf
  v_fmac_f32_dpp v67, v66, v23 quad_perm:[1,0,3,2] row_mask:0xf bank_mask:0xf
  v_fmac_f32_dpp v75, v74, v24 quad_perm:[1,0,3,2] row_mask:0xf bank_mask:0xf
  v_fmac_f32_dpp v83, v82, v25 quad_perm:[1,0,3,2] row_mask:0xf bank_mask:0xf
  v_alignbit_b32 v212, v212, v200, 16
  v_alignbit_b32 v213, v213, v201, 16
  v_alignbit_b32 v214, v214, v202, 16
  v_alignbit_b32 v215, v215, v203, 16
  ds_write_b128 v186, v[212:215] offset:20800
  buffer_load_dwordx4 a[44:47], v2, s[52:55], s34 offen offset:3072 sc1
  v_fmac_f32 v52, v16, v51
  v_fmac_f32 v60, v17, v59
  v_fmac_f32 v68, v18, v67
  v_fmac_f32 v76, v19, v75
  v_fmac_f32_e64 v84, v20, v83
  v_fmac_f32_dpp v52, v51, v21 quad_perm:[1,0,3,2] row_mask:0xf bank_mask:0xf
  v_fmac_f32_dpp v60, v59, v22 quad_perm:[1,0,3,2] row_mask:0xf bank_mask:0xf
  v_fmac_f32_dpp v68, v67, v23 quad_perm:[1,0,3,2] row_mask:0xf bank_mask:0xf
  v_fmac_f32_dpp v76, v75, v24 quad_perm:[1,0,3,2] row_mask:0xf bank_mask:0xf
  v_fmac_f32_dpp v84, v83, v25 quad_perm:[1,0,3,2] row_mask:0xf bank_mask:0xf
  s_cmp_lg_u32 s7, 0
  s_cbranch_scc1 skip_27
  v_mov_b32 v216, 0
  v_mov_b32 v217, 0
  v_mov_b32 v218, 0
  v_mov_b32 v219, 0
  s_mov_b64 exec, 0xfff
  ds_write_b128 v163, v[216:219]
  s_mov_b64 exec, 1
  ds_write_b16 v163, v192 offset:4190
  ds_write_b16 v163, v196 offset:12510
  ds_write_b16 v163, v200 offset:20830
  s_mov_b64 exec, -1
skip_27:
  s_add_u32 s34, s34, 4096
  buffer_load_dwordx4 a[48:51], v2, s[52:55], s34 offen offset:0 sc1
  v_fmac_f32 v53, v16, v52
  v_fmac_f32 v61, v17, v60
  v_fmac_f32 v69, v18, v68
  v_fmac_f32 v77, v19, v76
  v_fmac_f32_e64 v85, v20, v84
  v_fmac_f32_dpp v53, v52, v21 quad_perm:[1,0,3,2] row_mask:0xf bank_mask:0xf
  v_fmac_f32_dpp v61, v60, v22 quad_perm:[1,0,3,2] row_mask:0xf bank_mask:0xf
  v_fmac_f32_dpp v69, v68, v23 quad_perm:[1,0,3,2] row_mask:0xf bank_mask:0xf
  v_fmac_f32_dpp v77, v76, v24 quad_perm:[1,0,3,2] row_mask:0xf bank_mask:0xf
  v_fmac_f32_dpp v85, v84, v25 quad_perm:[1,0,3,2] row_mask:0xf bank_mask:0xf
  ds_write_b64 v228, v[152:153]
  buffer_load_dwordx4 a[52:55], v2, s[52:55], s34 offen offset:1024 sc1
  v_fmac_f32 v54, v16, v53
  v_fmac_f32 v62, v17, v61
  v_fmac_f32 v70, v18, v69
  v_fmac_f32 v78, v19, v77
  v_fmac_f32_e64 v86, v20, v85
  v_fmac_f32_dpp v54, v53, v21 quad_perm:[1,0,3,2] row_mask:0xf bank_mask:0xf
  v_fmac_f32_dpp v62, v61, v22 quad_perm:[1,0,3,2] row_mask:0xf bank_mask:0xf
  v_fmac_f32_dpp v70, v69, v23 quad_perm:[1,0,3,2] row_mask:0xf bank_mask:0xf
  v_fmac_f32_dpp v78, v77, v24 quad_perm:[1,0,3,2] row_mask:0xf bank_mask:0xf
  v_fmac_f32_dpp v86, v85, v25 quad_perm:[1,0,3,2] row_mask:0xf bank_mask:0xf
  buffer_load_dwordx4 a[56:59], v2, s[52:55], s34 offen offset:2048 sc1
  v_fmac_f32 v55, v16, v54
  v_fmac_f32 v63, v17, v62
  v_fmac_f32 v71, v18, v70
  v_fmac_f32 v79, v19, v78
  v_fmac_f32_e64 v87, v20, v86
  v_fmac_f32_dpp v55, v54, v21 quad_perm:[1,0,3,2] row_mask:0xf bank_mask:0xf
  v_fmac_f32_dpp v63, v62, v22 quad_perm:[1,0,3,2] row_mask:0xf bank_mask:0xf
  v_fmac_f32_dpp v71, v70, v23 quad_perm:[1,0,3,2] row_mask:0xf bank_mask:0xf
  v_fmac_f32_dpp v79, v78, v24 quad_perm:[1,0,3,2] row_mask:0xf bank_mask:0xf
  v_fmac_f32_dpp v87, v86, v25 quad_perm:[1,0,3,2] row_mask:0xf bank_mask:0xf
  v_add_u32 v11, 152320, v9
  v_min_u32 v12, 39, v1
  v_mul_u32_u24 v44, 48, v12
  s_lshl_b32 s12, s7, 3
  s_add_u32 s12, s12, 149504
  v_add_u32 v44, s12, v44
  ds_write_b32 v11, v55 offset:0
  ds_write_b32 v11, v63 offset:1152
  ds_write_b32 v11, v71 offset:2304
  ds_write_b32 v11, v79 offset:3456
  ds_write_b32 v11, v87 offset:4608
  v_mul_u32_u24 v46, 144, v12
  v_add_u32 v46, 152320, v46
  s_waitcnt lgkmcnt(0)
  s_barrier
  ds_read_b128 v[90:93], v46 offset:0
  ds_read_b128 v[94:97], v46 offset:16
  ds_read_b128 v[98:101], v46 offset:32
  ds_read_b128 v[102:105], v46 offset:48
  ds_read_b128 v[106:109], v46 offset:64
  ds_read_b128 v[110:113], v46 offset:80
  ds_read_b128 v[114:117], v46 offset:96
  ds_read_b128 v[118:121], v46 offset:112
  s_waitcnt lgkmcnt(7)
  v_pk_fma_f32 v[92:93], v[90:91], v[36:37], v[92:93] op_sel:[1,1,0] op_sel_hi:[0,1,1] neg_lo:[0,1,0]
  v_pk_fma_f32 v[92:93], v[90:91], v[36:37], v[92:93] op_sel:[0,0,0] op_sel_hi:[1,0,1]
  buffer_load_dwordx4 a[60:63], v2, s[52:55], s34 offen offset:3072 sc1
  s_waitcnt lgkmcnt(6)
  v_pk_fma_f32 v[94:95], v[92:93], v[36:37], v[94:95] op_sel:[1,1,0] op_sel_hi:[0,1,1] neg_lo:[0,1,0]
  v_pk_fma_f32 v[94:95], v[92:93], v[36:37], v[94:95] op_sel:[0,0,0] op_sel_hi:[1,0,1]
  v_pk_fma_f32 v[96:97], v[94:95], v[36:37], v[96:97] op_sel:[1,1,0] op_sel_hi:[0,1,1] neg_lo:[0,1,0]
  v_pk_fma_f32 v[96:97], v[94:95], v[36:37], v[96:97] op_sel:[0,0,0] op_sel_hi:[1,0,1]
  s_waitcnt lgkmcnt(5)
  s_add_u32 s34, s34, 4096
  buffer_load_dwordx4 a[64:67], v2, s[52:55], s34 offen offset:0 sc1
  v_pk_fma_f32 v[98:99], v[96:97], v[36:37], v[98:99] op_sel:[1,1,0] op_sel_hi:[0,1,1] neg_lo:[0,1,0]
  v_pk_fma_f32 v[98:99], v[96:97], v[36:37], v[98:99] op_sel:[0,0,0] op_sel_hi:[1,0,1]
  v_pk_fma_f32 v[100:101], v[98:99], v[36:37], v[100:101] op_sel:[1,1,0] op_sel_hi:[0,1,1] neg_lo:[0,1,0]
  v_pk_fma_f32 v[100:101], v[98:99], v[36:37], v[100:101] op_sel:[0,0,0] op_sel_hi:[1,0,1]
  s_waitcnt lgkmcnt(4)
  v_pk_fma_f32 v[102:103], v[100:101], v[36:37], v[102:103] op_sel:[1,1,0] op_sel_hi:[0,1,1] neg_lo:[0,1,0]
  buffer_load_dwordx4 a[68:71], v2, s[52:55], s34 offen offset:1024 sc1
  v_pk_fma_f32 v[102:103], v[100:101], v[36:37], v[102:103] op_sel:[0,0,0] op_sel_hi:[1,0,1]
  v_pk_fma_f32 v[104:105], v[102:103], v[36:37], v[104:105] op_sel:[1,1,0] op_sel_hi:[0,1,1] neg_lo:[0,1,0]
  v_pk_fma_f32 v[104:105], v[102:103], v[36:37], v[104:105] op_sel:[0,0,0] op_sel_hi:[1,0,1]
  s_waitcnt lgkmcnt(3)
  v_pk_fma_f32 v[106:107], v[104:105], v[36:37], v[106:107] op_sel:[1,1,0] op_sel_hi:[0,1,1] neg_lo:[0,1,0]
  v_pk_fma_f32 v[106:107], v[104:105], v[36:37], v[106:107] op_sel:[0,0,0] op_sel_hi:[1,0,1]
  buffer_load_dwordx4 a[72:75], v2, s[52:55], s34 offen offset:2048 sc1
  v_pk_fma_f32 v[108:109], v[106:107], v[36:37], v[108:109] op_sel:[1,1,0] op_sel_hi:[0,1,1] neg_lo:[0,1,0]
  v_pk_fma_f32 v[108:109], v[106:107], v[36:37], v[108:109] op_sel:[0,0,0] op_sel_hi:[1,0,1]
  s_waitcnt lgkmcnt(2)
  v_pk_fma_f32 v[110:111], v[108:109], v[36:37], v[110:111] op_sel:[1,1,0] op_sel_hi:[0,1,1] neg_lo:[0,1,0]
  v_pk_fma_f32 v[110:111], v[108:109], v[36:37], v[110:111] op_sel:[0,0,0] op_sel_hi:[1,0,1]
  v_pk_fma_f32 v[112:113], v[110:111], v[36:37], v[112:113] op_sel:[1,1,0] op_sel_hi:[0,1,1] neg_lo:[0,1,0]
  buffer_load_dwordx4 a[76:79], v2, s[52:55], s34 offen offset:3072 sc1
  v_pk_fma_f32 v[112:113], v[110:111], v[36:37], v[112:113] op_sel:[0,0,0] op_sel_hi:[1,0,1]
  s_waitcnt lgkmcnt(1)
  v_pk_fma_f32 v[114:115], v[112:113], v[36:37], v[114:115] op_sel:[1,1,0] op_sel_hi:[0,1,1] neg_lo:[0,1,0]
  v_pk_fma_f32 v[114:115], v[112:113], v[36:37], v[114:115] op_sel:[0,0,0] op_sel_hi:[1,0,1]
  v_pk_fma_f32 v[116:117], v[114:115], v[36:37], v[116:117] op_sel:[1,1,0] op_sel_hi:[0,1,1] neg_lo:[0,1,0]
  v_pk_fma_f32 v[116:117], v[114:115], v[36:37], v[116:117] op_sel:[0,0,0] op_sel_hi:[1,0,1]
  s_waitcnt lgkmcnt(0)
  v_pk_fma_f32 v[118:119], v[116:117], v[36:37], v[118:119] op_sel:[1,1,0] op_sel_hi:[0,1,1] neg_lo:[0,1,0]
  v_pk_fma_f32 v[118:119], v[116:117], v[36:37], v[118:119] op_sel:[0,0,0] op_sel_hi:[1,0,1]
  v_pk_fma_f32 v[120:121], v[118:119], v[36:37], v[120:121] op_sel:[1,1,0] op_sel_hi:[0,1,1] neg_lo:[0,1,0]
  v_pk_fma_f32 v[120:121], v[118:119], v[36:37], v[120:121] op_sel:[0,0,0] op_sel_hi:[1,0,1]
  v_mov_b32 v122, s8
  v_mov_b32 v123, s8
  s_add_u32 s12, s83, 10240
  s_mov_b64 exec, s[96:97]
  buffer_store_dwordx4 v[120:123], v2, s[52:55], s12 offen sc1
  s_mov_b64 exec, -1
  v_accvgpr_read_b32 v232, a200
  v_accvgpr_read_b32 v236, a201
  v_accvgpr_read_b32 v240, a202
  v_accvgpr_read_b32 v241, a203
  v_add_u32 v233, 1024, v232
  v_add_u32 v234, 2048, v232
  v_add_u32 v235, 3072, v232
  v_add_u32 v237, 1024, v236
  v_add_u32 v238, 2048, v236
  v_add_u32 v239, 3072, v236
  ds_read2_b32 v[156:157], v235 offset0:128 offset1:129
  ds_read2_b32 v[158:159], v235 offset0:130 offset1:131
  ds_read_b128 v[160:163], v240 offset:3584
  ds_read2_b32 v[152:153], v235 offset0:0 offset1:1
  ds_read2_b32 v[154:155], v235 offset0:2 offset1:3
  ds_read_b128 v[164:167], v240 offset:3072
  ds_read2_b32 v[148:149], v234 offset0:128 offset1:129
  ds_read2_b32 v[150:151], v234 offset0:130 offset1:131
  s_waitcnt lgkmcnt(5)
  v_mfma_f32_16x16x32_bf16 v[220:223], v[156:159], v[160:163], 0
  ds_read_b128 v[168:171], v240 offset:2560
  s_waitcnt lgkmcnt(4)
  v_mfma_f32_16x16x32_bf16 v[216:219], v[152:155], v[160:163], 0
  ds_read2_b32 v[144:145], v234 offset0:0 offset1:1
  ds_read2_b32 v[146:147], v234 offset0:2 offset1:3
  s_waitcnt lgkmcnt(5)
  v_mfma_f32_16x16x32_bf16 v[220:223], v[152:155], v[164:167], v[220:223]
  ds_read_b128 v[172:175], v240 offset:2048
  s_waitcnt lgkmcnt(4)
  v_mfma_f32_16x16x32_bf16 v[212:215], v[148:151], v[160:163], 0
  ds_read2_b32 v[140:141], v233 offset0:128 offset1:129
  ds_read2_b32 v[142:143], v233 offset0:130 offset1:131
  v_subrev_u32 v46, 8576, v46
  v_mov_b32 v88, 0
  v_mov_b32 v89, 0
  s_mov_b32 exec_hi, 0xff
  s_cmp_eq_u32 s7, 1
  s_cbranch_scc1 w1_30
  s_cmp_eq_u32 s7, 2
  s_cbranch_scc1 w2_31
  s_cmp_eq_u32 s7, 3
  s_cbranch_scc1 w3_32
w0_29:
  ds_write_b128 v46, v[88:91] offset:0
  ds_write_b128 v46, v[92:95] offset:16
  s_branch join_28
w1_30:
  ds_write_b128 v46, v[96:99] offset:32
  ds_write_b128 v46, v[100:103] offset:48
  s_branch join_28
w2_31:
  ds_write_b128 v46, v[104:107] offset:64
  ds_write_b128 v46, v[108:111] offset:80
  s_branch join_28
w3_32:
  ds_write_b128 v46, v[112:115] offset:96
  ds_write_b128 v46, v[116:119] offset:112
join_28:
  s_mov_b32 exec_hi, -1
  v_add_u32 v46, 143744, v9
  ds_read_b32 v244, v46 offset:0
  s_add_u32 s34, s34, 4096
  buffer_load_dwordx4 a[80:83], v2, s[52:55], s34 offen offset:0 sc1
  s_add_u32 m0, s48, 0
  s_nop 0
  buffer_load_dwordx4 v224, s[68:71], s20 offen lds
  ds_read_b64 a[226:227], v227
  v_mfma_f32_16x16x32_bf16 v[216:219], v[148:151], v[164:167], v[216:219]
  ds_read_b128 v[176:179], v240 offset:1536
  s_waitcnt lgkmcnt(10)
  v_mfma_f32_16x16x32_bf16 v[220:223], v[148:151], v[168:171], v[220:223]
  ds_read2_b32 v[136:137], v233 offset0:0 offset1:1
  ds_read2_b32 v[138:139], v233 offset0:2 offset1:3
  s_waitcnt lgkmcnt(10)
  v_mfma_f32_16x16x32_bf16 v[208:211], v[144:147], v[160:163], 0
  ds_read_b128 v[180:183], v240 offset:1024
  v_mfma_f32_16x16x32_bf16 v[212:215], v[144:147], v[164:167], v[212:215]
  ds_read2_b32 v[132:133], v232 offset0:128 offset1:129
  ds_read2_b32 v[134:135], v232 offset0:130 offset1:131
  ds_read_b32 v246, v46 offset:1152
  ds_read_b32 v248, v46 offset:2304
  ds_read_b32 v250, v46 offset:3456
  s_add_u32 m0, s48, 1024
  s_nop 0
  buffer_load_dwordx4 v225, s[68:71], s20 offen lds
  s_mov_b32 s60, s46
  s_and_b32 s61, s47, 0xffff
  s_mov_b32 s62, 5242880
  s_mov_b32 s63, 0x20000
  v_mfma_f32_16x16x32_bf16 v[216:219], v[144:147], v[168:171], v[216:219]
  ds_read_b32 v252, v46 offset:4608
  v_and_b32 v43, 1, v3
  s_waitcnt lgkmcnt(15)
  v_mfma_f32_16x16x32_bf16 v[220:223], v[144:147], v[172:175], v[220:223]
  v_cvt_f32_u32 v43, v43
  s_waitcnt lgkmcnt(14)
  v_mfma_f32_16x16x32_bf16 v[204:207], v[140:143], v[160:163], 0
  buffer_load_dwordx4 a[84:87], v2, s[52:55], s34 offen offset:1024 sc1
  v_mfma_f32_16x16x32_bf16 v[208:211], v[140:143], v[164:167], v[208:211]
  s_add_u32 m0, s48, 2048
  s_mov_b32 exec_hi, 0
  buffer_load_dwordx4 v226, s[68:71], s20 offen lds
  s_mov_b32 exec_hi, -1
  v_mfma_f32_16x16x32_bf16 v[212:215], v[140:143], v[168:171], v[212:215]
  v_fma_f32 v43, 2.0, v43, -1.0
  s_waitcnt lgkmcnt(0)
  s_nop 0
  v_mul_f32_dpp v245, v244, v43 quad_perm:[1,0,3,2] row_mask:0xf bank_mask:0xf
  v_mfma_f32_16x16x32_bf16 v[216:219], v[140:143], v[172:175], v[216:219]
  ds_read_b128 v[184:187], v240 offset:512
  v_mfma_f32_16x16x32_bf16 v[220:223], v[140:143], v[176:179], v[220:223]
  ds_read2_b32 v[128:129], v232 offset0:0 offset1:1
  ds_read2_b32 v[130:131], v232 offset0:2 offset1:3
  v_mfma_f32_16x16x32_bf16 v[200:203], v[136:139], v[160:163], 0
  s_mov_b32 s64, s32
  s_and_b32 s65, s33, 0xffff
  s_mov_b32 s66, 1280
  s_mov_b32 s67, 0x20000
  s_add_u32 m0, s48, 2560
  s_mul_i32 s12, s6, 160
  s_mov_b64 exec, 0x3ff
  buffer_load_dwordx4 v2, s[64:67], s12 offen lds
  s_mov_b64 exec, -1
  v_mov_b32 v228, -1
  v_mov_b32 v229, -1
  v_mov_b32 v230, -1
  v_mov_b32 v231, -1
  v_lshlrev_b32_e64 v11, 3, v1
  buffer_store_dwordx2 v[228:229], v11, s[52:55], s51 offen sc1
  v_mfma_f32_16x16x32_bf16 v[204:207], v[136:139], v[164:167], v[204:207]
  v_mul_f32_dpp v247, v246, v43 quad_perm:[1,0,3,2] row_mask:0xf bank_mask:0xf
  v_mul_f32_dpp v249, v248, v43 quad_perm:[1,0,3,2] row_mask:0xf bank_mask:0xf
  v_mfma_f32_16x16x32_bf16 v[208:211], v[136:139], v[168:171], v[208:211]
  v_mul_f32_dpp v251, v250, v43 quad_perm:[1,0,3,2] row_mask:0xf bank_mask:0xf
  v_mfma_f32_16x16x32_bf16 v[212:215], v[136:139], v[172:175], v[212:215]
  buffer_load_dwordx4 a[88:91], v2, s[52:55], s34 offen offset:2048 sc1
  v_mfma_f32_16x16x32_bf16 v[216:219], v[136:139], v[176:179], v[216:219]
  buffer_store_dwordx4 v[228:231], v2, s[52:55], s50 offen offset:0 sc1
  v_mfma_f32_16x16x32_bf16 v[220:223], v[136:139], v[180:183], v[220:223]
  v_mul_f32_dpp v253, v252, v43 quad_perm:[1,0,3,2] row_mask:0xf bank_mask:0xf
  v_mfma_f32_16x16x32_bf16 v[196:199], v[132:135], v[160:163], 0
  ds_read_b128 v[188:191], v240 offset:0
  v_mfma_f32_16x16x32_bf16 v[200:203], v[132:135], v[164:167], v[200:203]
  ds_read2_b32 v[156:157], v235 offset0:144 offset1:145
  ds_read2_b32 v[158:159], v235 offset0:146 offset1:147
  v_mfma_f32_16x16x32_bf16 v[204:207], v[132:135], v[168:171], v[204:207]
  ds_read2_b32 v[152:153], v235 offset0:16 offset1:17
  ds_read2_b32 v[154:155], v235 offset0:18 offset1:19
  buffer_store_dwordx4 v[228:231], v2, s[52:55], s50 offen offset:1024 sc1
  v_mfma_f32_16x16x32_bf16 v[208:211], v[132:135], v[172:175], v[208:211]
  buffer_load_dwordx4 a[92:95], v2, s[52:55], s34 offen offset:3072 sc1
  v_mfma_f32_16x16x32_bf16 v[212:215], v[132:135], v[176:179], v[212:215]
  ds_read2_b32 v[148:149], v234 offset0:144 offset1:145
  ds_read2_b32 v[150:151], v234 offset0:146 offset1:147
  v_mfma_f32_16x16x32_bf16 v[216:219], v[132:135], v[180:183], v[216:219]
  s_waitcnt lgkmcnt(9)
  v_mfma_f32_16x16x32_bf16 v[220:223], v[132:135], v[184:187], v[220:223]
  s_waitcnt lgkmcnt(7)
  v_mfma_f32_16x16x32_bf16 v[192:195], v[128:131], v[160:163], 0
  ds_read_b128 v[160:163], v240 offset:3648
  v_mfma_f32_16x16x32_bf16 v[196:199], v[128:131], v[164:167], v[196:199]
  ds_read2_b32 v[144:145], v234 offset0:16 offset1:17
  ds_read2_b32 v[146:147], v234 offset0:18 offset1:19
  v_mfma_f32_16x16x32_bf16 v[200:203], v[128:131], v[168:171], v[200:203]
  ds_read_b128 v[164:167], v240 offset:3136
  v_mfma_f32_16x16x32_bf16 v[204:207], v[128:131], v[172:175], v[204:207]
  ds_read_b128 v[168:171], v240 offset:2624
  v_mfma_f32_16x16x32_bf16 v[208:211], v[128:131], v[176:179], v[208:211]
  ds_read_b128 v[172:175], v240 offset:2112
  v_mfma_f32_16x16x32_bf16 v[212:215], v[128:131], v[180:183], v[212:215]
  ds_read2_b32 v[140:141], v233 offset0:144 offset1:145
  ds_read2_b32 v[142:143], v233 offset0:146 offset1:147
  v_mfma_f32_16x16x32_bf16 v[216:219], v[128:131], v[184:187], v[216:219]
  s_add_u32 s34, s34, 4096
  buffer_load_dwordx4 a[96:99], v2, s[52:55], s34 offen offset:0 sc1
  s_waitcnt lgkmcnt(14)
  v_mfma_f32_16x16x32_bf16 v[220:223], v[128:131], v[188:191], v[220:223]
  s_waitcnt lgkmcnt(7)
  v_mfma_f32_16x16x32_bf16 v[220:223], v[156:159], v[160:163], v[220:223]
  ds_read_b128 v[176:179], v240 offset:1600
  v_mfma_f32_16x16x32_bf16 v[216:219], v[152:155], v[160:163], v[216:219]
  ds_read2_b32 v[136:137], v233 offset0:16 offset1:17
  ds_read2_b32 v[138:139], v233 offset0:18 offset1:19
  s_waitcnt lgkmcnt(7)
  v_mfma_f32_16x16x32_bf16 v[220:223], v[152:155], v[164:167], v[220:223]
  v_mfma_f32_16x16x32_bf16 v[212:215], v[148:151], v[160:163], v[212:215]
  v_mfma_f32_16x16x32_bf16 v[216:219], v[148:151], v[164:167], v[216:219]
  buffer_load_dwordx4 a[100:103], v2, s[52:55], s34 offen offset:1024 sc1
  s_waitcnt lgkmcnt(6)
  v_mfma_f32_16x16x32_bf16 v[220:223], v[148:151], v[168:171], v[220:223]
  s_and_b32 vcc_lo, s1, 7
  s_lshl_b32 vcc_lo, vcc_lo, 2
  s_add_u32 vcc_lo, vcc_lo, s7
  s_lshl_b32 vcc_lo, vcc_lo, 11
  v_lshl_add_u32 v15, v3, 7, vcc_lo
  v_min_u32 v15, L_codeend-L_pc-4, v15
  s_mov_b64 exec, 0xffff
  global_load_dword a250, v15, s[98:99]
  s_mov_b64 exec, -1
  v_mfma_f32_16x16x32_bf16 v[208:211], v[144:147], v[160:163], v[208:211]
  ds_read_b128 v[180:183], v240 offset:1088
  v_mfma_f32_16x16x32_bf16 v[212:215], v[144:147], v[164:167], v[212:215]
  ds_read2_b32 v[132:133], v232 offset0:144 offset1:145
  ds_read2_b32 v[134:135], v232 offset0:146 offset1:147
  v_mfma_f32_16x16x32_bf16 v[216:219], v[144:147], v[168:171], v[216:219]
  s_waitcnt lgkmcnt(8)
  v_mfma_f32_16x16x32_bf16 v[220:223], v[144:147], v[172:175], v[220:223]
  s_waitcnt lgkmcnt(6)
  v_mfma_f32_16x16x32_bf16 v[204:207], v[140:143], v[160:163], v[204:207]
  v_mfma_f32_16x16x32_bf16 v[208:211], v[140:143], v[164:167], v[208:211]
  v_mfma_f32_16x16x32_bf16 v[212:215], v[140:143], v[168:171], v[212:215]
  buffer_load_dwordx4 a[104:107], v2, s[52:55], s34 offen offset:2048 sc1
  v_mfma_f32_16x16x32_bf16 v[216:219], v[140:143], v[172:175], v[216:219]
  ds_read_b128 v[184:187], v240 offset:576
  s_waitcnt lgkmcnt(6)
  v_mfma_f32_16x16x32_bf16 v[220:223], v[140:143], v[176:179], v[220:223]
  ds_read2_b32 v[128:129], v232 offset0:16 offset1:17
  ds_read2_b32 v[130:131], v232 offset0:18 offset1:19
  s_waitcnt lgkmcnt(6)
  v_mfma_f32_16x16x32_bf16 v[200:203], v[136:139], v[160:163], v[200:203]
  v_accvgpr_read_b32 v11, a245
  s_and_b32 exec_lo, s96, 0x3fffffff
  s_mov_b32 exec_hi, 0
  buffer_load_dword a250, v11, s[52:55], 0 offen
  s_mov_b64 exec, -1
  v_mfma_f32_16x16x32_bf16 v[204:207], v[136:139], v[164:167], v[204:207]
  v_mfma_f32_16x16x32_bf16 v[208:211], v[136:139], v[168:171], v[208:211]
  v_mfma_f32_16x16x32_bf16 v[212:215], v[136:139], v[172:175], v[212:215]
  v_mfma_f32_16x16x32_bf16 v[216:219], v[136:139], v[176:179], v[216:219]
  s_waitcnt lgkmcnt(5)
  v_mfma_f32_16x16x32_bf16 v[220:223], v[136:139], v[180:183], v[220:223]
  buffer_load_dwordx4 a[108:111], v2, s[52:55], s34 offen offset:3072 sc1
  s_waitcnt lgkmcnt(3)
  v_mfma_f32_16x16x32_bf16 v[196:199], v[132:135], v[160:163], v[196:199]
  ds_read_b128 v[188:191], v240 offset:64
  v_mfma_f32_16x16x32_bf16 v[200:203], v[132:135], v[164:167], v[200:203]
  ds_read2_b32 v[156:157], v235 offset0:160 offset1:161
  ds_read2_b32 v[158:159], v235 offset0:162 offset1:163
  v_mfma_f32_16x16x32_bf16 v[204:207], v[132:135], v[168:171], v[204:207]
  ds_read2_b32 v[152:153], v235 offset0:32 offset1:33
  ds_read2_b32 v[154:155], v235 offset0:34 offset1:35
  s_waitcnt vmcnt(9)
  ds_read_b64 a[216:217], v242 offset:0
  v_mfma_f32_16x16x32_bf16 v[208:211], v[132:135], v[172:175], v[208:211]
  ds_read_b64 a[218:219], v242 offset:32
  v_mfma_f32_16x16x32_bf16 v[212:215], v[132:135], v[176:179], v[212:215]
  ds_read2_b32 v[148:149], v234 offset0:160 offset1:161
  ds_read2_b32 v[150:151], v234 offset0:162 offset1:163
  v_mfma_f32_16x16x32_bf16 v[216:219], v[132:135], v[180:183], v[216:219]
  ds_read_b64 a[220:221], v242 offset:64
  s_waitcnt lgkmcnt(12)
  v_mfma_f32_16x16x32_bf16 v[220:223], v[132:135], v[184:187], v[220:223]
  s_waitcnt lgkmcnt(10)
  v_mfma_f32_16x16x32_bf16 v[192:195], v[128:131], v[160:163], v[192:195]
  ds_read_b128 v[160:163], v240 offset:3712
  v_mfma_f32_16x16x32_bf16 v[196:199], v[128:131], v[164:167], v[196:199]
  ds_read2_b32 v[144:145], v234 offset0:32 offset1:33
  ds_read2_b32 v[146:147], v234 offset0:34 offset1:35
  v_mfma_f32_16x16x32_bf16 v[200:203], v[128:131], v[168:171], v[200:203]
  ds_read_b128 v[164:167], v240 offset:3200
  v_mfma_f32_16x16x32_bf16 v[204:207], v[128:131], v[172:175], v[204:207]
  ds_read_b128 v[168:171], v240 offset:2688
  s_add_u32 s34, s34, 4096
  buffer_load_dwordx4 a[112:115], v2, s[52:55], s34 offen offset:0 sc1
  ds_read_b64 a[222:223], v242 offset:96
  ds_read_b64 a[224:225], v242 offset:128
  v_mfma_f32_16x16x32_bf16 v[208:211], v[128:131], v[176:179], v[208:211]
  ds_read_b128 v[172:175], v240 offset:2176
  v_mfma_f32_16x16x32_bf16 v[212:215], v[128:131], v[180:183], v[212:215]
  ds_read2_b32 v[140:141], v233 offset0:160 offset1:161
  ds_read2_b32 v[142:143], v233 offset0:162 offset1:163
  v_mfma_f32_16x16x32_bf16 v[216:219], v[128:131], v[184:187], v[216:219]
  ds_read_b64 a[230:231], v243 offset:2560
  s_waitcnt lgkmcnt(15)
  v_mfma_f32_16x16x32_bf16 v[220:223], v[128:131], v[188:191], v[220:223]
  ds_read_b64 a[232:233], v243 offset:2592
  s_waitcnt lgkmcnt(11)
  v_mfma_f32_16x16x32_bf16 v[220:223], v[156:159], v[160:163], v[220:223]
  ds_read_b128 v[176:179], v240 offset:1664
  v_mfma_f32_16x16x32_bf16 v[216:219], v[152:155], v[160:163], v[216:219]
  ds_read2_b32 v[136:137], v233 offset0:32 offset1:33
  ds_read2_b32 v[138:139], v233 offset0:34 offset1:35
  s_waitcnt lgkmcnt(11)
  v_mfma_f32_16x16x32_bf16 v[220:223], v[152:155], v[164:167], v[220:223]
  buffer_load_dwordx4 a[116:119], v2, s[52:55], s34 offen offset:1024 sc1
  ds_read_b64 a[234:235], v243 offset:2624
  v_mfma_f32_16x16x32_bf16 v[212:215], v[148:151], v[160:163], v[212:215]
  ds_read_b64 a[236:237], v243 offset:2656
  v_mfma_f32_16x16x32_bf16 v[216:219], v[148:151], v[164:167], v[216:219]
  ds_read_b64 a[238:239], v243 offset:2688
  s_lshl_b32 s90, s7, 2
  s_waitcnt lgkmcnt(13)
  v_mfma_f32_16x16x32_bf16 v[220:223], v[148:151], v[168:171], v[220:223]
  s_sub_u32 s90, 12, s90
  v_mfma_f32_16x16x32_bf16 v[208:211], v[144:147], v[160:163], v[208:211]
  ds_read_b128 v[180:183], v240 offset:1152
  v_mfma_f32_16x16x32_bf16 v[212:215], v[144:147], v[164:167], v[212:215]
  ds_read2_b32 v[132:133], v232 offset0:160 offset1:161
  ds_read2_b32 v[134:135], v232 offset0:162 offset1:163
  s_mul_i32 s90, s90, 640
  s_add_u32 s90, s90, s83
  v_mfma_f32_16x16x32_bf16 v[216:219], v[144:147], v[168:171], v[216:219]
  s_add_u32 s90, s90, 0
  s_waitcnt lgkmcnt(13)
  v_mfma_f32_16x16x32_bf16 v[220:223], v[144:147], v[172:175], v[220:223]
  v_min_u32 v42, 39, v1
  s_waitcnt lgkmcnt(11)
  v_mfma_f32_16x16x32_bf16 v[204:207], v[140:143], v[160:163], v[204:207]
  v_lshlrev_b32 v42, 4, v42
  v_mfma_f32_16x16x32_bf16 v[208:211], v[140:143], v[164:167], v[208:211]
  v_mfma_f32_16x16x32_bf16 v[212:215], v[140:143], v[168:171], v[212:215]
  buffer_load_dwordx3 v[88:90], v42, s[52:55], s90 offen offset:0 sc1
  v_mfma_f32_16x16x32_bf16 v[216:219], v[140:143], v[172:175], v[216:219]
  ds_read_b128 v[184:187], v240 offset:640
  s_waitcnt lgkmcnt(9)
  v_mfma_f32_16x16x32_bf16 v[220:223], v[140:143], v[176:179], v[220:223]
  ds_read2_b32 v[128:129], v232 offset0:32 offset1:33
  ds_read2_b32 v[130:131], v232 offset0:34 offset1:35
  s_waitcnt lgkmcnt(9)
  v_mfma_f32_16x16x32_bf16 v[200:203], v[136:139], v[160:163], v[200:203]
  buffer_load_dwordx3 v[92:94], v42, s[52:55], s90 offen offset:640 sc1
  v_mfma_f32_16x16x32_bf16 v[204:207], v[136:139], v[164:167], v[204:207]
  buffer_load_dwordx3 v[96:98], v42, s[52:55], s90 offen offset:1280 sc1
  v_mfma_f32_16x16x32_bf16 v[208:211], v[136:139], v[168:171], v[208:211]
  buffer_load_dwordx3 v[100:102], v42, s[52:55], s90 offen offset:1920 sc1
  v_mfma_f32_16x16x32_bf16 v[212:215], v[136:139], v[172:175], v[212:215]
  v_mfma_f32_16x16x32_bf16 v[216:219], v[136:139], v[176:179], v[216:219]
  s_waitcnt lgkmcnt(5)
  v_mfma_f32_16x16x32_bf16 v[220:223], v[136:139], v[180:183], v[220:223]
  s_waitcnt lgkmcnt(3)
  v_mfma_f32_16x16x32_bf16 v[196:199], v[132:135], v[160:163], v[196:199]
  ds_read_b128 v[188:191], v240 offset:128
  v_mfma_f32_16x16x32_bf16 v[200:203], v[132:135], v[164:167], v[200:203]
  v_mfma_f32_16x16x32_bf16 v[204:207], v[132:135], v[168:171], v[204:207]
  v_mfma_f32_16x16x32_bf16 v[208:211], v[132:135], v[172:175], v[208:211]
  v_mfma_f32_16x16x32_bf16 v[212:215], v[132:135], v[176:179], v[212:215]
  v_mfma_f32_16x16x32_bf16 v[216:219], v[132:135], v[180:183], v[216:219]
  s_waitcnt lgkmcnt(3)
  v_mfma_f32_16x16x32_bf16 v[220:223], v[132:135], v[184:187], v[220:223]
  s_waitcnt lgkmcnt(1)
  v_mfma_f32_16x16x32_bf16 v[192:195], v[128:131], v[160:163], v[192:195]
  v_mfma_f32_16x16x32_bf16 v[196:199], v[128:131], v[164:167], v[196:199]
  v_mfma_f32_16x16x32_bf16 v[200:203], v[128:131], v[168:171], v[200:203]
  v_mfma_f32_16x16x32_bf16 v[204:207], v[128:131], v[172:175], v[204:207]
  v_mfma_f32_16x16x32_bf16 v[208:211], v[128:131], v[176:179], v[208:211]
  v_mfma_f32_16x16x32_bf16 v[212:215], v[128:131], v[180:183], v[212:215]
  v_mfma_f32_16x16x32_bf16 v[216:219], v[128:131], v[184:187], v[216:219]
  s_waitcnt lgkmcnt(0)
  v_mfma_f32_16x16x32_bf16 v[220:223], v[128:131], v[188:191], v[220:223]
  v_lshrrev_b32 v11, 1, v3
  v_mul_u32_u24 v12, 80, v11
  v_add_u32 v12, 160640, v12
  v_mul_u32_u24_e64 v11, 48, v11
  v_add_u32 v11, 149504, v11
  ds_read_b128 v[128:131], v12 offset:0
  ds_read_b128 v[132:135], v12 offset:16
  ds_read_b128 v[136:139], v12 offset:32
  ds_read_b128 v[140:143], v12 offset:48
  ds_read_b128 v[144:147], v12 offset:640
  ds_read_b128 v[148:151], v12 offset:656
  ds_read_b128 v[152:155], v12 offset:672
  ds_read_b128 v[156:159], v12 offset:688
  v_accvgpr_read_b32 v254, a240
  v_accvgpr_read_b32 v255, a241
  v_accvgpr_read_b32 v47, a242
  s_waitcnt vmcnt(0)
  v_min3_u32 v14, v90, v94, s8
  v_max3_u32 v15, v90, v94, s8
  v_min3_u32 v14, v14, v98, v102
  v_max3_u32 v15, v15, v98, v102
  v_cmp_ne_u32 vcc, v14, v15
  s_cbranch_vccz ok_34
again_33:
  buffer_load_dwordx3 v[88:90], v42, s[52:55], s90 offen offset:0 sc1
  buffer_load_dwordx3 v[92:94], v42, s[52:55], s90 offen offset:640 sc1
  buffer_load_dwordx3 v[96:98], v42, s[52:55], s90 offen offset:1280 sc1
  buffer_load_dwordx3 v[100:102], v42, s[52:55], s90 offen offset:1920 sc1
  s_sub_u32 s10, s10, 1
  s_cmp_gt_i32 s10, 0
  s_waitcnt vmcnt(0)
  v_min3_u32 v14, v90, v94, s8
  v_max3_u32 v15, v90, v94, s8
  v_min3_u32 v14, v14, v98, v102
  v_max3_u32 v15, v15, v98, v102
  v_cmp_ne_u32 vcc, v14, v15
  s_cbranch_scc0 out_35
  s_cbranch_vccnz again_33
out_35:
ok_34:
  v_pk_fma_f32 v[92:93], v[88:89], v[38:39], v[92:93] op_sel:[1,1,0] op_sel_hi:[0,1,1] neg_lo:[0,1,0]
  v_pk_fma_f32 v[92:93], v[88:89], v[38:39], v[92:93] op_sel:[0,0,0] op_sel_hi:[1,0,1]
  v_pk_fma_f32 v[96:97], v[92:93], v[38:39], v[96:97] op_sel:[1,1,0] op_sel_hi:[0,1,1] neg_lo:[0,1,0]
  v_pk_fma_f32 v[96:97], v[92:93], v[38:39], v[96:97] op_sel:[0,0,0] op_sel_hi:[1,0,1]
  v_pk_fma_f32 v[100:101], v[96:97], v[38:39], v[100:101] op_sel:[1,1,0] op_sel_hi:[0,1,1] neg_lo:[0,1,0]
  v_pk_fma_f32 v[100:101], v[96:97], v[38:39], v[100:101] op_sel:[0,0,0] op_sel_hi:[1,0,1]
  v_pk_mul_f32 v[88:89], v[100:101], v[40:41] op_sel:[1,1] op_sel_hi:[0,1] neg_lo:[0,1]
  v_pk_fma_f32 v[88:89], v[100:101], v[40:41], v[88:89] op_sel:[0,0,0] op_sel_hi:[1,0,1]
  buffer_load_dwordx4 a[120:123], v2, s[52:55], s34 offen offset:2048 sc1
  s_mov_b32 exec_hi, 0xff
  ds_write_b64 v44, v[88:89]
  s_mov_b32 exec_hi, -1
  s_waitcnt lgkmcnt(0)
  s_barrier
  ds_read_b128 v[88:91], v11 offset:0
  ds_read_b128 v[92:95], v11 offset:16
  ds_read_b128 v[96:99], v11 offset:384
  ds_read_b128 v[100:103], v11 offset:400
  ds_read_b128 v[224:227], v11 offset:768
  ds_read_b128 v[228:231], v11 offset:784
  ds_read_b128 v[160:163], v12 offset:1280
  ds_read_b128 v[164:167], v12 offset:1296
  ds_read_b128 v[168:171], v12 offset:1312
  ds_read_b128 v[172:175], v12 offset:1328
  buffer_load_dwordx4 a[124:127], v2, s[52:55], s34 offen offset:3072 sc1
  s_waitcnt lgkmcnt(8)
  v_pk_add_f32 v[88:89], v[88:89], v[90:91]
  v_pk_add_f32 v[92:93], v[92:93], v[94:95]
  v_pk_add_f32 v[88:89], v[88:89], v[92:93]
  v_pk_fma_f32 v[244:245], v[26:27], v[88:89], v[244:245] op_sel:[0,0,0] op_sel_hi:[1,0,1]
  v_pk_fma_f32 v[244:245], v[26:27], v[88:89], v[244:245] op_sel:[1,1,0] op_sel_hi:[0,1,1] neg_hi:[1,0,0]
  ds_read_b128 v[88:91], v11 offset:1152
  ds_read_b128 v[92:95], v11 offset:1168
  s_waitcnt lgkmcnt(8)
  v_pk_add_f32 v[96:97], v[96:97], v[98:99]
  v_pk_add_f32 v[100:101], v[100:101], v[102:103]
  v_pk_add_f32 v[96:97], v[96:97], v[100:101]
  v_pk_fma_f32 v[246:247], v[28:29], v[96:97], v[246:247] op_sel:[0,0,0] op_sel_hi:[1,0,1]
  v_pk_fma_f32 v[246:247], v[28:29], v[96:97], v[246:247] op_sel:[1,1,0] op_sel_hi:[0,1,1] neg_hi:[1,0,0]
  ds_read_b128 v[96:99], v11 offset:1536
  ds_read_b128 v[100:103], v11 offset:1552
  ds_read_b128 v[176:179], v12 offset:1920
  ds_read_b128 v[180:183], v12 offset:1936
  ds_read_b128 v[184:187], v12 offset:1952
  ds_read_b128 v[188:191], v12 offset:1968
  v_pk_fma_f32 v[48:49], v[128:129], v[244:245], v[48:49] op_sel:[0,0,0] op_sel_hi:[1,0,1]
  v_pk_fma_f32 v[50:51], v[130:131], v[244:245], v[50:51] op_sel:[0,0,0] op_sel_hi:[1,0,1]
  v_pk_fma_f32 v[52:53], v[132:133], v[244:245], v[52:53] op_sel:[0,0,0] op_sel_hi:[1,0,1]
  v_pk_fma_f32 v[54:55], v[134:135], v[244:245], v[54:55] op_sel:[0,0,0] op_sel_hi:[1,0,1]
  s_add_u32 s34, s34, 4096
  buffer_load_dwordx4 a[128:131], v2, s[52:55], s34 offen offset:0 sc1
  v_pk_fma_f32 v[48:49], v[136:137], v[244:245], v[48:49] op_sel:[0,1,0] op_sel_hi:[1,1,1]
  v_pk_fma_f32 v[50:51], v[138:139], v[244:245], v[50:51] op_sel:[0,1,0] op_sel_hi:[1,1,1]
  v_pk_fma_f32 v[52:53], v[140:141], v[244:245], v[52:53] op_sel:[0,1,0] op_sel_hi:[1,1,1]
  v_pk_fma_f32 v[54:55], v[142:143], v[244:245], v[54:55] op_sel:[0,1,0] op_sel_hi:[1,1,1]
  v_cvt_pk_bf16_f32 v120, v48, v49
  v_cvt_pk_bf16_f32 v121, v50, v51
  v_cvt_pk_bf16_f32 v122, v52, v53
  v_cvt_pk_bf16_f32 v123, v54, v55
  ds_write_b128 v254, v[120:123]
  buffer_load_dwordx4 a[132:135], v2, s[52:55], s34 offen offset:1024 sc1
  ds_read_b64_tr_b16 v[52:53], v255
  ds_read_b64_tr_b16 v[54:55], v255 offset:640
  s_waitcnt lgkmcnt(15)
  v_pk_add_f32 v[224:225], v[224:225], v[226:227]
  v_pk_add_f32 v[228:229], v[228:229], v[230:231]
  v_pk_add_f32 v[224:225], v[224:225], v[228:229]
  v_pk_fma_f32 v[248:249], v[30:31], v[224:225], v[248:249] op_sel:[0,0,0] op_sel_hi:[1,0,1]
  v_pk_fma_f32 v[248:249], v[30:31], v[224:225], v[248:249] op_sel:[1,1,0] op_sel_hi:[0,1,1] neg_hi:[1,0,0]
  s_lshl_b32 s12, s86, 1
  s_add_u32 s12, s12, 24576
  v_mov_b32 v15, s8
  s_and_b32 exec_lo, s96, 1
  s_mov_b32 exec_hi, 0
  buffer_store_dword v15, off, s[52:55], s12 sc1
  s_mov_b64 exec, -1
  ds_read_b128 v[104:107], v12 offset:2560
  ds_read_b128 v[108:111], v12 offset:2576
  ds_read_b128 v[112:115], v12 offset:2592
  ds_read_b128 v[116:119], v12 offset:2608
  v_pk_fma_f32 v[56:57], v[144:145], v[246:247], v[56:57] op_sel:[0,0,0] op_sel_hi:[1,0,1]
  v_pk_fma_f32 v[58:59], v[146:147], v[246:247], v[58:59] op_sel:[0,0,0] op_sel_hi:[1,0,1]
  v_pk_fma_f32 v[60:61], v[148:149], v[246:247], v[60:61] op_sel:[0,0,0] op_sel_hi:[1,0,1]
  v_pk_fma_f32 v[62:63], v[150:151], v[246:247], v[62:63] op_sel:[0,0,0] op_sel_hi:[1,0,1]
  buffer_load_dwordx4 a[136:139], v2, s[52:55], s34 offen offset:2048 sc1
  v_pk_fma_f32 v[56:57], v[152:153], v[246:247], v[56:57] op_sel:[0,1,0] op_sel_hi:[1,1,1]
  v_pk_fma_f32 v[58:59], v[154:155], v[246:247], v[58:59] op_sel:[0,1,0] op_sel_hi:[1,1,1]
  v_pk_fma_f32 v[60:61], v[156:157], v[246:247], v[60:61] op_sel:[0,1,0] op_sel_hi:[1,1,1]
  v_pk_fma_f32 v[62:63], v[158:159], v[246:247], v[62:63] op_sel:[0,1,0] op_sel_hi:[1,1,1]
  v_cvt_pk_bf16_f32 v124, v56, v57
  v_cvt_pk_bf16_f32 v125, v58, v59
  v_cvt_pk_bf16_f32 v126, v60, v61
  v_cvt_pk_bf16_f32 v127, v62, v63
  ds_write_b128 v254, v[124:127]
  buffer_load_dwordx4 a[140:143], v2, s[52:55], s34 offen offset:3072 sc1
  ds_read_b64_tr_b16 v[60:61], v255
  ds_read_b64_tr_b16 v[62:63], v255 offset:640
  s_waitcnt lgkmcnt(15)
  v_pk_add_f32 v[88:89], v[88:89], v[90:91]
  v_pk_add_f32 v[92:93], v[92:93], v[94:95]
  v_pk_add_f32 v[88:89], v[88:89], v[92:93]
  v_pk_fma_f32 v[250:251], v[32:33], v[88:89], v[250:251] op_sel:[0,0,0] op_sel_hi:[1,0,1]
  v_pk_fma_f32 v[250:251], v[32:33], v[88:89], v[250:251] op_sel:[1,1,0] op_sel_hi:[0,1,1] neg_hi:[1,0,0]
  s_add_u32 s13, s78, 0
  s_waitcnt lgkmcnt(7)
  buffer_store_dwordx4 v[52:55], v47, s[60:63], s13 offen sc1
  v_pk_fma_f32 v[64:65], v[160:161], v[248:249], v[64:65] op_sel:[0,0,0] op_sel_hi:[1,0,1]
  v_pk_fma_f32 v[66:67], v[162:163], v[248:249], v[66:67] op_sel:[0,0,0] op_sel_hi:[1,0,1]
  v_pk_fma_f32 v[68:69], v[164:165], v[248:249], v[68:69] op_sel:[0,0,0] op_sel_hi:[1,0,1]
  v_pk_fma_f32 v[70:71], v[166:167], v[248:249], v[70:71] op_sel:[0,0,0] op_sel_hi:[1,0,1]
  s_add_u32 s34, s34, 4096
  buffer_load_dwordx4 a[144:147], v2, s[52:55], s34 offen offset:0 sc1
  v_pk_fma_f32 v[64:65], v[168:169], v[248:249], v[64:65] op_sel:[0,1,0] op_sel_hi:[1,1,1]
  v_pk_fma_f32 v[66:67], v[170:171], v[248:249], v[66:67] op_sel:[0,1,0] op_sel_hi:[1,1,1]
  v_pk_fma_f32 v[68:69], v[172:173], v[248:249], v[68:69] op_sel:[0,1,0] op_sel_hi:[1,1,1]
  v_pk_fma_f32 v[70:71], v[174:175], v[248:249], v[70:71] op_sel:[0,1,0] op_sel_hi:[1,1,1]
  v_cvt_pk_bf16_f32 v120, v64, v65
  v_cvt_pk_bf16_f32 v121, v66, v67
  v_cvt_pk_bf16_f32 v122, v68, v69
  v_cvt_pk_bf16_f32 v123, v70, v71
  ds_write_b128 v254, v[120:123]
  buffer_load_dwordx4 a[148:151], v2, s[52:55], s34 offen offset:1024 sc1
  ds_read_b64_tr_b16 v[68:69], v255
  ds_read_b64_tr_b16 v[70:71], v255 offset:640
  v_pk_add_f32 v[96:97], v[96:97], v[98:99]
  v_pk_add_f32 v[100:101], v[100:101], v[102:103]
  v_pk_add_f32 v[96:97], v[96:97], v[100:101]
  v_pk_fma_f32 v[252:253], v[34:35], v[96:97], v[252:253] op_sel:[0,0,0] op_sel_hi:[1,0,1]
  v_pk_fma_f32 v[252:253], v[34:35], v[96:97], v[252:253] op_sel:[1,1,0] op_sel_hi:[0,1,1] neg_hi:[1,0,0]
  s_add_u32 s13, s79, 0
  s_waitcnt lgkmcnt(3)
  buffer_store_dwordx4 v[60:63], v47, s[60:63], s13 offen sc1
  v_pk_fma_f32 v[72:73], v[176:177], v[250:251], v[72:73] op_sel:[0,0,0] op_sel_hi:[1,0,1]
  v_pk_fma_f32 v[74:75], v[178:179], v[250:251], v[74:75] op_sel:[0,0,0] op_sel_hi:[1,0,1]
  v_pk_fma_f32 v[76:77], v[180:181], v[250:251], v[76:77] op_sel:[0,0,0] op_sel_hi:[1,0,1]
  v_pk_fma_f32 v[78:79], v[182:183], v[250:251], v[78:79] op_sel:[0,0,0] op_sel_hi:[1,0,1]
  v_pk_fma_f32 v[72:73], v[184:185], v[250:251], v[72:73] op_sel:[0,1,0] op_sel_hi:[1,1,1]
  v_pk_fma_f32 v[74:75], v[186:187], v[250:251], v[74:75] op_sel:[0,1,0] op_sel_hi:[1,1,1]
  v_pk_fma_f32 v[76:77], v[188:189], v[250:251], v[76:77] op_sel:[0,1,0] op_sel_hi:[1,1,1]
  v_pk_fma_f32 v[78:79], v[190:191], v[250:251], v[78:79] op_sel:[0,1,0] op_sel_hi:[1,1,1]
  v_cvt_pk_bf16_f32 v124, v72, v73
  v_cvt_pk_bf16_f32 v125, v74, v75
  v_cvt_pk_bf16_f32 v126, v76, v77
  v_cvt_pk_bf16_f32 v127, v78, v79
  ds_write_b128 v254, v[124:127]
  ds_read_b64_tr_b16 v[76:77], v255
  ds_read_b64_tr_b16 v[78:79], v255 offset:640
  s_add_u32 s13, s80, 0
  s_waitcnt lgkmcnt(3)
  buffer_store_dwordx4 v[68:71], v47, s[60:63], s13 offen sc1
  v_pk_fma_f32 v[80:81], v[104:105], v[252:253], v[80:81] op_sel:[0,0,0] op_sel_hi:[1,0,1]
  v_pk_fma_f32 v[82:83], v[106:107], v[252:253], v[82:83] op_sel:[0,0,0] op_sel_hi:[1,0,1]
  v_pk_fma_f32 v[84:85], v[108:109], v[252:253], v[84:85] op_sel:[0,0,0] op_sel_hi:[1,0,1]
  v_pk_fma_f32 v[86:87], v[110:111], v[252:253], v[86:87] op_sel:[0,0,0] op_sel_hi:[1,0,1]
  v_pk_fma_f32 v[80:81], v[112:113], v[252:253], v[80:81] op_sel:[0,1,0] op_sel_hi:[1,1,1]
  v_pk_fma_f32 v[82:83], v[114:115], v[252:253], v[82:83] op_sel:[0,1,0] op_sel_hi:[1,1,1]
  v_pk_fma_f32 v[84:85], v[116:117], v[252:253], v[84:85] op_sel:[0,1,0] op_sel_hi:[1,1,1]
  v_pk_fma_f32 v[86:87], v[118:119], v[252:253], v[86:87] op_sel:[0,1,0] op_sel_hi:[1,1,1]
  v_cvt_pk_bf16_f32 v120, v80, v81
  v_cvt_pk_bf16_f32 v121, v82, v83
  v_cvt_pk_bf16_f32 v122, v84, v85
  v_cvt_pk_bf16_f32 v123, v86, v87
  ds_write_b128 v254, v[120:123]
  ds_read_b64_tr_b16 v[84:85], v255
  ds_read_b64_tr_b16 v[86:87], v255 offset:640
  v_accvgpr_read_b32 v246, a204
  v_accvgpr_read_b32 v247, a205
  v_accvgpr_read_b32 v248, a206
  v_accvgpr_read_b32 v249, a207
  v_accvgpr_read_b32 v250, a208
  v_accvgpr_read_b32 v251, a209
  v_accvgpr_read_b32 v252, a210
  v_accvgpr_read_b32 v44, a211
  v_accvgpr_read_b32 v45, a212
  v_accvgpr_read_b32 v46, a213
  v_accvgpr_read_b32 v244, a214
  ds_read_b64 v[88:89], v247 offset:1536
  ds_read_b64 v[90:91], v247 offset:1024
  ds_read_b64 v[92:93], v247 offset:512
  ds_read_b64 v[94:95], v247 offset:0
  ds_read_b64 v[96:97], v248
  s_waitcnt lgkmcnt(5)
  s_bitcmp1_b32 s1, 0
  s_cbranch_scc1 type_36
  ds_read2_b32 v[156:157], v235 offset0:176 offset1:177
  ds_read2_b32 v[158:159], v235 offset0:178 offset1:179
  ds_read_b128 v[160:163], v240 offset:3776
  ds_read2_b32 v[152:153], v235 offset0:48 offset1:49
  ds_read2_b32 v[154:155], v235 offset0:50 offset1:51
  ds_read_b128 v[164:167], v240 offset:3264
  ds_read2_b32 v[148:149], v234 offset0:176 offset1:177
  ds_read2_b32 v[150:151], v234 offset0:178 offset1:179
  s_waitcnt lgkmcnt(5)
  v_mfma_f32_16x16x32_bf16 v[220:223], v[156:159], v[160:163], v[220:223]
  ds_read_b128 v[168:171], v240 offset:2752
  s_waitcnt lgkmcnt(4)
  v_mfma_f32_16x16x32_bf16 v[216:219], v[152:155], v[160:163], v[216:219]
  ds_read2_b32 v[144:145], v234 offset0:48 offset1:49
  ds_read2_b32 v[146:147], v234 offset0:50 offset1:51
  s_waitcnt lgkmcnt(5)
  v_mfma_f32_16x16x32_bf16 v[220:223], v[152:155], v[164:167], v[220:223]
  ds_read_b128 v[172:175], v240 offset:2240
  s_waitcnt lgkmcnt(4)
  v_mfma_f32_16x16x32_bf16 v[212:215], v[148:151], v[160:163], v[212:215]
  ds_read2_b32 v[140:141], v233 offset0:176 offset1:177
  ds_read2_b32 v[142:143], v233 offset0:178 offset1:179
  s_add_u32 s13, s81, 0
  buffer_store_dwordx4 v[76:79], v47, s[60:63], s13 offen sc1
  v_mfma_f32_16x16x32_bf16 v[216:219], v[148:151], v[164:167], v[216:219]
  ds_read_b128 v[176:179], v240 offset:1728
  s_waitcnt lgkmcnt(6)
  v_mfma_f32_16x16x32_bf16 v[220:223], v[148:151], v[168:171], v[220:223]
  ds_read2_b32 v[136:137], v233 offset0:48 offset1:49
  ds_read2_b32 v[138:139], v233 offset0:50 offset1:51
  s_waitcnt lgkmcnt(6)
  v_mfma_f32_16x16x32_bf16 v[208:211], v[144:147], v[160:163], v[208:211]
  ds_read_b128 v[180:183], v240 offset:1216
  v_mfma_f32_16x16x32_bf16 v[212:215], v[144:147], v[164:167], v[212:215]
  ds_read2_b32 v[132:133], v232 offset0:176 offset1:177
  ds_read2_b32 v[134:135], v232 offset0:178 offset1:179
  s_add_u32 s13, s82, 0
  buffer_store_dwordx4 v[84:87], v47, s[60:63], s13 offen sc1
  v_mfma_f32_16x16x32_bf16 v[216:219], v[144:147], v[168:171], v[216:219]
  s_waitcnt lgkmcnt(8)
  v_mfma_f32_16x16x32_bf16 v[220:223], v[144:147], v[172:175], v[220:223]
  s_waitcnt lgkmcnt(6)
  v_mfma_f32_16x16x32_bf16 v[204:207], v[140:143], v[160:163], v[204:207]
  v_mfma_f32_16x16x32_bf16 v[208:211], v[140:143], v[164:167], v[208:211]
  v_mfma_f32_16x16x32_bf16 v[212:215], v[140:143], v[168:171], v[212:215]
  buffer_load_dwordx4 a[152:155], v2, s[52:55], s34 offen offset:2048 sc1
  v_mfma_f32_16x16x32_bf16 v[216:219], v[140:143], v[172:175], v[216:219]
  ds_read_b128 v[184:187], v240 offset:704
  s_waitcnt lgkmcnt(6)
  v_mfma_f32_16x16x32_bf16 v[220:223], v[140:143], v[176:179], v[220:223]
  ds_read2_b32 v[128:129], v232 offset0:48 offset1:49
  ds_read2_b32 v[130:131], v232 offset0:50 offset1:51
  s_waitcnt lgkmcnt(6)
  v_mfma_f32_16x16x32_bf16 v[200:203], v[136:139], v[160:163], v[200:203]
  v_mfma_f32_16x16x32_bf16 v[204:207], v[136:139], v[164:167], v[204:207]
  buffer_load_dwordx4 a[156:159], v2, s[52:55], s34 offen offset:3072 sc1
  v_mfma_f32_16x16x32_bf16 v[208:211], v[136:139], v[168:171], v[208:211]
  v_mfma_f32_16x16x32_bf16 v[212:215], v[136:139], v[172:175], v[212:215]
  v_mfma_f32_16x16x32_bf16 v[216:219], v[136:139], v[176:179], v[216:219]
  s_waitcnt lgkmcnt(5)
  v_mfma_f32_16x16x32_bf16 v[220:223], v[136:139], v[180:183], v[220:223]
  s_add_u32 s34, s34, 4096
  buffer_load_dwordx4 a[160:163], v2, s[52:55], s34 offen offset:0 sc1
  s_waitcnt lgkmcnt(3)
  v_mfma_f32_16x16x32_bf16 v[196:199], v[132:135], v[160:163], v[196:199]
  ds_read_b128 v[188:191], v240 offset:192
  v_mfma_f32_16x16x32_bf16 v[200:203], v[132:135], v[164:167], v[200:203]
  ds_read2_b32 v[156:157], v239 offset0:128 offset1:129
  ds_read2_b32 v[158:159], v239 offset0:130 offset1:131
  v_mfma_f32_16x16x32_bf16 v[204:207], v[132:135], v[168:171], v[204:207]
  ds_read2_b32 v[152:153], v239 offset0:0 offset1:1
  ds_read2_b32 v[154:155], v239 offset0:2 offset1:3
  v_mfma_f32_16x16x32_bf16 v[208:211], v[132:135], v[172:175], v[208:211]
  ds_read2_b32 v[148:149], v238 offset0:128 offset1:129
  ds_read2_b32 v[150:151], v238 offset0:130 offset1:131
  v_mfma_f32_16x16x32_bf16 v[212:215], v[132:135], v[176:179], v[212:215]
  ds_read2_b32 v[144:145], v238 offset0:0 offset1:1
  ds_read2_b32 v[146:147], v238 offset0:2 offset1:3
  v_mfma_f32_16x16x32_bf16 v[216:219], v[132:135], v[180:183], v[216:219]
  buffer_load_dwordx4 a[164:167], v2, s[52:55], s34 offen offset:1024 sc1
  s_waitcnt lgkmcnt(11)
  v_mfma_f32_16x16x32_bf16 v[220:223], v[132:135], v[184:187], v[220:223]
  ds_read2_b32 v[140:141], v237 offset0:128 offset1:129
  ds_read2_b32 v[142:143], v237 offset0:130 offset1:131
  s_waitcnt lgkmcnt(11)
  v_mfma_f32_16x16x32_bf16 v[192:195], v[128:131], v[160:163], v[192:195]
  ds_read_b128 v[160:163], v241 offset:3584
  v_mfma_f32_16x16x32_bf16 v[196:199], v[128:131], v[164:167], v[196:199]
  ds_read_b128 v[164:167], v241 offset:3072
  v_mfma_f32_16x16x32_bf16 v[200:203], v[128:131], v[168:171], v[200:203]
  ds_read2_b32 v[136:137], v237 offset0:0 offset1:1
  ds_read2_b32 v[138:139], v237 offset0:2 offset1:3
  v_mfma_f32_16x16x32_bf16 v[204:207], v[128:131], v[172:175], v[204:207]
  ds_read_b128 v[168:171], v241 offset:2560
  buffer_load_dwordx4 a[168:171], v2, s[52:55], s34 offen offset:2048 sc1
  v_mfma_f32_16x16x32_bf16 v[208:211], v[128:131], v[176:179], v[208:211]
  ds_read_b128 v[172:175], v241 offset:2048
  v_mfma_f32_16x16x32_bf16 v[212:215], v[128:131], v[180:183], v[212:215]
  ds_read_b128 v[176:179], v241 offset:1536
  v_mfma_f32_16x16x32_bf16 v[216:219], v[128:131], v[184:187], v[216:219]
  ds_read2_b32 v[132:133], v236 offset0:128 offset1:129
  ds_read2_b32 v[134:135], v236 offset0:130 offset1:131
  s_waitcnt lgkmcnt(15)
  v_mfma_f32_16x16x32_bf16 v[220:223], v[128:131], v[188:191], v[220:223]
  ds_read_b128 v[180:183], v241 offset:1024
  buffer_load_dwordx4 a[172:175], v2, s[52:55], s34 offen offset:3072 sc1
  s_waitcnt vmcnt(6)
  s_add_u32 s14, s84, 4352
  v_mov_b32 v15, s8
  s_mov_b64 exec, 1
  s_cmp_eq_u32 s9, 0
  s_cbranch_scc1 slow_38
  buffer_store_dword v15, off, s[52:55], s14
back_39:
  s_mov_b64 exec, -1
  s_waitcnt lgkmcnt(9)
  v_mfma_f32_16x16x32_bf16 v[116:119], v[156:159], v[160:163], 0
  ds_read_b128 v[184:187], v241 offset:512
  s_waitcnt lgkmcnt(9)
  v_mfma_f32_16x16x32_bf16 v[116:119], v[152:155], v[164:167], v[116:119]
  ds_read2_b32 v[128:129], v236 offset0:0 offset1:1
  ds_read2_b32 v[130:131], v236 offset0:2 offset1:3
  s_waitcnt lgkmcnt(8)
  v_mfma_f32_16x16x32_bf16 v[116:119], v[148:151], v[168:171], v[116:119]
  v_mfma_f32_16x16x32_bf16 v[112:115], v[144:147], v[160:163], 0
  ds_read_b128 v[188:191], v241 offset:0
  s_waitcnt lgkmcnt(8)
  v_mfma_f32_16x16x32_bf16 v[116:119], v[144:147], v[172:175], v[116:119]
  ds_read2_b32 v[156:157], v239 offset0:144 offset1:145
  ds_read2_b32 v[158:159], v239 offset0:146 offset1:147
  v_mfma_f32_16x16x32_bf16 v[112:115], v[140:143], v[164:167], v[112:115]
  ds_read2_b32 v[152:153], v239 offset0:16 offset1:17
  ds_read2_b32 v[154:155], v239 offset0:18 offset1:19
  s_waitcnt lgkmcnt(11)
  v_mfma_f32_16x16x32_bf16 v[116:119], v[140:143], v[176:179], v[116:119]
  ds_read2_b32 v[148:149], v238 offset0:144 offset1:145
  ds_read2_b32 v[150:151], v238 offset0:146 offset1:147
  v_mfma_f32_16x16x32_bf16 v[108:111], v[136:139], v[160:163], 0
  ds_read2_b32 v[144:145], v238 offset0:16 offset1:17
  ds_read2_b32 v[146:147], v238 offset0:18 offset1:19
  s_add_u32 s34, s34, 4096
  buffer_load_dwordx4 a[176:179], v2, s[52:55], s34 offen offset:0 sc1
  s_bitcmp0_b32 s7, 0
  s_cbranch_scc1 skip_40
  v_swap_b32 v192, v208
  v_swap_b32 v193, v209
  v_swap_b32 v194, v210
  v_swap_b32 v195, v211
  v_swap_b32 v196, v212
  v_swap_b32 v197, v213
  v_swap_b32 v198, v214
  v_swap_b32 v199, v215
  v_swap_b32 v200, v216
  v_swap_b32 v201, v217
  v_swap_b32 v202, v218
  v_swap_b32 v203, v219
  v_swap_b32 v204, v220
  v_swap_b32 v205, v221
  v_swap_b32 v206, v222
  v_swap_b32 v207, v223
skip_40:
  v_mfma_f32_16x16x32_bf16 v[112:115], v[136:139], v[168:171], v[112:115]
  buffer_load_dwordx4 a[180:183], v2, s[52:55], s34 offen offset:1024 sc1
  s_waitcnt lgkmcnt(12)
  v_mfma_f32_16x16x32_bf16 v[116:119], v[136:139], v[180:183], v[116:119]
  ds_read2_b32 v[140:141], v237 offset0:144 offset1:145
  ds_read2_b32 v[142:143], v237 offset0:146 offset1:147
  v_mfma_f32_16x16x32_bf16 v[104:107], v[132:135], v[160:163], 0
  ds_read_b128 v[160:163], v241 offset:3648
  v_mfma_f32_16x16x32_bf16 v[108:111], v[132:135], v[164:167], v[108:111]
  ds_read2_b32 v[136:137], v237 offset0:16 offset1:17
  ds_read2_b32 v[138:139], v237 offset0:18 offset1:19
  ds_write_b128 v249, v[208:211] offset:0
  v_mfma_f32_16x16x32_bf16 v[112:115], v[132:135], v[172:175], v[112:115]
  ds_read_b128 v[172:175], v241 offset:2112
  s_waitcnt lgkmcnt(15)
  v_mfma_f32_16x16x32_bf16 v[116:119], v[132:135], v[184:187], v[116:119]
  ds_read_b128 v[180:183], v241 offset:1088
  v_mfma_f32_16x16x32_bf16 v[104:107], v[128:131], v[164:167], v[104:107]
  ds_read_b128 v[164:167], v241 offset:3136
  v_mfma_f32_16x16x32_bf16 v[108:111], v[128:131], v[168:171], v[108:111]
  ds_read2_b32 v[132:133], v236 offset0:144 offset1:145
  ds_read2_b32 v[134:135], v236 offset0:146 offset1:147
  buffer_load_dwordx4 a[184:187], v2, s[52:55], s34 offen offset:2048 sc1
  ds_write_b128 v249, v[212:215] offset:1024
  s_mov_b32 s92, 24576
  buffer_load_dwordx4 v[120:123], v2, s[52:55], s92 offen sc1
  v_mfma_f32_16x16x32_bf16 v[112:115], v[128:131], v[176:179], v[112:115]
  ds_read_b128 v[168:171], v241 offset:2624
  v_mfma_f32_16x16x32_bf16 v[116:119], v[128:131], v[188:191], v[116:119]
  ds_read_b128 v[176:179], v241 offset:1600
  s_waitcnt lgkmcnt(11)
  v_mfma_f32_16x16x32_bf16 v[116:119], v[156:159], v[160:163], v[116:119]
  ds_read_b128 v[184:187], v241 offset:576
  s_waitcnt lgkmcnt(6)
  v_mfma_f32_16x16x32_bf16 v[116:119], v[152:155], v[164:167], v[116:119]
  ds_read2_b32 v[128:129], v236 offset0:16 offset1:17
  ds_read2_b32 v[130:131], v236 offset0:18 offset1:19
  buffer_load_dwordx4 a[188:191], v2, s[52:55], s34 offen offset:3072 sc1
  ds_write_b128 v249, v[216:219] offset:2048
  s_barrier
  s_waitcnt lgkmcnt(5)
  v_mfma_f32_16x16x32_bf16 v[116:119], v[148:151], v[168:171], v[116:119]
  s_add_u32 s34, s34, 4096
  buffer_load_dwordx4 a[192:195], v2, s[52:55], s34 offen offset:0 sc1
  v_mfma_f32_16x16x32_bf16 v[112:115], v[144:147], v[160:163], v[112:115]
  ds_read_b128 v[188:191], v241 offset:64
  v_mfma_f32_16x16x32_bf16 v[116:119], v[144:147], v[172:175], v[116:119]
  ds_write_b128 v249, v[220:223] offset:3072
  v_mfma_f32_16x16x32_bf16 v[112:115], v[140:143], v[164:167], v[112:115]
  s_waitcnt lgkmcnt(6)
  v_mfma_f32_16x16x32_bf16 v[116:119], v[140:143], v[176:179], v[116:119]
  buffer_load_dwordx4 a[196:199], v2, s[52:55], s34 offen offset:1024 sc1
  v_mfma_f32_16x16x32_bf16 v[108:111], v[136:139], v[160:163], v[108:111]
  buffer_load_dwordx2 v[42:43], v244, s[52:55], s49 offen sc1
  v_mfma_f32_16x16x32_bf16 v[112:115], v[136:139], v[168:171], v[112:115]
  v_mfma_f32_16x16x32_bf16 v[116:119], v[136:139], v[180:183], v[116:119]
  v_mfma_f32_16x16x32_bf16 v[104:107], v[132:135], v[160:163], v[104:107]
  v_mfma_f32_16x16x32_bf16 v[108:111], v[132:135], v[164:167], v[108:111]
  v_mfma_f32_16x16x32_bf16 v[112:115], v[132:135], v[172:175], v[112:115]
  s_waitcnt lgkmcnt(5)
  v_mfma_f32_16x16x32_bf16 v[116:119], v[132:135], v[184:187], v[116:119]
  s_waitcnt lgkmcnt(3)
  v_mfma_f32_16x16x32_bf16 v[104:107], v[128:131], v[164:167], v[104:107]
  v_mfma_f32_16x16x32_bf16 v[108:111], v[128:131], v[168:171], v[108:111]
  v_mfma_f32_16x16x32_bf16 v[112:115], v[128:131], v[176:179], v[112:115]
  s_waitcnt lgkmcnt(1)
  v_mfma_f32_16x16x32_bf16 v[116:119], v[128:131], v[188:191], v[116:119]
  s_branch join_37
type_36:
  ds_read2_b32 v[156:157], v235 offset0:176 offset1:177
  ds_read2_b32 v[158:159], v235 offset0:178 offset1:179
  ds_read_b128 v[160:163], v240 offset:3776
  ds_read2_b32 v[152:153], v235 offset0:48 offset1:49
  ds_read2_b32 v[154:155], v235 offset0:50 offset1:51
  ds_read_b128 v[164:167], v240 offset:3264
  ds_read2_b32 v[148:149], v234 offset0:176 offset1:177
  ds_read2_b32 v[150:151], v234 offset0:178 offset1:179
  s_waitcnt lgkmcnt(5)
  v_mfma_f32_16x16x32_bf16 v[220:223], v[156:159], v[160:163], v[220:223]
  ds_read_b128 v[168:171], v240 offset:2752
  s_waitcnt lgkmcnt(4)
  v_mfma_f32_16x16x32_bf16 v[216:219], v[152:155], v[160:163], v[216:219]
  ds_read2_b32 v[144:145], v234 offset0:48 offset1:49
  ds_read2_b32 v[146:147], v234 offset0:50 offset1:51
  s_waitcnt lgkmcnt(5)
  v_mfma_f32_16x16x32_bf16 v[220:223], v[152:155], v[164:167], v[220:223]
  ds_read_b128 v[172:175], v240 offset:2240
  s_waitcnt lgkmcnt(4)
  v_mfma_f32_16x16x32_bf16 v[212:215], v[148:151], v[160:163], v[212:215]
  ds_read2_b32 v[140:141], v233 offset0:176 offset1:177
  ds_read2_b32 v[142:143], v233 offset0:178 offset1:179
  s_add_u32 s13, s81, 0
  buffer_store_dwordx4 v[76:79], v47, s[60:63], s13 offen sc1
  v_mfma_f32_16x16x32_bf16 v[216:219], v[148:151], v[164:167], v[216:219]
  ds_read_b128 v[176:179], v240 offset:1728
  s_waitcnt lgkmcnt(6)
  v_mfma_f32_16x16x32_bf16 v[220:223], v[148:151], v[168:171], v[220:223]
  ds_read2_b32 v[136:137], v233 offset0:48 offset1:49
  ds_read2_b32 v[138:139], v233 offset0:50 offset1:51
  s_waitcnt lgkmcnt(6)
  v_mfma_f32_16x16x32_bf16 v[208:211], v[144:147], v[160:163], v[208:211]
  ds_read_b128 v[180:183], v240 offset:1216
  v_mfma_f32_16x16x32_bf16 v[212:215], v[144:147], v[164:167], v[212:215]
  ds_read2_b32 v[132:133], v232 offset0:176 offset1:177
  ds_read2_b32 v[134:135], v232 offset0:178 offset1:179
  s_add_u32 s13, s82, 0
  buffer_store_dwordx4 v[84:87], v47, s[60:63], s13 offen sc1
  v_mfma_f32_16x16x32_bf16 v[216:219], v[144:147], v[168:171], v[216:219]
  s_waitcnt lgkmcnt(8)
  v_mfma_f32_16x16x32_bf16 v[220:223], v[144:147], v[172:175], v[220:223]
  s_waitcnt lgkmcnt(6)
  v_mfma_f32_16x16x32_bf16 v[204:207], v[140:143], v[160:163], v[204:207]
  v_mfma_f32_16x16x32_bf16 v[208:211], v[140:143], v[164:167], v[208:211]
  v_mfma_f32_16x16x32_bf16 v[212:215], v[140:143], v[168:171], v[212:215]
  buffer_load_dwordx4 a[152:155], v2, s[52:55], s34 offen offset:2048 sc1
  v_mfma_f32_16x16x32_bf16 v[216:219], v[140:143], v[172:175], v[216:219]
  ds_read_b128 v[184:187], v240 offset:704
  s_waitcnt lgkmcnt(6)
  v_mfma_f32_16x16x32_bf16 v[220:223], v[140:143], v[176:179], v[220:223]
  ds_read2_b32 v[128:129], v232 offset0:48 offset1:49
  ds_read2_b32 v[130:131], v232 offset0:50 offset1:51
  s_waitcnt lgkmcnt(6)
  v_mfma_f32_16x16x32_bf16 v[200:203], v[136:139], v[160:163], v[200:203]
  v_mfma_f32_16x16x32_bf16 v[204:207], v[136:139], v[164:167], v[204:207]
  buffer_load_dwordx4 a[156:159], v2, s[52:55], s34 offen offset:3072 sc1
  v_mfma_f32_16x16x32_bf16 v[208:211], v[136:139], v[168:171], v[208:211]
  v_mfma_f32_16x16x32_bf16 v[212:215], v[136:139], v[172:175], v[212:215]
  v_mfma_f32_16x16x32_bf16 v[216:219], v[136:139], v[176:179], v[216:219]
  s_waitcnt lgkmcnt(5)
  v_mfma_f32_16x16x32_bf16 v[220:223], v[136:139], v[180:183], v[220:223]
  s_add_u32 s34, s34, 4096
  buffer_load_dwordx4 a[160:163], v2, s[52:55], s34 offen offset:0 sc1
  s_waitcnt lgkmcnt(3)
  v_mfma_f32_16x16x32_bf16 v[196:199], v[132:135], v[160:163], v[196:199]
  ds_read_b128 v[188:191], v240 offset:192
  v_mfma_f32_16x16x32_bf16 v[200:203], v[132:135], v[164:167], v[200:203]
  ds_read2_b32 v[152:153], v239 offset0:0 offset1:1
  ds_read2_b32 v[154:155], v239 offset0:2 offset1:3
  v_mfma_f32_16x16x32_bf16 v[204:207], v[132:135], v[168:171], v[204:207]
  ds_read2_b32 v[148:149], v238 offset0:128 offset1:129
  ds_read2_b32 v[150:151], v238 offset0:130 offset1:131
  v_mfma_f32_16x16x32_bf16 v[208:211], v[132:135], v[172:175], v[208:211]
  buffer_load_dwordx4 a[164:167], v2, s[52:55], s34 offen offset:1024 sc1
  v_mfma_f32_16x16x32_bf16 v[212:215], v[132:135], v[176:179], v[212:215]
  ds_read2_b32 v[144:145], v238 offset0:0 offset1:1
  ds_read2_b32 v[146:147], v238 offset0:2 offset1:3
  v_mfma_f32_16x16x32_bf16 v[216:219], v[132:135], v[180:183], v[216:219]
  s_waitcnt lgkmcnt(9)
  v_mfma_f32_16x16x32_bf16 v[220:223], v[132:135], v[184:187], v[220:223]
  ds_read2_b32 v[140:141], v237 offset0:128 offset1:129
  ds_read2_b32 v[142:143], v237 offset0:130 offset1:131
  s_waitcnt lgkmcnt(9)
  v_mfma_f32_16x16x32_bf16 v[192:195], v[128:131], v[160:163], v[192:195]
  ds_read_b128 v[160:163], v241 offset:3584
  v_mfma_f32_16x16x32_bf16 v[196:199], v[128:131], v[164:167], v[196:199]
  ds_read_b128 v[164:167], v241 offset:3072
  v_mfma_f32_16x16x32_bf16 v[200:203], v[128:131], v[168:171], v[200:203]
  ds_read_b128 v[168:171], v241 offset:2560
  v_mfma_f32_16x16x32_bf16 v[204:207], v[128:131], v[172:175], v[204:207]
  ds_read2_b32 v[136:137], v237 offset0:0 offset1:1
  ds_read2_b32 v[138:139], v237 offset0:2 offset1:3
  buffer_load_dwordx4 a[168:171], v2, s[52:55], s34 offen offset:2048 sc1
  v_mfma_f32_16x16x32_bf16 v[208:211], v[128:131], v[176:179], v[208:211]
  ds_read_b128 v[172:175], v241 offset:2048
  v_mfma_f32_16x16x32_bf16 v[212:215], v[128:131], v[180:183], v[212:215]
  ds_read_b128 v[176:179], v241 offset:1536
  v_mfma_f32_16x16x32_bf16 v[216:219], v[128:131], v[184:187], v[216:219]
  ds_read2_b32 v[132:133], v236 offset0:128 offset1:129
  ds_read2_b32 v[134:135], v236 offset0:130 offset1:131
  s_waitcnt lgkmcnt(15)
  v_mfma_f32_16x16x32_bf16 v[220:223], v[128:131], v[188:191], v[220:223]
  ds_read_b128 v[180:183], v241 offset:1024
  buffer_load_dwordx4 a[172:175], v2, s[52:55], s34 offen offset:3072 sc1
  s_waitcnt vmcnt(6)
  s_add_u32 s14, s84, 4352
  v_mov_b32 v15, s8
  s_mov_b64 exec, 1
  s_cmp_eq_u32 s9, 0
  s_cbranch_scc1 slow_41
  buffer_store_dword v15, off, s[52:55], s14
back_42:
  s_mov_b64 exec, -1
  s_waitcnt lgkmcnt(9)
  v_mfma_f32_16x16x32_bf16 v[116:119], v[152:155], v[160:163], 0
  ds_read2_b32 v[128:129], v236 offset0:0 offset1:1
  ds_read2_b32 v[130:131], v236 offset0:2 offset1:3
  v_mfma_f32_16x16x32_bf16 v[112:115], v[148:151], v[160:163], 0
  s_waitcnt lgkmcnt(10)
  v_mfma_f32_16x16x32_bf16 v[116:119], v[148:151], v[164:167], v[116:119]
  v_mfma_f32_16x16x32_bf16 v[112:115], v[144:147], v[164:167], v[112:115]
  ds_read_b128 v[184:187], v241 offset:512
  s_waitcnt lgkmcnt(10)
  v_mfma_f32_16x16x32_bf16 v[116:119], v[144:147], v[168:171], v[116:119]
  ds_read2_b32 v[152:153], v239 offset0:16 offset1:17
  ds_read2_b32 v[154:155], v239 offset0:18 offset1:19
  v_mfma_f32_16x16x32_bf16 v[108:111], v[140:143], v[160:163], 0
  ds_read2_b32 v[148:149], v238 offset0:144 offset1:145
  ds_read2_b32 v[150:151], v238 offset0:146 offset1:147
  v_mfma_f32_16x16x32_bf16 v[112:115], v[140:143], v[168:171], v[112:115]
  s_add_u32 s34, s34, 4096
  buffer_load_dwordx4 a[176:179], v2, s[52:55], s34 offen offset:0 sc1
  s_waitcnt lgkmcnt(11)
  v_mfma_f32_16x16x32_bf16 v[116:119], v[140:143], v[172:175], v[116:119]
  ds_read2_b32 v[144:145], v238 offset0:16 offset1:17
  ds_read2_b32 v[146:147], v238 offset0:18 offset1:19
  s_bitcmp0_b32 s7, 0
  s_cbranch_scc1 skip_43
  v_swap_b32 v192, v208
  v_swap_b32 v193, v209
  v_swap_b32 v194, v210
  v_swap_b32 v195, v211
  v_swap_b32 v196, v212
  v_swap_b32 v197, v213
  v_swap_b32 v198, v214
  v_swap_b32 v199, v215
  v_swap_b32 v200, v216
  v_swap_b32 v201, v217
  v_swap_b32 v202, v218
  v_swap_b32 v203, v219
  v_swap_b32 v204, v220
  v_swap_b32 v205, v221
  v_swap_b32 v206, v222
  v_swap_b32 v207, v223
skip_43:
  v_mfma_f32_16x16x32_bf16 v[108:111], v[136:139], v[164:167], v[108:111]
  ds_read_b128 v[164:167], v241 offset:3136
  v_mfma_f32_16x16x32_bf16 v[112:115], v[136:139], v[172:175], v[112:115]
  ds_read2_b32 v[140:141], v237 offset0:144 offset1:145
  ds_read2_b32 v[142:143], v237 offset0:146 offset1:147
  s_waitcnt lgkmcnt(15)
  v_mfma_f32_16x16x32_bf16 v[116:119], v[136:139], v[176:179], v[116:119]
  buffer_load_dwordx4 a[180:183], v2, s[52:55], s34 offen offset:1024 sc1
  s_waitcnt lgkmcnt(13)
  v_mfma_f32_16x16x32_bf16 v[108:111], v[132:135], v[168:171], v[108:111]
  ds_read_b128 v[168:171], v241 offset:2624
  ds_write_b128 v249, v[208:211] offset:0
  v_mfma_f32_16x16x32_bf16 v[112:115], v[132:135], v[176:179], v[112:115]
  ds_read2_b32 v[136:137], v237 offset0:16 offset1:17
  ds_read2_b32 v[138:139], v237 offset0:18 offset1:19
  s_waitcnt lgkmcnt(15)
  v_mfma_f32_16x16x32_bf16 v[116:119], v[132:135], v[180:183], v[116:119]
  buffer_load_dwordx4 a[184:187], v2, s[52:55], s34 offen offset:2048 sc1
  s_waitcnt lgkmcnt(14)
  v_mfma_f32_16x16x32_bf16 v[104:107], v[128:131], v[160:163], 0
  ds_read_b128 v[160:163], v241 offset:3648
  v_mfma_f32_16x16x32_bf16 v[108:111], v[128:131], v[172:175], v[108:111]
  ds_read_b128 v[176:179], v241 offset:1600
  ds_write_b128 v249, v[212:215] offset:1024
  s_mov_b32 s92, 24576
  buffer_load_dwordx4 v[120:123], v2, s[52:55], s92 offen sc1
  v_mfma_f32_16x16x32_bf16 v[112:115], v[128:131], v[180:183], v[112:115]
  ds_read_b128 v[172:175], v241 offset:2112
  s_waitcnt lgkmcnt(15)
  v_mfma_f32_16x16x32_bf16 v[116:119], v[128:131], v[184:187], v[116:119]
  ds_read2_b32 v[132:133], v236 offset0:144 offset1:145
  ds_read2_b32 v[134:135], v236 offset0:146 offset1:147
  s_waitcnt lgkmcnt(5)
  v_mfma_f32_16x16x32_bf16 v[116:119], v[152:155], v[160:163], v[116:119]
  ds_read_b128 v[180:183], v241 offset:1088
  v_mfma_f32_16x16x32_bf16 v[112:115], v[148:151], v[160:163], v[112:115]
  ds_read2_b32 v[128:129], v236 offset0:16 offset1:17
  ds_read2_b32 v[130:131], v236 offset0:18 offset1:19
  buffer_load_dwordx4 a[188:191], v2, s[52:55], s34 offen offset:3072 sc1
  ds_write_b128 v249, v[216:219] offset:2048
  s_barrier
  v_mfma_f32_16x16x32_bf16 v[116:119], v[148:151], v[164:167], v[116:119]
  s_add_u32 s34, s34, 4096
  buffer_load_dwordx4 a[192:195], v2, s[52:55], s34 offen offset:0 sc1
  v_mfma_f32_16x16x32_bf16 v[112:115], v[144:147], v[164:167], v[112:115]
  ds_read_b128 v[184:187], v241 offset:576
  v_mfma_f32_16x16x32_bf16 v[116:119], v[144:147], v[168:171], v[116:119]
  ds_write_b128 v249, v[220:223] offset:3072
  v_mfma_f32_16x16x32_bf16 v[108:111], v[140:143], v[160:163], v[108:111]
  v_mfma_f32_16x16x32_bf16 v[112:115], v[140:143], v[168:171], v[112:115]
  buffer_load_dwordx4 a[196:199], v2, s[52:55], s34 offen offset:1024 sc1
  s_waitcnt lgkmcnt(8)
  v_mfma_f32_16x16x32_bf16 v[116:119], v[140:143], v[172:175], v[116:119]
  buffer_load_dwordx2 v[42:43], v244, s[52:55], s49 offen sc1
  v_mfma_f32_16x16x32_bf16 v[108:111], v[136:139], v[164:167], v[108:111]
  v_mfma_f32_16x16x32_bf16 v[112:115], v[136:139], v[172:175], v[112:115]
  v_mfma_f32_16x16x32_bf16 v[116:119], v[136:139], v[176:179], v[116:119]
  s_waitcnt lgkmcnt(6)
  v_mfma_f32_16x16x32_bf16 v[108:111], v[132:135], v[168:171], v[108:111]
  v_mfma_f32_16x16x32_bf16 v[112:115], v[132:135], v[176:179], v[112:115]
  s_waitcnt lgkmcnt(5)
  v_mfma_f32_16x16x32_bf16 v[116:119], v[132:135], v[180:183], v[116:119]
  s_waitcnt lgkmcnt(3)
  v_mfma_f32_16x16x32_bf16 v[104:107], v[128:131], v[160:163], v[104:107]
  v_mfma_f32_16x16x32_bf16 v[108:111], v[128:131], v[172:175], v[108:111]
  v_mfma_f32_16x16x32_bf16 v[112:115], v[128:131], v[180:183], v[112:115]
  s_waitcnt lgkmcnt(1)
  v_mfma_f32_16x16x32_bf16 v[116:119], v[128:131], v[184:187], v[116:119]
join_37:
  s_nop 3
  ds_write_b128 v252, v[104:107] offset:0
  ds_write_b128 v252, v[108:111] offset:1024
  ds_write_b128 v252, v[112:115] offset:2048
  s_nop 0
  ds_write_b128 v252, v[116:119] offset:3072
  v_dot2_f32_bf16 v192, v89, s31, v192
  v_dot2_f32_bf16 v193, v89, s30, v193
  v_dot2_f32_bf16 v194, v88, s31, v194
  v_dot2_f32_bf16 v195, v88, s30, v195
  v_dot2_f32_bf16 v196, v91, s31, v196
  v_dot2_f32_bf16 v197, v91, s30, v197
  v_dot2_f32_bf16 v198, v90, s31, v198
  v_dot2_f32_bf16 v199, v90, s30, v199
  v_dot2_f32_bf16 v200, v93, s31, v200
  v_dot2_f32_bf16 v201, v93, s30, v201
  v_dot2_f32_bf16 v202, v92, s31, v202
  v_dot2_f32_bf16 v203, v92, s30, v203
  v_dot2_f32_bf16 v204, v95, s31, v204
  v_dot2_f32_bf16 v205, v95, s30, v205
  v_dot2_f32_bf16 v206, v94, s31, v206
  v_dot2_f32_bf16 v207, v94, s30, v207
  s_waitcnt vmcnt(4)
  v_min3_u32 v15, v120, v121, s8
  v_max3_u32 v14, v120, v121, s8
  v_min3_u32 v15, v15, v122, v123
  v_max3_u32 v14, v14, v122, v123
  v_cmp_ne_u32 vcc, v15, v14
  s_cbranch_vccnz again_44
ok_45:
  s_waitcnt vmcnt(0)
  v_xor_b32 v15, s8, v42
  v_xor_b32 v14, s8, v43
  v_or_b32 v15, v15, v14
  v_cmp_ne_u32 vcc, 0, v15
  s_cbranch_vccz ok_47
again_46:
  buffer_load_dwordx2 v[42:43], v244, s[52:55], s49 offen sc1
  s_sub_u32 s10, s10, 1
  s_cmp_gt_i32 s10, 0
  s_waitcnt vmcnt(0)
  v_xor_b32 v15, s8, v42
  v_xor_b32 v14, s8, v43
  v_or_b32 v15, v15, v14
  v_cmp_ne_u32 vcc, 0, v15
  s_cbranch_scc0 out_48
  s_cbranch_vccnz again_46
out_48:
ok_47:
  buffer_load_dwordx4 v[128:131], v2, s[60:63], s16 offen offset:0 sc1
  buffer_load_dwordx4 v[132:135], v2, s[60:63], s16 offen offset:1024 sc1
  buffer_load_dwordx4 v[136:139], v2, s[60:63], s16 offen offset:2048 sc1
  buffer_load_dwordx4 v[140:143], v2, s[60:63], s16 offen offset:3072 sc1
  s_add_u32 s16, s16, 4096
  buffer_load_dwordx4 v[144:147], v2, s[60:63], s16 offen offset:0 sc1
  buffer_load_dwordx4 v[148:151], v2, s[60:63], s16 offen offset:1024 sc1
  buffer_load_dwordx4 v[152:155], v2, s[60:63], s16 offen offset:2048 sc1
  buffer_load_dwordx4 v[156:159], v2, s[60:63], s16 offen offset:3072 sc1
  s_waitcnt lgkmcnt(0)
  s_barrier
  ds_read_b128 v[208:211], v250 offset:0
  ds_read_b128 v[212:215], v250 offset:1024
  ds_read_b128 v[216:219], v250 offset:2048
  ds_read_b128 v[220:223], v250 offset:3072
  ds_read_b128 v[224:227], v251 offset:0
  ds_read_b128 v[228:231], v251 offset:4096
  ds_read_b128 v[232:235], v251 offset:8192
  ds_read_b128 v[236:239], v251 offset:12288
  s_waitcnt vmcnt(7)
  v_mfma_f32_16x16x32_bf16 v[48:51], a[0:3], v[128:131], 0
  s_add_u32 s16, s16, 4096
  buffer_load_dwordx4 v[160:163], v2, s[60:63], s16 offen offset:0 sc1
  s_waitcnt lgkmcnt(0)
  v_mfma_f32_16x16x32_bf16 v[52:55], a[4:7], v[128:131], 0
  v_add_f32 v208, v192, v208
  v_add_f32 v209, v193, v209
  v_mfma_f32_16x16x32_bf16 v[56:59], a[8:11], v[128:131], 0
  v_add_f32 v210, v194, v210
  v_add_f32 v211, v195, v211
  v_mfma_f32_16x16x32_bf16 v[60:63], a[12:15], v[128:131], 0
  v_cvt_pk_bf16_f32 v208, v208, v209
  v_cvt_pk_bf16_f32 v209, v210, v211
  v_mfma_f32_16x16x32_bf16 v[64:67], a[16:19], v[128:131], 0
  buffer_store_dwordx2 v[208:209], v246, s[52:55], s50 offen offset:0 sc1
  s_waitcnt vmcnt(8)
  v_mfma_f32_16x16x32_bf16 v[48:51], a[20:23], v[132:135], v[48:51]
  buffer_load_dwordx4 v[164:167], v2, s[60:63], s16 offen offset:1024 sc1
  v_add_f32 v212, v196, v212
  v_mfma_f32_16x16x32_bf16 v[52:55], a[24:27], v[132:135], v[52:55]
  v_add_f32 v213, v197, v213
  v_add_f32 v214, v198, v214
  v_mfma_f32_16x16x32_bf16 v[56:59], a[28:31], v[132:135], v[56:59]
  v_add_f32_e64 v215, v199, v215
  v_cvt_pk_bf16_f32 v212, v212, v213
  v_mfma_f32_16x16x32_bf16 v[60:63], a[32:35], v[132:135], v[60:63]
  v_cvt_pk_bf16_f32 v213, v214, v215
  buffer_store_dwordx2 v[212:213], v246, s[52:55], s50 offen offset:512 sc1
  v_mfma_f32_16x16x32_bf16 v[64:67], a[36:39], v[132:135], v[64:67]
  v_add_f32 v216, v200, v216
  s_waitcnt vmcnt(9)
  v_mfma_f32_16x16x32_bf16 v[48:51], a[40:43], v[136:139], v[48:51]
  buffer_load_dwordx4 v[168:171], v2, s[60:63], s17 offen offset:0 sc1
  v_add_f32_e64 v217, v201, v217
  v_mfma_f32_16x16x32_bf16 v[52:55], a[44:47], v[136:139], v[52:55]
  v_add_f32 v218, v202, v218
  v_add_f32 v219, v203, v219
  v_mfma_f32_16x16x32_bf16 v[56:59], a[48:51], v[136:139], v[56:59]
  v_cvt_pk_bf16_f32 v216, v216, v217
  v_cvt_pk_bf16_f32 v217, v218, v219
  v_mfma_f32_16x16x32_bf16 v[60:63], a[52:55], v[136:139], v[60:63]
  buffer_store_dwordx2 v[216:217], v246, s[52:55], s50 offen offset:1024 sc1
  v_add_f32_e64 v220, v204, v220
  v_mfma_f32_16x16x32_bf16 v[64:67], a[56:59], v[136:139], v[64:67]
  v_add_f32 v221, v205, v221
  s_waitcnt vmcnt(10)
  v_mfma_f32_16x16x32_bf16 v[48:51], a[60:63], v[140:143], v[48:51]
  buffer_load_dwordx4 v[172:175], v2, s[60:63], s17 offen offset:1024 sc1
  v_add_f32_e64 v222, v206, v222
  v_mfma_f32_16x16x32_bf16 v[52:55], a[64:67], v[140:143], v[52:55]
  v_add_f32_e64 v223, v207, v223
  v_cvt_pk_bf16_f32 v220, v220, v221
  v_mfma_f32_16x16x32_bf16 v[56:59], a[68:71], v[140:143], v[56:59]
  v_cvt_pk_bf16_f32 v221, v222, v223
  buffer_store_dwordx2 v[220:221], v246, s[52:55], s50 offen offset:1536 sc1
  v_mfma_f32_16x16x32_bf16 v[60:63], a[72:75], v[140:143], v[60:63]
  v_dot2_f32_bf16 v224, v97, s45, v224
  v_dot2_f32_bf16 v225, v97, s25, v225
  v_mfma_f32_16x16x32_bf16 v[64:67], a[76:79], v[140:143], v[64:67]
  v_dot2_f32_bf16 v226, v96, s45, v226
  s_waitcnt vmcnt(11)
  v_mfma_f32_16x16x32_bf16 v[48:51], a[80:83], v[144:147], v[48:51]
  buffer_load_dwordx4 v[176:179], v2, s[60:63], s17 offen offset:2048 sc1
  v_dot2_f32_bf16 v227, v96, s25, v227
  v_mfma_f32_16x16x32_bf16 v[52:55], a[84:87], v[144:147], v[52:55]
  v_add_f32 v228, v228, v232
  v_add_f32_e64 v229, v229, v233
  v_mfma_f32_16x16x32_bf16 v[56:59], a[88:91], v[144:147], v[56:59]
  v_add_f32 v230, v230, v234
  v_add_f32 v231, v231, v235
  v_mfma_f32_16x16x32_bf16 v[60:63], a[92:95], v[144:147], v[60:63]
  v_add_f32 v224, v224, v236
  v_add_f32 v225, v225, v237
  v_mfma_f32_16x16x32_bf16 v[64:67], a[96:99], v[144:147], v[64:67]
  v_add_f32 v226, v226, v238
  s_waitcnt vmcnt(11)
  v_mfma_f32_16x16x32_bf16 v[48:51], a[100:103], v[148:151], v[48:51]
  buffer_load_dwordx4 v[180:183], v2, s[60:63], s17 offen offset:3072 sc1
  v_add_f32_e64 v227, v227, v239
  v_mfma_f32_16x16x32_bf16 v[52:55], a[104:107], v[148:151], v[52:55]
  v_add_f32 v224, v224, v228
  v_add_f32 v225, v225, v229
  v_mfma_f32_16x16x32_bf16 v[56:59], a[108:111], v[148:151], v[56:59]
  v_add_f32 v226, v226, v230
  v_add_f32 v227, v227, v231
  v_mfma_f32_16x16x32_bf16 v[60:63], a[112:115], v[148:151], v[60:63]
  v_cvt_pk_bf16_f32 v224, v224, v225
  v_cvt_pk_bf16_f32 v225, v226, v227
  v_mfma_f32_16x16x32_bf16 v[64:67], a[116:119], v[148:151], v[64:67]
  buffer_store_dwordx2 v[224:225], v246, s[52:55], s51 offen sc1
  s_waitcnt vmcnt(12)
  v_mfma_f32_16x16x32_bf16 v[48:51], a[120:123], v[152:155], v[48:51]
  s_add_u32 s17, s17, 4096
  buffer_load_dwordx4 v[184:187], v2, s[60:63], s17 offen offset:0 sc1
  s_barrier
  v_mfma_f32_16x16x32_bf16 v[52:55], a[124:127], v[152:155], v[52:55]
  v_accvgpr_read_b32 v102, a226
  v_accvgpr_read_b32 v103, a227
  v_mfma_f32_16x16x32_bf16 v[56:59], a[128:131], v[152:155], v[56:59]
  v_mul_f32_e64 v102, v102, v103
  v_accvgpr_read_b32 v98, a216
  v_mfma_f32_16x16x32_bf16 v[60:63], a[132:135], v[152:155], v[60:63]
  v_accvgpr_read_b32 v100, a230
  v_accvgpr_read_b32 v99, a217
  v_mfma_f32_16x16x32_bf16 v[64:67], a[136:139], v[152:155], v[64:67]
  v_accvgpr_read_b32 v101, a231
  v_lshlrev_b32 v108, 16, v98
  s_waitcnt vmcnt(12)
  v_mfma_f32_16x16x32_bf16 v[48:51], a[140:143], v[156:159], v[48:51]
  buffer_load_dwordx4 v[188:191], v2, s[60:63], s17 offen offset:1024 sc1
  v_and_b32 v109, 0xffff0000, v98
  v_mfma_f32_16x16x32_bf16 v[52:55], a[144:147], v[156:159], v[52:55]
  v_lshlrev_b32_e64 v110, 16, v99
  v_and_b32 v111, 0xffff0000, v99
  v_mfma_f32_16x16x32_bf16 v[56:59], a[148:151], v[156:159], v[56:59]
  v_lshlrev_b32_e64 v92, 16, v100
  v_and_b32 v93, 0xffff0000, v100
  v_mfma_f32_16x16x32_bf16 v[60:63], a[152:155], v[156:159], v[60:63]
  v_lshlrev_b32_e64 v94, 16, v101
  v_and_b32 v95, 0xffff0000, v101
  v_mfma_f32_16x16x32_bf16 v[64:67], a[156:159], v[156:159], v[64:67]
  v_fma_f32 v88, v108, v103, -v102
  s_waitcnt vmcnt(12)
  v_mfma_f32_16x16x32_bf16 v[48:51], a[160:163], v[160:163], v[48:51]
  buffer_load_dwordx4 v[128:131], v2, s[60:63], s17 offen offset:2048 sc1
  v_fma_f32 v89, v109, v103, -v102
  v_mfma_f32_16x16x32_bf16 v[52:55], a[164:167], v[160:163], v[52:55]
  v_fma_f32 v90, v110, v103, -v102
  v_fma_f32 v91, v111, v103, -v102
  v_mfma_f32_16x16x32_bf16 v[56:59], a[168:171], v[160:163], v[56:59]
  v_fmac_f32 v108, v88, v92
  v_fmac_f32_e64 v109, v89, v93
  v_mfma_f32_16x16x32_bf16 v[60:63], a[172:175], v[160:163], v[60:63]
  v_fmac_f32 v110, v90, v94
  v_fmac_f32 v111, v91, v95
  v_mfma_f32_16x16x32_bf16 v[64:67], a[176:179], v[160:163], v[64:67]
  v_accvgpr_read_b32 v98, a218
  s_waitcnt vmcnt(11)
  v_mfma_f32_16x16x32_bf16 v[48:51], a[180:183], v[164:167], v[48:51]
  buffer_load_dwordx4 v[132:135], v2, s[60:63], s17 offen offset:3072 sc1
  v_accvgpr_read_b32 v100, a232
  v_mfma_f32_16x16x32_bf16 v[52:55], a[184:187], v[164:167], v[52:55]
  v_accvgpr_read_b32 v99, a219
  v_accvgpr_read_b32 v101, a233
  v_mfma_f32_16x16x32_bf16 v[56:59], a[188:191], v[164:167], v[56:59]
  v_lshlrev_b32 v112, 16, v98
  v_and_b32 v113, 0xffff0000, v98
  v_mfma_f32_16x16x32_bf16 v[60:63], a[192:195], v[164:167], v[60:63]
  v_lshlrev_b32_e64 v114, 16, v99
  v_and_b32 v115, 0xffff0000, v99
  v_mfma_f32_16x16x32_bf16 v[64:67], a[196:199], v[164:167], v[64:67]
  v_lshlrev_b32 v92, 16, v100
  s_waitcnt vmcnt(10)
  v_mfma_f32_16x16x32_bf16 v[68:71], a[0:3], v[168:171], 0
  s_add_u32 s17, s17, 4096
  buffer_load_dwordx4 v[136:139], v2, s[60:63], s17 offen offset:0 sc1
  v_and_b32 v93, 0xffff0000, v100
  v_mfma_f32_16x16x32_bf16 v[72:75], a[4:7], v[168:171], 0
  v_lshlrev_b32_e64 v94, 16, v101
  v_and_b32 v95, 0xffff0000, v101
  v_mfma_f32_16x16x32_bf16 v[76:79], a[8:11], v[168:171], 0
  v_fma_f32 v88, v112, v103, -v102
  v_fma_f32 v89, v113, v103, -v102
  v_mfma_f32_16x16x32_bf16 v[80:83], a[12:15], v[168:171], 0
  v_fma_f32 v90, v114, v103, -v102
  v_fma_f32 v91, v115, v103, -v102
  v_mfma_f32_16x16x32_bf16 v[84:87], a[16:19], v[168:171], 0
  v_fmac_f32 v112, v88, v92
  s_waitcnt vmcnt(9)
  v_mfma_f32_16x16x32_bf16 v[68:71], a[20:23], v[172:175], v[68:71]
  ds_write_b128 v44, v[48:51] offset:0
  ds_write_b128 v44, v[52:55] offset:1024
  buffer_load_dwordx4 v[140:143], v2, s[60:63], s17 offen offset:1024 sc1
  v_mfma_f32_16x16x32_bf16 v[72:75], a[24:27], v[172:175], v[72:75]
  v_fmac_f32 v113, v89, v93
  v_fmac_f32 v114, v90, v94
  v_mfma_f32_16x16x32_bf16 v[76:79], a[28:31], v[172:175], v[76:79]
  v_fmac_f32_e64 v115, v91, v95
  v_accvgpr_read_b32 v98, a220
  v_mfma_f32_16x16x32_bf16 v[80:83], a[32:35], v[172:175], v[80:83]
  v_accvgpr_read_b32 v100, a234
  v_accvgpr_read_b32 v99, a221
  v_mfma_f32_16x16x32_bf16 v[84:87], a[36:39], v[172:175], v[84:87]
  v_accvgpr_read_b32 v101, a235
  v_lshlrev_b32 v116, 16, v98
  s_waitcnt vmcnt(8)
  v_mfma_f32_16x16x32_bf16 v[68:71], a[40:43], v[176:179], v[68:71]
  ds_write_b128 v44, v[56:59] offset:2048
  ds_write_b128 v44, v[60:63] offset:3072
  buffer_load_dwordx4 v[144:147], v2, s[60:63], s18 offen offset:0 sc1
  v_mfma_f32_16x16x32_bf16 v[72:75], a[44:47], v[176:179], v[72:75]
  v_and_b32 v117, 0xffff0000, v98
  v_lshlrev_b32_e64 v118, 16, v99
  v_mfma_f32_16x16x32_bf16 v[76:79], a[48:51], v[176:179], v[76:79]
  v_and_b32 v119, 0xffff0000, v99
  v_lshlrev_b32_e64 v92, 16, v100
  v_mfma_f32_16x16x32_bf16 v[80:83], a[52:55], v[176:179], v[80:83]
  v_and_b32 v93, 0xffff0000, v100
  v_lshlrev_b32_e64 v94, 16, v101
  v_mfma_f32_16x16x32_bf16 v[84:87], a[56:59], v[176:179], v[84:87]
  v_and_b32 v95, 0xffff0000, v101
  v_fma_f32 v88, v116, v103, -v102
  s_waitcnt vmcnt(8)
  v_mfma_f32_16x16x32_bf16 v[68:71], a[60:63], v[180:183], v[68:71]
  ds_write_b128 v44, v[64:67] offset:4096
  buffer_load_dwordx4 v[148:151], v2, s[60:63], s18 offen offset:1024 sc1
  v_mfma_f32_16x16x32_bf16 v[72:75], a[64:67], v[180:183], v[72:75]
  v_fma_f32 v89, v117, v103, -v102
  v_fma_f32 v90, v118, v103, -v102
  v_mfma_f32_16x16x32_bf16 v[76:79], a[68:71], v[180:183], v[76:79]
  v_fma_f32 v91, v119, v103, -v102
  v_fmac_f32 v116, v88, v92
  v_mfma_f32_16x16x32_bf16 v[80:83], a[72:75], v[180:183], v[80:83]
  v_fmac_f32 v117, v89, v93
  v_fmac_f32 v118, v90, v94
  v_mfma_f32_16x16x32_bf16 v[84:87], a[76:79], v[180:183], v[84:87]
  v_fmac_f32_e64 v119, v91, v95
  v_accvgpr_read_b32 v98, a222
  s_waitcnt vmcnt(7)
  v_mfma_f32_16x16x32_bf16 v[68:71], a[80:83], v[184:187], v[68:71]
  buffer_load_dwordx4 v[152:155], v2, s[60:63], s18 offen offset:2048 sc1
  v_accvgpr_read_b32 v100, a236
  v_mfma_f32_16x16x32_bf16 v[72:75], a[84:87], v[184:187], v[72:75]
  v_accvgpr_read_b32 v99, a223
  v_accvgpr_read_b32 v101, a237
  v_mfma_f32_16x16x32_bf16 v[76:79], a[88:91], v[184:187], v[76:79]
  v_lshlrev_b32 v120, 16, v98
  v_and_b32 v121, 0xffff0000, v98
  v_mfma_f32_16x16x32_bf16 v[80:83], a[92:95], v[184:187], v[80:83]
  v_lshlrev_b32_e64 v122, 16, v99
  v_and_b32 v123, 0xffff0000, v99
  v_mfma_f32_16x16x32_bf16 v[84:87], a[96:99], v[184:187], v[84:87]
  v_lshlrev_b32 v92, 16, v100
  s_waitcnt vmcnt(7)
  v_mfma_f32_16x16x32_bf16 v[68:71], a[100:103], v[188:191], v[68:71]
  buffer_load_dwordx4 v[156:159], v2, s[60:63], s18 offen offset:3072 sc1
  v_and_b32 v93, 0xffff0000, v100
  v_mfma_f32_16x16x32_bf16 v[72:75], a[104:107], v[188:191], v[72:75]
  v_lshlrev_b32_e64 v94, 16, v101
  v_and_b32 v95, 0xffff0000, v101
  v_mfma_f32_16x16x32_bf16 v[76:79], a[108:111], v[188:191], v[76:79]
  v_fma_f32 v88, v120, v103, -v102
  v_fma_f32 v89, v121, v103, -v102
  v_mfma_f32_16x16x32_bf16 v[80:83], a[112:115], v[188:191], v[80:83]
  v_fma_f32 v90, v122, v103, -v102
  v_fma_f32 v91, v123, v103, -v102
  v_mfma_f32_16x16x32_bf16 v[84:87], a[116:119], v[188:191], v[84:87]
  v_fmac_f32 v120, v88, v92
  s_waitcnt vmcnt(7)
  v_mfma_f32_16x16x32_bf16 v[68:71], a[120:123], v[128:131], v[68:71]
  s_add_u32 s18, s18, 4096
  buffer_load_dwordx4 v[160:163], v2, s[60:63], s18 offen offset:0 sc1
  v_fmac_f32 v121, v89, v93
  v_fmac_f32 v122, v90, v94
  v_mfma_f32_16x16x32_bf16 v[72:75], a[124:127], v[128:131], v[72:75]
  v_fmac_f32_e64 v123, v91, v95
  v_accvgpr_read_b32 v98, a224
  v_accvgpr_read_b32 v100, a238
  v_mfma_f32_16x16x32_bf16 v[76:79], a[128:131], v[128:131], v[76:79]
  v_accvgpr_read_b32 v99, a225
  v_accvgpr_read_b32 v101, a239
  v_mfma_f32_16x16x32_bf16 v[80:83], a[132:135], v[128:131], v[80:83]
  v_lshlrev_b32_e64 v124, 16, v98
  s_mul_i32 s15, s7, 10240
  v_mfma_f32_16x16x32_bf16 v[84:87], a[136:139], v[128:131], v[84:87]
  s_add_u32 s15, s15, 102400
  v_add_u32 v47, s15, v2
  s_waitcnt vmcnt(7)
  v_mfma_f32_16x16x32_bf16 v[68:71], a[140:143], v[132:135], v[68:71]
  buffer_load_dwordx4 v[164:167], v2, s[60:63], s18 offen offset:1024 sc1
  v_and_b32 v125, 0xffff0000, v98
  v_mfma_f32_16x16x32_bf16 v[72:75], a[144:147], v[132:135], v[72:75]
  v_lshlrev_b32_e64 v126, 16, v99
  v_and_b32 v127, 0xffff0000, v99
  v_mfma_f32_16x16x32_bf16 v[76:79], a[148:151], v[132:135], v[76:79]
  v_lshlrev_b32_e64 v92, 16, v100
  v_and_b32 v93, 0xffff0000, v100
  v_mfma_f32_16x16x32_bf16 v[80:83], a[152:155], v[132:135], v[80:83]
  v_lshlrev_b32_e64 v94, 16, v101
  v_and_b32 v95, 0xffff0000, v101
  v_mfma_f32_16x16x32_bf16 v[84:87], a[156:159], v[132:135], v[84:87]
  v_fma_f32 v88, v124, v103, -v102
  s_waitcnt vmcnt(7)
  v_mfma_f32_16x16x32_bf16 v[68:71], a[160:163], v[136:139], v[68:71]
  buffer_load_dwordx4 v[168:171], v2, s[60:63], s18 offen offset:2048 sc1
  v_fma_f32 v89, v125, v103, -v102
  v_mfma_f32_16x16x32_bf16 v[72:75], a[164:167], v[136:139], v[72:75]
  v_fma_f32 v90, v126, v103, -v102
  v_fma_f32 v91, v127, v103, -v102
  v_mfma_f32_16x16x32_bf16 v[76:79], a[168:171], v[136:139], v[76:79]
  v_fmac_f32 v124, v88, v92
  v_fmac_f32_e64 v125, v89, v93
  v_mfma_f32_16x16x32_bf16 v[80:83], a[172:175], v[136:139], v[80:83]
  v_fmac_f32_e64 v126, v90, v94
  v_mfma_f32_16x16x32_bf16 v[84:87], a[176:179], v[136:139], v[84:87]
  v_fmac_f32 v127, v91, v95
  s_waitcnt vmcnt(7)
  v_mfma_f32_16x16x32_bf16 v[68:71], a[180:183], v[140:143], v[68:71]
  buffer_load_dwordx4 v[172:175], v2, s[60:63], s18 offen offset:3072 sc1
  v_mfma_f32_16x16x32_bf16 v[72:75], a[184:187], v[140:143], v[72:75]
  v_mfma_f32_16x16x32_bf16 v[76:79], a[188:191], v[140:143], v[76:79]
  v_mfma_f32_16x16x32_bf16 v[80:83], a[192:195], v[140:143], v[80:83]
  v_mfma_f32_16x16x32_bf16 v[84:87], a[196:199], v[140:143], v[84:87]
  s_waitcnt vmcnt(7)
  v_mfma_f32_16x16x32_bf16 v[48:51], a[0:3], v[144:147], 0
  s_add_u32 s18, s18, 4096
  buffer_load_dwordx4 v[176:179], v2, s[60:63], s18 offen offset:0 sc1
  v_mfma_f32_16x16x32_bf16 v[52:55], a[4:7], v[144:147], 0
  v_mfma_f32_16x16x32_bf16 v[56:59], a[8:11], v[144:147], 0
  v_mfma_f32_16x16x32_bf16 v[60:63], a[12:15], v[144:147], 0
  v_mfma_f32_16x16x32_bf16 v[64:67], a[16:19], v[144:147], 0
  s_waitcnt vmcnt(7)
  v_mfma_f32_16x16x32_bf16 v[48:51], a[20:23], v[148:151], v[48:51]
  ds_write_b128 v45, v[68:71] offset:0
  v_mfma_f32_16x16x32_bf16 v[52:55], a[24:27], v[148:151], v[52:55]
  ds_write_b128 v45, v[72:75] offset:1024
  v_mfma_f32_16x16x32_bf16 v[56:59], a[28:31], v[148:151], v[56:59]
  buffer_load_dwordx4 v[180:183], v2, s[60:63], s18 offen offset:1024 sc1
  v_mfma_f32_16x16x32_bf16 v[60:63], a[32:35], v[148:151], v[60:63]
  v_mfma_f32_16x16x32_bf16 v[64:67], a[36:39], v[148:151], v[64:67]
  s_waitcnt vmcnt(7)
  v_mfma_f32_16x16x32_bf16 v[48:51], a[40:43], v[152:155], v[48:51]
  ds_write_b128 v45, v[76:79] offset:2048
  v_mfma_f32_16x16x32_bf16 v[52:55], a[44:47], v[152:155], v[52:55]
  ds_write_b128 v45, v[80:83] offset:3072
  v_mfma_f32_16x16x32_bf16 v[56:59], a[48:51], v[152:155], v[56:59]
  buffer_load_dwordx4 v[184:187], v2, s[60:63], s19 offen offset:0 sc1
  v_mfma_f32_16x16x32_bf16 v[60:63], a[52:55], v[152:155], v[60:63]
  v_mfma_f32_16x16x32_bf16 v[64:67], a[56:59], v[152:155], v[64:67]
  s_waitcnt vmcnt(7)
  v_mfma_f32_16x16x32_bf16 v[48:51], a[60:63], v[156:159], v[48:51]
  ds_write_b128 v45, v[84:87] offset:4096
  v_mfma_f32_16x16x32_bf16 v[52:55], a[64:67], v[156:159], v[52:55]
  buffer_load_dwordx4 v[188:191], v2, s[60:63], s19 offen offset:1024 sc1
  v_mfma_f32_16x16x32_bf16 v[56:59], a[68:71], v[156:159], v[56:59]
  v_mfma_f32_16x16x32_bf16 v[60:63], a[72:75], v[156:159], v[60:63]
  v_mfma_f32_16x16x32_bf16 v[64:67], a[76:79], v[156:159], v[64:67]
  s_waitcnt vmcnt(7)
  v_mfma_f32_16x16x32_bf16 v[48:51], a[80:83], v[160:163], v[48:51]
  buffer_load_dwordx4 v[128:131], v2, s[60:63], s19 offen offset:2048 sc1
  s_waitcnt lgkmcnt(0)
  s_barrier
  v_mfma_f32_16x16x32_bf16 v[52:55], a[84:87], v[160:163], v[52:55]
  ds_read_b128 v[192:195], v47 offset:0
  ds_read_b128 v[196:199], v47 offset:1024
  v_mfma_f32_16x16x32_bf16 v[56:59], a[88:91], v[160:163], v[56:59]
  ds_read_b128 v[200:203], v47 offset:2048
  ds_read_b128 v[204:207], v47 offset:3072
  v_mfma_f32_16x16x32_bf16 v[60:63], a[92:95], v[160:163], v[60:63]
  ds_read_b128 v[208:211], v47 offset:4096
  ds_read_b128 v[212:215], v47 offset:5120
  v_mfma_f32_16x16x32_bf16 v[64:67], a[96:99], v[160:163], v[64:67]
  ds_read_b128 v[216:219], v47 offset:6144
  ds_read_b128 v[220:223], v47 offset:7168
  s_waitcnt vmcnt(7)
  v_mfma_f32_16x16x32_bf16 v[48:51], a[100:103], v[164:167], v[48:51]
  buffer_load_dwordx4 v[132:135], v2, s[60:63], s19 offen offset:3072 sc1
  ds_read_b128 v[224:227], v47 offset:8192
  v_mfma_f32_16x16x32_bf16 v[52:55], a[104:107], v[164:167], v[52:55]
  ds_read_b128 v[228:231], v47 offset:9216
  s_waitcnt lgkmcnt(5)
  v_mfma_f32_16x16x32_bf16 v[56:59], a[108:111], v[164:167], v[56:59]
  v_add_f32 v108, v108, v192
  v_add_f32_e64 v109, v109, v193
  v_mfma_f32_16x16x32_bf16 v[60:63], a[112:115], v[164:167], v[60:63]
  v_add_f32 v110, v110, v194
  v_add_f32 v111, v111, v195
  v_mfma_f32_16x16x32_bf16 v[64:67], a[116:119], v[164:167], v[64:67]
  v_add_f32 v112, v112, v196
  v_add_f32 v113, v113, v197
  s_waitcnt vmcnt(7)
  v_mfma_f32_16x16x32_bf16 v[48:51], a[120:123], v[168:171], v[48:51]
  s_add_u32 s19, s19, 4096
  buffer_load_dwordx4 v[136:139], v2, s[60:63], s19 offen offset:0 sc1
  v_add_f32 v114, v114, v198
  v_mfma_f32_16x16x32_bf16 v[52:55], a[124:127], v[168:171], v[52:55]
  v_add_f32 v115, v115, v199
  v_add_f32 v116, v116, v200
  v_mfma_f32_16x16x32_bf16 v[56:59], a[128:131], v[168:171], v[56:59]
  v_add_f32 v117, v117, v201
  v_add_f32 v118, v118, v202
  v_mfma_f32_16x16x32_bf16 v[60:63], a[132:135], v[168:171], v[60:63]
  v_add_f32 v119, v119, v203
  v_add_f32 v120, v120, v204
  v_mfma_f32_16x16x32_bf16 v[64:67], a[136:139], v[168:171], v[64:67]
  v_add_f32 v121, v121, v205
  v_add_f32 v122, v122, v206
  s_waitcnt vmcnt(7)
  v_mfma_f32_16x16x32_bf16 v[48:51], a[140:143], v[172:175], v[48:51]
  buffer_load_dwordx4 v[140:143], v2, s[60:63], s19 offen offset:1024 sc1
  s_mul_i32 s93, s6, 327680
  s_lshl_b32 s12, s5, 7
  s_add_u32 s93, s93, s12
  v_mfma_f32_16x16x32_bf16 v[52:55], a[144:147], v[172:175], v[52:55]
  s_lshr_b32 s12, s7, 1
  s_mul_i32 s94, s12, 5120
  s_add_u32 s94, s94, 143360
  s_lshl_b32 s12, s12, 6
  v_mfma_f32_16x16x32_bf16 v[56:59], a[148:151], v[172:175], v[56:59]
  s_add_u32 s93, s93, s12
  s_add_u32 s93, s93, 19922944
  s_mov_b32 s92, s93
  v_add_f32 v123, v123, v207
  v_mfma_f32_16x16x32_bf16 v[60:63], a[152:155], v[172:175], v[60:63]
  v_add_f32 v124, v124, v208
  v_add_f32 v125, v125, v209
  v_add_f32 v126, v126, v210
  v_add_f32 v127, v127, v211
  v_mfma_f32_16x16x32_bf16 v[64:67], a[156:159], v[172:175], v[64:67]
  s_waitcnt lgkmcnt(0)
  v_add_f32 v108, v108, v212
  v_add_f32 v109, v109, v213
  v_add_f32 v110, v110, v214
  s_waitcnt vmcnt(7)
  v_mfma_f32_16x16x32_bf16 v[48:51], a[160:163], v[176:179], v[48:51]
  buffer_load_dwordx4 v[144:147], v2, s[60:63], s19 offen offset:2048 sc1
  s_and_b32 s12, s7, 1
  s_mul_i32 s13, s12, 196608
  s_add_u32 s93, s93, s13
  s_mul_i32 s13, s12, 3072
  v_mfma_f32_16x16x32_bf16 v[52:55], a[164:167], v[176:179], v[52:55]
  s_add_u32 s95, s94, s13
  s_lshl_b32 s12, s12, 3
  s_add_u32 s94, s94, s12
  v_lshrrev_b32_e64 v252, 2, v1
  v_mfma_f32_16x16x32_bf16 v[56:59], a[168:171], v[176:179], v[56:59]
  v_lshlrev_b32 v252, 12, v252
  v_and_b32 v12, 3, v1
  v_lshl_add_u32 v252, v12, 4, v252
  v_add_f32_e64 v111, v111, v215
  v_mfma_f32_16x16x32_bf16 v[60:63], a[172:175], v[176:179], v[60:63]
  v_add_f32 v112, v112, v216
  v_add_f32 v113, v113, v217
  v_add_f32 v114, v114, v218
  v_add_f32 v115, v115, v219
  v_mfma_f32_16x16x32_bf16 v[64:67], a[176:179], v[176:179], v[64:67]
  v_add_f32 v116, v116, v220
  v_add_f32 v117, v117, v221
  v_add_f32 v118, v118, v222
  v_add_f32 v119, v119, v223
  s_waitcnt vmcnt(7)
  v_mfma_f32_16x16x32_bf16 v[48:51], a[180:183], v[180:183], v[48:51]
  buffer_load_dwordx4 v[148:151], v2, s[60:63], s19 offen offset:3072 sc1
  v_add_f32 v120, v120, v224
  v_mfma_f32_16x16x32_bf16 v[52:55], a[184:187], v[180:183], v[52:55]
  v_add_f32 v121, v121, v225
  v_add_f32 v122, v122, v226
  v_mfma_f32_16x16x32_bf16 v[56:59], a[188:191], v[180:183], v[56:59]
  v_add_f32 v123, v123, v227
  v_add_f32 v124, v124, v228
  v_mfma_f32_16x16x32_bf16 v[60:63], a[192:195], v[180:183], v[60:63]
  v_add_f32 v125, v125, v229
  v_add_f32 v126, v126, v230
  v_mfma_f32_16x16x32_bf16 v[64:67], a[196:199], v[180:183], v[64:67]
  v_add_f32 v127, v127, v231
  s_waitcnt vmcnt(7)
  v_mfma_f32_16x16x32_bf16 v[68:71], a[0:3], v[184:187], v[108:111]
  s_add_u32 s19, s19, 4096
  buffer_load_dwordx4 v[152:155], v2, s[60:63], s19 offen offset:0 sc1
  v_mfma_f32_16x16x32_bf16 v[72:75], a[4:7], v[184:187], v[112:115]
  v_mfma_f32_16x16x32_bf16 v[76:79], a[8:11], v[184:187], v[116:119]
  v_mfma_f32_16x16x32_bf16 v[80:83], a[12:15], v[184:187], v[120:123]
  v_mfma_f32_16x16x32_bf16 v[84:87], a[16:19], v[184:187], v[124:127]
  s_waitcnt vmcnt(7)
  v_mfma_f32_16x16x32_bf16 v[68:71], a[20:23], v[188:191], v[68:71]
  ds_write_b128 v46, v[48:51] offset:0
  v_mfma_f32_16x16x32_bf16 v[72:75], a[24:27], v[188:191], v[72:75]
  ds_write_b128 v46, v[52:55] offset:1024
  v_mfma_f32_16x16x32_bf16 v[76:79], a[28:31], v[188:191], v[76:79]
  buffer_load_dwordx4 v[156:159], v2, s[60:63], s19 offen offset:1024 sc1
  v_mfma_f32_16x16x32_bf16 v[80:83], a[32:35], v[188:191], v[80:83]
  v_mfma_f32_16x16x32_bf16 v[84:87], a[36:39], v[188:191], v[84:87]
  s_waitcnt vmcnt(7)
  v_mfma_f32_16x16x32_bf16 v[68:71], a[40:43], v[128:131], v[68:71]
  ds_write_b128 v46, v[56:59] offset:2048
  v_mfma_f32_16x16x32_bf16 v[72:75], a[44:47], v[128:131], v[72:75]
  ds_write_b128 v46, v[60:63] offset:3072
  v_mfma_f32_16x16x32_bf16 v[76:79], a[48:51], v[128:131], v[76:79]
  s_add_u32 m0, s95, 0
  s_nop 0
  buffer_load_dwordx4 v252, s[52:55], s93 offen sc1 lds
  s_add_u32 s93, s93, 65536
  v_mfma_f32_16x16x32_bf16 v[80:83], a[52:55], v[128:131], v[80:83]
  s_add_u32 m0, s95, 1024
  s_nop 0
  buffer_load_dwordx4 v252, s[52:55], s93 offen sc1 lds
  s_add_u32 s93, s93, 65536
  v_mfma_f32_16x16x32_bf16 v[84:87], a[56:59], v[128:131], v[84:87]
  s_add_u32 m0, s95, 2048
  s_bitcmp1_b32 s7, 0
  s_cselect_b32 s93, 1879048192, s93
  s_cselect_b32 m0, 163840, m0
  s_nop 0
  buffer_load_dwordx4 v252, s[52:55], s93 offen sc1 lds
  s_add_u32 s93, s93, 65536
  s_waitcnt vmcnt(9)
  v_mfma_f32_16x16x32_bf16 v[68:71], a[60:63], v[132:135], v[68:71]
  ds_write_b128 v46, v[64:67] offset:4096
  v_mfma_f32_16x16x32_bf16 v[72:75], a[64:67], v[132:135], v[72:75]
  v_add_u32_e64 v253, s94, v2
  v_mfma_f32_16x16x32_bf16 v[76:79], a[68:71], v[132:135], v[76:79]
  v_mfma_f32_16x16x32_bf16 v[80:83], a[72:75], v[132:135], v[80:83]
  v_mfma_f32_16x16x32_bf16 v[84:87], a[76:79], v[132:135], v[84:87]
  s_waitcnt vmcnt(8)
  v_mfma_f32_16x16x32_bf16 v[68:71], a[80:83], v[136:139], v[68:71]
  s_mul_i32 s15, s7, 5120
  v_mfma_f32_16x16x32_bf16 v[72:75], a[84:87], v[136:139], v[72:75]
  v_add_u32 v47, s15, v2
  v_mfma_f32_16x16x32_bf16 v[76:79], a[88:91], v[136:139], v[76:79]
  v_mfma_f32_16x16x32_bf16 v[80:83], a[92:95], v[136:139], v[80:83]
  v_mfma_f32_16x16x32_bf16 v[84:87], a[96:99], v[136:139], v[84:87]
  s_waitcnt vmcnt(7)
  v_mfma_f32_16x16x32_bf16 v[68:71], a[100:103], v[140:143], v[68:71]
  s_waitcnt lgkmcnt(0)
  s_barrier
  ds_read_b128 v[192:195], v47 offset:0
  v_mfma_f32_16x16x32_bf16 v[72:75], a[104:107], v[140:143], v[72:75]
  ds_read_b128 v[196:199], v47 offset:1024
  v_mfma_f32_16x16x32_bf16 v[76:79], a[108:111], v[140:143], v[76:79]
  ds_read_b128 v[200:203], v47 offset:2048
  v_mfma_f32_16x16x32_bf16 v[80:83], a[112:115], v[140:143], v[80:83]
  ds_read_b128 v[204:207], v47 offset:3072
  v_mfma_f32_16x16x32_bf16 v[84:87], a[116:119], v[140:143], v[84:87]
  ds_read_b128 v[208:211], v47 offset:4096
  s_waitcnt vmcnt(6)
  v_mfma_f32_16x16x32_bf16 v[68:71], a[120:123], v[144:147], v[68:71]
  s_lshr_b32 s88, s8, 0
  s_lshr_b32 s89, s8, 8
  v_mfma_f32_16x16x32_bf16 v[72:75], a[124:127], v[144:147], v[72:75]
  s_lshr_b32 s90, s8, 16
  s_lshr_b32 s91, s8, 24
  v_mfma_f32_16x16x32_bf16 v[76:79], a[128:131], v[144:147], v[76:79]
  v_mov_b32 v246, 0xff
  v_mfma_f32_16x16x32_bf16 v[80:83], a[132:135], v[144:147], v[80:83]
  v_accvgpr_read_b32 v244, a243
  v_mfma_f32_16x16x32_bf16 v[84:87], a[136:139], v[144:147], v[84:87]
  v_accvgpr_read_b32 v245, a244
  s_waitcnt vmcnt(5)
  v_mfma_f32_16x16x32_bf16 v[68:71], a[140:143], v[148:151], v[68:71]
  s_lshl_b32 s12, s5, 15
  s_lshl_b32 s13, s7, 9
  v_mfma_f32_16x16x32_bf16 v[72:75], a[144:147], v[148:151], v[72:75]
  s_add_u32 s12, s12, s13
  v_mfma_f32_16x16x32_bf16 v[76:79], a[148:151], v[148:151], v[76:79]
  s_add_u32 s12, s12, 1310720
  v_mfma_f32_16x16x32_bf16 v[80:83], a[152:155], v[148:151], v[80:83]
  s_lshl_b32 s13, s6, 12
  v_mfma_f32_16x16x32_bf16 v[84:87], a[156:159], v[148:151], v[84:87]
  s_add_u32 s13, s13, s12
  s_waitcnt vmcnt(4)
  v_mfma_f32_16x16x32_bf16 v[68:71], a[160:163], v[152:155], v[68:71]
  v_mfma_f32_16x16x32_bf16 v[72:75], a[164:167], v[152:155], v[72:75]
  v_mfma_f32_16x16x32_bf16 v[76:79], a[168:171], v[152:155], v[76:79]
  v_mfma_f32_16x16x32_bf16 v[80:83], a[172:175], v[152:155], v[80:83]
  v_mfma_f32_16x16x32_bf16 v[84:87], a[176:179], v[152:155], v[84:87]
  s_waitcnt vmcnt(3)
  v_mfma_f32_16x16x32_bf16 v[68:71], a[180:183], v[156:159], v[68:71]
  v_mfma_f32_16x16x32_bf16 v[72:75], a[184:187], v[156:159], v[72:75]
  v_mfma_f32_16x16x32_bf16 v[76:79], a[188:191], v[156:159], v[76:79]
  v_mfma_f32_16x16x32_bf16 v[80:83], a[192:195], v[156:159], v[80:83]
  v_mfma_f32_16x16x32_bf16 v[84:87], a[196:199], v[156:159], v[84:87]
  s_waitcnt lgkmcnt(0)
  s_waitcnt vmcnt(0)
  s_barrier
  ds_read_b64_tr_b16 v[232:233], v253 offset:0
  ds_read_b64_tr_b16 v[234:235], v253 offset:1024
  ds_read_b64_tr_b16 v[236:237], v253 offset:2048
  ds_read_b64_tr_b16 v[238:239], v253 offset:3072
  ds_read_b64_tr_b16 v[240:241], v253 offset:4096
  v_pk_add_f32 v[68:69], v[68:69], v[192:193]
  v_pk_add_f32 v[70:71], v[70:71], v[194:195]
  v_pk_add_f32 v[72:73], v[72:73], v[196:197]
  v_pk_add_f32 v[74:75], v[74:75], v[198:199]
  v_pk_add_f32 v[76:77], v[76:77], v[200:201]
  v_pk_add_f32 v[78:79], v[78:79], v[202:203]
  v_pk_add_f32 v[80:81], v[80:81], v[204:205]
  v_pk_add_f32 v[82:83], v[82:83], v[206:207]
  v_pk_add_f32 v[84:85], v[84:85], v[208:209]
  v_pk_add_f32 v[86:87], v[86:87], v[210:211]
  v_pk_add_f32 v[212:213], v[68:69], v[70:71]
  v_pk_mul_f32 v[214:215], v[68:69], v[68:69]
  v_pk_fma_f32 v[214:215], v[70:71], v[70:71], v[214:215]
  v_pk_add_f32 v[212:213], v[212:213], v[72:73]
  v_pk_fma_f32 v[214:215], v[72:73], v[72:73], v[214:215]
  v_pk_add_f32 v[212:213], v[212:213], v[74:75]
  v_pk_fma_f32 v[214:215], v[74:75], v[74:75], v[214:215]
  v_pk_add_f32 v[212:213], v[212:213], v[76:77]
  v_pk_fma_f32 v[214:215], v[76:77], v[76:77], v[214:215]
  v_pk_add_f32 v[212:213], v[212:213], v[78:79]
  v_pk_fma_f32 v[214:215], v[78:79], v[78:79], v[214:215]
  v_pk_add_f32 v[212:213], v[212:213], v[80:81]
  v_pk_fma_f32 v[214:215], v[80:81], v[80:81], v[214:215]
  v_pk_add_f32 v[212:213], v[212:213], v[82:83]
  v_pk_fma_f32 v[214:215], v[82:83], v[82:83], v[214:215]
  v_pk_add_f32 v[212:213], v[212:213], v[84:85]
  v_pk_fma_f32 v[214:215], v[84:85], v[84:85], v[214:215]
  v_pk_add_f32 v[212:213], v[212:213], v[86:87]
  v_pk_fma_f32 v[214:215], v[86:87], v[86:87], v[214:215]
redo_51:
  s_waitcnt lgkmcnt(4)
  v_lshlrev_b32_e64 v88, 16, v232
  v_and_b32 v89, 0xffff0000, v232
  v_lshlrev_b32_e64 v90, 16, v233
  v_and_b32 v91, 0xffff0000, v233
  s_add_u32 m0, s75, 0
  s_add_u32 s14, s74, 0
  buffer_load_dwordx4 v244, s[56:59], s14 offen lds
  buffer_load_dwordx4 v245, s[56:59], s14 offen offset:2048 lds
  v_pk_mul_f32 v[160:161], v[68:69], v[88:89]
  v_pk_mul_f32 v[226:227], v[88:89], v[88:89]
  v_pk_mul_f32 v[218:219], v[160:161], v[68:69]
  v_pk_mul_f32 v[220:221], v[160:161], v[160:161]
  v_pk_mul_f32 v[222:223], v[160:161], v[88:89]
  v_pk_mul_f32 v[162:163], v[70:71], v[90:91]
  v_pk_add_f32 v[224:225], v[88:89], v[90:91]
  v_pk_fma_f32 v[226:227], v[90:91], v[90:91], v[226:227]
  v_pk_add_f32 v[216:217], v[160:161], v[162:163]
  v_pk_fma_f32 v[218:219], v[162:163], v[70:71], v[218:219]
  v_pk_fma_f32 v[220:221], v[162:163], v[162:163], v[220:221]
  v_pk_fma_f32 v[222:223], v[162:163], v[90:91], v[222:223]
  s_waitcnt lgkmcnt(3)
  v_lshlrev_b32 v92, 16, v234
  v_and_b32 v93, 0xffff0000, v234
  v_lshlrev_b32_e64 v94, 16, v235
  v_and_b32 v95, 0xffff0000, v235
  v_pk_mul_f32 v[164:165], v[72:73], v[92:93]
  v_pk_add_f32 v[224:225], v[224:225], v[92:93]
  v_pk_fma_f32 v[226:227], v[92:93], v[92:93], v[226:227]
  v_pk_add_f32 v[216:217], v[216:217], v[164:165]
  v_pk_fma_f32 v[218:219], v[164:165], v[72:73], v[218:219]
  v_pk_fma_f32 v[220:221], v[164:165], v[164:165], v[220:221]
  v_pk_fma_f32 v[222:223], v[164:165], v[92:93], v[222:223]
  v_pk_mul_f32 v[166:167], v[74:75], v[94:95]
  v_pk_add_f32 v[224:225], v[224:225], v[94:95]
  v_pk_fma_f32 v[226:227], v[94:95], v[94:95], v[226:227]
  v_pk_add_f32 v[216:217], v[216:217], v[166:167]
  v_pk_fma_f32 v[218:219], v[166:167], v[74:75], v[218:219]
  v_pk_fma_f32 v[220:221], v[166:167], v[166:167], v[220:221]
  v_pk_fma_f32 v[222:223], v[166:167], v[94:95], v[222:223]
  s_waitcnt lgkmcnt(2)
  v_lshlrev_b32 v96, 16, v236
  v_and_b32 v97, 0xffff0000, v236
  v_lshlrev_b32_e64 v98, 16, v237
  v_and_b32 v99, 0xffff0000, v237
  s_add_u32 m0, s75, 4096
  s_add_u32 s14, s74, 20480
  buffer_load_dwordx4 v244, s[56:59], s14 offen lds
  buffer_load_dwordx4 v245, s[56:59], s14 offen offset:2048 lds
  v_pk_mul_f32 v[168:169], v[76:77], v[96:97]
  v_pk_add_f32 v[224:225], v[224:225], v[96:97]
  v_pk_fma_f32 v[226:227], v[96:97], v[96:97], v[226:227]
  v_pk_add_f32 v[216:217], v[216:217], v[168:169]
  v_pk_fma_f32 v[218:219], v[168:169], v[76:77], v[218:219]
  v_pk_fma_f32 v[220:221], v[168:169], v[168:169], v[220:221]
  v_pk_fma_f32 v[222:223], v[168:169], v[96:97], v[222:223]
  v_pk_mul_f32 v[170:171], v[78:79], v[98:99]
  v_pk_add_f32 v[224:225], v[224:225], v[98:99]
  v_pk_fma_f32 v[226:227], v[98:99], v[98:99], v[226:227]
  v_pk_add_f32 v[216:217], v[216:217], v[170:171]
  v_pk_fma_f32 v[218:219], v[170:171], v[78:79], v[218:219]
  v_pk_fma_f32 v[220:221], v[170:171], v[170:171], v[220:221]
  v_pk_fma_f32 v[222:223], v[170:171], v[98:99], v[222:223]
  s_waitcnt lgkmcnt(1)
  v_lshlrev_b32 v100, 16, v238
  v_and_b32 v101, 0xffff0000, v238
  v_lshlrev_b32_e64 v102, 16, v239
  v_and_b32 v103, 0xffff0000, v239
  v_pk_mul_f32 v[172:173], v[80:81], v[100:101]
  v_pk_add_f32 v[224:225], v[224:225], v[100:101]
  v_pk_fma_f32 v[226:227], v[100:101], v[100:101], v[226:227]
  v_pk_add_f32 v[216:217], v[216:217], v[172:173]
  v_pk_fma_f32 v[218:219], v[172:173], v[80:81], v[218:219]
  v_pk_fma_f32 v[220:221], v[172:173], v[172:173], v[220:221]
  v_pk_fma_f32 v[222:223], v[172:173], v[100:101], v[222:223]
  v_pk_mul_f32 v[174:175], v[82:83], v[102:103]
  v_pk_add_f32 v[224:225], v[224:225], v[102:103]
  v_pk_fma_f32 v[226:227], v[102:103], v[102:103], v[226:227]
  v_pk_add_f32 v[216:217], v[216:217], v[174:175]
  v_pk_fma_f32 v[218:219], v[174:175], v[82:83], v[218:219]
  v_pk_fma_f32 v[220:221], v[174:175], v[174:175], v[220:221]
  v_pk_fma_f32 v[222:223], v[174:175], v[102:103], v[222:223]
  s_waitcnt lgkmcnt(0)
  v_lshlrev_b32 v104, 16, v240
  v_and_b32 v105, 0xffff0000, v240
  v_lshlrev_b32_e64 v106, 16, v241
  v_and_b32 v107, 0xffff0000, v241
  s_add_u32 m0, s75, 8192
  s_add_u32 s14, s74, 40960
  buffer_load_dwordx4 v244, s[56:59], s14 offen lds
  v_pk_mul_f32 v[176:177], v[84:85], v[104:105]
  v_pk_add_f32 v[224:225], v[224:225], v[104:105]
  v_pk_fma_f32 v[226:227], v[104:105], v[104:105], v[226:227]
  v_pk_add_f32 v[216:217], v[216:217], v[176:177]
  v_pk_fma_f32 v[218:219], v[176:177], v[84:85], v[218:219]
  v_pk_fma_f32 v[220:221], v[176:177], v[176:177], v[220:221]
  v_pk_fma_f32 v[222:223], v[176:177], v[104:105], v[222:223]
  v_pk_mul_f32 v[178:179], v[86:87], v[106:107]
  v_pk_add_f32 v[224:225], v[224:225], v[106:107]
  v_pk_fma_f32 v[226:227], v[106:107], v[106:107], v[226:227]
  v_pk_add_f32 v[216:217], v[216:217], v[178:179]
  v_pk_fma_f32 v[218:219], v[178:179], v[86:87], v[218:219]
  v_pk_fma_f32 v[220:221], v[178:179], v[178:179], v[220:221]
  v_pk_fma_f32 v[222:223], v[178:179], v[106:107], v[222:223]
  v_cmp_u_f32 vcc, v224, v225
  s_cbranch_vccnz again_49
ok_50:
  v_add_f32 v212, v212, v213
  v_add_f32 v214, v214, v215
  v_add_f32 v216, v216, v217
  v_add_f32 v218, v218, v219
  v_add_f32 v220, v220, v221
  v_add_f32 v222, v222, v223
  v_add_f32 v224, v224, v225
  v_add_f32 v226, v226, v227
  v_permlane16_swap_b32 v212, v220
  v_permlane16_swap_b32 v214, v222
  v_permlane16_swap_b32 v216, v224
  v_permlane16_swap_b32 v218, v226
  v_add_f32 v228, v212, v220
  v_add_f32 v229, v214, v222
  v_add_f32 v230, v216, v224
  v_add_f32 v231, v218, v226
  v_mov_b32 v212, v228
  v_mov_b32 v213, v229
  v_mov_b32 v214, v230
  v_mov_b32 v215, v231
  v_permlane32_swap_b32 v228, v212
  v_permlane32_swap_b32 v229, v213
  v_permlane32_swap_b32 v230, v214
  v_permlane32_swap_b32 v231, v215
  v_add_f32 v228, v228, v212
  v_add_f32 v229, v229, v213
  v_add_f32 v230, v230, v214
  v_add_f32 v231, v231, v215
  v_bfi_b32 v228, v246, s88, v228
  v_bfi_b32 v229, v246, s89, v229
  v_bfi_b32 v230, v246, s90, v230
  v_bfi_b32 v231, v246, s91, v231
  s_mov_b32 exec_hi, 0
  s_cmp_eq_u32 s9, 0
  s_cbranch_scc1 slow_52
  buffer_store_dwordx4 v[228:231], v2, s[52:55], s13 offen
back_53:
  s_mov_b32 exec_hi, -1
  v_accvgpr_write_b32 a200, v232
  v_accvgpr_write_b32 a201, v233
  v_accvgpr_write_b32 a202, v234
  v_accvgpr_write_b32 a203, v235
  v_accvgpr_write_b32 a204, v236
  v_accvgpr_write_b32 a205, v237
  v_accvgpr_write_b32 a206, v238
  v_accvgpr_write_b32 a207, v239
  v_accvgpr_write_b32 a208, v240
  v_accvgpr_write_b32 a209, v241
  v_lshrrev_b32_e64 v11, 2, v3
  v_mul_u32_u24 v11, 5120, v11
  v_and_b32_e64 v12, 3, v3
  v_lshl_add_u32 v11, v12, 4, v11
  v_lshrrev_b32_e64 v12, 1, v4
  v_lshl_add_u32 v11, v12, 6, v11
  v_and_b32_e64 v12, 1, v4
  v_lshl_add_u32 v47, v12, 3, v11
  s_lshl_b32 s88, s5, 2
  s_add_u32 s88, s88, s7
  s_mul_i32 s88, s88, 20480
  s_mul_i32 s14, s6, 640
  s_add_u32 s88, s88, s14
  s_add_u32 s88, s88, 4194304
  v_accvgpr_read_b32 v190, a230
  v_accvgpr_read_b32 v191, a231
  v_accvgpr_read_b32 v192, a232
  v_accvgpr_read_b32 v193, a233
  v_accvgpr_read_b32 v194, a234
  v_accvgpr_read_b32 v195, a235
  v_accvgpr_read_b32 v196, a236
  v_accvgpr_read_b32 v197, a237
  v_accvgpr_read_b32 v198, a238
  v_accvgpr_read_b32 v199, a239
  v_lshlrev_b32 v108, 16, v190
  v_and_b32 v109, 0xffff0000, v190
  v_lshlrev_b32_e64 v110, 16, v191
  v_and_b32 v111, 0xffff0000, v191
  v_lshlrev_b32_e64 v112, 16, v192
  v_and_b32 v113, 0xffff0000, v192
  v_lshlrev_b32_e64 v114, 16, v193
  v_and_b32 v115, 0xffff0000, v193
  v_lshlrev_b32_e64 v116, 16, v194
  v_and_b32 v117, 0xffff0000, v194
  v_lshlrev_b32_e64 v118, 16, v195
  v_and_b32 v119, 0xffff0000, v195
  v_lshlrev_b32_e64 v120, 16, v196
  v_and_b32 v121, 0xffff0000, v196
  v_lshlrev_b32_e64 v122, 16, v197
  v_and_b32 v123, 0xffff0000, v197
  v_lshlrev_b32_e64 v124, 16, v198
  v_and_b32 v125, 0xffff0000, v198
  v_lshlrev_b32_e64 v126, 16, v199
  v_and_b32 v127, 0xffff0000, v199
  s_lshl_b32 s87, s3, 10
  s_lshr_b32 s13, s7, 1
  s_lshl_b32 s13, s13, 7
  s_add_u32 s87, s87, s13
  s_and_b32 s13, s7, 1
  s_lshl_b32 s13, s13, 3
  s_add_u32 s87, s87, s13
  s_add_u32 s87, s87, 4096
  v_and_b32 v46, 7, v1
  v_lshlrev_b32_e64 v46, 4, v46
  s_add_u32 s34, s76, 4194304
  s_add_u32 s35, s34, 20480
  s_lshl_b32 s44, s5, 5
  s_lshl_b32 s13, s6, 2
  s_add_u32 s44, s44, s13
  s_add_u32 s44, s44, s7
  v_and_b32 v11, 31, v1
  v_lshlrev_b32 v11, 4, v11
  v_lshrrev_b32_e64 v12, 5, v1
  v_lshl_add_u32 v11, v12, 14, v11
  s_mov_b32 s14, 0x0c0c0400
  s_mov_b32 s15, 0x04000c0c
  s_add_u32 s89, s12, 4096
  s_add_u32 s90, s12, 8192
  s_add_u32 s91, s12, 12288
stpoll_54:
  buffer_load_dwordx4 v[128:131], v11, s[52:55], s12 offen sc1
  buffer_load_dwordx4 v[132:135], v11, s[52:55], s89 offen sc1
  buffer_load_dwordx4 v[136:139], v11, s[52:55], s90 offen sc1
  buffer_load_dwordx4 v[140:143], v11, s[52:55], s91 offen sc1
  s_waitcnt vmcnt(0)
  v_perm_b32 v212, v129, v128, s14
  v_perm_b32 v213, v131, v130, s15
  v_perm_b32 v214, v133, v132, s14
  v_perm_b32 v215, v135, v134, s15
  v_perm_b32 v216, v137, v136, s14
  v_perm_b32 v217, v139, v138, s15
  v_perm_b32 v218, v141, v140, s14
  v_perm_b32 v219, v143, v142, s15
  v_or_b32 v212, v212, v213
  v_or_b32 v214, v214, v215
  v_or_b32 v216, v216, v217
  v_or_b32_e64 v218, v218, v219
  v_min3_u32 v13, v212, v214, s8
  v_max3_u32 v14, v212, v214, s8
  v_min3_u32 v13, v13, v216, v218
  v_max3_u32 v14, v14, v216, v218
  v_cmp_ne_u32 vcc, v13, v14
  s_sub_u32 s10, s10, 1
  s_cmp_gt_i32 s10, 0
  s_cbranch_scc0 giveup_56
  s_cbranch_vccnz stpoll_54
giveup_56:
  v_pk_add_f32 v[128:129], v[128:129], v[132:133]
  v_pk_add_f32 v[136:137], v[136:137], v[140:141]
  v_pk_add_f32 v[130:131], v[130:131], v[134:135]
  v_pk_add_f32 v[138:139], v[138:139], v[142:143]
  v_pk_add_f32 v[128:129], v[128:129], v[136:137]
  v_pk_add_f32 v[130:131], v[130:131], v[138:139]
  v_mov_b32 v132, v128
  v_mov_b32 v133, v129
  v_mov_b32 v134, v130
  v_mov_b32 v135, v131
  v_permlane32_swap_b32 v128, v132
  v_permlane32_swap_b32 v129, v133
  v_permlane32_swap_b32 v130, v134
  v_permlane32_swap_b32 v131, v135
  v_add_f32 v212, v128, v132
  v_add_f32 v213, v129, v133
  v_add_f32 v214, v130, v134
  v_add_f32 v215, v131, v135
  v_mov_b32 v216, v212
  v_mov_b32 v217, v213
  v_mov_b32 v218, v214
  v_mov_b32 v219, v215
  v_permlane16_swap_b32 v212, v216
  v_permlane16_swap_b32 v213, v217
  v_permlane16_swap_b32 v214, v218
  v_permlane16_swap_b32 v215, v219
  v_mul_f32 v200, 0x3acccccd, v212
  v_mul_f32 v204, 0x3acccccd, v213
  v_fma_f32 v204, -v200, v200, v204
  v_max_f32 v204, 0, v204
  v_add_f32 v204, 0x3727c5ac, v204
  v_rsq_f32 v202, v204
  s_nop 0
  v_mul_f32_e64 v203, v200, v202
  v_fma_f32 v204, v202, v214, v212
  v_fma_f32 v204, -v203, v218, v204
  v_mul_f32_e64 v205, v202, v216
  v_fma_f32 v205, 2.0, v215, v205
  v_fma_f32 v205, v202, v205, v213
  v_fma_f32 v214, v202, v217, v214
  v_mul_f32_e64 v219, v203, v219
  v_fma_f32 v214, -2.0, v214, v219
  v_fma_f32 v205, v203, v214, v205
  v_mul_f32 v204, 0x3acccccd, v204
  v_mul_f32 v205, 0x3acccccd, v205
  v_fma_f32 v205, -v204, v204, v205
  v_max_f32_e64 v205, 0, v205
  v_add_f32 v205, 0x3727c5ac, v205
  v_rsq_f32 v206, v205
  s_nop 0
  v_mul_f32_e64 v207, v204, v206
  v_pk_fma_f32 v[160:161], v[68:69], v[202:203], v[202:203] op_sel:[0,0,1] op_sel_hi:[1,0,1] neg_lo:[0,0,1] neg_hi:[0,0,1]
  v_pk_fma_f32 v[162:163], v[70:71], v[202:203], v[202:203] op_sel:[0,0,1] op_sel_hi:[1,0,1] neg_lo:[0,0,1] neg_hi:[0,0,1]
  v_pk_fma_f32 v[164:165], v[72:73], v[202:203], v[202:203] op_sel:[0,0,1] op_sel_hi:[1,0,1] neg_lo:[0,0,1] neg_hi:[0,0,1]
  v_pk_fma_f32 v[166:167], v[74:75], v[202:203], v[202:203] op_sel:[0,0,1] op_sel_hi:[1,0,1] neg_lo:[0,0,1] neg_hi:[0,0,1]
  v_pk_fma_f32 v[168:169], v[76:77], v[202:203], v[202:203] op_sel:[0,0,1] op_sel_hi:[1,0,1] neg_lo:[0,0,1] neg_hi:[0,0,1]
  v_pk_fma_f32 v[170:171], v[78:79], v[202:203], v[202:203] op_sel:[0,0,1] op_sel_hi:[1,0,1] neg_lo:[0,0,1] neg_hi:[0,0,1]
  v_pk_fma_f32 v[172:173], v[80:81], v[202:203], v[202:203] op_sel:[0,0,1] op_sel_hi:[1,0,1] neg_lo:[0,0,1] neg_hi:[0,0,1]
  v_pk_fma_f32 v[174:175], v[82:83], v[202:203], v[202:203] op_sel:[0,0,1] op_sel_hi:[1,0,1] neg_lo:[0,0,1] neg_hi:[0,0,1]
  v_pk_fma_f32 v[176:177], v[84:85], v[202:203], v[202:203] op_sel:[0,0,1] op_sel_hi:[1,0,1] neg_lo:[0,0,1] neg_hi:[0,0,1]
  v_pk_fma_f32 v[178:179], v[86:87], v[202:203], v[202:203] op_sel:[0,0,1] op_sel_hi:[1,0,1] neg_lo:[0,0,1] neg_hi:[0,0,1]
  v_pk_fma_f32 v[68:69], v[160:161], v[88:89], v[68:69]
  v_pk_fma_f32 v[70:71], v[162:163], v[90:91], v[70:71]
  v_pk_fma_f32 v[72:73], v[164:165], v[92:93], v[72:73]
  v_pk_fma_f32 v[74:75], v[166:167], v[94:95], v[74:75]
  v_pk_fma_f32 v[76:77], v[168:169], v[96:97], v[76:77]
  v_pk_fma_f32 v[78:79], v[170:171], v[98:99], v[78:79]
  v_pk_fma_f32 v[80:81], v[172:173], v[100:101], v[80:81]
  v_pk_fma_f32 v[82:83], v[174:175], v[102:103], v[82:83]
  v_pk_fma_f32 v[84:85], v[176:177], v[104:105], v[84:85]
  v_pk_fma_f32 v[86:87], v[178:179], v[106:107], v[86:87]
  v_pk_fma_f32 v[160:161], v[68:69], v[206:207], v[206:207] op_sel:[0,0,1] op_sel_hi:[1,0,1] neg_lo:[0,0,1] neg_hi:[0,0,1]
  v_pk_fma_f32 v[162:163], v[70:71], v[206:207], v[206:207] op_sel:[0,0,1] op_sel_hi:[1,0,1] neg_lo:[0,0,1] neg_hi:[0,0,1]
  v_pk_fma_f32 v[164:165], v[72:73], v[206:207], v[206:207] op_sel:[0,0,1] op_sel_hi:[1,0,1] neg_lo:[0,0,1] neg_hi:[0,0,1]
  v_pk_fma_f32 v[166:167], v[74:75], v[206:207], v[206:207] op_sel:[0,0,1] op_sel_hi:[1,0,1] neg_lo:[0,0,1] neg_hi:[0,0,1]
  v_pk_fma_f32 v[168:169], v[76:77], v[206:207], v[206:207] op_sel:[0,0,1] op_sel_hi:[1,0,1] neg_lo:[0,0,1] neg_hi:[0,0,1]
  v_pk_fma_f32 v[170:171], v[78:79], v[206:207], v[206:207] op_sel:[0,0,1] op_sel_hi:[1,0,1] neg_lo:[0,0,1] neg_hi:[0,0,1]
  v_pk_fma_f32 v[172:173], v[80:81], v[206:207], v[206:207] op_sel:[0,0,1] op_sel_hi:[1,0,1] neg_lo:[0,0,1] neg_hi:[0,0,1]
  v_pk_fma_f32 v[174:175], v[82:83], v[206:207], v[206:207] op_sel:[0,0,1] op_sel_hi:[1,0,1] neg_lo:[0,0,1] neg_hi:[0,0,1]
  v_pk_fma_f32 v[176:177], v[84:85], v[206:207], v[206:207] op_sel:[0,0,1] op_sel_hi:[1,0,1] neg_lo:[0,0,1] neg_hi:[0,0,1]
  v_pk_fma_f32 v[178:179], v[86:87], v[206:207], v[206:207] op_sel:[0,0,1] op_sel_hi:[1,0,1] neg_lo:[0,0,1] neg_hi:[0,0,1]
  v_cvt_pk_bf16_f32 v180, v160, v161
  v_cvt_pk_bf16_f32 v181, v162, v163
  v_cvt_pk_bf16_f32 v182, v164, v165
  v_cvt_pk_bf16_f32 v183, v166, v167
  v_cvt_pk_bf16_f32 v184, v168, v169
  v_cvt_pk_bf16_f32 v185, v170, v171
  v_cvt_pk_bf16_f32 v186, v172, v173
  v_cvt_pk_bf16_f32 v187, v174, v175
  v_cvt_pk_bf16_f32 v188, v176, v177
  v_cvt_pk_bf16_f32 v189, v178, v179
  buffer_store_dwordx2 v[180:181], v47, s[52:55], s88 offen offset:0 sc1
  buffer_store_dwordx2 v[182:183], v47, s[52:55], s88 offen offset:128 sc1
  buffer_store_dwordx2 v[184:185], v47, s[52:55], s88 offen offset:256 sc1
  buffer_store_dwordx2 v[186:187], v47, s[52:55], s88 offen offset:384 sc1
  buffer_store_dwordx2 v[188:189], v47, s[52:55], s88 offen offset:512 sc1
  v_pk_fma_f32 v[68:69], v[160:161], v[108:109], v[68:69]
  v_pk_fma_f32 v[70:71], v[162:163], v[110:111], v[70:71]
  v_pk_fma_f32 v[72:73], v[164:165], v[112:113], v[72:73]
  v_pk_fma_f32 v[74:75], v[166:167], v[114:115], v[74:75]
  v_pk_fma_f32 v[76:77], v[168:169], v[116:117], v[76:77]
  v_pk_fma_f32 v[78:79], v[170:171], v[118:119], v[78:79]
  v_pk_fma_f32 v[80:81], v[172:173], v[120:121], v[80:81]
  v_pk_fma_f32 v[82:83], v[174:175], v[122:123], v[82:83]
  v_pk_fma_f32 v[84:85], v[176:177], v[124:125], v[84:85]
  v_pk_fma_f32 v[86:87], v[178:179], v[126:127], v[86:87]
  v_accvgpr_write_b32 a210, v68
  v_accvgpr_write_b32 a211, v69
  v_accvgpr_write_b32 a212, v70
  v_accvgpr_write_b32 a213, v71
  v_accvgpr_write_b32 a214, v72
  v_accvgpr_write_b32 a215, v73
  v_accvgpr_write_b32 a216, v74
  v_accvgpr_write_b32 a217, v75
  v_accvgpr_write_b32 a218, v76
  v_accvgpr_write_b32 a219, v77
  v_accvgpr_write_b32 a220, v78
  v_accvgpr_write_b32 a221, v79
  v_accvgpr_write_b32 a222, v80
  v_accvgpr_write_b32 a223, v81
  v_accvgpr_write_b32 a224, v82
  v_accvgpr_write_b32 a225, v83
  v_accvgpr_write_b32 a226, v84
  v_accvgpr_write_b32 a227, v85
  v_accvgpr_write_b32 a228, v86
  v_accvgpr_write_b32 a229, v87
  s_add_u32 s13, s84, 4096
  s_waitcnt vmcnt(0)
  v_mov_b32 v15, s8
  s_mov_b64 exec, 1
  s_cmp_eq_u32 s9, 0
  s_cbranch_scc1 slow_57
  buffer_store_dword v15, off, s[52:55], s13
back_58:
  s_mov_b64 exec, -1
  s_cmp_lg_u32 s44, 992
  s_cbranch_scc1 skip_59
  v_mov_b32 v15, s8
  s_mov_b64 exec, 1
  buffer_store_dword v15, off, s[52:55], 0 sc1
  s_mov_b64 exec, -1
skip_59:
  ds_read_b128 v[88:91], v5 offset:20480
  ds_read_b128 v[92:95], v5 offset:22528
  ds_read_b128 v[96:99], v5 offset:24576
  ds_read_b128 v[100:103], v5 offset:26624
  ds_read_b128 v[104:107], v5 offset:28672
again_60:
  buffer_load_dwordx2 v[42:43], v46, s[52:55], s87 offen sc1
  s_sub_u32 s10, s10, 1
  s_cmp_gt_i32 s10, 0
  s_waitcnt vmcnt(0)
  v_xor_b32 v15, s8, v42
  v_xor_b32 v14, s8, v43
  v_or_b32 v15, v15, v14
  v_cmp_ne_u32 vcc, 0, v15
  s_cbranch_scc0 out_62
  s_cbranch_vccnz again_60
out_62:
ok_61:
  buffer_load_dwordx4 v[128:131], v0, s[52:55], s34 offen offset:1024 sc1
  buffer_load_dwordx4 v[132:135], v0, s[52:55], s35 offen offset:1024 sc1
  buffer_load_dwordx4 v[136:139], v0, s[52:55], s34 offen offset:1280 sc1
  buffer_load_dwordx4 v[140:143], v0, s[52:55], s35 offen offset:1280 sc1
  buffer_load_dwordx4 v[144:147], v0, s[52:55], s34 offen offset:1536 sc1
  buffer_load_dwordx4 v[148:151], v0, s[52:55], s35 offen offset:1536 sc1
  buffer_load_dwordx4 v[152:155], v0, s[52:55], s34 offen offset:1792 sc1
  buffer_load_dwordx4 v[156:159], v0, s[52:55], s35 offen offset:1792 sc1
  s_waitcnt vmcnt(6)
  s_waitcnt lgkmcnt(4)
  v_mfma_f32_16x16x32_bf16 v[48:51], v[128:131], v[88:91], 0
  ds_read_b128 v[108:111], v6 offset:20480
  v_mfma_f32_16x16x32_bf16 v[52:55], v[132:135], v[88:91], 0
  buffer_load_dwordx4 v[160:163], v0, s[52:55], s34 offen offset:2048 sc1
  s_waitcnt lgkmcnt(4)
  v_mfma_f32_16x16x32_bf16 v[56:59], v[128:131], v[92:95], 0
  ds_read_b128 v[112:115], v6 offset:22528
  v_mfma_f32_16x16x32_bf16 v[60:63], v[132:135], v[92:95], 0
  buffer_load_dwordx4 v[164:167], v0, s[52:55], s35 offen offset:2048 sc1
  s_waitcnt lgkmcnt(4)
  v_mfma_f32_16x16x32_bf16 v[64:67], v[128:131], v[96:99], 0
  ds_read_b128 v[116:119], v6 offset:24576
  v_mfma_f32_16x16x32_bf16 v[68:71], v[132:135], v[96:99], 0
  s_waitcnt lgkmcnt(4)
  v_mfma_f32_16x16x32_bf16 v[72:75], v[128:131], v[100:103], 0
  ds_read_b128 v[120:123], v6 offset:26624
  v_mfma_f32_16x16x32_bf16 v[76:79], v[132:135], v[100:103], 0
  s_waitcnt lgkmcnt(4)
  v_mfma_f32_16x16x32_bf16 v[80:83], v[128:131], v[104:107], 0
  ds_read_b128 v[124:127], v6 offset:28672
  v_mfma_f32_16x16x32_bf16 v[84:87], v[132:135], v[104:107], 0
  s_waitcnt vmcnt(6)
  s_waitcnt lgkmcnt(2)
  v_mfma_f32_16x16x32_bf16 v[48:51], v[136:139], v[108:111], v[48:51]
  ds_read_b128 v[88:91], v5 offset:30720
  v_mfma_f32_16x16x32_bf16 v[52:55], v[140:143], v[108:111], v[52:55]
  buffer_load_dwordx4 v[168:171], v0, s[52:55], s34 offen offset:2304 sc1
  v_mfma_f32_16x16x32_bf16 v[56:59], v[136:139], v[112:115], v[56:59]
  ds_read_b128 v[92:95], v5 offset:32768
  v_mfma_f32_16x16x32_bf16 v[60:63], v[140:143], v[112:115], v[60:63]
  buffer_load_dwordx4 v[172:175], v0, s[52:55], s35 offen offset:2304 sc1
  v_mfma_f32_16x16x32_bf16 v[64:67], v[136:139], v[116:119], v[64:67]
  ds_read_b128 v[96:99], v5 offset:34816
  v_mfma_f32_16x16x32_bf16 v[68:71], v[140:143], v[116:119], v[68:71]
  s_waitcnt lgkmcnt(3)
  v_mfma_f32_16x16x32_bf16 v[72:75], v[136:139], v[120:123], v[72:75]
  ds_read_b128 v[100:103], v5 offset:36864
  v_mfma_f32_16x16x32_bf16 v[76:79], v[140:143], v[120:123], v[76:79]
  v_mfma_f32_16x16x32_bf16 v[80:83], v[136:139], v[124:127], v[80:83]
  ds_read_b128 v[104:107], v5 offset:38912
  v_mfma_f32_16x16x32_bf16 v[84:87], v[140:143], v[124:127], v[84:87]
  s_waitcnt vmcnt(6)
  s_waitcnt lgkmcnt(2)
  v_mfma_f32_16x16x32_bf16 v[48:51], v[144:147], v[88:91], v[48:51]
  ds_read_b128 v[108:111], v6 offset:30720
  v_mfma_f32_16x16x32_bf16 v[52:55], v[148:151], v[88:91], v[52:55]
  buffer_load_dwordx4 v[176:179], v0, s[52:55], s34 offen offset:2560 sc1
  v_mfma_f32_16x16x32_bf16 v[56:59], v[144:147], v[92:95], v[56:59]
  ds_read_b128 v[112:115], v6 offset:32768
  v_mfma_f32_16x16x32_bf16 v[60:63], v[148:151], v[92:95], v[60:63]
  buffer_load_dwordx4 v[180:183], v0, s[52:55], s35 offen offset:2560 sc1
  v_mfma_f32_16x16x32_bf16 v[64:67], v[144:147], v[96:99], v[64:67]
  ds_read_b128 v[116:119], v6 offset:34816
  v_mfma_f32_16x16x32_bf16 v[68:71], v[148:151], v[96:99], v[68:71]
  s_waitcnt lgkmcnt(3)
  v_mfma_f32_16x16x32_bf16 v[72:75], v[144:147], v[100:103], v[72:75]
  ds_read_b128 v[120:123], v6 offset:36864
  v_mfma_f32_16x16x32_bf16 v[76:79], v[148:151], v[100:103], v[76:79]
  v_mfma_f32_16x16x32_bf16 v[80:83], v[144:147], v[104:107], v[80:83]
  ds_read_b128 v[124:127], v6 offset:38912
  v_mfma_f32_16x16x32_bf16 v[84:87], v[148:151], v[104:107], v[84:87]
  s_waitcnt vmcnt(6)
  s_waitcnt lgkmcnt(2)
  v_mfma_f32_16x16x32_bf16 v[48:51], v[152:155], v[108:111], v[48:51]
  ds_read_b128 v[88:91], v5 offset:40960
  v_mfma_f32_16x16x32_bf16 v[52:55], v[156:159], v[108:111], v[52:55]
  buffer_load_dwordx4 v[184:187], v0, s[52:55], s34 offen offset:2816 sc1
  v_mfma_f32_16x16x32_bf16 v[56:59], v[152:155], v[112:115], v[56:59]
  ds_read_b128 v[92:95], v5 offset:43008
  v_mfma_f32_16x16x32_bf16 v[60:63], v[156:159], v[112:115], v[60:63]
  buffer_load_dwordx4 v[188:191], v0, s[52:55], s35 offen offset:2816 sc1
  v_mfma_f32_16x16x32_bf16 v[64:67], v[152:155], v[116:119], v[64:67]
  ds_read_b128 v[96:99], v5 offset:45056
  v_mfma_f32_16x16x32_bf16 v[68:71], v[156:159], v[116:119], v[68:71]
  s_waitcnt lgkmcnt(3)
  v_mfma_f32_16x16x32_bf16 v[72:75], v[152:155], v[120:123], v[72:75]
  ds_read_b128 v[100:103], v5 offset:47104
  v_mfma_f32_16x16x32_bf16 v[76:79], v[156:159], v[120:123], v[76:79]
  v_mfma_f32_16x16x32_bf16 v[80:83], v[152:155], v[124:127], v[80:83]
  ds_read_b128 v[104:107], v5 offset:49152
  v_mfma_f32_16x16x32_bf16 v[84:87], v[156:159], v[124:127], v[84:87]
  s_waitcnt vmcnt(6)
  s_waitcnt lgkmcnt(2)
  v_mfma_f32_16x16x32_bf16 v[48:51], v[160:163], v[88:91], v[48:51]
  ds_read_b128 v[108:111], v6 offset:40960
  v_mfma_f32_16x16x32_bf16 v[52:55], v[164:167], v[88:91], v[52:55]
  buffer_load_dwordx4 v[128:131], v0, s[52:55], s34 offen offset:3072 sc1
  v_mfma_f32_16x16x32_bf16 v[56:59], v[160:163], v[92:95], v[56:59]
  ds_read_b128 v[112:115], v6 offset:43008
  v_mfma_f32_16x16x32_bf16 v[60:63], v[164:167], v[92:95], v[60:63]
  buffer_load_dwordx4 v[132:135], v0, s[52:55], s35 offen offset:3072 sc1
  v_mfma_f32_16x16x32_bf16 v[64:67], v[160:163], v[96:99], v[64:67]
  ds_read_b128 v[116:119], v6 offset:45056
  v_mfma_f32_16x16x32_bf16 v[68:71], v[164:167], v[96:99], v[68:71]
  s_waitcnt lgkmcnt(3)
  v_mfma_f32_16x16x32_bf16 v[72:75], v[160:163], v[100:103], v[72:75]
  ds_read_b128 v[120:123], v6 offset:47104
  v_mfma_f32_16x16x32_bf16 v[76:79], v[164:167], v[100:103], v[76:79]
  v_mfma_f32_16x16x32_bf16 v[80:83], v[160:163], v[104:107], v[80:83]
  ds_read_b128 v[124:127], v6 offset:49152
  v_mfma_f32_16x16x32_bf16 v[84:87], v[164:167], v[104:107], v[84:87]
  s_waitcnt vmcnt(6)
  s_waitcnt lgkmcnt(2)
  v_mfma_f32_16x16x32_bf16 v[48:51], v[168:171], v[108:111], v[48:51]
  ds_read_b128 v[88:91], v7 offset:0
  v_mfma_f32_16x16x32_bf16 v[52:55], v[172:175], v[108:111], v[52:55]
  buffer_load_dwordx4 v[136:139], v0, s[52:55], s34 offen offset:3328 sc1
  v_mfma_f32_16x16x32_bf16 v[56:59], v[168:171], v[112:115], v[56:59]
  ds_read_b128 v[92:95], v7 offset:2048
  v_mfma_f32_16x16x32_bf16 v[60:63], v[172:175], v[112:115], v[60:63]
  buffer_load_dwordx4 v[140:143], v0, s[52:55], s35 offen offset:3328 sc1
  v_mfma_f32_16x16x32_bf16 v[64:67], v[168:171], v[116:119], v[64:67]
  ds_read_b128 v[96:99], v7 offset:4096
  v_mfma_f32_16x16x32_bf16 v[68:71], v[172:175], v[116:119], v[68:71]
  s_waitcnt lgkmcnt(3)
  v_mfma_f32_16x16x32_bf16 v[72:75], v[168:171], v[120:123], v[72:75]
  ds_read_b128 v[100:103], v7 offset:6144
  v_mfma_f32_16x16x32_bf16 v[76:79], v[172:175], v[120:123], v[76:79]
  v_mfma_f32_16x16x32_bf16 v[80:83], v[168:171], v[124:127], v[80:83]
  ds_read_b128 v[104:107], v7 offset:8192
  v_mfma_f32_16x16x32_bf16 v[84:87], v[172:175], v[124:127], v[84:87]
  s_waitcnt vmcnt(6)
  s_waitcnt lgkmcnt(2)
  v_mfma_f32_16x16x32_bf16 v[48:51], v[176:179], v[88:91], v[48:51]
  ds_read_b128 v[108:111], v8 offset:0
  v_mfma_f32_16x16x32_bf16 v[52:55], v[180:183], v[88:91], v[52:55]
  buffer_load_dwordx4 v[144:147], v0, s[52:55], s34 offen offset:3584 sc1
  v_mfma_f32_16x16x32_bf16 v[56:59], v[176:179], v[92:95], v[56:59]
  ds_read_b128 v[112:115], v8 offset:2048
  v_mfma_f32_16x16x32_bf16 v[60:63], v[180:183], v[92:95], v[60:63]
  buffer_load_dwordx4 v[148:151], v0, s[52:55], s35 offen offset:3584 sc1
  v_mfma_f32_16x16x32_bf16 v[64:67], v[176:179], v[96:99], v[64:67]
  ds_read_b128 v[116:119], v8 offset:4096
  v_mfma_f32_16x16x32_bf16 v[68:71], v[180:183], v[96:99], v[68:71]
  s_waitcnt lgkmcnt(3)
  v_mfma_f32_16x16x32_bf16 v[72:75], v[176:179], v[100:103], v[72:75]
  ds_read_b128 v[120:123], v8 offset:6144
  v_mfma_f32_16x16x32_bf16 v[76:79], v[180:183], v[100:103], v[76:79]
  v_mfma_f32_16x16x32_bf16 v[80:83], v[176:179], v[104:107], v[80:83]
  ds_read_b128 v[124:127], v8 offset:8192
  v_mfma_f32_16x16x32_bf16 v[84:87], v[180:183], v[104:107], v[84:87]
  s_waitcnt vmcnt(6)
  s_waitcnt lgkmcnt(2)
  v_mfma_f32_16x16x32_bf16 v[48:51], v[184:187], v[108:111], v[48:51]
  ds_read_b128 v[88:91], v7 offset:10240
  v_mfma_f32_16x16x32_bf16 v[52:55], v[188:191], v[108:111], v[52:55]
  buffer_load_dwordx4 v[152:155], v0, s[52:55], s34 offen offset:3840 sc1
  v_mfma_f32_16x16x32_bf16 v[56:59], v[184:187], v[112:115], v[56:59]
  ds_read_b128 v[92:95], v7 offset:12288
  v_mfma_f32_16x16x32_bf16 v[60:63], v[188:191], v[112:115], v[60:63]
  buffer_load_dwordx4 v[156:159], v0, s[52:55], s35 offen offset:3840 sc1
  v_mfma_f32_16x16x32_bf16 v[64:67], v[184:187], v[116:119], v[64:67]
  ds_read_b128 v[96:99], v7 offset:14336
  v_mfma_f32_16x16x32_bf16 v[68:71], v[188:191], v[116:119], v[68:71]
  s_waitcnt lgkmcnt(3)
  v_mfma_f32_16x16x32_bf16 v[72:75], v[184:187], v[120:123], v[72:75]
  ds_read_b128 v[100:103], v7 offset:16384
  v_mfma_f32_16x16x32_bf16 v[76:79], v[188:191], v[120:123], v[76:79]
  v_mfma_f32_16x16x32_bf16 v[80:83], v[184:187], v[124:127], v[80:83]
  ds_read_b128 v[104:107], v7 offset:18432
  v_mfma_f32_16x16x32_bf16 v[84:87], v[188:191], v[124:127], v[84:87]
  s_waitcnt vmcnt(6)
  s_waitcnt lgkmcnt(2)
  v_mfma_f32_16x16x32_bf16 v[48:51], v[128:131], v[88:91], v[48:51]
  ds_read_b128 v[108:111], v8 offset:10240
  v_mfma_f32_16x16x32_bf16 v[52:55], v[132:135], v[88:91], v[52:55]
  s_add_u32 s34, s34, 4096
  buffer_load_dwordx4 v[160:163], v0, s[52:55], s34 offen offset:0 sc1
  v_mfma_f32_16x16x32_bf16 v[56:59], v[128:131], v[92:95], v[56:59]
  ds_read_b128 v[112:115], v8 offset:12288
  v_mfma_f32_16x16x32_bf16 v[60:63], v[132:135], v[92:95], v[60:63]
  s_add_u32 s35, s35, 4096
  buffer_load_dwordx4 v[164:167], v0, s[52:55], s35 offen offset:0 sc1
  v_mfma_f32_16x16x32_bf16 v[64:67], v[128:131], v[96:99], v[64:67]
  ds_read_b128 v[116:119], v8 offset:14336
  v_mfma_f32_16x16x32_bf16 v[68:71], v[132:135], v[96:99], v[68:71]
  s_waitcnt lgkmcnt(3)
  v_mfma_f32_16x16x32_bf16 v[72:75], v[128:131], v[100:103], v[72:75]
  ds_read_b128 v[120:123], v8 offset:16384
  v_mfma_f32_16x16x32_bf16 v[76:79], v[132:135], v[100:103], v[76:79]
  v_mfma_f32_16x16x32_bf16 v[80:83], v[128:131], v[104:107], v[80:83]
  ds_read_b128 v[124:127], v8 offset:18432
  v_mfma_f32_16x16x32_bf16 v[84:87], v[132:135], v[104:107], v[84:87]
  s_waitcnt vmcnt(6)
  s_waitcnt lgkmcnt(2)
  v_mfma_f32_16x16x32_bf16 v[48:51], v[136:139], v[108:111], v[48:51]
  ds_read_b128 v[88:91], v7 offset:20480
  v_mfma_f32_16x16x32_bf16 v[52:55], v[140:143], v[108:111], v[52:55]
  buffer_load_dwordx4 v[168:171], v0, s[52:55], s34 offen offset:256 sc1
  v_mfma_f32_16x16x32_bf16 v[56:59], v[136:139], v[112:115], v[56:59]
  ds_read_b128 v[92:95], v7 offset:22528
  v_mfma_f32_16x16x32_bf16 v[60:63], v[140:143], v[112:115], v[60:63]
  buffer_load_dwordx4 v[172:175], v0, s[52:55], s35 offen offset:256 sc1
  v_mfma_f32_16x16x32_bf16 v[64:67], v[136:139], v[116:119], v[64:67]
  ds_read_b128 v[96:99], v7 offset:24576
  v_mfma_f32_16x16x32_bf16 v[68:71], v[140:143], v[116:119], v[68:71]
  s_waitcnt lgkmcnt(3)
  v_mfma_f32_16x16x32_bf16 v[72:75], v[136:139], v[120:123], v[72:75]
  ds_read_b128 v[100:103], v7 offset:26624
  v_mfma_f32_16x16x32_bf16 v[76:79], v[140:143], v[120:123], v[76:79]
  v_mfma_f32_16x16x32_bf16 v[80:83], v[136:139], v[124:127], v[80:83]
  ds_read_b128 v[104:107], v7 offset:28672
  v_mfma_f32_16x16x32_bf16 v[84:87], v[140:143], v[124:127], v[84:87]
  s_waitcnt vmcnt(6)
  s_waitcnt lgkmcnt(2)
  v_mfma_f32_16x16x32_bf16 v[48:51], v[144:147], v[88:91], v[48:51]
  ds_read_b128 v[108:111], v8 offset:20480
  v_mfma_f32_16x16x32_bf16 v[52:55], v[148:151], v[88:91], v[52:55]
  buffer_load_dwordx4 v[176:179], v0, s[52:55], s34 offen offset:512 sc1
  v_mfma_f32_16x16x32_bf16 v[56:59], v[144:147], v[92:95], v[56:59]
  ds_read_b128 v[112:115], v8 offset:22528
  v_mfma_f32_16x16x32_bf16 v[60:63], v[148:151], v[92:95], v[60:63]
  buffer_load_dwordx4 v[180:183], v0, s[52:55], s35 offen offset:512 sc1
  v_mfma_f32_16x16x32_bf16 v[64:67], v[144:147], v[96:99], v[64:67]
  ds_read_b128 v[116:119], v8 offset:24576
  v_mfma_f32_16x16x32_bf16 v[68:71], v[148:151], v[96:99], v[68:71]
  s_waitcnt lgkmcnt(3)
  v_mfma_f32_16x16x32_bf16 v[72:75], v[144:147], v[100:103], v[72:75]
  ds_read_b128 v[120:123], v8 offset:26624
  v_mfma_f32_16x16x32_bf16 v[76:79], v[148:151], v[100:103], v[76:79]
  v_mfma_f32_16x16x32_bf16 v[80:83], v[144:147], v[104:107], v[80:83]
  ds_read_b128 v[124:127], v8 offset:28672
  v_mfma_f32_16x16x32_bf16 v[84:87], v[148:151], v[104:107], v[84:87]
  s_waitcnt vmcnt(6)
  s_waitcnt lgkmcnt(2)
  v_mfma_f32_16x16x32_bf16 v[48:51], v[152:155], v[108:111], v[48:51]
  ds_read_b128 v[88:91], v7 offset:30720
  v_mfma_f32_16x16x32_bf16 v[52:55], v[156:159], v[108:111], v[52:55]
  buffer_load_dwordx4 v[184:187], v0, s[52:55], s34 offen offset:768 sc1
  v_mfma_f32_16x16x32_bf16 v[56:59], v[152:155], v[112:115], v[56:59]
  ds_read_b128 v[92:95], v7 offset:32768
  v_mfma_f32_16x16x32_bf16 v[60:63], v[156:159], v[112:115], v[60:63]
  buffer_load_dwordx4 v[188:191], v0, s[52:55], s35 offen offset:768 sc1
  v_mfma_f32_16x16x32_bf16 v[64:67], v[152:155], v[116:119], v[64:67]
  ds_read_b128 v[96:99], v7 offset:34816
  v_mfma_f32_16x16x32_bf16 v[68:71], v[156:159], v[116:119], v[68:71]
  s_waitcnt lgkmcnt(3)
  v_mfma_f32_16x16x32_bf16 v[72:75], v[152:155], v[120:123], v[72:75]
  ds_read_b128 v[100:103], v7 offset:36864
  v_mfma_f32_16x16x32_bf16 v[76:79], v[156:159], v[120:123], v[76:79]
  v_mfma_f32_16x16x32_bf16 v[80:83], v[152:155], v[124:127], v[80:83]
  ds_read_b128 v[104:107], v7 offset:38912
  v_mfma_f32_16x16x32_bf16 v[84:87], v[156:159], v[124:127], v[84:87]
  s_waitcnt vmcnt(6)
  s_waitcnt lgkmcnt(2)
  v_mfma_f32_16x16x32_bf16 v[48:51], v[160:163], v[88:91], v[48:51]
  ds_read_b128 v[108:111], v8 offset:30720
  v_mfma_f32_16x16x32_bf16 v[52:55], v[164:167], v[88:91], v[52:55]
  s_sub_u32 s34, s34, 4096
  buffer_load_dwordx4 v[128:131], v0, s[52:55], s34 offen offset:0 sc1
  v_mfma_f32_16x16x32_bf16 v[56:59], v[160:163], v[92:95], v[56:59]
  ds_read_b128 v[112:115], v8 offset:32768
  v_mfma_f32_16x16x32_bf16 v[60:63], v[164:167], v[92:95], v[60:63]
  s_sub_u32 s35, s35, 4096
  buffer_load_dwordx4 v[132:135], v0, s[52:55], s35 offen offset:0 sc1
  v_mfma_f32_16x16x32_bf16 v[64:67], v[160:163], v[96:99], v[64:67]
  ds_read_b128 v[116:119], v8 offset:34816
  v_mfma_f32_16x16x32_bf16 v[68:71], v[164:167], v[96:99], v[68:71]
  s_waitcnt lgkmcnt(3)
  v_mfma_f32_16x16x32_bf16 v[72:75], v[160:163], v[100:103], v[72:75]
  ds_read_b128 v[120:123], v8 offset:36864
  v_mfma_f32_16x16x32_bf16 v[76:79], v[164:167], v[100:103], v[76:79]
  v_mfma_f32_16x16x32_bf16 v[80:83], v[160:163], v[104:107], v[80:83]
  ds_read_b128 v[124:127], v8 offset:38912
  v_mfma_f32_16x16x32_bf16 v[84:87], v[164:167], v[104:107], v[84:87]
  s_waitcnt vmcnt(6)
  s_waitcnt lgkmcnt(2)
  v_mfma_f32_16x16x32_bf16 v[48:51], v[168:171], v[108:111], v[48:51]
  ds_read_b128 v[88:91], v7 offset:40960
  v_mfma_f32_16x16x32_bf16 v[52:55], v[172:175], v[108:111], v[52:55]
  buffer_load_dwordx4 v[136:139], v0, s[52:55], s34 offen offset:256 sc1
  v_mfma_f32_16x16x32_bf16 v[56:59], v[168:171], v[112:115], v[56:59]
  ds_read_b128 v[92:95], v7 offset:43008
  v_mfma_f32_16x16x32_bf16 v[60:63], v[172:175], v[112:115], v[60:63]
  buffer_load_dwordx4 v[140:143], v0, s[52:55], s35 offen offset:256 sc1
  v_mfma_f32_16x16x32_bf16 v[64:67], v[168:171], v[116:119], v[64:67]
  ds_read_b128 v[96:99], v7 offset:45056
  v_mfma_f32_16x16x32_bf16 v[68:71], v[172:175], v[116:119], v[68:71]
  s_waitcnt lgkmcnt(3)
  v_mfma_f32_16x16x32_bf16 v[72:75], v[168:171], v[120:123], v[72:75]
  ds_read_b128 v[100:103], v7 offset:47104
  v_mfma_f32_16x16x32_bf16 v[76:79], v[172:175], v[120:123], v[76:79]
  v_mfma_f32_16x16x32_bf16 v[80:83], v[168:171], v[124:127], v[80:83]
  ds_read_b128 v[104:107], v7 offset:49152
  v_mfma_f32_16x16x32_bf16 v[84:87], v[172:175], v[124:127], v[84:87]
  s_waitcnt vmcnt(6)
  s_waitcnt lgkmcnt(2)
  v_mfma_f32_16x16x32_bf16 v[48:51], v[176:179], v[88:91], v[48:51]
  ds_read_b128 v[108:111], v8 offset:40960
  v_mfma_f32_16x16x32_bf16 v[52:55], v[180:183], v[88:91], v[52:55]
  buffer_load_dwordx4 v[144:147], v0, s[52:55], s34 offen offset:512 sc1
  v_mfma_f32_16x16x32_bf16 v[56:59], v[176:179], v[92:95], v[56:59]
  ds_read_b128 v[112:115], v8 offset:43008
  v_mfma_f32_16x16x32_bf16 v[60:63], v[180:183], v[92:95], v[60:63]
  buffer_load_dwordx4 v[148:151], v0, s[52:55], s35 offen offset:512 sc1
  v_mfma_f32_16x16x32_bf16 v[64:67], v[176:179], v[96:99], v[64:67]
  ds_read_b128 v[116:119], v8 offset:45056
  v_mfma_f32_16x16x32_bf16 v[68:71], v[180:183], v[96:99], v[68:71]
  s_waitcnt lgkmcnt(3)
  v_mfma_f32_16x16x32_bf16 v[72:75], v[176:179], v[100:103], v[72:75]
  ds_read_b128 v[120:123], v8 offset:47104
  v_mfma_f32_16x16x32_bf16 v[76:79], v[180:183], v[100:103], v[76:79]
  v_mfma_f32_16x16x32_bf16 v[80:83], v[176:179], v[104:107], v[80:83]
  ds_read_b128 v[124:127], v8 offset:49152
  v_mfma_f32_16x16x32_bf16 v[84:87], v[180:183], v[104:107], v[84:87]
  s_waitcnt vmcnt(6)
  s_barrier
  s_waitcnt lgkmcnt(2)
  v_mfma_f32_16x16x32_bf16 v[48:51], v[184:187], v[108:111], v[48:51]
  ds_read_b128 v[88:91], v5 offset:0
  v_mfma_f32_16x16x32_bf16 v[52:55], v[188:191], v[108:111], v[52:55]
  buffer_load_dwordx4 v[152:155], v0, s[52:55], s34 offen offset:768 sc1
  v_mfma_f32_16x16x32_bf16 v[56:59], v[184:187], v[112:115], v[56:59]
  ds_read_b128 v[92:95], v5 offset:2048
  v_mfma_f32_16x16x32_bf16 v[60:63], v[188:191], v[112:115], v[60:63]
  buffer_load_dwordx4 v[156:159], v0, s[52:55], s35 offen offset:768 sc1
  v_mfma_f32_16x16x32_bf16 v[64:67], v[184:187], v[116:119], v[64:67]
  ds_read_b128 v[96:99], v5 offset:4096
  v_mfma_f32_16x16x32_bf16 v[68:71], v[188:191], v[116:119], v[68:71]
  s_waitcnt lgkmcnt(3)
  v_mfma_f32_16x16x32_bf16 v[72:75], v[184:187], v[120:123], v[72:75]
  ds_read_b128 v[100:103], v5 offset:6144
  v_mfma_f32_16x16x32_bf16 v[76:79], v[188:191], v[120:123], v[76:79]
  v_mfma_f32_16x16x32_bf16 v[80:83], v[184:187], v[124:127], v[80:83]
  ds_read_b128 v[104:107], v5 offset:8192
  v_mfma_f32_16x16x32_bf16 v[84:87], v[188:191], v[124:127], v[84:87]
  s_waitcnt vmcnt(6)
  s_waitcnt lgkmcnt(2)
  v_mfma_f32_16x16x32_bf16 v[48:51], v[128:131], v[88:91], v[48:51]
  ds_read_b128 v[108:111], v6 offset:0
  v_mfma_f32_16x16x32_bf16 v[52:55], v[132:135], v[88:91], v[52:55]
  v_mfma_f32_16x16x32_bf16 v[56:59], v[128:131], v[92:95], v[56:59]
  ds_read_b128 v[112:115], v6 offset:2048
  v_mfma_f32_16x16x32_bf16 v[60:63], v[132:135], v[92:95], v[60:63]
  v_mfma_f32_16x16x32_bf16 v[64:67], v[128:131], v[96:99], v[64:67]
  ds_read_b128 v[116:119], v6 offset:4096
  v_mfma_f32_16x16x32_bf16 v[68:71], v[132:135], v[96:99], v[68:71]
  s_waitcnt lgkmcnt(3)
  v_mfma_f32_16x16x32_bf16 v[72:75], v[128:131], v[100:103], v[72:75]
  ds_read_b128 v[120:123], v6 offset:6144
  v_mfma_f32_16x16x32_bf16 v[76:79], v[132:135], v[100:103], v[76:79]
  v_mfma_f32_16x16x32_bf16 v[80:83], v[128:131], v[104:107], v[80:83]
  ds_read_b128 v[124:127], v6 offset:8192
  v_mfma_f32_16x16x32_bf16 v[84:87], v[132:135], v[104:107], v[84:87]
  s_waitcnt vmcnt(4)
  s_waitcnt lgkmcnt(2)
  v_mfma_f32_16x16x32_bf16 v[48:51], v[136:139], v[108:111], v[48:51]
  ds_read_b128 v[88:91], v5 offset:10240
  v_mfma_f32_16x16x32_bf16 v[52:55], v[140:143], v[108:111], v[52:55]
  v_accvgpr_read_b32 v11, a245
  s_and_b32 exec_lo, s96, 0x3fffffff
  s_mov_b32 exec_hi, 0
  buffer_load_dword a250, v11, s[52:55], 0 offen
  s_mov_b64 exec, -1
  v_mfma_f32_16x16x32_bf16 v[56:59], v[136:139], v[112:115], v[56:59]
  ds_read_b128 v[92:95], v5 offset:12288
  v_mfma_f32_16x16x32_bf16 v[60:63], v[140:143], v[112:115], v[60:63]
  v_mfma_f32_16x16x32_bf16 v[64:67], v[136:139], v[116:119], v[64:67]
  ds_read_b128 v[96:99], v5 offset:14336
  v_mfma_f32_16x16x32_bf16 v[68:71], v[140:143], v[116:119], v[68:71]
  s_waitcnt lgkmcnt(3)
  v_mfma_f32_16x16x32_bf16 v[72:75], v[136:139], v[120:123], v[72:75]
  ds_read_b128 v[100:103], v5 offset:16384
  v_mfma_f32_16x16x32_bf16 v[76:79], v[140:143], v[120:123], v[76:79]
  v_mfma_f32_16x16x32_bf16 v[80:83], v[136:139], v[124:127], v[80:83]
  ds_read_b128 v[104:107], v5 offset:18432
  v_mfma_f32_16x16x32_bf16 v[84:87], v[140:143], v[124:127], v[84:87]
  s_waitcnt vmcnt(2)
  s_waitcnt lgkmcnt(2)
  v_mfma_f32_16x16x32_bf16 v[48:51], v[144:147], v[88:91], v[48:51]
  ds_read_b128 v[108:111], v6 offset:10240
  v_mfma_f32_16x16x32_bf16 v[52:55], v[148:151], v[88:91], v[52:55]
  v_mfma_f32_16x16x32_bf16 v[56:59], v[144:147], v[92:95], v[56:59]
  ds_read_b128 v[112:115], v6 offset:12288
  v_mfma_f32_16x16x32_bf16 v[60:63], v[148:151], v[92:95], v[60:63]
  v_mfma_f32_16x16x32_bf16 v[64:67], v[144:147], v[96:99], v[64:67]
  ds_read_b128 v[116:119], v6 offset:14336
  v_mfma_f32_16x16x32_bf16 v[68:71], v[148:151], v[96:99], v[68:71]
  s_waitcnt lgkmcnt(3)
  v_mfma_f32_16x16x32_bf16 v[72:75], v[144:147], v[100:103], v[72:75]
  ds_read_b128 v[120:123], v6 offset:16384
  v_mfma_f32_16x16x32_bf16 v[76:79], v[148:151], v[100:103], v[76:79]
  v_mfma_f32_16x16x32_bf16 v[80:83], v[144:147], v[104:107], v[80:83]
  ds_read_b128 v[124:127], v6 offset:18432
  v_mfma_f32_16x16x32_bf16 v[84:87], v[148:151], v[104:107], v[84:87]
  s_waitcnt vmcnt(0)
  s_waitcnt lgkmcnt(2)
  v_mfma_f32_16x16x32_bf16 v[48:51], v[152:155], v[108:111], v[48:51]
  v_mfma_f32_16x16x32_bf16 v[52:55], v[156:159], v[108:111], v[52:55]
  v_mfma_f32_16x16x32_bf16 v[56:59], v[152:155], v[112:115], v[56:59]
  v_mfma_f32_16x16x32_bf16 v[60:63], v[156:159], v[112:115], v[60:63]
  v_mfma_f32_16x16x32_bf16 v[64:67], v[152:155], v[116:119], v[64:67]
  v_mfma_f32_16x16x32_bf16 v[68:71], v[156:159], v[116:119], v[68:71]
  s_waitcnt lgkmcnt(0)
  v_mfma_f32_16x16x32_bf16 v[72:75], v[152:155], v[120:123], v[72:75]
  v_mfma_f32_16x16x32_bf16 v[76:79], v[156:159], v[120:123], v[76:79]
  v_mfma_f32_16x16x32_bf16 v[80:83], v[152:155], v[124:127], v[80:83]
  v_mfma_f32_16x16x32_bf16 v[84:87], v[156:159], v[124:127], v[84:87]
  v_fmac_f32 v49, v16, v48
  v_fmac_f32 v57, v17, v56
  v_fmac_f32 v65, v18, v64
  s_nop 1
  v_fmac_f32 v73, v19, v72
  s_nop 0
  v_fmac_f32 v81, v20, v80
  v_fmac_f32_dpp v49, v48, v21 quad_perm:[1,0,3,2] row_mask:0xf bank_mask:0xf
  v_fmac_f32_dpp v57, v56, v22 quad_perm:[1,0,3,2] row_mask:0xf bank_mask:0xf
  v_fmac_f32_dpp v65, v64, v23 quad_perm:[1,0,3,2] row_mask:0xf bank_mask:0xf
  v_fmac_f32_dpp v73, v72, v24 quad_perm:[1,0,3,2] row_mask:0xf bank_mask:0xf
  v_fmac_f32_dpp v81, v80, v25 quad_perm:[1,0,3,2] row_mask:0xf bank_mask:0xf
  v_fmac_f32 v50, v16, v49
  v_fmac_f32 v58, v17, v57
  v_fmac_f32 v66, v18, v65
  v_fmac_f32 v74, v19, v73
  v_fmac_f32_e64 v82, v20, v81
  v_fmac_f32_dpp v50, v49, v21 quad_perm:[1,0,3,2] row_mask:0xf bank_mask:0xf
  v_fmac_f32_dpp v58, v57, v22 quad_perm:[1,0,3,2] row_mask:0xf bank_mask:0xf
  v_fmac_f32_dpp v66, v65, v23 quad_perm:[1,0,3,2] row_mask:0xf bank_mask:0xf
  v_fmac_f32_dpp v74, v73, v24 quad_perm:[1,0,3,2] row_mask:0xf bank_mask:0xf
  v_fmac_f32_dpp v82, v81, v25 quad_perm:[1,0,3,2] row_mask:0xf bank_mask:0xf
  v_fmac_f32 v51, v16, v50
  v_fmac_f32 v59, v17, v58
  v_fmac_f32 v67, v18, v66
  v_fmac_f32 v75, v19, v74
  v_fmac_f32_e64 v83, v20, v82
  v_fmac_f32_dpp v51, v50, v21 quad_perm:[1,0,3,2] row_mask:0xf bank_mask:0xf
  v_fmac_f32_dpp v59, v58, v22 quad_perm:[1,0,3,2] row_mask:0xf bank_mask:0xf
  v_fmac_f32_dpp v67, v66, v23 quad_perm:[1,0,3,2] row_mask:0xf bank_mask:0xf
  v_fmac_f32_dpp v75, v74, v24 quad_perm:[1,0,3,2] row_mask:0xf bank_mask:0xf
  v_fmac_f32_dpp v83, v82, v25 quad_perm:[1,0,3,2] row_mask:0xf bank_mask:0xf
  v_fmac_f32 v52, v16, v51
  v_fmac_f32 v60, v17, v59
  v_fmac_f32 v68, v18, v67
  v_fmac_f32 v76, v19, v75
  v_fmac_f32_e64 v84, v20, v83
  v_fmac_f32_dpp v52, v51, v21 quad_perm:[1,0,3,2] row_mask:0xf bank_mask:0xf
  v_fmac_f32_dpp v60, v59, v22 quad_perm:[1,0,3,2] row_mask:0xf bank_mask:0xf
  v_fmac_f32_dpp v68, v67, v23 quad_perm:[1,0,3,2] row_mask:0xf bank_mask:0xf
  v_fmac_f32_dpp v76, v75, v24 quad_perm:[1,0,3,2] row_mask:0xf bank_mask:0xf
  v_fmac_f32_dpp v84, v83, v25 quad_perm:[1,0,3,2] row_mask:0xf bank_mask:0xf
  v_fmac_f32 v53, v16, v52
  v_fmac_f32 v61, v17, v60
  v_fmac_f32 v69, v18, v68
  v_fmac_f32 v77, v19, v76
  v_fmac_f32_e64 v85, v20, v84
  v_fmac_f32_dpp v53, v52, v21 quad_perm:[1,0,3,2] row_mask:0xf bank_mask:0xf
  v_fmac_f32_dpp v61, v60, v22 quad_perm:[1,0,3,2] row_mask:0xf bank_mask:0xf
  v_fmac_f32_dpp v69, v68, v23 quad_perm:[1,0,3,2] row_mask:0xf bank_mask:0xf
  v_fmac_f32_dpp v77, v76, v24 quad_perm:[1,0,3,2] row_mask:0xf bank_mask:0xf
  v_fmac_f32_dpp v85, v84, v25 quad_perm:[1,0,3,2] row_mask:0xf bank_mask:0xf
  v_fmac_f32 v54, v16, v53
  v_fmac_f32 v62, v17, v61
  v_fmac_f32 v70, v18, v69
  v_fmac_f32 v78, v19, v77
  v_fmac_f32_e64 v86, v20, v85
  v_fmac_f32_dpp v54, v53, v21 quad_perm:[1,0,3,2] row_mask:0xf bank_mask:0xf
  v_fmac_f32_dpp v62, v61, v22 quad_perm:[1,0,3,2] row_mask:0xf bank_mask:0xf
  v_fmac_f32_dpp v70, v69, v23 quad_perm:[1,0,3,2] row_mask:0xf bank_mask:0xf
  v_fmac_f32_dpp v78, v77, v24 quad_perm:[1,0,3,2] row_mask:0xf bank_mask:0xf
  v_fmac_f32_dpp v86, v85, v25 quad_perm:[1,0,3,2] row_mask:0xf bank_mask:0xf
  v_fmac_f32 v55, v16, v54
  v_fmac_f32 v63, v17, v62
  v_fmac_f32 v71, v18, v70
  v_fmac_f32 v79, v19, v78
  v_fmac_f32_e64 v87, v20, v86
  v_fmac_f32_dpp v55, v54, v21 quad_perm:[1,0,3,2] row_mask:0xf bank_mask:0xf
  v_fmac_f32_dpp v63, v62, v22 quad_perm:[1,0,3,2] row_mask:0xf bank_mask:0xf
  v_fmac_f32_dpp v71, v70, v23 quad_perm:[1,0,3,2] row_mask:0xf bank_mask:0xf
  v_fmac_f32_dpp v79, v78, v24 quad_perm:[1,0,3,2] row_mask:0xf bank_mask:0xf
  v_fmac_f32_dpp v87, v86, v25 quad_perm:[1,0,3,2] row_mask:0xf bank_mask:0xf
  v_add_u32 v11, 152320, v9
  v_min_u32 v12, 39, v1
  v_mul_u32_u24 v44, 48, v12
  s_lshl_b32 s12, s7, 3
  s_add_u32 s12, s12, 149504
  v_add_u32 v44, s12, v44
  ds_write_b32 v11, v55 offset:0
  ds_write_b32 v11, v63 offset:1152
  ds_write_b32 v11, v71 offset:2304
  ds_write_b32 v11, v79 offset:3456
  ds_write_b32 v11, v87 offset:4608
  v_mul_u32_u24 v46, 144, v12
  v_add_u32 v46, 152320, v46
  s_waitcnt lgkmcnt(0)
  s_barrier
  ds_read_b128 v[90:93], v46 offset:0
  ds_read_b128 v[94:97], v46 offset:16
  ds_read_b128 v[98:101], v46 offset:32
  ds_read_b128 v[102:105], v46 offset:48
  ds_read_b128 v[106:109], v46 offset:64
  ds_read_b128 v[110:113], v46 offset:80
  ds_read_b128 v[114:117], v46 offset:96
  ds_read_b128 v[118:121], v46 offset:112
  s_waitcnt lgkmcnt(7)
  v_pk_fma_f32 v[92:93], v[90:91], v[36:37], v[92:93] op_sel:[1,1,0] op_sel_hi:[0,1,1] neg_lo:[0,1,0]
  v_pk_fma_f32 v[92:93], v[90:91], v[36:37], v[92:93] op_sel:[0,0,0] op_sel_hi:[1,0,1]
  s_waitcnt lgkmcnt(6)
  v_pk_fma_f32 v[94:95], v[92:93], v[36:37], v[94:95] op_sel:[1,1,0] op_sel_hi:[0,1,1] neg_lo:[0,1,0]
  v_pk_fma_f32 v[94:95], v[92:93], v[36:37], v[94:95] op_sel:[0,0,0] op_sel_hi:[1,0,1]
  v_pk_fma_f32 v[96:97], v[94:95], v[36:37], v[96:97] op_sel:[1,1,0] op_sel_hi:[0,1,1] neg_lo:[0,1,0]
  v_pk_fma_f32 v[96:97], v[94:95], v[36:37], v[96:97] op_sel:[0,0,0] op_sel_hi:[1,0,1]
  s_waitcnt lgkmcnt(5)
  v_pk_fma_f32 v[98:99], v[96:97], v[36:37], v[98:99] op_sel:[1,1,0] op_sel_hi:[0,1,1] neg_lo:[0,1,0]
  v_pk_fma_f32 v[98:99], v[96:97], v[36:37], v[98:99] op_sel:[0,0,0] op_sel_hi:[1,0,1]
  v_pk_fma_f32 v[100:101], v[98:99], v[36:37], v[100:101] op_sel:[1,1,0] op_sel_hi:[0,1,1] neg_lo:[0,1,0]
  v_pk_fma_f32 v[100:101], v[98:99], v[36:37], v[100:101] op_sel:[0,0,0] op_sel_hi:[1,0,1]
  s_waitcnt lgkmcnt(4)
  v_pk_fma_f32 v[102:103], v[100:101], v[36:37], v[102:103] op_sel:[1,1,0] op_sel_hi:[0,1,1] neg_lo:[0,1,0]
  v_pk_fma_f32 v[102:103], v[100:101], v[36:37], v[102:103] op_sel:[0,0,0] op_sel_hi:[1,0,1]
  v_pk_fma_f32 v[104:105], v[102:103], v[36:37], v[104:105] op_sel:[1,1,0] op_sel_hi:[0,1,1] neg_lo:[0,1,0]
  v_pk_fma_f32 v[104:105], v[102:103], v[36:37], v[104:105] op_sel:[0,0,0] op_sel_hi:[1,0,1]
  s_waitcnt lgkmcnt(3)
  v_pk_fma_f32 v[106:107], v[104:105], v[36:37], v[106:107] op_sel:[1,1,0] op_sel_hi:[0,1,1] neg_lo:[0,1,0]
  v_pk_fma_f32 v[106:107], v[104:105], v[36:37], v[106:107] op_sel:[0,0,0] op_sel_hi:[1,0,1]
  v_pk_fma_f32 v[108:109], v[106:107], v[36:37], v[108:109] op_sel:[1,1,0] op_sel_hi:[0,1,1] neg_lo:[0,1,0]
  v_pk_fma_f32 v[108:109], v[106:107], v[36:37], v[108:109] op_sel:[0,0,0] op_sel_hi:[1,0,1]
  s_waitcnt lgkmcnt(2)
  v_pk_fma_f32 v[110:111], v[108:109], v[36:37], v[110:111] op_sel:[1,1,0] op_sel_hi:[0,1,1] neg_lo:[0,1,0]
  v_pk_fma_f32 v[110:111], v[108:109], v[36:37], v[110:111] op_sel:[0,0,0] op_sel_hi:[1,0,1]
  v_pk_fma_f32 v[112:113], v[110:111], v[36:37], v[112:113] op_sel:[1,1,0] op_sel_hi:[0,1,1] neg_lo:[0,1,0]
  v_pk_fma_f32 v[112:113], v[110:111], v[36:37], v[112:113] op_sel:[0,0,0] op_sel_hi:[1,0,1]
  s_waitcnt lgkmcnt(1)
  v_pk_fma_f32 v[114:115], v[112:113], v[36:37], v[114:115] op_sel:[1,1,0] op_sel_hi:[0,1,1] neg_lo:[0,1,0]
  v_pk_fma_f32 v[114:115], v[112:113], v[36:37], v[114:115] op_sel:[0,0,0] op_sel_hi:[1,0,1]
  v_pk_fma_f32 v[116:117], v[114:115], v[36:37], v[116:117] op_sel:[1,1,0] op_sel_hi:[0,1,1] neg_lo:[0,1,0]
  v_pk_fma_f32 v[116:117], v[114:115], v[36:37], v[116:117] op_sel:[0,0,0] op_sel_hi:[1,0,1]
  s_waitcnt lgkmcnt(0)
  v_pk_fma_f32 v[118:119], v[116:117], v[36:37], v[118:119] op_sel:[1,1,0] op_sel_hi:[0,1,1] neg_lo:[0,1,0]
  v_pk_fma_f32 v[118:119], v[116:117], v[36:37], v[118:119] op_sel:[0,0,0] op_sel_hi:[1,0,1]
  v_pk_fma_f32 v[120:121], v[118:119], v[36:37], v[120:121] op_sel:[1,1,0] op_sel_hi:[0,1,1] neg_lo:[0,1,0]
  v_pk_fma_f32 v[120:121], v[118:119], v[36:37], v[120:121] op_sel:[0,0,0] op_sel_hi:[1,0,1]
  v_mov_b32 v122, s8
  v_mov_b32 v123, s8
  s_add_u32 s12, s83, 337920
  s_mov_b64 exec, s[96:97]
  buffer_store_dwordx4 v[120:123], v2, s[52:55], s12 offen sc1
  s_mov_b64 exec, -1
  v_subrev_u32 v46, 8576, v46
  v_mov_b32 v88, 0
  v_mov_b32 v89, 0
  s_mov_b32 exec_hi, 0xff
  s_cmp_eq_u32 s7, 1
  s_cbranch_scc1 w1_65
  s_cmp_eq_u32 s7, 2
  s_cbranch_scc1 w2_66
  s_cmp_eq_u32 s7, 3
  s_cbranch_scc1 w3_67
w0_64:
  ds_write_b128 v46, v[88:91] offset:0
  ds_write_b128 v46, v[92:95] offset:16
  s_branch join_63
w1_65:
  ds_write_b128 v46, v[96:99] offset:32
  ds_write_b128 v46, v[100:103] offset:48
  s_branch join_63
w2_66:
  ds_write_b128 v46, v[104:107] offset:64
  ds_write_b128 v46, v[108:111] offset:80
  s_branch join_63
w3_67:
  ds_write_b128 v46, v[112:115] offset:96
  ds_write_b128 v46, v[116:119] offset:112
join_63:
  s_mov_b32 exec_hi, -1
  v_add_u32 v46, 143744, v9
  ds_read_b32 v244, v46 offset:0
  ds_read_b32 v246, v46 offset:1152
  ds_read_b32 v248, v46 offset:2304
  ds_read_b32 v250, v46 offset:3456
  ds_read_b32 v252, v46 offset:4608
  v_and_b32 v43, 1, v3
  v_cvt_f32_u32 v43, v43
  v_fma_f32 v43, 2.0, v43, -1.0
  s_waitcnt lgkmcnt(0)
  s_nop 0
  v_mul_f32_dpp v245, v244, v43 quad_perm:[1,0,3,2] row_mask:0xf bank_mask:0xf
  v_mul_f32_dpp v247, v246, v43 quad_perm:[1,0,3,2] row_mask:0xf bank_mask:0xf
  v_mul_f32_dpp v249, v248, v43 quad_perm:[1,0,3,2] row_mask:0xf bank_mask:0xf
  v_mul_f32_dpp v251, v250, v43 quad_perm:[1,0,3,2] row_mask:0xf bank_mask:0xf
  v_mul_f32_dpp v253, v252, v43 quad_perm:[1,0,3,2] row_mask:0xf bank_mask:0xf
  s_and_b32 vcc_lo, s1, 7
  s_lshl_b32 vcc_lo, vcc_lo, 2
  s_add_u32 vcc_lo, vcc_lo, s7
  s_lshl_b32 vcc_lo, vcc_lo, 11
  v_lshl_add_u32 v15, v3, 7, vcc_lo
  v_min_u32 v15, L_codeend-L_pc-4, v15
  s_mov_b64 exec, 0xffff
  global_load_dword a250, v15, s[98:99]
  s_mov_b64 exec, -1
  s_lshl_b32 s90, s7, 2
  s_sub_u32 s90, 12, s90
  s_mul_i32 s90, s90, 640
  s_add_u32 s90, s90, s83
  s_add_u32 s90, s90, 327680
  v_min_u32 v42, 39, v1
  v_lshlrev_b32 v42, 4, v42
  buffer_load_dwordx3 v[88:90], v42, s[52:55], s90 offen offset:0 sc1
  buffer_load_dwordx3 v[92:94], v42, s[52:55], s90 offen offset:640 sc1
  buffer_load_dwordx3 v[96:98], v42, s[52:55], s90 offen offset:1280 sc1
  buffer_load_dwordx3 v[100:102], v42, s[52:55], s90 offen offset:1920 sc1
  s_mul_i32 s12, s7, 2560
  s_add_u32 s12, s12, 24576
  v_lshlrev_b32_e64 v11, 5, v3
  v_lshl_add_u32 v11, v4, 3, v11
  v_add_u32_e64 v11, s12, v11
  v_lshl_add_u32 v12, v1, 3, s12
  ds_write_b64 v11, a[200:201] offset:0
  ds_write_b64 v11, a[202:203] offset:512
  ds_write_b64 v11, a[204:205] offset:1024
  ds_write_b64 v11, a[206:207] offset:1536
  ds_write_b64 v11, a[208:209] offset:2048
  ds_read_b64 v[232:233], v12 offset:0
  ds_read_b64 v[234:235], v12 offset:512
  ds_read_b64 v[236:237], v12 offset:1024
  ds_read_b64 v[238:239], v12 offset:1536
  ds_read_b64 v[240:241], v12 offset:2048
  v_lshrrev_b32_e64 v11, 1, v3
  v_mul_u32_u24 v12, 80, v11
  v_add_u32 v12, 160640, v12
  v_mul_u32_u24_e64 v11, 48, v11
  v_add_u32 v11, 149504, v11
  ds_read_b128 v[128:131], v12 offset:0
  ds_read_b128 v[132:135], v12 offset:16
  ds_read_b128 v[136:139], v12 offset:32
  ds_read_b128 v[140:143], v12 offset:48
  ds_read_b128 v[144:147], v12 offset:640
  ds_read_b128 v[148:151], v12 offset:656
  ds_read_b128 v[152:155], v12 offset:672
  ds_read_b128 v[156:159], v12 offset:688
  ds_read_b128 v[160:163], v12 offset:1280
  ds_read_b128 v[164:167], v12 offset:1296
  ds_read_b128 v[168:171], v12 offset:1312
  ds_read_b128 v[172:175], v12 offset:1328
  ds_read_b128 v[176:179], v12 offset:1920
  ds_read_b128 v[180:183], v12 offset:1936
  ds_read_b128 v[184:187], v12 offset:1952
  ds_read_b128 v[188:191], v12 offset:1968
  ds_read_b128 v[104:107], v12 offset:2560
  ds_read_b128 v[108:111], v12 offset:2576
  ds_read_b128 v[112:115], v12 offset:2592
  ds_read_b128 v[116:119], v12 offset:2608
  v_accvgpr_read_b32 v254, a240
  v_accvgpr_read_b32 v255, a241
  v_accvgpr_read_b32 v47, a242
  s_waitcnt vmcnt(0)
  v_min3_u32 v14, v90, v94, s8
  v_max3_u32 v15, v90, v94, s8
  v_min3_u32 v14, v14, v98, v102
  v_max3_u32 v15, v15, v98, v102
  v_cmp_ne_u32 vcc, v14, v15
  s_cbranch_vccz ok_69
again_68:
  buffer_load_dwordx3 v[88:90], v42, s[52:55], s90 offen offset:0 sc1
  buffer_load_dwordx3 v[92:94], v42, s[52:55], s90 offen offset:640 sc1
  buffer_load_dwordx3 v[96:98], v42, s[52:55], s90 offen offset:1280 sc1
  buffer_load_dwordx3 v[100:102], v42, s[52:55], s90 offen offset:1920 sc1
  s_sub_u32 s10, s10, 1
  s_cmp_gt_i32 s10, 0
  s_waitcnt vmcnt(0)
  v_min3_u32 v14, v90, v94, s8
  v_max3_u32 v15, v90, v94, s8
  v_min3_u32 v14, v14, v98, v102
  v_max3_u32 v15, v15, v98, v102
  v_cmp_ne_u32 vcc, v14, v15
  s_cbranch_scc0 out_70
  s_cbranch_vccnz again_68
out_70:
ok_69:
  v_pk_fma_f32 v[92:93], v[88:89], v[38:39], v[92:93] op_sel:[1,1,0] op_sel_hi:[0,1,1] neg_lo:[0,1,0]
  v_pk_fma_f32 v[92:93], v[88:89], v[38:39], v[92:93] op_sel:[0,0,0] op_sel_hi:[1,0,1]
  v_pk_fma_f32 v[96:97], v[92:93], v[38:39], v[96:97] op_sel:[1,1,0] op_sel_hi:[0,1,1] neg_lo:[0,1,0]
  v_pk_fma_f32 v[96:97], v[92:93], v[38:39], v[96:97] op_sel:[0,0,0] op_sel_hi:[1,0,1]
  v_pk_fma_f32 v[100:101], v[96:97], v[38:39], v[100:101] op_sel:[1,1,0] op_sel_hi:[0,1,1] neg_lo:[0,1,0]
  v_pk_fma_f32 v[100:101], v[96:97], v[38:39], v[100:101] op_sel:[0,0,0] op_sel_hi:[1,0,1]
  v_pk_mul_f32 v[88:89], v[100:101], v[40:41] op_sel:[1,1] op_sel_hi:[0,1] neg_lo:[0,1]
  v_pk_fma_f32 v[88:89], v[100:101], v[40:41], v[88:89] op_sel:[0,0,0] op_sel_hi:[1,0,1]
  s_mov_b32 exec_hi, 0xff
  ds_write_b64 v44, v[88:89]
  s_mov_b32 exec_hi, -1
  s_waitcnt lgkmcnt(0)
  s_barrier
  ds_read_b128 v[88:91], v11 offset:0
  ds_read_b128 v[92:95], v11 offset:16
  ds_read_b128 v[96:99], v11 offset:384
  ds_read_b128 v[100:103], v11 offset:400
  ds_read_b128 v[224:227], v11 offset:768
  ds_read_b128 v[228:231], v11 offset:784
  s_waitcnt lgkmcnt(4)
  v_pk_add_f32 v[88:89], v[88:89], v[90:91]
  v_pk_add_f32 v[92:93], v[92:93], v[94:95]
  v_pk_add_f32 v[88:89], v[88:89], v[92:93]
  v_pk_fma_f32 v[244:245], v[26:27], v[88:89], v[244:245] op_sel:[0,0,0] op_sel_hi:[1,0,1]
  v_pk_fma_f32 v[244:245], v[26:27], v[88:89], v[244:245] op_sel:[1,1,0] op_sel_hi:[0,1,1] neg_hi:[1,0,0]
  ds_read_b128 v[88:91], v11 offset:1152
  ds_read_b128 v[92:95], v11 offset:1168
  s_waitcnt lgkmcnt(4)
  v_pk_add_f32 v[96:97], v[96:97], v[98:99]
  v_pk_add_f32 v[100:101], v[100:101], v[102:103]
  v_pk_add_f32 v[96:97], v[96:97], v[100:101]
  v_pk_fma_f32 v[246:247], v[28:29], v[96:97], v[246:247] op_sel:[0,0,0] op_sel_hi:[1,0,1]
  v_pk_fma_f32 v[246:247], v[28:29], v[96:97], v[246:247] op_sel:[1,1,0] op_sel_hi:[0,1,1] neg_hi:[1,0,0]
  ds_read_b128 v[96:99], v11 offset:1536
  ds_read_b128 v[100:103], v11 offset:1552
  v_pk_fma_f32 v[48:49], v[128:129], v[244:245], v[48:49] op_sel:[0,0,0] op_sel_hi:[1,0,1]
  v_pk_fma_f32 v[50:51], v[130:131], v[244:245], v[50:51] op_sel:[0,0,0] op_sel_hi:[1,0,1]
  v_pk_fma_f32 v[52:53], v[132:133], v[244:245], v[52:53] op_sel:[0,0,0] op_sel_hi:[1,0,1]
  v_pk_fma_f32 v[54:55], v[134:135], v[244:245], v[54:55] op_sel:[0,0,0] op_sel_hi:[1,0,1]
  v_pk_fma_f32 v[48:49], v[136:137], v[244:245], v[48:49] op_sel:[0,1,0] op_sel_hi:[1,1,1]
  v_pk_fma_f32 v[50:51], v[138:139], v[244:245], v[50:51] op_sel:[0,1,0] op_sel_hi:[1,1,1]
  v_pk_fma_f32 v[52:53], v[140:141], v[244:245], v[52:53] op_sel:[0,1,0] op_sel_hi:[1,1,1]
  v_pk_fma_f32 v[54:55], v[142:143], v[244:245], v[54:55] op_sel:[0,1,0] op_sel_hi:[1,1,1]
  v_cvt_pk_bf16_f32 v120, v48, v49
  v_cvt_pk_bf16_f32 v121, v50, v51
  v_cvt_pk_bf16_f32 v122, v52, v53
  v_cvt_pk_bf16_f32 v123, v54, v55
  ds_write_b128 v254, v[120:123]
  ds_read_b64_tr_b16 v[52:53], v255
  ds_read_b64_tr_b16 v[54:55], v255 offset:640
  s_waitcnt lgkmcnt(7)
  v_pk_add_f32 v[224:225], v[224:225], v[226:227]
  v_pk_add_f32 v[228:229], v[228:229], v[230:231]
  v_pk_add_f32 v[224:225], v[224:225], v[228:229]
  v_pk_fma_f32 v[248:249], v[30:31], v[224:225], v[248:249] op_sel:[0,0,0] op_sel_hi:[1,0,1]
  v_pk_fma_f32 v[248:249], v[30:31], v[224:225], v[248:249] op_sel:[1,1,0] op_sel_hi:[0,1,1] neg_hi:[1,0,0]
  v_pk_fma_f32 v[56:57], v[144:145], v[246:247], v[56:57] op_sel:[0,0,0] op_sel_hi:[1,0,1]
  v_pk_fma_f32 v[58:59], v[146:147], v[246:247], v[58:59] op_sel:[0,0,0] op_sel_hi:[1,0,1]
  v_pk_fma_f32 v[60:61], v[148:149], v[246:247], v[60:61] op_sel:[0,0,0] op_sel_hi:[1,0,1]
  v_pk_fma_f32 v[62:63], v[150:151], v[246:247], v[62:63] op_sel:[0,0,0] op_sel_hi:[1,0,1]
  v_pk_fma_f32 v[56:57], v[152:153], v[246:247], v[56:57] op_sel:[0,1,0] op_sel_hi:[1,1,1]
  v_pk_fma_f32 v[58:59], v[154:155], v[246:247], v[58:59] op_sel:[0,1,0] op_sel_hi:[1,1,1]
  v_pk_fma_f32 v[60:61], v[156:157], v[246:247], v[60:61] op_sel:[0,1,0] op_sel_hi:[1,1,1]
  v_pk_fma_f32 v[62:63], v[158:159], v[246:247], v[62:63] op_sel:[0,1,0] op_sel_hi:[1,1,1]
  v_cvt_pk_bf16_f32 v124, v56, v57
  v_cvt_pk_bf16_f32 v125, v58, v59
  v_cvt_pk_bf16_f32 v126, v60, v61
  v_cvt_pk_bf16_f32 v127, v62, v63
  ds_write_b128 v254, v[124:127]
  ds_read_b64_tr_b16 v[60:61], v255
  ds_read_b64_tr_b16 v[62:63], v255 offset:640
  s_waitcnt lgkmcnt(8)
  v_pk_add_f32 v[88:89], v[88:89], v[90:91]
  v_pk_add_f32 v[92:93], v[92:93], v[94:95]
  v_pk_add_f32 v[88:89], v[88:89], v[92:93]
  v_pk_fma_f32 v[250:251], v[32:33], v[88:89], v[250:251] op_sel:[0,0,0] op_sel_hi:[1,0,1]
  v_pk_fma_f32 v[250:251], v[32:33], v[88:89], v[250:251] op_sel:[1,1,0] op_sel_hi:[0,1,1] neg_hi:[1,0,0]
  s_add_u32 s13, s78, 0
  s_waitcnt lgkmcnt(3)
  s_cmp_eq_u32 s9, 0
  s_cbranch_scc1 slow_71
  buffer_store_dwordx4 v[52:55], v47, s[60:63], s13 offen
back_72:
  v_pk_fma_f32 v[64:65], v[160:161], v[248:249], v[64:65] op_sel:[0,0,0] op_sel_hi:[1,0,1]
  v_pk_fma_f32 v[66:67], v[162:163], v[248:249], v[66:67] op_sel:[0,0,0] op_sel_hi:[1,0,1]
  v_pk_fma_f32 v[68:69], v[164:165], v[248:249], v[68:69] op_sel:[0,0,0] op_sel_hi:[1,0,1]
  v_pk_fma_f32 v[70:71], v[166:167], v[248:249], v[70:71] op_sel:[0,0,0] op_sel_hi:[1,0,1]
  v_pk_fma_f32 v[64:65], v[168:169], v[248:249], v[64:65] op_sel:[0,1,0] op_sel_hi:[1,1,1]
  v_pk_fma_f32 v[66:67], v[170:171], v[248:249], v[66:67] op_sel:[0,1,0] op_sel_hi:[1,1,1]
  v_pk_fma_f32 v[68:69], v[172:173], v[248:249], v[68:69] op_sel:[0,1,0] op_sel_hi:[1,1,1]
  v_pk_fma_f32 v[70:71], v[174:175], v[248:249], v[70:71] op_sel:[0,1,0] op_sel_hi:[1,1,1]
  v_cvt_pk_bf16_f32 v120, v64, v65
  v_cvt_pk_bf16_f32 v121, v66, v67
  v_cvt_pk_bf16_f32 v122, v68, v69
  v_cvt_pk_bf16_f32 v123, v70, v71
  ds_write_b128 v254, v[120:123]
  ds_read_b64_tr_b16 v[68:69], v255
  ds_read_b64_tr_b16 v[70:71], v255 offset:640
  v_pk_add_f32 v[96:97], v[96:97], v[98:99]
  v_pk_add_f32 v[100:101], v[100:101], v[102:103]
  v_pk_add_f32 v[96:97], v[96:97], v[100:101]
  v_pk_fma_f32 v[252:253], v[34:35], v[96:97], v[252:253] op_sel:[0,0,0] op_sel_hi:[1,0,1]
  v_pk_fma_f32 v[252:253], v[34:35], v[96:97], v[252:253] op_sel:[1,1,0] op_sel_hi:[0,1,1] neg_hi:[1,0,0]
  s_add_u32 s13, s79, 0
  s_waitcnt lgkmcnt(3)
  s_cmp_eq_u32 s9, 0
  s_cbranch_scc1 slow_73
  buffer_store_dwordx4 v[60:63], v47, s[60:63], s13 offen
back_74:
  v_pk_fma_f32 v[72:73], v[176:177], v[250:251], v[72:73] op_sel:[0,0,0] op_sel_hi:[1,0,1]
  v_pk_fma_f32 v[74:75], v[178:179], v[250:251], v[74:75] op_sel:[0,0,0] op_sel_hi:[1,0,1]
  v_pk_fma_f32 v[76:77], v[180:181], v[250:251], v[76:77] op_sel:[0,0,0] op_sel_hi:[1,0,1]
  v_pk_fma_f32 v[78:79], v[182:183], v[250:251], v[78:79] op_sel:[0,0,0] op_sel_hi:[1,0,1]
  v_pk_fma_f32 v[72:73], v[184:185], v[250:251], v[72:73] op_sel:[0,1,0] op_sel_hi:[1,1,1]
  v_pk_fma_f32 v[74:75], v[186:187], v[250:251], v[74:75] op_sel:[0,1,0] op_sel_hi:[1,1,1]
  v_pk_fma_f32 v[76:77], v[188:189], v[250:251], v[76:77] op_sel:[0,1,0] op_sel_hi:[1,1,1]
  v_pk_fma_f32 v[78:79], v[190:191], v[250:251], v[78:79] op_sel:[0,1,0] op_sel_hi:[1,1,1]
  v_cvt_pk_bf16_f32 v124, v72, v73
  v_cvt_pk_bf16_f32 v125, v74, v75
  v_cvt_pk_bf16_f32 v126, v76, v77
  v_cvt_pk_bf16_f32 v127, v78, v79
  ds_write_b128 v254, v[124:127]
  ds_read_b64_tr_b16 v[76:77], v255
  ds_read_b64_tr_b16 v[78:79], v255 offset:640
  s_add_u32 s13, s80, 0
  s_waitcnt lgkmcnt(3)
  s_cmp_eq_u32 s9, 0
  s_cbranch_scc1 slow_75
  buffer_store_dwordx4 v[68:71], v47, s[60:63], s13 offen
back_76:
  v_pk_fma_f32 v[80:81], v[104:105], v[252:253], v[80:81] op_sel:[0,0,0] op_sel_hi:[1,0,1]
  v_pk_fma_f32 v[82:83], v[106:107], v[252:253], v[82:83] op_sel:[0,0,0] op_sel_hi:[1,0,1]
  v_pk_fma_f32 v[84:85], v[108:109], v[252:253], v[84:85] op_sel:[0,0,0] op_sel_hi:[1,0,1]
  v_pk_fma_f32 v[86:87], v[110:111], v[252:253], v[86:87] op_sel:[0,0,0] op_sel_hi:[1,0,1]
  v_pk_fma_f32 v[80:81], v[112:113], v[252:253], v[80:81] op_sel:[0,1,0] op_sel_hi:[1,1,1]
  v_pk_fma_f32 v[82:83], v[114:115], v[252:253], v[82:83] op_sel:[0,1,0] op_sel_hi:[1,1,1]
  v_pk_fma_f32 v[84:85], v[116:117], v[252:253], v[84:85] op_sel:[0,1,0] op_sel_hi:[1,1,1]
  v_pk_fma_f32 v[86:87], v[118:119], v[252:253], v[86:87] op_sel:[0,1,0] op_sel_hi:[1,1,1]
  v_cvt_pk_bf16_f32 v120, v80, v81
  v_cvt_pk_bf16_f32 v121, v82, v83
  v_cvt_pk_bf16_f32 v122, v84, v85
  v_cvt_pk_bf16_f32 v123, v86, v87
  ds_write_b128 v254, v[120:123]
  ds_read_b64_tr_b16 v[84:85], v255
  ds_read_b64_tr_b16 v[86:87], v255 offset:640
  s_add_u32 s13, s81, 0
  s_waitcnt lgkmcnt(3)
  s_cmp_eq_u32 s9, 0
  s_cbranch_scc1 slow_77
  buffer_store_dwordx4 v[76:79], v47, s[60:63], s13 offen
back_78:
  s_add_u32 s13, s82, 0
  s_waitcnt lgkmcnt(0)
  s_cmp_eq_u32 s9, 0
  s_cbranch_scc1 slow_79
  buffer_store_dwordx4 v[84:87], v47, s[60:63], s13 offen
back_80:
  s_mul_i32 s13, s5, 163840
  s_mul_i32 s14, s7, 10240
  s_add_u32 s13, s13, s14
  s_add_u32 s13, s13, 0
  s_add_u32 s14, s7, 1
  s_and_b32 s14, s14, 3
  s_mul_i32 s15, s14, 40960
  s_add_u32 s16, s15, s13
  s_mul_i32 s15, s14, 10240
  s_add_u32 s15, s15, 102400
  v_add_u32 v44, s15, v2
  s_add_u32 s14, s7, 2
  s_and_b32 s14, s14, 3
  s_mul_i32 s15, s14, 40960
  s_add_u32 s17, s15, s13
  s_mul_i32 s15, s14, 10240
  s_add_u32 s15, s15, 107520
  v_add_u32 v45, s15, v2
  s_add_u32 s14, s7, 3
  s_and_b32 s14, s14, 3
  s_mul_i32 s15, s14, 40960
  s_add_u32 s18, s15, s13
  s_mul_i32 s15, s14, 5120
  v_add_u32 v46, s15, v2
  s_add_u32 s14, s7, 4
  s_and_b32 s14, s14, 3
  s_mul_i32 s15, s14, 40960
  s_add_u32 s19, s15, s13
  s_lshl_b32 s49, s3, 10
  s_lshl_b32 s13, s7, 6
  s_add_u32 s49, s49, s13
  s_and_b32 s13, s5, 1
  s_lshl_b32 s13, s13, 3
  s_add_u32 s49, s49, s13
  s_add_u32 s49, s49, 4608
  v_and_b32 v244, 3, v1
  v_lshlrev_b32 v244, 4, v244
  s_waitcnt vmcnt(0)
  s_add_u32 s14, s84, 4608
  v_mov_b32 v15, s8
  s_mov_b64 exec, 1
  s_cmp_eq_u32 s9, 0
  s_cbranch_scc1 slow_81
  buffer_store_dword v15, off, s[52:55], s14
back_82:
  s_mov_b64 exec, -1
again_83:
  buffer_load_dwordx2 v[42:43], v244, s[52:55], s49 offen sc1
  s_sub_u32 s10, s10, 1
  s_cmp_gt_i32 s10, 0
  s_waitcnt vmcnt(0)
  v_xor_b32 v15, s8, v42
  v_xor_b32 v14, s8, v43
  v_or_b32 v15, v15, v14
  v_cmp_ne_u32 vcc, 0, v15
  s_cbranch_scc0 out_85
  s_cbranch_vccnz again_83
out_85:
ok_84:
  buffer_load_dwordx4 v[128:131], v2, s[60:63], s16 offen offset:0 sc1
  buffer_load_dwordx4 v[132:135], v2, s[60:63], s16 offen offset:1024 sc1
  buffer_load_dwordx4 v[136:139], v2, s[60:63], s16 offen offset:2048 sc1
  buffer_load_dwordx4 v[140:143], v2, s[60:63], s16 offen offset:3072 sc1
  s_add_u32 s16, s16, 4096
  buffer_load_dwordx4 v[144:147], v2, s[60:63], s16 offen offset:0 sc1
  buffer_load_dwordx4 v[148:151], v2, s[60:63], s16 offen offset:1024 sc1
  buffer_load_dwordx4 v[152:155], v2, s[60:63], s16 offen offset:2048 sc1
  buffer_load_dwordx4 v[156:159], v2, s[60:63], s16 offen offset:3072 sc1
  s_waitcnt vmcnt(7)
  v_mfma_f32_16x16x32_bf16 v[48:51], a[0:3], v[128:131], 0
  s_add_u32 s16, s16, 4096
  buffer_load_dwordx4 v[160:163], v2, s[60:63], s16 offen offset:0 sc1
  v_mfma_f32_16x16x32_bf16 v[52:55], a[4:7], v[128:131], 0
  v_mfma_f32_16x16x32_bf16 v[56:59], a[8:11], v[128:131], 0
  v_mfma_f32_16x16x32_bf16 v[60:63], a[12:15], v[128:131], 0
  v_mfma_f32_16x16x32_bf16 v[64:67], a[16:19], v[128:131], 0
  s_waitcnt vmcnt(7)
  v_mfma_f32_16x16x32_bf16 v[48:51], a[20:23], v[132:135], v[48:51]
  buffer_load_dwordx4 v[164:167], v2, s[60:63], s16 offen offset:1024 sc1
  v_mfma_f32_16x16x32_bf16 v[52:55], a[24:27], v[132:135], v[52:55]
  v_accvgpr_read_b32 v108, a210
  v_mfma_f32_16x16x32_bf16 v[56:59], a[28:31], v[132:135], v[56:59]
  v_accvgpr_read_b32 v109, a211
  v_mfma_f32_16x16x32_bf16 v[60:63], a[32:35], v[132:135], v[60:63]
  v_accvgpr_read_b32 v110, a212
  v_mfma_f32_16x16x32_bf16 v[64:67], a[36:39], v[132:135], v[64:67]
  s_waitcnt vmcnt(7)
  v_mfma_f32_16x16x32_bf16 v[48:51], a[40:43], v[136:139], v[48:51]
  buffer_load_dwordx4 v[168:171], v2, s[60:63], s17 offen offset:0 sc1
  v_mfma_f32_16x16x32_bf16 v[52:55], a[44:47], v[136:139], v[52:55]
  v_accvgpr_read_b32 v111, a213
  v_mfma_f32_16x16x32_bf16 v[56:59], a[48:51], v[136:139], v[56:59]
  v_accvgpr_read_b32 v112, a214
  v_mfma_f32_16x16x32_bf16 v[60:63], a[52:55], v[136:139], v[60:63]
  v_accvgpr_read_b32 v113, a215
  v_mfma_f32_16x16x32_bf16 v[64:67], a[56:59], v[136:139], v[64:67]
  s_waitcnt vmcnt(7)
  v_mfma_f32_16x16x32_bf16 v[48:51], a[60:63], v[140:143], v[48:51]
  buffer_load_dwordx4 v[172:175], v2, s[60:63], s17 offen offset:1024 sc1
  v_mfma_f32_16x16x32_bf16 v[52:55], a[64:67], v[140:143], v[52:55]
  v_accvgpr_read_b32 v114, a216
  v_mfma_f32_16x16x32_bf16 v[56:59], a[68:71], v[140:143], v[56:59]
  v_accvgpr_read_b32 v115, a217
  v_mfma_f32_16x16x32_bf16 v[60:63], a[72:75], v[140:143], v[60:63]
  v_accvgpr_read_b32 v116, a218
  v_mfma_f32_16x16x32_bf16 v[64:67], a[76:79], v[140:143], v[64:67]
  s_waitcnt vmcnt(7)
  v_mfma_f32_16x16x32_bf16 v[48:51], a[80:83], v[144:147], v[48:51]
  buffer_load_dwordx4 v[176:179], v2, s[60:63], s17 offen offset:2048 sc1
  v_mfma_f32_16x16x32_bf16 v[52:55], a[84:87], v[144:147], v[52:55]
  v_accvgpr_read_b32 v117, a219
  v_mfma_f32_16x16x32_bf16 v[56:59], a[88:91], v[144:147], v[56:59]
  v_accvgpr_read_b32 v118, a220
  v_mfma_f32_16x16x32_bf16 v[60:63], a[92:95], v[144:147], v[60:63]
  v_accvgpr_read_b32 v119, a221
  v_mfma_f32_16x16x32_bf16 v[64:67], a[96:99], v[144:147], v[64:67]
  s_waitcnt vmcnt(7)
  v_mfma_f32_16x16x32_bf16 v[48:51], a[100:103], v[148:151], v[48:51]
  buffer_load_dwordx4 v[180:183], v2, s[60:63], s17 offen offset:3072 sc1
  v_mfma_f32_16x16x32_bf16 v[52:55], a[104:107], v[148:151], v[52:55]
  v_accvgpr_read_b32 v120, a222
  v_mfma_f32_16x16x32_bf16 v[56:59], a[108:111], v[148:151], v[56:59]
  v_accvgpr_read_b32 v121, a223
  v_mfma_f32_16x16x32_bf16 v[60:63], a[112:115], v[148:151], v[60:63]
  v_accvgpr_read_b32 v122, a224
  v_mfma_f32_16x16x32_bf16 v[64:67], a[116:119], v[148:151], v[64:67]
  s_waitcnt vmcnt(7)
  v_mfma_f32_16x16x32_bf16 v[48:51], a[120:123], v[152:155], v[48:51]
  s_add_u32 s17, s17, 4096
  buffer_load_dwordx4 v[184:187], v2, s[60:63], s17 offen offset:0 sc1
  v_mfma_f32_16x16x32_bf16 v[52:55], a[124:127], v[152:155], v[52:55]
  v_accvgpr_read_b32 v123, a225
  v_mfma_f32_16x16x32_bf16 v[56:59], a[128:131], v[152:155], v[56:59]
  v_accvgpr_read_b32 v124, a226
  v_mfma_f32_16x16x32_bf16 v[60:63], a[132:135], v[152:155], v[60:63]
  v_accvgpr_read_b32 v125, a227
  v_mfma_f32_16x16x32_bf16 v[64:67], a[136:139], v[152:155], v[64:67]
  s_waitcnt vmcnt(7)
  v_mfma_f32_16x16x32_bf16 v[48:51], a[140:143], v[156:159], v[48:51]
  buffer_load_dwordx4 v[188:191], v2, s[60:63], s17 offen offset:1024 sc1
  v_mfma_f32_16x16x32_bf16 v[52:55], a[144:147], v[156:159], v[52:55]
  v_accvgpr_read_b32 v126, a228
  v_mfma_f32_16x16x32_bf16 v[56:59], a[148:151], v[156:159], v[56:59]
  v_accvgpr_read_b32 v127, a229
  v_mfma_f32_16x16x32_bf16 v[60:63], a[152:155], v[156:159], v[60:63]
  v_lshlrev_b32_e64 v88, 16, v232
  v_mfma_f32_16x16x32_bf16 v[64:67], a[156:159], v[156:159], v[64:67]
  s_waitcnt vmcnt(7)
  v_mfma_f32_16x16x32_bf16 v[48:51], a[160:163], v[160:163], v[48:51]
  buffer_load_dwordx4 v[128:131], v2, s[60:63], s17 offen offset:2048 sc1
  v_mfma_f32_16x16x32_bf16 v[52:55], a[164:167], v[160:163], v[52:55]
  v_and_b32 v89, 0xffff0000, v232
  v_mfma_f32_16x16x32_bf16 v[56:59], a[168:171], v[160:163], v[56:59]
  v_lshlrev_b32 v90, 16, v233
  v_mfma_f32_16x16x32_bf16 v[60:63], a[172:175], v[160:163], v[60:63]
  v_and_b32 v91, 0xffff0000, v233
  v_mfma_f32_16x16x32_bf16 v[64:67], a[176:179], v[160:163], v[64:67]
  s_waitcnt vmcnt(7)
  v_mfma_f32_16x16x32_bf16 v[48:51], a[180:183], v[164:167], v[48:51]
  buffer_load_dwordx4 v[132:135], v2, s[60:63], s17 offen offset:3072 sc1
  v_mfma_f32_16x16x32_bf16 v[52:55], a[184:187], v[164:167], v[52:55]
  v_lshlrev_b32 v92, 16, v234
  v_mfma_f32_16x16x32_bf16 v[56:59], a[188:191], v[164:167], v[56:59]
  v_and_b32 v93, 0xffff0000, v234
  v_mfma_f32_16x16x32_bf16 v[60:63], a[192:195], v[164:167], v[60:63]
  v_lshlrev_b32_e64 v94, 16, v235
  v_mfma_f32_16x16x32_bf16 v[64:67], a[196:199], v[164:167], v[64:67]
  s_waitcnt vmcnt(7)
  v_mfma_f32_16x16x32_bf16 v[68:71], a[0:3], v[168:171], 0
  s_add_u32 s17, s17, 4096
  buffer_load_dwordx4 v[136:139], v2, s[60:63], s17 offen offset:0 sc1
  v_mfma_f32_16x16x32_bf16 v[72:75], a[4:7], v[168:171], 0
  v_and_b32 v95, 0xffff0000, v235
  v_mfma_f32_16x16x32_bf16 v[76:79], a[8:11], v[168:171], 0
  v_lshlrev_b32 v96, 16, v236
  v_mfma_f32_16x16x32_bf16 v[80:83], a[12:15], v[168:171], 0
  v_and_b32 v97, 0xffff0000, v236
  v_mfma_f32_16x16x32_bf16 v[84:87], a[16:19], v[168:171], 0
  s_waitcnt vmcnt(7)
  v_mfma_f32_16x16x32_bf16 v[68:71], a[20:23], v[172:175], v[68:71]
  ds_write_b128 v44, v[48:51] offset:0
  ds_write_b128 v44, v[52:55] offset:1024
  v_mfma_f32_16x16x32_bf16 v[72:75], a[24:27], v[172:175], v[72:75]
  buffer_load_dwordx4 v[140:143], v2, s[60:63], s17 offen offset:1024 sc1
  v_mfma_f32_16x16x32_bf16 v[76:79], a[28:31], v[172:175], v[76:79]
  v_lshlrev_b32 v98, 16, v237
  v_mfma_f32_16x16x32_bf16 v[80:83], a[32:35], v[172:175], v[80:83]
  v_and_b32 v99, 0xffff0000, v237
  v_mfma_f32_16x16x32_bf16 v[84:87], a[36:39], v[172:175], v[84:87]
  v_lshlrev_b32 v100, 16, v238
  s_waitcnt vmcnt(7)
  v_mfma_f32_16x16x32_bf16 v[68:71], a[40:43], v[176:179], v[68:71]
  ds_write_b128 v44, v[56:59] offset:2048
  ds_write_b128 v44, v[60:63] offset:3072
  v_mfma_f32_16x16x32_bf16 v[72:75], a[44:47], v[176:179], v[72:75]
  buffer_load_dwordx4 v[144:147], v2, s[60:63], s18 offen offset:0 sc1
  v_mfma_f32_16x16x32_bf16 v[76:79], a[48:51], v[176:179], v[76:79]
  v_and_b32 v101, 0xffff0000, v238
  v_mfma_f32_16x16x32_bf16 v[80:83], a[52:55], v[176:179], v[80:83]
  v_lshlrev_b32_e64 v102, 16, v239
  v_mfma_f32_16x16x32_bf16 v[84:87], a[56:59], v[176:179], v[84:87]
  v_and_b32 v103, 0xffff0000, v239
  s_waitcnt vmcnt(7)
  v_mfma_f32_16x16x32_bf16 v[68:71], a[60:63], v[180:183], v[68:71]
  ds_write_b128 v44, v[64:67] offset:4096
  v_mfma_f32_16x16x32_bf16 v[72:75], a[64:67], v[180:183], v[72:75]
  buffer_load_dwordx4 v[148:151], v2, s[60:63], s18 offen offset:1024 sc1
  v_mfma_f32_16x16x32_bf16 v[76:79], a[68:71], v[180:183], v[76:79]
  v_lshlrev_b32 v104, 16, v240
  v_mfma_f32_16x16x32_bf16 v[80:83], a[72:75], v[180:183], v[80:83]
  v_and_b32 v105, 0xffff0000, v240
  v_mfma_f32_16x16x32_bf16 v[84:87], a[76:79], v[180:183], v[84:87]
  v_lshlrev_b32 v106, 16, v241
  s_waitcnt vmcnt(7)
  v_mfma_f32_16x16x32_bf16 v[68:71], a[80:83], v[184:187], v[68:71]
  buffer_load_dwordx4 v[152:155], v2, s[60:63], s18 offen offset:2048 sc1
  v_mfma_f32_16x16x32_bf16 v[72:75], a[84:87], v[184:187], v[72:75]
  v_and_b32 v107, 0xffff0000, v241
  v_mfma_f32_16x16x32_bf16 v[76:79], a[88:91], v[184:187], v[76:79]
  v_mfma_f32_16x16x32_bf16 v[80:83], a[92:95], v[184:187], v[80:83]
  v_mfma_f32_16x16x32_bf16 v[84:87], a[96:99], v[184:187], v[84:87]
  s_waitcnt vmcnt(7)
  v_mfma_f32_16x16x32_bf16 v[68:71], a[100:103], v[188:191], v[68:71]
  buffer_load_dwordx4 v[156:159], v2, s[60:63], s18 offen offset:3072 sc1
  v_mfma_f32_16x16x32_bf16 v[72:75], a[104:107], v[188:191], v[72:75]
  v_mfma_f32_16x16x32_bf16 v[76:79], a[108:111], v[188:191], v[76:79]
  v_mfma_f32_16x16x32_bf16 v[80:83], a[112:115], v[188:191], v[80:83]
  v_mfma_f32_16x16x32_bf16 v[84:87], a[116:119], v[188:191], v[84:87]
  s_waitcnt vmcnt(7)
  v_mfma_f32_16x16x32_bf16 v[68:71], a[120:123], v[128:131], v[68:71]
  s_add_u32 s18, s18, 4096
  buffer_load_dwordx4 v[160:163], v2, s[60:63], s18 offen offset:0 sc1
  v_mfma_f32_16x16x32_bf16 v[72:75], a[124:127], v[128:131], v[72:75]
  s_mul_i32 s15, s7, 10240
  v_mfma_f32_16x16x32_bf16 v[76:79], a[128:131], v[128:131], v[76:79]
  s_add_u32 s15, s15, 102400
  v_mfma_f32_16x16x32_bf16 v[80:83], a[132:135], v[128:131], v[80:83]
  v_add_u32_e64 v47, s15, v2
  v_mfma_f32_16x16x32_bf16 v[84:87], a[136:139], v[128:131], v[84:87]
  s_waitcnt vmcnt(7)
  v_mfma_f32_16x16x32_bf16 v[68:71], a[140:143], v[132:135], v[68:71]
  buffer_load_dwordx4 v[164:167], v2, s[60:63], s18 offen offset:1024 sc1
  v_mfma_f32_16x16x32_bf16 v[72:75], a[144:147], v[132:135], v[72:75]
  v_mfma_f32_16x16x32_bf16 v[76:79], a[148:151], v[132:135], v[76:79]
  v_mfma_f32_16x16x32_bf16 v[80:83], a[152:155], v[132:135], v[80:83]
  v_mfma_f32_16x16x32_bf16 v[84:87], a[156:159], v[132:135], v[84:87]
  s_waitcnt vmcnt(7)
  v_mfma_f32_16x16x32_bf16 v[68:71], a[160:163], v[136:139], v[68:71]
  buffer_load_dwordx4 v[168:171], v2, s[60:63], s18 offen offset:2048 sc1
  v_mfma_f32_16x16x32_bf16 v[72:75], a[164:167], v[136:139], v[72:75]
  v_mfma_f32_16x16x32_bf16 v[76:79], a[168:171], v[136:139], v[76:79]
  v_mfma_f32_16x16x32_bf16 v[80:83], a[172:175], v[136:139], v[80:83]
  v_mfma_f32_16x16x32_bf16 v[84:87], a[176:179], v[136:139], v[84:87]
  s_waitcnt vmcnt(7)
  v_mfma_f32_16x16x32_bf16 v[68:71], a[180:183], v[140:143], v[68:71]
  buffer_load_dwordx4 v[172:175], v2, s[60:63], s18 offen offset:3072 sc1
  v_mfma_f32_16x16x32_bf16 v[72:75], a[184:187], v[140:143], v[72:75]
  v_mfma_f32_16x16x32_bf16 v[76:79], a[188:191], v[140:143], v[76:79]
  v_mfma_f32_16x16x32_bf16 v[80:83], a[192:195], v[140:143], v[80:83]
  v_mfma_f32_16x16x32_bf16 v[84:87], a[196:199], v[140:143], v[84:87]
  s_waitcnt vmcnt(7)
  v_mfma_f32_16x16x32_bf16 v[48:51], a[0:3], v[144:147], 0
  s_add_u32 s18, s18, 4096
  buffer_load_dwordx4 v[176:179], v2, s[60:63], s18 offen offset:0 sc1
  v_mfma_f32_16x16x32_bf16 v[52:55], a[4:7], v[144:147], 0
  v_mfma_f32_16x16x32_bf16 v[56:59], a[8:11], v[144:147], 0
  v_mfma_f32_16x16x32_bf16 v[60:63], a[12:15], v[144:147], 0
  v_mfma_f32_16x16x32_bf16 v[64:67], a[16:19], v[144:147], 0
  s_waitcnt vmcnt(7)
  v_mfma_f32_16x16x32_bf16 v[48:51], a[20:23], v[148:151], v[48:51]
  ds_write_b128 v45, v[68:71] offset:0
  v_mfma_f32_16x16x32_bf16 v[52:55], a[24:27], v[148:151], v[52:55]
  ds_write_b128 v45, v[72:75] offset:1024
  v_mfma_f32_16x16x32_bf16 v[56:59], a[28:31], v[148:151], v[56:59]
  buffer_load_dwordx4 v[180:183], v2, s[60:63], s18 offen offset:1024 sc1
  v_mfma_f32_16x16x32_bf16 v[60:63], a[32:35], v[148:151], v[60:63]
  v_mfma_f32_16x16x32_bf16 v[64:67], a[36:39], v[148:151], v[64:67]
  s_waitcnt vmcnt(7)
  v_mfma_f32_16x16x32_bf16 v[48:51], a[40:43], v[152:155], v[48:51]
  ds_write_b128 v45, v[76:79] offset:2048
  v_mfma_f32_16x16x32_bf16 v[52:55], a[44:47], v[152:155], v[52:55]
  ds_write_b128 v45, v[80:83] offset:3072
  v_mfma_f32_16x16x32_bf16 v[56:59], a[48:51], v[152:155], v[56:59]
  buffer_load_dwordx4 v[184:187], v2, s[60:63], s19 offen offset:0 sc1
  v_mfma_f32_16x16x32_bf16 v[60:63], a[52:55], v[152:155], v[60:63]
  v_mfma_f32_16x16x32_bf16 v[64:67], a[56:59], v[152:155], v[64:67]
  s_waitcnt vmcnt(7)
  v_mfma_f32_16x16x32_bf16 v[48:51], a[60:63], v[156:159], v[48:51]
  ds_write_b128 v45, v[84:87] offset:4096
  v_mfma_f32_16x16x32_bf16 v[52:55], a[64:67], v[156:159], v[52:55]
  buffer_load_dwordx4 v[188:191], v2, s[60:63], s19 offen offset:1024 sc1
  v_mfma_f32_16x16x32_bf16 v[56:59], a[68:71], v[156:159], v[56:59]
  v_mfma_f32_16x16x32_bf16 v[60:63], a[72:75], v[156:159], v[60:63]
  v_mfma_f32_16x16x32_bf16 v[64:67], a[76:79], v[156:159], v[64:67]
  s_waitcnt vmcnt(7)
  v_mfma_f32_16x16x32_bf16 v[48:51], a[80:83], v[160:163], v[48:51]
  buffer_load_dwordx4 v[128:131], v2, s[60:63], s19 offen offset:2048 sc1
  s_waitcnt lgkmcnt(0)
  s_barrier
  v_mfma_f32_16x16x32_bf16 v[52:55], a[84:87], v[160:163], v[52:55]
  ds_read_b128 v[192:195], v47 offset:0
  ds_read_b128 v[196:199], v47 offset:1024
  v_mfma_f32_16x16x32_bf16 v[56:59], a[88:91], v[160:163], v[56:59]
  ds_read_b128 v[200:203], v47 offset:2048
  ds_read_b128 v[204:207], v47 offset:3072
  v_mfma_f32_16x16x32_bf16 v[60:63], a[92:95], v[160:163], v[60:63]
  ds_read_b128 v[208:211], v47 offset:4096
  ds_read_b128 v[212:215], v47 offset:5120
  v_mfma_f32_16x16x32_bf16 v[64:67], a[96:99], v[160:163], v[64:67]
  ds_read_b128 v[216:219], v47 offset:6144
  ds_read_b128 v[220:223], v47 offset:7168
  s_waitcnt vmcnt(7)
  v_mfma_f32_16x16x32_bf16 v[48:51], a[100:103], v[164:167], v[48:51]
  buffer_load_dwordx4 v[132:135], v2, s[60:63], s19 offen offset:3072 sc1
  ds_read_b128 v[224:227], v47 offset:8192
  v_mfma_f32_16x16x32_bf16 v[52:55], a[104:107], v[164:167], v[52:55]
  ds_read_b128 v[228:231], v47 offset:9216
  s_waitcnt lgkmcnt(5)
  v_mfma_f32_16x16x32_bf16 v[56:59], a[108:111], v[164:167], v[56:59]
  v_add_f32 v108, v108, v192
  v_add_f32 v109, v109, v193
  v_mfma_f32_16x16x32_bf16 v[60:63], a[112:115], v[164:167], v[60:63]
  v_add_f32 v110, v110, v194
  v_add_f32 v111, v111, v195
  v_mfma_f32_16x16x32_bf16 v[64:67], a[116:119], v[164:167], v[64:67]
  v_add_f32 v112, v112, v196
  v_add_f32 v113, v113, v197
  s_waitcnt vmcnt(7)
  v_mfma_f32_16x16x32_bf16 v[48:51], a[120:123], v[168:171], v[48:51]
  s_add_u32 s19, s19, 4096
  buffer_load_dwordx4 v[136:139], v2, s[60:63], s19 offen offset:0 sc1
  v_add_f32 v114, v114, v198
  v_mfma_f32_16x16x32_bf16 v[52:55], a[124:127], v[168:171], v[52:55]
  v_add_f32 v115, v115, v199
  v_add_f32 v116, v116, v200
  v_mfma_f32_16x16x32_bf16 v[56:59], a[128:131], v[168:171], v[56:59]
  v_add_f32 v117, v117, v201
  v_add_f32 v118, v118, v202
  v_mfma_f32_16x16x32_bf16 v[60:63], a[132:135], v[168:171], v[60:63]
  v_add_f32 v119, v119, v203
  v_add_f32 v120, v120, v204
  v_mfma_f32_16x16x32_bf16 v[64:67], a[136:139], v[168:171], v[64:67]
  v_add_f32 v121, v121, v205
  v_add_f32 v122, v122, v206
  s_waitcnt vmcnt(7)
  v_mfma_f32_16x16x32_bf16 v[48:51], a[140:143], v[172:175], v[48:51]
  buffer_load_dwordx4 v[140:143], v2, s[60:63], s19 offen offset:1024 sc1
  v_add_f32 v123, v123, v207
  v_mfma_f32_16x16x32_bf16 v[52:55], a[144:147], v[172:175], v[52:55]
  v_add_f32 v124, v124, v208
  v_add_f32 v125, v125, v209
  v_mfma_f32_16x16x32_bf16 v[56:59], a[148:151], v[172:175], v[56:59]
  v_add_f32 v126, v126, v210
  v_add_f32 v127, v127, v211
  v_mfma_f32_16x16x32_bf16 v[60:63], a[152:155], v[172:175], v[60:63]
  s_waitcnt lgkmcnt(0)
  v_add_f32 v108, v108, v212
  v_mfma_f32_16x16x32_bf16 v[64:67], a[156:159], v[172:175], v[64:67]
  v_add_f32 v109, v109, v213
  v_add_f32 v110, v110, v214
  s_waitcnt vmcnt(7)
  v_mfma_f32_16x16x32_bf16 v[48:51], a[160:163], v[176:179], v[48:51]
  buffer_load_dwordx4 v[144:147], v2, s[60:63], s19 offen offset:2048 sc1
  v_add_f32 v111, v111, v215
  v_mfma_f32_16x16x32_bf16 v[52:55], a[164:167], v[176:179], v[52:55]
  v_add_f32 v112, v112, v216
  v_add_f32 v113, v113, v217
  v_mfma_f32_16x16x32_bf16 v[56:59], a[168:171], v[176:179], v[56:59]
  v_add_f32 v114, v114, v218
  v_add_f32 v115, v115, v219
  v_mfma_f32_16x16x32_bf16 v[60:63], a[172:175], v[176:179], v[60:63]
  v_add_f32 v116, v116, v220
  v_add_f32 v117, v117, v221
  v_mfma_f32_16x16x32_bf16 v[64:67], a[176:179], v[176:179], v[64:67]
  v_add_f32 v118, v118, v222
  v_add_f32 v119, v119, v223
  s_waitcnt vmcnt(7)
  v_mfma_f32_16x16x32_bf16 v[48:51], a[180:183], v[180:183], v[48:51]
  buffer_load_dwordx4 v[148:151], v2, s[60:63], s19 offen offset:3072 sc1
  v_add_f32 v120, v120, v224
  v_mfma_f32_16x16x32_bf16 v[52:55], a[184:187], v[180:183], v[52:55]
  v_add_f32 v121, v121, v225
  v_add_f32 v122, v122, v226
  v_mfma_f32_16x16x32_bf16 v[56:59], a[188:191], v[180:183], v[56:59]
  v_add_f32 v123, v123, v227
  v_add_f32 v124, v124, v228
  v_mfma_f32_16x16x32_bf16 v[60:63], a[192:195], v[180:183], v[60:63]
  v_add_f32 v125, v125, v229
  v_add_f32 v126, v126, v230
  v_mfma_f32_16x16x32_bf16 v[64:67], a[196:199], v[180:183], v[64:67]
  v_add_f32 v127, v127, v231
  s_waitcnt vmcnt(7)
  v_mfma_f32_16x16x32_bf16 v[68:71], a[0:3], v[184:187], v[108:111]
  s_add_u32 s19, s19, 4096
  buffer_load_dwordx4 v[152:155], v2, s[60:63], s19 offen offset:0 sc1
  v_mfma_f32_16x16x32_bf16 v[72:75], a[4:7], v[184:187], v[112:115]
  v_mfma_f32_16x16x32_bf16 v[76:79], a[8:11], v[184:187], v[116:119]
  v_mfma_f32_16x16x32_bf16 v[80:83], a[12:15], v[184:187], v[120:123]
  v_mfma_f32_16x16x32_bf16 v[84:87], a[16:19], v[184:187], v[124:127]
  s_waitcnt vmcnt(7)
  v_mfma_f32_16x16x32_bf16 v[68:71], a[20:23], v[188:191], v[68:71]
  ds_write_b128 v46, v[48:51] offset:0
  v_mfma_f32_16x16x32_bf16 v[72:75], a[24:27], v[188:191], v[72:75]
  ds_write_b128 v46, v[52:55] offset:1024
  v_mfma_f32_16x16x32_bf16 v[76:79], a[28:31], v[188:191], v[76:79]
  buffer_load_dwordx4 v[156:159], v2, s[60:63], s19 offen offset:1024 sc1
  v_mfma_f32_16x16x32_bf16 v[80:83], a[32:35], v[188:191], v[80:83]
  v_mfma_f32_16x16x32_bf16 v[84:87], a[36:39], v[188:191], v[84:87]
  s_waitcnt vmcnt(7)
  v_mfma_f32_16x16x32_bf16 v[68:71], a[40:43], v[128:131], v[68:71]
  ds_write_b128 v46, v[56:59] offset:2048
  v_mfma_f32_16x16x32_bf16 v[72:75], a[44:47], v[128:131], v[72:75]
  ds_write_b128 v46, v[60:63] offset:3072
  v_mfma_f32_16x16x32_bf16 v[76:79], a[48:51], v[128:131], v[76:79]
  v_mfma_f32_16x16x32_bf16 v[80:83], a[52:55], v[128:131], v[80:83]
  v_mfma_f32_16x16x32_bf16 v[84:87], a[56:59], v[128:131], v[84:87]
  s_waitcnt vmcnt(6)
  v_mfma_f32_16x16x32_bf16 v[68:71], a[60:63], v[132:135], v[68:71]
  ds_write_b128 v46, v[64:67] offset:4096
  v_mfma_f32_16x16x32_bf16 v[72:75], a[64:67], v[132:135], v[72:75]
  v_mfma_f32_16x16x32_bf16 v[76:79], a[68:71], v[132:135], v[76:79]
  v_mfma_f32_16x16x32_bf16 v[80:83], a[72:75], v[132:135], v[80:83]
  v_mfma_f32_16x16x32_bf16 v[84:87], a[76:79], v[132:135], v[84:87]
  s_waitcnt vmcnt(5)
  v_mfma_f32_16x16x32_bf16 v[68:71], a[80:83], v[136:139], v[68:71]
  s_mul_i32 s15, s7, 5120
  v_mfma_f32_16x16x32_bf16 v[72:75], a[84:87], v[136:139], v[72:75]
  v_add_u32_e64 v47, s15, v2
  v_mfma_f32_16x16x32_bf16 v[76:79], a[88:91], v[136:139], v[76:79]
  v_mfma_f32_16x16x32_bf16 v[80:83], a[92:95], v[136:139], v[80:83]
  v_mfma_f32_16x16x32_bf16 v[84:87], a[96:99], v[136:139], v[84:87]
  s_waitcnt vmcnt(4)
  v_mfma_f32_16x16x32_bf16 v[68:71], a[100:103], v[140:143], v[68:71]
  s_waitcnt vmcnt(0)
  s_waitcnt lgkmcnt(0)
  s_barrier
  ds_read_b128 v[192:195], v47 offset:0
  v_mfma_f32_16x16x32_bf16 v[72:75], a[104:107], v[140:143], v[72:75]
  ds_read_b128 v[196:199], v47 offset:1024
  v_mfma_f32_16x16x32_bf16 v[76:79], a[108:111], v[140:143], v[76:79]
  ds_read_b128 v[200:203], v47 offset:2048
  v_mfma_f32_16x16x32_bf16 v[80:83], a[112:115], v[140:143], v[80:83]
  ds_read_b128 v[204:207], v47 offset:3072
  v_mfma_f32_16x16x32_bf16 v[84:87], a[116:119], v[140:143], v[84:87]
  ds_read_b128 v[208:211], v47 offset:4096
  v_mfma_f32_16x16x32_bf16 v[68:71], a[120:123], v[144:147], v[68:71]
  v_mfma_f32_16x16x32_bf16 v[72:75], a[124:127], v[144:147], v[72:75]
  v_mfma_f32_16x16x32_bf16 v[76:79], a[128:131], v[144:147], v[76:79]
  v_mfma_f32_16x16x32_bf16 v[80:83], a[132:135], v[144:147], v[80:83]
  v_mfma_f32_16x16x32_bf16 v[84:87], a[136:139], v[144:147], v[84:87]
  v_mfma_f32_16x16x32_bf16 v[68:71], a[140:143], v[148:151], v[68:71]
  s_lshl_b32 s12, s5, 15
  s_lshl_b32 s13, s7, 8
  v_mfma_f32_16x16x32_bf16 v[72:75], a[144:147], v[148:151], v[72:75]
  s_add_u32 s12, s12, s13
  v_mfma_f32_16x16x32_bf16 v[76:79], a[148:151], v[148:151], v[76:79]
  s_add_u32 s12, s12, 1312768
  v_mfma_f32_16x16x32_bf16 v[80:83], a[152:155], v[148:151], v[80:83]
  s_lshl_b32 s13, s6, 12
  v_mfma_f32_16x16x32_bf16 v[84:87], a[156:159], v[148:151], v[84:87]
  s_add_u32 s13, s13, s12
  v_mfma_f32_16x16x32_bf16 v[68:71], a[160:163], v[152:155], v[68:71]
  v_mfma_f32_16x16x32_bf16 v[72:75], a[164:167], v[152:155], v[72:75]
  v_mfma_f32_16x16x32_bf16 v[76:79], a[168:171], v[152:155], v[76:79]
  v_mfma_f32_16x16x32_bf16 v[80:83], a[172:175], v[152:155], v[80:83]
  v_mfma_f32_16x16x32_bf16 v[84:87], a[176:179], v[152:155], v[84:87]
  v_mfma_f32_16x16x32_bf16 v[68:71], a[180:183], v[156:159], v[68:71]
  v_mfma_f32_16x16x32_bf16 v[72:75], a[184:187], v[156:159], v[72:75]
  v_mfma_f32_16x16x32_bf16 v[76:79], a[188:191], v[156:159], v[76:79]
  v_mfma_f32_16x16x32_bf16 v[80:83], a[192:195], v[156:159], v[80:83]
  v_mfma_f32_16x16x32_bf16 v[84:87], a[196:199], v[156:159], v[84:87]
  s_waitcnt lgkmcnt(0)
  s_nop 2
  v_pk_add_f32 v[68:69], v[68:69], v[192:193]
  v_pk_add_f32 v[70:71], v[70:71], v[194:195]
  v_pk_add_f32 v[72:73], v[72:73], v[196:197]
  v_pk_add_f32 v[74:75], v[74:75], v[198:199]
  v_pk_add_f32 v[76:77], v[76:77], v[200:201]
  v_pk_add_f32 v[78:79], v[78:79], v[202:203]
  v_pk_add_f32 v[80:81], v[80:81], v[204:205]
  v_pk_add_f32 v[82:83], v[82:83], v[206:207]
  v_pk_add_f32 v[84:85], v[84:85], v[208:209]
  v_pk_add_f32 v[86:87], v[86:87], v[210:211]
  v_pk_add_f32 v[212:213], v[68:69], v[70:71]
  v_pk_mul_f32 v[214:215], v[68:69], v[68:69]
  v_pk_fma_f32 v[214:215], v[70:71], v[70:71], v[214:215]
  v_pk_add_f32 v[212:213], v[212:213], v[72:73]
  v_pk_fma_f32 v[214:215], v[72:73], v[72:73], v[214:215]
  v_pk_add_f32 v[212:213], v[212:213], v[74:75]
  v_pk_fma_f32 v[214:215], v[74:75], v[74:75], v[214:215]
  v_pk_add_f32 v[212:213], v[212:213], v[76:77]
  v_pk_fma_f32 v[214:215], v[76:77], v[76:77], v[214:215]
  v_pk_add_f32 v[212:213], v[212:213], v[78:79]
  v_pk_fma_f32 v[214:215], v[78:79], v[78:79], v[214:215]
  v_pk_add_f32 v[212:213], v[212:213], v[80:81]
  v_pk_fma_f32 v[214:215], v[80:81], v[80:81], v[214:215]
  v_pk_add_f32 v[212:213], v[212:213], v[82:83]
  v_pk_fma_f32 v[214:215], v[82:83], v[82:83], v[214:215]
  v_pk_add_f32 v[212:213], v[212:213], v[84:85]
  v_pk_fma_f32 v[214:215], v[84:85], v[84:85], v[214:215]
  v_pk_add_f32 v[212:213], v[212:213], v[86:87]
  v_pk_fma_f32 v[214:215], v[86:87], v[86:87], v[214:215]
  v_add_f32 v228, v212, v213
  v_add_f32 v229, v214, v215
  v_mov_b32 v230, s8
  v_mov_b32 v231, s8
  v_mov_b32 v212, v228
  v_mov_b32 v213, v229
  s_nop 0
  v_permlane32_swap_b32 v228, v212
  v_permlane32_swap_b32 v229, v213
  v_add_f32 v228, v228, v212
  v_add_f32 v229, v229, v213
  v_mov_b32 v212, v228
  v_mov_b32 v213, v229
  s_nop 0
  v_permlane16_swap_b32 v228, v212
  v_permlane16_swap_b32 v229, v213
  v_add_f32 v228, v228, v212
  v_add_f32_e64 v229, v229, v213
  s_mov_b64 exec, 0xffff
  s_cmp_eq_u32 s9, 0
  s_cbranch_scc1 slow_86
  buffer_store_dwordx4 v[228:231], v2, s[52:55], s13 offen
back_87:
  s_mov_b64 exec, -1
  s_mul_i32 s14, s7, 10240
  s_add_u32 s14, s14, 102400
  v_lshrrev_b32 v12, 1, v3
  v_xor_b32 v12, v12, v4
  v_and_b32 v12, 3, v12
  v_lshlrev_b32_e64 v12, 4, v12
  v_lshl_add_u32 v12, v3, 6, v12
  v_add_u32_e64 v44, s14, v12
  ds_write_b128 v44, v[68:71] offset:0
  ds_write_b128 v44, v[72:75] offset:1024
  ds_write_b128 v44, v[76:79] offset:2048
  ds_write_b128 v44, v[80:83] offset:3072
  ds_write_b128 v44, v[84:87] offset:4096
  v_lshrrev_b32 v12, 3, v1
  v_xor_b32 v12, v12, v1
  v_and_b32 v12, 3, v12
  v_lshlrev_b32 v12, 4, v12
  v_lshrrev_b32_e64 v13, 2, v1
  v_lshl_add_u32 v12, v13, 6, v12
  v_add_u32_e64 v45, s14, v12
  ds_read_b128 v[160:163], v45 offset:0
  ds_read_b128 v[164:167], v45 offset:1024
  ds_read_b128 v[168:171], v45 offset:2048
  ds_read_b128 v[172:175], v45 offset:3072
  ds_read_b128 v[176:179], v45 offset:4096
  v_and_b32 v14, 3, v1
  v_lshlrev_b32 v11, 13, v14
  v_lshl_add_u32 v11, v13, 4, v11
  s_add_u32 s13, s12, 4096
  v_lshrrev_b32_e64 v12, 2, v13
  v_lshl_add_u32 v12, v12, 2, v13
  v_mul_u32_u24 v12, 2560, v12
  v_lshl_add_u32 v46, v14, 4, v12
  s_lshl_b32 s15, s5, 6
  s_lshr_b32 s88, s7, 1
  s_lshl_b32 s88, s88, 5
  s_add_u32 s15, s15, s88
  s_and_b32 s88, s7, 1
  s_lshl_b32 s88, s88, 2
  s_add_u32 s15, s15, s88
  s_mul_i32 s15, s15, 2560
  s_mul_i32 s88, s6, 320
  s_add_u32 s15, s15, s88
again_88:
  buffer_load_dwordx3 v[128:130], v11, s[52:55], s12 offen sc1
  buffer_load_dwordx3 v[132:134], v11, s[52:55], s13 offen sc1
  s_sub_u32 s10, s10, 1
  s_cmp_gt_i32 s10, 0
  s_waitcnt vmcnt(0)
  v_xor_b32 v15, s8, v130
  v_xor_b32 v14, s8, v134
  v_or_b32 v15, v15, v14
  v_cmp_ne_u32 vcc, 0, v15
  s_cbranch_scc0 out_90
  s_cbranch_vccnz again_88
out_90:
ok_89:
  s_waitcnt lgkmcnt(0)
  v_pk_add_f32 v[128:129], v[128:129], v[132:133]
  s_nop 1
  v_add_f32_dpp v128, v128, v128 quad_perm:[1,0,3,2] row_mask:0xf bank_mask:0xf
  v_add_f32_dpp v129, v129, v129 quad_perm:[1,0,3,2] row_mask:0xf bank_mask:0xf
  s_nop 0
  v_add_f32_dpp v128, v128, v128 quad_perm:[2,3,0,1] row_mask:0xf bank_mask:0xf
  v_add_f32_dpp v129, v129, v129 quad_perm:[2,3,0,1] row_mask:0xf bank_mask:0xf
  v_mul_f32 v128, 0x3acccccd, v128
  v_mul_f32 v202, 0x3acccccd, v129
  v_fma_f32 v202, -v128, v128, v202
  v_max_f32_e64 v202, 0, v202
  v_add_f32 v202, 0x3727c5ac, v202
  v_rsq_f32 v200, v202
  s_nop 0
  v_mul_f32 v201, v128, v200
  s_cmp_eq_u32 s9, 0
  s_cbranch_scc1 slow_91
  v_pk_fma_f32 v[132:133], v[160:161], v[200:201], v[200:201] op_sel:[0,0,1] op_sel_hi:[1,0,1] neg_lo:[0,0,1] neg_hi:[0,0,1]
  v_pk_fma_f32 v[134:135], v[162:163], v[200:201], v[200:201] op_sel:[0,0,1] op_sel_hi:[1,0,1] neg_lo:[0,0,1] neg_hi:[0,0,1]
  v_pk_fma_f32 v[160:161], v[132:133], v[88:89], v[160:161]
  v_pk_fma_f32 v[162:163], v[134:135], v[90:91], v[162:163]
  buffer_store_dwordx4 v[160:163], v46, s[60:63], s15 offen offset:0
  v_pk_fma_f32 v[136:137], v[164:165], v[200:201], v[200:201] op_sel:[0,0,1] op_sel_hi:[1,0,1] neg_lo:[0,0,1] neg_hi:[0,0,1]
  v_pk_fma_f32 v[138:139], v[166:167], v[200:201], v[200:201] op_sel:[0,0,1] op_sel_hi:[1,0,1] neg_lo:[0,0,1] neg_hi:[0,0,1]
  v_pk_fma_f32 v[164:165], v[136:137], v[92:93], v[164:165]
  v_pk_fma_f32 v[166:167], v[138:139], v[94:95], v[166:167]
  buffer_store_dwordx4 v[164:167], v46, s[60:63], s15 offen offset:64
  v_pk_fma_f32 v[132:133], v[168:169], v[200:201], v[200:201] op_sel:[0,0,1] op_sel_hi:[1,0,1] neg_lo:[0,0,1] neg_hi:[0,0,1]
  v_pk_fma_f32 v[134:135], v[170:171], v[200:201], v[200:201] op_sel:[0,0,1] op_sel_hi:[1,0,1] neg_lo:[0,0,1] neg_hi:[0,0,1]
  v_pk_fma_f32 v[168:169], v[132:133], v[96:97], v[168:169]
  v_pk_fma_f32 v[170:171], v[134:135], v[98:99], v[170:171]
  buffer_store_dwordx4 v[168:171], v46, s[60:63], s15 offen offset:128
  v_pk_fma_f32 v[136:137], v[172:173], v[200:201], v[200:201] op_sel:[0,0,1] op_sel_hi:[1,0,1] neg_lo:[0,0,1] neg_hi:[0,0,1]
  v_pk_fma_f32 v[138:139], v[174:175], v[200:201], v[200:201] op_sel:[0,0,1] op_sel_hi:[1,0,1] neg_lo:[0,0,1] neg_hi:[0,0,1]
  v_pk_fma_f32 v[172:173], v[136:137], v[100:101], v[172:173]
  v_pk_fma_f32 v[174:175], v[138:139], v[102:103], v[174:175]
  buffer_store_dwordx4 v[172:175], v46, s[60:63], s15 offen offset:192
  v_pk_fma_f32 v[132:133], v[176:177], v[200:201], v[200:201] op_sel:[0,0,1] op_sel_hi:[1,0,1] neg_lo:[0,0,1] neg_hi:[0,0,1]
  v_pk_fma_f32 v[134:135], v[178:179], v[200:201], v[200:201] op_sel:[0,0,1] op_sel_hi:[1,0,1] neg_lo:[0,0,1] neg_hi:[0,0,1]
  v_pk_fma_f32 v[176:177], v[132:133], v[104:105], v[176:177]
  v_pk_fma_f32 v[178:179], v[134:135], v[106:107], v[178:179]
  buffer_store_dwordx4 v[176:179], v46, s[60:63], s15 offen offset:256
back_92:
L_end:
  s_endpgm
again_13:
  s_sub_u32 s10, s10, 1
  s_cmp_gt_i32 s10, 0
  s_cbranch_scc0 ok_14
  buffer_load_dword v184, v185, s[52:55], s89 offen sc1
  s_waitcnt vmcnt(0)
  v_xor_b32 v15, s8, v184
  v_cmp_lt_u32 vcc, 15, v15
  s_cbranch_vccz ok_14
  s_and_b32 s13, s10, 3
  s_cbranch_scc1 again_13
  buffer_load_dword v184, v185, s[52:55], s89 offen offset:128 sc1
  s_waitcnt vmcnt(0)
  v_xor_b32 v15, s8, v184
  v_cmp_lt_u32 vcc, 15, v15
  s_cbranch_vccnz again_13
  s_branch ok_14
again_15:
  s_sub_u32 s10, s10, 1
  s_cmp_gt_i32 s10, 0
  s_cbranch_scc0 ok_16
  buffer_load_dword v184, v185, s[52:55], s89 offen sc1
  s_waitcnt vmcnt(0)
  v_xor_b32 v15, s8, v184
  v_cmp_lt_u32 vcc, 15, v15
  s_cbranch_vccz ok_16
  s_and_b32 s13, s10, 3
  s_cbranch_scc1 again_15
  buffer_load_dword v184, v185, s[52:55], s89 offen offset:128 sc1
  s_waitcnt vmcnt(0)
  v_xor_b32 v15, s8, v184
  v_cmp_lt_u32 vcc, 15, v15
  s_cbranch_vccnz again_15
  s_branch ok_16
slow_17:
  buffer_store_dword v15, off, s[52:55], s41 sc1
  s_nop 1
  s_branch back_18
again_19:
  s_sub_u32 s10, s10, 1
  s_cmp_gt_i32 s10, 0
  s_cbranch_scc0 ok_20
  buffer_load_dwordx2 v[188:189], v187, s[52:55], s87 offen sc1
  s_waitcnt vmcnt(0)
  v_xor_b32 v15, s8, v188
  v_xor_b32 v14, s8, v189
  v_or_b32 v15, v15, v14
  v_cmp_ne_u32 vcc, 0, v15
  s_cbranch_vccnz again_19
  s_branch ok_20
again_21:
  s_sub_u32 s10, s10, 1
  s_cmp_gt_i32 s10, 0
  s_cbranch_scc0 ok_22
  buffer_load_dwordx3 v[152:154], v160, s[52:55], s93 offen sc1
  buffer_load_dwordx2 v[156:157], v161, s[52:55], s94 offen sc1
  buffer_load_dwordx2 v[158:159], v162, s[52:55], s94 offen offset:512 sc1
  s_waitcnt vmcnt(0)
  v_min3_u32 v15, v154, v154, s8
  v_max3_u32 v14, v154, v154, s8
  v_min3_u32 v15, v15, v157, v159
  v_max3_u32 v14, v14, v157, v159
  v_cmp_ne_u32 vcc, v15, v14
  s_cbranch_vccnz again_21
  s_branch ok_22
again_23:
  s_sub_u32 s10, s10, 1
  s_cmp_gt_i32 s10, 0
  s_cbranch_scc0 ok_24
  buffer_load_dwordx4 v[220:223], v2, s[52:55], s36 offen sc1
  s_waitcnt vmcnt(0)
  v_min3_u32 v15, v220, v221, s8
  v_max3_u32 v14, v220, v221, s8
  v_min3_u32 v15, v15, v222, v223
  v_max3_u32 v14, v14, v222, v223
  v_cmp_ne_u32 vcc, v15, v14
  s_cbranch_vccnz again_23
  s_branch ok_24
again_25:
  s_sub_u32 s10, s10, 1
  s_cmp_gt_i32 s10, 0
  s_cbranch_scc0 ok_26
  buffer_load_dwordx4 v[188:191], v187, s[52:55], s88 offen sc1
  s_waitcnt vmcnt(0)
  v_min3_u32 v15, v188, v189, s8
  v_max3_u32 v14, v188, v189, s8
  v_min3_u32 v15, v15, v190, v191
  v_max3_u32 v14, v14, v190, v191
  v_cmp_ne_u32 vcc, v15, v14
  s_cbranch_vccnz again_25
  s_branch ok_26
slow_38:
  buffer_store_dword v15, off, s[52:55], s14 sc1
  s_nop 1
  s_branch back_39
slow_41:
  buffer_store_dword v15, off, s[52:55], s14 sc1
  s_nop 1
  s_branch back_42
again_44:
  s_sub_u32 s10, s10, 1
  s_cmp_gt_i32 s10, 0
  s_cbranch_scc0 ok_45
  buffer_load_dwordx4 v[120:123], v2, s[52:55], s92 offen sc1
  s_waitcnt vmcnt(0)
  v_min3_u32 v15, v120, v121, s8
  v_max3_u32 v14, v120, v121, s8
  v_min3_u32 v15, v15, v122, v123
  v_max3_u32 v14, v14, v122, v123
  v_cmp_ne_u32 vcc, v15, v14
  s_cbranch_vccnz again_44
  s_branch ok_45
again_49:
  s_sub_u32 s10, s10, 1
  s_cmp_gt_i32 s10, 0
  s_cbranch_scc0 ok_50
  s_mul_i32 s95, s7, 10240
  s_add_u32 s95, s95, 107520
  s_and_b32 s93, s7, 1
  s_lshl_b32 s93, s93, 3
  s_add_u32 s93, s93, s95
  v_add_u32 v253, s93, v2
  s_add_u32 m0, s95, 0
  s_add_u32 s93, s92, 0
  buffer_load_dwordx4 v252, s[52:55], s93 offen sc1 lds
  s_add_u32 m0, s95, 1024
  s_add_u32 s93, s92, 65536
  buffer_load_dwordx4 v252, s[52:55], s93 offen sc1 lds
  s_add_u32 m0, s95, 2048
  s_add_u32 s93, s92, 131072
  buffer_load_dwordx4 v252, s[52:55], s93 offen sc1 lds
  s_add_u32 m0, s95, 3072
  s_add_u32 s93, s92, 196608
  buffer_load_dwordx4 v252, s[52:55], s93 offen sc1 lds
  s_add_u32 m0, s95, 4096
  s_add_u32 s93, s92, 262144
  buffer_load_dwordx4 v252, s[52:55], s93 offen sc1 lds
  s_waitcnt vmcnt(0)
  ds_read_b64_tr_b16 v[232:233], v253 offset:0
  ds_read_b64_tr_b16 v[234:235], v253 offset:1024
  ds_read_b64_tr_b16 v[236:237], v253 offset:2048
  ds_read_b64_tr_b16 v[238:239], v253 offset:3072
  ds_read_b64_tr_b16 v[240:241], v253 offset:4096
  s_waitcnt lgkmcnt(0)
  s_branch redo_51
slow_52:
  buffer_store_dwordx4 v[228:231], v2, s[52:55], s13 offen sc1
  s_nop 1
  s_branch back_53
slow_57:
  buffer_store_dword v15, off, s[52:55], s13 sc1
  s_nop 1
  s_branch back_58
slow_71:
  buffer_store_dwordx4 v[52:55], v47, s[60:63], s13 offen sc1
  s_nop 1
  s_branch back_72
slow_73:
  buffer_store_dwordx4 v[60:63], v47, s[60:63], s13 offen sc1
  s_nop 1
  s_branch back_74
slow_75:
  buffer_store_dwordx4 v[68:71], v47, s[60:63], s13 offen sc1
  s_nop 1
  s_branch back_76
slow_77:
  buffer_store_dwordx4 v[76:79], v47, s[60:63], s13 offen sc1
  s_nop 1
  s_branch back_78
slow_79:
  buffer_store_dwordx4 v[84:87], v47, s[60:63], s13 offen sc1
  s_nop 1
  s_branch back_80
slow_81:
  buffer_store_dword v15, off, s[52:55], s14 sc1
  s_nop 1
  s_branch back_82
slow_86:
  buffer_store_dwordx4 v[228:231], v2, s[52:55], s13 offen sc1
  s_nop 1
  s_branch back_87
slow_91:
  v_pk_fma_f32 v[132:133], v[160:161], v[200:201], v[200:201] op_sel:[0,0,1] op_sel_hi:[1,0,1] neg_lo:[0,0,1] neg_hi:[0,0,1]
  v_pk_fma_f32 v[134:135], v[162:163], v[200:201], v[200:201] op_sel:[0,0,1] op_sel_hi:[1,0,1] neg_lo:[0,0,1] neg_hi:[0,0,1]
  v_pk_fma_f32 v[160:161], v[132:133], v[88:89], v[160:161]
  v_pk_fma_f32 v[162:163], v[134:135], v[90:91], v[162:163]
  buffer_store_dwordx4 v[160:163], v46, s[60:63], s15 offen offset:0 sc1
  v_pk_fma_f32 v[136:137], v[164:165], v[200:201], v[200:201] op_sel:[0,0,1] op_sel_hi:[1,0,1] neg_lo:[0,0,1] neg_hi:[0,0,1]
  v_pk_fma_f32 v[138:139], v[166:167], v[200:201], v[200:201] op_sel:[0,0,1] op_sel_hi:[1,0,1] neg_lo:[0,0,1] neg_hi:[0,0,1]
  v_pk_fma_f32 v[164:165], v[136:137], v[92:93], v[164:165]
  v_pk_fma_f32 v[166:167], v[138:139], v[94:95], v[166:167]
  buffer_store_dwordx4 v[164:167], v46, s[60:63], s15 offen offset:64 sc1
  v_pk_fma_f32 v[132:133], v[168:169], v[200:201], v[200:201] op_sel:[0,0,1] op_sel_hi:[1,0,1] neg_lo:[0,0,1] neg_hi:[0,0,1]
  v_pk_fma_f32 v[134:135], v[170:171], v[200:201], v[200:201] op_sel:[0,0,1] op_sel_hi:[1,0,1] neg_lo:[0,0,1] neg_hi:[0,0,1]
  v_pk_fma_f32 v[168:169], v[132:133], v[96:97], v[168:169]
  v_pk_fma_f32 v[170:171], v[134:135], v[98:99], v[170:171]
  buffer_store_dwordx4 v[168:171], v46, s[60:63], s15 offen offset:128 sc1
  v_pk_fma_f32 v[136:137], v[172:173], v[200:201], v[200:201] op_sel:[0,0,1] op_sel_hi:[1,0,1] neg_lo:[0,0,1] neg_hi:[0,0,1]
  v_pk_fma_f32 v[138:139], v[174:175], v[200:201], v[200:201] op_sel:[0,0,1] op_sel_hi:[1,0,1] neg_lo:[0,0,1] neg_hi:[0,0,1]
  v_pk_fma_f32 v[172:173], v[136:137], v[100:101], v[172:173]
  v_pk_fma_f32 v[174:175], v[138:139], v[102:103], v[174:175]
  buffer_store_dwordx4 v[172:175], v46, s[60:63], s15 offen offset:192 sc1
  v_pk_fma_f32 v[132:133], v[176:177], v[200:201], v[200:201] op_sel:[0,0,1] op_sel_hi:[1,0,1] neg_lo:[0,0,1] neg_hi:[0,0,1]
  v_pk_fma_f32 v[134:135], v[178:179], v[200:201], v[200:201] op_sel:[0,0,1] op_sel_hi:[1,0,1] neg_lo:[0,0,1] neg_hi:[0,0,1]
  v_pk_fma_f32 v[176:177], v[132:133], v[104:105], v[176:177]
  v_pk_fma_f32 v[178:179], v[134:135], v[106:107], v[178:179]
  buffer_store_dwordx4 v[176:179], v46, s[60:63], s15 offen offset:256 sc1
  s_nop 1
  s_branch back_92
  s_endpgm
L_codeend:
.section .rodata,"a"
.p2align 6
.amdhsa_kernel interleave_layers__ssm_conv_s5__ssm_conv_h3__prompt_kernel
  .amdhsa_next_free_vgpr 512
  .amdhsa_next_free_sgpr 102
  .amdhsa_accum_offset 256
  .amdhsa_group_segment_fixed_size 0
  .amdhsa_kernarg_size 144
  .amdhsa_user_sgpr_count 2
  .amdhsa_user_sgpr_kernarg_segment_ptr 1
  .amdhsa_system_sgpr_workgroup_id_x 1
.end_amdhsa_kernel
```

```asm
; @launch grid=(256,1,1) block=(256,1,1) lds=163840
.amdgcn_target "amdgcn-amd-amdhsa--gfx950"
.text
.globl interleave_layers__ssm_conv_s5__ssm_conv_h3__prompt_kernel
.p2align 8
.type interleave_layers__ssm_conv_s5__ssm_conv_h3__prompt_kernel,@function
interleave_layers__ssm_conv_s5__ssm_conv_h3__prompt_kernel:
  s_cmp_ge_u32 s2, 256
  s_cbranch_scc1 L_end
  s_load_dwordx16 s[16:31], s[0:1], 0
  s_load_dwordx16 s[32:47], s[0:1], 64
  s_load_dwordx4 s[48:51], s[0:1], 128
  v_and_b32 v1, 63, v0
  v_lshrrev_b32 v11, 6, v0
  v_lshlrev_b32 v2, 4, v1
  v_readfirstlane_b32 s7, v11
  v_and_b32 v3, 15, v1
  v_lshrrev_b32 v4, 4, v1
  s_and_b32 s12, s2, 7
  s_lshr_b32 s13, s2, 3
  s_getpc_b64 s[98:99]
L_pc:
  s_and_b32 s4, s13, 15
  s_lshr_b32 s14, s13, 4
  s_lshl_b32 s3, s12, 1
  s_add_u32 s3, s3, s14
  s_mov_b32 s0, s12
  s_mov_b32 s1, s13
  s_and_b32 vcc_lo, s1, 7
  s_lshl_b32 vcc_lo, vcc_lo, 2
  s_add_u32 vcc_lo, vcc_lo, s7
  s_lshl_b32 vcc_lo, vcc_lo, 11
  v_lshl_add_u32 v15, v3, 7, vcc_lo
  v_min_u32 v15, L_codeend-L_pc-4, v15
  s_mov_b64 exec, 0xffff
  global_load_dword a250, v15, s[98:99]
  s_mov_b64 exec, -1
  v_lshrrev_b32 v11, 3, v1
  v_and_b32_e64 v13, 7, v1
  v_mul_u32_u24 v150, 1280, v11
  v_lshl_add_u32 v150, v13, 4, v150
  s_mul_i32 s12, s1, 81920
  s_lshl_b32 s13, s0, 7
  s_add_u32 s12, s12, s13
  v_add_u32 v169, s12, v150
  s_lshl_b32 s95, s0, 5
  s_add_u32 s95, s95, s1
  s_mul_i32 s12, s95, 10240
  s_add_u32 s12, s12, 1024
  v_add_u32 v170, s12, v150
  s_cmp_eq_u32 s7, 1
  s_cbranch_scc1 w1_3
  s_cmp_eq_u32 s7, 2
  s_cbranch_scc1 w2_4
  s_cmp_eq_u32 s7, 3
  s_cbranch_scc1 w3_5
w0_2:
  s_waitcnt lgkmcnt(0)
  s_mov_b32 s60, s36
  s_and_b32 s61, s37, 0xffff
  s_mov_b32 s62, 2621440
  s_mov_b32 s63, 0x20000
  s_mov_b32 m0, 119840
  s_nop 0
  buffer_load_dwordx4 v169, s[60:63], 0 offen nt lds
  s_mov_b32 m0, 120896
  s_mov_b32 s12, 10240
  buffer_load_dwordx4 v169, s[60:63], s12 offen nt lds
  s_mov_b32 m0, 121952
  s_mov_b32 s12, 20480
  buffer_load_dwordx4 v169, s[60:63], s12 offen nt lds
  s_mov_b32 m0, 123008
  s_mov_b32 s12, 30720
  buffer_load_dwordx4 v169, s[60:63], s12 offen nt lds
  s_mov_b32 m0, 124064
  s_mov_b32 s12, 40960
  buffer_load_dwordx4 v169, s[60:63], s12 offen nt lds
  s_mov_b32 m0, 125120
  s_mov_b32 s12, 51200
  buffer_load_dwordx4 v169, s[60:63], s12 offen nt lds
  s_mov_b32 m0, 126176
  s_mov_b32 s12, 61440
  buffer_load_dwordx4 v169, s[60:63], s12 offen nt lds
  v_subrev_u32 v11, 10240, v169
  s_mov_b32 exec_lo, 0
  s_mov_b32 exec_hi, 0xffffff00
  s_mov_b32 m0, 118784
  s_nop 0
  buffer_load_dwordx4 v11, s[60:63], 0 offen nt lds
  s_mov_b64 exec, -1
  s_mov_b32 s52, s50
  s_and_b32 s53, s51, 0xffff
  s_mov_b32 s54, 41943040
  s_mov_b32 s55, 0x20000
  s_lshl_b32 s12, s3, 4
  s_add_u32 s12, s12, s4
  s_lshl_b32 s12, s12, 12
  s_add_u32 s12, s12, 1310720
  s_sub_u32 s12, s12, 0
  v_mov_b32 v11, s12
  s_lshl_b32 s12, s3, 10
  s_add_u32 s12, s12, 4096
  s_sub_u32 s12, s12, 3072
  v_cmp_lt_u32 vcc, 23, v1
  v_mov_b32 v15, s12
  s_nop 0
  v_cndmask_b32 v11, v11, v15, vcc
  s_lshl_b32 s12, s0, 11
  s_add_u32 s12, s12, 65536
  s_sub_u32 s12, s12, 4096
  v_cmp_lt_u32 vcc, 31, v1
  v_mov_b32 v15, s12
  s_nop 0
  v_cndmask_b32 v11, v11, v15, vcc
  s_lshl_b32 s12, s4, 5
  s_add_u32 s12, s12, s3
  s_mul_i32 s12, s12, 640
  s_add_u32 s12, s12, 337920
  s_sub_u32 s12, s12, 5248
  v_cmp_lt_u32 vcc, 40, v1
  v_mov_b32 v15, s12
  s_nop 0
  v_cndmask_b32 v11, v11, v15, vcc
  s_lshl_b32 s12, s4, 5
  s_add_u32 s12, s12, s3
  s_mul_i32 s12, s12, 640
  s_add_u32 s12, s12, 665600
  s_sub_u32 s12, s12, 5888
  v_cmp_lt_u32 vcc, 45, v1
  v_mov_b32 v15, s12
  s_nop 0
  v_cndmask_b32 v11, v11, v15, vcc
  s_mul_i32 s12, s4, 640
  s_add_u32 s12, s12, 303104
  s_sub_u32 s12, s12, 6528
  v_cmp_lt_u32 vcc, 50, v1
  v_mov_b32 v15, s12
  s_nop 0
  v_cndmask_b32 v11, v11, v15, vcc
  s_lshl_b32 s12, s0, 7
  s_add_u32 s12, s12, 24576
  s_sub_u32 s12, s12, 7168
  v_cmp_lt_u32 vcc, 55, v1
  v_mov_b32 v15, s12
  s_nop 0
  v_cndmask_b32 v11, v11, v15, vcc
  s_lshl_b32 s12, s0, 7
  s_add_u32 s12, s12, 32768
  s_sub_u32 s12, s12, 7296
  v_cmp_lt_u32 vcc, 56, v1
  v_mov_b32 v15, s12
  s_nop 0
  v_cndmask_b32 v11, v11, v15, vcc
  v_lshl_add_u32 v11, v1, 7, v11
  s_mov_b32 exec_hi, 67108863
  buffer_load_dword a250, v11, s[52:55], 0 offen
  s_mov_b32 exec_hi, -1
  s_branch join_1
w1_3:
  s_waitcnt lgkmcnt(0)
  v_min_u32 v11, 39, v1
  s_mul_i32 s12, s4, 80
  v_lshl_add_u32 v14, v11, 1, s12
  global_load_ushort v229, v14, s[18:19]
  global_load_ushort v230, v14, s[20:21]
  global_load_ushort v231, v14, s[30:31]
  s_mov_b32 s64, s38
  s_and_b32 s65, s39, 0xffff
  s_mov_b32 s66, 2621440
  s_mov_b32 s67, 0x20000
  s_mov_b32 m0, 132512
  s_nop 0
  buffer_load_dwordx4 v169, s[64:67], 0 offen nt lds
  s_mov_b32 m0, 133568
  s_mov_b32 s12, 10240
  buffer_load_dwordx4 v169, s[64:67], s12 offen nt lds
  s_mov_b32 m0, 134624
  s_mov_b32 s12, 20480
  buffer_load_dwordx4 v169, s[64:67], s12 offen nt lds
  s_mov_b32 m0, 135680
  s_mov_b32 s12, 30720
  buffer_load_dwordx4 v169, s[64:67], s12 offen nt lds
  s_mov_b32 m0, 136736
  s_mov_b32 s12, 40960
  buffer_load_dwordx4 v169, s[64:67], s12 offen nt lds
  s_mov_b32 m0, 137792
  s_mov_b32 s12, 51200
  buffer_load_dwordx4 v169, s[64:67], s12 offen nt lds
  s_mov_b32 m0, 138848
  s_mov_b32 s12, 61440
  buffer_load_dwordx4 v169, s[64:67], s12 offen nt lds
  s_mov_b32 m0, 139904
  s_mov_b32 s12, 71680
  buffer_load_dwordx4 v169, s[64:67], s12 offen nt lds
  s_branch join_1
w2_4:
  s_waitcnt lgkmcnt(0)
  s_mov_b32 s60, s36
  s_and_b32 s61, s37, 0xffff
  s_mov_b32 s62, 2621440
  s_mov_b32 s63, 0x20000
  s_mov_b32 s64, s38
  s_and_b32 s65, s39, 0xffff
  s_mov_b32 s66, 2621440
  s_mov_b32 s67, 0x20000
  s_mov_b32 m0, 127232
  s_mov_b32 s12, 71680
  buffer_load_dwordx4 v169, s[60:63], s12 offen nt lds
  s_mov_b32 m0, 129344
  s_nop 0
  buffer_load_dwordx4 v170, s[60:63], 0 offen nt lds
  s_mov_b32 m0, 142016
  s_nop 0
  buffer_load_dwordx4 v170, s[64:67], 0 offen nt lds
  s_mov_b32 m0, 131456
  s_mov_b32 s12, 128
  buffer_load_dwordx4 v170, s[60:63], s12 offen nt lds
  s_mov_b32 m0, 144128
  s_mov_b32 s12, 128
  buffer_load_dwordx4 v170, s[64:67], s12 offen nt lds
  v_subrev_u32 v11, 10240, v170
  s_mov_b32 exec_lo, 0
  s_mov_b32 exec_hi, 0xffffff00
  s_mov_b32 m0, 128288
  s_nop 0
  buffer_load_dwordx4 v11, s[60:63], 0 offen nt lds
  s_mov_b64 exec, -1
  v_subrev_u32 v11, 10240, v170
  s_mov_b32 exec_lo, 0
  s_mov_b32 exec_hi, 0xffffff00
  s_mov_b32 m0, 130400
  s_mov_b32 s12, 128
  buffer_load_dwordx4 v11, s[60:63], s12 offen nt lds
  s_mov_b64 exec, -1
  s_mov_b32 s64, s40
  s_and_b32 s65, s41, 0xffff
  s_mov_b32 s66, 5120
  s_mov_b32 s67, 0x20000
  s_mov_b32 m0, 143072
  s_movk_i32 s12, 4096
  buffer_load_dwordx4 v2, s[64:67], s12 offen lds
  s_mov_b32 m0, 140960
  s_lshl_b32 s12, s0, 9
  s_mov_b32 exec_hi, 0
  buffer_load_dwordx4 v2, s[64:67], s12 offen lds
  s_mov_b32 exec_hi, -1
  s_branch join_1
w3_5:
  s_waitcnt lgkmcnt(0)
  s_mov_b32 s68, s16
  s_and_b32 s69, s17, 0xffff
  s_mov_b32 s70, 2621440
  s_mov_b32 s71, 0x20000
  s_lshl_b32 s12, s3, 4
  s_add_u32 s12, s12, s4
  s_mul_i32 s12, s12, 10240
  buffer_load_dwordx4 v[48:51], v150, s[68:71], s12 offen offset:0
  buffer_load_dwordx4 v[52:55], v150, s[68:71], s12 offen offset:128
  buffer_load_dwordx4 v[56:59], v150, s[68:71], s12 offen offset:256
  buffer_load_dwordx4 v[60:63], v150, s[68:71], s12 offen offset:384
  buffer_load_dwordx4 v[64:67], v150, s[68:71], s12 offen offset:512
  buffer_load_dwordx4 v[68:71], v150, s[68:71], s12 offen offset:640
  buffer_load_dwordx4 v[72:75], v150, s[68:71], s12 offen offset:768
  buffer_load_dwordx4 v[76:79], v150, s[68:71], s12 offen offset:896
  buffer_load_dwordx4 v[80:83], v150, s[68:71], s12 offen offset:1024
  buffer_load_dwordx4 v[84:87], v150, s[68:71], s12 offen offset:1152
join_1:
  s_load_dword s8, s[50:51], 0
  s_lshl_b32 s86, s95, 1
  s_lshl_b32 s12, s86, 1
  s_load_dword s72, s[44:45], s12
  s_and_b32 s12, s95, 0xfffffffc
  s_add_u32 s12, s12, 1024
  s_load_dword s73, s[44:45], s12
  v_and_b32 v185, 31, v1
  v_lshlrev_b32 v185, 2, v185
  s_lshl_b32 s89, s0, 11
  s_add_u32 s89, s89, 66560
  s_getreg_b32 s11, hwreg(HW_REG_XCC_ID, 0, 4)
  s_mov_b32 s10, 262144
  s_mov_b32 s2, 0x3f803f80
  v_lshrrev_b32 v11, 3, v1
  v_and_b32 v12, 6, v11
  v_and_b32 v13, 7, v1
  s_movk_i32 s15, 0x78
  v_bfe_u32 v14, s15, v12, 2
  v_xor_b32_e64 v14, v14, v13
  v_mul_u32_u24 v146, 1280, v11
  v_lshl_add_u32 v148, v14, 4, v146
  s_and_b32 s12, s7, 1
  s_lshl_b32 s13, s12, 6
  v_xor_b32_e64 v148, s13, v148
  v_add_u32 v149, 8192, v148
  v_xor_b32 v12, v12, v13
  v_and_b32 v11, 4, v11
  v_mul_u32_u24 v11, 1280, v11
  v_lshl_add_u32 v11, v12, 4, v11
  v_add_u32_e64 v146, v11, v146
  v_add_u32 v147, 19456, v146
  s_lshr_b32 s13, s7, 1
  s_mul_i32 s75, s13, 10240
  s_lshl_b32 s12, s12, 10
  s_add_u32 s75, s75, s12
  s_mul_i32 s74, s4, 51200
  s_lshl_b32 s13, s13, 7
  s_add_u32 s74, s74, s13
  s_lshl_b32 s76, s3, 2
  s_add_u32 s76, s76, s7
  s_mul_i32 s76, s76, 40960
  s_lshl_b32 s77, s7, 11
  s_add_u32 s77, s77, 102400
  s_bitcmp1_b32 s7, 0
  s_cselect_b32 s56, s24, s22
  s_cselect_b32 s57, s25, s23
  s_and_b32 s57, s57, 0xffff
  s_mov_b32 s58, 819200
  s_mov_b32 s59, 0x20000
  s_bitcmp1_b32 s3, 3
  s_cselect_b32 s60, s24, s22
  s_cselect_b32 s61, s25, s23
  s_and_b32 s61, s61, 0xffff
  s_mov_b32 s62, 819200
  s_mov_b32 s63, 0x20000
  s_mov_b32 s68, s16
  s_and_b32 s69, s17, 0xffff
  s_mov_b32 s70, 2621440
  s_mov_b32 s71, 0x20000
  s_mov_b32 s52, s50
  s_and_b32 s53, s51, 0xffff
  s_mov_b32 s54, 41943040
  s_mov_b32 s55, 0x20000
  s_lshr_b32 s24, s95, 1
  s_add_u32 s24, s24, 512
  s_lshr_b32 s14, s4, 3
  s_lshl_b32 s5, s3, 1
  s_add_u32 s5, s5, s14
  s_and_b32 s6, s4, 7
  s_lshl_b32 s84, s3, 10
  s_lshl_b32 s13, s4, 4
  s_add_u32 s84, s84, s13
  s_lshl_b32 s13, s7, 2
  s_add_u32 s84, s84, s13
  s_lshl_b32 s85, s0, 11
  s_add_u32 s85, s85, s13
  s_lshl_b32 s13, s1, 4
  s_add_u32 s85, s85, s13
  s_lshl_b32 s83, s4, 5
  s_add_u32 s83, s83, s3
  s_mul_i32 s83, s83, 640
  s_add_u32 s83, s83, 327680
  s_cmp_eq_u32 s7, 0
  s_cselect_b32 s96, -1, 0
  s_cselect_b32 s97, 0xff, 0
  s_lshl_b32 s12, s76, 1
  s_mul_i32 s13, s4, 5
  s_add_u32 s14, s13, 0
  s_lshr_b32 s15, s14, 2
  s_lshl_b32 s15, s15, 11
  s_and_b32 s14, s14, 3
  s_lshl_b32 s14, s14, 8
  s_add_u32 s14, s14, s15
  s_add_u32 s78, s14, s12
  s_add_u32 s14, s13, 1
  s_lshr_b32 s15, s14, 2
  s_lshl_b32 s15, s15, 11
  s_and_b32 s14, s14, 3
  s_lshl_b32 s14, s14, 8
  s_add_u32 s14, s14, s15
  s_add_u32 s79, s14, s12
  s_add_u32 s14, s13, 2
  s_lshr_b32 s15, s14, 2
  s_lshl_b32 s15, s15, 11
  s_and_b32 s14, s14, 3
  s_lshl_b32 s14, s14, 8
  s_add_u32 s14, s14, s15
  s_add_u32 s80, s14, s12
  s_add_u32 s14, s13, 3
  s_lshr_b32 s15, s14, 2
  s_lshl_b32 s15, s15, 11
  s_and_b32 s14, s14, 3
  s_lshl_b32 s14, s14, 8
  s_add_u32 s14, s14, s15
  s_add_u32 s81, s14, s12
  s_add_u32 s14, s13, 4
  s_lshr_b32 s15, s14, 2
  s_lshl_b32 s15, s15, 11
  s_and_b32 s14, s14, 3
  s_lshl_b32 s14, s14, 8
  s_add_u32 s14, s14, s15
  s_add_u32 s82, s14, s12
  s_mul_i32 s12, s7, 1280
  s_add_u32 s12, s12, 13824
  v_mul_u32_u24 v11, 80, v3
  v_lshl_add_u32 v11, v4, 4, v11
  v_add_u32 v42, s12, v11
  v_bfe_u32 v12, v1, 2, 2
  v_mul_u32_u24 v12, 160, v12
  v_and_b32_e64 v13, 3, v1
  v_lshl_add_u32 v12, v13, 4, v12
  v_lshrrev_b32_e64 v13, 1, v4
  v_mul_u32_u24 v14, 80, v13
  v_lshlrev_b32_e64 v13, 10, v13
  v_add3_u32 v12, v12, v14, s12
  v_and_b32_e64 v14, 1, v4
  v_lshl_add_u32 v43, v14, 3, v12
  v_mul_u32_u24 v14, 40960, v14
  v_lshl_add_u32 v13, v3, 4, v13
  v_add_u32_e64 v44, v13, v14
  v_accvgpr_write_b32 a240, v42
  v_accvgpr_write_b32 a241, v43
  v_accvgpr_write_b32 a242, v44
  v_accvgpr_write_b32 a243, v148
  v_accvgpr_write_b32 a244, v149
  v_lshrrev_b32_e64 v11, 2, v3
  v_mul_u32_u24 v11, 5120, v11
  v_and_b32_e64 v12, 3, v3
  v_lshl_add_u32 v11, v12, 4, v11
  v_lshl_add_u32 v0, v4, 6, v11
  v_and_b32 v11, 1, v3
  v_lshrrev_b32 v12, 1, v3
  v_and_b32 v13, 6, v12
  s_movk_i32 s15, 0x78
  v_bfe_u32 v13, s15, v13, 2
  v_xor_b32_e64 v13, v13, v4
  v_lshl_add_u32 v13, v11, 2, v13
  v_lshlrev_b32_e64 v13, 4, v13
  v_lshl_add_u32 v13, v12, 7, v13
  v_lshl_add_u32 v5, v11, 10, v13
  v_xor_b32_e64 v6, 64, v5
  v_add_u32 v7, 51200, v5
  v_add_u32 v8, 51200, v6
  v_mul_u32_u24 v9, 144, v12
  v_lshl_add_u32 v9, v11, 2, v9
  v_lshl_add_u32 v9, v4, 3, v9
  s_lshl_b32 s12, s7, 5
  v_add_u32 v9, s12, v9
  v_and_b32 v11, 6, v3
  v_xor_b32 v11, v11, v4
  v_lshlrev_b32_e64 v11, 4, v11
  v_lshl_add_u32 v11, v3, 7, v11
  v_add_u32 v144, s77, v11
  v_xor_b32 v145, 64, v144
  v_lshrrev_b32 v11, 3, v1
  v_and_b32 v12, 7, v1
  v_mul_u32_u24 v13, 1056, v12
  v_lshl_add_u32 v13, v11, 3, v13
  s_lshl_b32 s12, s7, 6
  s_add_u32 s12, s12, 118784
  v_add_u32 v172, s12, v13
  s_lshl_b32 s12, s7, 8
  s_add_u32 s12, s12, 140960
  v_lshl_add_u32 v173, v11, 5, s12
  v_sub_u32 v13, 7, v12
  v_lshlrev_b32_e64 v13, 4, v13
  v_lshl_add_u32 v171, v11, 14, v13
  s_mul_i32 s12, s0, 80
  s_lshl_b32 s13, s7, 5
  s_add_u32 s12, s12, s13
  s_lshl_b32 s12, s12, 12
  s_lshl_b32 s13, s1, 7
  s_sub_u32 s12, s12, s13
  s_add_u32 s87, s12, 4198272
  s_add_u32 s41, s85, 65536
  s_movk_i32 s36, 4096
  s_cmp_lg_u32 s7, 2
  s_cbranch_scc1 skip_6
  v_bfe_u32 v13, v1, 4, 1
  v_mul_u32_u24 v13, 2112, v13
  v_and_b32_e64 v14, 15, v1
  v_lshl_add_u32 v13, v14, 3, v13
  v_add_u32 v172, 128288, v13
  v_and_b32 v13, 31, v1
  v_lshlrev_b32 v13, 5, v13
  v_add_u32 v173, 143072, v13
  v_cmp_gt_u32_e64 vcc, 32, v1
  v_mov_b32 v14, 1879048192
  s_lshl_b32 s87, s95, 11
  s_add_u32 s87, s87, 26214400
  v_cndmask_b32 v171, v14, v2, vcc
  s_lshl_b32 s41, s95, 2
  s_add_u32 s41, s41, 32768
  s_movk_i32 s36, 512
skip_6:
  s_lshl_b32 s12, s86, 12
  s_lshl_b32 s13, s7, 10
  s_add_u32 s90, s12, s13
  s_add_u32 s91, s90, 4096
  s_lshl_b32 s92, s24, 12
  s_add_u32 s92, s92, s13
  s_add_u32 s13, s13, 102432
  v_add_u32 v186, s13, v2
  v_lshrrev_b32_e64 v11, 1, v1
  v_mul_u32_u24 v11, 4160, v11
  v_and_b32_e64 v12, 1, v1
  v_lshl_add_u32 v11, v12, 4, v11
  v_add_u32 v163, 102400, v11
  s_waitcnt lgkmcnt(0)
  s_lshr_b32 s8, s8, 4
  s_mul_i32 s8, s8, 0x19660d
  s_add_u32 s8, s8, 0x3c6ef35f
  s_lshl_b32 s8, s8, 4
  s_cmp_eq_u32 s7, 1
  s_cbranch_scc1 w1_8
  s_cmp_eq_u32 s7, 2
  s_cbranch_scc1 w2_9
  s_cmp_eq_u32 s7, 3
  s_cbranch_scc1 w3_10
  s_branch join_7
w1_8:
  s_waitcnt vmcnt(8)
  v_lshlrev_b32 v229, 16, v229
  v_lshlrev_b32 v230, 16, v230
  v_lshlrev_b32 v231, 16, v231
  v_mul_f32 v231, 0x3fb8aa3b, v231
  v_exp_f32 v231, v231
  v_min_u32 v104, 39, v1
  v_mul_u32_u24 v102, 80, v104
  v_mul_u32_u24 v103, 176, v104
  v_cvt_pk_bf16_f32 v231, v231, v231
  v_and_b32 v231, 0xffff0000, v231
  v_mul_f32 v96, v231, v229
  v_mul_f32 v97, v231, v230
  v_mul_f32 v96, 0x3fb8aa3b, v96
  v_mul_f32 v97, 0x3e22f983, v97
  v_mul_f32 v98, 1.0, v96
  v_mul_f32 v99, 1.0, v97
  v_exp_f32 v98, v98
  v_fract_f32 v99, v99
  v_sin_f32 v100, v99
  v_cos_f32 v101, v99
  v_mul_f32 v107, v98, v100
  v_mul_f32_e64 v106, v98, v101
  v_mul_f32 v98, 0x41000000, v96
  v_mul_f32 v99, 0x41000000, v97
  v_exp_f32 v98, v98
  v_fract_f32 v99, v99
  v_sin_f32 v100, v99
  v_cos_f32 v101, v99
  v_mul_f32 v51, v98, v100
  v_mul_f32 v50, v98, v101
  v_mul_f32 v98, v229, v229
  v_fmac_f32 v98, v230, v230
  v_rcp_f32 v98, v98
  v_add_f32 v99, -1.0, v106
  v_add_f32 v98, v98, v98
  v_mul_f32 v100, v99, v229
  v_fmac_f32 v100, v107, v230
  v_mul_f32 v101, v107, v229
  v_fma_f32 v101, -v99, v230, v101
  v_mul_f32 v100, v98, v100
  v_mul_f32 v101, v98, v101
  v_and_b32 v98, 1, v104
  v_lshrrev_b32 v104, 1, v104
  v_lshlrev_b32_e64 v104, 4, v104
  v_lshl_add_u32 v104, v98, 2, v104
  v_add_u32 v104, 159744, v104
  v_add_u32 v102, 160640, v102
  v_add_u32 v103, 145184, v103
  ds_write2_b32 v104, v100, v101 offset0:0 offset1:2
  v_mov_b32 v48, 1.0
  v_mov_b32 v49, 0
  v_mov_b32 v84, 1.0
  v_mov_b32 v85, 0
  v_pk_mul_f32 v[52:53], v[50:51], v[50:51] op_sel:[1,1] op_sel_hi:[0,1] neg_lo:[0,1]
  v_pk_mul_f32 v[108:109], v[106:107], v[106:107] op_sel:[1,1] op_sel_hi:[0,1] neg_lo:[0,1]
  v_pk_fma_f32 v[52:53], v[50:51], v[50:51], v[52:53] op_sel:[0,0,0] op_sel_hi:[1,0,1]
  v_pk_fma_f32 v[108:109], v[106:107], v[106:107], v[108:109] op_sel:[0,0,0] op_sel_hi:[1,0,1]
  v_pk_mul_f32 v[54:55], v[52:53], v[50:51] op_sel:[1,1] op_sel_hi:[0,1] neg_lo:[0,1]
  v_pk_mul_f32 v[110:111], v[108:109], v[106:107] op_sel:[1,1] op_sel_hi:[0,1] neg_lo:[0,1]
  v_pk_fma_f32 v[54:55], v[52:53], v[50:51], v[54:55] op_sel:[0,0,0] op_sel_hi:[1,0,1]
  v_pk_fma_f32 v[110:111], v[108:109], v[106:107], v[110:111] op_sel:[0,0,0] op_sel_hi:[1,0,1]
  ds_write_b128 v103, v[48:51] offset:0
  v_pk_mul_f32 v[56:57], v[54:55], v[50:51] op_sel:[1,1] op_sel_hi:[0,1] neg_lo:[0,1]
  v_pk_mul_f32 v[112:113], v[110:111], v[106:107] op_sel:[1,1] op_sel_hi:[0,1] neg_lo:[0,1]
  v_pk_fma_f32 v[56:57], v[54:55], v[50:51], v[56:57] op_sel:[0,0,0] op_sel_hi:[1,0,1]
  v_pk_fma_f32 v[112:113], v[110:111], v[106:107], v[112:113] op_sel:[0,0,0] op_sel_hi:[1,0,1]
  v_pk_mul_f32 v[58:59], v[56:57], v[50:51] op_sel:[1,1] op_sel_hi:[0,1] neg_lo:[0,1]
  v_pk_mul_f32 v[114:115], v[112:113], v[106:107] op_sel:[1,1] op_sel_hi:[0,1] neg_lo:[0,1]
  v_pk_fma_f32 v[58:59], v[56:57], v[50:51], v[58:59] op_sel:[0,0,0] op_sel_hi:[1,0,1]
  v_pk_fma_f32 v[114:115], v[112:113], v[106:107], v[114:115] op_sel:[0,0,0] op_sel_hi:[1,0,1]
  ds_write_b128 v103, v[52:55] offset:16
  v_pk_mul_f32 v[60:61], v[58:59], v[50:51] op_sel:[1,1] op_sel_hi:[0,1] neg_lo:[0,1]
  v_pk_mul_f32 v[116:117], v[114:115], v[106:107] op_sel:[1,1] op_sel_hi:[0,1] neg_lo:[0,1]
  v_pk_fma_f32 v[60:61], v[58:59], v[50:51], v[60:61] op_sel:[0,0,0] op_sel_hi:[1,0,1]
  v_pk_fma_f32 v[116:117], v[114:115], v[106:107], v[116:117] op_sel:[0,0,0] op_sel_hi:[1,0,1]
  v_pk_mul_f32 v[62:63], v[60:61], v[50:51] op_sel:[1,1] op_sel_hi:[0,1] neg_lo:[0,1]
  v_pk_mul_f32 v[118:119], v[116:117], v[106:107] op_sel:[1,1] op_sel_hi:[0,1] neg_lo:[0,1]
  v_pk_fma_f32 v[62:63], v[60:61], v[50:51], v[62:63] op_sel:[0,0,0] op_sel_hi:[1,0,1]
  v_pk_fma_f32 v[118:119], v[116:117], v[106:107], v[118:119] op_sel:[0,0,0] op_sel_hi:[1,0,1]
  ds_write_b128 v103, v[56:59] offset:32
  v_pk_mul_f32 v[64:65], v[62:63], v[50:51] op_sel:[1,1] op_sel_hi:[0,1] neg_lo:[0,1]
  v_pk_fma_f32 v[64:65], v[62:63], v[50:51], v[64:65] op_sel:[0,0,0] op_sel_hi:[1,0,1]
  ds_write2_b32 v102, v106, v107 offset0:0 offset1:8
  v_pk_mul_f32 v[66:67], v[64:65], v[50:51] op_sel:[1,1] op_sel_hi:[0,1] neg_lo:[0,1]
  v_pk_fma_f32 v[66:67], v[64:65], v[50:51], v[66:67] op_sel:[0,0,0] op_sel_hi:[1,0,1]
  ds_write2_b32 v102, v108, v109 offset0:1 offset1:9
  ds_write_b128 v103, v[60:63] offset:48
  v_pk_mul_f32 v[68:69], v[66:67], v[50:51] op_sel:[1,1] op_sel_hi:[0,1] neg_lo:[0,1]
  v_pk_fma_f32 v[68:69], v[66:67], v[50:51], v[68:69] op_sel:[0,0,0] op_sel_hi:[1,0,1]
  ds_write2_b32 v102, v110, v111 offset0:2 offset1:10
  v_pk_mul_f32 v[70:71], v[68:69], v[50:51] op_sel:[1,1] op_sel_hi:[0,1] neg_lo:[0,1]
  v_pk_fma_f32 v[70:71], v[68:69], v[50:51], v[70:71] op_sel:[0,0,0] op_sel_hi:[1,0,1]
  ds_write2_b32 v102, v112, v113 offset0:3 offset1:11
  ds_write_b128 v103, v[64:67] offset:64
  v_pk_mul_f32 v[72:73], v[70:71], v[50:51] op_sel:[1,1] op_sel_hi:[0,1] neg_lo:[0,1]
  v_pk_fma_f32 v[72:73], v[70:71], v[50:51], v[72:73] op_sel:[0,0,0] op_sel_hi:[1,0,1]
  ds_write2_b32 v102, v114, v115 offset0:4 offset1:12
  v_pk_mul_f32 v[74:75], v[72:73], v[50:51] op_sel:[1,1] op_sel_hi:[0,1] neg_lo:[0,1]
  v_pk_fma_f32 v[74:75], v[72:73], v[50:51], v[74:75] op_sel:[0,0,0] op_sel_hi:[1,0,1]
  ds_write2_b32 v102, v116, v117 offset0:5 offset1:13
  ds_write_b128 v103, v[68:71] offset:80
  v_pk_mul_f32 v[76:77], v[74:75], v[50:51] op_sel:[1,1] op_sel_hi:[0,1] neg_lo:[0,1]
  v_pk_fma_f32 v[76:77], v[74:75], v[50:51], v[76:77] op_sel:[0,0,0] op_sel_hi:[1,0,1]
  ds_write2_b32 v102, v118, v119 offset0:6 offset1:14
  v_pk_mul_f32 v[78:79], v[76:77], v[50:51] op_sel:[1,1] op_sel_hi:[0,1] neg_lo:[0,1]
  v_pk_fma_f32 v[78:79], v[76:77], v[50:51], v[78:79] op_sel:[0,0,0] op_sel_hi:[1,0,1]
  ds_write_b128 v103, v[72:75] offset:96
  v_pk_mul_f32 v[80:81], v[78:79], v[50:51] op_sel:[1,1] op_sel_hi:[0,1] neg_lo:[0,1]
  v_pk_fma_f32 v[80:81], v[78:79], v[50:51], v[80:81] op_sel:[0,0,0] op_sel_hi:[1,0,1]
  ds_write2_b32 v102, v50, v51 offset0:7 offset1:15
  ds_write_b128 v103, v[76:79] offset:112
  v_pk_mul_f32 v[98:99], v[80:81], v[80:81] op_sel:[1,1] op_sel_hi:[0,1] neg_lo:[0,1]
  v_pk_fma_f32 v[98:99], v[80:81], v[80:81], v[98:99] op_sel:[0,0,0] op_sel_hi:[1,0,1]
  v_pk_mul_f32 v[86:87], v[98:99], v[98:99] op_sel:[1,1] op_sel_hi:[0,1] neg_lo:[0,1]
  v_pk_fma_f32 v[86:87], v[98:99], v[98:99], v[86:87] op_sel:[0,0,0] op_sel_hi:[1,0,1]
  v_pk_mul_f32 v[88:89], v[86:87], v[86:87] op_sel:[1,1] op_sel_hi:[0,1] neg_lo:[0,1]
  v_pk_fma_f32 v[88:89], v[86:87], v[86:87], v[88:89] op_sel:[0,0,0] op_sel_hi:[1,0,1]
  v_pk_mul_f32 v[90:91], v[88:89], v[86:87] op_sel:[1,1] op_sel_hi:[0,1] neg_lo:[0,1]
  v_pk_fma_f32 v[90:91], v[88:89], v[86:87], v[90:91] op_sel:[0,0,0] op_sel_hi:[1,0,1]
  ds_write_b64 v103, v[80:81] offset:128
  ds_write_b128 v103, v[84:87] offset:144
  ds_write_b128 v103, v[88:91] offset:160
  s_branch join_7
w2_9:
  v_mov_b32 v88, 0
  s_lshl_b32 s12, s0, 11
  s_lshl_b32 s13, s1, 2
  s_add_u32 s12, s12, s13
  s_add_u32 s12, s12, 66560
  s_or_b32 s13, s8, s11
  v_mov_b32 v15, s13
  s_mov_b64 exec, 1
  buffer_store_dword v15, off, s[52:55], s12
  s_mov_b64 exec, -1
  s_lshl_b32 s12, s0, 11
  s_lshl_b32 s13, s1, 2
  s_add_u32 s12, s12, s13
  s_add_u32 s12, s12, 66560
  s_or_b32 s13, s8, s11
  v_mov_b32 v15, s13
  s_mov_b64 exec, 1
  buffer_store_dword v15, off, s[52:55], s12 offset:128 sc1
  s_mov_b64 exec, -1
  v_mov_b32 v89, 0
  v_mov_b32 v90, s8
  v_mov_b32_e64 v91, s8
  s_add_u32 s12, s83, 327680
  s_mov_b32 exec_hi, 0xff
  buffer_store_dwordx4 v[88:91], v2, s[52:55], s83 offen sc1
  buffer_store_dwordx4 v[88:91], v2, s[52:55], s12 offen sc1
  s_mov_b32 exec_hi, -1
  s_branch join_7
w3_10:
  s_waitcnt vmcnt(0)
  v_dot2_f32_bf16 v88, v48, s2, 0
  v_dot2_f32_bf16 v90, v48, v48, 0
  v_dot2_f32_bf16 v88, v49, s2, v88
  v_dot2_f32_bf16 v90, v49, v49, v90
  v_dot2_f32_bf16 v88, v50, s2, v88
  v_dot2_f32_bf16 v90, v50, v50, v90
  v_dot2_f32_bf16 v88, v51, s2, v88
  v_dot2_f32_bf16 v90, v51, v51, v90
  v_dot2_f32_bf16 v88, v52, s2, v88
  v_dot2_f32_bf16 v90, v52, v52, v90
  v_dot2_f32_bf16 v88, v53, s2, v88
  v_dot2_f32_bf16 v90, v53, v53, v90
  v_dot2_f32_bf16 v88, v54, s2, v88
  v_dot2_f32_bf16 v90, v54, v54, v90
  v_dot2_f32_bf16 v88, v55, s2, v88
  v_dot2_f32_bf16 v90, v55, v55, v90
  v_dot2_f32_bf16 v88, v56, s2, v88
  v_dot2_f32_bf16 v90, v56, v56, v90
  v_dot2_f32_bf16 v88, v57, s2, v88
  v_dot2_f32_bf16 v90, v57, v57, v90
  v_dot2_f32_bf16 v88, v58, s2, v88
  v_dot2_f32_bf16 v90, v58, v58, v90
  v_dot2_f32_bf16 v88, v59, s2, v88
  v_dot2_f32_bf16 v90, v59, v59, v90
  v_dot2_f32_bf16 v88, v60, s2, v88
  v_dot2_f32_bf16 v90, v60, v60, v90
  v_dot2_f32_bf16 v88, v61, s2, v88
  v_dot2_f32_bf16 v90, v61, v61, v90
  v_dot2_f32_bf16 v88, v62, s2, v88
  v_dot2_f32_bf16 v90, v62, v62, v90
  v_dot2_f32_bf16 v88, v63, s2, v88
  v_dot2_f32_bf16 v90, v63, v63, v90
  v_dot2_f32_bf16 v88, v64, s2, v88
  v_dot2_f32_bf16 v90, v64, v64, v90
  v_dot2_f32_bf16 v88, v65, s2, v88
  v_dot2_f32_bf16 v90, v65, v65, v90
  v_dot2_f32_bf16 v88, v66, s2, v88
  v_dot2_f32_bf16 v90, v66, v66, v90
  v_dot2_f32_bf16 v88, v67, s2, v88
  v_dot2_f32_bf16 v90, v67, v67, v90
  v_dot2_f32_bf16 v88, v68, s2, v88
  v_dot2_f32_bf16 v90, v68, v68, v90
  v_dot2_f32_bf16 v88, v69, s2, v88
  v_dot2_f32_bf16 v90, v69, v69, v90
  v_dot2_f32_bf16 v88, v70, s2, v88
  v_dot2_f32_bf16 v90, v70, v70, v90
  v_dot2_f32_bf16 v88, v71, s2, v88
  v_dot2_f32_bf16 v90, v71, v71, v90
  v_dot2_f32_bf16 v88, v72, s2, v88
  v_dot2_f32_bf16 v90, v72, v72, v90
  v_dot2_f32_bf16 v88, v73, s2, v88
  v_dot2_f32_bf16 v90, v73, v73, v90
  v_dot2_f32_bf16 v88, v74, s2, v88
  v_dot2_f32_bf16 v90, v74, v74, v90
  v_dot2_f32_bf16 v88, v75, s2, v88
  v_dot2_f32_bf16 v90, v75, v75, v90
  v_dot2_f32_bf16 v88, v76, s2, v88
  v_dot2_f32_bf16 v90, v76, v76, v90
  v_dot2_f32_bf16 v88, v77, s2, v88
  v_dot2_f32_bf16 v90, v77, v77, v90
  v_dot2_f32_bf16 v88, v78, s2, v88
  v_dot2_f32_bf16 v90, v78, v78, v90
  v_dot2_f32_bf16 v88, v79, s2, v88
  v_dot2_f32_bf16 v90, v79, v79, v90
  v_dot2_f32_bf16 v88, v80, s2, v88
  v_dot2_f32_bf16 v90, v80, v80, v90
  v_dot2_f32_bf16 v88, v81, s2, v88
  v_dot2_f32_bf16 v90, v81, v81, v90
  v_dot2_f32_bf16 v88, v82, s2, v88
  v_dot2_f32_bf16 v90, v82, v82, v90
  v_dot2_f32_bf16 v88, v83, s2, v88
  v_dot2_f32_bf16 v90, v83, v83, v90
  v_dot2_f32_bf16 v88, v84, s2, v88
  v_dot2_f32_bf16 v90, v84, v84, v90
  v_dot2_f32_bf16 v88, v85, s2, v88
  v_dot2_f32_bf16 v90, v85, v85, v90
  v_dot2_f32_bf16 v88, v86, s2, v88
  v_dot2_f32_bf16 v90, v86, v86, v90
  v_dot2_f32_bf16 v88, v87, s2, v88
  v_dot2_f32_bf16 v90, v87, v87, v90
  s_nop 1
  v_add_f32_dpp v88, v88, v88 quad_perm:[1,0,3,2] row_mask:0xf bank_mask:0xf
  v_add_f32_dpp v90, v90, v90 quad_perm:[1,0,3,2] row_mask:0xf bank_mask:0xf
  s_nop 0
  v_add_f32_dpp v88, v88, v88 quad_perm:[2,3,0,1] row_mask:0xf bank_mask:0xf
  v_add_f32_dpp v90, v90, v90 quad_perm:[2,3,0,1] row_mask:0xf bank_mask:0xf
  s_nop 0
  v_add_f32_dpp v88, v88, v88 row_half_mirror row_mask:0xf bank_mask:0xf
  v_add_f32_dpp v90, v90, v90 row_half_mirror row_mask:0xf bank_mask:0xf
  v_mul_f32 v88, 0x3acccccd, v88
  v_mul_f32 v90, 0x3acccccd, v90
  v_fma_f32 v90, -v88, v88, v90
  v_max_f32_e64 v90, 0, v90
  v_cvt_pk_bf16_f32 v88, v88, v88
  v_and_b32 v88, 0xffff0000, v88
  v_cvt_pk_bf16_f32 v90, v90, v90
  v_and_b32 v90, 0xffff0000, v90
  v_add_f32 v90, 0x3727c5ac, v90
  v_cvt_pk_bf16_f32 v90, v90, v90
  v_and_b32 v90, 0xffff0000, v90
  v_sqrt_f32 v90, v90
  s_nop 0
  v_cvt_pk_bf16_f32 v90, v90, v90
  v_and_b32 v90, 0xffff0000, v90
  v_rcp_f32 v89, v90
  v_mov_b32 v90, s8
  v_mov_b32 v91, s8
  v_lshlrev_b32 v11, 1, v1
  s_lshl_b32 s12, s3, 4
  s_add_u32 s12, s12, s4
  s_lshl_b32 s12, s12, 7
  s_add_u32 s12, s12, 262144
  s_mov_b32 exec_lo, 0x01010101
  s_mov_b32 exec_hi, 0x01010101
  buffer_store_dwordx4 v[88:91], v11, s[52:55], s12 offen sc1
  s_mov_b64 exec, -1
join_7:
  s_lshl_b32 s93, s3, 11
  s_lshl_b32 s12, s7, 9
  s_add_u32 s93, s93, s12
  s_add_u32 s93, s93, 262144
  v_and_b32 v160, 7, v3
  v_lshlrev_b32_e64 v160, 4, v160
  v_lshl_add_u32 v160, v4, 7, v160
  s_mul_i32 s94, s4, 640
  s_add_u32 s94, s94, 303104
  v_lshlrev_b32 v161, 3, v1
  v_lshlrev_b32 v162, 3, v3
  v_and_b32 v187, 31, v1
  v_lshlrev_b32 v187, 4, v187
  s_lshl_b32 s88, s6, 11
  s_add_u32 s88, s88, 66048
  v_add_u32 v11, 1, v3
  v_and_b32_e64 v12, 1, v11
  v_mul_u32_u24 v12, 4160, v12
  v_lshrrev_b32_e64 v11, 1, v11
  v_lshl_add_u32 v12, v11, 2, v12
  v_lshl_add_u32 v12, v4, 4, v12
  v_sub_u32 v11, 15, v3
  v_lshlrev_b32 v11, 5, v11
  v_lshl_add_u32 v11, v4, 4, v11
  s_lshr_b32 s12, s7, 1
  s_and_b32 s13, s7, 1
  s_lshl_b32 s13, s13, 8
  s_mul_i32 s14, s12, 8320
  s_add_u32 s14, s14, s13
  s_add_u32 s14, s14, 102400
  v_add_u32_e64 v232, s14, v12
  s_mul_i32 s14, s12, 4608
  s_add_u32 s14, s14, s13
  v_add_u32 v240, s14, v11
  s_lshl_b32 s13, s7, 7
  s_add_u32 s14, s13, 119040
  v_add_u32 v236, s14, v12
  s_add_u32 s14, s13, 9216
  v_add_u32_e64 v241, s14, v11
  v_accvgpr_write_b32 a200, v232
  v_accvgpr_write_b32 a201, v236
  v_accvgpr_write_b32 a202, v240
  v_accvgpr_write_b32 a203, v241
  s_mul_i32 s13, s5, 163840
  s_mul_i32 s14, s7, 10240
  s_add_u32 s13, s13, s14
  s_add_u32 s13, s13, 0
  s_add_u32 s14, s7, 1
  s_and_b32 s14, s14, 3
  s_mul_i32 s15, s14, 40960
  s_add_u32 s16, s15, s13
  s_mul_i32 s15, s14, 10240
  s_add_u32 s15, s15, 102400
  v_add_u32 v44, s15, v2
  s_add_u32 s14, s7, 2
  s_and_b32 s14, s14, 3
  s_mul_i32 s15, s14, 40960
  s_add_u32 s17, s15, s13
  s_mul_i32 s15, s14, 10240
  s_add_u32 s15, s15, 107520
  v_add_u32 v45, s15, v2
  s_add_u32 s14, s7, 3
  s_and_b32 s14, s14, 3
  s_mul_i32 s15, s14, 40960
  s_add_u32 s18, s15, s13
  s_mul_i32 s15, s14, 5120
  v_add_u32 v46, s15, v2
  s_add_u32 s14, s7, 4
  s_and_b32 s14, s14, 3
  s_mul_i32 s15, s14, 40960
  s_add_u32 s19, s15, s13
  s_lshl_b32 s49, s3, 10
  s_lshl_b32 s13, s7, 6
  s_add_u32 s49, s49, s13
  s_and_b32 s13, s5, 1
  s_lshl_b32 s13, s13, 3
  s_add_u32 s49, s49, s13
  s_add_u32 s49, s49, 4352
  v_and_b32 v244, 3, v1
  v_lshlrev_b32_e64 v244, 4, v244
  v_accvgpr_write_b32 a211, v44
  v_accvgpr_write_b32 a212, v45
  v_accvgpr_write_b32 a213, v46
  v_accvgpr_write_b32 a214, v244
  s_lshr_b32 s13, s7, 1
  s_add_u32 s12, s86, s13
  s_bitcmp1_b32 s12, 0
  s_cselect_b32 s14, 16, 0
  s_lshr_b32 s72, s72, s14
  s_and_b32 s30, s72, 0xffff
  s_lshl_b32 s31, s72, 16
  s_bitcmp1_b32 s24, 0
  s_cselect_b32 s14, 16, 0
  s_lshr_b32 s73, s73, s14
  s_and_b32 s25, s73, 0xffff
  s_lshl_b32 s45, s73, 16
  s_lshl_b32 s50, s12, 12
  s_and_b32 s12, s7, 1
  s_lshl_b32 s12, s12, 11
  s_add_u32 s50, s50, s12
  s_add_u32 s50, s50, 19922944
  s_mul_i32 s13, s13, 4608
  s_sub_u32 s13, s13, s12
  s_add_u32 s13, s13, 2552
  v_lshlrev_b32 v246, 5, v3
  v_lshl_add_u32 v246, v4, 3, v246
  v_sub_u32 v247, s13, v246
  s_bitcmp1_b32 s1, 0
  s_movk_i32 s12, 0x7421
  s_cselect_b32 s12, 0x6530, s12
  s_lshl_b32 s13, s7, 2
  s_lshr_b32 s12, s12, s13
  s_and_b32 s12, s12, 7
  s_lshl_b32 s12, s12, 9
  s_lshl_b32 s51, s24, 12
  s_add_u32 s51, s51, s12
  s_add_u32 s51, s51, 19922944
  s_sub_u32 s12, 13304, s12
  v_sub_u32 v248, s12, v246
  s_lshl_b32 s12, s7, 12
  s_add_u32 s13, s12, 102400
  v_add_u32 v252, s13, v2
  s_add_u32 s13, s12, 127360
  v_add_u32_e64 v249, s13, v2
  s_xor_b32 s13, s12, 4096
  s_add_u32 s13, s13, 127360
  v_add_u32 v250, s13, v2
  s_lshl_b32 s13, s7, 10
  s_add_u32 s13, s13, 102400
  v_add_u32_e64 v251, s13, v2
  v_accvgpr_write_b32 a204, v246
  v_accvgpr_write_b32 a205, v247
  v_accvgpr_write_b32 a206, v248
  v_accvgpr_write_b32 a207, v249
  v_accvgpr_write_b32 a208, v250
  v_accvgpr_write_b32 a209, v251
  v_accvgpr_write_b32 a210, v252
  s_lshl_b32 s12, s5, 6
  s_lshr_b32 s13, s7, 1
  s_lshl_b32 s13, s13, 5
  s_add_u32 s12, s12, s13
  s_and_b32 s13, s7, 1
  s_lshl_b32 s13, s13, 2
  s_add_u32 s12, s12, s13
  s_mul_i32 s20, s12, 1280
  s_mul_i32 s13, s6, 160
  s_add_u32 s20, s20, s13
  s_lshl_b32 s48, s7, 12
  s_add_u32 s48, s48, 127360
  v_add_u32 v11, 0, v1
  v_mul_u32_u24 v12, 205, v11
  v_lshrrev_b32 v12, 11, v12
  v_lshrrev_b32 v13, 2, v12
  v_mul_u32_u24 v12, 1120, v12
  v_mul_u32_u24 v13, 5120, v13
  v_lshlrev_b32_e64 v11, 4, v11
  v_add3_u32 v224, v11, v12, v13
  v_add_u32_e64 v11, 64, v1
  v_mul_u32_u24 v12, 205, v11
  v_lshrrev_b32 v12, 11, v12
  v_lshrrev_b32 v13, 2, v12
  v_mul_u32_u24 v12, 1120, v12
  v_mul_u32_u24 v13, 5120, v13
  v_lshlrev_b32_e64 v11, 4, v11
  v_add3_u32 v225, v11, v12, v13
  v_add_u32 v11, 128, v1
  v_mul_u32_u24 v12, 205, v11
  v_lshrrev_b32 v12, 11, v12
  v_lshrrev_b32 v13, 2, v12
  v_mul_u32_u24 v12, 1120, v12
  v_mul_u32_u24 v13, 5120, v13
  v_lshlrev_b32_e64 v11, 4, v11
  v_add3_u32 v226, v11, v12, v13
  s_and_b32 s12, s5, 1
  s_lshl_b32 s12, s12, 2
  s_add_u32 s12, s12, s7
  s_lshr_b32 s13, s12, 1
  s_lshl_b32 s13, s13, 8
  s_and_b32 s12, s12, 1
  s_lshl_b32 s12, s12, 5
  s_add_u32 s12, s12, s13
  s_add_u32 s12, s12, 158720
  v_lshrrev_b32 v12, 2, v3
  v_lshlrev_b32 v12, 6, v12
  v_and_b32_e64 v13, 3, v3
  v_lshl_add_u32 v12, v13, 3, v12
  v_add_u32 v227, s12, v12
  v_and_b32 v13, 7, v3
  v_lshlrev_b32_e64 v13, 3, v13
  v_lshl_add_u32 v13, v4, 6, v13
  s_lshl_b32 s12, s7, 8
  s_add_u32 s12, s12, 158720
  v_add_u32 v228, s12, v13
  v_lshl_add_u32 v243, v4, 3, s48
  v_mul_u32_u24 v242, 160, v3
  v_lshl_add_u32 v242, v4, 3, v242
  v_add_u32 v242, s48, v242
  s_lshl_b32 s12, s3, 4
  s_add_u32 s12, s12, s4
  s_lshl_b32 s12, s12, 12
  s_add_u32 s12, s12, 1310720
  s_sub_u32 s12, s12, 0
  v_mov_b32 v11, s12
  s_lshl_b32 s12, s3, 10
  s_add_u32 s12, s12, 4096
  s_sub_u32 s12, s12, 3072
  v_cmp_lt_u32 vcc, 23, v1
  v_mov_b32 v15, s12
  s_nop 0
  v_cndmask_b32 v11, v11, v15, vcc
  v_lshl_add_u32 v11, v1, 7, v11
  v_accvgpr_write_b32 a245, v11
  s_add_u32 m0, s75, 0
  s_add_u32 s14, s74, 0
  buffer_load_dwordx4 v148, s[56:59], s14 offen lds
  buffer_load_dwordx4 v149, s[56:59], s14 offen offset:2048 lds
  s_add_u32 m0, s75, 4096
  s_add_u32 s14, s74, 20480
  buffer_load_dwordx4 v148, s[56:59], s14 offen lds
  buffer_load_dwordx4 v149, s[56:59], s14 offen offset:2048 lds
  s_add_u32 m0, s75, 8192
  s_add_u32 s14, s74, 40960
  buffer_load_dwordx4 v148, s[56:59], s14 offen lds
  s_add_u32 m0, s77, 0
  s_add_u32 s15, s76, 0
  buffer_load_dwordx4 v146, s[68:71], s15 offen lds
  buffer_load_dwordx4 v147, s[68:71], s15 offen offset:1024 lds
  s_add_u32 m0, s77, 8192
  s_add_u32 s15, s76, 5120
  buffer_load_dwordx4 v146, s[68:71], s15 offen lds
  buffer_load_dwordx4 v147, s[68:71], s15 offen offset:1024 lds
  v_mul_u32_u24 v11, 171, v1
  v_lshrrev_b32 v11, 11, v11
  v_mul_u32_u24 v12, 12, v11
  v_sub_u32 v12, v1, v12
  s_mul_i32 s12, s4, 5
  v_min_u32 v13, 4, v11
  v_add_u32 v13, s12, v13
  s_mul_i32 s13, s7, 12
  v_add_u32 v12, s13, v12
  v_cmp_gt_u32 vcc, 40, v12
  v_cmp_gt_u32 s[14:15], 5, v11
  s_lshr_b32 s13, s1, 4
  s_mul_i32 s13, s13, 40
  v_min_u32 v12, 39, v12
  s_and_b64 vcc, vcc, s[14:15]
  v_add_u32_e64 v12, s13, v12
  s_mul_i32 s14, s0, 102400
  v_mul_u32_u24 v14, 1280, v12
  v_lshl_add_u32 v14, v13, 4, v14
  v_add_u32_e64 v14, s14, v14
  global_load_dwordx4 v[176:179], v14, s[26:27]
  global_load_dwordx4 v[180:183], v14, s[28:29]
  v_lshrrev_b32_e64 v14, 2, v13
  v_mul_u32_u24 v14, 10240, v14
  v_and_b32_e64 v13, 3, v13
  v_lshl_add_u32 v14, v13, 8, v14
  v_lshrrev_b32_e64 v13, 4, v12
  v_lshl_add_u32 v14, v13, 10, v14
  v_and_b32_e64 v12, 15, v12
  v_lshl_add_u32 v14, v12, 4, v14
  v_mov_b32 v13, 1879048192
  v_cndmask_b32 v174, v13, v14, vcc
  v_min_u32 v11, 4, v11
  v_lshlrev_b32_e64 v11, 6, v11
  v_add_u32 v175, 159744, v11
  s_waitcnt vmcnt(11)
  s_waitcnt lgkmcnt(0)
  s_barrier
  buffer_load_dword v184, v185, s[52:55], s89 offen sc1
  v_lshrrev_b32 v11, 1, v3
  v_mul_u32_u24 v12, 176, v11
  v_mul_u32_u24 v11, 80, v11
  v_and_b32_e64 v13, 1, v3
  v_lshl_add_u32 v12, v13, 2, v12
  v_lshl_add_u32 v12, v4, 3, v12
  s_lshl_b32 s12, s7, 5
  s_add_u32 s12, s12, 145184
  v_add_u32 v12, s12, v12
  v_add_u32 v11, 160640, v11
  v_cvt_f32_u32 v151, v13
  v_min_u32 v13, 39, v1
  v_mul_u32_u24 v13, 176, v13
  v_fma_f32 v151, 2.0, v151, -1.0
  v_add_u32 v13, 145184, v13
  s_lshl_b32 s12, s7, 3
  ds_read_b32 v16, v11 offset:0
  ds_read_b32 v21, v11 offset:32
  ds_read_b32 v26, v12 offset:0
  ds_read_b32 v17, v11 offset:640
  ds_read_b32 v22, v11 offset:672
  ds_read_b32 v28, v12 offset:1408
  ds_read_b32 v18, v11 offset:1280
  ds_read_b32 v23, v11 offset:1312
  ds_read_b32 v30, v12 offset:2816
  ds_read_b32 v19, v11 offset:1920
  ds_read_b32 v24, v11 offset:1952
  ds_read_b32 v32, v12 offset:4224
  ds_read_b32 v20, v11 offset:2560
  ds_read_b32 v25, v11 offset:2592
  ds_read_b32 v34, v12 offset:5632
  ds_read_b64 v[36:37], v13 offset:8
  ds_read_b64 v[38:39], v13 offset:128
  v_add_u32 v13, s12, v13
  ds_read_b64 v[40:41], v13 offset:144
  s_cmp_eq_u32 s7, 3
  s_cbranch_scc1 w3_11
  ds_read_b128 v[88:91], v173
  ds_read_b128 v[92:95], v173 offset:16
  ds_read_b64 v[48:49], v172 offset:640
  ds_read_b64 v[50:51], v172 offset:768
  ds_read_b64 v[52:53], v172 offset:896
  ds_read_b64 v[54:55], v172 offset:1056
  ds_read_b64 v[56:57], v172 offset:1184
  ds_read_b64 v[58:59], v172 offset:1312
  ds_read_b64 v[60:61], v172 offset:1440
  ds_read_b64 v[62:63], v172 offset:1568
  ds_read_b64 v[64:65], v172 offset:1696
  ds_read_b64 v[66:67], v172 offset:1824
  ds_read_b64 v[68:69], v172 offset:1952
  ds_read_b64 v[70:71], v172 offset:13728
  ds_read_b64 v[72:73], v172 offset:13856
  ds_read_b64 v[74:75], v172 offset:13984
  ds_read_b64 v[76:77], v172 offset:14112
  ds_read_b64 v[78:79], v172 offset:14240
  ds_read_b64 v[80:81], v172 offset:14368
  ds_read_b64 v[82:83], v172 offset:14496
  ds_read_b64 v[84:85], v172 offset:14624
  s_waitcnt lgkmcnt(15)
  v_lshlrev_b32 v96, 16, v88
  v_and_b32 v100, 0xffff0000, v88
  v_lshlrev_b32_e64 v104, 16, v89
  v_and_b32 v108, 0xffff0000, v89
  v_lshlrev_b32_e64 v97, 16, v90
  v_and_b32 v101, 0xffff0000, v90
  v_lshlrev_b32_e64 v105, 16, v91
  v_and_b32 v109, 0xffff0000, v91
  v_lshlrev_b32_e64 v98, 16, v92
  v_and_b32 v102, 0xffff0000, v92
  v_lshlrev_b32_e64 v106, 16, v93
  v_and_b32 v110, 0xffff0000, v93
  v_lshlrev_b32_e64 v99, 16, v94
  v_and_b32 v103, 0xffff0000, v94
  v_lshlrev_b32_e64 v107, 16, v95
  v_and_b32 v111, 0xffff0000, v95
  s_waitcnt lgkmcnt(8)
  v_lshlrev_b32 v216, 16, v48
  v_and_b32 v217, 0xffff0000, v48
  v_pk_mul_f32 v[112:113], v[216:217], v[108:109]
  v_lshlrev_b32_e64 v218, 16, v50
  v_and_b32 v219, 0xffff0000, v50
  v_pk_mul_f32 v[114:115], v[218:219], v[108:109]
  v_lshlrev_b32_e64 v216, 16, v52
  v_and_b32 v217, 0xffff0000, v52
  v_pk_fma_f32 v[112:113], v[218:219], v[104:105], v[112:113]
  v_pk_mul_f32 v[116:117], v[216:217], v[108:109]
  v_lshlrev_b32_e64 v218, 16, v54
  v_and_b32 v219, 0xffff0000, v54
  v_pk_fma_f32 v[114:115], v[216:217], v[104:105], v[114:115]
  v_pk_fma_f32 v[112:113], v[216:217], v[100:101], v[112:113]
  v_pk_mul_f32 v[118:119], v[218:219], v[108:109]
  v_lshlrev_b32_e64 v216, 16, v56
  v_and_b32 v217, 0xffff0000, v56
  v_pk_fma_f32 v[116:117], v[218:219], v[104:105], v[116:117]
  v_pk_fma_f32 v[114:115], v[218:219], v[100:101], v[114:115]
  v_pk_fma_f32 v[112:113], v[218:219], v[96:97], v[112:113]
  v_pk_mul_f32 v[120:121], v[216:217], v[108:109]
  v_lshlrev_b32_e64 v218, 16, v58
  v_and_b32 v219, 0xffff0000, v58
  v_pk_fma_f32 v[118:119], v[216:217], v[104:105], v[118:119]
  v_pk_fma_f32 v[116:117], v[216:217], v[100:101], v[116:117]
  v_pk_fma_f32 v[114:115], v[216:217], v[96:97], v[114:115]
  v_pk_mul_f32 v[122:123], v[218:219], v[108:109]
  v_lshlrev_b32_e64 v216, 16, v60
  v_and_b32 v217, 0xffff0000, v60
  v_pk_fma_f32 v[120:121], v[218:219], v[104:105], v[120:121]
  v_pk_fma_f32 v[118:119], v[218:219], v[100:101], v[118:119]
  v_pk_fma_f32 v[116:117], v[218:219], v[96:97], v[116:117]
  v_pk_mul_f32 v[124:125], v[216:217], v[108:109]
  v_lshlrev_b32_e64 v218, 16, v62
  v_and_b32 v219, 0xffff0000, v62
  v_pk_fma_f32 v[122:123], v[216:217], v[104:105], v[122:123]
  v_pk_fma_f32 v[120:121], v[216:217], v[100:101], v[120:121]
  v_pk_fma_f32 v[118:119], v[216:217], v[96:97], v[118:119]
  v_pk_mul_f32 v[126:127], v[218:219], v[108:109]
  v_lshlrev_b32_e64 v216, 16, v64
  v_and_b32 v217, 0xffff0000, v64
  v_pk_fma_f32 v[124:125], v[218:219], v[104:105], v[124:125]
  v_pk_fma_f32 v[122:123], v[218:219], v[100:101], v[122:123]
  v_pk_fma_f32 v[120:121], v[218:219], v[96:97], v[120:121]
  v_pk_fma_f32 v[126:127], v[216:217], v[104:105], v[126:127]
  v_lshlrev_b32_e64 v218, 16, v66
  v_and_b32 v219, 0xffff0000, v66
  v_pk_fma_f32 v[124:125], v[216:217], v[100:101], v[124:125]
  v_pk_fma_f32 v[122:123], v[216:217], v[96:97], v[122:123]
  v_pk_fma_f32 v[126:127], v[218:219], v[100:101], v[126:127]
  v_lshlrev_b32_e64 v216, 16, v68
  v_and_b32 v217, 0xffff0000, v68
  v_pk_fma_f32 v[124:125], v[218:219], v[96:97], v[124:125]
  v_pk_fma_f32 v[126:127], v[216:217], v[96:97], v[126:127]
  s_waitcnt lgkmcnt(0)
  v_lshlrev_b32 v220, 16, v70
  v_and_b32 v221, 0xffff0000, v70
  v_lshlrev_b32_e64 v222, 16, v72
  v_and_b32 v223, 0xffff0000, v72
  v_pk_mul_f32 v[112:113], v[112:113], v[220:221]
  v_lshlrev_b32_e64 v220, 16, v74
  v_and_b32 v221, 0xffff0000, v74
  v_pk_mul_f32 v[114:115], v[114:115], v[222:223]
  v_lshlrev_b32_e64 v222, 16, v76
  v_and_b32 v223, 0xffff0000, v76
  v_pk_mul_f32 v[116:117], v[116:117], v[220:221]
  v_lshlrev_b32_e64 v220, 16, v78
  v_and_b32 v221, 0xffff0000, v78
  v_pk_mul_f32 v[118:119], v[118:119], v[222:223]
  v_lshlrev_b32_e64 v222, 16, v80
  v_and_b32 v223, 0xffff0000, v80
  v_pk_mul_f32 v[120:121], v[120:121], v[220:221]
  v_lshlrev_b32_e64 v220, 16, v82
  v_and_b32 v221, 0xffff0000, v82
  v_pk_mul_f32 v[122:123], v[122:123], v[222:223]
  v_lshlrev_b32_e64 v222, 16, v84
  v_and_b32 v223, 0xffff0000, v84
  v_pk_mul_f32 v[124:125], v[124:125], v[220:221]
  v_pk_mul_f32 v[126:127], v[126:127], v[222:223]
  v_cvt_pk_bf16_f32 v232, v126, v124
  v_cvt_pk_bf16_f32 v233, v122, v120
  v_cvt_pk_bf16_f32 v234, v118, v116
  v_cvt_pk_bf16_f32 v235, v114, v112
  v_cvt_pk_bf16_f32 v236, v127, v125
  v_cvt_pk_bf16_f32 v237, v123, v121
  v_cvt_pk_bf16_f32 v238, v119, v117
  v_cvt_pk_bf16_f32 v239, v115, v113
  v_lshlrev_b32_e64 v216, 16, v49
  v_and_b32 v217, 0xffff0000, v49
  v_pk_mul_f32 v[112:113], v[216:217], v[110:111]
  v_lshlrev_b32_e64 v218, 16, v51
  v_and_b32 v219, 0xffff0000, v51
  v_pk_mul_f32 v[114:115], v[218:219], v[110:111]
  v_lshlrev_b32_e64 v216, 16, v53
  v_and_b32 v217, 0xffff0000, v53
  v_pk_fma_f32 v[112:113], v[218:219], v[106:107], v[112:113]
  v_pk_mul_f32 v[116:117], v[216:217], v[110:111]
  v_lshlrev_b32_e64 v218, 16, v55
  v_and_b32 v219, 0xffff0000, v55
  v_pk_fma_f32 v[114:115], v[216:217], v[106:107], v[114:115]
  v_pk_fma_f32 v[112:113], v[216:217], v[102:103], v[112:113]
  v_pk_mul_f32 v[118:119], v[218:219], v[110:111]
  v_lshlrev_b32_e64 v216, 16, v57
  v_and_b32 v217, 0xffff0000, v57
  v_pk_fma_f32 v[116:117], v[218:219], v[106:107], v[116:117]
  v_pk_fma_f32 v[114:115], v[218:219], v[102:103], v[114:115]
  v_pk_fma_f32 v[112:113], v[218:219], v[98:99], v[112:113]
  v_pk_mul_f32 v[120:121], v[216:217], v[110:111]
  v_lshlrev_b32_e64 v218, 16, v59
  v_and_b32 v219, 0xffff0000, v59
  v_pk_fma_f32 v[118:119], v[216:217], v[106:107], v[118:119]
  v_pk_fma_f32 v[116:117], v[216:217], v[102:103], v[116:117]
  v_pk_fma_f32 v[114:115], v[216:217], v[98:99], v[114:115]
  v_pk_mul_f32 v[122:123], v[218:219], v[110:111]
  v_lshlrev_b32_e64 v216, 16, v61
  v_and_b32 v217, 0xffff0000, v61
  v_pk_fma_f32 v[120:121], v[218:219], v[106:107], v[120:121]
  v_pk_fma_f32 v[118:119], v[218:219], v[102:103], v[118:119]
  v_pk_fma_f32 v[116:117], v[218:219], v[98:99], v[116:117]
  v_pk_mul_f32 v[124:125], v[216:217], v[110:111]
  v_lshlrev_b32_e64 v218, 16, v63
  v_and_b32 v219, 0xffff0000, v63
  v_pk_fma_f32 v[122:123], v[216:217], v[106:107], v[122:123]
  v_pk_fma_f32 v[120:121], v[216:217], v[102:103], v[120:121]
  v_pk_fma_f32 v[118:119], v[216:217], v[98:99], v[118:119]
  v_pk_mul_f32 v[126:127], v[218:219], v[110:111]
  v_lshlrev_b32_e64 v216, 16, v65
  v_and_b32 v217, 0xffff0000, v65
  v_pk_fma_f32 v[124:125], v[218:219], v[106:107], v[124:125]
  v_pk_fma_f32 v[122:123], v[218:219], v[102:103], v[122:123]
  v_pk_fma_f32 v[120:121], v[218:219], v[98:99], v[120:121]
  v_pk_fma_f32 v[126:127], v[216:217], v[106:107], v[126:127]
  v_lshlrev_b32_e64 v218, 16, v67
  v_and_b32 v219, 0xffff0000, v67
  v_pk_fma_f32 v[124:125], v[216:217], v[102:103], v[124:125]
  v_pk_fma_f32 v[122:123], v[216:217], v[98:99], v[122:123]
  v_pk_fma_f32 v[126:127], v[218:219], v[102:103], v[126:127]
  v_lshlrev_b32_e64 v216, 16, v69
  v_and_b32 v217, 0xffff0000, v69
  v_pk_fma_f32 v[124:125], v[218:219], v[98:99], v[124:125]
  v_pk_fma_f32 v[126:127], v[216:217], v[98:99], v[126:127]
  v_lshlrev_b32_e64 v220, 16, v71
  v_and_b32 v221, 0xffff0000, v71
  v_lshlrev_b32_e64 v222, 16, v73
  v_and_b32 v223, 0xffff0000, v73
  v_pk_mul_f32 v[112:113], v[112:113], v[220:221]
  v_lshlrev_b32_e64 v220, 16, v75
  v_and_b32 v221, 0xffff0000, v75
  v_pk_mul_f32 v[114:115], v[114:115], v[222:223]
  v_lshlrev_b32_e64 v222, 16, v77
  v_and_b32 v223, 0xffff0000, v77
  v_pk_mul_f32 v[116:117], v[116:117], v[220:221]
  v_lshlrev_b32_e64 v220, 16, v79
  v_and_b32 v221, 0xffff0000, v79
  v_pk_mul_f32 v[118:119], v[118:119], v[222:223]
  v_lshlrev_b32_e64 v222, 16, v81
  v_and_b32 v223, 0xffff0000, v81
  v_pk_mul_f32 v[120:121], v[120:121], v[220:221]
  v_lshlrev_b32_e64 v220, 16, v83
  v_and_b32 v221, 0xffff0000, v83
  v_pk_mul_f32 v[122:123], v[122:123], v[222:223]
  v_lshlrev_b32_e64 v222, 16, v85
  v_and_b32 v223, 0xffff0000, v85
  v_pk_mul_f32 v[124:125], v[124:125], v[220:221]
  v_pk_mul_f32 v[126:127], v[126:127], v[222:223]
  v_cvt_pk_bf16_f32 v88, v126, v124
  v_cvt_pk_bf16_f32 v89, v122, v120
  v_cvt_pk_bf16_f32 v90, v118, v116
  v_cvt_pk_bf16_f32 v91, v114, v112
  v_cvt_pk_bf16_f32 v92, v127, v125
  v_cvt_pk_bf16_f32 v93, v123, v121
  v_cvt_pk_bf16_f32 v94, v119, v117
  v_cvt_pk_bf16_f32 v95, v115, v113
  s_waitcnt vmcnt(0)
  v_xor_b32 v15, s8, v184
  v_cmp_lt_u32 vcc, 15, v15
  s_cbranch_vccnz again_13
ok_14:
  s_or_b32 s13, s8, s11
  v_cmp_ne_u32 vcc, s13, v184
  s_cmp_eq_u64 vcc, 0
  s_cselect_b32 s9, 1, 0
  s_cmp_eq_u32 s7, 2
  s_cselect_b32 s40, 0, s9
  buffer_store_dwordx4 v[232:235], v171, s[52:55], s87 offen sc1
  s_add_u32 s87, s87, s36
  buffer_store_dwordx4 v[236:239], v171, s[52:55], s87 offen sc1
  s_add_u32 s87, s87, s36
  buffer_store_dwordx4 v[88:91], v171, s[52:55], s87 offen sc1
  s_add_u32 s87, s87, s36
  buffer_store_dwordx4 v[92:95], v171, s[52:55], s87 offen sc1
  s_branch join_12
w3_11:
  v_mov_b32 v171, 1879048192
  s_lshl_b32 s12, s4, 3
  s_and_b32 s13, s3, 7
  s_add_u32 s12, s12, s13
  s_mul_i32 s12, s12, 6400
  s_mov_b32 exec_hi, 0xff
  buffer_load_dwordx4 v[48:51], v150, s[60:63], s12 offen offset:0
  buffer_load_dwordx4 v[52:55], v150, s[60:63], s12 offen offset:128
  buffer_load_dwordx4 v[56:59], v150, s[60:63], s12 offen offset:256
  buffer_load_dwordx4 v[60:63], v150, s[60:63], s12 offen offset:384
  buffer_load_dwordx4 v[64:67], v150, s[60:63], s12 offen offset:512
  buffer_load_dwordx4 v[68:71], v150, s[60:63], s12 offen offset:640
  buffer_load_dwordx4 v[72:75], v150, s[60:63], s12 offen offset:768
  buffer_load_dwordx4 v[76:79], v150, s[60:63], s12 offen offset:896
  buffer_load_dwordx4 v[80:83], v150, s[60:63], s12 offen offset:1024
  buffer_load_dwordx4 v[84:87], v150, s[60:63], s12 offen offset:1152
  s_mov_b32 exec_hi, -1
  s_mov_b32 s64, s22
  s_and_b32 s65, s23, 0xffff
  s_mov_b32 s66, 819200
  s_mov_b32 s67, 0x20000
  v_xor_b32 v11, 64, v148
  v_xor_b32_e64 v12, 64, v149
  s_mul_i32 s15, s4, 51200
  s_add_u32 s14, s15, 256
  s_mov_b32 m0, 20480
  s_nop 0
  buffer_load_dwordx4 v11, s[64:67], s14 offen lds
  buffer_load_dwordx4 v12, s[64:67], s14 offen offset:2048 lds
  s_mov_b32 m0, 21504
  s_nop 0
  buffer_load_dwordx4 v148, s[56:59], s14 offen lds
  buffer_load_dwordx4 v149, s[56:59], s14 offen offset:2048 lds
  s_add_u32 s14, s15, 20736
  s_mov_b32 m0, 24576
  s_nop 0
  buffer_load_dwordx4 v11, s[64:67], s14 offen lds
  buffer_load_dwordx4 v12, s[64:67], s14 offen offset:2048 lds
  s_mov_b32 m0, 25600
  s_nop 0
  buffer_load_dwordx4 v148, s[56:59], s14 offen lds
  buffer_load_dwordx4 v149, s[56:59], s14 offen offset:2048 lds
  s_add_u32 s14, s15, 41216
  s_mov_b32 m0, 28672
  s_nop 0
  buffer_load_dwordx4 v11, s[64:67], s14 offen lds
  s_mov_b32 m0, 29696
  s_nop 0
  buffer_load_dwordx4 v148, s[56:59], s14 offen lds
  s_add_u32 s14, s15, 384
  s_mov_b32 m0, 30720
  s_nop 0
  buffer_load_dwordx4 v11, s[64:67], s14 offen lds
  buffer_load_dwordx4 v12, s[64:67], s14 offen offset:2048 lds
  s_mov_b32 m0, 31744
  s_nop 0
  buffer_load_dwordx4 v148, s[56:59], s14 offen lds
  buffer_load_dwordx4 v149, s[56:59], s14 offen offset:2048 lds
  s_add_u32 s14, s15, 20864
  s_mov_b32 m0, 34816
  s_nop 0
  buffer_load_dwordx4 v11, s[64:67], s14 offen lds
  buffer_load_dwordx4 v12, s[64:67], s14 offen offset:2048 lds
  s_mov_b32 m0, 35840
  s_nop 0
  buffer_load_dwordx4 v148, s[56:59], s14 offen lds
  buffer_load_dwordx4 v149, s[56:59], s14 offen offset:2048 lds
  s_add_u32 s14, s15, 41344
  s_mov_b32 m0, 38912
  s_nop 0
  buffer_load_dwordx4 v11, s[64:67], s14 offen lds
  s_mov_b32 m0, 39936
  s_nop 0
  buffer_load_dwordx4 v148, s[56:59], s14 offen lds
  s_mov_b32 s64, s22
  s_and_b32 s65, s23, 0xffff
  s_mov_b32 s66, 819200
  s_mov_b32 s67, 0x20000
  v_xor_b32 v11, 64, v148
  v_xor_b32_e64 v12, 64, v149
  s_mul_i32 s15, s4, 51200
  s_add_u32 s14, s15, 512
  s_mov_b32 m0, 40960
  s_nop 0
  buffer_load_dwordx4 v11, s[64:67], s14 offen lds
  buffer_load_dwordx4 v12, s[64:67], s14 offen offset:2048 lds
  s_mov_b32 m0, 41984
  s_nop 0
  buffer_load_dwordx4 v148, s[56:59], s14 offen lds
  buffer_load_dwordx4 v149, s[56:59], s14 offen offset:2048 lds
  s_add_u32 s14, s15, 20992
  s_mov_b32 m0, 45056
  s_nop 0
  buffer_load_dwordx4 v11, s[64:67], s14 offen lds
  buffer_load_dwordx4 v12, s[64:67], s14 offen offset:2048 lds
  s_mov_b32 m0, 46080
  s_nop 0
  buffer_load_dwordx4 v148, s[56:59], s14 offen lds
  buffer_load_dwordx4 v149, s[56:59], s14 offen offset:2048 lds
  s_add_u32 s14, s15, 41472
  s_mov_b32 m0, 49152
  s_nop 0
  buffer_load_dwordx4 v11, s[64:67], s14 offen lds
  s_mov_b32 m0, 50176
  s_nop 0
  buffer_load_dwordx4 v148, s[56:59], s14 offen lds
  s_add_u32 s14, s15, 640
  s_mov_b32 m0, 51200
  s_nop 0
  buffer_load_dwordx4 v11, s[64:67], s14 offen lds
  buffer_load_dwordx4 v12, s[64:67], s14 offen offset:2048 lds
  s_mov_b32 m0, 52224
  s_nop 0
  buffer_load_dwordx4 v148, s[56:59], s14 offen lds
  buffer_load_dwordx4 v149, s[56:59], s14 offen offset:2048 lds
  s_add_u32 s14, s15, 21120
  s_mov_b32 m0, 55296
  s_nop 0
  buffer_load_dwordx4 v11, s[64:67], s14 offen lds
  buffer_load_dwordx4 v12, s[64:67], s14 offen offset:2048 lds
  s_mov_b32 m0, 56320
  s_nop 0
  buffer_load_dwordx4 v148, s[56:59], s14 offen lds
  buffer_load_dwordx4 v149, s[56:59], s14 offen offset:2048 lds
  s_add_u32 s14, s15, 41600
  s_mov_b32 m0, 59392
  s_nop 0
  buffer_load_dwordx4 v11, s[64:67], s14 offen lds
  s_mov_b32 m0, 60416
  s_nop 0
  buffer_load_dwordx4 v148, s[56:59], s14 offen lds
  s_waitcnt vmcnt(50)
  v_xor_b32 v15, s8, v184
  v_cmp_lt_u32 vcc, 15, v15
  s_cbranch_vccnz again_15
ok_16:
  s_or_b32 s13, s8, s11
  v_cmp_ne_u32 vcc, s13, v184
  s_cmp_eq_u64 vcc, 0
  s_cselect_b32 s9, 1, 0
  s_cmp_eq_u32 s7, 2
  s_cselect_b32 s40, 0, s9
  s_waitcnt vmcnt(40)
  v_dot2_f32_bf16 v88, v48, s2, 0
  v_dot2_f32_bf16 v89, v49, s2, 0
  v_dot2_f32_bf16 v88, v50, s2, v88
  v_dot2_f32_bf16 v89, v51, s2, v89
  v_dot2_f32_bf16 v88, v52, s2, v88
  v_dot2_f32_bf16 v89, v53, s2, v89
  v_dot2_f32_bf16 v88, v54, s2, v88
  v_dot2_f32_bf16 v89, v55, s2, v89
  v_dot2_f32_bf16 v88, v56, s2, v88
  v_dot2_f32_bf16 v89, v57, s2, v89
  v_dot2_f32_bf16 v88, v58, s2, v88
  v_dot2_f32_bf16 v89, v59, s2, v89
  v_dot2_f32_bf16 v88, v60, s2, v88
  v_dot2_f32_bf16 v89, v61, s2, v89
  v_dot2_f32_bf16 v88, v62, s2, v88
  v_dot2_f32_bf16 v89, v63, s2, v89
  v_dot2_f32_bf16 v88, v64, s2, v88
  v_dot2_f32_bf16 v89, v65, s2, v89
  v_dot2_f32_bf16 v88, v66, s2, v88
  v_dot2_f32_bf16 v89, v67, s2, v89
  v_dot2_f32_bf16 v88, v68, s2, v88
  v_dot2_f32_bf16 v89, v69, s2, v89
  v_dot2_f32_bf16 v88, v70, s2, v88
  v_dot2_f32_bf16 v89, v71, s2, v89
  v_dot2_f32_bf16 v88, v72, s2, v88
  v_dot2_f32_bf16 v89, v73, s2, v89
  v_dot2_f32_bf16 v88, v74, s2, v88
  v_dot2_f32_bf16 v89, v75, s2, v89
  v_dot2_f32_bf16 v88, v76, s2, v88
  v_dot2_f32_bf16 v89, v77, s2, v89
  v_dot2_f32_bf16 v88, v78, s2, v88
  v_dot2_f32_bf16 v89, v79, s2, v89
  v_dot2_f32_bf16 v88, v80, s2, v88
  v_dot2_f32_bf16 v89, v81, s2, v89
  v_dot2_f32_bf16 v88, v82, s2, v88
  v_dot2_f32_bf16 v89, v83, s2, v89
  v_dot2_f32_bf16 v88, v84, s2, v88
  v_dot2_f32_bf16 v89, v85, s2, v89
  v_dot2_f32_bf16 v88, v86, s2, v88
  v_dot2_f32_bf16 v89, v87, s2, v89
  s_nop 2
  v_add_f32 v88, v88, v89
  s_nop 1
  v_add_f32_dpp v88, v88, v88 quad_perm:[1,0,3,2] row_mask:0xf bank_mask:0xf
  s_nop 1
  v_add_f32_dpp v88, v88, v88 quad_perm:[2,3,0,1] row_mask:0xf bank_mask:0xf
  s_nop 1
  v_add_f32_dpp v88, v88, v88 row_half_mirror row_mask:0xf bank_mask:0xf
  v_mov_b32 v89, s8
  v_lshlrev_b32 v11, 1, v1
  s_lshl_b32 s12, s4, 3
  s_and_b32 s13, s3, 7
  s_add_u32 s12, s12, s13
  s_mul_i32 s12, s12, 80
  s_and_b32 s13, s3, 8
  s_add_u32 s12, s12, s13
  s_add_u32 s12, s12, 303104
  s_mov_b32 exec_lo, 0x01010101
  s_mov_b32 exec_hi, 1
  buffer_store_dwordx2 v[88:89], v11, s[52:55], s12 offen sc1
  s_mov_b64 exec, -1
join_12:
  s_waitcnt lgkmcnt(0)
  v_mul_f32_e64 v21, v151, v21
  v_mul_f32_dpp v27, v26, v151 quad_perm:[1,0,3,2] row_mask:0xf bank_mask:0xf
  v_mul_f32_e64 v22, v151, v22
  v_mul_f32_dpp v29, v28, v151 quad_perm:[1,0,3,2] row_mask:0xf bank_mask:0xf
  v_mul_f32_e64 v23, v151, v23
  v_mul_f32_dpp v31, v30, v151 quad_perm:[1,0,3,2] row_mask:0xf bank_mask:0xf
  v_mul_f32_e64 v24, v151, v24
  v_mul_f32_dpp v33, v32, v151 quad_perm:[1,0,3,2] row_mask:0xf bank_mask:0xf
  v_mul_f32_e64 v25, v151, v25
  v_mul_f32_dpp v35, v34, v151 quad_perm:[1,0,3,2] row_mask:0xf bank_mask:0xf
  s_waitcnt vmcnt(7)
  s_barrier
  ds_read_b128 v[128:131], v144 offset:0
  ds_read_b128 v[132:135], v144 offset:8192
  ds_read_b128 v[88:91], v5 offset:0
  ds_read_b128 v[92:95], v5 offset:2048
  ds_read_b128 v[96:99], v5 offset:4096
  ds_read_b128 v[100:103], v5 offset:6144
  ds_read_b128 v[104:107], v5 offset:8192
  s_add_u32 m0, s77, 16384
  s_add_u32 s15, s76, 128
  buffer_load_dwordx4 v146, s[68:71], s15 offen lds
  buffer_load_dwordx4 v147, s[68:71], s15 offen offset:1024 lds
  s_add_u32 m0, s77, 24576
  s_add_u32 s15, s76, 5248
  buffer_load_dwordx4 v146, s[68:71], s15 offen lds
  buffer_load_dwordx4 v147, s[68:71], s15 offen offset:1024 lds
  s_waitcnt lgkmcnt(4)
  v_mfma_f32_16x16x32_bf16 v[48:51], v[128:131], v[88:91], 0
  ds_read_b128 v[136:139], v145 offset:0
  ds_read_b128 v[140:143], v145 offset:8192
  ds_read_b128 v[108:111], v6 offset:0
  ds_read_b128 v[192:195], v175 offset:0
  ds_read_b128 v[196:199], v175 offset:16
  v_mfma_f32_16x16x32_bf16 v[52:55], v[132:135], v[88:91], 0
  ds_read_b128 v[200:203], v175 offset:32
  ds_read_b128 v[204:207], v175 offset:48
  s_waitcnt lgkmcnt(10)
  v_mfma_f32_16x16x32_bf16 v[56:59], v[128:131], v[92:95], 0
  ds_read_b128 v[112:115], v6 offset:2048
  s_waitcnt vmcnt(9)
  s_waitcnt lgkmcnt(1)
  v_lshlrev_b32_e64 v152, 16, v176
  v_mfma_f32_16x16x32_bf16 v[60:63], v[132:135], v[92:95], 0
  v_and_b32 v153, 0xffff0000, v176
  v_lshlrev_b32_e64 v154, 16, v180
  v_mfma_f32_16x16x32_bf16 v[64:67], v[128:131], v[96:99], 0
  ds_read_b128 v[116:119], v6 offset:4096
  v_and_b32 v155, 0xffff0000, v180
  v_pk_mul_f32 v[156:157], v[152:153], v[192:193]
  v_mfma_f32_16x16x32_bf16 v[68:71], v[132:135], v[96:99], 0
  v_pk_mul_f32 v[158:159], v[152:153], v[194:195] neg_lo:[0,1] neg_hi:[0,1]
  v_pk_fma_f32 v[156:157], v[154:155], v[194:195], v[156:157] neg_lo:[0,1,0] neg_hi:[0,1,0]
  v_mfma_f32_16x16x32_bf16 v[72:75], v[128:131], v[100:103], 0
  ds_read_b128 v[120:123], v6 offset:6144
  v_pk_fma_f32 v[158:159], v[154:155], v[192:193], v[158:159] neg_lo:[0,1,0] neg_hi:[0,1,0]
  v_cvt_pk_bf16_f32 v176, v156, v157
  v_mfma_f32_16x16x32_bf16 v[76:79], v[132:135], v[100:103], 0
  s_add_u32 m0, s77, 32768
  s_add_u32 s15, s76, 256
  buffer_load_dwordx4 v146, s[68:71], s15 offen lds
  buffer_load_dwordx4 v147, s[68:71], s15 offen offset:1024 lds
  s_add_u32 m0, s77, 40960
  s_add_u32 s15, s76, 5376
  buffer_load_dwordx4 v146, s[68:71], s15 offen lds
  buffer_load_dwordx4 v147, s[68:71], s15 offen offset:1024 lds
  v_mfma_f32_16x16x32_bf16 v[80:83], v[128:131], v[104:107], 0
  ds_read_b128 v[124:127], v6 offset:8192
  s_add_u32 m0, s75, 61440
  s_add_u32 s14, s74, 768
  buffer_load_dwordx4 v148, s[56:59], s14 offen lds
  buffer_load_dwordx4 v149, s[56:59], s14 offen offset:2048 lds
  v_mfma_f32_16x16x32_bf16 v[84:87], v[132:135], v[104:107], 0
  s_add_u32 m0, s75, 65536
  s_add_u32 s14, s74, 21248
  buffer_load_dwordx4 v148, s[56:59], s14 offen lds
  buffer_load_dwordx4 v149, s[56:59], s14 offen offset:2048 lds
  s_waitcnt vmcnt(8)
  s_waitcnt lgkmcnt(2)
  v_mfma_f32_16x16x32_bf16 v[48:51], v[136:139], v[108:111], v[48:51]
  ds_read_b128 v[128:131], v144 offset:16384
  ds_read_b128 v[132:135], v144 offset:24576
  ds_read_b128 v[88:91], v5 offset:10240
  v_cvt_pk_bf16_f32 v180, v158, v159
  v_lshlrev_b32_e64 v152, 16, v177
  v_mfma_f32_16x16x32_bf16 v[52:55], v[140:143], v[108:111], v[52:55]
  v_and_b32 v153, 0xffff0000, v177
  v_lshlrev_b32_e64 v154, 16, v181
  v_mfma_f32_16x16x32_bf16 v[56:59], v[136:139], v[112:115], v[56:59]
  ds_read_b128 v[92:95], v5 offset:12288
  v_and_b32 v155, 0xffff0000, v181
  v_pk_mul_f32 v[156:157], v[152:153], v[196:197]
  v_mfma_f32_16x16x32_bf16 v[60:63], v[140:143], v[112:115], v[60:63]
  v_pk_mul_f32 v[158:159], v[152:153], v[198:199] neg_lo:[0,1] neg_hi:[0,1]
  v_pk_fma_f32 v[156:157], v[154:155], v[198:199], v[156:157] neg_lo:[0,1,0] neg_hi:[0,1,0]
  v_mfma_f32_16x16x32_bf16 v[64:67], v[136:139], v[116:119], v[64:67]
  ds_read_b128 v[96:99], v5 offset:14336
  v_pk_fma_f32 v[158:159], v[154:155], v[196:197], v[158:159] neg_lo:[0,1,0] neg_hi:[0,1,0]
  v_cvt_pk_bf16_f32 v177, v156, v157
  v_mfma_f32_16x16x32_bf16 v[68:71], v[140:143], v[116:119], v[68:71]
  v_cvt_pk_bf16_f32 v181, v158, v159
  v_lshlrev_b32 v152, 16, v178
  s_waitcnt lgkmcnt(5)
  v_mfma_f32_16x16x32_bf16 v[72:75], v[136:139], v[120:123], v[72:75]
  ds_read_b128 v[100:103], v5 offset:16384
  v_and_b32 v153, 0xffff0000, v178
  v_lshlrev_b32_e64 v154, 16, v182
  v_mfma_f32_16x16x32_bf16 v[76:79], v[140:143], v[120:123], v[76:79]
  s_add_u32 m0, s77, 49152
  s_add_u32 s15, s76, 384
  buffer_load_dwordx4 v146, s[68:71], s15 offen lds
  buffer_load_dwordx4 v147, s[68:71], s15 offen offset:1024 lds
  v_mfma_f32_16x16x32_bf16 v[80:83], v[136:139], v[124:127], v[80:83]
  ds_read_b128 v[104:107], v5 offset:18432
  s_add_u32 m0, s77, 0
  s_add_u32 s15, s76, 5504
  buffer_load_dwordx4 v146, s[68:71], s15 offen lds
  buffer_load_dwordx4 v147, s[68:71], s15 offen offset:1024 lds
  v_mfma_f32_16x16x32_bf16 v[84:87], v[140:143], v[124:127], v[84:87]
  s_add_u32 m0, s75, 69632
  s_add_u32 s14, s74, 41728
  buffer_load_dwordx4 v148, s[56:59], s14 offen lds
  s_waitcnt lgkmcnt(2)
  v_mfma_f32_16x16x32_bf16 v[48:51], v[128:131], v[88:91], v[48:51]
  ds_read_b128 v[136:139], v145 offset:16384
  ds_read_b128 v[140:143], v145 offset:24576
  ds_read_b128 v[108:111], v6 offset:10240
  v_and_b32 v155, 0xffff0000, v182
  v_pk_mul_f32 v[156:157], v[152:153], v[200:201]
  v_mfma_f32_16x16x32_bf16 v[52:55], v[132:135], v[88:91], v[52:55]
  v_pk_mul_f32 v[158:159], v[152:153], v[202:203] neg_lo:[0,1] neg_hi:[0,1]
  v_pk_fma_f32 v[156:157], v[154:155], v[202:203], v[156:157] neg_lo:[0,1,0] neg_hi:[0,1,0]
  v_mfma_f32_16x16x32_bf16 v[56:59], v[128:131], v[92:95], v[56:59]
  ds_read_b128 v[112:115], v6 offset:12288
  v_pk_fma_f32 v[158:159], v[154:155], v[200:201], v[158:159] neg_lo:[0,1,0] neg_hi:[0,1,0]
  v_cvt_pk_bf16_f32 v178, v156, v157
  v_mfma_f32_16x16x32_bf16 v[60:63], v[132:135], v[92:95], v[60:63]
  v_cvt_pk_bf16_f32 v182, v158, v159
  v_lshlrev_b32_e64 v152, 16, v179
  v_mfma_f32_16x16x32_bf16 v[64:67], v[128:131], v[96:99], v[64:67]
  ds_read_b128 v[116:119], v6 offset:14336
  v_and_b32 v153, 0xffff0000, v179
  v_lshlrev_b32_e64 v154, 16, v183
  v_mfma_f32_16x16x32_bf16 v[68:71], v[132:135], v[96:99], v[68:71]
  v_and_b32 v155, 0xffff0000, v183
  v_pk_mul_f32 v[156:157], v[152:153], v[204:205]
  s_waitcnt lgkmcnt(5)
  v_mfma_f32_16x16x32_bf16 v[72:75], v[128:131], v[100:103], v[72:75]
  ds_read_b128 v[120:123], v6 offset:16384
  v_pk_mul_f32 v[158:159], v[152:153], v[206:207] neg_lo:[0,1] neg_hi:[0,1]
  v_pk_fma_f32 v[156:157], v[154:155], v[206:207], v[156:157] neg_lo:[0,1,0] neg_hi:[0,1,0]
  v_mfma_f32_16x16x32_bf16 v[76:79], v[132:135], v[100:103], v[76:79]
  s_add_u32 m0, s77, 8192
  s_add_u32 s15, s76, 512
  buffer_load_dwordx4 v146, s[68:71], s15 offen lds
  buffer_load_dwordx4 v147, s[68:71], s15 offen offset:1024 lds
  v_mfma_f32_16x16x32_bf16 v[80:83], v[128:131], v[104:107], v[80:83]
  ds_read_b128 v[124:127], v6 offset:18432
  s_add_u32 m0, s75, 81920
  s_add_u32 s14, s74, 1024
  buffer_load_dwordx4 v148, s[56:59], s14 offen lds
  buffer_load_dwordx4 v149, s[56:59], s14 offen offset:2048 lds
  v_mfma_f32_16x16x32_bf16 v[84:87], v[132:135], v[104:107], v[84:87]
  s_add_u32 m0, s75, 86016
  s_add_u32 s14, s74, 21504
  buffer_load_dwordx4 v148, s[56:59], s14 offen lds
  buffer_load_dwordx4 v149, s[56:59], s14 offen offset:2048 lds
  s_waitcnt vmcnt(15)
  s_barrier
  s_waitcnt lgkmcnt(2)
  v_mfma_f32_16x16x32_bf16 v[48:51], v[136:139], v[108:111], v[48:51]
  ds_read_b128 v[128:131], v144 offset:32768
  ds_read_b128 v[132:135], v144 offset:40960
  ds_read_b128 v[88:91], v5 offset:20480
  v_pk_fma_f32 v[158:159], v[154:155], v[204:205], v[158:159] neg_lo:[0,1,0] neg_hi:[0,1,0]
  v_mfma_f32_16x16x32_bf16 v[52:55], v[140:143], v[108:111], v[52:55]
  v_cvt_pk_bf16_f32 v179, v156, v157
  v_mfma_f32_16x16x32_bf16 v[56:59], v[136:139], v[112:115], v[56:59]
  ds_read_b128 v[92:95], v5 offset:22528
  v_cvt_pk_bf16_f32 v183, v158, v159
  v_mfma_f32_16x16x32_bf16 v[60:63], v[140:143], v[112:115], v[60:63]
  s_mul_i32 s12, s0, 204800
  s_add_u32 s12, s12, 23068672
  s_add_u32 s13, s12, 5120
  buffer_store_dwordx4 v[176:179], v174, s[52:55], s12 offen sc1
  buffer_store_dwordx4 v[180:183], v174, s[52:55], s13 offen sc1
  v_mfma_f32_16x16x32_bf16 v[64:67], v[136:139], v[116:119], v[64:67]
  ds_read_b128 v[96:99], v5 offset:24576
  s_add_u32 m0, s77, 16384
  s_add_u32 s15, s76, 5632
  buffer_load_dwordx4 v146, s[68:71], s15 offen lds
  buffer_load_dwordx4 v147, s[68:71], s15 offen offset:1024 lds
  v_mfma_f32_16x16x32_bf16 v[68:71], v[140:143], v[116:119], v[68:71]
  s_add_u32 m0, s75, 90112
  s_add_u32 s14, s74, 41984
  buffer_load_dwordx4 v148, s[56:59], s14 offen lds
  s_waitcnt lgkmcnt(5)
  v_mfma_f32_16x16x32_bf16 v[72:75], v[136:139], v[120:123], v[72:75]
  ds_read_b128 v[100:103], v5 offset:26624
  v_mfma_f32_16x16x32_bf16 v[76:79], v[140:143], v[120:123], v[76:79]
  v_mfma_f32_16x16x32_bf16 v[80:83], v[136:139], v[124:127], v[80:83]
  ds_read_b128 v[104:107], v5 offset:28672
  v_mfma_f32_16x16x32_bf16 v[84:87], v[140:143], v[124:127], v[84:87]
  s_waitcnt lgkmcnt(2)
  v_mfma_f32_16x16x32_bf16 v[48:51], v[128:131], v[88:91], v[48:51]
  ds_read_b128 v[136:139], v145 offset:32768
  ds_read_b128 v[140:143], v145 offset:40960
  ds_read_b128 v[108:111], v6 offset:20480
  s_add_u32 m0, s77, 24576
  s_add_u32 s15, s76, 640
  buffer_load_dwordx4 v146, s[68:71], s15 offen lds
  buffer_load_dwordx4 v147, s[68:71], s15 offen offset:1024 lds
  v_mfma_f32_16x16x32_bf16 v[52:55], v[132:135], v[88:91], v[52:55]
  v_mfma_f32_16x16x32_bf16 v[56:59], v[128:131], v[92:95], v[56:59]
  ds_read_b128 v[112:115], v6 offset:22528
  v_mfma_f32_16x16x32_bf16 v[60:63], v[132:135], v[92:95], v[60:63]
  v_mfma_f32_16x16x32_bf16 v[64:67], v[128:131], v[96:99], v[64:67]
  ds_read_b128 v[116:119], v6 offset:24576
  v_mfma_f32_16x16x32_bf16 v[68:71], v[132:135], v[96:99], v[68:71]
  s_waitcnt lgkmcnt(5)
  v_mfma_f32_16x16x32_bf16 v[72:75], v[128:131], v[100:103], v[72:75]
  ds_read_b128 v[120:123], v6 offset:26624
  v_mfma_f32_16x16x32_bf16 v[76:79], v[132:135], v[100:103], v[76:79]
  v_mfma_f32_16x16x32_bf16 v[80:83], v[128:131], v[104:107], v[80:83]
  ds_read_b128 v[124:127], v6 offset:28672
  v_mfma_f32_16x16x32_bf16 v[84:87], v[132:135], v[104:107], v[84:87]
  s_waitcnt vmcnt(14)
  s_waitcnt lgkmcnt(2)
  v_mfma_f32_16x16x32_bf16 v[48:51], v[136:139], v[108:111], v[48:51]
  ds_read_b128 v[128:131], v144 offset:49152
  ds_read_b128 v[132:135], v144 offset:0
  ds_read_b128 v[88:91], v5 offset:30720
  s_add_u32 m0, s77, 32768
  s_add_u32 s15, s76, 5760
  buffer_load_dwordx4 v146, s[68:71], s15 offen lds
  buffer_load_dwordx4 v147, s[68:71], s15 offen offset:1024 lds
  v_mfma_f32_16x16x32_bf16 v[52:55], v[140:143], v[108:111], v[52:55]
  v_mov_b32 v15, s8
  s_mov_b64 exec, 1
  s_cmp_eq_u32 s40, 0
  s_cbranch_scc1 slow_17
  buffer_store_dword v15, off, s[52:55], s41
back_18:
  s_mov_b64 exec, -1
  v_mfma_f32_16x16x32_bf16 v[56:59], v[136:139], v[112:115], v[56:59]
  ds_read_b128 v[92:95], v5 offset:32768
  v_mfma_f32_16x16x32_bf16 v[60:63], v[140:143], v[112:115], v[60:63]
  v_mfma_f32_16x16x32_bf16 v[64:67], v[136:139], v[116:119], v[64:67]
  ds_read_b128 v[96:99], v5 offset:34816
  v_mfma_f32_16x16x32_bf16 v[68:71], v[140:143], v[116:119], v[68:71]
  s_waitcnt lgkmcnt(5)
  v_mfma_f32_16x16x32_bf16 v[72:75], v[136:139], v[120:123], v[72:75]
  ds_read_b128 v[100:103], v5 offset:36864
  v_mfma_f32_16x16x32_bf16 v[76:79], v[140:143], v[120:123], v[76:79]
  v_mfma_f32_16x16x32_bf16 v[80:83], v[136:139], v[124:127], v[80:83]
  ds_read_b128 v[104:107], v5 offset:38912
  v_mfma_f32_16x16x32_bf16 v[84:87], v[140:143], v[124:127], v[84:87]
  s_waitcnt lgkmcnt(2)
  v_mfma_f32_16x16x32_bf16 v[48:51], v[128:131], v[88:91], v[48:51]
  ds_read_b128 v[136:139], v145 offset:49152
  ds_read_b128 v[140:143], v145 offset:0
  ds_read_b128 v[108:111], v6 offset:30720
  s_add_u32 m0, s77, 40960
  s_add_u32 s15, s76, 768
  buffer_load_dwordx4 v146, s[68:71], s15 offen lds
  buffer_load_dwordx4 v147, s[68:71], s15 offen offset:1024 lds
  v_mfma_f32_16x16x32_bf16 v[52:55], v[132:135], v[88:91], v[52:55]
  v_mfma_f32_16x16x32_bf16 v[56:59], v[128:131], v[92:95], v[56:59]
  ds_read_b128 v[112:115], v6 offset:32768
  v_mfma_f32_16x16x32_bf16 v[60:63], v[132:135], v[92:95], v[60:63]
  v_mfma_f32_16x16x32_bf16 v[64:67], v[128:131], v[96:99], v[64:67]
  ds_read_b128 v[116:119], v6 offset:34816
  v_mfma_f32_16x16x32_bf16 v[68:71], v[132:135], v[96:99], v[68:71]
  s_waitcnt lgkmcnt(5)
  v_mfma_f32_16x16x32_bf16 v[72:75], v[128:131], v[100:103], v[72:75]
  ds_read_b128 v[120:123], v6 offset:36864
  v_mfma_f32_16x16x32_bf16 v[76:79], v[132:135], v[100:103], v[76:79]
  v_mfma_f32_16x16x32_bf16 v[80:83], v[128:131], v[104:107], v[80:83]
  ds_read_b128 v[124:127], v6 offset:38912
  v_mfma_f32_16x16x32_bf16 v[84:87], v[132:135], v[104:107], v[84:87]
  s_waitcnt vmcnt(8)
  s_barrier
  s_waitcnt lgkmcnt(2)
  v_mfma_f32_16x16x32_bf16 v[48:51], v[136:139], v[108:111], v[48:51]
  ds_read_b128 v[128:131], v144 offset:8192
  ds_read_b128 v[132:135], v144 offset:16384
  ds_read_b128 v[88:91], v5 offset:40960
  s_add_u32 m0, s77, 49152
  s_add_u32 s15, s76, 5888
  buffer_load_dwordx4 v146, s[68:71], s15 offen lds
  buffer_load_dwordx4 v147, s[68:71], s15 offen offset:1024 lds
  v_mfma_f32_16x16x32_bf16 v[52:55], v[140:143], v[108:111], v[52:55]
  s_add_u32 s12, s85, 66048
  v_mov_b32 v15, s8
  s_mov_b64 exec, 1
  buffer_store_dword v15, off, s[52:55], s12 sc1
  s_mov_b64 exec, -1
  v_mfma_f32_16x16x32_bf16 v[56:59], v[136:139], v[112:115], v[56:59]
  ds_read_b128 v[92:95], v5 offset:43008
  v_mfma_f32_16x16x32_bf16 v[60:63], v[140:143], v[112:115], v[60:63]
  v_mfma_f32_16x16x32_bf16 v[64:67], v[136:139], v[116:119], v[64:67]
  ds_read_b128 v[96:99], v5 offset:45056
  v_mfma_f32_16x16x32_bf16 v[68:71], v[140:143], v[116:119], v[68:71]
  s_waitcnt lgkmcnt(5)
  v_mfma_f32_16x16x32_bf16 v[72:75], v[136:139], v[120:123], v[72:75]
  ds_read_b128 v[100:103], v5 offset:47104
  v_mfma_f32_16x16x32_bf16 v[76:79], v[140:143], v[120:123], v[76:79]
  v_mfma_f32_16x16x32_bf16 v[80:83], v[136:139], v[124:127], v[80:83]
  ds_read_b128 v[104:107], v5 offset:49152
  v_mfma_f32_16x16x32_bf16 v[84:87], v[140:143], v[124:127], v[84:87]
  s_waitcnt lgkmcnt(2)
  v_mfma_f32_16x16x32_bf16 v[48:51], v[128:131], v[88:91], v[48:51]
  ds_read_b128 v[136:139], v145 offset:8192
  ds_read_b128 v[140:143], v145 offset:16384
  ds_read_b128 v[108:111], v6 offset:40960
  s_add_u32 m0, s77, 0
  s_add_u32 s15, s76, 896
  buffer_load_dwordx4 v146, s[68:71], s15 offen lds
  buffer_load_dwordx4 v147, s[68:71], s15 offen offset:1024 lds
  v_mfma_f32_16x16x32_bf16 v[52:55], v[132:135], v[88:91], v[52:55]
  s_min_u32 s12, s7, 2
  s_mul_i32 s12, s12, 4608
  v_add_u32 v11, s12, v2
  v_mov_b32 v216, 0
  v_mov_b32 v217, 0
  v_mov_b32 v218, 0
  v_mov_b32 v219, 0
  s_mov_b32 exec_hi, 0
  ds_write_b128 v11, v[216:219] offset:4096
  s_mov_b32 exec_hi, -1
  v_mfma_f32_16x16x32_bf16 v[56:59], v[128:131], v[92:95], v[56:59]
  ds_read_b128 v[112:115], v6 offset:43008
  v_mfma_f32_16x16x32_bf16 v[60:63], v[132:135], v[92:95], v[60:63]
  v_mfma_f32_16x16x32_bf16 v[64:67], v[128:131], v[96:99], v[64:67]
  ds_read_b128 v[116:119], v6 offset:45056
  v_mfma_f32_16x16x32_bf16 v[68:71], v[132:135], v[96:99], v[68:71]
  s_waitcnt lgkmcnt(6)
  v_mfma_f32_16x16x32_bf16 v[72:75], v[128:131], v[100:103], v[72:75]
  ds_read_b128 v[120:123], v6 offset:47104
  v_mfma_f32_16x16x32_bf16 v[76:79], v[132:135], v[100:103], v[76:79]
  v_mfma_f32_16x16x32_bf16 v[80:83], v[128:131], v[104:107], v[80:83]
  ds_read_b128 v[124:127], v6 offset:49152
  v_mfma_f32_16x16x32_bf16 v[84:87], v[132:135], v[104:107], v[84:87]
  s_waitcnt vmcnt(8)
  s_waitcnt lgkmcnt(2)
  v_mfma_f32_16x16x32_bf16 v[48:51], v[136:139], v[108:111], v[48:51]
  ds_read_b128 v[128:131], v144 offset:24576
  ds_read_b128 v[132:135], v144 offset:32768
  ds_read_b128 v[88:91], v7 offset:0
  s_add_u32 m0, s77, 8192
  s_add_u32 s15, s76, 6016
  buffer_load_dwordx4 v146, s[68:71], s15 offen lds
  buffer_load_dwordx4 v147, s[68:71], s15 offen offset:1024 lds
  v_mfma_f32_16x16x32_bf16 v[52:55], v[140:143], v[108:111], v[52:55]
  v_mfma_f32_16x16x32_bf16 v[56:59], v[136:139], v[112:115], v[56:59]
  ds_read_b128 v[92:95], v7 offset:2048
  v_mfma_f32_16x16x32_bf16 v[60:63], v[140:143], v[112:115], v[60:63]
  v_mfma_f32_16x16x32_bf16 v[64:67], v[136:139], v[116:119], v[64:67]
  ds_read_b128 v[96:99], v7 offset:4096
  v_mfma_f32_16x16x32_bf16 v[68:71], v[140:143], v[116:119], v[68:71]
  s_waitcnt lgkmcnt(5)
  v_mfma_f32_16x16x32_bf16 v[72:75], v[136:139], v[120:123], v[72:75]
  ds_read_b128 v[100:103], v7 offset:6144
  v_mfma_f32_16x16x32_bf16 v[76:79], v[140:143], v[120:123], v[76:79]
  v_mfma_f32_16x16x32_bf16 v[80:83], v[136:139], v[124:127], v[80:83]
  ds_read_b128 v[104:107], v7 offset:8192
  v_mfma_f32_16x16x32_bf16 v[84:87], v[140:143], v[124:127], v[84:87]
  s_waitcnt lgkmcnt(2)
  v_mfma_f32_16x16x32_bf16 v[48:51], v[128:131], v[88:91], v[48:51]
  ds_read_b128 v[136:139], v145 offset:24576
  ds_read_b128 v[140:143], v145 offset:32768
  ds_read_b128 v[108:111], v8 offset:0
  s_add_u32 m0, s77, 16384
  s_add_u32 s15, s76, 1024
  buffer_load_dwordx4 v146, s[68:71], s15 offen lds
  buffer_load_dwordx4 v147, s[68:71], s15 offen offset:1024 lds
  v_mfma_f32_16x16x32_bf16 v[52:55], v[132:135], v[88:91], v[52:55]
  s_and_b32 s87, s85, 0x3800
  s_add_u32 s87, s87, 65536
  buffer_load_dwordx2 v[188:189], v187, s[52:55], s87 offen sc1
  v_mfma_f32_16x16x32_bf16 v[56:59], v[128:131], v[92:95], v[56:59]
  ds_read_b128 v[112:115], v8 offset:2048
  v_mfma_f32_16x16x32_bf16 v[60:63], v[132:135], v[92:95], v[60:63]
  v_mfma_f32_16x16x32_bf16 v[64:67], v[128:131], v[96:99], v[64:67]
  ds_read_b128 v[116:119], v8 offset:4096
  v_mfma_f32_16x16x32_bf16 v[68:71], v[132:135], v[96:99], v[68:71]
  s_waitcnt lgkmcnt(5)
  v_mfma_f32_16x16x32_bf16 v[72:75], v[128:131], v[100:103], v[72:75]
  ds_read_b128 v[120:123], v8 offset:6144
  v_mfma_f32_16x16x32_bf16 v[76:79], v[132:135], v[100:103], v[76:79]
  v_mfma_f32_16x16x32_bf16 v[80:83], v[128:131], v[104:107], v[80:83]
  ds_read_b128 v[124:127], v8 offset:8192
  v_mfma_f32_16x16x32_bf16 v[84:87], v[132:135], v[104:107], v[84:87]
  s_waitcnt vmcnt(8)
  s_barrier
  s_waitcnt lgkmcnt(2)
  v_mfma_f32_16x16x32_bf16 v[48:51], v[136:139], v[108:111], v[48:51]
  ds_read_b128 v[128:131], v144 offset:40960
  ds_read_b128 v[132:135], v144 offset:49152
  ds_read_b128 v[88:91], v7 offset:10240
  s_add_u32 m0, s77, 24576
  s_add_u32 s15, s76, 6144
  buffer_load_dwordx4 v146, s[68:71], s15 offen lds
  buffer_load_dwordx4 v147, s[68:71], s15 offen offset:1024 lds
  v_mfma_f32_16x16x32_bf16 v[52:55], v[140:143], v[108:111], v[52:55]
  v_mfma_f32_16x16x32_bf16 v[56:59], v[136:139], v[112:115], v[56:59]
  ds_read_b128 v[92:95], v7 offset:12288
  v_mfma_f32_16x16x32_bf16 v[60:63], v[140:143], v[112:115], v[60:63]
  v_mfma_f32_16x16x32_bf16 v[64:67], v[136:139], v[116:119], v[64:67]
  ds_read_b128 v[96:99], v7 offset:14336
  v_mfma_f32_16x16x32_bf16 v[68:71], v[140:143], v[116:119], v[68:71]
  s_waitcnt lgkmcnt(5)
  v_mfma_f32_16x16x32_bf16 v[72:75], v[136:139], v[120:123], v[72:75]
  ds_read_b128 v[100:103], v7 offset:16384
  v_mfma_f32_16x16x32_bf16 v[76:79], v[140:143], v[120:123], v[76:79]
  v_mfma_f32_16x16x32_bf16 v[80:83], v[136:139], v[124:127], v[80:83]
  ds_read_b128 v[104:107], v7 offset:18432
  v_mfma_f32_16x16x32_bf16 v[84:87], v[140:143], v[124:127], v[84:87]
  s_waitcnt lgkmcnt(2)
  v_mfma_f32_16x16x32_bf16 v[48:51], v[128:131], v[88:91], v[48:51]
  ds_read_b128 v[136:139], v145 offset:40960
  ds_read_b128 v[140:143], v145 offset:49152
  ds_read_b128 v[108:111], v8 offset:10240
  s_add_u32 m0, s77, 32768
  s_add_u32 s15, s76, 1152
  buffer_load_dwordx4 v146, s[68:71], s15 offen lds
  buffer_load_dwordx4 v147, s[68:71], s15 offen offset:1024 lds
  v_mfma_f32_16x16x32_bf16 v[52:55], v[132:135], v[88:91], v[52:55]
  s_waitcnt vmcnt(4)
  v_xor_b32 v15, s8, v188
  v_xor_b32 v14, s8, v189
  v_or_b32 v15, v15, v14
  v_cmp_ne_u32 vcc, 0, v15
  s_cbranch_vccnz again_19
ok_20:
  s_lshl_b32 s12, s0, 16
  s_add_u32 s12, s12, s90
  s_add_u32 s12, s12, 4194304
  s_lshl_b32 m0, s7, 10
  s_nop 0
  buffer_load_dwordx4 v2, s[52:55], s12 offen sc1 lds
  s_lshl_b32 s12, s0, 16
  s_add_u32 s12, s12, s91
  s_add_u32 s12, s12, 4194304
  s_lshl_b32 m0, s7, 10
  s_add_u32 m0, m0, 4608
  s_nop 0
  buffer_load_dwordx4 v2, s[52:55], s12 offen sc1 lds
  v_mfma_f32_16x16x32_bf16 v[56:59], v[128:131], v[92:95], v[56:59]
  ds_read_b128 v[112:115], v8 offset:12288
  v_mfma_f32_16x16x32_bf16 v[60:63], v[132:135], v[92:95], v[60:63]
  v_mfma_f32_16x16x32_bf16 v[64:67], v[128:131], v[96:99], v[64:67]
  ds_read_b128 v[116:119], v8 offset:14336
  v_mfma_f32_16x16x32_bf16 v[68:71], v[132:135], v[96:99], v[68:71]
  s_waitcnt lgkmcnt(5)
  v_mfma_f32_16x16x32_bf16 v[72:75], v[128:131], v[100:103], v[72:75]
  ds_read_b128 v[120:123], v8 offset:16384
  v_mfma_f32_16x16x32_bf16 v[76:79], v[132:135], v[100:103], v[76:79]
  v_mfma_f32_16x16x32_bf16 v[80:83], v[128:131], v[104:107], v[80:83]
  ds_read_b128 v[124:127], v8 offset:18432
  v_mfma_f32_16x16x32_bf16 v[84:87], v[132:135], v[104:107], v[84:87]
  s_waitcnt lgkmcnt(2)
  v_mfma_f32_16x16x32_bf16 v[48:51], v[136:139], v[108:111], v[48:51]
  ds_read_b128 v[128:131], v144 offset:0
  ds_read_b128 v[132:135], v144 offset:8192
  ds_read_b128 v[88:91], v7 offset:20480
  s_add_u32 m0, s77, 40960
  s_add_u32 s15, s76, 6272
  buffer_load_dwordx4 v146, s[68:71], s15 offen lds
  buffer_load_dwordx4 v147, s[68:71], s15 offen offset:1024 lds
  v_mfma_f32_16x16x32_bf16 v[52:55], v[140:143], v[108:111], v[52:55]
  buffer_load_dwordx3 v[152:154], v160, s[52:55], s93 offen sc1
  v_mfma_f32_16x16x32_bf16 v[56:59], v[136:139], v[112:115], v[56:59]
  ds_read_b128 v[92:95], v7 offset:22528
  buffer_load_dwordx2 v[156:157], v161, s[52:55], s94 offen sc1
  v_mfma_f32_16x16x32_bf16 v[60:63], v[140:143], v[112:115], v[60:63]
  buffer_load_dwordx2 v[158:159], v162, s[52:55], s94 offen offset:512 sc1
  v_mfma_f32_16x16x32_bf16 v[64:67], v[136:139], v[116:119], v[64:67]
  ds_read_b128 v[96:99], v7 offset:24576
  s_mov_b32 s36, 32768
  buffer_load_dwordx4 v[220:223], v2, s[52:55], s36 offen sc1
  v_mfma_f32_16x16x32_bf16 v[68:71], v[140:143], v[116:119], v[68:71]
  s_waitcnt lgkmcnt(5)
  v_mfma_f32_16x16x32_bf16 v[72:75], v[136:139], v[120:123], v[72:75]
  ds_read_b128 v[100:103], v7 offset:26624
  v_mfma_f32_16x16x32_bf16 v[76:79], v[140:143], v[120:123], v[76:79]
  v_mfma_f32_16x16x32_bf16 v[80:83], v[136:139], v[124:127], v[80:83]
  ds_read_b128 v[104:107], v7 offset:28672
  v_mfma_f32_16x16x32_bf16 v[84:87], v[140:143], v[124:127], v[84:87]
  s_waitcnt lgkmcnt(2)
  v_mfma_f32_16x16x32_bf16 v[48:51], v[128:131], v[88:91], v[48:51]
  ds_read_b128 v[136:139], v145 offset:0
  ds_read_b128 v[140:143], v145 offset:8192
  ds_read_b128 v[108:111], v8 offset:20480
  s_mov_b32 s64, s42
  s_and_b32 s65, s43, 0xffff
  s_mov_b32 s66, 2621440
  s_mov_b32 s67, 0x20000
  v_mfma_f32_16x16x32_bf16 v[52:55], v[132:135], v[88:91], v[52:55]
  buffer_load_dwordx4 v[192:195], v2, s[64:67], s90 offen nt
  v_mfma_f32_16x16x32_bf16 v[56:59], v[128:131], v[92:95], v[56:59]
  ds_read_b128 v[112:115], v8 offset:22528
  buffer_load_dwordx4 v[204:207], v2, s[64:67], s90 offen offset:4 nt
  v_mfma_f32_16x16x32_bf16 v[60:63], v[132:135], v[92:95], v[60:63]
  buffer_load_dwordx4 v[188:191], v187, s[52:55], s88 offen sc1
  v_mfma_f32_16x16x32_bf16 v[64:67], v[128:131], v[96:99], v[64:67]
  ds_read_b128 v[116:119], v8 offset:24576
  v_mfma_f32_16x16x32_bf16 v[68:71], v[132:135], v[96:99], v[68:71]
  s_waitcnt lgkmcnt(5)
  v_mfma_f32_16x16x32_bf16 v[72:75], v[128:131], v[100:103], v[72:75]
  ds_read_b128 v[120:123], v8 offset:26624
  v_mfma_f32_16x16x32_bf16 v[76:79], v[132:135], v[100:103], v[76:79]
  v_mfma_f32_16x16x32_bf16 v[80:83], v[128:131], v[104:107], v[80:83]
  ds_read_b128 v[124:127], v8 offset:28672
  v_mfma_f32_16x16x32_bf16 v[84:87], v[132:135], v[104:107], v[84:87]
  s_waitcnt vmcnt(13)
  s_barrier
  s_waitcnt lgkmcnt(2)
  v_mfma_f32_16x16x32_bf16 v[48:51], v[136:139], v[108:111], v[48:51]
  ds_read_b128 v[128:131], v144 offset:16384
  ds_read_b128 v[132:135], v144 offset:24576
  ds_read_b128 v[88:91], v7 offset:30720
  buffer_load_dwordx4 v[196:199], v2, s[64:67], s91 offen nt
  v_mfma_f32_16x16x32_bf16 v[52:55], v[140:143], v[108:111], v[52:55]
  buffer_load_dwordx4 v[208:211], v2, s[64:67], s91 offen offset:4 nt
  v_mfma_f32_16x16x32_bf16 v[56:59], v[136:139], v[112:115], v[56:59]
  ds_read_b128 v[92:95], v7 offset:32768
  buffer_load_dwordx4 v[200:203], v2, s[64:67], s92 offen nt
  v_mfma_f32_16x16x32_bf16 v[60:63], v[140:143], v[112:115], v[60:63]
  v_mfma_f32_16x16x32_bf16 v[64:67], v[136:139], v[116:119], v[64:67]
  ds_read_b128 v[96:99], v7 offset:34816
  v_mfma_f32_16x16x32_bf16 v[68:71], v[140:143], v[116:119], v[68:71]
  s_waitcnt lgkmcnt(5)
  v_mfma_f32_16x16x32_bf16 v[72:75], v[136:139], v[120:123], v[72:75]
  ds_read_b128 v[100:103], v7 offset:36864
  v_mfma_f32_16x16x32_bf16 v[76:79], v[140:143], v[120:123], v[76:79]
  v_mfma_f32_16x16x32_bf16 v[80:83], v[136:139], v[124:127], v[80:83]
  ds_read_b128 v[104:107], v7 offset:38912
  v_mfma_f32_16x16x32_bf16 v[84:87], v[140:143], v[124:127], v[84:87]
  s_waitcnt lgkmcnt(2)
  v_mfma_f32_16x16x32_bf16 v[48:51], v[128:131], v[88:91], v[48:51]
  ds_read_b128 v[136:139], v145 offset:16384
  ds_read_b128 v[140:143], v145 offset:24576
  ds_read_b128 v[108:111], v8 offset:30720
  buffer_load_dwordx4 v[212:215], v2, s[64:67], s92 offen offset:4 nt
  v_mfma_f32_16x16x32_bf16 v[52:55], v[132:135], v[88:91], v[52:55]
  v_mfma_f32_16x16x32_bf16 v[56:59], v[128:131], v[92:95], v[56:59]
  ds_read_b128 v[112:115], v8 offset:32768
  v_mfma_f32_16x16x32_bf16 v[60:63], v[132:135], v[92:95], v[60:63]
  v_mfma_f32_16x16x32_bf16 v[64:67], v[128:131], v[96:99], v[64:67]
  ds_read_b128 v[116:119], v8 offset:34816
  v_mfma_f32_16x16x32_bf16 v[68:71], v[132:135], v[96:99], v[68:71]
  s_waitcnt lgkmcnt(5)
  v_mfma_f32_16x16x32_bf16 v[72:75], v[128:131], v[100:103], v[72:75]
  ds_read_b128 v[120:123], v8 offset:36864
  v_mfma_f32_16x16x32_bf16 v[76:79], v[132:135], v[100:103], v[76:79]
  v_mfma_f32_16x16x32_bf16 v[80:83], v[128:131], v[104:107], v[80:83]
  ds_read_b128 v[124:127], v8 offset:38912
  v_mfma_f32_16x16x32_bf16 v[84:87], v[132:135], v[104:107], v[84:87]
  s_waitcnt vmcnt(11)
  s_waitcnt lgkmcnt(2)
  v_mfma_f32_16x16x32_bf16 v[48:51], v[136:139], v[108:111], v[48:51]
  ds_read_b128 v[128:131], v144 offset:32768
  ds_read_b128 v[132:135], v144 offset:40960
  ds_read_b128 v[88:91], v7 offset:40960
  s_waitcnt vmcnt(8)
  v_min3_u32 v15, v154, v154, s8
  v_max3_u32 v14, v154, v154, s8
  v_min3_u32 v15, v15, v157, v159
  v_max3_u32 v14, v14, v157, v159
  v_cmp_ne_u32 vcc, v15, v14
  s_cbranch_vccnz again_21
ok_22:
  v_mfma_f32_16x16x32_bf16 v[52:55], v[140:143], v[108:111], v[52:55]
  s_waitcnt vmcnt(7)
  v_min3_u32 v15, v220, v221, s8
  v_max3_u32 v14, v220, v221, s8
  v_min3_u32 v15, v15, v222, v223
  v_max3_u32 v14, v14, v222, v223
  v_cmp_ne_u32 vcc, v15, v14
  s_cbranch_vccnz again_23
ok_24:
  s_lshl_b32 s13, s7, 6
  s_sub_u32 s12, 255, s13
  v_sub_u32 v11, s12, v1
  v_lshlrev_b32 v11, 11, v11
  s_and_b32 s12, s24, 3
  s_lshl_b32 s12, s12, 9
  s_bfe_u32 s14, s24, 0x50002
  s_lshl_b32 s14, s14, 4
  s_add_u32 s12, s12, s14
  s_add_u32 s12, s12, 26214400
  s_lshl_b32 s13, s13, 4
  s_add_u32 m0, s13, 9216
  s_nop 0
  buffer_load_dwordx4 v11, s[52:55], s12 offen sc1 lds
  v_mfma_f32_16x16x32_bf16 v[56:59], v[136:139], v[112:115], v[56:59]
  ds_read_b128 v[92:95], v7 offset:43008
  s_waitcnt vmcnt(5)
  v_min3_u32 v15, v188, v189, s8
  v_max3_u32 v14, v188, v189, s8
  v_min3_u32 v15, v15, v190, v191
  v_max3_u32 v14, v14, v190, v191
  v_cmp_ne_u32 vcc, v15, v14
  s_cbranch_vccnz again_25
ok_26:
  s_mul_i32 s34, s6, 200
  s_mul_i32 s12, s7, 50
  s_add_u32 s34, s34, s12
  s_lshl_b32 s34, s34, 10
  s_add_u32 s34, s34, 23068672
  v_mfma_f32_16x16x32_bf16 v[60:63], v[140:143], v[112:115], v[60:63]
  buffer_load_dwordx4 a[0:3], v2, s[52:55], s34 offen offset:0 sc1
  v_mfma_f32_16x16x32_bf16 v[64:67], v[136:139], v[116:119], v[64:67]
  ds_read_b128 v[96:99], v7 offset:45056
  buffer_load_dwordx4 a[4:7], v2, s[52:55], s34 offen offset:1024 sc1
  v_mfma_f32_16x16x32_bf16 v[68:71], v[140:143], v[116:119], v[68:71]
  buffer_load_dwordx4 a[8:11], v2, s[52:55], s34 offen offset:2048 sc1
  s_waitcnt lgkmcnt(5)
  v_mfma_f32_16x16x32_bf16 v[72:75], v[136:139], v[120:123], v[72:75]
  ds_read_b128 v[100:103], v7 offset:47104
  v_mfma_f32_16x16x32_bf16 v[76:79], v[140:143], v[120:123], v[76:79]
  v_mfma_f32_16x16x32_bf16 v[80:83], v[136:139], v[124:127], v[80:83]
  ds_read_b128 v[104:107], v7 offset:49152
  v_mfma_f32_16x16x32_bf16 v[84:87], v[140:143], v[124:127], v[84:87]
  s_waitcnt lgkmcnt(2)
  v_mfma_f32_16x16x32_bf16 v[48:51], v[128:131], v[88:91], v[48:51]
  ds_read_b128 v[136:139], v145 offset:32768
  ds_read_b128 v[140:143], v145 offset:40960
  ds_read_b128 v[108:111], v8 offset:40960
  buffer_load_dwordx4 a[12:15], v2, s[52:55], s34 offen offset:3072 sc1
  v_mfma_f32_16x16x32_bf16 v[52:55], v[132:135], v[88:91], v[52:55]
  s_add_u32 s34, s34, 4096
  buffer_load_dwordx4 a[16:19], v2, s[52:55], s34 offen offset:0 sc1
  v_mfma_f32_16x16x32_bf16 v[56:59], v[128:131], v[92:95], v[56:59]
  ds_read_b128 v[112:115], v8 offset:43008
  buffer_load_dwordx4 a[20:23], v2, s[52:55], s34 offen offset:1024 sc1
  v_mfma_f32_16x16x32_bf16 v[60:63], v[132:135], v[92:95], v[60:63]
  v_mfma_f32_16x16x32_bf16 v[64:67], v[128:131], v[96:99], v[64:67]
  ds_read_b128 v[116:119], v8 offset:45056
  v_mfma_f32_16x16x32_bf16 v[68:71], v[132:135], v[96:99], v[68:71]
  s_waitcnt lgkmcnt(5)
  v_mfma_f32_16x16x32_bf16 v[72:75], v[128:131], v[100:103], v[72:75]
  ds_read_b128 v[120:123], v8 offset:47104
  v_mfma_f32_16x16x32_bf16 v[76:79], v[132:135], v[100:103], v[76:79]
  v_mfma_f32_16x16x32_bf16 v[80:83], v[128:131], v[104:107], v[80:83]
  ds_read_b128 v[124:127], v8 offset:49152
  v_mfma_f32_16x16x32_bf16 v[84:87], v[132:135], v[104:107], v[84:87]
  s_waitcnt lgkmcnt(2)
  s_barrier
  v_mfma_f32_16x16x32_bf16 v[48:51], v[136:139], v[108:111], v[48:51]
  buffer_load_dwordx4 a[24:27], v2, s[52:55], s34 offen offset:2048 sc1
  buffer_load_dwordx4 a[28:31], v2, s[52:55], s34 offen offset:3072 sc1
  v_mov_b32 v246, v156
  v_mfma_f32_16x16x32_bf16 v[52:55], v[140:143], v[108:111], v[52:55]
  v_mov_b32 v247, v156
  v_mov_b32 v250, v158
  s_nop 0
  v_permlane16_swap_b32 v246, v247
  v_mfma_f32_16x16x32_bf16 v[56:59], v[136:139], v[112:115], v[56:59]
  v_mov_b32 v248, v246
  v_mov_b32 v249, v247
  s_nop 0
  v_permlane32_swap_b32 v246, v248
  v_mfma_f32_16x16x32_bf16 v[60:63], v[140:143], v[112:115], v[60:63]
  v_permlane32_swap_b32 v247, v249
  v_mov_b32_dpp v88, v152 row_newbcast:0 row_mask:0xf bank_mask:0xf
  v_mov_b32_dpp v96, v153 row_newbcast:0 row_mask:0xf bank_mask:0xf
  v_mfma_f32_16x16x32_bf16 v[64:67], v[136:139], v[116:119], v[64:67]
  v_mov_b32_dpp v89, v152 row_newbcast:1 row_mask:0xf bank_mask:0xf
  v_mov_b32_dpp v97, v153 row_newbcast:1 row_mask:0xf bank_mask:0xf
  v_mov_b32_dpp v90, v152 row_newbcast:2 row_mask:0xf bank_mask:0xf
  v_mfma_f32_16x16x32_bf16 v[68:71], v[140:143], v[116:119], v[68:71]
  v_mov_b32_dpp v98, v153 row_newbcast:2 row_mask:0xf bank_mask:0xf
  v_mov_b32_dpp v91, v152 row_newbcast:3 row_mask:0xf bank_mask:0xf
  v_mov_b32_dpp v99, v153 row_newbcast:3 row_mask:0xf bank_mask:0xf
  s_waitcnt lgkmcnt(0)
  v_mfma_f32_16x16x32_bf16 v[72:75], v[136:139], v[120:123], v[72:75]
  v_mov_b32_dpp v92, v152 row_newbcast:4 row_mask:0xf bank_mask:0xf
  v_mov_b32_dpp v100, v153 row_newbcast:4 row_mask:0xf bank_mask:0xf
  v_mfma_f32_16x16x32_bf16 v[76:79], v[140:143], v[120:123], v[76:79]
  v_mov_b32_dpp v93, v152 row_newbcast:5 row_mask:0xf bank_mask:0xf
  v_mov_b32_dpp v101, v153 row_newbcast:5 row_mask:0xf bank_mask:0xf
  v_mfma_f32_16x16x32_bf16 v[80:83], v[136:139], v[124:127], v[80:83]
  v_mov_b32_dpp v94, v152 row_newbcast:6 row_mask:0xf bank_mask:0xf
  v_mov_b32_dpp v102, v153 row_newbcast:6 row_mask:0xf bank_mask:0xf
  v_mfma_f32_16x16x32_bf16 v[84:87], v[140:143], v[124:127], v[84:87]
  v_mov_b32_dpp v95, v152 row_newbcast:7 row_mask:0xf bank_mask:0xf
  v_mov_b32_dpp v103, v153 row_newbcast:7 row_mask:0xf bank_mask:0xf
  v_pk_fma_f32 v[48:49], v[88:89], v[246:247], v[48:49] op_sel_hi:[1,0,1] neg_lo:[1,0,0] neg_hi:[1,0,0]
  v_pk_fma_f32 v[50:51], v[90:91], v[246:247], v[50:51] op_sel_hi:[1,0,1] neg_lo:[1,0,0] neg_hi:[1,0,0]
  v_pk_fma_f32 v[52:53], v[92:93], v[246:247], v[52:53] op_sel_hi:[1,0,1] neg_lo:[1,0,0] neg_hi:[1,0,0]
  v_pk_fma_f32 v[54:55], v[94:95], v[246:247], v[54:55] op_sel_hi:[1,0,1] neg_lo:[1,0,0] neg_hi:[1,0,0]
  v_pk_fma_f32 v[56:57], v[88:89], v[246:247], v[56:57] op_sel:[0,1,0] op_sel_hi:[1,1,1] neg_lo:[1,0,0] neg_hi:[1,0,0]
  v_pk_fma_f32 v[58:59], v[90:91], v[246:247], v[58:59] op_sel:[0,1,0] op_sel_hi:[1,1,1] neg_lo:[1,0,0] neg_hi:[1,0,0]
  v_pk_fma_f32 v[60:61], v[92:93], v[246:247], v[60:61] op_sel:[0,1,0] op_sel_hi:[1,1,1] neg_lo:[1,0,0] neg_hi:[1,0,0]
  v_pk_fma_f32 v[62:63], v[94:95], v[246:247], v[62:63] op_sel:[0,1,0] op_sel_hi:[1,1,1] neg_lo:[1,0,0] neg_hi:[1,0,0]
  v_pk_fma_f32 v[64:65], v[88:89], v[248:249], v[64:65] op_sel_hi:[1,0,1] neg_lo:[1,0,0] neg_hi:[1,0,0]
  v_pk_fma_f32 v[66:67], v[90:91], v[248:249], v[66:67] op_sel_hi:[1,0,1] neg_lo:[1,0,0] neg_hi:[1,0,0]
  v_pk_fma_f32 v[68:69], v[92:93], v[248:249], v[68:69] op_sel_hi:[1,0,1] neg_lo:[1,0,0] neg_hi:[1,0,0]
  v_pk_fma_f32 v[70:71], v[94:95], v[248:249], v[70:71] op_sel_hi:[1,0,1] neg_lo:[1,0,0] neg_hi:[1,0,0]
  v_pk_fma_f32 v[72:73], v[88:89], v[248:249], v[72:73] op_sel:[0,1,0] op_sel_hi:[1,1,1] neg_lo:[1,0,0] neg_hi:[1,0,0]
  v_pk_fma_f32 v[74:75], v[90:91], v[248:249], v[74:75] op_sel:[0,1,0] op_sel_hi:[1,1,1] neg_lo:[1,0,0] neg_hi:[1,0,0]
  v_pk_fma_f32 v[76:77], v[92:93], v[248:249], v[76:77] op_sel:[0,1,0] op_sel_hi:[1,1,1] neg_lo:[1,0,0] neg_hi:[1,0,0]
  v_pk_fma_f32 v[78:79], v[94:95], v[248:249], v[78:79] op_sel:[0,1,0] op_sel_hi:[1,1,1] neg_lo:[1,0,0] neg_hi:[1,0,0]
  v_pk_fma_f32 v[80:81], v[88:89], v[250:251], v[80:81] op_sel_hi:[1,0,1] neg_lo:[1,0,0] neg_hi:[1,0,0]
  v_pk_fma_f32 v[82:83], v[90:91], v[250:251], v[82:83] op_sel_hi:[1,0,1] neg_lo:[1,0,0] neg_hi:[1,0,0]
  v_pk_fma_f32 v[84:85], v[92:93], v[250:251], v[84:85] op_sel_hi:[1,0,1] neg_lo:[1,0,0] neg_hi:[1,0,0]
  v_pk_fma_f32 v[86:87], v[94:95], v[250:251], v[86:87] op_sel_hi:[1,0,1] neg_lo:[1,0,0] neg_hi:[1,0,0]
  v_pk_mul_f32 v[48:49], v[48:49], v[96:97]
  v_pk_mul_f32 v[50:51], v[50:51], v[98:99]
  v_pk_mul_f32 v[52:53], v[52:53], v[100:101]
  v_pk_mul_f32 v[54:55], v[54:55], v[102:103]
  v_pk_mul_f32 v[56:57], v[56:57], v[96:97]
  v_pk_mul_f32 v[58:59], v[58:59], v[98:99]
  v_pk_mul_f32 v[60:61], v[60:61], v[100:101]
  v_pk_mul_f32 v[62:63], v[62:63], v[102:103]
  v_pk_mul_f32 v[64:65], v[64:65], v[96:97]
  v_pk_mul_f32 v[66:67], v[66:67], v[98:99]
  v_pk_mul_f32 v[68:69], v[68:69], v[100:101]
  v_pk_mul_f32 v[70:71], v[70:71], v[102:103]
  v_pk_mul_f32 v[72:73], v[72:73], v[96:97]
  v_pk_mul_f32 v[74:75], v[74:75], v[98:99]
  v_pk_mul_f32 v[76:77], v[76:77], v[100:101]
  v_pk_mul_f32 v[78:79], v[78:79], v[102:103]
  v_pk_mul_f32 v[80:81], v[80:81], v[96:97]
  v_pk_mul_f32 v[82:83], v[82:83], v[98:99]
  v_pk_mul_f32 v[84:85], v[84:85], v[100:101]
  v_pk_mul_f32 v[86:87], v[86:87], v[102:103]
  s_waitcnt vmcnt(9)
  ds_write_b128 v186, v[192:195] offset:0
  s_add_u32 s34, s34, 4096
  buffer_load_dwordx4 a[32:35], v2, s[52:55], s34 offen offset:0 sc1
  v_fmac_f32 v49, v16, v48
  v_fmac_f32 v57, v17, v56
  v_fmac_f32 v65, v18, v64
  v_fmac_f32 v73, v19, v72
  v_fmac_f32 v81, v20, v80
  v_fmac_f32_dpp v49, v48, v21 quad_perm:[1,0,3,2] row_mask:0xf bank_mask:0xf
  v_fmac_f32_dpp v57, v56, v22 quad_perm:[1,0,3,2] row_mask:0xf bank_mask:0xf
  v_fmac_f32_dpp v65, v64, v23 quad_perm:[1,0,3,2] row_mask:0xf bank_mask:0xf
  v_fmac_f32_dpp v73, v72, v24 quad_perm:[1,0,3,2] row_mask:0xf bank_mask:0xf
  v_fmac_f32_dpp v81, v80, v25 quad_perm:[1,0,3,2] row_mask:0xf bank_mask:0xf
  v_alignbit_b32 v204, v204, v192, 16
  v_alignbit_b32 v205, v205, v193, 16
  v_alignbit_b32 v206, v206, v194, 16
  v_alignbit_b32 v207, v207, v195, 16
  ds_write_b128 v186, v[204:207] offset:4160
  ds_write_b128 v186, v[196:199] offset:8320
  buffer_load_dwordx4 a[36:39], v2, s[52:55], s34 offen offset:1024 sc1
  v_fmac_f32 v50, v16, v49
  v_fmac_f32 v58, v17, v57
  v_fmac_f32 v66, v18, v65
  v_fmac_f32 v74, v19, v73
  v_fmac_f32_e64 v82, v20, v81
  v_fmac_f32_dpp v50, v49, v21 quad_perm:[1,0,3,2] row_mask:0xf bank_mask:0xf
  v_fmac_f32_dpp v58, v57, v22 quad_perm:[1,0,3,2] row_mask:0xf bank_mask:0xf
  v_fmac_f32_dpp v66, v65, v23 quad_perm:[1,0,3,2] row_mask:0xf bank_mask:0xf
  v_fmac_f32_dpp v74, v73, v24 quad_perm:[1,0,3,2] row_mask:0xf bank_mask:0xf
  v_fmac_f32_dpp v82, v81, v25 quad_perm:[1,0,3,2] row_mask:0xf bank_mask:0xf
  v_alignbit_b32 v208, v208, v196, 16
  v_alignbit_b32 v209, v209, v197, 16
  v_alignbit_b32 v210, v210, v198, 16
  v_alignbit_b32 v211, v211, v199, 16
  ds_write_b128 v186, v[208:211] offset:12480
  ds_write_b128 v186, v[200:203] offset:16640
  buffer_load_dwordx4 a[40:43], v2, s[52:55], s34 offen offset:2048 sc1
  v_fmac_f32 v51, v16, v50
  v_fmac_f32 v59, v17, v58
  v_fmac_f32 v67, v18, v66
  v_fmac_f32 v75, v19, v74
  v_fmac_f32_e64 v83, v20, v82
  v_fmac_f32_dpp v51, v50, v21 quad_perm:[1,0,3,2] row_mask:0xf bank_mask:0xf
  v_fmac_f32_dpp v59, v58, v22 quad_perm:[1,0,3,2] row_mask:0xf bank_mask:0xf
  v_fmac_f32_dpp v67, v66, v23 quad_perm:[1,0,3,2] row_mask:0xf bank_mask:0xf
  v_fmac_f32_dpp v75, v74, v24 quad_perm:[1,0,3,2] row_mask:0xf bank_mask:0xf
  v_fmac_f32_dpp v83, v82, v25 quad_perm:[1,0,3,2] row_mask:0xf bank_mask:0xf
  v_alignbit_b32 v212, v212, v200, 16
  v_alignbit_b32 v213, v213, v201, 16
  v_alignbit_b32 v214, v214, v202, 16
  v_alignbit_b32 v215, v215, v203, 16
  ds_write_b128 v186, v[212:215] offset:20800
  buffer_load_dwordx4 a[44:47], v2, s[52:55], s34 offen offset:3072 sc1
  v_fmac_f32 v52, v16, v51
  v_fmac_f32 v60, v17, v59
  v_fmac_f32 v68, v18, v67
  v_fmac_f32 v76, v19, v75
  v_fmac_f32_e64 v84, v20, v83
  v_fmac_f32_dpp v52, v51, v21 quad_perm:[1,0,3,2] row_mask:0xf bank_mask:0xf
  v_fmac_f32_dpp v60, v59, v22 quad_perm:[1,0,3,2] row_mask:0xf bank_mask:0xf
  v_fmac_f32_dpp v68, v67, v23 quad_perm:[1,0,3,2] row_mask:0xf bank_mask:0xf
  v_fmac_f32_dpp v76, v75, v24 quad_perm:[1,0,3,2] row_mask:0xf bank_mask:0xf
  v_fmac_f32_dpp v84, v83, v25 quad_perm:[1,0,3,2] row_mask:0xf bank_mask:0xf
  s_cmp_lg_u32 s7, 0
  s_cbranch_scc1 skip_27
  v_mov_b32 v216, 0
  v_mov_b32 v217, 0
  v_mov_b32 v218, 0
  v_mov_b32 v219, 0
  s_mov_b64 exec, 0xfff
  ds_write_b128 v163, v[216:219]
  s_mov_b64 exec, 1
  ds_write_b16 v163, v192 offset:4190
  ds_write_b16 v163, v196 offset:12510
  ds_write_b16 v163, v200 offset:20830
  s_mov_b64 exec, -1
skip_27:
  s_add_u32 s34, s34, 4096
  buffer_load_dwordx4 a[48:51], v2, s[52:55], s34 offen offset:0 sc1
  v_fmac_f32 v53, v16, v52
  v_fmac_f32 v61, v17, v60
  v_fmac_f32 v69, v18, v68
  v_fmac_f32 v77, v19, v76
  v_fmac_f32_e64 v85, v20, v84
  v_fmac_f32_dpp v53, v52, v21 quad_perm:[1,0,3,2] row_mask:0xf bank_mask:0xf
  v_fmac_f32_dpp v61, v60, v22 quad_perm:[1,0,3,2] row_mask:0xf bank_mask:0xf
  v_fmac_f32_dpp v69, v68, v23 quad_perm:[1,0,3,2] row_mask:0xf bank_mask:0xf
  v_fmac_f32_dpp v77, v76, v24 quad_perm:[1,0,3,2] row_mask:0xf bank_mask:0xf
  v_fmac_f32_dpp v85, v84, v25 quad_perm:[1,0,3,2] row_mask:0xf bank_mask:0xf
  ds_write_b64 v228, v[152:153]
  buffer_load_dwordx4 a[52:55], v2, s[52:55], s34 offen offset:1024 sc1
  v_fmac_f32 v54, v16, v53
  v_fmac_f32 v62, v17, v61
  v_fmac_f32 v70, v18, v69
  v_fmac_f32 v78, v19, v77
  v_fmac_f32_e64 v86, v20, v85
  v_fmac_f32_dpp v54, v53, v21 quad_perm:[1,0,3,2] row_mask:0xf bank_mask:0xf
  v_fmac_f32_dpp v62, v61, v22 quad_perm:[1,0,3,2] row_mask:0xf bank_mask:0xf
  v_fmac_f32_dpp v70, v69, v23 quad_perm:[1,0,3,2] row_mask:0xf bank_mask:0xf
  v_fmac_f32_dpp v78, v77, v24 quad_perm:[1,0,3,2] row_mask:0xf bank_mask:0xf
  v_fmac_f32_dpp v86, v85, v25 quad_perm:[1,0,3,2] row_mask:0xf bank_mask:0xf
  buffer_load_dwordx4 a[56:59], v2, s[52:55], s34 offen offset:2048 sc1
  v_fmac_f32 v55, v16, v54
  v_fmac_f32 v63, v17, v62
  v_fmac_f32 v71, v18, v70
  v_fmac_f32 v79, v19, v78
  v_fmac_f32_e64 v87, v20, v86
  v_fmac_f32_dpp v55, v54, v21 quad_perm:[1,0,3,2] row_mask:0xf bank_mask:0xf
  v_fmac_f32_dpp v63, v62, v22 quad_perm:[1,0,3,2] row_mask:0xf bank_mask:0xf
  v_fmac_f32_dpp v71, v70, v23 quad_perm:[1,0,3,2] row_mask:0xf bank_mask:0xf
  v_fmac_f32_dpp v79, v78, v24 quad_perm:[1,0,3,2] row_mask:0xf bank_mask:0xf
  v_fmac_f32_dpp v87, v86, v25 quad_perm:[1,0,3,2] row_mask:0xf bank_mask:0xf
  v_add_u32 v11, 152320, v9
  v_min_u32 v12, 39, v1
  v_mul_u32_u24 v44, 48, v12
  s_lshl_b32 s12, s7, 3
  s_add_u32 s12, s12, 149504
  v_add_u32 v44, s12, v44
  ds_write_b32 v11, v55 offset:0
  ds_write_b32 v11, v63 offset:1152
  ds_write_b32 v11, v71 offset:2304
  ds_write_b32 v11, v79 offset:3456
  ds_write_b32 v11, v87 offset:4608
  v_mul_u32_u24 v46, 144, v12
  v_add_u32 v46, 152320, v46
  s_waitcnt lgkmcnt(0)
  s_barrier
  ds_read_b128 v[90:93], v46 offset:0
  ds_read_b128 v[94:97], v46 offset:16
  ds_read_b128 v[98:101], v46 offset:32
  ds_read_b128 v[102:105], v46 offset:48
  ds_read_b128 v[106:109], v46 offset:64
  ds_read_b128 v[110:113], v46 offset:80
  ds_read_b128 v[114:117], v46 offset:96
  ds_read_b128 v[118:121], v46 offset:112
  s_waitcnt lgkmcnt(7)
  v_pk_fma_f32 v[92:93], v[90:91], v[36:37], v[92:93] op_sel:[1,1,0] op_sel_hi:[0,1,1] neg_lo:[0,1,0]
  v_pk_fma_f32 v[92:93], v[90:91], v[36:37], v[92:93] op_sel:[0,0,0] op_sel_hi:[1,0,1]
  buffer_load_dwordx4 a[60:63], v2, s[52:55], s34 offen offset:3072 sc1
  s_waitcnt lgkmcnt(6)
  v_pk_fma_f32 v[94:95], v[92:93], v[36:37], v[94:95] op_sel:[1,1,0] op_sel_hi:[0,1,1] neg_lo:[0,1,0]
  v_pk_fma_f32 v[94:95], v[92:93], v[36:37], v[94:95] op_sel:[0,0,0] op_sel_hi:[1,0,1]
  v_pk_fma_f32 v[96:97], v[94:95], v[36:37], v[96:97] op_sel:[1,1,0] op_sel_hi:[0,1,1] neg_lo:[0,1,0]
  v_pk_fma_f32 v[96:97], v[94:95], v[36:37], v[96:97] op_sel:[0,0,0] op_sel_hi:[1,0,1]
  s_waitcnt lgkmcnt(5)
  s_add_u32 s34, s34, 4096
  buffer_load_dwordx4 a[64:67], v2, s[52:55], s34 offen offset:0 sc1
  v_pk_fma_f32 v[98:99], v[96:97], v[36:37], v[98:99] op_sel:[1,1,0] op_sel_hi:[0,1,1] neg_lo:[0,1,0]
  v_pk_fma_f32 v[98:99], v[96:97], v[36:37], v[98:99] op_sel:[0,0,0] op_sel_hi:[1,0,1]
  v_pk_fma_f32 v[100:101], v[98:99], v[36:37], v[100:101] op_sel:[1,1,0] op_sel_hi:[0,1,1] neg_lo:[0,1,0]
  v_pk_fma_f32 v[100:101], v[98:99], v[36:37], v[100:101] op_sel:[0,0,0] op_sel_hi:[1,0,1]
  s_waitcnt lgkmcnt(4)
  v_pk_fma_f32 v[102:103], v[100:101], v[36:37], v[102:103] op_sel:[1,1,0] op_sel_hi:[0,1,1] neg_lo:[0,1,0]
  buffer_load_dwordx4 a[68:71], v2, s[52:55], s34 offen offset:1024 sc1
  v_pk_fma_f32 v[102:103], v[100:101], v[36:37], v[102:103] op_sel:[0,0,0] op_sel_hi:[1,0,1]
  v_pk_fma_f32 v[104:105], v[102:103], v[36:37], v[104:105] op_sel:[1,1,0] op_sel_hi:[0,1,1] neg_lo:[0,1,0]
  v_pk_fma_f32 v[104:105], v[102:103], v[36:37], v[104:105] op_sel:[0,0,0] op_sel_hi:[1,0,1]
  s_waitcnt lgkmcnt(3)
  v_pk_fma_f32 v[106:107], v[104:105], v[36:37], v[106:107] op_sel:[1,1,0] op_sel_hi:[0,1,1] neg_lo:[0,1,0]
  v_pk_fma_f32 v[106:107], v[104:105], v[36:37], v[106:107] op_sel:[0,0,0] op_sel_hi:[1,0,1]
  buffer_load_dwordx4 a[72:75], v2, s[52:55], s34 offen offset:2048 sc1
  v_pk_fma_f32 v[108:109], v[106:107], v[36:37], v[108:109] op_sel:[1,1,0] op_sel_hi:[0,1,1] neg_lo:[0,1,0]
  v_pk_fma_f32 v[108:109], v[106:107], v[36:37], v[108:109] op_sel:[0,0,0] op_sel_hi:[1,0,1]
  s_waitcnt lgkmcnt(2)
  v_pk_fma_f32 v[110:111], v[108:109], v[36:37], v[110:111] op_sel:[1,1,0] op_sel_hi:[0,1,1] neg_lo:[0,1,0]
  v_pk_fma_f32 v[110:111], v[108:109], v[36:37], v[110:111] op_sel:[0,0,0] op_sel_hi:[1,0,1]
  v_pk_fma_f32 v[112:113], v[110:111], v[36:37], v[112:113] op_sel:[1,1,0] op_sel_hi:[0,1,1] neg_lo:[0,1,0]
  buffer_load_dwordx4 a[76:79], v2, s[52:55], s34 offen offset:3072 sc1
  v_pk_fma_f32 v[112:113], v[110:111], v[36:37], v[112:113] op_sel:[0,0,0] op_sel_hi:[1,0,1]
  s_waitcnt lgkmcnt(1)
  v_pk_fma_f32 v[114:115], v[112:113], v[36:37], v[114:115] op_sel:[1,1,0] op_sel_hi:[0,1,1] neg_lo:[0,1,0]
  v_pk_fma_f32 v[114:115], v[112:113], v[36:37], v[114:115] op_sel:[0,0,0] op_sel_hi:[1,0,1]
  v_pk_fma_f32 v[116:117], v[114:115], v[36:37], v[116:117] op_sel:[1,1,0] op_sel_hi:[0,1,1] neg_lo:[0,1,0]
  v_pk_fma_f32 v[116:117], v[114:115], v[36:37], v[116:117] op_sel:[0,0,0] op_sel_hi:[1,0,1]
  s_waitcnt lgkmcnt(0)
  v_pk_fma_f32 v[118:119], v[116:117], v[36:37], v[118:119] op_sel:[1,1,0] op_sel_hi:[0,1,1] neg_lo:[0,1,0]
  v_pk_fma_f32 v[118:119], v[116:117], v[36:37], v[118:119] op_sel:[0,0,0] op_sel_hi:[1,0,1]
  v_pk_fma_f32 v[120:121], v[118:119], v[36:37], v[120:121] op_sel:[1,1,0] op_sel_hi:[0,1,1] neg_lo:[0,1,0]
  v_pk_fma_f32 v[120:121], v[118:119], v[36:37], v[120:121] op_sel:[0,0,0] op_sel_hi:[1,0,1]
  v_mov_b32 v122, s8
  v_mov_b32 v123, s8
  s_add_u32 s12, s83, 10240
  s_mov_b64 exec, s[96:97]
  buffer_store_dwordx4 v[120:123], v2, s[52:55], s12 offen sc1
  s_mov_b64 exec, -1
  v_accvgpr_read_b32 v232, a200
  v_accvgpr_read_b32 v236, a201
  v_accvgpr_read_b32 v240, a202
  v_accvgpr_read_b32 v241, a203
  v_add_u32 v233, 1024, v232
  v_add_u32 v234, 2048, v232
  v_add_u32 v235, 3072, v232
  v_add_u32 v237, 1024, v236
  v_add_u32 v238, 2048, v236
  v_add_u32 v239, 3072, v236
  ds_read2_b32 v[156:157], v235 offset0:128 offset1:129
  ds_read2_b32 v[158:159], v235 offset0:130 offset1:131
  ds_read_b128 v[160:163], v240 offset:3584
  ds_read2_b32 v[152:153], v235 offset0:0 offset1:1
  ds_read2_b32 v[154:155], v235 offset0:2 offset1:3
  ds_read_b128 v[164:167], v240 offset:3072
  ds_read2_b32 v[148:149], v234 offset0:128 offset1:129
  ds_read2_b32 v[150:151], v234 offset0:130 offset1:131
  s_waitcnt lgkmcnt(5)
  v_mfma_f32_16x16x32_bf16 v[220:223], v[156:159], v[160:163], 0
  ds_read_b128 v[168:171], v240 offset:2560
  s_waitcnt lgkmcnt(4)
  v_mfma_f32_16x16x32_bf16 v[216:219], v[152:155], v[160:163], 0
  ds_read2_b32 v[144:145], v234 offset0:0 offset1:1
  ds_read2_b32 v[146:147], v234 offset0:2 offset1:3
  s_waitcnt lgkmcnt(5)
  v_mfma_f32_16x16x32_bf16 v[220:223], v[152:155], v[164:167], v[220:223]
  ds_read_b128 v[172:175], v240 offset:2048
  s_waitcnt lgkmcnt(4)
  v_mfma_f32_16x16x32_bf16 v[212:215], v[148:151], v[160:163], 0
  ds_read2_b32 v[140:141], v233 offset0:128 offset1:129
  ds_read2_b32 v[142:143], v233 offset0:130 offset1:131
  v_subrev_u32 v46, 8576, v46
  v_mov_b32 v88, 0
  v_mov_b32 v89, 0
  s_mov_b32 exec_hi, 0xff
  s_cmp_eq_u32 s7, 1
  s_cbranch_scc1 w1_30
  s_cmp_eq_u32 s7, 2
  s_cbranch_scc1 w2_31
  s_cmp_eq_u32 s7, 3
  s_cbranch_scc1 w3_32
w0_29:
  ds_write_b128 v46, v[88:91] offset:0
  ds_write_b128 v46, v[92:95] offset:16
  s_branch join_28
w1_30:
  ds_write_b128 v46, v[96:99] offset:32
  ds_write_b128 v46, v[100:103] offset:48
  s_branch join_28
w2_31:
  ds_write_b128 v46, v[104:107] offset:64
  ds_write_b128 v46, v[108:111] offset:80
  s_branch join_28
w3_32:
  ds_write_b128 v46, v[112:115] offset:96
  ds_write_b128 v46, v[116:119] offset:112
join_28:
  s_mov_b32 exec_hi, -1
  v_add_u32 v46, 143744, v9
  ds_read_b32 v244, v46 offset:0
  s_add_u32 s34, s34, 4096
  buffer_load_dwordx4 a[80:83], v2, s[52:55], s34 offen offset:0 sc1
  s_add_u32 m0, s48, 0
  s_nop 0
  buffer_load_dwordx4 v224, s[68:71], s20 offen lds
  ds_read_b64 a[226:227], v227
  v_mfma_f32_16x16x32_bf16 v[216:219], v[148:151], v[164:167], v[216:219]
  ds_read_b128 v[176:179], v240 offset:1536
  s_waitcnt lgkmcnt(10)
  v_mfma_f32_16x16x32_bf16 v[220:223], v[148:151], v[168:171], v[220:223]
  ds_read2_b32 v[136:137], v233 offset0:0 offset1:1
  ds_read2_b32 v[138:139], v233 offset0:2 offset1:3
  s_waitcnt lgkmcnt(10)
  v_mfma_f32_16x16x32_bf16 v[208:211], v[144:147], v[160:163], 0
  ds_read_b128 v[180:183], v240 offset:1024
  v_mfma_f32_16x16x32_bf16 v[212:215], v[144:147], v[164:167], v[212:215]
  ds_read2_b32 v[132:133], v232 offset0:128 offset1:129
  ds_read2_b32 v[134:135], v232 offset0:130 offset1:131
  ds_read_b32 v246, v46 offset:1152
  ds_read_b32 v248, v46 offset:2304
  ds_read_b32 v250, v46 offset:3456
  s_add_u32 m0, s48, 1024
  s_nop 0
  buffer_load_dwordx4 v225, s[68:71], s20 offen lds
  s_mov_b32 s60, s46
  s_and_b32 s61, s47, 0xffff
  s_mov_b32 s62, 5242880
  s_mov_b32 s63, 0x20000
  v_mfma_f32_16x16x32_bf16 v[216:219], v[144:147], v[168:171], v[216:219]
  ds_read_b32 v252, v46 offset:4608
  v_and_b32 v43, 1, v3
  s_waitcnt lgkmcnt(15)
  v_mfma_f32_16x16x32_bf16 v[220:223], v[144:147], v[172:175], v[220:223]
  v_cvt_f32_u32 v43, v43
  s_waitcnt lgkmcnt(14)
  v_mfma_f32_16x16x32_bf16 v[204:207], v[140:143], v[160:163], 0
  buffer_load_dwordx4 a[84:87], v2, s[52:55], s34 offen offset:1024 sc1
  v_mfma_f32_16x16x32_bf16 v[208:211], v[140:143], v[164:167], v[208:211]
  s_add_u32 m0, s48, 2048
  s_mov_b32 exec_hi, 0
  buffer_load_dwordx4 v226, s[68:71], s20 offen lds
  s_mov_b32 exec_hi, -1
  v_mfma_f32_16x16x32_bf16 v[212:215], v[140:143], v[168:171], v[212:215]
  v_fma_f32 v43, 2.0, v43, -1.0
  s_waitcnt lgkmcnt(0)
  s_nop 0
  v_mul_f32_dpp v245, v244, v43 quad_perm:[1,0,3,2] row_mask:0xf bank_mask:0xf
  v_mfma_f32_16x16x32_bf16 v[216:219], v[140:143], v[172:175], v[216:219]
  ds_read_b128 v[184:187], v240 offset:512
  v_mfma_f32_16x16x32_bf16 v[220:223], v[140:143], v[176:179], v[220:223]
  ds_read2_b32 v[128:129], v232 offset0:0 offset1:1
  ds_read2_b32 v[130:131], v232 offset0:2 offset1:3
  v_mfma_f32_16x16x32_bf16 v[200:203], v[136:139], v[160:163], 0
  s_mov_b32 s64, s32
  s_and_b32 s65, s33, 0xffff
  s_mov_b32 s66, 1280
  s_mov_b32 s67, 0x20000
  s_add_u32 m0, s48, 2560
  s_mul_i32 s12, s6, 160
  s_mov_b64 exec, 0x3ff
  buffer_load_dwordx4 v2, s[64:67], s12 offen lds
  s_mov_b64 exec, -1
  v_mov_b32 v228, -1
  v_mov_b32 v229, -1
  v_mov_b32 v230, -1
  v_mov_b32 v231, -1
  v_lshlrev_b32_e64 v11, 3, v1
  buffer_store_dwordx2 v[228:229], v11, s[52:55], s51 offen sc1
  v_mfma_f32_16x16x32_bf16 v[204:207], v[136:139], v[164:167], v[204:207]
  v_mul_f32_dpp v247, v246, v43 quad_perm:[1,0,3,2] row_mask:0xf bank_mask:0xf
  v_mul_f32_dpp v249, v248, v43 quad_perm:[1,0,3,2] row_mask:0xf bank_mask:0xf
  v_mfma_f32_16x16x32_bf16 v[208:211], v[136:139], v[168:171], v[208:211]
  v_mul_f32_dpp v251, v250, v43 quad_perm:[1,0,3,2] row_mask:0xf bank_mask:0xf
  v_mfma_f32_16x16x32_bf16 v[212:215], v[136:139], v[172:175], v[212:215]
  buffer_load_dwordx4 a[88:91], v2, s[52:55], s34 offen offset:2048 sc1
  v_mfma_f32_16x16x32_bf16 v[216:219], v[136:139], v[176:179], v[216:219]
  buffer_store_dwordx4 v[228:231], v2, s[52:55], s50 offen offset:0 sc1
  v_mfma_f32_16x16x32_bf16 v[220:223], v[136:139], v[180:183], v[220:223]
  v_mul_f32_dpp v253, v252, v43 quad_perm:[1,0,3,2] row_mask:0xf bank_mask:0xf
  v_mfma_f32_16x16x32_bf16 v[196:199], v[132:135], v[160:163], 0
  ds_read_b128 v[188:191], v240 offset:0
  v_mfma_f32_16x16x32_bf16 v[200:203], v[132:135], v[164:167], v[200:203]
  ds_read2_b32 v[156:157], v235 offset0:144 offset1:145
  ds_read2_b32 v[158:159], v235 offset0:146 offset1:147
  v_mfma_f32_16x16x32_bf16 v[204:207], v[132:135], v[168:171], v[204:207]
  ds_read2_b32 v[152:153], v235 offset0:16 offset1:17
  ds_read2_b32 v[154:155], v235 offset0:18 offset1:19
  buffer_store_dwordx4 v[228:231], v2, s[52:55], s50 offen offset:1024 sc1
  v_mfma_f32_16x16x32_bf16 v[208:211], v[132:135], v[172:175], v[208:211]
  buffer_load_dwordx4 a[92:95], v2, s[52:55], s34 offen offset:3072 sc1
  v_mfma_f32_16x16x32_bf16 v[212:215], v[132:135], v[176:179], v[212:215]
  ds_read2_b32 v[148:149], v234 offset0:144 offset1:145
  ds_read2_b32 v[150:151], v234 offset0:146 offset1:147
  v_mfma_f32_16x16x32_bf16 v[216:219], v[132:135], v[180:183], v[216:219]
  s_waitcnt lgkmcnt(9)
  v_mfma_f32_16x16x32_bf16 v[220:223], v[132:135], v[184:187], v[220:223]
  s_waitcnt lgkmcnt(7)
  v_mfma_f32_16x16x32_bf16 v[192:195], v[128:131], v[160:163], 0
  ds_read_b128 v[160:163], v240 offset:3648
  v_mfma_f32_16x16x32_bf16 v[196:199], v[128:131], v[164:167], v[196:199]
  ds_read2_b32 v[144:145], v234 offset0:16 offset1:17
  ds_read2_b32 v[146:147], v234 offset0:18 offset1:19
  v_mfma_f32_16x16x32_bf16 v[200:203], v[128:131], v[168:171], v[200:203]
  ds_read_b128 v[164:167], v240 offset:3136
  v_mfma_f32_16x16x32_bf16 v[204:207], v[128:131], v[172:175], v[204:207]
  ds_read_b128 v[168:171], v240 offset:2624
  v_mfma_f32_16x16x32_bf16 v[208:211], v[128:131], v[176:179], v[208:211]
  ds_read_b128 v[172:175], v240 offset:2112
  v_mfma_f32_16x16x32_bf16 v[212:215], v[128:131], v[180:183], v[212:215]
  ds_read2_b32 v[140:141], v233 offset0:144 offset1:145
  ds_read2_b32 v[142:143], v233 offset0:146 offset1:147
  v_mfma_f32_16x16x32_bf16 v[216:219], v[128:131], v[184:187], v[216:219]
  s_add_u32 s34, s34, 4096
  buffer_load_dwordx4 a[96:99], v2, s[52:55], s34 offen offset:0 sc1
  s_waitcnt lgkmcnt(14)
  v_mfma_f32_16x16x32_bf16 v[220:223], v[128:131], v[188:191], v[220:223]
  s_waitcnt lgkmcnt(7)
  v_mfma_f32_16x16x32_bf16 v[220:223], v[156:159], v[160:163], v[220:223]
  ds_read_b128 v[176:179], v240 offset:1600
  v_mfma_f32_16x16x32_bf16 v[216:219], v[152:155], v[160:163], v[216:219]
  ds_read2_b32 v[136:137], v233 offset0:16 offset1:17
  ds_read2_b32 v[138:139], v233 offset0:18 offset1:19
  s_waitcnt lgkmcnt(7)
  v_mfma_f32_16x16x32_bf16 v[220:223], v[152:155], v[164:167], v[220:223]
  v_mfma_f32_16x16x32_bf16 v[212:215], v[148:151], v[160:163], v[212:215]
  v_mfma_f32_16x16x32_bf16 v[216:219], v[148:151], v[164:167], v[216:219]
  buffer_load_dwordx4 a[100:103], v2, s[52:55], s34 offen offset:1024 sc1
  s_waitcnt lgkmcnt(6)
  v_mfma_f32_16x16x32_bf16 v[220:223], v[148:151], v[168:171], v[220:223]
  s_and_b32 vcc_lo, s1, 7
  s_lshl_b32 vcc_lo, vcc_lo, 2
  s_add_u32 vcc_lo, vcc_lo, s7
  s_lshl_b32 vcc_lo, vcc_lo, 11
  v_lshl_add_u32 v15, v3, 7, vcc_lo
  v_min_u32 v15, L_codeend-L_pc-4, v15
  s_mov_b64 exec, 0xffff
  global_load_dword a250, v15, s[98:99]
  s_mov_b64 exec, -1
  v_mfma_f32_16x16x32_bf16 v[208:211], v[144:147], v[160:163], v[208:211]
  ds_read_b128 v[180:183], v240 offset:1088
  v_mfma_f32_16x16x32_bf16 v[212:215], v[144:147], v[164:167], v[212:215]
  ds_read2_b32 v[132:133], v232 offset0:144 offset1:145
  ds_read2_b32 v[134:135], v232 offset0:146 offset1:147
  v_mfma_f32_16x16x32_bf16 v[216:219], v[144:147], v[168:171], v[216:219]
  s_waitcnt lgkmcnt(8)
  v_mfma_f32_16x16x32_bf16 v[220:223], v[144:147], v[172:175], v[220:223]
  s_waitcnt lgkmcnt(6)
  v_mfma_f32_16x16x32_bf16 v[204:207], v[140:143], v[160:163], v[204:207]
  v_mfma_f32_16x16x32_bf16 v[208:211], v[140:143], v[164:167], v[208:211]
  v_mfma_f32_16x16x32_bf16 v[212:215], v[140:143], v[168:171], v[212:215]
  buffer_load_dwordx4 a[104:107], v2, s[52:55], s34 offen offset:2048 sc1
  v_mfma_f32_16x16x32_bf16 v[216:219], v[140:143], v[172:175], v[216:219]
  ds_read_b128 v[184:187], v240 offset:576
  s_waitcnt lgkmcnt(6)
  v_mfma_f32_16x16x32_bf16 v[220:223], v[140:143], v[176:179], v[220:223]
  ds_read2_b32 v[128:129], v232 offset0:16 offset1:17
  ds_read2_b32 v[130:131], v232 offset0:18 offset1:19
  s_waitcnt lgkmcnt(6)
  v_mfma_f32_16x16x32_bf16 v[200:203], v[136:139], v[160:163], v[200:203]
  v_accvgpr_read_b32 v11, a245
  s_mov_b32 exec_lo, s96
  s_mov_b32 exec_hi, 0
  buffer_load_dword a250, v11, s[52:55], 0 offen
  s_mov_b64 exec, -1
  v_mfma_f32_16x16x32_bf16 v[204:207], v[136:139], v[164:167], v[204:207]
  v_mfma_f32_16x16x32_bf16 v[208:211], v[136:139], v[168:171], v[208:211]
  v_mfma_f32_16x16x32_bf16 v[212:215], v[136:139], v[172:175], v[212:215]
  v_mfma_f32_16x16x32_bf16 v[216:219], v[136:139], v[176:179], v[216:219]
  s_waitcnt lgkmcnt(5)
  v_mfma_f32_16x16x32_bf16 v[220:223], v[136:139], v[180:183], v[220:223]
  buffer_load_dwordx4 a[108:111], v2, s[52:55], s34 offen offset:3072 sc1
  s_waitcnt lgkmcnt(3)
  v_mfma_f32_16x16x32_bf16 v[196:199], v[132:135], v[160:163], v[196:199]
  ds_read_b128 v[188:191], v240 offset:64
  v_mfma_f32_16x16x32_bf16 v[200:203], v[132:135], v[164:167], v[200:203]
  ds_read2_b32 v[156:157], v235 offset0:160 offset1:161
  ds_read2_b32 v[158:159], v235 offset0:162 offset1:163
  v_mfma_f32_16x16x32_bf16 v[204:207], v[132:135], v[168:171], v[204:207]
  ds_read2_b32 v[152:153], v235 offset0:32 offset1:33
  ds_read2_b32 v[154:155], v235 offset0:34 offset1:35
  s_waitcnt vmcnt(9)
  ds_read_b64 a[216:217], v242 offset:0
  v_mfma_f32_16x16x32_bf16 v[208:211], v[132:135], v[172:175], v[208:211]
  ds_read_b64 a[218:219], v242 offset:32
  v_mfma_f32_16x16x32_bf16 v[212:215], v[132:135], v[176:179], v[212:215]
  ds_read2_b32 v[148:149], v234 offset0:160 offset1:161
  ds_read2_b32 v[150:151], v234 offset0:162 offset1:163
  v_mfma_f32_16x16x32_bf16 v[216:219], v[132:135], v[180:183], v[216:219]
  ds_read_b64 a[220:221], v242 offset:64
  s_waitcnt lgkmcnt(12)
  v_mfma_f32_16x16x32_bf16 v[220:223], v[132:135], v[184:187], v[220:223]
  s_waitcnt lgkmcnt(10)
  v_mfma_f32_16x16x32_bf16 v[192:195], v[128:131], v[160:163], v[192:195]
  ds_read_b128 v[160:163], v240 offset:3712
  v_mfma_f32_16x16x32_bf16 v[196:199], v[128:131], v[164:167], v[196:199]
  ds_read2_b32 v[144:145], v234 offset0:32 offset1:33
  ds_read2_b32 v[146:147], v234 offset0:34 offset1:35
  v_mfma_f32_16x16x32_bf16 v[200:203], v[128:131], v[168:171], v[200:203]
  ds_read_b128 v[164:167], v240 offset:3200
  v_mfma_f32_16x16x32_bf16 v[204:207], v[128:131], v[172:175], v[204:207]
  ds_read_b128 v[168:171], v240 offset:2688
  s_add_u32 s34, s34, 4096
  buffer_load_dwordx4 a[112:115], v2, s[52:55], s34 offen offset:0 sc1
  ds_read_b64 a[222:223], v242 offset:96
  ds_read_b64 a[224:225], v242 offset:128
  v_mfma_f32_16x16x32_bf16 v[208:211], v[128:131], v[176:179], v[208:211]
  ds_read_b128 v[172:175], v240 offset:2176
  v_mfma_f32_16x16x32_bf16 v[212:215], v[128:131], v[180:183], v[212:215]
  ds_read2_b32 v[140:141], v233 offset0:160 offset1:161
  ds_read2_b32 v[142:143], v233 offset0:162 offset1:163
  v_mfma_f32_16x16x32_bf16 v[216:219], v[128:131], v[184:187], v[216:219]
  ds_read_b64 a[230:231], v243 offset:2560
  s_waitcnt lgkmcnt(15)
  v_mfma_f32_16x16x32_bf16 v[220:223], v[128:131], v[188:191], v[220:223]
  ds_read_b64 a[232:233], v243 offset:2592
  s_waitcnt lgkmcnt(11)
  v_mfma_f32_16x16x32_bf16 v[220:223], v[156:159], v[160:163], v[220:223]
  ds_read_b128 v[176:179], v240 offset:1664
  v_mfma_f32_16x16x32_bf16 v[216:219], v[152:155], v[160:163], v[216:219]
  ds_read2_b32 v[136:137], v233 offset0:32 offset1:33
  ds_read2_b32 v[138:139], v233 offset0:34 offset1:35
  s_waitcnt lgkmcnt(11)
  v_mfma_f32_16x16x32_bf16 v[220:223], v[152:155], v[164:167], v[220:223]
  buffer_load_dwordx4 a[116:119], v2, s[52:55], s34 offen offset:1024 sc1
  ds_read_b64 a[234:235], v243 offset:2624
  v_mfma_f32_16x16x32_bf16 v[212:215], v[148:151], v[160:163], v[212:215]
  ds_read_b64 a[236:237], v243 offset:2656
  v_mfma_f32_16x16x32_bf16 v[216:219], v[148:151], v[164:167], v[216:219]
  ds_read_b64 a[238:239], v243 offset:2688
  s_lshl_b32 s90, s7, 2
  s_waitcnt lgkmcnt(13)
  v_mfma_f32_16x16x32_bf16 v[220:223], v[148:151], v[168:171], v[220:223]
  s_sub_u32 s90, 12, s90
  v_mfma_f32_16x16x32_bf16 v[208:211], v[144:147], v[160:163], v[208:211]
  ds_read_b128 v[180:183], v240 offset:1152
  v_mfma_f32_16x16x32_bf16 v[212:215], v[144:147], v[164:167], v[212:215]
  ds_read2_b32 v[132:133], v232 offset0:160 offset1:161
  ds_read2_b32 v[134:135], v232 offset0:162 offset1:163
  s_mul_i32 s90, s90, 640
  s_add_u32 s90, s90, s83
  v_mfma_f32_16x16x32_bf16 v[216:219], v[144:147], v[168:171], v[216:219]
  s_add_u32 s90, s90, 0
  s_waitcnt lgkmcnt(13)
  v_mfma_f32_16x16x32_bf16 v[220:223], v[144:147], v[172:175], v[220:223]
  v_min_u32 v42, 39, v1
  s_waitcnt lgkmcnt(11)
  v_mfma_f32_16x16x32_bf16 v[204:207], v[140:143], v[160:163], v[204:207]
  v_lshlrev_b32_e64 v42, 4, v42
  v_mfma_f32_16x16x32_bf16 v[208:211], v[140:143], v[164:167], v[208:211]
  v_mfma_f32_16x16x32_bf16 v[212:215], v[140:143], v[168:171], v[212:215]
  buffer_load_dwordx3 v[88:90], v42, s[52:55], s90 offen offset:0 sc1
  v_mfma_f32_16x16x32_bf16 v[216:219], v[140:143], v[172:175], v[216:219]
  ds_read_b128 v[184:187], v240 offset:640
  s_waitcnt lgkmcnt(9)
  v_mfma_f32_16x16x32_bf16 v[220:223], v[140:143], v[176:179], v[220:223]
  ds_read2_b32 v[128:129], v232 offset0:32 offset1:33
  ds_read2_b32 v[130:131], v232 offset0:34 offset1:35
  s_waitcnt lgkmcnt(9)
  v_mfma_f32_16x16x32_bf16 v[200:203], v[136:139], v[160:163], v[200:203]
  buffer_load_dwordx3 v[92:94], v42, s[52:55], s90 offen offset:640 sc1
  v_mfma_f32_16x16x32_bf16 v[204:207], v[136:139], v[164:167], v[204:207]
  buffer_load_dwordx3 v[96:98], v42, s[52:55], s90 offen offset:1280 sc1
  v_mfma_f32_16x16x32_bf16 v[208:211], v[136:139], v[168:171], v[208:211]
  buffer_load_dwordx3 v[100:102], v42, s[52:55], s90 offen offset:1920 sc1
  v_mfma_f32_16x16x32_bf16 v[212:215], v[136:139], v[172:175], v[212:215]
  v_mfma_f32_16x16x32_bf16 v[216:219], v[136:139], v[176:179], v[216:219]
  s_waitcnt lgkmcnt(5)
  v_mfma_f32_16x16x32_bf16 v[220:223], v[136:139], v[180:183], v[220:223]
  s_waitcnt lgkmcnt(3)
  v_mfma_f32_16x16x32_bf16 v[196:199], v[132:135], v[160:163], v[196:199]
  ds_read_b128 v[188:191], v240 offset:128
  v_mfma_f32_16x16x32_bf16 v[200:203], v[132:135], v[164:167], v[200:203]
  v_mfma_f32_16x16x32_bf16 v[204:207], v[132:135], v[168:171], v[204:207]
  v_mfma_f32_16x16x32_bf16 v[208:211], v[132:135], v[172:175], v[208:211]
  v_mfma_f32_16x16x32_bf16 v[212:215], v[132:135], v[176:179], v[212:215]
  v_mfma_f32_16x16x32_bf16 v[216:219], v[132:135], v[180:183], v[216:219]
  s_waitcnt lgkmcnt(3)
  v_mfma_f32_16x16x32_bf16 v[220:223], v[132:135], v[184:187], v[220:223]
  s_waitcnt lgkmcnt(1)
  v_mfma_f32_16x16x32_bf16 v[192:195], v[128:131], v[160:163], v[192:195]
  v_mfma_f32_16x16x32_bf16 v[196:199], v[128:131], v[164:167], v[196:199]
  v_mfma_f32_16x16x32_bf16 v[200:203], v[128:131], v[168:171], v[200:203]
  v_mfma_f32_16x16x32_bf16 v[204:207], v[128:131], v[172:175], v[204:207]
  v_mfma_f32_16x16x32_bf16 v[208:211], v[128:131], v[176:179], v[208:211]
  v_mfma_f32_16x16x32_bf16 v[212:215], v[128:131], v[180:183], v[212:215]
  v_mfma_f32_16x16x32_bf16 v[216:219], v[128:131], v[184:187], v[216:219]
  s_waitcnt lgkmcnt(0)
  v_mfma_f32_16x16x32_bf16 v[220:223], v[128:131], v[188:191], v[220:223]
  v_lshrrev_b32 v11, 1, v3
  v_mul_u32_u24 v12, 80, v11
  v_add_u32 v12, 160640, v12
  v_mul_u32_u24_e64 v11, 48, v11
  v_add_u32 v11, 149504, v11
  ds_read_b128 v[128:131], v12 offset:0
  ds_read_b128 v[132:135], v12 offset:16
  ds_read_b128 v[136:139], v12 offset:32
  ds_read_b128 v[140:143], v12 offset:48
  ds_read_b128 v[144:147], v12 offset:640
  ds_read_b128 v[148:151], v12 offset:656
  ds_read_b128 v[152:155], v12 offset:672
  ds_read_b128 v[156:159], v12 offset:688
  v_accvgpr_read_b32 v254, a240
  v_accvgpr_read_b32 v255, a241
  v_accvgpr_read_b32 v47, a242
  s_waitcnt vmcnt(0)
  v_min3_u32 v14, v90, v94, s8
  v_max3_u32 v15, v90, v94, s8
  v_min3_u32 v14, v14, v98, v102
  v_max3_u32 v15, v15, v98, v102
  v_cmp_ne_u32 vcc, v14, v15
  s_cbranch_vccz ok_34
again_33:
  buffer_load_dwordx3 v[88:90], v42, s[52:55], s90 offen offset:0 sc1
  buffer_load_dwordx3 v[92:94], v42, s[52:55], s90 offen offset:640 sc1
  buffer_load_dwordx3 v[96:98], v42, s[52:55], s90 offen offset:1280 sc1
  buffer_load_dwordx3 v[100:102], v42, s[52:55], s90 offen offset:1920 sc1
  s_sub_u32 s10, s10, 1
  s_cmp_gt_i32 s10, 0
  s_waitcnt vmcnt(0)
  v_min3_u32 v14, v90, v94, s8
  v_max3_u32 v15, v90, v94, s8
  v_min3_u32 v14, v14, v98, v102
  v_max3_u32 v15, v15, v98, v102
  v_cmp_ne_u32 vcc, v14, v15
  s_cbranch_scc0 out_35
  s_cbranch_vccnz again_33
out_35:
ok_34:
  v_pk_fma_f32 v[92:93], v[88:89], v[38:39], v[92:93] op_sel:[1,1,0] op_sel_hi:[0,1,1] neg_lo:[0,1,0]
  v_pk_fma_f32 v[92:93], v[88:89], v[38:39], v[92:93] op_sel:[0,0,0] op_sel_hi:[1,0,1]
  v_pk_fma_f32 v[96:97], v[92:93], v[38:39], v[96:97] op_sel:[1,1,0] op_sel_hi:[0,1,1] neg_lo:[0,1,0]
  v_pk_fma_f32 v[96:97], v[92:93], v[38:39], v[96:97] op_sel:[0,0,0] op_sel_hi:[1,0,1]
  v_pk_fma_f32 v[100:101], v[96:97], v[38:39], v[100:101] op_sel:[1,1,0] op_sel_hi:[0,1,1] neg_lo:[0,1,0]
  v_pk_fma_f32 v[100:101], v[96:97], v[38:39], v[100:101] op_sel:[0,0,0] op_sel_hi:[1,0,1]
  v_pk_mul_f32 v[88:89], v[100:101], v[40:41] op_sel:[1,1] op_sel_hi:[0,1] neg_lo:[0,1]
  v_pk_fma_f32 v[88:89], v[100:101], v[40:41], v[88:89] op_sel:[0,0,0] op_sel_hi:[1,0,1]
  buffer_load_dwordx4 a[120:123], v2, s[52:55], s34 offen offset:2048 sc1
  s_mov_b32 exec_hi, 0xff
  ds_write_b64 v44, v[88:89]
  s_mov_b32 exec_hi, -1
  s_waitcnt lgkmcnt(0)
  s_barrier
  ds_read_b128 v[88:91], v11 offset:0
  ds_read_b128 v[92:95], v11 offset:16
  ds_read_b128 v[96:99], v11 offset:384
  ds_read_b128 v[100:103], v11 offset:400
  ds_read_b128 v[224:227], v11 offset:768
  ds_read_b128 v[228:231], v11 offset:784
  ds_read_b128 v[160:163], v12 offset:1280
  ds_read_b128 v[164:167], v12 offset:1296
  ds_read_b128 v[168:171], v12 offset:1312
  ds_read_b128 v[172:175], v12 offset:1328
  buffer_load_dwordx4 a[124:127], v2, s[52:55], s34 offen offset:3072 sc1
  s_waitcnt lgkmcnt(8)
  v_pk_add_f32 v[88:89], v[88:89], v[90:91]
  v_pk_add_f32 v[92:93], v[92:93], v[94:95]
  v_pk_add_f32 v[88:89], v[88:89], v[92:93]
  v_pk_fma_f32 v[244:245], v[26:27], v[88:89], v[244:245] op_sel:[0,0,0] op_sel_hi:[1,0,1]
  v_pk_fma_f32 v[244:245], v[26:27], v[88:89], v[244:245] op_sel:[1,1,0] op_sel_hi:[0,1,1] neg_hi:[1,0,0]
  ds_read_b128 v[88:91], v11 offset:1152
  ds_read_b128 v[92:95], v11 offset:1168
  s_waitcnt lgkmcnt(8)
  v_pk_add_f32 v[96:97], v[96:97], v[98:99]
  v_pk_add_f32 v[100:101], v[100:101], v[102:103]
  v_pk_add_f32 v[96:97], v[96:97], v[100:101]
  v_pk_fma_f32 v[246:247], v[28:29], v[96:97], v[246:247] op_sel:[0,0,0] op_sel_hi:[1,0,1]
  v_pk_fma_f32 v[246:247], v[28:29], v[96:97], v[246:247] op_sel:[1,1,0] op_sel_hi:[0,1,1] neg_hi:[1,0,0]
  ds_read_b128 v[96:99], v11 offset:1536
  ds_read_b128 v[100:103], v11 offset:1552
  ds_read_b128 v[176:179], v12 offset:1920
  ds_read_b128 v[180:183], v12 offset:1936
  ds_read_b128 v[184:187], v12 offset:1952
  ds_read_b128 v[188:191], v12 offset:1968
  v_pk_fma_f32 v[48:49], v[128:129], v[244:245], v[48:49] op_sel:[0,0,0] op_sel_hi:[1,0,1]
  v_pk_fma_f32 v[50:51], v[130:131], v[244:245], v[50:51] op_sel:[0,0,0] op_sel_hi:[1,0,1]
  v_pk_fma_f32 v[52:53], v[132:133], v[244:245], v[52:53] op_sel:[0,0,0] op_sel_hi:[1,0,1]
  v_pk_fma_f32 v[54:55], v[134:135], v[244:245], v[54:55] op_sel:[0,0,0] op_sel_hi:[1,0,1]
  s_add_u32 s34, s34, 4096
  buffer_load_dwordx4 a[128:131], v2, s[52:55], s34 offen offset:0 sc1
  v_pk_fma_f32 v[48:49], v[136:137], v[244:245], v[48:49] op_sel:[0,1,0] op_sel_hi:[1,1,1]
  v_pk_fma_f32 v[50:51], v[138:139], v[244:245], v[50:51] op_sel:[0,1,0] op_sel_hi:[1,1,1]
  v_pk_fma_f32 v[52:53], v[140:141], v[244:245], v[52:53] op_sel:[0,1,0] op_sel_hi:[1,1,1]
  v_pk_fma_f32 v[54:55], v[142:143], v[244:245], v[54:55] op_sel:[0,1,0] op_sel_hi:[1,1,1]
  v_cvt_pk_bf16_f32 v120, v48, v49
  v_cvt_pk_bf16_f32 v121, v50, v51
  v_cvt_pk_bf16_f32 v122, v52, v53
  v_cvt_pk_bf16_f32 v123, v54, v55
  ds_write_b128 v254, v[120:123]
  buffer_load_dwordx4 a[132:135], v2, s[52:55], s34 offen offset:1024 sc1
  ds_read_b64_tr_b16 v[52:53], v255
  ds_read_b64_tr_b16 v[54:55], v255 offset:640
  s_waitcnt lgkmcnt(15)
  v_pk_add_f32 v[224:225], v[224:225], v[226:227]
  v_pk_add_f32 v[228:229], v[228:229], v[230:231]
  v_pk_add_f32 v[224:225], v[224:225], v[228:229]
  v_pk_fma_f32 v[248:249], v[30:31], v[224:225], v[248:249] op_sel:[0,0,0] op_sel_hi:[1,0,1]
  v_pk_fma_f32 v[248:249], v[30:31], v[224:225], v[248:249] op_sel:[1,1,0] op_sel_hi:[0,1,1] neg_hi:[1,0,0]
  s_lshl_b32 s12, s86, 1
  s_add_u32 s12, s12, 24576
  v_mov_b32 v15, s8
  s_and_b32 exec_lo, s96, 1
  s_mov_b32 exec_hi, 0
  buffer_store_dword v15, off, s[52:55], s12 sc1
  s_mov_b64 exec, -1
  ds_read_b128 v[104:107], v12 offset:2560
  ds_read_b128 v[108:111], v12 offset:2576
  ds_read_b128 v[112:115], v12 offset:2592
  ds_read_b128 v[116:119], v12 offset:2608
  v_pk_fma_f32 v[56:57], v[144:145], v[246:247], v[56:57] op_sel:[0,0,0] op_sel_hi:[1,0,1]
  v_pk_fma_f32 v[58:59], v[146:147], v[246:247], v[58:59] op_sel:[0,0,0] op_sel_hi:[1,0,1]
  v_pk_fma_f32 v[60:61], v[148:149], v[246:247], v[60:61] op_sel:[0,0,0] op_sel_hi:[1,0,1]
  v_pk_fma_f32 v[62:63], v[150:151], v[246:247], v[62:63] op_sel:[0,0,0] op_sel_hi:[1,0,1]
  buffer_load_dwordx4 a[136:139], v2, s[52:55], s34 offen offset:2048 sc1
  v_pk_fma_f32 v[56:57], v[152:153], v[246:247], v[56:57] op_sel:[0,1,0] op_sel_hi:[1,1,1]
  v_pk_fma_f32 v[58:59], v[154:155], v[246:247], v[58:59] op_sel:[0,1,0] op_sel_hi:[1,1,1]
  v_pk_fma_f32 v[60:61], v[156:157], v[246:247], v[60:61] op_sel:[0,1,0] op_sel_hi:[1,1,1]
  v_pk_fma_f32 v[62:63], v[158:159], v[246:247], v[62:63] op_sel:[0,1,0] op_sel_hi:[1,1,1]
  v_cvt_pk_bf16_f32 v124, v56, v57
  v_cvt_pk_bf16_f32 v125, v58, v59
  v_cvt_pk_bf16_f32 v126, v60, v61
  v_cvt_pk_bf16_f32 v127, v62, v63
  ds_write_b128 v254, v[124:127]
  buffer_load_dwordx4 a[140:143], v2, s[52:55], s34 offen offset:3072 sc1
  ds_read_b64_tr_b16 v[60:61], v255
  ds_read_b64_tr_b16 v[62:63], v255 offset:640
  s_waitcnt lgkmcnt(15)
  v_pk_add_f32 v[88:89], v[88:89], v[90:91]
  v_pk_add_f32 v[92:93], v[92:93], v[94:95]
  v_pk_add_f32 v[88:89], v[88:89], v[92:93]
  v_pk_fma_f32 v[250:251], v[32:33], v[88:89], v[250:251] op_sel:[0,0,0] op_sel_hi:[1,0,1]
  v_pk_fma_f32 v[250:251], v[32:33], v[88:89], v[250:251] op_sel:[1,1,0] op_sel_hi:[0,1,1] neg_hi:[1,0,0]
  s_add_u32 s13, s78, 0
  s_waitcnt lgkmcnt(7)
  buffer_store_dwordx4 v[52:55], v47, s[60:63], s13 offen sc1
  v_pk_fma_f32 v[64:65], v[160:161], v[248:249], v[64:65] op_sel:[0,0,0] op_sel_hi:[1,0,1]
  v_pk_fma_f32 v[66:67], v[162:163], v[248:249], v[66:67] op_sel:[0,0,0] op_sel_hi:[1,0,1]
  v_pk_fma_f32 v[68:69], v[164:165], v[248:249], v[68:69] op_sel:[0,0,0] op_sel_hi:[1,0,1]
  v_pk_fma_f32 v[70:71], v[166:167], v[248:249], v[70:71] op_sel:[0,0,0] op_sel_hi:[1,0,1]
  s_add_u32 s34, s34, 4096
  buffer_load_dwordx4 a[144:147], v2, s[52:55], s34 offen offset:0 sc1
  v_pk_fma_f32 v[64:65], v[168:169], v[248:249], v[64:65] op_sel:[0,1,0] op_sel_hi:[1,1,1]
  v_pk_fma_f32 v[66:67], v[170:171], v[248:249], v[66:67] op_sel:[0,1,0] op_sel_hi:[1,1,1]
  v_pk_fma_f32 v[68:69], v[172:173], v[248:249], v[68:69] op_sel:[0,1,0] op_sel_hi:[1,1,1]
  v_pk_fma_f32 v[70:71], v[174:175], v[248:249], v[70:71] op_sel:[0,1,0] op_sel_hi:[1,1,1]
  v_cvt_pk_bf16_f32 v120, v64, v65
  v_cvt_pk_bf16_f32 v121, v66, v67
  v_cvt_pk_bf16_f32 v122, v68, v69
  v_cvt_pk_bf16_f32 v123, v70, v71
  ds_write_b128 v254, v[120:123]
  buffer_load_dwordx4 a[148:151], v2, s[52:55], s34 offen offset:1024 sc1
  ds_read_b64_tr_b16 v[68:69], v255
  ds_read_b64_tr_b16 v[70:71], v255 offset:640
  v_pk_add_f32 v[96:97], v[96:97], v[98:99]
  v_pk_add_f32 v[100:101], v[100:101], v[102:103]
  v_pk_add_f32 v[96:97], v[96:97], v[100:101]
  v_pk_fma_f32 v[252:253], v[34:35], v[96:97], v[252:253] op_sel:[0,0,0] op_sel_hi:[1,0,1]
  v_pk_fma_f32 v[252:253], v[34:35], v[96:97], v[252:253] op_sel:[1,1,0] op_sel_hi:[0,1,1] neg_hi:[1,0,0]
  s_add_u32 s13, s79, 0
  s_waitcnt lgkmcnt(3)
  buffer_store_dwordx4 v[60:63], v47, s[60:63], s13 offen sc1
  v_pk_fma_f32 v[72:73], v[176:177], v[250:251], v[72:73] op_sel:[0,0,0] op_sel_hi:[1,0,1]
  v_pk_fma_f32 v[74:75], v[178:179], v[250:251], v[74:75] op_sel:[0,0,0] op_sel_hi:[1,0,1]
  v_pk_fma_f32 v[76:77], v[180:181], v[250:251], v[76:77] op_sel:[0,0,0] op_sel_hi:[1,0,1]
  v_pk_fma_f32 v[78:79], v[182:183], v[250:251], v[78:79] op_sel:[0,0,0] op_sel_hi:[1,0,1]
  v_pk_fma_f32 v[72:73], v[184:185], v[250:251], v[72:73] op_sel:[0,1,0] op_sel_hi:[1,1,1]
  v_pk_fma_f32 v[74:75], v[186:187], v[250:251], v[74:75] op_sel:[0,1,0] op_sel_hi:[1,1,1]
  v_pk_fma_f32 v[76:77], v[188:189], v[250:251], v[76:77] op_sel:[0,1,0] op_sel_hi:[1,1,1]
  v_pk_fma_f32 v[78:79], v[190:191], v[250:251], v[78:79] op_sel:[0,1,0] op_sel_hi:[1,1,1]
  v_cvt_pk_bf16_f32 v124, v72, v73
  v_cvt_pk_bf16_f32 v125, v74, v75
  v_cvt_pk_bf16_f32 v126, v76, v77
  v_cvt_pk_bf16_f32 v127, v78, v79
  ds_write_b128 v254, v[124:127]
  ds_read_b64_tr_b16 v[76:77], v255
  ds_read_b64_tr_b16 v[78:79], v255 offset:640
  s_add_u32 s13, s80, 0
  s_waitcnt lgkmcnt(3)
  buffer_store_dwordx4 v[68:71], v47, s[60:63], s13 offen sc1
  v_pk_fma_f32 v[80:81], v[104:105], v[252:253], v[80:81] op_sel:[0,0,0] op_sel_hi:[1,0,1]
  v_pk_fma_f32 v[82:83], v[106:107], v[252:253], v[82:83] op_sel:[0,0,0] op_sel_hi:[1,0,1]
  v_pk_fma_f32 v[84:85], v[108:109], v[252:253], v[84:85] op_sel:[0,0,0] op_sel_hi:[1,0,1]
  v_pk_fma_f32 v[86:87], v[110:111], v[252:253], v[86:87] op_sel:[0,0,0] op_sel_hi:[1,0,1]
  v_pk_fma_f32 v[80:81], v[112:113], v[252:253], v[80:81] op_sel:[0,1,0] op_sel_hi:[1,1,1]
  v_pk_fma_f32 v[82:83], v[114:115], v[252:253], v[82:83] op_sel:[0,1,0] op_sel_hi:[1,1,1]
  v_pk_fma_f32 v[84:85], v[116:117], v[252:253], v[84:85] op_sel:[0,1,0] op_sel_hi:[1,1,1]
  v_pk_fma_f32 v[86:87], v[118:119], v[252:253], v[86:87] op_sel:[0,1,0] op_sel_hi:[1,1,1]
  v_cvt_pk_bf16_f32 v120, v80, v81
  v_cvt_pk_bf16_f32 v121, v82, v83
  v_cvt_pk_bf16_f32 v122, v84, v85
  v_cvt_pk_bf16_f32 v123, v86, v87
  ds_write_b128 v254, v[120:123]
  ds_read_b64_tr_b16 v[84:85], v255
  ds_read_b64_tr_b16 v[86:87], v255 offset:640
  v_accvgpr_read_b32 v246, a204
  v_accvgpr_read_b32 v247, a205
  v_accvgpr_read_b32 v248, a206
  v_accvgpr_read_b32 v249, a207
  v_accvgpr_read_b32 v250, a208
  v_accvgpr_read_b32 v251, a209
  v_accvgpr_read_b32 v252, a210
  v_accvgpr_read_b32 v44, a211
  v_accvgpr_read_b32 v45, a212
  v_accvgpr_read_b32 v46, a213
  v_accvgpr_read_b32 v244, a214
  ds_read_b64 v[88:89], v247 offset:1536
  ds_read_b64 v[90:91], v247 offset:1024
  ds_read_b64 v[92:93], v247 offset:512
  ds_read_b64 v[94:95], v247 offset:0
  ds_read_b64 v[96:97], v248
  s_waitcnt lgkmcnt(5)
  s_bitcmp1_b32 s1, 0
  s_cbranch_scc1 type_36
  ds_read2_b32 v[156:157], v235 offset0:176 offset1:177
  ds_read2_b32 v[158:159], v235 offset0:178 offset1:179
  ds_read_b128 v[160:163], v240 offset:3776
  ds_read2_b32 v[152:153], v235 offset0:48 offset1:49
  ds_read2_b32 v[154:155], v235 offset0:50 offset1:51
  ds_read_b128 v[164:167], v240 offset:3264
  ds_read2_b32 v[148:149], v234 offset0:176 offset1:177
  ds_read2_b32 v[150:151], v234 offset0:178 offset1:179
  s_waitcnt lgkmcnt(5)
  v_mfma_f32_16x16x32_bf16 v[220:223], v[156:159], v[160:163], v[220:223]
  ds_read_b128 v[168:171], v240 offset:2752
  s_waitcnt lgkmcnt(4)
  v_mfma_f32_16x16x32_bf16 v[216:219], v[152:155], v[160:163], v[216:219]
  ds_read2_b32 v[144:145], v234 offset0:48 offset1:49
  ds_read2_b32 v[146:147], v234 offset0:50 offset1:51
  s_waitcnt lgkmcnt(5)
  v_mfma_f32_16x16x32_bf16 v[220:223], v[152:155], v[164:167], v[220:223]
  ds_read_b128 v[172:175], v240 offset:2240
  s_waitcnt lgkmcnt(4)
  v_mfma_f32_16x16x32_bf16 v[212:215], v[148:151], v[160:163], v[212:215]
  ds_read2_b32 v[140:141], v233 offset0:176 offset1:177
  ds_read2_b32 v[142:143], v233 offset0:178 offset1:179
  s_add_u32 s13, s81, 0
  buffer_store_dwordx4 v[76:79], v47, s[60:63], s13 offen sc1
  v_mfma_f32_16x16x32_bf16 v[216:219], v[148:151], v[164:167], v[216:219]
  ds_read_b128 v[176:179], v240 offset:1728
  s_waitcnt lgkmcnt(6)
  v_mfma_f32_16x16x32_bf16 v[220:223], v[148:151], v[168:171], v[220:223]
  ds_read2_b32 v[136:137], v233 offset0:48 offset1:49
  ds_read2_b32 v[138:139], v233 offset0:50 offset1:51
  s_waitcnt lgkmcnt(6)
  v_mfma_f32_16x16x32_bf16 v[208:211], v[144:147], v[160:163], v[208:211]
  ds_read_b128 v[180:183], v240 offset:1216
  v_mfma_f32_16x16x32_bf16 v[212:215], v[144:147], v[164:167], v[212:215]
  ds_read2_b32 v[132:133], v232 offset0:176 offset1:177
  ds_read2_b32 v[134:135], v232 offset0:178 offset1:179
  s_add_u32 s13, s82, 0
  buffer_store_dwordx4 v[84:87], v47, s[60:63], s13 offen sc1
  v_mfma_f32_16x16x32_bf16 v[216:219], v[144:147], v[168:171], v[216:219]
  s_waitcnt lgkmcnt(8)
  v_mfma_f32_16x16x32_bf16 v[220:223], v[144:147], v[172:175], v[220:223]
  s_waitcnt lgkmcnt(6)
  v_mfma_f32_16x16x32_bf16 v[204:207], v[140:143], v[160:163], v[204:207]
  v_mfma_f32_16x16x32_bf16 v[208:211], v[140:143], v[164:167], v[208:211]
  v_mfma_f32_16x16x32_bf16 v[212:215], v[140:143], v[168:171], v[212:215]
  buffer_load_dwordx4 a[152:155], v2, s[52:55], s34 offen offset:2048 sc1
  v_mfma_f32_16x16x32_bf16 v[216:219], v[140:143], v[172:175], v[216:219]
  ds_read_b128 v[184:187], v240 offset:704
  s_waitcnt lgkmcnt(6)
  v_mfma_f32_16x16x32_bf16 v[220:223], v[140:143], v[176:179], v[220:223]
  ds_read2_b32 v[128:129], v232 offset0:48 offset1:49
  ds_read2_b32 v[130:131], v232 offset0:50 offset1:51
  s_waitcnt lgkmcnt(6)
  v_mfma_f32_16x16x32_bf16 v[200:203], v[136:139], v[160:163], v[200:203]
  v_mfma_f32_16x16x32_bf16 v[204:207], v[136:139], v[164:167], v[204:207]
  buffer_load_dwordx4 a[156:159], v2, s[52:55], s34 offen offset:3072 sc1
  v_mfma_f32_16x16x32_bf16 v[208:211], v[136:139], v[168:171], v[208:211]
  v_mfma_f32_16x16x32_bf16 v[212:215], v[136:139], v[172:175], v[212:215]
  v_mfma_f32_16x16x32_bf16 v[216:219], v[136:139], v[176:179], v[216:219]
  s_waitcnt lgkmcnt(5)
  v_mfma_f32_16x16x32_bf16 v[220:223], v[136:139], v[180:183], v[220:223]
  s_add_u32 s34, s34, 4096
  buffer_load_dwordx4 a[160:163], v2, s[52:55], s34 offen offset:0 sc1
  s_waitcnt lgkmcnt(3)
  v_mfma_f32_16x16x32_bf16 v[196:199], v[132:135], v[160:163], v[196:199]
  ds_read_b128 v[188:191], v240 offset:192
  v_mfma_f32_16x16x32_bf16 v[200:203], v[132:135], v[164:167], v[200:203]
  ds_read2_b32 v[156:157], v239 offset0:128 offset1:129
  ds_read2_b32 v[158:159], v239 offset0:130 offset1:131
  v_mfma_f32_16x16x32_bf16 v[204:207], v[132:135], v[168:171], v[204:207]
  ds_read2_b32 v[152:153], v239 offset0:0 offset1:1
  ds_read2_b32 v[154:155], v239 offset0:2 offset1:3
  v_mfma_f32_16x16x32_bf16 v[208:211], v[132:135], v[172:175], v[208:211]
  ds_read2_b32 v[148:149], v238 offset0:128 offset1:129
  ds_read2_b32 v[150:151], v238 offset0:130 offset1:131
  v_mfma_f32_16x16x32_bf16 v[212:215], v[132:135], v[176:179], v[212:215]
  ds_read2_b32 v[144:145], v238 offset0:0 offset1:1
  ds_read2_b32 v[146:147], v238 offset0:2 offset1:3
  v_mfma_f32_16x16x32_bf16 v[216:219], v[132:135], v[180:183], v[216:219]
  buffer_load_dwordx4 a[164:167], v2, s[52:55], s34 offen offset:1024 sc1
  s_waitcnt lgkmcnt(11)
  v_mfma_f32_16x16x32_bf16 v[220:223], v[132:135], v[184:187], v[220:223]
  ds_read2_b32 v[140:141], v237 offset0:128 offset1:129
  ds_read2_b32 v[142:143], v237 offset0:130 offset1:131
  s_waitcnt lgkmcnt(11)
  v_mfma_f32_16x16x32_bf16 v[192:195], v[128:131], v[160:163], v[192:195]
  ds_read_b128 v[160:163], v241 offset:3584
  v_mfma_f32_16x16x32_bf16 v[196:199], v[128:131], v[164:167], v[196:199]
  ds_read_b128 v[164:167], v241 offset:3072
  v_mfma_f32_16x16x32_bf16 v[200:203], v[128:131], v[168:171], v[200:203]
  ds_read2_b32 v[136:137], v237 offset0:0 offset1:1
  ds_read2_b32 v[138:139], v237 offset0:2 offset1:3
  v_mfma_f32_16x16x32_bf16 v[204:207], v[128:131], v[172:175], v[204:207]
  ds_read_b128 v[168:171], v241 offset:2560
  buffer_load_dwordx4 a[168:171], v2, s[52:55], s34 offen offset:2048 sc1
  v_mfma_f32_16x16x32_bf16 v[208:211], v[128:131], v[176:179], v[208:211]
  ds_read_b128 v[172:175], v241 offset:2048
  v_mfma_f32_16x16x32_bf16 v[212:215], v[128:131], v[180:183], v[212:215]
  ds_read_b128 v[176:179], v241 offset:1536
  v_mfma_f32_16x16x32_bf16 v[216:219], v[128:131], v[184:187], v[216:219]
  ds_read2_b32 v[132:133], v236 offset0:128 offset1:129
  ds_read2_b32 v[134:135], v236 offset0:130 offset1:131
  s_waitcnt lgkmcnt(15)
  v_mfma_f32_16x16x32_bf16 v[220:223], v[128:131], v[188:191], v[220:223]
  ds_read_b128 v[180:183], v241 offset:1024
  buffer_load_dwordx4 a[172:175], v2, s[52:55], s34 offen offset:3072 sc1
  s_waitcnt vmcnt(6)
  s_add_u32 s14, s84, 4352
  v_mov_b32 v15, s8
  s_mov_b64 exec, 1
  s_cmp_eq_u32 s9, 0
  s_cbranch_scc1 slow_38
  buffer_store_dword v15, off, s[52:55], s14
back_39:
  s_mov_b64 exec, -1
  s_waitcnt lgkmcnt(9)
  v_mfma_f32_16x16x32_bf16 v[116:119], v[156:159], v[160:163], 0
  ds_read_b128 v[184:187], v241 offset:512
  s_waitcnt lgkmcnt(9)
  v_mfma_f32_16x16x32_bf16 v[116:119], v[152:155], v[164:167], v[116:119]
  ds_read2_b32 v[128:129], v236 offset0:0 offset1:1
  ds_read2_b32 v[130:131], v236 offset0:2 offset1:3
  s_waitcnt lgkmcnt(8)
  v_mfma_f32_16x16x32_bf16 v[116:119], v[148:151], v[168:171], v[116:119]
  v_mfma_f32_16x16x32_bf16 v[112:115], v[144:147], v[160:163], 0
  ds_read_b128 v[188:191], v241 offset:0
  s_waitcnt lgkmcnt(8)
  v_mfma_f32_16x16x32_bf16 v[116:119], v[144:147], v[172:175], v[116:119]
  ds_read2_b32 v[156:157], v239 offset0:144 offset1:145
  ds_read2_b32 v[158:159], v239 offset0:146 offset1:147
  v_mfma_f32_16x16x32_bf16 v[112:115], v[140:143], v[164:167], v[112:115]
  ds_read2_b32 v[152:153], v239 offset0:16 offset1:17
  ds_read2_b32 v[154:155], v239 offset0:18 offset1:19
  s_waitcnt lgkmcnt(11)
  v_mfma_f32_16x16x32_bf16 v[116:119], v[140:143], v[176:179], v[116:119]
  ds_read2_b32 v[148:149], v238 offset0:144 offset1:145
  ds_read2_b32 v[150:151], v238 offset0:146 offset1:147
  v_mfma_f32_16x16x32_bf16 v[108:111], v[136:139], v[160:163], 0
  ds_read2_b32 v[144:145], v238 offset0:16 offset1:17
  ds_read2_b32 v[146:147], v238 offset0:18 offset1:19
  s_add_u32 s34, s34, 4096
  buffer_load_dwordx4 a[176:179], v2, s[52:55], s34 offen offset:0 sc1
  s_bitcmp0_b32 s7, 0
  s_cbranch_scc1 skip_40
  v_swap_b32 v192, v208
  v_swap_b32 v193, v209
  v_swap_b32 v194, v210
  v_swap_b32 v195, v211
  v_swap_b32 v196, v212
  v_swap_b32 v197, v213
  v_swap_b32 v198, v214
  v_swap_b32 v199, v215
  v_swap_b32 v200, v216
  v_swap_b32 v201, v217
  v_swap_b32 v202, v218
  v_swap_b32 v203, v219
  v_swap_b32 v204, v220
  v_swap_b32 v205, v221
  v_swap_b32 v206, v222
  v_swap_b32 v207, v223
skip_40:
  v_mfma_f32_16x16x32_bf16 v[112:115], v[136:139], v[168:171], v[112:115]
  buffer_load_dwordx4 a[180:183], v2, s[52:55], s34 offen offset:1024 sc1
  s_waitcnt lgkmcnt(12)
  v_mfma_f32_16x16x32_bf16 v[116:119], v[136:139], v[180:183], v[116:119]
  ds_read2_b32 v[140:141], v237 offset0:144 offset1:145
  ds_read2_b32 v[142:143], v237 offset0:146 offset1:147
  v_mfma_f32_16x16x32_bf16 v[104:107], v[132:135], v[160:163], 0
  ds_read_b128 v[160:163], v241 offset:3648
  v_mfma_f32_16x16x32_bf16 v[108:111], v[132:135], v[164:167], v[108:111]
  ds_read2_b32 v[136:137], v237 offset0:16 offset1:17
  ds_read2_b32 v[138:139], v237 offset0:18 offset1:19
  ds_write_b128 v249, v[208:211] offset:0
  v_mfma_f32_16x16x32_bf16 v[112:115], v[132:135], v[172:175], v[112:115]
  ds_read_b128 v[172:175], v241 offset:2112
  s_waitcnt lgkmcnt(15)
  v_mfma_f32_16x16x32_bf16 v[116:119], v[132:135], v[184:187], v[116:119]
  ds_read_b128 v[180:183], v241 offset:1088
  v_mfma_f32_16x16x32_bf16 v[104:107], v[128:131], v[164:167], v[104:107]
  ds_read_b128 v[164:167], v241 offset:3136
  v_mfma_f32_16x16x32_bf16 v[108:111], v[128:131], v[168:171], v[108:111]
  ds_read2_b32 v[132:133], v236 offset0:144 offset1:145
  ds_read2_b32 v[134:135], v236 offset0:146 offset1:147
  buffer_load_dwordx4 a[184:187], v2, s[52:55], s34 offen offset:2048 sc1
  ds_write_b128 v249, v[212:215] offset:1024
  s_mov_b32 s92, 24576
  buffer_load_dwordx4 v[120:123], v2, s[52:55], s92 offen sc1
  v_mfma_f32_16x16x32_bf16 v[112:115], v[128:131], v[176:179], v[112:115]
  ds_read_b128 v[168:171], v241 offset:2624
  v_mfma_f32_16x16x32_bf16 v[116:119], v[128:131], v[188:191], v[116:119]
  ds_read_b128 v[176:179], v241 offset:1600
  s_waitcnt lgkmcnt(11)
  v_mfma_f32_16x16x32_bf16 v[116:119], v[156:159], v[160:163], v[116:119]
  ds_read_b128 v[184:187], v241 offset:576
  s_waitcnt lgkmcnt(6)
  v_mfma_f32_16x16x32_bf16 v[116:119], v[152:155], v[164:167], v[116:119]
  ds_read2_b32 v[128:129], v236 offset0:16 offset1:17
  ds_read2_b32 v[130:131], v236 offset0:18 offset1:19
  buffer_load_dwordx4 a[188:191], v2, s[52:55], s34 offen offset:3072 sc1
  ds_write_b128 v249, v[216:219] offset:2048
  s_barrier
  s_waitcnt lgkmcnt(5)
  v_mfma_f32_16x16x32_bf16 v[116:119], v[148:151], v[168:171], v[116:119]
  s_add_u32 s34, s34, 4096
  buffer_load_dwordx4 a[192:195], v2, s[52:55], s34 offen offset:0 sc1
  v_mfma_f32_16x16x32_bf16 v[112:115], v[144:147], v[160:163], v[112:115]
  ds_read_b128 v[188:191], v241 offset:64
  v_mfma_f32_16x16x32_bf16 v[116:119], v[144:147], v[172:175], v[116:119]
  ds_write_b128 v249, v[220:223] offset:3072
  v_mfma_f32_16x16x32_bf16 v[112:115], v[140:143], v[164:167], v[112:115]
  s_waitcnt lgkmcnt(6)
  v_mfma_f32_16x16x32_bf16 v[116:119], v[140:143], v[176:179], v[116:119]
  buffer_load_dwordx4 a[196:199], v2, s[52:55], s34 offen offset:1024 sc1
  v_mfma_f32_16x16x32_bf16 v[108:111], v[136:139], v[160:163], v[108:111]
  buffer_load_dwordx2 v[42:43], v244, s[52:55], s49 offen sc1
  v_mfma_f32_16x16x32_bf16 v[112:115], v[136:139], v[168:171], v[112:115]
  v_mfma_f32_16x16x32_bf16 v[116:119], v[136:139], v[180:183], v[116:119]
  v_mfma_f32_16x16x32_bf16 v[104:107], v[132:135], v[160:163], v[104:107]
  v_mfma_f32_16x16x32_bf16 v[108:111], v[132:135], v[164:167], v[108:111]
  v_mfma_f32_16x16x32_bf16 v[112:115], v[132:135], v[172:175], v[112:115]
  s_waitcnt lgkmcnt(5)
  v_mfma_f32_16x16x32_bf16 v[116:119], v[132:135], v[184:187], v[116:119]
  s_waitcnt lgkmcnt(3)
  v_mfma_f32_16x16x32_bf16 v[104:107], v[128:131], v[164:167], v[104:107]
  v_mfma_f32_16x16x32_bf16 v[108:111], v[128:131], v[168:171], v[108:111]
  v_mfma_f32_16x16x32_bf16 v[112:115], v[128:131], v[176:179], v[112:115]
  s_waitcnt lgkmcnt(1)
  v_mfma_f32_16x16x32_bf16 v[116:119], v[128:131], v[188:191], v[116:119]
  s_branch join_37
type_36:
  ds_read2_b32 v[156:157], v235 offset0:176 offset1:177
  ds_read2_b32 v[158:159], v235 offset0:178 offset1:179
  ds_read_b128 v[160:163], v240 offset:3776
  ds_read2_b32 v[152:153], v235 offset0:48 offset1:49
  ds_read2_b32 v[154:155], v235 offset0:50 offset1:51
  ds_read_b128 v[164:167], v240 offset:3264
  ds_read2_b32 v[148:149], v234 offset0:176 offset1:177
  ds_read2_b32 v[150:151], v234 offset0:178 offset1:179
  s_waitcnt lgkmcnt(5)
  v_mfma_f32_16x16x32_bf16 v[220:223], v[156:159], v[160:163], v[220:223]
  ds_read_b128 v[168:171], v240 offset:2752
  s_waitcnt lgkmcnt(4)
  v_mfma_f32_16x16x32_bf16 v[216:219], v[152:155], v[160:163], v[216:219]
  ds_read2_b32 v[144:145], v234 offset0:48 offset1:49
  ds_read2_b32 v[146:147], v234 offset0:50 offset1:51
  s_waitcnt lgkmcnt(5)
  v_mfma_f32_16x16x32_bf16 v[220:223], v[152:155], v[164:167], v[220:223]
  ds_read_b128 v[172:175], v240 offset:2240
  s_waitcnt lgkmcnt(4)
  v_mfma_f32_16x16x32_bf16 v[212:215], v[148:151], v[160:163], v[212:215]
  ds_read2_b32 v[140:141], v233 offset0:176 offset1:177
  ds_read2_b32 v[142:143], v233 offset0:178 offset1:179
  s_add_u32 s13, s81, 0
  buffer_store_dwordx4 v[76:79], v47, s[60:63], s13 offen sc1
  v_mfma_f32_16x16x32_bf16 v[216:219], v[148:151], v[164:167], v[216:219]
  ds_read_b128 v[176:179], v240 offset:1728
  s_waitcnt lgkmcnt(6)
  v_mfma_f32_16x16x32_bf16 v[220:223], v[148:151], v[168:171], v[220:223]
  ds_read2_b32 v[136:137], v233 offset0:48 offset1:49
  ds_read2_b32 v[138:139], v233 offset0:50 offset1:51
  s_waitcnt lgkmcnt(6)
  v_mfma_f32_16x16x32_bf16 v[208:211], v[144:147], v[160:163], v[208:211]
  ds_read_b128 v[180:183], v240 offset:1216
  v_mfma_f32_16x16x32_bf16 v[212:215], v[144:147], v[164:167], v[212:215]
  ds_read2_b32 v[132:133], v232 offset0:176 offset1:177
  ds_read2_b32 v[134:135], v232 offset0:178 offset1:179
  s_add_u32 s13, s82, 0
  buffer_store_dwordx4 v[84:87], v47, s[60:63], s13 offen sc1
  v_mfma_f32_16x16x32_bf16 v[216:219], v[144:147], v[168:171], v[216:219]
  s_waitcnt lgkmcnt(8)
  v_mfma_f32_16x16x32_bf16 v[220:223], v[144:147], v[172:175], v[220:223]
  s_waitcnt lgkmcnt(6)
  v_mfma_f32_16x16x32_bf16 v[204:207], v[140:143], v[160:163], v[204:207]
  v_mfma_f32_16x16x32_bf16 v[208:211], v[140:143], v[164:167], v[208:211]
  v_mfma_f32_16x16x32_bf16 v[212:215], v[140:143], v[168:171], v[212:215]
  buffer_load_dwordx4 a[152:155], v2, s[52:55], s34 offen offset:2048 sc1
  v_mfma_f32_16x16x32_bf16 v[216:219], v[140:143], v[172:175], v[216:219]
  ds_read_b128 v[184:187], v240 offset:704
  s_waitcnt lgkmcnt(6)
  v_mfma_f32_16x16x32_bf16 v[220:223], v[140:143], v[176:179], v[220:223]
  ds_read2_b32 v[128:129], v232 offset0:48 offset1:49
  ds_read2_b32 v[130:131], v232 offset0:50 offset1:51
  s_waitcnt lgkmcnt(6)
  v_mfma_f32_16x16x32_bf16 v[200:203], v[136:139], v[160:163], v[200:203]
  v_mfma_f32_16x16x32_bf16 v[204:207], v[136:139], v[164:167], v[204:207]
  buffer_load_dwordx4 a[156:159], v2, s[52:55], s34 offen offset:3072 sc1
  v_mfma_f32_16x16x32_bf16 v[208:211], v[136:139], v[168:171], v[208:211]
  v_mfma_f32_16x16x32_bf16 v[212:215], v[136:139], v[172:175], v[212:215]
  v_mfma_f32_16x16x32_bf16 v[216:219], v[136:139], v[176:179], v[216:219]
  s_waitcnt lgkmcnt(5)
  v_mfma_f32_16x16x32_bf16 v[220:223], v[136:139], v[180:183], v[220:223]
  s_add_u32 s34, s34, 4096
  buffer_load_dwordx4 a[160:163], v2, s[52:55], s34 offen offset:0 sc1
  s_waitcnt lgkmcnt(3)
  v_mfma_f32_16x16x32_bf16 v[196:199], v[132:135], v[160:163], v[196:199]
  ds_read_b128 v[188:191], v240 offset:192
  v_mfma_f32_16x16x32_bf16 v[200:203], v[132:135], v[164:167], v[200:203]
  ds_read2_b32 v[152:153], v239 offset0:0 offset1:1
  ds_read2_b32 v[154:155], v239 offset0:2 offset1:3
  v_mfma_f32_16x16x32_bf16 v[204:207], v[132:135], v[168:171], v[204:207]
  ds_read2_b32 v[148:149], v238 offset0:128 offset1:129
  ds_read2_b32 v[150:151], v238 offset0:130 offset1:131
  v_mfma_f32_16x16x32_bf16 v[208:211], v[132:135], v[172:175], v[208:211]
  buffer_load_dwordx4 a[164:167], v2, s[52:55], s34 offen offset:1024 sc1
  v_mfma_f32_16x16x32_bf16 v[212:215], v[132:135], v[176:179], v[212:215]
  ds_read2_b32 v[144:145], v238 offset0:0 offset1:1
  ds_read2_b32 v[146:147], v238 offset0:2 offset1:3
  v_mfma_f32_16x16x32_bf16 v[216:219], v[132:135], v[180:183], v[216:219]
  s_waitcnt lgkmcnt(9)
  v_mfma_f32_16x16x32_bf16 v[220:223], v[132:135], v[184:187], v[220:223]
  ds_read2_b32 v[140:141], v237 offset0:128 offset1:129
  ds_read2_b32 v[142:143], v237 offset0:130 offset1:131
  s_waitcnt lgkmcnt(9)
  v_mfma_f32_16x16x32_bf16 v[192:195], v[128:131], v[160:163], v[192:195]
  ds_read_b128 v[160:163], v241 offset:3584
  v_mfma_f32_16x16x32_bf16 v[196:199], v[128:131], v[164:167], v[196:199]
  ds_read_b128 v[164:167], v241 offset:3072
  v_mfma_f32_16x16x32_bf16 v[200:203], v[128:131], v[168:171], v[200:203]
  ds_read_b128 v[168:171], v241 offset:2560
  v_mfma_f32_16x16x32_bf16 v[204:207], v[128:131], v[172:175], v[204:207]
  ds_read2_b32 v[136:137], v237 offset0:0 offset1:1
  ds_read2_b32 v[138:139], v237 offset0:2 offset1:3
  buffer_load_dwordx4 a[168:171], v2, s[52:55], s34 offen offset:2048 sc1
  v_mfma_f32_16x16x32_bf16 v[208:211], v[128:131], v[176:179], v[208:211]
  ds_read_b128 v[172:175], v241 offset:2048
  v_mfma_f32_16x16x32_bf16 v[212:215], v[128:131], v[180:183], v[212:215]
  ds_read_b128 v[176:179], v241 offset:1536
  v_mfma_f32_16x16x32_bf16 v[216:219], v[128:131], v[184:187], v[216:219]
  ds_read2_b32 v[132:133], v236 offset0:128 offset1:129
  ds_read2_b32 v[134:135], v236 offset0:130 offset1:131
  s_waitcnt lgkmcnt(15)
  v_mfma_f32_16x16x32_bf16 v[220:223], v[128:131], v[188:191], v[220:223]
  ds_read_b128 v[180:183], v241 offset:1024
  buffer_load_dwordx4 a[172:175], v2, s[52:55], s34 offen offset:3072 sc1
  s_waitcnt vmcnt(6)
  s_add_u32 s14, s84, 4352
  v_mov_b32 v15, s8
  s_mov_b64 exec, 1
  s_cmp_eq_u32 s9, 0
  s_cbranch_scc1 slow_41
  buffer_store_dword v15, off, s[52:55], s14
back_42:
  s_mov_b64 exec, -1
  s_waitcnt lgkmcnt(9)
  v_mfma_f32_16x16x32_bf16 v[116:119], v[152:155], v[160:163], 0
  ds_read2_b32 v[128:129], v236 offset0:0 offset1:1
  ds_read2_b32 v[130:131], v236 offset0:2 offset1:3
  v_mfma_f32_16x16x32_bf16 v[112:115], v[148:151], v[160:163], 0
  s_waitcnt lgkmcnt(10)
  v_mfma_f32_16x16x32_bf16 v[116:119], v[148:151], v[164:167], v[116:119]
  v_mfma_f32_16x16x32_bf16 v[112:115], v[144:147], v[164:167], v[112:115]
  ds_read_b128 v[184:187], v241 offset:512
  s_waitcnt lgkmcnt(10)
  v_mfma_f32_16x16x32_bf16 v[116:119], v[144:147], v[168:171], v[116:119]
  ds_read2_b32 v[152:153], v239 offset0:16 offset1:17
  ds_read2_b32 v[154:155], v239 offset0:18 offset1:19
  v_mfma_f32_16x16x32_bf16 v[108:111], v[140:143], v[160:163], 0
  ds_read2_b32 v[148:149], v238 offset0:144 offset1:145
  ds_read2_b32 v[150:151], v238 offset0:146 offset1:147
  v_mfma_f32_16x16x32_bf16 v[112:115], v[140:143], v[168:171], v[112:115]
  s_add_u32 s34, s34, 4096
  buffer_load_dwordx4 a[176:179], v2, s[52:55], s34 offen offset:0 sc1
  s_waitcnt lgkmcnt(11)
  v_mfma_f32_16x16x32_bf16 v[116:119], v[140:143], v[172:175], v[116:119]
  ds_read2_b32 v[144:145], v238 offset0:16 offset1:17
  ds_read2_b32 v[146:147], v238 offset0:18 offset1:19
  s_bitcmp0_b32 s7, 0
  s_cbranch_scc1 skip_43
  v_swap_b32 v192, v208
  v_swap_b32 v193, v209
  v_swap_b32 v194, v210
  v_swap_b32 v195, v211
  v_swap_b32 v196, v212
  v_swap_b32 v197, v213
  v_swap_b32 v198, v214
  v_swap_b32 v199, v215
  v_swap_b32 v200, v216
  v_swap_b32 v201, v217
  v_swap_b32 v202, v218
  v_swap_b32 v203, v219
  v_swap_b32 v204, v220
  v_swap_b32 v205, v221
  v_swap_b32 v206, v222
  v_swap_b32 v207, v223
skip_43:
  v_mfma_f32_16x16x32_bf16 v[108:111], v[136:139], v[164:167], v[108:111]
  ds_read_b128 v[164:167], v241 offset:3136
  v_mfma_f32_16x16x32_bf16 v[112:115], v[136:139], v[172:175], v[112:115]
  ds_read2_b32 v[140:141], v237 offset0:144 offset1:145
  ds_read2_b32 v[142:143], v237 offset0:146 offset1:147
  s_waitcnt lgkmcnt(15)
  v_mfma_f32_16x16x32_bf16 v[116:119], v[136:139], v[176:179], v[116:119]
  buffer_load_dwordx4 a[180:183], v2, s[52:55], s34 offen offset:1024 sc1
  s_waitcnt lgkmcnt(13)
  v_mfma_f32_16x16x32_bf16 v[108:111], v[132:135], v[168:171], v[108:111]
  ds_read_b128 v[168:171], v241 offset:2624
  ds_write_b128 v249, v[208:211] offset:0
  v_mfma_f32_16x16x32_bf16 v[112:115], v[132:135], v[176:179], v[112:115]
  ds_read2_b32 v[136:137], v237 offset0:16 offset1:17
  ds_read2_b32 v[138:139], v237 offset0:18 offset1:19
  s_waitcnt lgkmcnt(15)
  v_mfma_f32_16x16x32_bf16 v[116:119], v[132:135], v[180:183], v[116:119]
  buffer_load_dwordx4 a[184:187], v2, s[52:55], s34 offen offset:2048 sc1
  s_waitcnt lgkmcnt(14)
  v_mfma_f32_16x16x32_bf16 v[104:107], v[128:131], v[160:163], 0
  ds_read_b128 v[160:163], v241 offset:3648
  v_mfma_f32_16x16x32_bf16 v[108:111], v[128:131], v[172:175], v[108:111]
  ds_read_b128 v[176:179], v241 offset:1600
  ds_write_b128 v249, v[212:215] offset:1024
  s_mov_b32 s92, 24576
  buffer_load_dwordx4 v[120:123], v2, s[52:55], s92 offen sc1
  v_mfma_f32_16x16x32_bf16 v[112:115], v[128:131], v[180:183], v[112:115]
  ds_read_b128 v[172:175], v241 offset:2112
  s_waitcnt lgkmcnt(15)
  v_mfma_f32_16x16x32_bf16 v[116:119], v[128:131], v[184:187], v[116:119]
  ds_read2_b32 v[132:133], v236 offset0:144 offset1:145
  ds_read2_b32 v[134:135], v236 offset0:146 offset1:147
  s_waitcnt lgkmcnt(5)
  v_mfma_f32_16x16x32_bf16 v[116:119], v[152:155], v[160:163], v[116:119]
  ds_read_b128 v[180:183], v241 offset:1088
  v_mfma_f32_16x16x32_bf16 v[112:115], v[148:151], v[160:163], v[112:115]
  ds_read2_b32 v[128:129], v236 offset0:16 offset1:17
  ds_read2_b32 v[130:131], v236 offset0:18 offset1:19
  buffer_load_dwordx4 a[188:191], v2, s[52:55], s34 offen offset:3072 sc1
  ds_write_b128 v249, v[216:219] offset:2048
  s_barrier
  v_mfma_f32_16x16x32_bf16 v[116:119], v[148:151], v[164:167], v[116:119]
  s_add_u32 s34, s34, 4096
  buffer_load_dwordx4 a[192:195], v2, s[52:55], s34 offen offset:0 sc1
  v_mfma_f32_16x16x32_bf16 v[112:115], v[144:147], v[164:167], v[112:115]
  ds_read_b128 v[184:187], v241 offset:576
  v_mfma_f32_16x16x32_bf16 v[116:119], v[144:147], v[168:171], v[116:119]
  ds_write_b128 v249, v[220:223] offset:3072
  v_mfma_f32_16x16x32_bf16 v[108:111], v[140:143], v[160:163], v[108:111]
  v_mfma_f32_16x16x32_bf16 v[112:115], v[140:143], v[168:171], v[112:115]
  buffer_load_dwordx4 a[196:199], v2, s[52:55], s34 offen offset:1024 sc1
  s_waitcnt lgkmcnt(8)
  v_mfma_f32_16x16x32_bf16 v[116:119], v[140:143], v[172:175], v[116:119]
  buffer_load_dwordx2 v[42:43], v244, s[52:55], s49 offen sc1
  v_mfma_f32_16x16x32_bf16 v[108:111], v[136:139], v[164:167], v[108:111]
  v_mfma_f32_16x16x32_bf16 v[112:115], v[136:139], v[172:175], v[112:115]
  v_mfma_f32_16x16x32_bf16 v[116:119], v[136:139], v[176:179], v[116:119]
  s_waitcnt lgkmcnt(6)
  v_mfma_f32_16x16x32_bf16 v[108:111], v[132:135], v[168:171], v[108:111]
  v_mfma_f32_16x16x32_bf16 v[112:115], v[132:135], v[176:179], v[112:115]
  s_waitcnt lgkmcnt(5)
  v_mfma_f32_16x16x32_bf16 v[116:119], v[132:135], v[180:183], v[116:119]
  s_waitcnt lgkmcnt(3)
  v_mfma_f32_16x16x32_bf16 v[104:107], v[128:131], v[160:163], v[104:107]
  v_mfma_f32_16x16x32_bf16 v[108:111], v[128:131], v[172:175], v[108:111]
  v_mfma_f32_16x16x32_bf16 v[112:115], v[128:131], v[180:183], v[112:115]
  s_waitcnt lgkmcnt(1)
  v_mfma_f32_16x16x32_bf16 v[116:119], v[128:131], v[184:187], v[116:119]
join_37:
  s_nop 3
  ds_write_b128 v252, v[104:107] offset:0
  ds_write_b128 v252, v[108:111] offset:1024
  ds_write_b128 v252, v[112:115] offset:2048
  s_nop 0
  ds_write_b128 v252, v[116:119] offset:3072
  v_dot2_f32_bf16 v192, v89, s31, v192
  v_dot2_f32_bf16 v193, v89, s30, v193
  v_dot2_f32_bf16 v194, v88, s31, v194
  v_dot2_f32_bf16 v195, v88, s30, v195
  v_dot2_f32_bf16 v196, v91, s31, v196
  v_dot2_f32_bf16 v197, v91, s30, v197
  v_dot2_f32_bf16 v198, v90, s31, v198
  v_dot2_f32_bf16 v199, v90, s30, v199
  v_dot2_f32_bf16 v200, v93, s31, v200
  v_dot2_f32_bf16 v201, v93, s30, v201
  v_dot2_f32_bf16 v202, v92, s31, v202
  v_dot2_f32_bf16 v203, v92, s30, v203
  v_dot2_f32_bf16 v204, v95, s31, v204
  v_dot2_f32_bf16 v205, v95, s30, v205
  v_dot2_f32_bf16 v206, v94, s31, v206
  v_dot2_f32_bf16 v207, v94, s30, v207
  s_waitcnt vmcnt(4)
  v_min3_u32 v15, v120, v121, s8
  v_max3_u32 v14, v120, v121, s8
  v_min3_u32 v15, v15, v122, v123
  v_max3_u32 v14, v14, v122, v123
  v_cmp_ne_u32 vcc, v15, v14
  s_cbranch_vccnz again_44
ok_45:
  s_waitcnt vmcnt(0)
  v_xor_b32 v15, s8, v42
  v_xor_b32 v14, s8, v43
  v_or_b32 v15, v15, v14
  v_cmp_ne_u32 vcc, 0, v15
  s_cbranch_vccz ok_47
again_46:
  buffer_load_dwordx2 v[42:43], v244, s[52:55], s49 offen sc1
  s_sub_u32 s10, s10, 1
  s_cmp_gt_i32 s10, 0
  s_waitcnt vmcnt(0)
  v_xor_b32 v15, s8, v42
  v_xor_b32 v14, s8, v43
  v_or_b32 v15, v15, v14
  v_cmp_ne_u32 vcc, 0, v15
  s_cbranch_scc0 out_48
  s_cbranch_vccnz again_46
out_48:
ok_47:
  buffer_load_dwordx4 v[128:131], v2, s[60:63], s16 offen offset:0 sc1
  buffer_load_dwordx4 v[132:135], v2, s[60:63], s16 offen offset:1024 sc1
  buffer_load_dwordx4 v[136:139], v2, s[60:63], s16 offen offset:2048 sc1
  buffer_load_dwordx4 v[140:143], v2, s[60:63], s16 offen offset:3072 sc1
  s_add_u32 s16, s16, 4096
  buffer_load_dwordx4 v[144:147], v2, s[60:63], s16 offen offset:0 sc1
  buffer_load_dwordx4 v[148:151], v2, s[60:63], s16 offen offset:1024 sc1
  buffer_load_dwordx4 v[152:155], v2, s[60:63], s16 offen offset:2048 sc1
  buffer_load_dwordx4 v[156:159], v2, s[60:63], s16 offen offset:3072 sc1
  s_waitcnt lgkmcnt(0)
  s_barrier
  ds_read_b128 v[208:211], v250 offset:0
  ds_read_b128 v[212:215], v250 offset:1024
  ds_read_b128 v[216:219], v250 offset:2048
  ds_read_b128 v[220:223], v250 offset:3072
  ds_read_b128 v[224:227], v251 offset:0
  ds_read_b128 v[228:231], v251 offset:4096
  ds_read_b128 v[232:235], v251 offset:8192
  ds_read_b128 v[236:239], v251 offset:12288
  s_waitcnt vmcnt(7)
  v_mfma_f32_16x16x32_bf16 v[48:51], a[0:3], v[128:131], 0
  s_add_u32 s16, s16, 4096
  buffer_load_dwordx4 v[160:163], v2, s[60:63], s16 offen offset:0 sc1
  s_waitcnt lgkmcnt(0)
  v_mfma_f32_16x16x32_bf16 v[52:55], a[4:7], v[128:131], 0
  v_add_f32 v208, v192, v208
  v_add_f32 v209, v193, v209
  v_mfma_f32_16x16x32_bf16 v[56:59], a[8:11], v[128:131], 0
  v_add_f32 v210, v194, v210
  v_add_f32 v211, v195, v211
  v_mfma_f32_16x16x32_bf16 v[60:63], a[12:15], v[128:131], 0
  v_cvt_pk_bf16_f32 v208, v208, v209
  v_cvt_pk_bf16_f32 v209, v210, v211
  v_mfma_f32_16x16x32_bf16 v[64:67], a[16:19], v[128:131], 0
  buffer_store_dwordx2 v[208:209], v246, s[52:55], s50 offen offset:0 sc1
  s_waitcnt vmcnt(8)
  v_mfma_f32_16x16x32_bf16 v[48:51], a[20:23], v[132:135], v[48:51]
  buffer_load_dwordx4 v[164:167], v2, s[60:63], s16 offen offset:1024 sc1
  v_add_f32 v212, v196, v212
  v_mfma_f32_16x16x32_bf16 v[52:55], a[24:27], v[132:135], v[52:55]
  v_add_f32 v213, v197, v213
  v_add_f32 v214, v198, v214
  v_mfma_f32_16x16x32_bf16 v[56:59], a[28:31], v[132:135], v[56:59]
  v_add_f32_e64 v215, v199, v215
  v_cvt_pk_bf16_f32 v212, v212, v213
  v_mfma_f32_16x16x32_bf16 v[60:63], a[32:35], v[132:135], v[60:63]
  v_cvt_pk_bf16_f32 v213, v214, v215
  buffer_store_dwordx2 v[212:213], v246, s[52:55], s50 offen offset:512 sc1
  v_mfma_f32_16x16x32_bf16 v[64:67], a[36:39], v[132:135], v[64:67]
  v_add_f32 v216, v200, v216
  s_waitcnt vmcnt(9)
  v_mfma_f32_16x16x32_bf16 v[48:51], a[40:43], v[136:139], v[48:51]
  buffer_load_dwordx4 v[168:171], v2, s[60:63], s17 offen offset:0 sc1
  v_add_f32_e64 v217, v201, v217
  v_mfma_f32_16x16x32_bf16 v[52:55], a[44:47], v[136:139], v[52:55]
  v_add_f32 v218, v202, v218
  v_add_f32 v219, v203, v219
  v_mfma_f32_16x16x32_bf16 v[56:59], a[48:51], v[136:139], v[56:59]
  v_cvt_pk_bf16_f32 v216, v216, v217
  v_cvt_pk_bf16_f32 v217, v218, v219
  v_mfma_f32_16x16x32_bf16 v[60:63], a[52:55], v[136:139], v[60:63]
  buffer_store_dwordx2 v[216:217], v246, s[52:55], s50 offen offset:1024 sc1
  v_add_f32_e64 v220, v204, v220
  v_mfma_f32_16x16x32_bf16 v[64:67], a[56:59], v[136:139], v[64:67]
  v_add_f32 v221, v205, v221
  s_waitcnt vmcnt(10)
  v_mfma_f32_16x16x32_bf16 v[48:51], a[60:63], v[140:143], v[48:51]
  buffer_load_dwordx4 v[172:175], v2, s[60:63], s17 offen offset:1024 sc1
  v_add_f32_e64 v222, v206, v222
  v_mfma_f32_16x16x32_bf16 v[52:55], a[64:67], v[140:143], v[52:55]
  v_add_f32_e64 v223, v207, v223
  v_cvt_pk_bf16_f32 v220, v220, v221
  v_mfma_f32_16x16x32_bf16 v[56:59], a[68:71], v[140:143], v[56:59]
  v_cvt_pk_bf16_f32 v221, v222, v223
  buffer_store_dwordx2 v[220:221], v246, s[52:55], s50 offen offset:1536 sc1
  v_mfma_f32_16x16x32_bf16 v[60:63], a[72:75], v[140:143], v[60:63]
  v_dot2_f32_bf16 v224, v97, s45, v224
  v_dot2_f32_bf16 v225, v97, s25, v225
  v_mfma_f32_16x16x32_bf16 v[64:67], a[76:79], v[140:143], v[64:67]
  v_dot2_f32_bf16 v226, v96, s45, v226
  s_waitcnt vmcnt(11)
  v_mfma_f32_16x16x32_bf16 v[48:51], a[80:83], v[144:147], v[48:51]
  buffer_load_dwordx4 v[176:179], v2, s[60:63], s17 offen offset:2048 sc1
  v_dot2_f32_bf16 v227, v96, s25, v227
  v_mfma_f32_16x16x32_bf16 v[52:55], a[84:87], v[144:147], v[52:55]
  v_add_f32 v228, v228, v232
  v_add_f32_e64 v229, v229, v233
  v_mfma_f32_16x16x32_bf16 v[56:59], a[88:91], v[144:147], v[56:59]
  v_add_f32 v230, v230, v234
  v_add_f32 v231, v231, v235
  v_mfma_f32_16x16x32_bf16 v[60:63], a[92:95], v[144:147], v[60:63]
  v_add_f32 v224, v224, v236
  v_add_f32 v225, v225, v237
  v_mfma_f32_16x16x32_bf16 v[64:67], a[96:99], v[144:147], v[64:67]
  v_add_f32 v226, v226, v238
  s_waitcnt vmcnt(11)
  v_mfma_f32_16x16x32_bf16 v[48:51], a[100:103], v[148:151], v[48:51]
  buffer_load_dwordx4 v[180:183], v2, s[60:63], s17 offen offset:3072 sc1
  v_add_f32_e64 v227, v227, v239
  v_mfma_f32_16x16x32_bf16 v[52:55], a[104:107], v[148:151], v[52:55]
  v_add_f32 v224, v224, v228
  v_add_f32 v225, v225, v229
  v_mfma_f32_16x16x32_bf16 v[56:59], a[108:111], v[148:151], v[56:59]
  v_add_f32 v226, v226, v230
  v_add_f32 v227, v227, v231
  v_mfma_f32_16x16x32_bf16 v[60:63], a[112:115], v[148:151], v[60:63]
  v_cvt_pk_bf16_f32 v224, v224, v225
  v_cvt_pk_bf16_f32 v225, v226, v227
  v_mfma_f32_16x16x32_bf16 v[64:67], a[116:119], v[148:151], v[64:67]
  buffer_store_dwordx2 v[224:225], v246, s[52:55], s51 offen sc1
  s_waitcnt vmcnt(12)
  v_mfma_f32_16x16x32_bf16 v[48:51], a[120:123], v[152:155], v[48:51]
  s_add_u32 s17, s17, 4096
  buffer_load_dwordx4 v[184:187], v2, s[60:63], s17 offen offset:0 sc1
  s_barrier
  v_mfma_f32_16x16x32_bf16 v[52:55], a[124:127], v[152:155], v[52:55]
  v_accvgpr_read_b32 v102, a226
  v_accvgpr_read_b32 v103, a227
  v_mfma_f32_16x16x32_bf16 v[56:59], a[128:131], v[152:155], v[56:59]
  v_mul_f32_e64 v102, v102, v103
  v_accvgpr_read_b32 v98, a216
  v_mfma_f32_16x16x32_bf16 v[60:63], a[132:135], v[152:155], v[60:63]
  v_accvgpr_read_b32 v100, a230
  v_accvgpr_read_b32 v99, a217
  v_mfma_f32_16x16x32_bf16 v[64:67], a[136:139], v[152:155], v[64:67]
  v_accvgpr_read_b32 v101, a231
  v_lshlrev_b32 v108, 16, v98
  s_waitcnt vmcnt(12)
  v_mfma_f32_16x16x32_bf16 v[48:51], a[140:143], v[156:159], v[48:51]
  buffer_load_dwordx4 v[188:191], v2, s[60:63], s17 offen offset:1024 sc1
  v_and_b32 v109, 0xffff0000, v98
  v_mfma_f32_16x16x32_bf16 v[52:55], a[144:147], v[156:159], v[52:55]
  v_lshlrev_b32_e64 v110, 16, v99
  v_and_b32 v111, 0xffff0000, v99
  v_mfma_f32_16x16x32_bf16 v[56:59], a[148:151], v[156:159], v[56:59]
  v_lshlrev_b32_e64 v92, 16, v100
  v_and_b32 v93, 0xffff0000, v100
  v_mfma_f32_16x16x32_bf16 v[60:63], a[152:155], v[156:159], v[60:63]
  v_lshlrev_b32_e64 v94, 16, v101
  v_and_b32 v95, 0xffff0000, v101
  v_mfma_f32_16x16x32_bf16 v[64:67], a[156:159], v[156:159], v[64:67]
  v_fma_f32 v88, v108, v103, -v102
  s_waitcnt vmcnt(12)
  v_mfma_f32_16x16x32_bf16 v[48:51], a[160:163], v[160:163], v[48:51]
  buffer_load_dwordx4 v[128:131], v2, s[60:63], s17 offen offset:2048 sc1
  v_fma_f32 v89, v109, v103, -v102
  v_mfma_f32_16x16x32_bf16 v[52:55], a[164:167], v[160:163], v[52:55]
  v_fma_f32 v90, v110, v103, -v102
  v_fma_f32 v91, v111, v103, -v102
  v_mfma_f32_16x16x32_bf16 v[56:59], a[168:171], v[160:163], v[56:59]
  v_fmac_f32 v108, v88, v92
  v_fmac_f32_e64 v109, v89, v93
  v_mfma_f32_16x16x32_bf16 v[60:63], a[172:175], v[160:163], v[60:63]
  v_fmac_f32 v110, v90, v94
  v_fmac_f32 v111, v91, v95
  v_mfma_f32_16x16x32_bf16 v[64:67], a[176:179], v[160:163], v[64:67]
  v_accvgpr_read_b32 v98, a218
  s_waitcnt vmcnt(11)
  v_mfma_f32_16x16x32_bf16 v[48:51], a[180:183], v[164:167], v[48:51]
  buffer_load_dwordx4 v[132:135], v2, s[60:63], s17 offen offset:3072 sc1
  v_accvgpr_read_b32 v100, a232
  v_mfma_f32_16x16x32_bf16 v[52:55], a[184:187], v[164:167], v[52:55]
  v_accvgpr_read_b32 v99, a219
  v_accvgpr_read_b32 v101, a233
  v_mfma_f32_16x16x32_bf16 v[56:59], a[188:191], v[164:167], v[56:59]
  v_lshlrev_b32 v112, 16, v98
  v_and_b32 v113, 0xffff0000, v98
  v_mfma_f32_16x16x32_bf16 v[60:63], a[192:195], v[164:167], v[60:63]
  v_lshlrev_b32_e64 v114, 16, v99
  v_and_b32 v115, 0xffff0000, v99
  v_mfma_f32_16x16x32_bf16 v[64:67], a[196:199], v[164:167], v[64:67]
  v_lshlrev_b32 v92, 16, v100
  s_waitcnt vmcnt(10)
  v_mfma_f32_16x16x32_bf16 v[68:71], a[0:3], v[168:171], 0
  s_add_u32 s17, s17, 4096
  buffer_load_dwordx4 v[136:139], v2, s[60:63], s17 offen offset:0 sc1
  v_and_b32 v93, 0xffff0000, v100
  v_mfma_f32_16x16x32_bf16 v[72:75], a[4:7], v[168:171], 0
  v_lshlrev_b32_e64 v94, 16, v101
  v_and_b32 v95, 0xffff0000, v101
  v_mfma_f32_16x16x32_bf16 v[76:79], a[8:11], v[168:171], 0
  v_fma_f32 v88, v112, v103, -v102
  v_fma_f32 v89, v113, v103, -v102
  v_mfma_f32_16x16x32_bf16 v[80:83], a[12:15], v[168:171], 0
  v_fma_f32 v90, v114, v103, -v102
  v_fma_f32 v91, v115, v103, -v102
  v_mfma_f32_16x16x32_bf16 v[84:87], a[16:19], v[168:171], 0
  v_fmac_f32 v112, v88, v92
  s_waitcnt vmcnt(9)
  v_mfma_f32_16x16x32_bf16 v[68:71], a[20:23], v[172:175], v[68:71]
  ds_write_b128 v44, v[48:51] offset:0
  ds_write_b128 v44, v[52:55] offset:1024
  buffer_load_dwordx4 v[140:143], v2, s[60:63], s17 offen offset:1024 sc1
  v_mfma_f32_16x16x32_bf16 v[72:75], a[24:27], v[172:175], v[72:75]
  v_fmac_f32 v113, v89, v93
  v_fmac_f32 v114, v90, v94
  v_mfma_f32_16x16x32_bf16 v[76:79], a[28:31], v[172:175], v[76:79]
  v_fmac_f32_e64 v115, v91, v95
  v_accvgpr_read_b32 v98, a220
  v_mfma_f32_16x16x32_bf16 v[80:83], a[32:35], v[172:175], v[80:83]
  v_accvgpr_read_b32 v100, a234
  v_accvgpr_read_b32 v99, a221
  v_mfma_f32_16x16x32_bf16 v[84:87], a[36:39], v[172:175], v[84:87]
  v_accvgpr_read_b32 v101, a235
  v_lshlrev_b32 v116, 16, v98
  s_waitcnt vmcnt(8)
  v_mfma_f32_16x16x32_bf16 v[68:71], a[40:43], v[176:179], v[68:71]
  ds_write_b128 v44, v[56:59] offset:2048
  ds_write_b128 v44, v[60:63] offset:3072
  buffer_load_dwordx4 v[144:147], v2, s[60:63], s18 offen offset:0 sc1
  v_mfma_f32_16x16x32_bf16 v[72:75], a[44:47], v[176:179], v[72:75]
  v_and_b32 v117, 0xffff0000, v98
  v_lshlrev_b32_e64 v118, 16, v99
  v_mfma_f32_16x16x32_bf16 v[76:79], a[48:51], v[176:179], v[76:79]
  v_and_b32 v119, 0xffff0000, v99
  v_lshlrev_b32_e64 v92, 16, v100
  v_mfma_f32_16x16x32_bf16 v[80:83], a[52:55], v[176:179], v[80:83]
  v_and_b32 v93, 0xffff0000, v100
  v_lshlrev_b32_e64 v94, 16, v101
  v_mfma_f32_16x16x32_bf16 v[84:87], a[56:59], v[176:179], v[84:87]
  v_and_b32 v95, 0xffff0000, v101
  v_fma_f32 v88, v116, v103, -v102
  s_waitcnt vmcnt(8)
  v_mfma_f32_16x16x32_bf16 v[68:71], a[60:63], v[180:183], v[68:71]
  ds_write_b128 v44, v[64:67] offset:4096
  buffer_load_dwordx4 v[148:151], v2, s[60:63], s18 offen offset:1024 sc1
  v_mfma_f32_16x16x32_bf16 v[72:75], a[64:67], v[180:183], v[72:75]
  v_fma_f32 v89, v117, v103, -v102
  v_fma_f32 v90, v118, v103, -v102
  v_mfma_f32_16x16x32_bf16 v[76:79], a[68:71], v[180:183], v[76:79]
  v_fma_f32 v91, v119, v103, -v102
  v_fmac_f32 v116, v88, v92
  v_mfma_f32_16x16x32_bf16 v[80:83], a[72:75], v[180:183], v[80:83]
  v_fmac_f32 v117, v89, v93
  v_fmac_f32 v118, v90, v94
  v_mfma_f32_16x16x32_bf16 v[84:87], a[76:79], v[180:183], v[84:87]
  v_fmac_f32_e64 v119, v91, v95
  v_accvgpr_read_b32 v98, a222
  s_waitcnt vmcnt(7)
  v_mfma_f32_16x16x32_bf16 v[68:71], a[80:83], v[184:187], v[68:71]
  buffer_load_dwordx4 v[152:155], v2, s[60:63], s18 offen offset:2048 sc1
  v_accvgpr_read_b32 v100, a236
  v_mfma_f32_16x16x32_bf16 v[72:75], a[84:87], v[184:187], v[72:75]
  v_accvgpr_read_b32 v99, a223
  v_accvgpr_read_b32 v101, a237
  v_mfma_f32_16x16x32_bf16 v[76:79], a[88:91], v[184:187], v[76:79]
  v_lshlrev_b32 v120, 16, v98
  v_and_b32 v121, 0xffff0000, v98
  v_mfma_f32_16x16x32_bf16 v[80:83], a[92:95], v[184:187], v[80:83]
  v_lshlrev_b32_e64 v122, 16, v99
  v_and_b32 v123, 0xffff0000, v99
  v_mfma_f32_16x16x32_bf16 v[84:87], a[96:99], v[184:187], v[84:87]
  v_lshlrev_b32 v92, 16, v100
  s_waitcnt vmcnt(7)
  v_mfma_f32_16x16x32_bf16 v[68:71], a[100:103], v[188:191], v[68:71]
  buffer_load_dwordx4 v[156:159], v2, s[60:63], s18 offen offset:3072 sc1
  v_and_b32 v93, 0xffff0000, v100
  v_mfma_f32_16x16x32_bf16 v[72:75], a[104:107], v[188:191], v[72:75]
  v_lshlrev_b32_e64 v94, 16, v101
  v_and_b32 v95, 0xffff0000, v101
  v_mfma_f32_16x16x32_bf16 v[76:79], a[108:111], v[188:191], v[76:79]
  v_fma_f32 v88, v120, v103, -v102
  v_fma_f32 v89, v121, v103, -v102
  v_mfma_f32_16x16x32_bf16 v[80:83], a[112:115], v[188:191], v[80:83]
  v_fma_f32 v90, v122, v103, -v102
  v_fma_f32 v91, v123, v103, -v102
  v_mfma_f32_16x16x32_bf16 v[84:87], a[116:119], v[188:191], v[84:87]
  v_fmac_f32 v120, v88, v92
  s_waitcnt vmcnt(7)
  v_mfma_f32_16x16x32_bf16 v[68:71], a[120:123], v[128:131], v[68:71]
  s_add_u32 s18, s18, 4096
  buffer_load_dwordx4 v[160:163], v2, s[60:63], s18 offen offset:0 sc1
  v_fmac_f32 v121, v89, v93
  v_fmac_f32 v122, v90, v94
  v_mfma_f32_16x16x32_bf16 v[72:75], a[124:127], v[128:131], v[72:75]
  v_fmac_f32_e64 v123, v91, v95
  v_accvgpr_read_b32 v98, a224
  v_accvgpr_read_b32 v100, a238
  v_mfma_f32_16x16x32_bf16 v[76:79], a[128:131], v[128:131], v[76:79]
  v_accvgpr_read_b32 v99, a225
  v_accvgpr_read_b32 v101, a239
  v_mfma_f32_16x16x32_bf16 v[80:83], a[132:135], v[128:131], v[80:83]
  v_lshlrev_b32_e64 v124, 16, v98
  s_mul_i32 s15, s7, 10240
  v_mfma_f32_16x16x32_bf16 v[84:87], a[136:139], v[128:131], v[84:87]
  s_add_u32 s15, s15, 102400
  v_add_u32 v47, s15, v2
  s_waitcnt vmcnt(7)
  v_mfma_f32_16x16x32_bf16 v[68:71], a[140:143], v[132:135], v[68:71]
  buffer_load_dwordx4 v[164:167], v2, s[60:63], s18 offen offset:1024 sc1
  v_and_b32 v125, 0xffff0000, v98
  v_mfma_f32_16x16x32_bf16 v[72:75], a[144:147], v[132:135], v[72:75]
  v_lshlrev_b32_e64 v126, 16, v99
  v_and_b32 v127, 0xffff0000, v99
  v_mfma_f32_16x16x32_bf16 v[76:79], a[148:151], v[132:135], v[76:79]
  v_lshlrev_b32_e64 v92, 16, v100
  v_and_b32 v93, 0xffff0000, v100
  v_mfma_f32_16x16x32_bf16 v[80:83], a[152:155], v[132:135], v[80:83]
  v_lshlrev_b32_e64 v94, 16, v101
  v_and_b32 v95, 0xffff0000, v101
  v_mfma_f32_16x16x32_bf16 v[84:87], a[156:159], v[132:135], v[84:87]
  v_fma_f32 v88, v124, v103, -v102
  s_waitcnt vmcnt(7)
  v_mfma_f32_16x16x32_bf16 v[68:71], a[160:163], v[136:139], v[68:71]
  buffer_load_dwordx4 v[168:171], v2, s[60:63], s18 offen offset:2048 sc1
  v_fma_f32 v89, v125, v103, -v102
  v_mfma_f32_16x16x32_bf16 v[72:75], a[164:167], v[136:139], v[72:75]
  v_fma_f32 v90, v126, v103, -v102
  v_fma_f32 v91, v127, v103, -v102
  v_mfma_f32_16x16x32_bf16 v[76:79], a[168:171], v[136:139], v[76:79]
  v_fmac_f32 v124, v88, v92
  v_fmac_f32_e64 v125, v89, v93
  v_mfma_f32_16x16x32_bf16 v[80:83], a[172:175], v[136:139], v[80:83]
  v_fmac_f32_e64 v126, v90, v94
  v_mfma_f32_16x16x32_bf16 v[84:87], a[176:179], v[136:139], v[84:87]
  v_fmac_f32 v127, v91, v95
  s_waitcnt vmcnt(7)
  v_mfma_f32_16x16x32_bf16 v[68:71], a[180:183], v[140:143], v[68:71]
  buffer_load_dwordx4 v[172:175], v2, s[60:63], s18 offen offset:3072 sc1
  v_mfma_f32_16x16x32_bf16 v[72:75], a[184:187], v[140:143], v[72:75]
  v_mfma_f32_16x16x32_bf16 v[76:79], a[188:191], v[140:143], v[76:79]
  v_mfma_f32_16x16x32_bf16 v[80:83], a[192:195], v[140:143], v[80:83]
  v_mfma_f32_16x16x32_bf16 v[84:87], a[196:199], v[140:143], v[84:87]
  s_waitcnt vmcnt(7)
  v_mfma_f32_16x16x32_bf16 v[48:51], a[0:3], v[144:147], 0
  s_add_u32 s18, s18, 4096
  buffer_load_dwordx4 v[176:179], v2, s[60:63], s18 offen offset:0 sc1
  v_mfma_f32_16x16x32_bf16 v[52:55], a[4:7], v[144:147], 0
  v_mfma_f32_16x16x32_bf16 v[56:59], a[8:11], v[144:147], 0
  v_mfma_f32_16x16x32_bf16 v[60:63], a[12:15], v[144:147], 0
  v_mfma_f32_16x16x32_bf16 v[64:67], a[16:19], v[144:147], 0
  s_waitcnt vmcnt(7)
  v_mfma_f32_16x16x32_bf16 v[48:51], a[20:23], v[148:151], v[48:51]
  ds_write_b128 v45, v[68:71] offset:0
  v_mfma_f32_16x16x32_bf16 v[52:55], a[24:27], v[148:151], v[52:55]
  ds_write_b128 v45, v[72:75] offset:1024
  v_mfma_f32_16x16x32_bf16 v[56:59], a[28:31], v[148:151], v[56:59]
  buffer_load_dwordx4 v[180:183], v2, s[60:63], s18 offen offset:1024 sc1
  v_mfma_f32_16x16x32_bf16 v[60:63], a[32:35], v[148:151], v[60:63]
  v_mfma_f32_16x16x32_bf16 v[64:67], a[36:39], v[148:151], v[64:67]
  s_waitcnt vmcnt(7)
  v_mfma_f32_16x16x32_bf16 v[48:51], a[40:43], v[152:155], v[48:51]
  ds_write_b128 v45, v[76:79] offset:2048
  v_mfma_f32_16x16x32_bf16 v[52:55], a[44:47], v[152:155], v[52:55]
  ds_write_b128 v45, v[80:83] offset:3072
  v_mfma_f32_16x16x32_bf16 v[56:59], a[48:51], v[152:155], v[56:59]
  buffer_load_dwordx4 v[184:187], v2, s[60:63], s19 offen offset:0 sc1
  v_mfma_f32_16x16x32_bf16 v[60:63], a[52:55], v[152:155], v[60:63]
  v_mfma_f32_16x16x32_bf16 v[64:67], a[56:59], v[152:155], v[64:67]
  s_waitcnt vmcnt(7)
  v_mfma_f32_16x16x32_bf16 v[48:51], a[60:63], v[156:159], v[48:51]
  ds_write_b128 v45, v[84:87] offset:4096
  v_mfma_f32_16x16x32_bf16 v[52:55], a[64:67], v[156:159], v[52:55]
  buffer_load_dwordx4 v[188:191], v2, s[60:63], s19 offen offset:1024 sc1
  v_mfma_f32_16x16x32_bf16 v[56:59], a[68:71], v[156:159], v[56:59]
  v_mfma_f32_16x16x32_bf16 v[60:63], a[72:75], v[156:159], v[60:63]
  v_mfma_f32_16x16x32_bf16 v[64:67], a[76:79], v[156:159], v[64:67]
  s_waitcnt vmcnt(7)
  v_mfma_f32_16x16x32_bf16 v[48:51], a[80:83], v[160:163], v[48:51]
  buffer_load_dwordx4 v[128:131], v2, s[60:63], s19 offen offset:2048 sc1
  s_waitcnt lgkmcnt(0)
  s_barrier
  v_mfma_f32_16x16x32_bf16 v[52:55], a[84:87], v[160:163], v[52:55]
  ds_read_b128 v[192:195], v47 offset:0
  ds_read_b128 v[196:199], v47 offset:1024
  v_mfma_f32_16x16x32_bf16 v[56:59], a[88:91], v[160:163], v[56:59]
  ds_read_b128 v[200:203], v47 offset:2048
  ds_read_b128 v[204:207], v47 offset:3072
  v_mfma_f32_16x16x32_bf16 v[60:63], a[92:95], v[160:163], v[60:63]
  ds_read_b128 v[208:211], v47 offset:4096
  ds_read_b128 v[212:215], v47 offset:5120
  v_mfma_f32_16x16x32_bf16 v[64:67], a[96:99], v[160:163], v[64:67]
  ds_read_b128 v[216:219], v47 offset:6144
  ds_read_b128 v[220:223], v47 offset:7168
  s_waitcnt vmcnt(7)
  v_mfma_f32_16x16x32_bf16 v[48:51], a[100:103], v[164:167], v[48:51]
  buffer_load_dwordx4 v[132:135], v2, s[60:63], s19 offen offset:3072 sc1
  ds_read_b128 v[224:227], v47 offset:8192
  v_mfma_f32_16x16x32_bf16 v[52:55], a[104:107], v[164:167], v[52:55]
  ds_read_b128 v[228:231], v47 offset:9216
  s_waitcnt lgkmcnt(5)
  v_mfma_f32_16x16x32_bf16 v[56:59], a[108:111], v[164:167], v[56:59]
  v_add_f32 v108, v108, v192
  v_add_f32_e64 v109, v109, v193
  v_mfma_f32_16x16x32_bf16 v[60:63], a[112:115], v[164:167], v[60:63]
  v_add_f32 v110, v110, v194
  v_add_f32 v111, v111, v195
  v_mfma_f32_16x16x32_bf16 v[64:67], a[116:119], v[164:167], v[64:67]
  v_add_f32 v112, v112, v196
  v_add_f32 v113, v113, v197
  s_waitcnt vmcnt(7)
  v_mfma_f32_16x16x32_bf16 v[48:51], a[120:123], v[168:171], v[48:51]
  s_add_u32 s19, s19, 4096
  buffer_load_dwordx4 v[136:139], v2, s[60:63], s19 offen offset:0 sc1
  v_add_f32 v114, v114, v198
  v_mfma_f32_16x16x32_bf16 v[52:55], a[124:127], v[168:171], v[52:55]
  v_add_f32 v115, v115, v199
  v_add_f32 v116, v116, v200
  v_mfma_f32_16x16x32_bf16 v[56:59], a[128:131], v[168:171], v[56:59]
  v_add_f32 v117, v117, v201
  v_add_f32 v118, v118, v202
  v_mfma_f32_16x16x32_bf16 v[60:63], a[132:135], v[168:171], v[60:63]
  v_add_f32 v119, v119, v203
  v_add_f32 v120, v120, v204
  v_mfma_f32_16x16x32_bf16 v[64:67], a[136:139], v[168:171], v[64:67]
  v_add_f32 v121, v121, v205
  v_add_f32 v122, v122, v206
  s_waitcnt vmcnt(7)
  v_mfma_f32_16x16x32_bf16 v[48:51], a[140:143], v[172:175], v[48:51]
  buffer_load_dwordx4 v[140:143], v2, s[60:63], s19 offen offset:1024 sc1
  s_mul_i32 s93, s6, 327680
  s_lshl_b32 s12, s5, 7
  s_add_u32 s93, s93, s12
  v_mfma_f32_16x16x32_bf16 v[52:55], a[144:147], v[172:175], v[52:55]
  s_lshr_b32 s12, s7, 1
  s_mul_i32 s94, s12, 5120
  s_add_u32 s94, s94, 143360
  s_lshl_b32 s12, s12, 6
  v_mfma_f32_16x16x32_bf16 v[56:59], a[148:151], v[172:175], v[56:59]
  s_add_u32 s93, s93, s12
  s_add_u32 s93, s93, 19922944
  s_mov_b32 s92, s93
  v_add_f32 v123, v123, v207
  v_mfma_f32_16x16x32_bf16 v[60:63], a[152:155], v[172:175], v[60:63]
  v_add_f32 v124, v124, v208
  v_add_f32 v125, v125, v209
  v_add_f32 v126, v126, v210
  v_add_f32 v127, v127, v211
  v_mfma_f32_16x16x32_bf16 v[64:67], a[156:159], v[172:175], v[64:67]
  s_waitcnt lgkmcnt(0)
  v_add_f32 v108, v108, v212
  v_add_f32 v109, v109, v213
  v_add_f32 v110, v110, v214
  s_waitcnt vmcnt(7)
  v_mfma_f32_16x16x32_bf16 v[48:51], a[160:163], v[176:179], v[48:51]
  buffer_load_dwordx4 v[144:147], v2, s[60:63], s19 offen offset:2048 sc1
  s_and_b32 s12, s7, 1
  s_mul_i32 s13, s12, 196608
  s_add_u32 s93, s93, s13
  s_mul_i32 s13, s12, 3072
  v_mfma_f32_16x16x32_bf16 v[52:55], a[164:167], v[176:179], v[52:55]
  s_add_u32 s95, s94, s13
  s_lshl_b32 s12, s12, 3
  s_add_u32 s94, s94, s12
  v_lshrrev_b32_e64 v252, 2, v1
  v_mfma_f32_16x16x32_bf16 v[56:59], a[168:171], v[176:179], v[56:59]
  v_lshlrev_b32 v252, 12, v252
  v_and_b32 v12, 3, v1
  v_lshl_add_u32 v252, v12, 4, v252
  v_add_f32_e64 v111, v111, v215
  v_mfma_f32_16x16x32_bf16 v[60:63], a[172:175], v[176:179], v[60:63]
  v_add_f32 v112, v112, v216
  v_add_f32 v113, v113, v217
  v_add_f32 v114, v114, v218
  v_add_f32 v115, v115, v219
  v_mfma_f32_16x16x32_bf16 v[64:67], a[176:179], v[176:179], v[64:67]
  v_add_f32 v116, v116, v220
  v_add_f32 v117, v117, v221
  v_add_f32 v118, v118, v222
  v_add_f32 v119, v119, v223
  s_waitcnt vmcnt(7)
  v_mfma_f32_16x16x32_bf16 v[48:51], a[180:183], v[180:183], v[48:51]
  buffer_load_dwordx4 v[148:151], v2, s[60:63], s19 offen offset:3072 sc1
  v_add_f32 v120, v120, v224
  v_mfma_f32_16x16x32_bf16 v[52:55], a[184:187], v[180:183], v[52:55]
  v_add_f32 v121, v121, v225
  v_add_f32 v122, v122, v226
  v_mfma_f32_16x16x32_bf16 v[56:59], a[188:191], v[180:183], v[56:59]
  v_add_f32 v123, v123, v227
  v_add_f32 v124, v124, v228
  v_mfma_f32_16x16x32_bf16 v[60:63], a[192:195], v[180:183], v[60:63]
  v_add_f32 v125, v125, v229
  v_add_f32 v126, v126, v230
  v_mfma_f32_16x16x32_bf16 v[64:67], a[196:199], v[180:183], v[64:67]
  v_add_f32 v127, v127, v231
  s_waitcnt vmcnt(7)
  v_mfma_f32_16x16x32_bf16 v[68:71], a[0:3], v[184:187], v[108:111]
  s_add_u32 s19, s19, 4096
  buffer_load_dwordx4 v[152:155], v2, s[60:63], s19 offen offset:0 sc1
  v_mfma_f32_16x16x32_bf16 v[72:75], a[4:7], v[184:187], v[112:115]
  v_mfma_f32_16x16x32_bf16 v[76:79], a[8:11], v[184:187], v[116:119]
  v_mfma_f32_16x16x32_bf16 v[80:83], a[12:15], v[184:187], v[120:123]
  v_mfma_f32_16x16x32_bf16 v[84:87], a[16:19], v[184:187], v[124:127]
  s_waitcnt vmcnt(7)
  v_mfma_f32_16x16x32_bf16 v[68:71], a[20:23], v[188:191], v[68:71]
  ds_write_b128 v46, v[48:51] offset:0
  v_mfma_f32_16x16x32_bf16 v[72:75], a[24:27], v[188:191], v[72:75]
  ds_write_b128 v46, v[52:55] offset:1024
  v_mfma_f32_16x16x32_bf16 v[76:79], a[28:31], v[188:191], v[76:79]
  buffer_load_dwordx4 v[156:159], v2, s[60:63], s19 offen offset:1024 sc1
  v_mfma_f32_16x16x32_bf16 v[80:83], a[32:35], v[188:191], v[80:83]
  v_mfma_f32_16x16x32_bf16 v[84:87], a[36:39], v[188:191], v[84:87]
  s_waitcnt vmcnt(7)
  v_mfma_f32_16x16x32_bf16 v[68:71], a[40:43], v[128:131], v[68:71]
  ds_write_b128 v46, v[56:59] offset:2048
  v_mfma_f32_16x16x32_bf16 v[72:75], a[44:47], v[128:131], v[72:75]
  ds_write_b128 v46, v[60:63] offset:3072
  v_mfma_f32_16x16x32_bf16 v[76:79], a[48:51], v[128:131], v[76:79]
  s_add_u32 m0, s95, 0
  s_nop 0
  buffer_load_dwordx4 v252, s[52:55], s93 offen sc1 lds
  s_add_u32 s93, s93, 65536
  v_mfma_f32_16x16x32_bf16 v[80:83], a[52:55], v[128:131], v[80:83]
  s_add_u32 m0, s95, 1024
  s_nop 0
  buffer_load_dwordx4 v252, s[52:55], s93 offen sc1 lds
  s_add_u32 s93, s93, 65536
  v_mfma_f32_16x16x32_bf16 v[84:87], a[56:59], v[128:131], v[84:87]
  s_add_u32 m0, s95, 2048
  s_bitcmp1_b32 s7, 0
  s_cselect_b32 s93, 1879048192, s93
  s_cselect_b32 m0, 163840, m0
  s_nop 0
  buffer_load_dwordx4 v252, s[52:55], s93 offen sc1 lds
  s_add_u32 s93, s93, 65536
  s_waitcnt vmcnt(9)
  v_mfma_f32_16x16x32_bf16 v[68:71], a[60:63], v[132:135], v[68:71]
  ds_write_b128 v46, v[64:67] offset:4096
  v_mfma_f32_16x16x32_bf16 v[72:75], a[64:67], v[132:135], v[72:75]
  v_add_u32_e64 v253, s94, v2
  v_mfma_f32_16x16x32_bf16 v[76:79], a[68:71], v[132:135], v[76:79]
  v_mfma_f32_16x16x32_bf16 v[80:83], a[72:75], v[132:135], v[80:83]
  v_mfma_f32_16x16x32_bf16 v[84:87], a[76:79], v[132:135], v[84:87]
  s_waitcnt vmcnt(8)
  v_mfma_f32_16x16x32_bf16 v[68:71], a[80:83], v[136:139], v[68:71]
  s_mul_i32 s15, s7, 5120
  v_mfma_f32_16x16x32_bf16 v[72:75], a[84:87], v[136:139], v[72:75]
  v_add_u32 v47, s15, v2
  v_mfma_f32_16x16x32_bf16 v[76:79], a[88:91], v[136:139], v[76:79]
  v_mfma_f32_16x16x32_bf16 v[80:83], a[92:95], v[136:139], v[80:83]
  v_mfma_f32_16x16x32_bf16 v[84:87], a[96:99], v[136:139], v[84:87]
  s_waitcnt vmcnt(7)
  v_mfma_f32_16x16x32_bf16 v[68:71], a[100:103], v[140:143], v[68:71]
  s_waitcnt lgkmcnt(0)
  s_barrier
  ds_read_b128 v[192:195], v47 offset:0
  v_mfma_f32_16x16x32_bf16 v[72:75], a[104:107], v[140:143], v[72:75]
  ds_read_b128 v[196:199], v47 offset:1024
  v_mfma_f32_16x16x32_bf16 v[76:79], a[108:111], v[140:143], v[76:79]
  ds_read_b128 v[200:203], v47 offset:2048
  v_mfma_f32_16x16x32_bf16 v[80:83], a[112:115], v[140:143], v[80:83]
  ds_read_b128 v[204:207], v47 offset:3072
  v_mfma_f32_16x16x32_bf16 v[84:87], a[116:119], v[140:143], v[84:87]
  ds_read_b128 v[208:211], v47 offset:4096
  s_waitcnt vmcnt(6)
  v_mfma_f32_16x16x32_bf16 v[68:71], a[120:123], v[144:147], v[68:71]
  s_lshr_b32 s88, s8, 0
  s_lshr_b32 s89, s8, 8
  v_mfma_f32_16x16x32_bf16 v[72:75], a[124:127], v[144:147], v[72:75]
  s_lshr_b32 s90, s8, 16
  s_lshr_b32 s91, s8, 24
  v_mfma_f32_16x16x32_bf16 v[76:79], a[128:131], v[144:147], v[76:79]
  v_mov_b32 v246, 0xff
  v_mfma_f32_16x16x32_bf16 v[80:83], a[132:135], v[144:147], v[80:83]
  v_accvgpr_read_b32 v244, a243
  v_mfma_f32_16x16x32_bf16 v[84:87], a[136:139], v[144:147], v[84:87]
  v_accvgpr_read_b32 v245, a244
  s_waitcnt vmcnt(5)
  v_mfma_f32_16x16x32_bf16 v[68:71], a[140:143], v[148:151], v[68:71]
  s_lshl_b32 s12, s5, 15
  s_lshl_b32 s13, s7, 9
  v_mfma_f32_16x16x32_bf16 v[72:75], a[144:147], v[148:151], v[72:75]
  s_add_u32 s12, s12, s13
  v_mfma_f32_16x16x32_bf16 v[76:79], a[148:151], v[148:151], v[76:79]
  s_add_u32 s12, s12, 1310720
  v_mfma_f32_16x16x32_bf16 v[80:83], a[152:155], v[148:151], v[80:83]
  s_lshl_b32 s13, s6, 12
  v_mfma_f32_16x16x32_bf16 v[84:87], a[156:159], v[148:151], v[84:87]
  s_add_u32 s13, s13, s12
  s_waitcnt vmcnt(4)
  v_mfma_f32_16x16x32_bf16 v[68:71], a[160:163], v[152:155], v[68:71]
  v_mfma_f32_16x16x32_bf16 v[72:75], a[164:167], v[152:155], v[72:75]
  v_mfma_f32_16x16x32_bf16 v[76:79], a[168:171], v[152:155], v[76:79]
  v_mfma_f32_16x16x32_bf16 v[80:83], a[172:175], v[152:155], v[80:83]
  v_mfma_f32_16x16x32_bf16 v[84:87], a[176:179], v[152:155], v[84:87]
  s_waitcnt vmcnt(3)
  v_mfma_f32_16x16x32_bf16 v[68:71], a[180:183], v[156:159], v[68:71]
  v_mfma_f32_16x16x32_bf16 v[72:75], a[184:187], v[156:159], v[72:75]
  v_mfma_f32_16x16x32_bf16 v[76:79], a[188:191], v[156:159], v[76:79]
  v_mfma_f32_16x16x32_bf16 v[80:83], a[192:195], v[156:159], v[80:83]
  v_mfma_f32_16x16x32_bf16 v[84:87], a[196:199], v[156:159], v[84:87]
  s_waitcnt lgkmcnt(0)
  s_waitcnt vmcnt(0)
  s_barrier
  ds_read_b64_tr_b16 v[232:233], v253 offset:0
  ds_read_b64_tr_b16 v[234:235], v253 offset:1024
  ds_read_b64_tr_b16 v[236:237], v253 offset:2048
  ds_read_b64_tr_b16 v[238:239], v253 offset:3072
  ds_read_b64_tr_b16 v[240:241], v253 offset:4096
  v_pk_add_f32 v[68:69], v[68:69], v[192:193]
  v_pk_add_f32 v[70:71], v[70:71], v[194:195]
  v_pk_add_f32 v[72:73], v[72:73], v[196:197]
  v_pk_add_f32 v[74:75], v[74:75], v[198:199]
  v_pk_add_f32 v[76:77], v[76:77], v[200:201]
  v_pk_add_f32 v[78:79], v[78:79], v[202:203]
  v_pk_add_f32 v[80:81], v[80:81], v[204:205]
  v_pk_add_f32 v[82:83], v[82:83], v[206:207]
  v_pk_add_f32 v[84:85], v[84:85], v[208:209]
  v_pk_add_f32 v[86:87], v[86:87], v[210:211]
  v_pk_add_f32 v[212:213], v[68:69], v[70:71]
  v_pk_mul_f32 v[214:215], v[68:69], v[68:69]
  v_pk_fma_f32 v[214:215], v[70:71], v[70:71], v[214:215]
  v_pk_add_f32 v[212:213], v[212:213], v[72:73]
  v_pk_fma_f32 v[214:215], v[72:73], v[72:73], v[214:215]
  v_pk_add_f32 v[212:213], v[212:213], v[74:75]
  v_pk_fma_f32 v[214:215], v[74:75], v[74:75], v[214:215]
  v_pk_add_f32 v[212:213], v[212:213], v[76:77]
  v_pk_fma_f32 v[214:215], v[76:77], v[76:77], v[214:215]
  v_pk_add_f32 v[212:213], v[212:213], v[78:79]
  v_pk_fma_f32 v[214:215], v[78:79], v[78:79], v[214:215]
  v_pk_add_f32 v[212:213], v[212:213], v[80:81]
  v_pk_fma_f32 v[214:215], v[80:81], v[80:81], v[214:215]
  v_pk_add_f32 v[212:213], v[212:213], v[82:83]
  v_pk_fma_f32 v[214:215], v[82:83], v[82:83], v[214:215]
  v_pk_add_f32 v[212:213], v[212:213], v[84:85]
  v_pk_fma_f32 v[214:215], v[84:85], v[84:85], v[214:215]
  v_pk_add_f32 v[212:213], v[212:213], v[86:87]
  v_pk_fma_f32 v[214:215], v[86:87], v[86:87], v[214:215]
redo_51:
  s_waitcnt lgkmcnt(4)
  v_lshlrev_b32_e64 v88, 16, v232
  v_and_b32 v89, 0xffff0000, v232
  v_lshlrev_b32_e64 v90, 16, v233
  v_and_b32 v91, 0xffff0000, v233
  s_add_u32 m0, s75, 0
  s_add_u32 s14, s74, 0
  buffer_load_dwordx4 v244, s[56:59], s14 offen lds
  buffer_load_dwordx4 v245, s[56:59], s14 offen offset:2048 lds
  v_pk_mul_f32 v[160:161], v[68:69], v[88:89]
  v_pk_mul_f32 v[226:227], v[88:89], v[88:89]
  v_pk_mul_f32 v[218:219], v[160:161], v[68:69]
  v_pk_mul_f32 v[220:221], v[160:161], v[160:161]
  v_pk_mul_f32 v[222:223], v[160:161], v[88:89]
  v_pk_mul_f32 v[162:163], v[70:71], v[90:91]
  v_pk_add_f32 v[224:225], v[88:89], v[90:91]
  v_pk_fma_f32 v[226:227], v[90:91], v[90:91], v[226:227]
  v_pk_add_f32 v[216:217], v[160:161], v[162:163]
  v_pk_fma_f32 v[218:219], v[162:163], v[70:71], v[218:219]
  v_pk_fma_f32 v[220:221], v[162:163], v[162:163], v[220:221]
  v_pk_fma_f32 v[222:223], v[162:163], v[90:91], v[222:223]
  s_waitcnt lgkmcnt(3)
  v_lshlrev_b32 v92, 16, v234
  v_and_b32 v93, 0xffff0000, v234
  v_lshlrev_b32_e64 v94, 16, v235
  v_and_b32 v95, 0xffff0000, v235
  v_pk_mul_f32 v[164:165], v[72:73], v[92:93]
  v_pk_add_f32 v[224:225], v[224:225], v[92:93]
  v_pk_fma_f32 v[226:227], v[92:93], v[92:93], v[226:227]
  v_pk_add_f32 v[216:217], v[216:217], v[164:165]
  v_pk_fma_f32 v[218:219], v[164:165], v[72:73], v[218:219]
  v_pk_fma_f32 v[220:221], v[164:165], v[164:165], v[220:221]
  v_pk_fma_f32 v[222:223], v[164:165], v[92:93], v[222:223]
  v_pk_mul_f32 v[166:167], v[74:75], v[94:95]
  v_pk_add_f32 v[224:225], v[224:225], v[94:95]
  v_pk_fma_f32 v[226:227], v[94:95], v[94:95], v[226:227]
  v_pk_add_f32 v[216:217], v[216:217], v[166:167]
  v_pk_fma_f32 v[218:219], v[166:167], v[74:75], v[218:219]
  v_pk_fma_f32 v[220:221], v[166:167], v[166:167], v[220:221]
  v_pk_fma_f32 v[222:223], v[166:167], v[94:95], v[222:223]
  s_waitcnt lgkmcnt(2)
  v_lshlrev_b32 v96, 16, v236
  v_and_b32 v97, 0xffff0000, v236
  v_lshlrev_b32_e64 v98, 16, v237
  v_and_b32 v99, 0xffff0000, v237
  s_add_u32 m0, s75, 4096
  s_add_u32 s14, s74, 20480
  buffer_load_dwordx4 v244, s[56:59], s14 offen lds
  buffer_load_dwordx4 v245, s[56:59], s14 offen offset:2048 lds
  v_pk_mul_f32 v[168:169], v[76:77], v[96:97]
  v_pk_add_f32 v[224:225], v[224:225], v[96:97]
  v_pk_fma_f32 v[226:227], v[96:97], v[96:97], v[226:227]
  v_pk_add_f32 v[216:217], v[216:217], v[168:169]
  v_pk_fma_f32 v[218:219], v[168:169], v[76:77], v[218:219]
  v_pk_fma_f32 v[220:221], v[168:169], v[168:169], v[220:221]
  v_pk_fma_f32 v[222:223], v[168:169], v[96:97], v[222:223]
  v_pk_mul_f32 v[170:171], v[78:79], v[98:99]
  v_pk_add_f32 v[224:225], v[224:225], v[98:99]
  v_pk_fma_f32 v[226:227], v[98:99], v[98:99], v[226:227]
  v_pk_add_f32 v[216:217], v[216:217], v[170:171]
  v_pk_fma_f32 v[218:219], v[170:171], v[78:79], v[218:219]
  v_pk_fma_f32 v[220:221], v[170:171], v[170:171], v[220:221]
  v_pk_fma_f32 v[222:223], v[170:171], v[98:99], v[222:223]
  s_waitcnt lgkmcnt(1)
  v_lshlrev_b32 v100, 16, v238
  v_and_b32 v101, 0xffff0000, v238
  v_lshlrev_b32_e64 v102, 16, v239
  v_and_b32 v103, 0xffff0000, v239
  v_pk_mul_f32 v[172:173], v[80:81], v[100:101]
  v_pk_add_f32 v[224:225], v[224:225], v[100:101]
  v_pk_fma_f32 v[226:227], v[100:101], v[100:101], v[226:227]
  v_pk_add_f32 v[216:217], v[216:217], v[172:173]
  v_pk_fma_f32 v[218:219], v[172:173], v[80:81], v[218:219]
  v_pk_fma_f32 v[220:221], v[172:173], v[172:173], v[220:221]
  v_pk_fma_f32 v[222:223], v[172:173], v[100:101], v[222:223]
  v_pk_mul_f32 v[174:175], v[82:83], v[102:103]
  v_pk_add_f32 v[224:225], v[224:225], v[102:103]
  v_pk_fma_f32 v[226:227], v[102:103], v[102:103], v[226:227]
  v_pk_add_f32 v[216:217], v[216:217], v[174:175]
  v_pk_fma_f32 v[218:219], v[174:175], v[82:83], v[218:219]
  v_pk_fma_f32 v[220:221], v[174:175], v[174:175], v[220:221]
  v_pk_fma_f32 v[222:223], v[174:175], v[102:103], v[222:223]
  s_waitcnt lgkmcnt(0)
  v_lshlrev_b32 v104, 16, v240
  v_and_b32 v105, 0xffff0000, v240
  v_lshlrev_b32_e64 v106, 16, v241
  v_and_b32 v107, 0xffff0000, v241
  s_add_u32 m0, s75, 8192
  s_add_u32 s14, s74, 40960
  buffer_load_dwordx4 v244, s[56:59], s14 offen lds
  v_pk_mul_f32 v[176:177], v[84:85], v[104:105]
  v_pk_add_f32 v[224:225], v[224:225], v[104:105]
  v_pk_fma_f32 v[226:227], v[104:105], v[104:105], v[226:227]
  v_pk_add_f32 v[216:217], v[216:217], v[176:177]
  v_pk_fma_f32 v[218:219], v[176:177], v[84:85], v[218:219]
  v_pk_fma_f32 v[220:221], v[176:177], v[176:177], v[220:221]
  v_pk_fma_f32 v[222:223], v[176:177], v[104:105], v[222:223]
  v_pk_mul_f32 v[178:179], v[86:87], v[106:107]
  v_pk_add_f32 v[224:225], v[224:225], v[106:107]
  v_pk_fma_f32 v[226:227], v[106:107], v[106:107], v[226:227]
  v_pk_add_f32 v[216:217], v[216:217], v[178:179]
  v_pk_fma_f32 v[218:219], v[178:179], v[86:87], v[218:219]
  v_pk_fma_f32 v[220:221], v[178:179], v[178:179], v[220:221]
  v_pk_fma_f32 v[222:223], v[178:179], v[106:107], v[222:223]
  v_cmp_u_f32 vcc, v224, v225
  s_cbranch_vccnz again_49
ok_50:
  v_add_f32 v212, v212, v213
  v_add_f32 v214, v214, v215
  v_add_f32 v216, v216, v217
  v_add_f32 v218, v218, v219
  v_add_f32 v220, v220, v221
  v_add_f32 v222, v222, v223
  v_add_f32 v224, v224, v225
  v_add_f32 v226, v226, v227
  v_permlane16_swap_b32 v212, v220
  v_permlane16_swap_b32 v214, v222
  v_permlane16_swap_b32 v216, v224
  v_permlane16_swap_b32 v218, v226
  v_add_f32 v228, v212, v220
  v_add_f32 v229, v214, v222
  v_add_f32 v230, v216, v224
  v_add_f32 v231, v218, v226
  v_mov_b32 v212, v228
  v_mov_b32 v213, v229
  v_mov_b32 v214, v230
  v_mov_b32 v215, v231
  v_permlane32_swap_b32 v228, v212
  v_permlane32_swap_b32 v229, v213
  v_permlane32_swap_b32 v230, v214
  v_permlane32_swap_b32 v231, v215
  v_add_f32 v228, v228, v212
  v_add_f32 v229, v229, v213
  v_add_f32 v230, v230, v214
  v_add_f32 v231, v231, v215
  v_bfi_b32 v228, v246, s88, v228
  v_bfi_b32 v229, v246, s89, v229
  v_bfi_b32 v230, v246, s90, v230
  v_bfi_b32 v231, v246, s91, v231
  s_mov_b32 exec_hi, 0
  s_cmp_eq_u32 s9, 0
  s_cbranch_scc1 slow_52
  buffer_store_dwordx4 v[228:231], v2, s[52:55], s13 offen
back_53:
  s_mov_b32 exec_hi, -1
  v_accvgpr_write_b32 a200, v232
  v_accvgpr_write_b32 a201, v233
  v_accvgpr_write_b32 a202, v234
  v_accvgpr_write_b32 a203, v235
  v_accvgpr_write_b32 a204, v236
  v_accvgpr_write_b32 a205, v237
  v_accvgpr_write_b32 a206, v238
  v_accvgpr_write_b32 a207, v239
  v_accvgpr_write_b32 a208, v240
  v_accvgpr_write_b32 a209, v241
  v_lshrrev_b32_e64 v11, 2, v3
  v_mul_u32_u24 v11, 5120, v11
  v_and_b32_e64 v12, 3, v3
  v_lshl_add_u32 v11, v12, 4, v11
  v_lshrrev_b32_e64 v12, 1, v4
  v_lshl_add_u32 v11, v12, 6, v11
  v_and_b32_e64 v12, 1, v4
  v_lshl_add_u32 v47, v12, 3, v11
  s_lshl_b32 s88, s5, 3
  s_add_u32 s88, s88, s7
  s_mul_i32 s88, s88, 20480
  s_mul_i32 s14, s6, 640
  s_add_u32 s88, s88, s14
  s_add_u32 s88, s88, 0
  v_accvgpr_read_b32 v190, a230
  v_accvgpr_read_b32 v191, a231
  v_accvgpr_read_b32 v192, a232
  v_accvgpr_read_b32 v193, a233
  v_accvgpr_read_b32 v194, a234
  v_accvgpr_read_b32 v195, a235
  v_accvgpr_read_b32 v196, a236
  v_accvgpr_read_b32 v197, a237
  v_accvgpr_read_b32 v198, a238
  v_accvgpr_read_b32 v199, a239
  v_lshlrev_b32_e64 v108, 16, v190
  v_and_b32 v109, 0xffff0000, v190
  v_lshlrev_b32_e64 v110, 16, v191
  v_and_b32 v111, 0xffff0000, v191
  v_lshlrev_b32_e64 v112, 16, v192
  v_and_b32 v113, 0xffff0000, v192
  v_lshlrev_b32_e64 v114, 16, v193
  v_and_b32 v115, 0xffff0000, v193
  v_lshlrev_b32_e64 v116, 16, v194
  v_and_b32 v117, 0xffff0000, v194
  v_lshlrev_b32_e64 v118, 16, v195
  v_and_b32 v119, 0xffff0000, v195
  v_lshlrev_b32_e64 v120, 16, v196
  v_and_b32 v121, 0xffff0000, v196
  v_lshlrev_b32_e64 v122, 16, v197
  v_and_b32 v123, 0xffff0000, v197
  v_lshlrev_b32_e64 v124, 16, v198
  v_and_b32 v125, 0xffff0000, v198
  v_lshlrev_b32_e64 v126, 16, v199
  v_and_b32 v127, 0xffff0000, v199
  s_lshl_b32 s87, s3, 10
  s_lshr_b32 s13, s7, 1
  s_lshl_b32 s13, s13, 7
  s_add_u32 s87, s87, s13
  s_and_b32 s13, s7, 1
  s_lshl_b32 s13, s13, 3
  s_add_u32 s87, s87, s13
  s_add_u32 s87, s87, 4096
  v_and_b32 v46, 7, v1
  v_lshlrev_b32 v46, 4, v46
  s_lshl_b32 s34, s76, 1
  s_and_b32 s13, s7, 1
  s_mul_i32 s13, s13, 40960
  s_sub_u32 s34, s34, s13
  s_add_u32 s35, s34, 20480
  s_lshl_b32 s44, s5, 5
  s_lshl_b32 s13, s6, 2
  s_add_u32 s44, s44, s13
  s_add_u32 s44, s44, s7
  v_and_b32 v11, 31, v1
  v_lshlrev_b32 v11, 4, v11
  v_lshrrev_b32_e64 v12, 5, v1
  v_lshl_add_u32 v11, v12, 14, v11
  s_mov_b32 s14, 0x0c0c0400
  s_mov_b32 s15, 0x04000c0c
  s_add_u32 s89, s12, 4096
  s_add_u32 s90, s12, 8192
  s_add_u32 s91, s12, 12288
stpoll_54:
  buffer_load_dwordx4 v[128:131], v11, s[52:55], s12 offen sc1
  buffer_load_dwordx4 v[132:135], v11, s[52:55], s89 offen sc1
  buffer_load_dwordx4 v[136:139], v11, s[52:55], s90 offen sc1
  buffer_load_dwordx4 v[140:143], v11, s[52:55], s91 offen sc1
  s_waitcnt vmcnt(0)
  v_perm_b32 v212, v129, v128, s14
  v_perm_b32 v213, v131, v130, s15
  v_perm_b32 v214, v133, v132, s14
  v_perm_b32 v215, v135, v134, s15
  v_perm_b32 v216, v137, v136, s14
  v_perm_b32 v217, v139, v138, s15
  v_perm_b32 v218, v141, v140, s14
  v_perm_b32 v219, v143, v142, s15
  v_or_b32 v212, v212, v213
  v_or_b32 v214, v214, v215
  v_or_b32 v216, v216, v217
  v_or_b32_e64 v218, v218, v219
  v_min3_u32 v13, v212, v214, s8
  v_max3_u32 v14, v212, v214, s8
  v_min3_u32 v13, v13, v216, v218
  v_max3_u32 v14, v14, v216, v218
  v_cmp_ne_u32 vcc, v13, v14
  s_sub_u32 s10, s10, 1
  s_cmp_gt_i32 s10, 0
  s_cbranch_scc0 giveup_56
  s_cbranch_vccnz stpoll_54
giveup_56:
  v_pk_add_f32 v[128:129], v[128:129], v[132:133]
  v_pk_add_f32 v[136:137], v[136:137], v[140:141]
  v_pk_add_f32 v[130:131], v[130:131], v[134:135]
  v_pk_add_f32 v[138:139], v[138:139], v[142:143]
  v_pk_add_f32 v[128:129], v[128:129], v[136:137]
  v_pk_add_f32 v[130:131], v[130:131], v[138:139]
  v_mov_b32 v132, v128
  v_mov_b32 v133, v129
  v_mov_b32 v134, v130
  v_mov_b32 v135, v131
  v_permlane32_swap_b32 v128, v132
  v_permlane32_swap_b32 v129, v133
  v_permlane32_swap_b32 v130, v134
  v_permlane32_swap_b32 v131, v135
  v_add_f32 v212, v128, v132
  v_add_f32 v213, v129, v133
  v_add_f32 v214, v130, v134
  v_add_f32 v215, v131, v135
  v_mov_b32 v216, v212
  v_mov_b32 v217, v213
  v_mov_b32 v218, v214
  v_mov_b32 v219, v215
  v_permlane16_swap_b32 v212, v216
  v_permlane16_swap_b32 v213, v217
  v_permlane16_swap_b32 v214, v218
  v_permlane16_swap_b32 v215, v219
  v_mul_f32 v200, 0x3acccccd, v212
  v_mul_f32 v204, 0x3acccccd, v213
  v_fma_f32 v204, -v200, v200, v204
  v_max_f32 v204, 0, v204
  v_add_f32 v204, 0x3727c5ac, v204
  v_rsq_f32 v202, v204
  s_nop 0
  v_mul_f32_e64 v203, v200, v202
  v_fma_f32 v204, v202, v214, v212
  v_fma_f32 v204, -v203, v218, v204
  v_mul_f32_e64 v205, v202, v216
  v_fma_f32 v205, 2.0, v215, v205
  v_fma_f32 v205, v202, v205, v213
  v_fma_f32 v214, v202, v217, v214
  v_mul_f32_e64 v219, v203, v219
  v_fma_f32 v214, -2.0, v214, v219
  v_fma_f32 v205, v203, v214, v205
  v_mul_f32 v204, 0x3acccccd, v204
  v_mul_f32 v205, 0x3acccccd, v205
  v_fma_f32 v205, -v204, v204, v205
  v_max_f32_e64 v205, 0, v205
  v_add_f32 v205, 0x3727c5ac, v205
  v_rsq_f32 v206, v205
  s_nop 0
  v_mul_f32_e64 v207, v204, v206
  v_pk_fma_f32 v[160:161], v[68:69], v[202:203], v[202:203] op_sel:[0,0,1] op_sel_hi:[1,0,1] neg_lo:[0,0,1] neg_hi:[0,0,1]
  v_pk_fma_f32 v[162:163], v[70:71], v[202:203], v[202:203] op_sel:[0,0,1] op_sel_hi:[1,0,1] neg_lo:[0,0,1] neg_hi:[0,0,1]
  v_pk_fma_f32 v[164:165], v[72:73], v[202:203], v[202:203] op_sel:[0,0,1] op_sel_hi:[1,0,1] neg_lo:[0,0,1] neg_hi:[0,0,1]
  v_pk_fma_f32 v[166:167], v[74:75], v[202:203], v[202:203] op_sel:[0,0,1] op_sel_hi:[1,0,1] neg_lo:[0,0,1] neg_hi:[0,0,1]
  v_pk_fma_f32 v[168:169], v[76:77], v[202:203], v[202:203] op_sel:[0,0,1] op_sel_hi:[1,0,1] neg_lo:[0,0,1] neg_hi:[0,0,1]
  v_pk_fma_f32 v[170:171], v[78:79], v[202:203], v[202:203] op_sel:[0,0,1] op_sel_hi:[1,0,1] neg_lo:[0,0,1] neg_hi:[0,0,1]
  v_pk_fma_f32 v[172:173], v[80:81], v[202:203], v[202:203] op_sel:[0,0,1] op_sel_hi:[1,0,1] neg_lo:[0,0,1] neg_hi:[0,0,1]
  v_pk_fma_f32 v[174:175], v[82:83], v[202:203], v[202:203] op_sel:[0,0,1] op_sel_hi:[1,0,1] neg_lo:[0,0,1] neg_hi:[0,0,1]
  v_pk_fma_f32 v[176:177], v[84:85], v[202:203], v[202:203] op_sel:[0,0,1] op_sel_hi:[1,0,1] neg_lo:[0,0,1] neg_hi:[0,0,1]
  v_pk_fma_f32 v[178:179], v[86:87], v[202:203], v[202:203] op_sel:[0,0,1] op_sel_hi:[1,0,1] neg_lo:[0,0,1] neg_hi:[0,0,1]
  v_pk_fma_f32 v[68:69], v[160:161], v[88:89], v[68:69]
  v_pk_fma_f32 v[70:71], v[162:163], v[90:91], v[70:71]
  v_pk_fma_f32 v[72:73], v[164:165], v[92:93], v[72:73]
  v_pk_fma_f32 v[74:75], v[166:167], v[94:95], v[74:75]
  v_pk_fma_f32 v[76:77], v[168:169], v[96:97], v[76:77]
  v_pk_fma_f32 v[78:79], v[170:171], v[98:99], v[78:79]
  v_pk_fma_f32 v[80:81], v[172:173], v[100:101], v[80:81]
  v_pk_fma_f32 v[82:83], v[174:175], v[102:103], v[82:83]
  v_pk_fma_f32 v[84:85], v[176:177], v[104:105], v[84:85]
  v_pk_fma_f32 v[86:87], v[178:179], v[106:107], v[86:87]
  v_pk_fma_f32 v[160:161], v[68:69], v[206:207], v[206:207] op_sel:[0,0,1] op_sel_hi:[1,0,1] neg_lo:[0,0,1] neg_hi:[0,0,1]
  v_pk_fma_f32 v[162:163], v[70:71], v[206:207], v[206:207] op_sel:[0,0,1] op_sel_hi:[1,0,1] neg_lo:[0,0,1] neg_hi:[0,0,1]
  v_pk_fma_f32 v[164:165], v[72:73], v[206:207], v[206:207] op_sel:[0,0,1] op_sel_hi:[1,0,1] neg_lo:[0,0,1] neg_hi:[0,0,1]
  v_pk_fma_f32 v[166:167], v[74:75], v[206:207], v[206:207] op_sel:[0,0,1] op_sel_hi:[1,0,1] neg_lo:[0,0,1] neg_hi:[0,0,1]
  v_pk_fma_f32 v[168:169], v[76:77], v[206:207], v[206:207] op_sel:[0,0,1] op_sel_hi:[1,0,1] neg_lo:[0,0,1] neg_hi:[0,0,1]
  v_pk_fma_f32 v[170:171], v[78:79], v[206:207], v[206:207] op_sel:[0,0,1] op_sel_hi:[1,0,1] neg_lo:[0,0,1] neg_hi:[0,0,1]
  v_pk_fma_f32 v[172:173], v[80:81], v[206:207], v[206:207] op_sel:[0,0,1] op_sel_hi:[1,0,1] neg_lo:[0,0,1] neg_hi:[0,0,1]
  v_pk_fma_f32 v[174:175], v[82:83], v[206:207], v[206:207] op_sel:[0,0,1] op_sel_hi:[1,0,1] neg_lo:[0,0,1] neg_hi:[0,0,1]
  v_pk_fma_f32 v[176:177], v[84:85], v[206:207], v[206:207] op_sel:[0,0,1] op_sel_hi:[1,0,1] neg_lo:[0,0,1] neg_hi:[0,0,1]
  v_pk_fma_f32 v[178:179], v[86:87], v[206:207], v[206:207] op_sel:[0,0,1] op_sel_hi:[1,0,1] neg_lo:[0,0,1] neg_hi:[0,0,1]
  v_cvt_pk_bf16_f32 v180, v160, v161
  v_cvt_pk_bf16_f32 v181, v162, v163
  v_cvt_pk_bf16_f32 v182, v164, v165
  v_cvt_pk_bf16_f32 v183, v166, v167
  v_cvt_pk_bf16_f32 v184, v168, v169
  v_cvt_pk_bf16_f32 v185, v170, v171
  v_cvt_pk_bf16_f32 v186, v172, v173
  v_cvt_pk_bf16_f32 v187, v174, v175
  v_cvt_pk_bf16_f32 v188, v176, v177
  v_cvt_pk_bf16_f32 v189, v178, v179
  s_cmp_eq_u32 s9, 0
  s_cbranch_scc1 slow_57
  buffer_store_dwordx2 v[180:181], v47, s[60:63], s88 offen offset:0
  buffer_store_dwordx2 v[182:183], v47, s[60:63], s88 offen offset:128
  buffer_store_dwordx2 v[184:185], v47, s[60:63], s88 offen offset:256
  buffer_store_dwordx2 v[186:187], v47, s[60:63], s88 offen offset:384
  buffer_store_dwordx2 v[188:189], v47, s[60:63], s88 offen offset:512
back_58:
  v_pk_fma_f32 v[68:69], v[160:161], v[108:109], v[68:69]
  v_pk_fma_f32 v[70:71], v[162:163], v[110:111], v[70:71]
  v_pk_fma_f32 v[72:73], v[164:165], v[112:113], v[72:73]
  v_pk_fma_f32 v[74:75], v[166:167], v[114:115], v[74:75]
  v_pk_fma_f32 v[76:77], v[168:169], v[116:117], v[76:77]
  v_pk_fma_f32 v[78:79], v[170:171], v[118:119], v[78:79]
  v_pk_fma_f32 v[80:81], v[172:173], v[120:121], v[80:81]
  v_pk_fma_f32 v[82:83], v[174:175], v[122:123], v[82:83]
  v_pk_fma_f32 v[84:85], v[176:177], v[124:125], v[84:85]
  v_pk_fma_f32 v[86:87], v[178:179], v[126:127], v[86:87]
  v_accvgpr_write_b32 a210, v68
  v_accvgpr_write_b32 a211, v69
  v_accvgpr_write_b32 a212, v70
  v_accvgpr_write_b32 a213, v71
  v_accvgpr_write_b32 a214, v72
  v_accvgpr_write_b32 a215, v73
  v_accvgpr_write_b32 a216, v74
  v_accvgpr_write_b32 a217, v75
  v_accvgpr_write_b32 a218, v76
  v_accvgpr_write_b32 a219, v77
  v_accvgpr_write_b32 a220, v78
  v_accvgpr_write_b32 a221, v79
  v_accvgpr_write_b32 a222, v80
  v_accvgpr_write_b32 a223, v81
  v_accvgpr_write_b32 a224, v82
  v_accvgpr_write_b32 a225, v83
  v_accvgpr_write_b32 a226, v84
  v_accvgpr_write_b32 a227, v85
  v_accvgpr_write_b32 a228, v86
  v_accvgpr_write_b32 a229, v87
  s_add_u32 s13, s84, 4096
  s_waitcnt vmcnt(0)
  v_mov_b32 v15, s8
  s_mov_b64 exec, 1
  s_cmp_eq_u32 s9, 0
  s_cbranch_scc1 slow_59
  buffer_store_dword v15, off, s[52:55], s13
back_60:
  s_mov_b64 exec, -1
  s_cmp_lg_u32 s44, 992
  s_cbranch_scc1 skip_61
  v_mov_b32 v15, s8
  s_mov_b64 exec, 1
  buffer_store_dword v15, off, s[52:55], 0 sc1
  s_mov_b64 exec, -1
skip_61:
  ds_read_b128 v[88:91], v5 offset:20480
  ds_read_b128 v[92:95], v5 offset:22528
  ds_read_b128 v[96:99], v5 offset:24576
  ds_read_b128 v[100:103], v5 offset:26624
  ds_read_b128 v[104:107], v5 offset:28672
again_62:
  buffer_load_dwordx2 v[42:43], v46, s[52:55], s87 offen sc1
  s_sub_u32 s10, s10, 1
  s_cmp_gt_i32 s10, 0
  s_waitcnt vmcnt(0)
  v_xor_b32 v15, s8, v42
  v_xor_b32 v14, s8, v43
  v_or_b32 v15, v15, v14
  v_cmp_ne_u32 vcc, 0, v15
  s_cbranch_scc0 out_64
  s_cbranch_vccnz again_62
out_64:
ok_63:
  buffer_load_dwordx4 v[128:131], v0, s[60:63], s34 offen offset:1024 sc1
  buffer_load_dwordx4 v[132:135], v0, s[60:63], s35 offen offset:1024 sc1
  buffer_load_dwordx4 v[136:139], v0, s[60:63], s34 offen offset:1280 sc1
  buffer_load_dwordx4 v[140:143], v0, s[60:63], s35 offen offset:1280 sc1
  buffer_load_dwordx4 v[144:147], v0, s[60:63], s34 offen offset:1536 sc1
  buffer_load_dwordx4 v[148:151], v0, s[60:63], s35 offen offset:1536 sc1
  buffer_load_dwordx4 v[152:155], v0, s[60:63], s34 offen offset:1792 sc1
  buffer_load_dwordx4 v[156:159], v0, s[60:63], s35 offen offset:1792 sc1
  s_waitcnt vmcnt(6)
  s_waitcnt lgkmcnt(4)
  v_mfma_f32_16x16x32_bf16 v[48:51], v[128:131], v[88:91], 0
  ds_read_b128 v[108:111], v6 offset:20480
  v_mfma_f32_16x16x32_bf16 v[52:55], v[132:135], v[88:91], 0
  buffer_load_dwordx4 v[160:163], v0, s[60:63], s34 offen offset:2048 sc1
  s_waitcnt lgkmcnt(4)
  v_mfma_f32_16x16x32_bf16 v[56:59], v[128:131], v[92:95], 0
  ds_read_b128 v[112:115], v6 offset:22528
  v_mfma_f32_16x16x32_bf16 v[60:63], v[132:135], v[92:95], 0
  buffer_load_dwordx4 v[164:167], v0, s[60:63], s35 offen offset:2048 sc1
  s_waitcnt lgkmcnt(4)
  v_mfma_f32_16x16x32_bf16 v[64:67], v[128:131], v[96:99], 0
  ds_read_b128 v[116:119], v6 offset:24576
  v_mfma_f32_16x16x32_bf16 v[68:71], v[132:135], v[96:99], 0
  s_waitcnt lgkmcnt(4)
  v_mfma_f32_16x16x32_bf16 v[72:75], v[128:131], v[100:103], 0
  ds_read_b128 v[120:123], v6 offset:26624
  v_mfma_f32_16x16x32_bf16 v[76:79], v[132:135], v[100:103], 0
  s_waitcnt lgkmcnt(4)
  v_mfma_f32_16x16x32_bf16 v[80:83], v[128:131], v[104:107], 0
  ds_read_b128 v[124:127], v6 offset:28672
  v_mfma_f32_16x16x32_bf16 v[84:87], v[132:135], v[104:107], 0
  s_waitcnt vmcnt(6)
  s_waitcnt lgkmcnt(2)
  v_mfma_f32_16x16x32_bf16 v[48:51], v[136:139], v[108:111], v[48:51]
  ds_read_b128 v[88:91], v5 offset:30720
  v_mfma_f32_16x16x32_bf16 v[52:55], v[140:143], v[108:111], v[52:55]
  buffer_load_dwordx4 v[168:171], v0, s[60:63], s34 offen offset:2304 sc1
  v_mfma_f32_16x16x32_bf16 v[56:59], v[136:139], v[112:115], v[56:59]
  ds_read_b128 v[92:95], v5 offset:32768
  v_mfma_f32_16x16x32_bf16 v[60:63], v[140:143], v[112:115], v[60:63]
  buffer_load_dwordx4 v[172:175], v0, s[60:63], s35 offen offset:2304 sc1
  v_mfma_f32_16x16x32_bf16 v[64:67], v[136:139], v[116:119], v[64:67]
  ds_read_b128 v[96:99], v5 offset:34816
  v_mfma_f32_16x16x32_bf16 v[68:71], v[140:143], v[116:119], v[68:71]
  s_waitcnt lgkmcnt(3)
  v_mfma_f32_16x16x32_bf16 v[72:75], v[136:139], v[120:123], v[72:75]
  ds_read_b128 v[100:103], v5 offset:36864
  v_mfma_f32_16x16x32_bf16 v[76:79], v[140:143], v[120:123], v[76:79]
  v_mfma_f32_16x16x32_bf16 v[80:83], v[136:139], v[124:127], v[80:83]
  ds_read_b128 v[104:107], v5 offset:38912
  v_mfma_f32_16x16x32_bf16 v[84:87], v[140:143], v[124:127], v[84:87]
  s_waitcnt vmcnt(6)
  s_waitcnt lgkmcnt(2)
  v_mfma_f32_16x16x32_bf16 v[48:51], v[144:147], v[88:91], v[48:51]
  ds_read_b128 v[108:111], v6 offset:30720
  v_mfma_f32_16x16x32_bf16 v[52:55], v[148:151], v[88:91], v[52:55]
  buffer_load_dwordx4 v[176:179], v0, s[60:63], s34 offen offset:2560 sc1
  v_mfma_f32_16x16x32_bf16 v[56:59], v[144:147], v[92:95], v[56:59]
  ds_read_b128 v[112:115], v6 offset:32768
  v_mfma_f32_16x16x32_bf16 v[60:63], v[148:151], v[92:95], v[60:63]
  buffer_load_dwordx4 v[180:183], v0, s[60:63], s35 offen offset:2560 sc1
  v_mfma_f32_16x16x32_bf16 v[64:67], v[144:147], v[96:99], v[64:67]
  ds_read_b128 v[116:119], v6 offset:34816
  v_mfma_f32_16x16x32_bf16 v[68:71], v[148:151], v[96:99], v[68:71]
  s_waitcnt lgkmcnt(3)
  v_mfma_f32_16x16x32_bf16 v[72:75], v[144:147], v[100:103], v[72:75]
  ds_read_b128 v[120:123], v6 offset:36864
  v_mfma_f32_16x16x32_bf16 v[76:79], v[148:151], v[100:103], v[76:79]
  v_mfma_f32_16x16x32_bf16 v[80:83], v[144:147], v[104:107], v[80:83]
  ds_read_b128 v[124:127], v6 offset:38912
  v_mfma_f32_16x16x32_bf16 v[84:87], v[148:151], v[104:107], v[84:87]
  s_waitcnt vmcnt(6)
  s_waitcnt lgkmcnt(2)
  v_mfma_f32_16x16x32_bf16 v[48:51], v[152:155], v[108:111], v[48:51]
  ds_read_b128 v[88:91], v5 offset:40960
  v_mfma_f32_16x16x32_bf16 v[52:55], v[156:159], v[108:111], v[52:55]
  buffer_load_dwordx4 v[184:187], v0, s[60:63], s34 offen offset:2816 sc1
  v_mfma_f32_16x16x32_bf16 v[56:59], v[152:155], v[112:115], v[56:59]
  ds_read_b128 v[92:95], v5 offset:43008
  v_mfma_f32_16x16x32_bf16 v[60:63], v[156:159], v[112:115], v[60:63]
  buffer_load_dwordx4 v[188:191], v0, s[60:63], s35 offen offset:2816 sc1
  v_mfma_f32_16x16x32_bf16 v[64:67], v[152:155], v[116:119], v[64:67]
  ds_read_b128 v[96:99], v5 offset:45056
  v_mfma_f32_16x16x32_bf16 v[68:71], v[156:159], v[116:119], v[68:71]
  s_waitcnt lgkmcnt(3)
  v_mfma_f32_16x16x32_bf16 v[72:75], v[152:155], v[120:123], v[72:75]
  ds_read_b128 v[100:103], v5 offset:47104
  v_mfma_f32_16x16x32_bf16 v[76:79], v[156:159], v[120:123], v[76:79]
  v_mfma_f32_16x16x32_bf16 v[80:83], v[152:155], v[124:127], v[80:83]
  ds_read_b128 v[104:107], v5 offset:49152
  v_mfma_f32_16x16x32_bf16 v[84:87], v[156:159], v[124:127], v[84:87]
  s_waitcnt vmcnt(6)
  s_waitcnt lgkmcnt(2)
  v_mfma_f32_16x16x32_bf16 v[48:51], v[160:163], v[88:91], v[48:51]
  ds_read_b128 v[108:111], v6 offset:40960
  v_mfma_f32_16x16x32_bf16 v[52:55], v[164:167], v[88:91], v[52:55]
  buffer_load_dwordx4 v[128:131], v0, s[60:63], s34 offen offset:3072 sc1
  v_mfma_f32_16x16x32_bf16 v[56:59], v[160:163], v[92:95], v[56:59]
  ds_read_b128 v[112:115], v6 offset:43008
  v_mfma_f32_16x16x32_bf16 v[60:63], v[164:167], v[92:95], v[60:63]
  buffer_load_dwordx4 v[132:135], v0, s[60:63], s35 offen offset:3072 sc1
  v_mfma_f32_16x16x32_bf16 v[64:67], v[160:163], v[96:99], v[64:67]
  ds_read_b128 v[116:119], v6 offset:45056
  v_mfma_f32_16x16x32_bf16 v[68:71], v[164:167], v[96:99], v[68:71]
  s_waitcnt lgkmcnt(3)
  v_mfma_f32_16x16x32_bf16 v[72:75], v[160:163], v[100:103], v[72:75]
  ds_read_b128 v[120:123], v6 offset:47104
  v_mfma_f32_16x16x32_bf16 v[76:79], v[164:167], v[100:103], v[76:79]
  v_mfma_f32_16x16x32_bf16 v[80:83], v[160:163], v[104:107], v[80:83]
  ds_read_b128 v[124:127], v6 offset:49152
  v_mfma_f32_16x16x32_bf16 v[84:87], v[164:167], v[104:107], v[84:87]
  s_waitcnt vmcnt(6)
  s_waitcnt lgkmcnt(2)
  v_mfma_f32_16x16x32_bf16 v[48:51], v[168:171], v[108:111], v[48:51]
  ds_read_b128 v[88:91], v7 offset:0
  v_mfma_f32_16x16x32_bf16 v[52:55], v[172:175], v[108:111], v[52:55]
  buffer_load_dwordx4 v[136:139], v0, s[60:63], s34 offen offset:3328 sc1
  v_mfma_f32_16x16x32_bf16 v[56:59], v[168:171], v[112:115], v[56:59]
  ds_read_b128 v[92:95], v7 offset:2048
  v_mfma_f32_16x16x32_bf16 v[60:63], v[172:175], v[112:115], v[60:63]
  buffer_load_dwordx4 v[140:143], v0, s[60:63], s35 offen offset:3328 sc1
  v_mfma_f32_16x16x32_bf16 v[64:67], v[168:171], v[116:119], v[64:67]
  ds_read_b128 v[96:99], v7 offset:4096
  v_mfma_f32_16x16x32_bf16 v[68:71], v[172:175], v[116:119], v[68:71]
  s_waitcnt lgkmcnt(3)
  v_mfma_f32_16x16x32_bf16 v[72:75], v[168:171], v[120:123], v[72:75]
  ds_read_b128 v[100:103], v7 offset:6144
  v_mfma_f32_16x16x32_bf16 v[76:79], v[172:175], v[120:123], v[76:79]
  v_mfma_f32_16x16x32_bf16 v[80:83], v[168:171], v[124:127], v[80:83]
  ds_read_b128 v[104:107], v7 offset:8192
  v_mfma_f32_16x16x32_bf16 v[84:87], v[172:175], v[124:127], v[84:87]
  s_waitcnt vmcnt(6)
  s_waitcnt lgkmcnt(2)
  v_mfma_f32_16x16x32_bf16 v[48:51], v[176:179], v[88:91], v[48:51]
  ds_read_b128 v[108:111], v8 offset:0
  v_mfma_f32_16x16x32_bf16 v[52:55], v[180:183], v[88:91], v[52:55]
  buffer_load_dwordx4 v[144:147], v0, s[60:63], s34 offen offset:3584 sc1
  v_mfma_f32_16x16x32_bf16 v[56:59], v[176:179], v[92:95], v[56:59]
  ds_read_b128 v[112:115], v8 offset:2048
  v_mfma_f32_16x16x32_bf16 v[60:63], v[180:183], v[92:95], v[60:63]
  buffer_load_dwordx4 v[148:151], v0, s[60:63], s35 offen offset:3584 sc1
  v_mfma_f32_16x16x32_bf16 v[64:67], v[176:179], v[96:99], v[64:67]
  ds_read_b128 v[116:119], v8 offset:4096
  v_mfma_f32_16x16x32_bf16 v[68:71], v[180:183], v[96:99], v[68:71]
  s_waitcnt lgkmcnt(3)
  v_mfma_f32_16x16x32_bf16 v[72:75], v[176:179], v[100:103], v[72:75]
  ds_read_b128 v[120:123], v8 offset:6144
  v_mfma_f32_16x16x32_bf16 v[76:79], v[180:183], v[100:103], v[76:79]
  v_mfma_f32_16x16x32_bf16 v[80:83], v[176:179], v[104:107], v[80:83]
  ds_read_b128 v[124:127], v8 offset:8192
  v_mfma_f32_16x16x32_bf16 v[84:87], v[180:183], v[104:107], v[84:87]
  s_waitcnt vmcnt(6)
  s_waitcnt lgkmcnt(2)
  v_mfma_f32_16x16x32_bf16 v[48:51], v[184:187], v[108:111], v[48:51]
  ds_read_b128 v[88:91], v7 offset:10240
  v_mfma_f32_16x16x32_bf16 v[52:55], v[188:191], v[108:111], v[52:55]
  buffer_load_dwordx4 v[152:155], v0, s[60:63], s34 offen offset:3840 sc1
  v_mfma_f32_16x16x32_bf16 v[56:59], v[184:187], v[112:115], v[56:59]
  ds_read_b128 v[92:95], v7 offset:12288
  v_mfma_f32_16x16x32_bf16 v[60:63], v[188:191], v[112:115], v[60:63]
  buffer_load_dwordx4 v[156:159], v0, s[60:63], s35 offen offset:3840 sc1
  v_mfma_f32_16x16x32_bf16 v[64:67], v[184:187], v[116:119], v[64:67]
  ds_read_b128 v[96:99], v7 offset:14336
  v_mfma_f32_16x16x32_bf16 v[68:71], v[188:191], v[116:119], v[68:71]
  s_waitcnt lgkmcnt(3)
  v_mfma_f32_16x16x32_bf16 v[72:75], v[184:187], v[120:123], v[72:75]
  ds_read_b128 v[100:103], v7 offset:16384
  v_mfma_f32_16x16x32_bf16 v[76:79], v[188:191], v[120:123], v[76:79]
  v_mfma_f32_16x16x32_bf16 v[80:83], v[184:187], v[124:127], v[80:83]
  ds_read_b128 v[104:107], v7 offset:18432
  v_mfma_f32_16x16x32_bf16 v[84:87], v[188:191], v[124:127], v[84:87]
  s_waitcnt vmcnt(6)
  s_waitcnt lgkmcnt(2)
  v_mfma_f32_16x16x32_bf16 v[48:51], v[128:131], v[88:91], v[48:51]
  ds_read_b128 v[108:111], v8 offset:10240
  v_mfma_f32_16x16x32_bf16 v[52:55], v[132:135], v[88:91], v[52:55]
  s_add_u32 s34, s34, 4096
  buffer_load_dwordx4 v[160:163], v0, s[60:63], s34 offen offset:0 sc1
  v_mfma_f32_16x16x32_bf16 v[56:59], v[128:131], v[92:95], v[56:59]
  ds_read_b128 v[112:115], v8 offset:12288
  v_mfma_f32_16x16x32_bf16 v[60:63], v[132:135], v[92:95], v[60:63]
  s_add_u32 s35, s35, 4096
  buffer_load_dwordx4 v[164:167], v0, s[60:63], s35 offen offset:0 sc1
  v_mfma_f32_16x16x32_bf16 v[64:67], v[128:131], v[96:99], v[64:67]
  ds_read_b128 v[116:119], v8 offset:14336
  v_mfma_f32_16x16x32_bf16 v[68:71], v[132:135], v[96:99], v[68:71]
  s_waitcnt lgkmcnt(3)
  v_mfma_f32_16x16x32_bf16 v[72:75], v[128:131], v[100:103], v[72:75]
  ds_read_b128 v[120:123], v8 offset:16384
  v_mfma_f32_16x16x32_bf16 v[76:79], v[132:135], v[100:103], v[76:79]
  v_mfma_f32_16x16x32_bf16 v[80:83], v[128:131], v[104:107], v[80:83]
  ds_read_b128 v[124:127], v8 offset:18432
  v_mfma_f32_16x16x32_bf16 v[84:87], v[132:135], v[104:107], v[84:87]
  s_waitcnt vmcnt(6)
  s_waitcnt lgkmcnt(2)
  v_mfma_f32_16x16x32_bf16 v[48:51], v[136:139], v[108:111], v[48:51]
  ds_read_b128 v[88:91], v7 offset:20480
  v_mfma_f32_16x16x32_bf16 v[52:55], v[140:143], v[108:111], v[52:55]
  buffer_load_dwordx4 v[168:171], v0, s[60:63], s34 offen offset:256 sc1
  v_mfma_f32_16x16x32_bf16 v[56:59], v[136:139], v[112:115], v[56:59]
  ds_read_b128 v[92:95], v7 offset:22528
  v_mfma_f32_16x16x32_bf16 v[60:63], v[140:143], v[112:115], v[60:63]
  buffer_load_dwordx4 v[172:175], v0, s[60:63], s35 offen offset:256 sc1
  v_mfma_f32_16x16x32_bf16 v[64:67], v[136:139], v[116:119], v[64:67]
  ds_read_b128 v[96:99], v7 offset:24576
  v_mfma_f32_16x16x32_bf16 v[68:71], v[140:143], v[116:119], v[68:71]
  s_waitcnt lgkmcnt(3)
  v_mfma_f32_16x16x32_bf16 v[72:75], v[136:139], v[120:123], v[72:75]
  ds_read_b128 v[100:103], v7 offset:26624
  v_mfma_f32_16x16x32_bf16 v[76:79], v[140:143], v[120:123], v[76:79]
  v_mfma_f32_16x16x32_bf16 v[80:83], v[136:139], v[124:127], v[80:83]
  ds_read_b128 v[104:107], v7 offset:28672
  v_mfma_f32_16x16x32_bf16 v[84:87], v[140:143], v[124:127], v[84:87]
  s_waitcnt vmcnt(6)
  s_waitcnt lgkmcnt(2)
  v_mfma_f32_16x16x32_bf16 v[48:51], v[144:147], v[88:91], v[48:51]
  ds_read_b128 v[108:111], v8 offset:20480
  v_mfma_f32_16x16x32_bf16 v[52:55], v[148:151], v[88:91], v[52:55]
  buffer_load_dwordx4 v[176:179], v0, s[60:63], s34 offen offset:512 sc1
  v_mfma_f32_16x16x32_bf16 v[56:59], v[144:147], v[92:95], v[56:59]
  ds_read_b128 v[112:115], v8 offset:22528
  v_mfma_f32_16x16x32_bf16 v[60:63], v[148:151], v[92:95], v[60:63]
  buffer_load_dwordx4 v[180:183], v0, s[60:63], s35 offen offset:512 sc1
  v_mfma_f32_16x16x32_bf16 v[64:67], v[144:147], v[96:99], v[64:67]
  ds_read_b128 v[116:119], v8 offset:24576
  v_mfma_f32_16x16x32_bf16 v[68:71], v[148:151], v[96:99], v[68:71]
  s_waitcnt lgkmcnt(3)
  v_mfma_f32_16x16x32_bf16 v[72:75], v[144:147], v[100:103], v[72:75]
  ds_read_b128 v[120:123], v8 offset:26624
  v_mfma_f32_16x16x32_bf16 v[76:79], v[148:151], v[100:103], v[76:79]
  v_mfma_f32_16x16x32_bf16 v[80:83], v[144:147], v[104:107], v[80:83]
  ds_read_b128 v[124:127], v8 offset:28672
  v_mfma_f32_16x16x32_bf16 v[84:87], v[148:151], v[104:107], v[84:87]
  s_waitcnt vmcnt(6)
  s_waitcnt lgkmcnt(2)
  v_mfma_f32_16x16x32_bf16 v[48:51], v[152:155], v[108:111], v[48:51]
  ds_read_b128 v[88:91], v7 offset:30720
  v_mfma_f32_16x16x32_bf16 v[52:55], v[156:159], v[108:111], v[52:55]
  buffer_load_dwordx4 v[184:187], v0, s[60:63], s34 offen offset:768 sc1
  v_mfma_f32_16x16x32_bf16 v[56:59], v[152:155], v[112:115], v[56:59]
  ds_read_b128 v[92:95], v7 offset:32768
  v_mfma_f32_16x16x32_bf16 v[60:63], v[156:159], v[112:115], v[60:63]
  buffer_load_dwordx4 v[188:191], v0, s[60:63], s35 offen offset:768 sc1
  v_mfma_f32_16x16x32_bf16 v[64:67], v[152:155], v[116:119], v[64:67]
  ds_read_b128 v[96:99], v7 offset:34816
  v_mfma_f32_16x16x32_bf16 v[68:71], v[156:159], v[116:119], v[68:71]
  s_waitcnt lgkmcnt(3)
  v_mfma_f32_16x16x32_bf16 v[72:75], v[152:155], v[120:123], v[72:75]
  ds_read_b128 v[100:103], v7 offset:36864
  v_mfma_f32_16x16x32_bf16 v[76:79], v[156:159], v[120:123], v[76:79]
  v_mfma_f32_16x16x32_bf16 v[80:83], v[152:155], v[124:127], v[80:83]
  ds_read_b128 v[104:107], v7 offset:38912
  v_mfma_f32_16x16x32_bf16 v[84:87], v[156:159], v[124:127], v[84:87]
  s_waitcnt vmcnt(6)
  s_waitcnt lgkmcnt(2)
  v_mfma_f32_16x16x32_bf16 v[48:51], v[160:163], v[88:91], v[48:51]
  ds_read_b128 v[108:111], v8 offset:30720
  v_mfma_f32_16x16x32_bf16 v[52:55], v[164:167], v[88:91], v[52:55]
  s_sub_u32 s34, s34, 4096
  buffer_load_dwordx4 v[128:131], v0, s[60:63], s34 offen offset:0 sc1
  v_mfma_f32_16x16x32_bf16 v[56:59], v[160:163], v[92:95], v[56:59]
  ds_read_b128 v[112:115], v8 offset:32768
  v_mfma_f32_16x16x32_bf16 v[60:63], v[164:167], v[92:95], v[60:63]
  s_sub_u32 s35, s35, 4096
  buffer_load_dwordx4 v[132:135], v0, s[60:63], s35 offen offset:0 sc1
  v_mfma_f32_16x16x32_bf16 v[64:67], v[160:163], v[96:99], v[64:67]
  ds_read_b128 v[116:119], v8 offset:34816
  v_mfma_f32_16x16x32_bf16 v[68:71], v[164:167], v[96:99], v[68:71]
  s_waitcnt lgkmcnt(3)
  v_mfma_f32_16x16x32_bf16 v[72:75], v[160:163], v[100:103], v[72:75]
  ds_read_b128 v[120:123], v8 offset:36864
  v_mfma_f32_16x16x32_bf16 v[76:79], v[164:167], v[100:103], v[76:79]
  v_mfma_f32_16x16x32_bf16 v[80:83], v[160:163], v[104:107], v[80:83]
  ds_read_b128 v[124:127], v8 offset:38912
  v_mfma_f32_16x16x32_bf16 v[84:87], v[164:167], v[104:107], v[84:87]
  s_waitcnt vmcnt(6)
  s_waitcnt lgkmcnt(2)
  v_mfma_f32_16x16x32_bf16 v[48:51], v[168:171], v[108:111], v[48:51]
  ds_read_b128 v[88:91], v7 offset:40960
  v_mfma_f32_16x16x32_bf16 v[52:55], v[172:175], v[108:111], v[52:55]
  buffer_load_dwordx4 v[136:139], v0, s[60:63], s34 offen offset:256 sc1
  v_mfma_f32_16x16x32_bf16 v[56:59], v[168:171], v[112:115], v[56:59]
  ds_read_b128 v[92:95], v7 offset:43008
  v_mfma_f32_16x16x32_bf16 v[60:63], v[172:175], v[112:115], v[60:63]
  buffer_load_dwordx4 v[140:143], v0, s[60:63], s35 offen offset:256 sc1
  v_mfma_f32_16x16x32_bf16 v[64:67], v[168:171], v[116:119], v[64:67]
  ds_read_b128 v[96:99], v7 offset:45056
  v_mfma_f32_16x16x32_bf16 v[68:71], v[172:175], v[116:119], v[68:71]
  s_waitcnt lgkmcnt(3)
  v_mfma_f32_16x16x32_bf16 v[72:75], v[168:171], v[120:123], v[72:75]
  ds_read_b128 v[100:103], v7 offset:47104
  v_mfma_f32_16x16x32_bf16 v[76:79], v[172:175], v[120:123], v[76:79]
  v_mfma_f32_16x16x32_bf16 v[80:83], v[168:171], v[124:127], v[80:83]
  ds_read_b128 v[104:107], v7 offset:49152
  v_mfma_f32_16x16x32_bf16 v[84:87], v[172:175], v[124:127], v[84:87]
  s_waitcnt vmcnt(6)
  s_waitcnt lgkmcnt(2)
  v_mfma_f32_16x16x32_bf16 v[48:51], v[176:179], v[88:91], v[48:51]
  ds_read_b128 v[108:111], v8 offset:40960
  v_mfma_f32_16x16x32_bf16 v[52:55], v[180:183], v[88:91], v[52:55]
  buffer_load_dwordx4 v[144:147], v0, s[60:63], s34 offen offset:512 sc1
  v_mfma_f32_16x16x32_bf16 v[56:59], v[176:179], v[92:95], v[56:59]
  ds_read_b128 v[112:115], v8 offset:43008
  v_mfma_f32_16x16x32_bf16 v[60:63], v[180:183], v[92:95], v[60:63]
  buffer_load_dwordx4 v[148:151], v0, s[60:63], s35 offen offset:512 sc1
  v_mfma_f32_16x16x32_bf16 v[64:67], v[176:179], v[96:99], v[64:67]
  ds_read_b128 v[116:119], v8 offset:45056
  v_mfma_f32_16x16x32_bf16 v[68:71], v[180:183], v[96:99], v[68:71]
  s_waitcnt lgkmcnt(3)
  v_mfma_f32_16x16x32_bf16 v[72:75], v[176:179], v[100:103], v[72:75]
  ds_read_b128 v[120:123], v8 offset:47104
  v_mfma_f32_16x16x32_bf16 v[76:79], v[180:183], v[100:103], v[76:79]
  v_mfma_f32_16x16x32_bf16 v[80:83], v[176:179], v[104:107], v[80:83]
  ds_read_b128 v[124:127], v8 offset:49152
  v_mfma_f32_16x16x32_bf16 v[84:87], v[180:183], v[104:107], v[84:87]
  s_waitcnt vmcnt(6)
  s_barrier
  s_waitcnt lgkmcnt(2)
  v_mfma_f32_16x16x32_bf16 v[48:51], v[184:187], v[108:111], v[48:51]
  ds_read_b128 v[88:91], v5 offset:0
  v_mfma_f32_16x16x32_bf16 v[52:55], v[188:191], v[108:111], v[52:55]
  buffer_load_dwordx4 v[152:155], v0, s[60:63], s34 offen offset:768 sc1
  v_mfma_f32_16x16x32_bf16 v[56:59], v[184:187], v[112:115], v[56:59]
  ds_read_b128 v[92:95], v5 offset:2048
  v_mfma_f32_16x16x32_bf16 v[60:63], v[188:191], v[112:115], v[60:63]
  buffer_load_dwordx4 v[156:159], v0, s[60:63], s35 offen offset:768 sc1
  v_mfma_f32_16x16x32_bf16 v[64:67], v[184:187], v[116:119], v[64:67]
  ds_read_b128 v[96:99], v5 offset:4096
  v_mfma_f32_16x16x32_bf16 v[68:71], v[188:191], v[116:119], v[68:71]
  s_waitcnt lgkmcnt(3)
  v_mfma_f32_16x16x32_bf16 v[72:75], v[184:187], v[120:123], v[72:75]
  ds_read_b128 v[100:103], v5 offset:6144
  v_mfma_f32_16x16x32_bf16 v[76:79], v[188:191], v[120:123], v[76:79]
  v_mfma_f32_16x16x32_bf16 v[80:83], v[184:187], v[124:127], v[80:83]
  ds_read_b128 v[104:107], v5 offset:8192
  v_mfma_f32_16x16x32_bf16 v[84:87], v[188:191], v[124:127], v[84:87]
  s_waitcnt vmcnt(6)
  s_waitcnt lgkmcnt(2)
  v_mfma_f32_16x16x32_bf16 v[48:51], v[128:131], v[88:91], v[48:51]
  ds_read_b128 v[108:111], v6 offset:0
  v_mfma_f32_16x16x32_bf16 v[52:55], v[132:135], v[88:91], v[52:55]
  v_mfma_f32_16x16x32_bf16 v[56:59], v[128:131], v[92:95], v[56:59]
  ds_read_b128 v[112:115], v6 offset:2048
  v_mfma_f32_16x16x32_bf16 v[60:63], v[132:135], v[92:95], v[60:63]
  v_mfma_f32_16x16x32_bf16 v[64:67], v[128:131], v[96:99], v[64:67]
  ds_read_b128 v[116:119], v6 offset:4096
  v_mfma_f32_16x16x32_bf16 v[68:71], v[132:135], v[96:99], v[68:71]
  s_waitcnt lgkmcnt(3)
  v_mfma_f32_16x16x32_bf16 v[72:75], v[128:131], v[100:103], v[72:75]
  ds_read_b128 v[120:123], v6 offset:6144
  v_mfma_f32_16x16x32_bf16 v[76:79], v[132:135], v[100:103], v[76:79]
  v_mfma_f32_16x16x32_bf16 v[80:83], v[128:131], v[104:107], v[80:83]
  ds_read_b128 v[124:127], v6 offset:8192
  v_mfma_f32_16x16x32_bf16 v[84:87], v[132:135], v[104:107], v[84:87]
  s_waitcnt vmcnt(4)
  s_waitcnt lgkmcnt(2)
  v_mfma_f32_16x16x32_bf16 v[48:51], v[136:139], v[108:111], v[48:51]
  ds_read_b128 v[88:91], v5 offset:10240
  v_mfma_f32_16x16x32_bf16 v[52:55], v[140:143], v[108:111], v[52:55]
  v_accvgpr_read_b32 v11, a245
  s_mov_b32 exec_lo, s96
  s_mov_b32 exec_hi, 0
  buffer_load_dword a250, v11, s[52:55], 0 offen
  s_mov_b64 exec, -1
  v_mfma_f32_16x16x32_bf16 v[56:59], v[136:139], v[112:115], v[56:59]
  ds_read_b128 v[92:95], v5 offset:12288
  v_mfma_f32_16x16x32_bf16 v[60:63], v[140:143], v[112:115], v[60:63]
  v_mfma_f32_16x16x32_bf16 v[64:67], v[136:139], v[116:119], v[64:67]
  ds_read_b128 v[96:99], v5 offset:14336
  v_mfma_f32_16x16x32_bf16 v[68:71], v[140:143], v[116:119], v[68:71]
  s_waitcnt lgkmcnt(3)
  v_mfma_f32_16x16x32_bf16 v[72:75], v[136:139], v[120:123], v[72:75]
  ds_read_b128 v[100:103], v5 offset:16384
  v_mfma_f32_16x16x32_bf16 v[76:79], v[140:143], v[120:123], v[76:79]
  v_mfma_f32_16x16x32_bf16 v[80:83], v[136:139], v[124:127], v[80:83]
  ds_read_b128 v[104:107], v5 offset:18432
  v_mfma_f32_16x16x32_bf16 v[84:87], v[140:143], v[124:127], v[84:87]
  s_waitcnt vmcnt(2)
  s_waitcnt lgkmcnt(2)
  v_mfma_f32_16x16x32_bf16 v[48:51], v[144:147], v[88:91], v[48:51]
  ds_read_b128 v[108:111], v6 offset:10240
  v_mfma_f32_16x16x32_bf16 v[52:55], v[148:151], v[88:91], v[52:55]
  v_mfma_f32_16x16x32_bf16 v[56:59], v[144:147], v[92:95], v[56:59]
  ds_read_b128 v[112:115], v6 offset:12288
  v_mfma_f32_16x16x32_bf16 v[60:63], v[148:151], v[92:95], v[60:63]
  v_mfma_f32_16x16x32_bf16 v[64:67], v[144:147], v[96:99], v[64:67]
  ds_read_b128 v[116:119], v6 offset:14336
  v_mfma_f32_16x16x32_bf16 v[68:71], v[148:151], v[96:99], v[68:71]
  s_waitcnt lgkmcnt(3)
  v_mfma_f32_16x16x32_bf16 v[72:75], v[144:147], v[100:103], v[72:75]
  ds_read_b128 v[120:123], v6 offset:16384
  v_mfma_f32_16x16x32_bf16 v[76:79], v[148:151], v[100:103], v[76:79]
  v_mfma_f32_16x16x32_bf16 v[80:83], v[144:147], v[104:107], v[80:83]
  ds_read_b128 v[124:127], v6 offset:18432
  v_mfma_f32_16x16x32_bf16 v[84:87], v[148:151], v[104:107], v[84:87]
  s_waitcnt vmcnt(0)
  s_waitcnt lgkmcnt(2)
  v_mfma_f32_16x16x32_bf16 v[48:51], v[152:155], v[108:111], v[48:51]
  v_mfma_f32_16x16x32_bf16 v[52:55], v[156:159], v[108:111], v[52:55]
  s_add_u32 s12, s84, 4864
  v_mov_b32 v15, s8
  s_mov_b64 exec, 1
  s_cmp_eq_u32 s9, 0
  s_cbranch_scc1 slow_65
  buffer_store_dword v15, off, s[52:55], s12
back_66:
  s_mov_b64 exec, -1
  v_mfma_f32_16x16x32_bf16 v[56:59], v[152:155], v[112:115], v[56:59]
  v_mfma_f32_16x16x32_bf16 v[60:63], v[156:159], v[112:115], v[60:63]
  v_mfma_f32_16x16x32_bf16 v[64:67], v[152:155], v[116:119], v[64:67]
  v_mfma_f32_16x16x32_bf16 v[68:71], v[156:159], v[116:119], v[68:71]
  s_waitcnt lgkmcnt(0)
  v_mfma_f32_16x16x32_bf16 v[72:75], v[152:155], v[120:123], v[72:75]
  v_mfma_f32_16x16x32_bf16 v[76:79], v[156:159], v[120:123], v[76:79]
  v_mfma_f32_16x16x32_bf16 v[80:83], v[152:155], v[124:127], v[80:83]
  v_mfma_f32_16x16x32_bf16 v[84:87], v[156:159], v[124:127], v[84:87]
  v_fmac_f32 v49, v16, v48
  v_fmac_f32 v57, v17, v56
  v_fmac_f32 v65, v18, v64
  s_nop 1
  v_fmac_f32 v73, v19, v72
  s_nop 0
  v_fmac_f32 v81, v20, v80
  v_fmac_f32_dpp v49, v48, v21 quad_perm:[1,0,3,2] row_mask:0xf bank_mask:0xf
  v_fmac_f32_dpp v57, v56, v22 quad_perm:[1,0,3,2] row_mask:0xf bank_mask:0xf
  v_fmac_f32_dpp v65, v64, v23 quad_perm:[1,0,3,2] row_mask:0xf bank_mask:0xf
  v_fmac_f32_dpp v73, v72, v24 quad_perm:[1,0,3,2] row_mask:0xf bank_mask:0xf
  v_fmac_f32_dpp v81, v80, v25 quad_perm:[1,0,3,2] row_mask:0xf bank_mask:0xf
  v_fmac_f32 v50, v16, v49
  v_fmac_f32 v58, v17, v57
  v_fmac_f32 v66, v18, v65
  v_fmac_f32 v74, v19, v73
  v_fmac_f32_e64 v82, v20, v81
  v_fmac_f32_dpp v50, v49, v21 quad_perm:[1,0,3,2] row_mask:0xf bank_mask:0xf
  v_fmac_f32_dpp v58, v57, v22 quad_perm:[1,0,3,2] row_mask:0xf bank_mask:0xf
  v_fmac_f32_dpp v66, v65, v23 quad_perm:[1,0,3,2] row_mask:0xf bank_mask:0xf
  v_fmac_f32_dpp v74, v73, v24 quad_perm:[1,0,3,2] row_mask:0xf bank_mask:0xf
  v_fmac_f32_dpp v82, v81, v25 quad_perm:[1,0,3,2] row_mask:0xf bank_mask:0xf
  v_fmac_f32 v51, v16, v50
  v_fmac_f32 v59, v17, v58
  v_fmac_f32 v67, v18, v66
  v_fmac_f32 v75, v19, v74
  v_fmac_f32_e64 v83, v20, v82
  v_fmac_f32_dpp v51, v50, v21 quad_perm:[1,0,3,2] row_mask:0xf bank_mask:0xf
  v_fmac_f32_dpp v59, v58, v22 quad_perm:[1,0,3,2] row_mask:0xf bank_mask:0xf
  v_fmac_f32_dpp v67, v66, v23 quad_perm:[1,0,3,2] row_mask:0xf bank_mask:0xf
  v_fmac_f32_dpp v75, v74, v24 quad_perm:[1,0,3,2] row_mask:0xf bank_mask:0xf
  v_fmac_f32_dpp v83, v82, v25 quad_perm:[1,0,3,2] row_mask:0xf bank_mask:0xf
  v_fmac_f32 v52, v16, v51
  v_fmac_f32 v60, v17, v59
  v_fmac_f32 v68, v18, v67
  v_fmac_f32 v76, v19, v75
  v_fmac_f32_e64 v84, v20, v83
  v_fmac_f32_dpp v52, v51, v21 quad_perm:[1,0,3,2] row_mask:0xf bank_mask:0xf
  v_fmac_f32_dpp v60, v59, v22 quad_perm:[1,0,3,2] row_mask:0xf bank_mask:0xf
  v_fmac_f32_dpp v68, v67, v23 quad_perm:[1,0,3,2] row_mask:0xf bank_mask:0xf
  v_fmac_f32_dpp v76, v75, v24 quad_perm:[1,0,3,2] row_mask:0xf bank_mask:0xf
  v_fmac_f32_dpp v84, v83, v25 quad_perm:[1,0,3,2] row_mask:0xf bank_mask:0xf
  v_fmac_f32 v53, v16, v52
  v_fmac_f32 v61, v17, v60
  v_fmac_f32 v69, v18, v68
  v_fmac_f32 v77, v19, v76
  v_fmac_f32_e64 v85, v20, v84
  v_fmac_f32_dpp v53, v52, v21 quad_perm:[1,0,3,2] row_mask:0xf bank_mask:0xf
  v_fmac_f32_dpp v61, v60, v22 quad_perm:[1,0,3,2] row_mask:0xf bank_mask:0xf
  v_fmac_f32_dpp v69, v68, v23 quad_perm:[1,0,3,2] row_mask:0xf bank_mask:0xf
  v_fmac_f32_dpp v77, v76, v24 quad_perm:[1,0,3,2] row_mask:0xf bank_mask:0xf
  v_fmac_f32_dpp v85, v84, v25 quad_perm:[1,0,3,2] row_mask:0xf bank_mask:0xf
  v_fmac_f32 v54, v16, v53
  v_fmac_f32 v62, v17, v61
  v_fmac_f32 v70, v18, v69
  v_fmac_f32 v78, v19, v77
  v_fmac_f32_e64 v86, v20, v85
  v_fmac_f32_dpp v54, v53, v21 quad_perm:[1,0,3,2] row_mask:0xf bank_mask:0xf
  v_fmac_f32_dpp v62, v61, v22 quad_perm:[1,0,3,2] row_mask:0xf bank_mask:0xf
  v_fmac_f32_dpp v70, v69, v23 quad_perm:[1,0,3,2] row_mask:0xf bank_mask:0xf
  v_fmac_f32_dpp v78, v77, v24 quad_perm:[1,0,3,2] row_mask:0xf bank_mask:0xf
  v_fmac_f32_dpp v86, v85, v25 quad_perm:[1,0,3,2] row_mask:0xf bank_mask:0xf
  v_fmac_f32 v55, v16, v54
  v_fmac_f32 v63, v17, v62
  v_fmac_f32 v71, v18, v70
  v_fmac_f32 v79, v19, v78
  v_fmac_f32_e64 v87, v20, v86
  v_fmac_f32_dpp v55, v54, v21 quad_perm:[1,0,3,2] row_mask:0xf bank_mask:0xf
  v_fmac_f32_dpp v63, v62, v22 quad_perm:[1,0,3,2] row_mask:0xf bank_mask:0xf
  v_fmac_f32_dpp v71, v70, v23 quad_perm:[1,0,3,2] row_mask:0xf bank_mask:0xf
  v_fmac_f32_dpp v79, v78, v24 quad_perm:[1,0,3,2] row_mask:0xf bank_mask:0xf
  v_fmac_f32_dpp v87, v86, v25 quad_perm:[1,0,3,2] row_mask:0xf bank_mask:0xf
  v_add_u32 v11, 152320, v9
  v_min_u32 v12, 39, v1
  v_mul_u32_u24 v44, 48, v12
  s_lshl_b32 s12, s7, 3
  s_add_u32 s12, s12, 149504
  v_add_u32 v44, s12, v44
  ds_write_b32 v11, v55 offset:0
  ds_write_b32 v11, v63 offset:1152
  ds_write_b32 v11, v71 offset:2304
  ds_write_b32 v11, v79 offset:3456
  ds_write_b32 v11, v87 offset:4608
  v_mul_u32_u24 v46, 144, v12
  v_add_u32 v46, 152320, v46
  s_waitcnt lgkmcnt(0)
  s_barrier
  ds_read_b128 v[90:93], v46 offset:0
  ds_read_b128 v[94:97], v46 offset:16
  ds_read_b128 v[98:101], v46 offset:32
  ds_read_b128 v[102:105], v46 offset:48
  ds_read_b128 v[106:109], v46 offset:64
  ds_read_b128 v[110:113], v46 offset:80
  ds_read_b128 v[114:117], v46 offset:96
  ds_read_b128 v[118:121], v46 offset:112
  s_waitcnt lgkmcnt(7)
  v_pk_fma_f32 v[92:93], v[90:91], v[36:37], v[92:93] op_sel:[1,1,0] op_sel_hi:[0,1,1] neg_lo:[0,1,0]
  v_pk_fma_f32 v[92:93], v[90:91], v[36:37], v[92:93] op_sel:[0,0,0] op_sel_hi:[1,0,1]
  s_waitcnt lgkmcnt(6)
  v_pk_fma_f32 v[94:95], v[92:93], v[36:37], v[94:95] op_sel:[1,1,0] op_sel_hi:[0,1,1] neg_lo:[0,1,0]
  v_pk_fma_f32 v[94:95], v[92:93], v[36:37], v[94:95] op_sel:[0,0,0] op_sel_hi:[1,0,1]
  v_pk_fma_f32 v[96:97], v[94:95], v[36:37], v[96:97] op_sel:[1,1,0] op_sel_hi:[0,1,1] neg_lo:[0,1,0]
  v_pk_fma_f32 v[96:97], v[94:95], v[36:37], v[96:97] op_sel:[0,0,0] op_sel_hi:[1,0,1]
  s_waitcnt lgkmcnt(5)
  v_pk_fma_f32 v[98:99], v[96:97], v[36:37], v[98:99] op_sel:[1,1,0] op_sel_hi:[0,1,1] neg_lo:[0,1,0]
  v_pk_fma_f32 v[98:99], v[96:97], v[36:37], v[98:99] op_sel:[0,0,0] op_sel_hi:[1,0,1]
  v_pk_fma_f32 v[100:101], v[98:99], v[36:37], v[100:101] op_sel:[1,1,0] op_sel_hi:[0,1,1] neg_lo:[0,1,0]
  v_pk_fma_f32 v[100:101], v[98:99], v[36:37], v[100:101] op_sel:[0,0,0] op_sel_hi:[1,0,1]
  s_waitcnt lgkmcnt(4)
  v_pk_fma_f32 v[102:103], v[100:101], v[36:37], v[102:103] op_sel:[1,1,0] op_sel_hi:[0,1,1] neg_lo:[0,1,0]
  v_pk_fma_f32 v[102:103], v[100:101], v[36:37], v[102:103] op_sel:[0,0,0] op_sel_hi:[1,0,1]
  v_pk_fma_f32 v[104:105], v[102:103], v[36:37], v[104:105] op_sel:[1,1,0] op_sel_hi:[0,1,1] neg_lo:[0,1,0]
  v_pk_fma_f32 v[104:105], v[102:103], v[36:37], v[104:105] op_sel:[0,0,0] op_sel_hi:[1,0,1]
  s_waitcnt lgkmcnt(3)
  v_pk_fma_f32 v[106:107], v[104:105], v[36:37], v[106:107] op_sel:[1,1,0] op_sel_hi:[0,1,1] neg_lo:[0,1,0]
  v_pk_fma_f32 v[106:107], v[104:105], v[36:37], v[106:107] op_sel:[0,0,0] op_sel_hi:[1,0,1]
  v_pk_fma_f32 v[108:109], v[106:107], v[36:37], v[108:109] op_sel:[1,1,0] op_sel_hi:[0,1,1] neg_lo:[0,1,0]
  v_pk_fma_f32 v[108:109], v[106:107], v[36:37], v[108:109] op_sel:[0,0,0] op_sel_hi:[1,0,1]
  s_waitcnt lgkmcnt(2)
  v_pk_fma_f32 v[110:111], v[108:109], v[36:37], v[110:111] op_sel:[1,1,0] op_sel_hi:[0,1,1] neg_lo:[0,1,0]
  v_pk_fma_f32 v[110:111], v[108:109], v[36:37], v[110:111] op_sel:[0,0,0] op_sel_hi:[1,0,1]
  v_pk_fma_f32 v[112:113], v[110:111], v[36:37], v[112:113] op_sel:[1,1,0] op_sel_hi:[0,1,1] neg_lo:[0,1,0]
  v_pk_fma_f32 v[112:113], v[110:111], v[36:37], v[112:113] op_sel:[0,0,0] op_sel_hi:[1,0,1]
  s_waitcnt lgkmcnt(1)
  v_pk_fma_f32 v[114:115], v[112:113], v[36:37], v[114:115] op_sel:[1,1,0] op_sel_hi:[0,1,1] neg_lo:[0,1,0]
  v_pk_fma_f32 v[114:115], v[112:113], v[36:37], v[114:115] op_sel:[0,0,0] op_sel_hi:[1,0,1]
  v_pk_fma_f32 v[116:117], v[114:115], v[36:37], v[116:117] op_sel:[1,1,0] op_sel_hi:[0,1,1] neg_lo:[0,1,0]
  v_pk_fma_f32 v[116:117], v[114:115], v[36:37], v[116:117] op_sel:[0,0,0] op_sel_hi:[1,0,1]
  s_waitcnt lgkmcnt(0)
  v_pk_fma_f32 v[118:119], v[116:117], v[36:37], v[118:119] op_sel:[1,1,0] op_sel_hi:[0,1,1] neg_lo:[0,1,0]
  v_pk_fma_f32 v[118:119], v[116:117], v[36:37], v[118:119] op_sel:[0,0,0] op_sel_hi:[1,0,1]
  v_pk_fma_f32 v[120:121], v[118:119], v[36:37], v[120:121] op_sel:[1,1,0] op_sel_hi:[0,1,1] neg_lo:[0,1,0]
  v_pk_fma_f32 v[120:121], v[118:119], v[36:37], v[120:121] op_sel:[0,0,0] op_sel_hi:[1,0,1]
  v_mov_b32 v122, s8
  v_mov_b32 v123, s8
  s_add_u32 s12, s83, 337920
  s_mov_b64 exec, s[96:97]
  buffer_store_dwordx4 v[120:123], v2, s[52:55], s12 offen sc1
  s_mov_b64 exec, -1
  v_subrev_u32 v46, 8576, v46
  v_mov_b32 v88, 0
  v_mov_b32 v89, 0
  s_mov_b32 exec_hi, 0xff
  s_cmp_eq_u32 s7, 1
  s_cbranch_scc1 w1_69
  s_cmp_eq_u32 s7, 2
  s_cbranch_scc1 w2_70
  s_cmp_eq_u32 s7, 3
  s_cbranch_scc1 w3_71
w0_68:
  ds_write_b128 v46, v[88:91] offset:0
  ds_write_b128 v46, v[92:95] offset:16
  s_branch join_67
w1_69:
  ds_write_b128 v46, v[96:99] offset:32
  ds_write_b128 v46, v[100:103] offset:48
  s_branch join_67
w2_70:
  ds_write_b128 v46, v[104:107] offset:64
  ds_write_b128 v46, v[108:111] offset:80
  s_branch join_67
w3_71:
  ds_write_b128 v46, v[112:115] offset:96
  ds_write_b128 v46, v[116:119] offset:112
join_67:
  s_mov_b32 exec_hi, -1
  v_add_u32 v46, 143744, v9
  ds_read_b32 v244, v46 offset:0
  ds_read_b32 v246, v46 offset:1152
  ds_read_b32 v248, v46 offset:2304
  ds_read_b32 v250, v46 offset:3456
  ds_read_b32 v252, v46 offset:4608
  v_and_b32 v43, 1, v3
  v_cvt_f32_u32 v43, v43
  v_fma_f32 v43, 2.0, v43, -1.0
  s_waitcnt lgkmcnt(0)
  s_nop 0
  v_mul_f32_dpp v245, v244, v43 quad_perm:[1,0,3,2] row_mask:0xf bank_mask:0xf
  v_mul_f32_dpp v247, v246, v43 quad_perm:[1,0,3,2] row_mask:0xf bank_mask:0xf
  v_mul_f32_dpp v249, v248, v43 quad_perm:[1,0,3,2] row_mask:0xf bank_mask:0xf
  v_mul_f32_dpp v251, v250, v43 quad_perm:[1,0,3,2] row_mask:0xf bank_mask:0xf
  v_mul_f32_dpp v253, v252, v43 quad_perm:[1,0,3,2] row_mask:0xf bank_mask:0xf
  s_and_b32 vcc_lo, s1, 7
  s_lshl_b32 vcc_lo, vcc_lo, 2
  s_add_u32 vcc_lo, vcc_lo, s7
  s_lshl_b32 vcc_lo, vcc_lo, 11
  v_lshl_add_u32 v15, v3, 7, vcc_lo
  v_min_u32 v15, L_codeend-L_pc-4, v15
  s_mov_b64 exec, 0xffff
  global_load_dword a250, v15, s[98:99]
  s_mov_b64 exec, -1
  s_lshl_b32 s90, s7, 2
  s_sub_u32 s90, 12, s90
  s_mul_i32 s90, s90, 640
  s_add_u32 s90, s90, s83
  s_add_u32 s90, s90, 327680
  v_min_u32 v42, 39, v1
  v_lshlrev_b32 v42, 4, v42
  v_lshlrev_b32_e64 v193, 2, v1
  s_and_b32 s91, s84, 0x3c00
  s_add_u32 s91, s91, 4864
  buffer_load_dword v192, v193, s[52:55], s91 offen sc1
  buffer_load_dwordx3 v[88:90], v42, s[52:55], s90 offen offset:0 sc1
  buffer_load_dwordx3 v[92:94], v42, s[52:55], s90 offen offset:640 sc1
  buffer_load_dwordx3 v[96:98], v42, s[52:55], s90 offen offset:1280 sc1
  buffer_load_dwordx3 v[100:102], v42, s[52:55], s90 offen offset:1920 sc1
  s_mul_i32 s12, s7, 2560
  s_add_u32 s12, s12, 24576
  v_lshlrev_b32_e64 v11, 5, v3
  v_lshl_add_u32 v11, v4, 3, v11
  v_add_u32_e64 v11, s12, v11
  v_lshl_add_u32 v12, v1, 3, s12
  ds_write_b64 v11, a[200:201] offset:0
  ds_write_b64 v11, a[202:203] offset:512
  ds_write_b64 v11, a[204:205] offset:1024
  ds_write_b64 v11, a[206:207] offset:1536
  ds_write_b64 v11, a[208:209] offset:2048
  ds_read_b64 v[232:233], v12 offset:0
  ds_read_b64 v[234:235], v12 offset:512
  ds_read_b64 v[236:237], v12 offset:1024
  ds_read_b64 v[238:239], v12 offset:1536
  ds_read_b64 v[240:241], v12 offset:2048
  v_lshrrev_b32_e64 v11, 1, v3
  v_mul_u32_u24 v12, 80, v11
  v_add_u32 v12, 160640, v12
  v_mul_u32_u24_e64 v11, 48, v11
  v_add_u32 v11, 149504, v11
  ds_read_b128 v[128:131], v12 offset:0
  ds_read_b128 v[132:135], v12 offset:16
  ds_read_b128 v[136:139], v12 offset:32
  ds_read_b128 v[140:143], v12 offset:48
  ds_read_b128 v[144:147], v12 offset:640
  ds_read_b128 v[148:151], v12 offset:656
  ds_read_b128 v[152:155], v12 offset:672
  ds_read_b128 v[156:159], v12 offset:688
  ds_read_b128 v[160:163], v12 offset:1280
  ds_read_b128 v[164:167], v12 offset:1296
  ds_read_b128 v[168:171], v12 offset:1312
  ds_read_b128 v[172:175], v12 offset:1328
  ds_read_b128 v[176:179], v12 offset:1920
  ds_read_b128 v[180:183], v12 offset:1936
  ds_read_b128 v[184:187], v12 offset:1952
  ds_read_b128 v[188:191], v12 offset:1968
  ds_read_b128 v[104:107], v12 offset:2560
  ds_read_b128 v[108:111], v12 offset:2576
  ds_read_b128 v[112:115], v12 offset:2592
  ds_read_b128 v[116:119], v12 offset:2608
  v_accvgpr_read_b32 v254, a240
  v_accvgpr_read_b32 v255, a241
  v_accvgpr_read_b32 v47, a242
  s_waitcnt vmcnt(0)
  v_min3_u32 v14, v90, v94, s8
  v_max3_u32 v15, v90, v94, s8
  v_min3_u32 v14, v14, v98, v102
  v_max3_u32 v15, v15, v98, v102
  v_cmp_ne_u32 vcc, v14, v15
  s_cbranch_vccz ok_73
again_72:
  buffer_load_dwordx3 v[88:90], v42, s[52:55], s90 offen offset:0 sc1
  buffer_load_dwordx3 v[92:94], v42, s[52:55], s90 offen offset:640 sc1
  buffer_load_dwordx3 v[96:98], v42, s[52:55], s90 offen offset:1280 sc1
  buffer_load_dwordx3 v[100:102], v42, s[52:55], s90 offen offset:1920 sc1
  s_sub_u32 s10, s10, 1
  s_cmp_gt_i32 s10, 0
  s_waitcnt vmcnt(0)
  v_min3_u32 v14, v90, v94, s8
  v_max3_u32 v15, v90, v94, s8
  v_min3_u32 v14, v14, v98, v102
  v_max3_u32 v15, v15, v98, v102
  v_cmp_ne_u32 vcc, v14, v15
  s_cbranch_scc0 out_74
  s_cbranch_vccnz again_72
out_74:
ok_73:
  v_xor_b32 v15, s8, v192
  v_cmp_ne_u32 vcc, 0, v15
  s_cbranch_vccnz again_75
ok_76:
  v_pk_fma_f32 v[92:93], v[88:89], v[38:39], v[92:93] op_sel:[1,1,0] op_sel_hi:[0,1,1] neg_lo:[0,1,0]
  v_pk_fma_f32 v[92:93], v[88:89], v[38:39], v[92:93] op_sel:[0,0,0] op_sel_hi:[1,0,1]
  v_pk_fma_f32 v[96:97], v[92:93], v[38:39], v[96:97] op_sel:[1,1,0] op_sel_hi:[0,1,1] neg_lo:[0,1,0]
  v_pk_fma_f32 v[96:97], v[92:93], v[38:39], v[96:97] op_sel:[0,0,0] op_sel_hi:[1,0,1]
  v_pk_fma_f32 v[100:101], v[96:97], v[38:39], v[100:101] op_sel:[1,1,0] op_sel_hi:[0,1,1] neg_lo:[0,1,0]
  v_pk_fma_f32 v[100:101], v[96:97], v[38:39], v[100:101] op_sel:[0,0,0] op_sel_hi:[1,0,1]
  v_pk_mul_f32 v[88:89], v[100:101], v[40:41] op_sel:[1,1] op_sel_hi:[0,1] neg_lo:[0,1]
  v_pk_fma_f32 v[88:89], v[100:101], v[40:41], v[88:89] op_sel:[0,0,0] op_sel_hi:[1,0,1]
  s_mov_b32 exec_hi, 0xff
  ds_write_b64 v44, v[88:89]
  s_mov_b32 exec_hi, -1
  s_waitcnt lgkmcnt(0)
  s_barrier
  ds_read_b128 v[88:91], v11 offset:0
  ds_read_b128 v[92:95], v11 offset:16
  ds_read_b128 v[96:99], v11 offset:384
  ds_read_b128 v[100:103], v11 offset:400
  ds_read_b128 v[224:227], v11 offset:768
  ds_read_b128 v[228:231], v11 offset:784
  s_waitcnt lgkmcnt(4)
  v_pk_add_f32 v[88:89], v[88:89], v[90:91]
  v_pk_add_f32 v[92:93], v[92:93], v[94:95]
  v_pk_add_f32 v[88:89], v[88:89], v[92:93]
  v_pk_fma_f32 v[244:245], v[26:27], v[88:89], v[244:245] op_sel:[0,0,0] op_sel_hi:[1,0,1]
  v_pk_fma_f32 v[244:245], v[26:27], v[88:89], v[244:245] op_sel:[1,1,0] op_sel_hi:[0,1,1] neg_hi:[1,0,0]
  ds_read_b128 v[88:91], v11 offset:1152
  ds_read_b128 v[92:95], v11 offset:1168
  s_waitcnt lgkmcnt(4)
  v_pk_add_f32 v[96:97], v[96:97], v[98:99]
  v_pk_add_f32 v[100:101], v[100:101], v[102:103]
  v_pk_add_f32 v[96:97], v[96:97], v[100:101]
  v_pk_fma_f32 v[246:247], v[28:29], v[96:97], v[246:247] op_sel:[0,0,0] op_sel_hi:[1,0,1]
  v_pk_fma_f32 v[246:247], v[28:29], v[96:97], v[246:247] op_sel:[1,1,0] op_sel_hi:[0,1,1] neg_hi:[1,0,0]
  ds_read_b128 v[96:99], v11 offset:1536
  ds_read_b128 v[100:103], v11 offset:1552
  v_pk_fma_f32 v[48:49], v[128:129], v[244:245], v[48:49] op_sel:[0,0,0] op_sel_hi:[1,0,1]
  v_pk_fma_f32 v[50:51], v[130:131], v[244:245], v[50:51] op_sel:[0,0,0] op_sel_hi:[1,0,1]
  v_pk_fma_f32 v[52:53], v[132:133], v[244:245], v[52:53] op_sel:[0,0,0] op_sel_hi:[1,0,1]
  v_pk_fma_f32 v[54:55], v[134:135], v[244:245], v[54:55] op_sel:[0,0,0] op_sel_hi:[1,0,1]
  v_pk_fma_f32 v[48:49], v[136:137], v[244:245], v[48:49] op_sel:[0,1,0] op_sel_hi:[1,1,1]
  v_pk_fma_f32 v[50:51], v[138:139], v[244:245], v[50:51] op_sel:[0,1,0] op_sel_hi:[1,1,1]
  v_pk_fma_f32 v[52:53], v[140:141], v[244:245], v[52:53] op_sel:[0,1,0] op_sel_hi:[1,1,1]
  v_pk_fma_f32 v[54:55], v[142:143], v[244:245], v[54:55] op_sel:[0,1,0] op_sel_hi:[1,1,1]
  v_cvt_pk_bf16_f32 v120, v48, v49
  v_cvt_pk_bf16_f32 v121, v50, v51
  v_cvt_pk_bf16_f32 v122, v52, v53
  v_cvt_pk_bf16_f32 v123, v54, v55
  ds_write_b128 v254, v[120:123]
  ds_read_b64_tr_b16 v[52:53], v255
  ds_read_b64_tr_b16 v[54:55], v255 offset:640
  s_waitcnt lgkmcnt(7)
  v_pk_add_f32 v[224:225], v[224:225], v[226:227]
  v_pk_add_f32 v[228:229], v[228:229], v[230:231]
  v_pk_add_f32 v[224:225], v[224:225], v[228:229]
  v_pk_fma_f32 v[248:249], v[30:31], v[224:225], v[248:249] op_sel:[0,0,0] op_sel_hi:[1,0,1]
  v_pk_fma_f32 v[248:249], v[30:31], v[224:225], v[248:249] op_sel:[1,1,0] op_sel_hi:[0,1,1] neg_hi:[1,0,0]
  v_pk_fma_f32 v[56:57], v[144:145], v[246:247], v[56:57] op_sel:[0,0,0] op_sel_hi:[1,0,1]
  v_pk_fma_f32 v[58:59], v[146:147], v[246:247], v[58:59] op_sel:[0,0,0] op_sel_hi:[1,0,1]
  v_pk_fma_f32 v[60:61], v[148:149], v[246:247], v[60:61] op_sel:[0,0,0] op_sel_hi:[1,0,1]
  v_pk_fma_f32 v[62:63], v[150:151], v[246:247], v[62:63] op_sel:[0,0,0] op_sel_hi:[1,0,1]
  v_pk_fma_f32 v[56:57], v[152:153], v[246:247], v[56:57] op_sel:[0,1,0] op_sel_hi:[1,1,1]
  v_pk_fma_f32 v[58:59], v[154:155], v[246:247], v[58:59] op_sel:[0,1,0] op_sel_hi:[1,1,1]
  v_pk_fma_f32 v[60:61], v[156:157], v[246:247], v[60:61] op_sel:[0,1,0] op_sel_hi:[1,1,1]
  v_pk_fma_f32 v[62:63], v[158:159], v[246:247], v[62:63] op_sel:[0,1,0] op_sel_hi:[1,1,1]
  v_cvt_pk_bf16_f32 v124, v56, v57
  v_cvt_pk_bf16_f32 v125, v58, v59
  v_cvt_pk_bf16_f32 v126, v60, v61
  v_cvt_pk_bf16_f32 v127, v62, v63
  ds_write_b128 v254, v[124:127]
  ds_read_b64_tr_b16 v[60:61], v255
  ds_read_b64_tr_b16 v[62:63], v255 offset:640
  s_waitcnt lgkmcnt(8)
  v_pk_add_f32 v[88:89], v[88:89], v[90:91]
  v_pk_add_f32 v[92:93], v[92:93], v[94:95]
  v_pk_add_f32 v[88:89], v[88:89], v[92:93]
  v_pk_fma_f32 v[250:251], v[32:33], v[88:89], v[250:251] op_sel:[0,0,0] op_sel_hi:[1,0,1]
  v_pk_fma_f32 v[250:251], v[32:33], v[88:89], v[250:251] op_sel:[1,1,0] op_sel_hi:[0,1,1] neg_hi:[1,0,0]
  s_add_u32 s13, s78, 0
  s_waitcnt lgkmcnt(3)
  s_cmp_eq_u32 s9, 0
  s_cbranch_scc1 slow_77
  buffer_store_dwordx4 v[52:55], v47, s[60:63], s13 offen
back_78:
  v_pk_fma_f32 v[64:65], v[160:161], v[248:249], v[64:65] op_sel:[0,0,0] op_sel_hi:[1,0,1]
  v_pk_fma_f32 v[66:67], v[162:163], v[248:249], v[66:67] op_sel:[0,0,0] op_sel_hi:[1,0,1]
  v_pk_fma_f32 v[68:69], v[164:165], v[248:249], v[68:69] op_sel:[0,0,0] op_sel_hi:[1,0,1]
  v_pk_fma_f32 v[70:71], v[166:167], v[248:249], v[70:71] op_sel:[0,0,0] op_sel_hi:[1,0,1]
  v_pk_fma_f32 v[64:65], v[168:169], v[248:249], v[64:65] op_sel:[0,1,0] op_sel_hi:[1,1,1]
  v_pk_fma_f32 v[66:67], v[170:171], v[248:249], v[66:67] op_sel:[0,1,0] op_sel_hi:[1,1,1]
  v_pk_fma_f32 v[68:69], v[172:173], v[248:249], v[68:69] op_sel:[0,1,0] op_sel_hi:[1,1,1]
  v_pk_fma_f32 v[70:71], v[174:175], v[248:249], v[70:71] op_sel:[0,1,0] op_sel_hi:[1,1,1]
  v_cvt_pk_bf16_f32 v120, v64, v65
  v_cvt_pk_bf16_f32 v121, v66, v67
  v_cvt_pk_bf16_f32 v122, v68, v69
  v_cvt_pk_bf16_f32 v123, v70, v71
  ds_write_b128 v254, v[120:123]
  ds_read_b64_tr_b16 v[68:69], v255
  ds_read_b64_tr_b16 v[70:71], v255 offset:640
  v_pk_add_f32 v[96:97], v[96:97], v[98:99]
  v_pk_add_f32 v[100:101], v[100:101], v[102:103]
  v_pk_add_f32 v[96:97], v[96:97], v[100:101]
  v_pk_fma_f32 v[252:253], v[34:35], v[96:97], v[252:253] op_sel:[0,0,0] op_sel_hi:[1,0,1]
  v_pk_fma_f32 v[252:253], v[34:35], v[96:97], v[252:253] op_sel:[1,1,0] op_sel_hi:[0,1,1] neg_hi:[1,0,0]
  s_add_u32 s13, s79, 0
  s_waitcnt lgkmcnt(3)
  s_cmp_eq_u32 s9, 0
  s_cbranch_scc1 slow_79
  buffer_store_dwordx4 v[60:63], v47, s[60:63], s13 offen
back_80:
  v_pk_fma_f32 v[72:73], v[176:177], v[250:251], v[72:73] op_sel:[0,0,0] op_sel_hi:[1,0,1]
  v_pk_fma_f32 v[74:75], v[178:179], v[250:251], v[74:75] op_sel:[0,0,0] op_sel_hi:[1,0,1]
  v_pk_fma_f32 v[76:77], v[180:181], v[250:251], v[76:77] op_sel:[0,0,0] op_sel_hi:[1,0,1]
  v_pk_fma_f32 v[78:79], v[182:183], v[250:251], v[78:79] op_sel:[0,0,0] op_sel_hi:[1,0,1]
  v_pk_fma_f32 v[72:73], v[184:185], v[250:251], v[72:73] op_sel:[0,1,0] op_sel_hi:[1,1,1]
  v_pk_fma_f32 v[74:75], v[186:187], v[250:251], v[74:75] op_sel:[0,1,0] op_sel_hi:[1,1,1]
  v_pk_fma_f32 v[76:77], v[188:189], v[250:251], v[76:77] op_sel:[0,1,0] op_sel_hi:[1,1,1]
  v_pk_fma_f32 v[78:79], v[190:191], v[250:251], v[78:79] op_sel:[0,1,0] op_sel_hi:[1,1,1]
  v_cvt_pk_bf16_f32 v124, v72, v73
  v_cvt_pk_bf16_f32 v125, v74, v75
  v_cvt_pk_bf16_f32 v126, v76, v77
  v_cvt_pk_bf16_f32 v127, v78, v79
  ds_write_b128 v254, v[124:127]
  ds_read_b64_tr_b16 v[76:77], v255
  ds_read_b64_tr_b16 v[78:79], v255 offset:640
  s_add_u32 s13, s80, 0
  s_waitcnt lgkmcnt(3)
  s_cmp_eq_u32 s9, 0
  s_cbranch_scc1 slow_81
  buffer_store_dwordx4 v[68:71], v47, s[60:63], s13 offen
back_82:
  v_pk_fma_f32 v[80:81], v[104:105], v[252:253], v[80:81] op_sel:[0,0,0] op_sel_hi:[1,0,1]
  v_pk_fma_f32 v[82:83], v[106:107], v[252:253], v[82:83] op_sel:[0,0,0] op_sel_hi:[1,0,1]
  v_pk_fma_f32 v[84:85], v[108:109], v[252:253], v[84:85] op_sel:[0,0,0] op_sel_hi:[1,0,1]
  v_pk_fma_f32 v[86:87], v[110:111], v[252:253], v[86:87] op_sel:[0,0,0] op_sel_hi:[1,0,1]
  v_pk_fma_f32 v[80:81], v[112:113], v[252:253], v[80:81] op_sel:[0,1,0] op_sel_hi:[1,1,1]
  v_pk_fma_f32 v[82:83], v[114:115], v[252:253], v[82:83] op_sel:[0,1,0] op_sel_hi:[1,1,1]
  v_pk_fma_f32 v[84:85], v[116:117], v[252:253], v[84:85] op_sel:[0,1,0] op_sel_hi:[1,1,1]
  v_pk_fma_f32 v[86:87], v[118:119], v[252:253], v[86:87] op_sel:[0,1,0] op_sel_hi:[1,1,1]
  v_cvt_pk_bf16_f32 v120, v80, v81
  v_cvt_pk_bf16_f32 v121, v82, v83
  v_cvt_pk_bf16_f32 v122, v84, v85
  v_cvt_pk_bf16_f32 v123, v86, v87
  ds_write_b128 v254, v[120:123]
  ds_read_b64_tr_b16 v[84:85], v255
  ds_read_b64_tr_b16 v[86:87], v255 offset:640
  s_add_u32 s13, s81, 0
  s_waitcnt lgkmcnt(3)
  s_cmp_eq_u32 s9, 0
  s_cbranch_scc1 slow_83
  buffer_store_dwordx4 v[76:79], v47, s[60:63], s13 offen
back_84:
  s_add_u32 s13, s82, 0
  s_waitcnt lgkmcnt(0)
  s_cmp_eq_u32 s9, 0
  s_cbranch_scc1 slow_85
  buffer_store_dwordx4 v[84:87], v47, s[60:63], s13 offen
back_86:
  s_mul_i32 s13, s5, 163840
  s_mul_i32 s14, s7, 10240
  s_add_u32 s13, s13, s14
  s_add_u32 s13, s13, 0
  s_add_u32 s14, s7, 1
  s_and_b32 s14, s14, 3
  s_mul_i32 s15, s14, 40960
  s_add_u32 s16, s15, s13
  s_mul_i32 s15, s14, 10240
  s_add_u32 s15, s15, 102400
  v_add_u32 v44, s15, v2
  s_add_u32 s14, s7, 2
  s_and_b32 s14, s14, 3
  s_mul_i32 s15, s14, 40960
  s_add_u32 s17, s15, s13
  s_mul_i32 s15, s14, 10240
  s_add_u32 s15, s15, 107520
  v_add_u32 v45, s15, v2
  s_add_u32 s14, s7, 3
  s_and_b32 s14, s14, 3
  s_mul_i32 s15, s14, 40960
  s_add_u32 s18, s15, s13
  s_mul_i32 s15, s14, 5120
  v_add_u32 v46, s15, v2
  s_add_u32 s14, s7, 4
  s_and_b32 s14, s14, 3
  s_mul_i32 s15, s14, 40960
  s_add_u32 s19, s15, s13
  s_lshl_b32 s49, s3, 10
  s_lshl_b32 s13, s7, 6
  s_add_u32 s49, s49, s13
  s_and_b32 s13, s5, 1
  s_lshl_b32 s13, s13, 3
  s_add_u32 s49, s49, s13
  s_add_u32 s49, s49, 4608
  v_and_b32 v244, 3, v1
  v_lshlrev_b32 v244, 4, v244
  s_waitcnt vmcnt(0)
  s_add_u32 s14, s84, 4608
  v_mov_b32 v15, s8
  s_mov_b64 exec, 1
  s_cmp_eq_u32 s9, 0
  s_cbranch_scc1 slow_87
  buffer_store_dword v15, off, s[52:55], s14
back_88:
  s_mov_b64 exec, -1
again_89:
  buffer_load_dwordx2 v[42:43], v244, s[52:55], s49 offen sc1
  s_sub_u32 s10, s10, 1
  s_cmp_gt_i32 s10, 0
  s_waitcnt vmcnt(0)
  v_xor_b32 v15, s8, v42
  v_xor_b32 v14, s8, v43
  v_or_b32 v15, v15, v14
  v_cmp_ne_u32 vcc, 0, v15
  s_cbranch_scc0 out_91
  s_cbranch_vccnz again_89
out_91:
ok_90:
  buffer_load_dwordx4 v[128:131], v2, s[60:63], s16 offen offset:0 sc1
  buffer_load_dwordx4 v[132:135], v2, s[60:63], s16 offen offset:1024 sc1
  buffer_load_dwordx4 v[136:139], v2, s[60:63], s16 offen offset:2048 sc1
  buffer_load_dwordx4 v[140:143], v2, s[60:63], s16 offen offset:3072 sc1
  s_add_u32 s16, s16, 4096
  buffer_load_dwordx4 v[144:147], v2, s[60:63], s16 offen offset:0 sc1
  buffer_load_dwordx4 v[148:151], v2, s[60:63], s16 offen offset:1024 sc1
  buffer_load_dwordx4 v[152:155], v2, s[60:63], s16 offen offset:2048 sc1
  buffer_load_dwordx4 v[156:159], v2, s[60:63], s16 offen offset:3072 sc1
  s_waitcnt vmcnt(7)
  v_mfma_f32_16x16x32_bf16 v[48:51], a[0:3], v[128:131], 0
  s_add_u32 s16, s16, 4096
  buffer_load_dwordx4 v[160:163], v2, s[60:63], s16 offen offset:0 sc1
  v_mfma_f32_16x16x32_bf16 v[52:55], a[4:7], v[128:131], 0
  v_mfma_f32_16x16x32_bf16 v[56:59], a[8:11], v[128:131], 0
  v_mfma_f32_16x16x32_bf16 v[60:63], a[12:15], v[128:131], 0
  v_mfma_f32_16x16x32_bf16 v[64:67], a[16:19], v[128:131], 0
  s_waitcnt vmcnt(7)
  v_mfma_f32_16x16x32_bf16 v[48:51], a[20:23], v[132:135], v[48:51]
  buffer_load_dwordx4 v[164:167], v2, s[60:63], s16 offen offset:1024 sc1
  v_mfma_f32_16x16x32_bf16 v[52:55], a[24:27], v[132:135], v[52:55]
  v_accvgpr_read_b32 v108, a210
  v_mfma_f32_16x16x32_bf16 v[56:59], a[28:31], v[132:135], v[56:59]
  v_accvgpr_read_b32 v109, a211
  v_mfma_f32_16x16x32_bf16 v[60:63], a[32:35], v[132:135], v[60:63]
  v_accvgpr_read_b32 v110, a212
  v_mfma_f32_16x16x32_bf16 v[64:67], a[36:39], v[132:135], v[64:67]
  s_waitcnt vmcnt(7)
  v_mfma_f32_16x16x32_bf16 v[48:51], a[40:43], v[136:139], v[48:51]
  buffer_load_dwordx4 v[168:171], v2, s[60:63], s17 offen offset:0 sc1
  v_mfma_f32_16x16x32_bf16 v[52:55], a[44:47], v[136:139], v[52:55]
  v_accvgpr_read_b32 v111, a213
  v_mfma_f32_16x16x32_bf16 v[56:59], a[48:51], v[136:139], v[56:59]
  v_accvgpr_read_b32 v112, a214
  v_mfma_f32_16x16x32_bf16 v[60:63], a[52:55], v[136:139], v[60:63]
  v_accvgpr_read_b32 v113, a215
  v_mfma_f32_16x16x32_bf16 v[64:67], a[56:59], v[136:139], v[64:67]
  s_waitcnt vmcnt(7)
  v_mfma_f32_16x16x32_bf16 v[48:51], a[60:63], v[140:143], v[48:51]
  buffer_load_dwordx4 v[172:175], v2, s[60:63], s17 offen offset:1024 sc1
  v_mfma_f32_16x16x32_bf16 v[52:55], a[64:67], v[140:143], v[52:55]
  v_accvgpr_read_b32 v114, a216
  v_mfma_f32_16x16x32_bf16 v[56:59], a[68:71], v[140:143], v[56:59]
  v_accvgpr_read_b32 v115, a217
  v_mfma_f32_16x16x32_bf16 v[60:63], a[72:75], v[140:143], v[60:63]
  v_accvgpr_read_b32 v116, a218
  v_mfma_f32_16x16x32_bf16 v[64:67], a[76:79], v[140:143], v[64:67]
  s_waitcnt vmcnt(7)
  v_mfma_f32_16x16x32_bf16 v[48:51], a[80:83], v[144:147], v[48:51]
  buffer_load_dwordx4 v[176:179], v2, s[60:63], s17 offen offset:2048 sc1
  v_mfma_f32_16x16x32_bf16 v[52:55], a[84:87], v[144:147], v[52:55]
  v_accvgpr_read_b32 v117, a219
  v_mfma_f32_16x16x32_bf16 v[56:59], a[88:91], v[144:147], v[56:59]
  v_accvgpr_read_b32 v118, a220
  v_mfma_f32_16x16x32_bf16 v[60:63], a[92:95], v[144:147], v[60:63]
  v_accvgpr_read_b32 v119, a221
  v_mfma_f32_16x16x32_bf16 v[64:67], a[96:99], v[144:147], v[64:67]
  s_waitcnt vmcnt(7)
  v_mfma_f32_16x16x32_bf16 v[48:51], a[100:103], v[148:151], v[48:51]
  buffer_load_dwordx4 v[180:183], v2, s[60:63], s17 offen offset:3072 sc1
  v_mfma_f32_16x16x32_bf16 v[52:55], a[104:107], v[148:151], v[52:55]
  v_accvgpr_read_b32 v120, a222
  v_mfma_f32_16x16x32_bf16 v[56:59], a[108:111], v[148:151], v[56:59]
  v_accvgpr_read_b32 v121, a223
  v_mfma_f32_16x16x32_bf16 v[60:63], a[112:115], v[148:151], v[60:63]
  v_accvgpr_read_b32 v122, a224
  v_mfma_f32_16x16x32_bf16 v[64:67], a[116:119], v[148:151], v[64:67]
  s_waitcnt vmcnt(7)
  v_mfma_f32_16x16x32_bf16 v[48:51], a[120:123], v[152:155], v[48:51]
  s_add_u32 s17, s17, 4096
  buffer_load_dwordx4 v[184:187], v2, s[60:63], s17 offen offset:0 sc1
  v_mfma_f32_16x16x32_bf16 v[52:55], a[124:127], v[152:155], v[52:55]
  v_accvgpr_read_b32 v123, a225
  v_mfma_f32_16x16x32_bf16 v[56:59], a[128:131], v[152:155], v[56:59]
  v_accvgpr_read_b32 v124, a226
  v_mfma_f32_16x16x32_bf16 v[60:63], a[132:135], v[152:155], v[60:63]
  v_accvgpr_read_b32 v125, a227
  v_mfma_f32_16x16x32_bf16 v[64:67], a[136:139], v[152:155], v[64:67]
  s_waitcnt vmcnt(7)
  v_mfma_f32_16x16x32_bf16 v[48:51], a[140:143], v[156:159], v[48:51]
  buffer_load_dwordx4 v[188:191], v2, s[60:63], s17 offen offset:1024 sc1
  v_mfma_f32_16x16x32_bf16 v[52:55], a[144:147], v[156:159], v[52:55]
  v_accvgpr_read_b32 v126, a228
  v_mfma_f32_16x16x32_bf16 v[56:59], a[148:151], v[156:159], v[56:59]
  v_accvgpr_read_b32 v127, a229
  v_mfma_f32_16x16x32_bf16 v[60:63], a[152:155], v[156:159], v[60:63]
  v_lshlrev_b32 v88, 16, v232
  v_mfma_f32_16x16x32_bf16 v[64:67], a[156:159], v[156:159], v[64:67]
  s_waitcnt vmcnt(7)
  v_mfma_f32_16x16x32_bf16 v[48:51], a[160:163], v[160:163], v[48:51]
  buffer_load_dwordx4 v[128:131], v2, s[60:63], s17 offen offset:2048 sc1
  v_mfma_f32_16x16x32_bf16 v[52:55], a[164:167], v[160:163], v[52:55]
  v_and_b32 v89, 0xffff0000, v232
  v_mfma_f32_16x16x32_bf16 v[56:59], a[168:171], v[160:163], v[56:59]
  v_lshlrev_b32 v90, 16, v233
  v_mfma_f32_16x16x32_bf16 v[60:63], a[172:175], v[160:163], v[60:63]
  v_and_b32 v91, 0xffff0000, v233
  v_mfma_f32_16x16x32_bf16 v[64:67], a[176:179], v[160:163], v[64:67]
  s_waitcnt vmcnt(7)
  v_mfma_f32_16x16x32_bf16 v[48:51], a[180:183], v[164:167], v[48:51]
  buffer_load_dwordx4 v[132:135], v2, s[60:63], s17 offen offset:3072 sc1
  v_mfma_f32_16x16x32_bf16 v[52:55], a[184:187], v[164:167], v[52:55]
  v_lshlrev_b32 v92, 16, v234
  v_mfma_f32_16x16x32_bf16 v[56:59], a[188:191], v[164:167], v[56:59]
  v_and_b32 v93, 0xffff0000, v234
  v_mfma_f32_16x16x32_bf16 v[60:63], a[192:195], v[164:167], v[60:63]
  v_lshlrev_b32_e64 v94, 16, v235
  v_mfma_f32_16x16x32_bf16 v[64:67], a[196:199], v[164:167], v[64:67]
  s_waitcnt vmcnt(7)
  v_mfma_f32_16x16x32_bf16 v[68:71], a[0:3], v[168:171], 0
  s_add_u32 s17, s17, 4096
  buffer_load_dwordx4 v[136:139], v2, s[60:63], s17 offen offset:0 sc1
  v_mfma_f32_16x16x32_bf16 v[72:75], a[4:7], v[168:171], 0
  v_and_b32 v95, 0xffff0000, v235
  v_mfma_f32_16x16x32_bf16 v[76:79], a[8:11], v[168:171], 0
  v_lshlrev_b32 v96, 16, v236
  v_mfma_f32_16x16x32_bf16 v[80:83], a[12:15], v[168:171], 0
  v_and_b32 v97, 0xffff0000, v236
  v_mfma_f32_16x16x32_bf16 v[84:87], a[16:19], v[168:171], 0
  s_waitcnt vmcnt(7)
  v_mfma_f32_16x16x32_bf16 v[68:71], a[20:23], v[172:175], v[68:71]
  ds_write_b128 v44, v[48:51] offset:0
  ds_write_b128 v44, v[52:55] offset:1024
  v_mfma_f32_16x16x32_bf16 v[72:75], a[24:27], v[172:175], v[72:75]
  buffer_load_dwordx4 v[140:143], v2, s[60:63], s17 offen offset:1024 sc1
  v_mfma_f32_16x16x32_bf16 v[76:79], a[28:31], v[172:175], v[76:79]
  v_lshlrev_b32 v98, 16, v237
  v_mfma_f32_16x16x32_bf16 v[80:83], a[32:35], v[172:175], v[80:83]
  v_and_b32 v99, 0xffff0000, v237
  v_mfma_f32_16x16x32_bf16 v[84:87], a[36:39], v[172:175], v[84:87]
  v_lshlrev_b32 v100, 16, v238
  s_waitcnt vmcnt(7)
  v_mfma_f32_16x16x32_bf16 v[68:71], a[40:43], v[176:179], v[68:71]
  ds_write_b128 v44, v[56:59] offset:2048
  ds_write_b128 v44, v[60:63] offset:3072
  v_mfma_f32_16x16x32_bf16 v[72:75], a[44:47], v[176:179], v[72:75]
  buffer_load_dwordx4 v[144:147], v2, s[60:63], s18 offen offset:0 sc1
  v_mfma_f32_16x16x32_bf16 v[76:79], a[48:51], v[176:179], v[76:79]
  v_and_b32 v101, 0xffff0000, v238
  v_mfma_f32_16x16x32_bf16 v[80:83], a[52:55], v[176:179], v[80:83]
  v_lshlrev_b32_e64 v102, 16, v239
  v_mfma_f32_16x16x32_bf16 v[84:87], a[56:59], v[176:179], v[84:87]
  v_and_b32 v103, 0xffff0000, v239
  s_waitcnt vmcnt(7)
  v_mfma_f32_16x16x32_bf16 v[68:71], a[60:63], v[180:183], v[68:71]
  ds_write_b128 v44, v[64:67] offset:4096
  v_mfma_f32_16x16x32_bf16 v[72:75], a[64:67], v[180:183], v[72:75]
  buffer_load_dwordx4 v[148:151], v2, s[60:63], s18 offen offset:1024 sc1
  v_mfma_f32_16x16x32_bf16 v[76:79], a[68:71], v[180:183], v[76:79]
  v_lshlrev_b32 v104, 16, v240
  v_mfma_f32_16x16x32_bf16 v[80:83], a[72:75], v[180:183], v[80:83]
  v_and_b32 v105, 0xffff0000, v240
  v_mfma_f32_16x16x32_bf16 v[84:87], a[76:79], v[180:183], v[84:87]
  v_lshlrev_b32 v106, 16, v241
  s_waitcnt vmcnt(7)
  v_mfma_f32_16x16x32_bf16 v[68:71], a[80:83], v[184:187], v[68:71]
  buffer_load_dwordx4 v[152:155], v2, s[60:63], s18 offen offset:2048 sc1
  v_mfma_f32_16x16x32_bf16 v[72:75], a[84:87], v[184:187], v[72:75]
  v_and_b32 v107, 0xffff0000, v241
  v_mfma_f32_16x16x32_bf16 v[76:79], a[88:91], v[184:187], v[76:79]
  v_mfma_f32_16x16x32_bf16 v[80:83], a[92:95], v[184:187], v[80:83]
  v_mfma_f32_16x16x32_bf16 v[84:87], a[96:99], v[184:187], v[84:87]
  s_waitcnt vmcnt(7)
  v_mfma_f32_16x16x32_bf16 v[68:71], a[100:103], v[188:191], v[68:71]
  buffer_load_dwordx4 v[156:159], v2, s[60:63], s18 offen offset:3072 sc1
  v_mfma_f32_16x16x32_bf16 v[72:75], a[104:107], v[188:191], v[72:75]
  v_mfma_f32_16x16x32_bf16 v[76:79], a[108:111], v[188:191], v[76:79]
  v_mfma_f32_16x16x32_bf16 v[80:83], a[112:115], v[188:191], v[80:83]
  v_mfma_f32_16x16x32_bf16 v[84:87], a[116:119], v[188:191], v[84:87]
  s_waitcnt vmcnt(7)
  v_mfma_f32_16x16x32_bf16 v[68:71], a[120:123], v[128:131], v[68:71]
  s_add_u32 s18, s18, 4096
  buffer_load_dwordx4 v[160:163], v2, s[60:63], s18 offen offset:0 sc1
  v_mfma_f32_16x16x32_bf16 v[72:75], a[124:127], v[128:131], v[72:75]
  s_mul_i32 s15, s7, 10240
  v_mfma_f32_16x16x32_bf16 v[76:79], a[128:131], v[128:131], v[76:79]
  s_add_u32 s15, s15, 102400
  v_mfma_f32_16x16x32_bf16 v[80:83], a[132:135], v[128:131], v[80:83]
  v_add_u32_e64 v47, s15, v2
  v_mfma_f32_16x16x32_bf16 v[84:87], a[136:139], v[128:131], v[84:87]
  s_waitcnt vmcnt(7)
  v_mfma_f32_16x16x32_bf16 v[68:71], a[140:143], v[132:135], v[68:71]
  buffer_load_dwordx4 v[164:167], v2, s[60:63], s18 offen offset:1024 sc1
  v_mfma_f32_16x16x32_bf16 v[72:75], a[144:147], v[132:135], v[72:75]
  v_mfma_f32_16x16x32_bf16 v[76:79], a[148:151], v[132:135], v[76:79]
  v_mfma_f32_16x16x32_bf16 v[80:83], a[152:155], v[132:135], v[80:83]
  v_mfma_f32_16x16x32_bf16 v[84:87], a[156:159], v[132:135], v[84:87]
  s_waitcnt vmcnt(7)
  v_mfma_f32_16x16x32_bf16 v[68:71], a[160:163], v[136:139], v[68:71]
  buffer_load_dwordx4 v[168:171], v2, s[60:63], s18 offen offset:2048 sc1
  v_mfma_f32_16x16x32_bf16 v[72:75], a[164:167], v[136:139], v[72:75]
  v_mfma_f32_16x16x32_bf16 v[76:79], a[168:171], v[136:139], v[76:79]
  v_mfma_f32_16x16x32_bf16 v[80:83], a[172:175], v[136:139], v[80:83]
  v_mfma_f32_16x16x32_bf16 v[84:87], a[176:179], v[136:139], v[84:87]
  s_waitcnt vmcnt(7)
  v_mfma_f32_16x16x32_bf16 v[68:71], a[180:183], v[140:143], v[68:71]
  buffer_load_dwordx4 v[172:175], v2, s[60:63], s18 offen offset:3072 sc1
  v_mfma_f32_16x16x32_bf16 v[72:75], a[184:187], v[140:143], v[72:75]
  v_mfma_f32_16x16x32_bf16 v[76:79], a[188:191], v[140:143], v[76:79]
  v_mfma_f32_16x16x32_bf16 v[80:83], a[192:195], v[140:143], v[80:83]
  v_mfma_f32_16x16x32_bf16 v[84:87], a[196:199], v[140:143], v[84:87]
  s_waitcnt vmcnt(7)
  v_mfma_f32_16x16x32_bf16 v[48:51], a[0:3], v[144:147], 0
  s_add_u32 s18, s18, 4096
  buffer_load_dwordx4 v[176:179], v2, s[60:63], s18 offen offset:0 sc1
  v_mfma_f32_16x16x32_bf16 v[52:55], a[4:7], v[144:147], 0
  v_mfma_f32_16x16x32_bf16 v[56:59], a[8:11], v[144:147], 0
  v_mfma_f32_16x16x32_bf16 v[60:63], a[12:15], v[144:147], 0
  v_mfma_f32_16x16x32_bf16 v[64:67], a[16:19], v[144:147], 0
  s_waitcnt vmcnt(7)
  v_mfma_f32_16x16x32_bf16 v[48:51], a[20:23], v[148:151], v[48:51]
  ds_write_b128 v45, v[68:71] offset:0
  v_mfma_f32_16x16x32_bf16 v[52:55], a[24:27], v[148:151], v[52:55]
  ds_write_b128 v45, v[72:75] offset:1024
  v_mfma_f32_16x16x32_bf16 v[56:59], a[28:31], v[148:151], v[56:59]
  buffer_load_dwordx4 v[180:183], v2, s[60:63], s18 offen offset:1024 sc1
  v_mfma_f32_16x16x32_bf16 v[60:63], a[32:35], v[148:151], v[60:63]
  v_mfma_f32_16x16x32_bf16 v[64:67], a[36:39], v[148:151], v[64:67]
  s_waitcnt vmcnt(7)
  v_mfma_f32_16x16x32_bf16 v[48:51], a[40:43], v[152:155], v[48:51]
  ds_write_b128 v45, v[76:79] offset:2048
  v_mfma_f32_16x16x32_bf16 v[52:55], a[44:47], v[152:155], v[52:55]
  ds_write_b128 v45, v[80:83] offset:3072
  v_mfma_f32_16x16x32_bf16 v[56:59], a[48:51], v[152:155], v[56:59]
  buffer_load_dwordx4 v[184:187], v2, s[60:63], s19 offen offset:0 sc1
  v_mfma_f32_16x16x32_bf16 v[60:63], a[52:55], v[152:155], v[60:63]
  v_mfma_f32_16x16x32_bf16 v[64:67], a[56:59], v[152:155], v[64:67]
  s_waitcnt vmcnt(7)
  v_mfma_f32_16x16x32_bf16 v[48:51], a[60:63], v[156:159], v[48:51]
  ds_write_b128 v45, v[84:87] offset:4096
  v_mfma_f32_16x16x32_bf16 v[52:55], a[64:67], v[156:159], v[52:55]
  buffer_load_dwordx4 v[188:191], v2, s[60:63], s19 offen offset:1024 sc1
  v_mfma_f32_16x16x32_bf16 v[56:59], a[68:71], v[156:159], v[56:59]
  v_mfma_f32_16x16x32_bf16 v[60:63], a[72:75], v[156:159], v[60:63]
  v_mfma_f32_16x16x32_bf16 v[64:67], a[76:79], v[156:159], v[64:67]
  s_waitcnt vmcnt(7)
  v_mfma_f32_16x16x32_bf16 v[48:51], a[80:83], v[160:163], v[48:51]
  buffer_load_dwordx4 v[128:131], v2, s[60:63], s19 offen offset:2048 sc1
  s_waitcnt lgkmcnt(0)
  s_barrier
  v_mfma_f32_16x16x32_bf16 v[52:55], a[84:87], v[160:163], v[52:55]
  ds_read_b128 v[192:195], v47 offset:0
  ds_read_b128 v[196:199], v47 offset:1024
  v_mfma_f32_16x16x32_bf16 v[56:59], a[88:91], v[160:163], v[56:59]
  ds_read_b128 v[200:203], v47 offset:2048
  ds_read_b128 v[204:207], v47 offset:3072
  v_mfma_f32_16x16x32_bf16 v[60:63], a[92:95], v[160:163], v[60:63]
  ds_read_b128 v[208:211], v47 offset:4096
  ds_read_b128 v[212:215], v47 offset:5120
  v_mfma_f32_16x16x32_bf16 v[64:67], a[96:99], v[160:163], v[64:67]
  ds_read_b128 v[216:219], v47 offset:6144
  ds_read_b128 v[220:223], v47 offset:7168
  s_waitcnt vmcnt(7)
  v_mfma_f32_16x16x32_bf16 v[48:51], a[100:103], v[164:167], v[48:51]
  buffer_load_dwordx4 v[132:135], v2, s[60:63], s19 offen offset:3072 sc1
  ds_read_b128 v[224:227], v47 offset:8192
  v_mfma_f32_16x16x32_bf16 v[52:55], a[104:107], v[164:167], v[52:55]
  ds_read_b128 v[228:231], v47 offset:9216
  s_waitcnt lgkmcnt(5)
  v_mfma_f32_16x16x32_bf16 v[56:59], a[108:111], v[164:167], v[56:59]
  v_add_f32 v108, v108, v192
  v_add_f32 v109, v109, v193
  v_mfma_f32_16x16x32_bf16 v[60:63], a[112:115], v[164:167], v[60:63]
  v_add_f32 v110, v110, v194
  v_add_f32 v111, v111, v195
  v_mfma_f32_16x16x32_bf16 v[64:67], a[116:119], v[164:167], v[64:67]
  v_add_f32 v112, v112, v196
  v_add_f32 v113, v113, v197
  s_waitcnt vmcnt(7)
  v_mfma_f32_16x16x32_bf16 v[48:51], a[120:123], v[168:171], v[48:51]
  s_add_u32 s19, s19, 4096
  buffer_load_dwordx4 v[136:139], v2, s[60:63], s19 offen offset:0 sc1
  v_add_f32 v114, v114, v198
  v_mfma_f32_16x16x32_bf16 v[52:55], a[124:127], v[168:171], v[52:55]
  v_add_f32 v115, v115, v199
  v_add_f32 v116, v116, v200
  v_mfma_f32_16x16x32_bf16 v[56:59], a[128:131], v[168:171], v[56:59]
  v_add_f32 v117, v117, v201
  v_add_f32 v118, v118, v202
  v_mfma_f32_16x16x32_bf16 v[60:63], a[132:135], v[168:171], v[60:63]
  v_add_f32 v119, v119, v203
  v_add_f32 v120, v120, v204
  v_mfma_f32_16x16x32_bf16 v[64:67], a[136:139], v[168:171], v[64:67]
  v_add_f32 v121, v121, v205
  v_add_f32 v122, v122, v206
  s_waitcnt vmcnt(7)
  v_mfma_f32_16x16x32_bf16 v[48:51], a[140:143], v[172:175], v[48:51]
  buffer_load_dwordx4 v[140:143], v2, s[60:63], s19 offen offset:1024 sc1
  v_add_f32 v123, v123, v207
  v_mfma_f32_16x16x32_bf16 v[52:55], a[144:147], v[172:175], v[52:55]
  v_add_f32 v124, v124, v208
  v_add_f32 v125, v125, v209
  v_mfma_f32_16x16x32_bf16 v[56:59], a[148:151], v[172:175], v[56:59]
  v_add_f32 v126, v126, v210
  v_add_f32 v127, v127, v211
  v_mfma_f32_16x16x32_bf16 v[60:63], a[152:155], v[172:175], v[60:63]
  s_waitcnt lgkmcnt(0)
  v_add_f32 v108, v108, v212
  v_mfma_f32_16x16x32_bf16 v[64:67], a[156:159], v[172:175], v[64:67]
  v_add_f32 v109, v109, v213
  v_add_f32 v110, v110, v214
  s_waitcnt vmcnt(7)
  v_mfma_f32_16x16x32_bf16 v[48:51], a[160:163], v[176:179], v[48:51]
  buffer_load_dwordx4 v[144:147], v2, s[60:63], s19 offen offset:2048 sc1
  v_add_f32 v111, v111, v215
  v_mfma_f32_16x16x32_bf16 v[52:55], a[164:167], v[176:179], v[52:55]
  v_add_f32 v112, v112, v216
  v_add_f32 v113, v113, v217
  v_mfma_f32_16x16x32_bf16 v[56:59], a[168:171], v[176:179], v[56:59]
  v_add_f32 v114, v114, v218
  v_add_f32 v115, v115, v219
  v_mfma_f32_16x16x32_bf16 v[60:63], a[172:175], v[176:179], v[60:63]
  v_add_f32 v116, v116, v220
  v_add_f32 v117, v117, v221
  v_mfma_f32_16x16x32_bf16 v[64:67], a[176:179], v[176:179], v[64:67]
  v_add_f32 v118, v118, v222
  v_add_f32 v119, v119, v223
  s_waitcnt vmcnt(7)
  v_mfma_f32_16x16x32_bf16 v[48:51], a[180:183], v[180:183], v[48:51]
  buffer_load_dwordx4 v[148:151], v2, s[60:63], s19 offen offset:3072 sc1
  v_add_f32 v120, v120, v224
  v_mfma_f32_16x16x32_bf16 v[52:55], a[184:187], v[180:183], v[52:55]
  v_add_f32 v121, v121, v225
  v_add_f32 v122, v122, v226
  v_mfma_f32_16x16x32_bf16 v[56:59], a[188:191], v[180:183], v[56:59]
  v_add_f32 v123, v123, v227
  v_add_f32 v124, v124, v228
  v_mfma_f32_16x16x32_bf16 v[60:63], a[192:195], v[180:183], v[60:63]
  v_add_f32 v125, v125, v229
  v_add_f32 v126, v126, v230
  v_mfma_f32_16x16x32_bf16 v[64:67], a[196:199], v[180:183], v[64:67]
  v_add_f32 v127, v127, v231
  s_waitcnt vmcnt(7)
  v_mfma_f32_16x16x32_bf16 v[68:71], a[0:3], v[184:187], v[108:111]
  s_add_u32 s19, s19, 4096
  buffer_load_dwordx4 v[152:155], v2, s[60:63], s19 offen offset:0 sc1
  v_mfma_f32_16x16x32_bf16 v[72:75], a[4:7], v[184:187], v[112:115]
  v_mfma_f32_16x16x32_bf16 v[76:79], a[8:11], v[184:187], v[116:119]
  v_mfma_f32_16x16x32_bf16 v[80:83], a[12:15], v[184:187], v[120:123]
  v_mfma_f32_16x16x32_bf16 v[84:87], a[16:19], v[184:187], v[124:127]
  s_waitcnt vmcnt(7)
  v_mfma_f32_16x16x32_bf16 v[68:71], a[20:23], v[188:191], v[68:71]
  ds_write_b128 v46, v[48:51] offset:0
  v_mfma_f32_16x16x32_bf16 v[72:75], a[24:27], v[188:191], v[72:75]
  ds_write_b128 v46, v[52:55] offset:1024
  v_mfma_f32_16x16x32_bf16 v[76:79], a[28:31], v[188:191], v[76:79]
  buffer_load_dwordx4 v[156:159], v2, s[60:63], s19 offen offset:1024 sc1
  v_mfma_f32_16x16x32_bf16 v[80:83], a[32:35], v[188:191], v[80:83]
  v_mfma_f32_16x16x32_bf16 v[84:87], a[36:39], v[188:191], v[84:87]
  s_waitcnt vmcnt(7)
  v_mfma_f32_16x16x32_bf16 v[68:71], a[40:43], v[128:131], v[68:71]
  ds_write_b128 v46, v[56:59] offset:2048
  v_mfma_f32_16x16x32_bf16 v[72:75], a[44:47], v[128:131], v[72:75]
  ds_write_b128 v46, v[60:63] offset:3072
  v_mfma_f32_16x16x32_bf16 v[76:79], a[48:51], v[128:131], v[76:79]
  v_mfma_f32_16x16x32_bf16 v[80:83], a[52:55], v[128:131], v[80:83]
  v_mfma_f32_16x16x32_bf16 v[84:87], a[56:59], v[128:131], v[84:87]
  s_waitcnt vmcnt(6)
  v_mfma_f32_16x16x32_bf16 v[68:71], a[60:63], v[132:135], v[68:71]
  ds_write_b128 v46, v[64:67] offset:4096
  v_mfma_f32_16x16x32_bf16 v[72:75], a[64:67], v[132:135], v[72:75]
  v_mfma_f32_16x16x32_bf16 v[76:79], a[68:71], v[132:135], v[76:79]
  v_mfma_f32_16x16x32_bf16 v[80:83], a[72:75], v[132:135], v[80:83]
  v_mfma_f32_16x16x32_bf16 v[84:87], a[76:79], v[132:135], v[84:87]
  s_waitcnt vmcnt(5)
  v_mfma_f32_16x16x32_bf16 v[68:71], a[80:83], v[136:139], v[68:71]
  s_mul_i32 s15, s7, 5120
  v_mfma_f32_16x16x32_bf16 v[72:75], a[84:87], v[136:139], v[72:75]
  v_add_u32_e64 v47, s15, v2
  v_mfma_f32_16x16x32_bf16 v[76:79], a[88:91], v[136:139], v[76:79]
  v_mfma_f32_16x16x32_bf16 v[80:83], a[92:95], v[136:139], v[80:83]
  v_mfma_f32_16x16x32_bf16 v[84:87], a[96:99], v[136:139], v[84:87]
  s_waitcnt vmcnt(4)
  v_mfma_f32_16x16x32_bf16 v[68:71], a[100:103], v[140:143], v[68:71]
  s_waitcnt vmcnt(0)
  s_waitcnt lgkmcnt(0)
  s_barrier
  ds_read_b128 v[192:195], v47 offset:0
  v_mfma_f32_16x16x32_bf16 v[72:75], a[104:107], v[140:143], v[72:75]
  ds_read_b128 v[196:199], v47 offset:1024
  v_mfma_f32_16x16x32_bf16 v[76:79], a[108:111], v[140:143], v[76:79]
  ds_read_b128 v[200:203], v47 offset:2048
  v_mfma_f32_16x16x32_bf16 v[80:83], a[112:115], v[140:143], v[80:83]
  ds_read_b128 v[204:207], v47 offset:3072
  v_mfma_f32_16x16x32_bf16 v[84:87], a[116:119], v[140:143], v[84:87]
  ds_read_b128 v[208:211], v47 offset:4096
  v_mfma_f32_16x16x32_bf16 v[68:71], a[120:123], v[144:147], v[68:71]
  v_mfma_f32_16x16x32_bf16 v[72:75], a[124:127], v[144:147], v[72:75]
  v_mfma_f32_16x16x32_bf16 v[76:79], a[128:131], v[144:147], v[76:79]
  v_mfma_f32_16x16x32_bf16 v[80:83], a[132:135], v[144:147], v[80:83]
  v_mfma_f32_16x16x32_bf16 v[84:87], a[136:139], v[144:147], v[84:87]
  v_mfma_f32_16x16x32_bf16 v[68:71], a[140:143], v[148:151], v[68:71]
  s_lshl_b32 s12, s5, 15
  s_lshl_b32 s13, s7, 8
  v_mfma_f32_16x16x32_bf16 v[72:75], a[144:147], v[148:151], v[72:75]
  s_add_u32 s12, s12, s13
  v_mfma_f32_16x16x32_bf16 v[76:79], a[148:151], v[148:151], v[76:79]
  s_add_u32 s12, s12, 1312768
  v_mfma_f32_16x16x32_bf16 v[80:83], a[152:155], v[148:151], v[80:83]
  s_lshl_b32 s13, s6, 12
  v_mfma_f32_16x16x32_bf16 v[84:87], a[156:159], v[148:151], v[84:87]
  s_add_u32 s13, s13, s12
  v_mfma_f32_16x16x32_bf16 v[68:71], a[160:163], v[152:155], v[68:71]
  v_mfma_f32_16x16x32_bf16 v[72:75], a[164:167], v[152:155], v[72:75]
  v_mfma_f32_16x16x32_bf16 v[76:79], a[168:171], v[152:155], v[76:79]
  v_mfma_f32_16x16x32_bf16 v[80:83], a[172:175], v[152:155], v[80:83]
  v_mfma_f32_16x16x32_bf16 v[84:87], a[176:179], v[152:155], v[84:87]
  v_mfma_f32_16x16x32_bf16 v[68:71], a[180:183], v[156:159], v[68:71]
  v_mfma_f32_16x16x32_bf16 v[72:75], a[184:187], v[156:159], v[72:75]
  v_mfma_f32_16x16x32_bf16 v[76:79], a[188:191], v[156:159], v[76:79]
  v_mfma_f32_16x16x32_bf16 v[80:83], a[192:195], v[156:159], v[80:83]
  v_mfma_f32_16x16x32_bf16 v[84:87], a[196:199], v[156:159], v[84:87]
  s_waitcnt lgkmcnt(0)
  s_nop 2
  v_pk_add_f32 v[68:69], v[68:69], v[192:193]
  v_pk_add_f32 v[70:71], v[70:71], v[194:195]
  v_pk_add_f32 v[72:73], v[72:73], v[196:197]
  v_pk_add_f32 v[74:75], v[74:75], v[198:199]
  v_pk_add_f32 v[76:77], v[76:77], v[200:201]
  v_pk_add_f32 v[78:79], v[78:79], v[202:203]
  v_pk_add_f32 v[80:81], v[80:81], v[204:205]
  v_pk_add_f32 v[82:83], v[82:83], v[206:207]
  v_pk_add_f32 v[84:85], v[84:85], v[208:209]
  v_pk_add_f32 v[86:87], v[86:87], v[210:211]
  v_pk_add_f32 v[212:213], v[68:69], v[70:71]
  v_pk_mul_f32 v[214:215], v[68:69], v[68:69]
  v_pk_fma_f32 v[214:215], v[70:71], v[70:71], v[214:215]
  v_pk_add_f32 v[212:213], v[212:213], v[72:73]
  v_pk_fma_f32 v[214:215], v[72:73], v[72:73], v[214:215]
  v_pk_add_f32 v[212:213], v[212:213], v[74:75]
  v_pk_fma_f32 v[214:215], v[74:75], v[74:75], v[214:215]
  v_pk_add_f32 v[212:213], v[212:213], v[76:77]
  v_pk_fma_f32 v[214:215], v[76:77], v[76:77], v[214:215]
  v_pk_add_f32 v[212:213], v[212:213], v[78:79]
  v_pk_fma_f32 v[214:215], v[78:79], v[78:79], v[214:215]
  v_pk_add_f32 v[212:213], v[212:213], v[80:81]
  v_pk_fma_f32 v[214:215], v[80:81], v[80:81], v[214:215]
  v_pk_add_f32 v[212:213], v[212:213], v[82:83]
  v_pk_fma_f32 v[214:215], v[82:83], v[82:83], v[214:215]
  v_pk_add_f32 v[212:213], v[212:213], v[84:85]
  v_pk_fma_f32 v[214:215], v[84:85], v[84:85], v[214:215]
  v_pk_add_f32 v[212:213], v[212:213], v[86:87]
  v_pk_fma_f32 v[214:215], v[86:87], v[86:87], v[214:215]
  v_add_f32 v228, v212, v213
  v_add_f32 v229, v214, v215
  v_mov_b32 v230, s8
  v_mov_b32 v231, s8
  v_mov_b32 v212, v228
  v_mov_b32 v213, v229
  s_nop 0
  v_permlane32_swap_b32 v228, v212
  v_permlane32_swap_b32 v229, v213
  v_add_f32 v228, v228, v212
  v_add_f32 v229, v229, v213
  v_mov_b32 v212, v228
  v_mov_b32 v213, v229
  s_nop 0
  v_permlane16_swap_b32 v228, v212
  v_permlane16_swap_b32 v229, v213
  v_add_f32 v228, v228, v212
  v_add_f32_e64 v229, v229, v213
  s_mov_b64 exec, 0xffff
  s_cmp_eq_u32 s9, 0
  s_cbranch_scc1 slow_92
  buffer_store_dwordx4 v[228:231], v2, s[52:55], s13 offen
back_93:
  s_mov_b64 exec, -1
  s_mul_i32 s14, s7, 10240
  s_add_u32 s14, s14, 102400
  v_lshrrev_b32 v12, 1, v3
  v_xor_b32 v12, v12, v4
  v_and_b32 v12, 3, v12
  v_lshlrev_b32_e64 v12, 4, v12
  v_lshl_add_u32 v12, v3, 6, v12
  v_add_u32_e64 v44, s14, v12
  ds_write_b128 v44, v[68:71] offset:0
  ds_write_b128 v44, v[72:75] offset:1024
  ds_write_b128 v44, v[76:79] offset:2048
  ds_write_b128 v44, v[80:83] offset:3072
  ds_write_b128 v44, v[84:87] offset:4096
  v_lshrrev_b32 v12, 3, v1
  v_xor_b32 v12, v12, v1
  v_and_b32 v12, 3, v12
  v_lshlrev_b32 v12, 4, v12
  v_lshrrev_b32_e64 v13, 2, v1
  v_lshl_add_u32 v12, v13, 6, v12
  v_add_u32_e64 v45, s14, v12
  ds_read_b128 v[160:163], v45 offset:0
  ds_read_b128 v[164:167], v45 offset:1024
  ds_read_b128 v[168:171], v45 offset:2048
  ds_read_b128 v[172:175], v45 offset:3072
  ds_read_b128 v[176:179], v45 offset:4096
  v_and_b32 v14, 3, v1
  v_lshlrev_b32 v11, 13, v14
  v_lshl_add_u32 v11, v13, 4, v11
  s_add_u32 s13, s12, 4096
  v_lshrrev_b32_e64 v12, 2, v13
  v_lshl_add_u32 v12, v12, 2, v13
  v_mul_u32_u24 v12, 2560, v12
  v_lshl_add_u32 v46, v14, 4, v12
  s_lshl_b32 s15, s5, 6
  s_lshr_b32 s88, s7, 1
  s_lshl_b32 s88, s88, 5
  s_add_u32 s15, s15, s88
  s_and_b32 s88, s7, 1
  s_lshl_b32 s88, s88, 2
  s_add_u32 s15, s15, s88
  s_mul_i32 s15, s15, 2560
  s_mul_i32 s88, s6, 320
  s_add_u32 s15, s15, s88
again_94:
  buffer_load_dwordx3 v[128:130], v11, s[52:55], s12 offen sc1
  buffer_load_dwordx3 v[132:134], v11, s[52:55], s13 offen sc1
  s_sub_u32 s10, s10, 1
  s_cmp_gt_i32 s10, 0
  s_waitcnt vmcnt(0)
  v_xor_b32 v15, s8, v130
  v_xor_b32 v14, s8, v134
  v_or_b32 v15, v15, v14
  v_cmp_ne_u32 vcc, 0, v15
  s_cbranch_scc0 out_96
  s_cbranch_vccnz again_94
out_96:
ok_95:
  s_waitcnt lgkmcnt(0)
  v_pk_add_f32 v[128:129], v[128:129], v[132:133]
  s_nop 1
  v_add_f32_dpp v128, v128, v128 quad_perm:[1,0,3,2] row_mask:0xf bank_mask:0xf
  v_add_f32_dpp v129, v129, v129 quad_perm:[1,0,3,2] row_mask:0xf bank_mask:0xf
  s_nop 0
  v_add_f32_dpp v128, v128, v128 quad_perm:[2,3,0,1] row_mask:0xf bank_mask:0xf
  v_add_f32_dpp v129, v129, v129 quad_perm:[2,3,0,1] row_mask:0xf bank_mask:0xf
  v_mul_f32 v128, 0x3acccccd, v128
  v_mul_f32 v202, 0x3acccccd, v129
  v_fma_f32 v202, -v128, v128, v202
  v_max_f32_e64 v202, 0, v202
  v_add_f32 v202, 0x3727c5ac, v202
  v_rsq_f32 v200, v202
  s_nop 0
  v_mul_f32 v201, v128, v200
  s_cmp_eq_u32 s9, 0
  s_cbranch_scc1 slow_97
  v_pk_fma_f32 v[132:133], v[160:161], v[200:201], v[200:201] op_sel:[0,0,1] op_sel_hi:[1,0,1] neg_lo:[0,0,1] neg_hi:[0,0,1]
  v_pk_fma_f32 v[134:135], v[162:163], v[200:201], v[200:201] op_sel:[0,0,1] op_sel_hi:[1,0,1] neg_lo:[0,0,1] neg_hi:[0,0,1]
  v_pk_fma_f32 v[160:161], v[132:133], v[88:89], v[160:161]
  v_pk_fma_f32 v[162:163], v[134:135], v[90:91], v[162:163]
  buffer_store_dwordx4 v[160:163], v46, s[60:63], s15 offen offset:0
  v_pk_fma_f32 v[136:137], v[164:165], v[200:201], v[200:201] op_sel:[0,0,1] op_sel_hi:[1,0,1] neg_lo:[0,0,1] neg_hi:[0,0,1]
  v_pk_fma_f32 v[138:139], v[166:167], v[200:201], v[200:201] op_sel:[0,0,1] op_sel_hi:[1,0,1] neg_lo:[0,0,1] neg_hi:[0,0,1]
  v_pk_fma_f32 v[164:165], v[136:137], v[92:93], v[164:165]
  v_pk_fma_f32 v[166:167], v[138:139], v[94:95], v[166:167]
  buffer_store_dwordx4 v[164:167], v46, s[60:63], s15 offen offset:64
  v_pk_fma_f32 v[132:133], v[168:169], v[200:201], v[200:201] op_sel:[0,0,1] op_sel_hi:[1,0,1] neg_lo:[0,0,1] neg_hi:[0,0,1]
  v_pk_fma_f32 v[134:135], v[170:171], v[200:201], v[200:201] op_sel:[0,0,1] op_sel_hi:[1,0,1] neg_lo:[0,0,1] neg_hi:[0,0,1]
  v_pk_fma_f32 v[168:169], v[132:133], v[96:97], v[168:169]
  v_pk_fma_f32 v[170:171], v[134:135], v[98:99], v[170:171]
  buffer_store_dwordx4 v[168:171], v46, s[60:63], s15 offen offset:128
  v_pk_fma_f32 v[136:137], v[172:173], v[200:201], v[200:201] op_sel:[0,0,1] op_sel_hi:[1,0,1] neg_lo:[0,0,1] neg_hi:[0,0,1]
  v_pk_fma_f32 v[138:139], v[174:175], v[200:201], v[200:201] op_sel:[0,0,1] op_sel_hi:[1,0,1] neg_lo:[0,0,1] neg_hi:[0,0,1]
  v_pk_fma_f32 v[172:173], v[136:137], v[100:101], v[172:173]
  v_pk_fma_f32 v[174:175], v[138:139], v[102:103], v[174:175]
  buffer_store_dwordx4 v[172:175], v46, s[60:63], s15 offen offset:192
  v_pk_fma_f32 v[132:133], v[176:177], v[200:201], v[200:201] op_sel:[0,0,1] op_sel_hi:[1,0,1] neg_lo:[0,0,1] neg_hi:[0,0,1]
  v_pk_fma_f32 v[134:135], v[178:179], v[200:201], v[200:201] op_sel:[0,0,1] op_sel_hi:[1,0,1] neg_lo:[0,0,1] neg_hi:[0,0,1]
  v_pk_fma_f32 v[176:177], v[132:133], v[104:105], v[176:177]
  v_pk_fma_f32 v[178:179], v[134:135], v[106:107], v[178:179]
  buffer_store_dwordx4 v[176:179], v46, s[60:63], s15 offen offset:256
back_98:
L_end:
  s_endpgm
again_13:
  s_sub_u32 s10, s10, 1
  s_cmp_gt_i32 s10, 0
  s_cbranch_scc0 ok_14
  buffer_load_dword v184, v185, s[52:55], s89 offen sc1
  s_waitcnt vmcnt(0)
  v_xor_b32 v15, s8, v184
  v_cmp_lt_u32 vcc, 15, v15
  s_cbranch_vccz ok_14
  s_and_b32 s13, s10, 3
  s_cbranch_scc1 again_13
  buffer_load_dword v184, v185, s[52:55], s89 offen offset:128 sc1
  s_waitcnt vmcnt(0)
  v_xor_b32 v15, s8, v184
  v_cmp_lt_u32 vcc, 15, v15
  s_cbranch_vccnz again_13
  s_branch ok_14
again_15:
  s_sub_u32 s10, s10, 1
  s_cmp_gt_i32 s10, 0
  s_cbranch_scc0 ok_16
  buffer_load_dword v184, v185, s[52:55], s89 offen sc1
  s_waitcnt vmcnt(0)
  v_xor_b32 v15, s8, v184
  v_cmp_lt_u32 vcc, 15, v15
  s_cbranch_vccz ok_16
  s_and_b32 s13, s10, 3
  s_cbranch_scc1 again_15
  buffer_load_dword v184, v185, s[52:55], s89 offen offset:128 sc1
  s_waitcnt vmcnt(0)
  v_xor_b32 v15, s8, v184
  v_cmp_lt_u32 vcc, 15, v15
  s_cbranch_vccnz again_15
  s_branch ok_16
slow_17:
  buffer_store_dword v15, off, s[52:55], s41 sc1
  s_nop 1
  s_branch back_18
again_19:
  s_sub_u32 s10, s10, 1
  s_cmp_gt_i32 s10, 0
  s_cbranch_scc0 ok_20
  buffer_load_dwordx2 v[188:189], v187, s[52:55], s87 offen sc1
  s_waitcnt vmcnt(0)
  v_xor_b32 v15, s8, v188
  v_xor_b32 v14, s8, v189
  v_or_b32 v15, v15, v14
  v_cmp_ne_u32 vcc, 0, v15
  s_cbranch_vccnz again_19
  s_branch ok_20
again_21:
  s_sub_u32 s10, s10, 1
  s_cmp_gt_i32 s10, 0
  s_cbranch_scc0 ok_22
  buffer_load_dwordx3 v[152:154], v160, s[52:55], s93 offen sc1
  buffer_load_dwordx2 v[156:157], v161, s[52:55], s94 offen sc1
  buffer_load_dwordx2 v[158:159], v162, s[52:55], s94 offen offset:512 sc1
  s_waitcnt vmcnt(0)
  v_min3_u32 v15, v154, v154, s8
  v_max3_u32 v14, v154, v154, s8
  v_min3_u32 v15, v15, v157, v159
  v_max3_u32 v14, v14, v157, v159
  v_cmp_ne_u32 vcc, v15, v14
  s_cbranch_vccnz again_21
  s_branch ok_22
again_23:
  s_sub_u32 s10, s10, 1
  s_cmp_gt_i32 s10, 0
  s_cbranch_scc0 ok_24
  buffer_load_dwordx4 v[220:223], v2, s[52:55], s36 offen sc1
  s_waitcnt vmcnt(0)
  v_min3_u32 v15, v220, v221, s8
  v_max3_u32 v14, v220, v221, s8
  v_min3_u32 v15, v15, v222, v223
  v_max3_u32 v14, v14, v222, v223
  v_cmp_ne_u32 vcc, v15, v14
  s_cbranch_vccnz again_23
  s_branch ok_24
again_25:
  s_sub_u32 s10, s10, 1
  s_cmp_gt_i32 s10, 0
  s_cbranch_scc0 ok_26
  buffer_load_dwordx4 v[188:191], v187, s[52:55], s88 offen sc1
  s_waitcnt vmcnt(0)
  v_min3_u32 v15, v188, v189, s8
  v_max3_u32 v14, v188, v189, s8
  v_min3_u32 v15, v15, v190, v191
  v_max3_u32 v14, v14, v190, v191
  v_cmp_ne_u32 vcc, v15, v14
  s_cbranch_vccnz again_25
  s_branch ok_26
slow_38:
  buffer_store_dword v15, off, s[52:55], s14 sc1
  s_nop 1
  s_branch back_39
slow_41:
  buffer_store_dword v15, off, s[52:55], s14 sc1
  s_nop 1
  s_branch back_42
again_44:
  s_sub_u32 s10, s10, 1
  s_cmp_gt_i32 s10, 0
  s_cbranch_scc0 ok_45
  buffer_load_dwordx4 v[120:123], v2, s[52:55], s92 offen sc1
  s_waitcnt vmcnt(0)
  v_min3_u32 v15, v120, v121, s8
  v_max3_u32 v14, v120, v121, s8
  v_min3_u32 v15, v15, v122, v123
  v_max3_u32 v14, v14, v122, v123
  v_cmp_ne_u32 vcc, v15, v14
  s_cbranch_vccnz again_44
  s_branch ok_45
again_49:
  s_sub_u32 s10, s10, 1
  s_cmp_gt_i32 s10, 0
  s_cbranch_scc0 ok_50
  s_mul_i32 s95, s7, 10240
  s_add_u32 s95, s95, 107520
  s_and_b32 s93, s7, 1
  s_lshl_b32 s93, s93, 3
  s_add_u32 s93, s93, s95
  v_add_u32 v253, s93, v2
  s_add_u32 m0, s95, 0
  s_add_u32 s93, s92, 0
  buffer_load_dwordx4 v252, s[52:55], s93 offen sc1 lds
  s_add_u32 m0, s95, 1024
  s_add_u32 s93, s92, 65536
  buffer_load_dwordx4 v252, s[52:55], s93 offen sc1 lds
  s_add_u32 m0, s95, 2048
  s_add_u32 s93, s92, 131072
  buffer_load_dwordx4 v252, s[52:55], s93 offen sc1 lds
  s_add_u32 m0, s95, 3072
  s_add_u32 s93, s92, 196608
  buffer_load_dwordx4 v252, s[52:55], s93 offen sc1 lds
  s_add_u32 m0, s95, 4096
  s_add_u32 s93, s92, 262144
  buffer_load_dwordx4 v252, s[52:55], s93 offen sc1 lds
  s_waitcnt vmcnt(0)
  ds_read_b64_tr_b16 v[232:233], v253 offset:0
  ds_read_b64_tr_b16 v[234:235], v253 offset:1024
  ds_read_b64_tr_b16 v[236:237], v253 offset:2048
  ds_read_b64_tr_b16 v[238:239], v253 offset:3072
  ds_read_b64_tr_b16 v[240:241], v253 offset:4096
  s_waitcnt lgkmcnt(0)
  s_branch redo_51
slow_52:
  buffer_store_dwordx4 v[228:231], v2, s[52:55], s13 offen sc1
  s_nop 1
  s_branch back_53
slow_57:
  buffer_store_dwordx2 v[180:181], v47, s[60:63], s88 offen offset:0 sc1
  buffer_store_dwordx2 v[182:183], v47, s[60:63], s88 offen offset:128 sc1
  buffer_store_dwordx2 v[184:185], v47, s[60:63], s88 offen offset:256 sc1
  buffer_store_dwordx2 v[186:187], v47, s[60:63], s88 offen offset:384 sc1
  buffer_store_dwordx2 v[188:189], v47, s[60:63], s88 offen offset:512 sc1
  s_nop 1
  s_branch back_58
slow_59:
  buffer_store_dword v15, off, s[52:55], s13 sc1
  s_nop 1
  s_branch back_60
slow_65:
  buffer_store_dword v15, off, s[52:55], s12 sc1
  s_nop 1
  s_branch back_66
again_75:
  s_sub_u32 s10, s10, 1
  s_cmp_gt_i32 s10, 0
  s_cbranch_scc0 ok_76
  buffer_load_dword v192, v193, s[52:55], s91 offen sc1
  s_waitcnt vmcnt(0)
  v_xor_b32 v15, s8, v192
  v_cmp_ne_u32 vcc, 0, v15
  s_cbranch_vccnz again_75
  s_branch ok_76
slow_77:
  buffer_store_dwordx4 v[52:55], v47, s[60:63], s13 offen sc1
  s_nop 1
  s_branch back_78
slow_79:
  buffer_store_dwordx4 v[60:63], v47, s[60:63], s13 offen sc1
  s_nop 1
  s_branch back_80
slow_81:
  buffer_store_dwordx4 v[68:71], v47, s[60:63], s13 offen sc1
  s_nop 1
  s_branch back_82
slow_83:
  buffer_store_dwordx4 v[76:79], v47, s[60:63], s13 offen sc1
  s_nop 1
  s_branch back_84
slow_85:
  buffer_store_dwordx4 v[84:87], v47, s[60:63], s13 offen sc1
  s_nop 1
  s_branch back_86
slow_87:
  buffer_store_dword v15, off, s[52:55], s14 sc1
  s_nop 1
  s_branch back_88
slow_92:
  buffer_store_dwordx4 v[228:231], v2, s[52:55], s13 offen sc1
  s_nop 1
  s_branch back_93
slow_97:
  v_pk_fma_f32 v[132:133], v[160:161], v[200:201], v[200:201] op_sel:[0,0,1] op_sel_hi:[1,0,1] neg_lo:[0,0,1] neg_hi:[0,0,1]
  v_pk_fma_f32 v[134:135], v[162:163], v[200:201], v[200:201] op_sel:[0,0,1] op_sel_hi:[1,0,1] neg_lo:[0,0,1] neg_hi:[0,0,1]
  v_pk_fma_f32 v[160:161], v[132:133], v[88:89], v[160:161]
  v_pk_fma_f32 v[162:163], v[134:135], v[90:91], v[162:163]
  buffer_store_dwordx4 v[160:163], v46, s[60:63], s15 offen offset:0 sc1
  v_pk_fma_f32 v[136:137], v[164:165], v[200:201], v[200:201] op_sel:[0,0,1] op_sel_hi:[1,0,1] neg_lo:[0,0,1] neg_hi:[0,0,1]
  v_pk_fma_f32 v[138:139], v[166:167], v[200:201], v[200:201] op_sel:[0,0,1] op_sel_hi:[1,0,1] neg_lo:[0,0,1] neg_hi:[0,0,1]
  v_pk_fma_f32 v[164:165], v[136:137], v[92:93], v[164:165]
  v_pk_fma_f32 v[166:167], v[138:139], v[94:95], v[166:167]
  buffer_store_dwordx4 v[164:167], v46, s[60:63], s15 offen offset:64 sc1
  v_pk_fma_f32 v[132:133], v[168:169], v[200:201], v[200:201] op_sel:[0,0,1] op_sel_hi:[1,0,1] neg_lo:[0,0,1] neg_hi:[0,0,1]
  v_pk_fma_f32 v[134:135], v[170:171], v[200:201], v[200:201] op_sel:[0,0,1] op_sel_hi:[1,0,1] neg_lo:[0,0,1] neg_hi:[0,0,1]
  v_pk_fma_f32 v[168:169], v[132:133], v[96:97], v[168:169]
  v_pk_fma_f32 v[170:171], v[134:135], v[98:99], v[170:171]
  buffer_store_dwordx4 v[168:171], v46, s[60:63], s15 offen offset:128 sc1
  v_pk_fma_f32 v[136:137], v[172:173], v[200:201], v[200:201] op_sel:[0,0,1] op_sel_hi:[1,0,1] neg_lo:[0,0,1] neg_hi:[0,0,1]
  v_pk_fma_f32 v[138:139], v[174:175], v[200:201], v[200:201] op_sel:[0,0,1] op_sel_hi:[1,0,1] neg_lo:[0,0,1] neg_hi:[0,0,1]
  v_pk_fma_f32 v[172:173], v[136:137], v[100:101], v[172:173]
  v_pk_fma_f32 v[174:175], v[138:139], v[102:103], v[174:175]
  buffer_store_dwordx4 v[172:175], v46, s[60:63], s15 offen offset:192 sc1
  v_pk_fma_f32 v[132:133], v[176:177], v[200:201], v[200:201] op_sel:[0,0,1] op_sel_hi:[1,0,1] neg_lo:[0,0,1] neg_hi:[0,0,1]
  v_pk_fma_f32 v[134:135], v[178:179], v[200:201], v[200:201] op_sel:[0,0,1] op_sel_hi:[1,0,1] neg_lo:[0,0,1] neg_hi:[0,0,1]
  v_pk_fma_f32 v[176:177], v[132:133], v[104:105], v[176:177]
  v_pk_fma_f32 v[178:179], v[134:135], v[106:107], v[178:179]
  buffer_store_dwordx4 v[176:179], v46, s[60:63], s15 offen offset:256 sc1
  s_nop 1
  s_branch back_98
  s_endpgm
L_codeend:
.section .rodata,"a"
.p2align 6
.amdhsa_kernel interleave_layers__ssm_conv_s5__ssm_conv_h3__prompt_kernel
  .amdhsa_next_free_vgpr 512
  .amdhsa_next_free_sgpr 102
  .amdhsa_accum_offset 256
  .amdhsa_group_segment_fixed_size 0
  .amdhsa_kernarg_size 144
  .amdhsa_user_sgpr_count 2
  .amdhsa_user_sgpr_kernarg_segment_ptr 1
  .amdhsa_system_sgpr_workgroup_id_x 1
.end_amdhsa_kernel
```
